```python
import torch

def _softmax(x, axis=-1):
    return torch.softmax(x, dim=axis)

def _gelu(x):
    return torch.nn.functional.gelu(x, approximate='tanh')

def _silu(x):
    return torch.nn.functional.silu(x)

def _sigmoid(x):
    return torch.sigmoid(x)

def _layernorm(x, axis=-1, eps=1e-05):
    m = x.mean(dim=axis, keepdim=True)
    v = x.var(dim=axis, keepdim=True, unbiased=False)
    return (x - m) / torch.sqrt(v + eps)

def _scatter_add(tgt, idx, src, axis=0):
    return tgt.clone().index_add_(axis, idx, src)

def _segment_sum(src, seg, n):
    out = torch.zeros((n,) + src.shape[1:], dtype=src.dtype)
    return out.index_add_(0, seg, src)

def _pad(x, pw):
    flat = tuple((v for pair in reversed(pw) for v in pair))
    return torch.nn.functional.pad(x, flat)
kernel_name = 'concat_heads__ssm_conv_s5__memory_aug_recurrent_mem_tr__prompt'

def setup_inputs():

    _w = lambda a: (lambda t: t.to(torch.bfloat16) if t.is_floating_point() else t)(torch.as_tensor(a))

    def _A_setup():
        B, S, D = (1, 2048, 1024)
        P = D
        Lambda_re = -0.5 * (lambda _x: torch.exp(torch.as_tensor(_x)))((lambda *s: torch.randn(*s, dtype=torch.bfloat16) * 0.8)(P))
        Lambda_im = (lambda *s: torch.randn(*s, dtype=torch.bfloat16) * 0.8)(P) * 1.0
        B_re = (lambda *s: torch.randn(*s, dtype=torch.bfloat16) * 0.8)(P, D) * D ** (-0.5)
        B_im = (lambda *s: torch.randn(*s, dtype=torch.bfloat16) * 0.8)(P, D) * D ** (-0.5)
        C_re = (lambda *s: torch.randn(*s, dtype=torch.bfloat16) * 0.8)(D, P) * P ** (-0.5)
        C_im = (lambda *s: torch.randn(*s, dtype=torch.bfloat16) * 0.8)(D, P) * P ** (-0.5)
        log_dt = (lambda *s: torch.randn(*s, dtype=torch.bfloat16) * 0.8)(P) * 0.3 - 2.0
        Dskip = (lambda *s: torch.randn(*s, dtype=torch.bfloat16) * 0.8)(D)
        return {'x': _w((lambda *s: torch.randn(*s, dtype=torch.bfloat16) * 0.05)(B, S, D)), 'Lambda_re': _w(Lambda_re), 'Lambda_im': _w(Lambda_im), 'B_re': _w(B_re), 'B_im': _w(B_im), 'C_re': _w(C_re), 'C_im': _w(C_im), 'log_dt': _w(log_dt), 'Dskip': _w(Dskip)}
    _A_in = _A_setup()

    def _B_setup():
        B, S, Dm = (1, 2048, 1024)
        H, Dh = (32, 128)
        M, seg = (8, 32)
        seg = min(seg, S)
        S = S // seg * seg
        return {'x': _w((lambda *s: torch.randn(*s, dtype=torch.bfloat16) * 0.05)(B, S, Dm)), 'mem0': _w((lambda *s: torch.randn(*s, dtype=torch.bfloat16) * 0.8)(B, M, Dm)), 'Wq': _w((lambda *s: torch.randn(*s, dtype=torch.bfloat16) * 3.2)(Dm, H, Dh) * Dm ** (-0.5)), 'Wk': _w((lambda *s: torch.randn(*s, dtype=torch.bfloat16) * 3.2)(Dm, H, Dh) * Dm ** (-0.5)), 'Wv': _w((lambda *s: torch.randn(*s, dtype=torch.bfloat16) * 0.8)(Dm, H, Dh) * Dm ** (-0.5)), 'Wo': _w((lambda *s: torch.randn(*s, dtype=torch.bfloat16) * 0.8)(H, Dh, Dm) * (H * Dh) ** (-0.5)), 'seg_len': seg}
    _B_in = _B_setup()
    return {'A_x': _A_in['x'], 'A_Lambda_re': _A_in['Lambda_re'], 'A_Lambda_im': _A_in['Lambda_im'], 'A_B_re': _A_in['B_re'], 'A_B_im': _A_in['B_im'], 'A_C_re': _A_in['C_re'], 'A_C_im': _A_in['C_im'], 'A_log_dt': _A_in['log_dt'], 'A_Dskip': _A_in['Dskip'], 'B_x': _B_in['x'], 'B_mem0': _B_in['mem0'], 'B_Wq': _B_in['Wq'], 'B_Wk': _B_in['Wk'], 'B_Wv': _B_in['Wv'], 'B_Wo': _B_in['Wo'], 'B_seg_len': _B_in['seg_len']}

def reference(A_x, A_Lambda_re, A_Lambda_im, A_B_re, A_B_im, A_C_re, A_C_im, A_log_dt, A_Dskip, B_x, B_mem0, B_Wq, B_Wk, B_Wv, B_Wo, B_seg_len):

    def _A_ref(x, Lambda_re, Lambda_im, B_re, B_im, C_re, C_im, log_dt, Dskip):
        Bsz, L, H = x.shape
        Lam = Lambda_re + 1j * Lambda_im
        Bmat = B_re + 1j * B_im
        Cmat = C_re + 1j * C_im
        dt = torch.exp(log_dt)
        Lam_bar = torch.exp(dt * Lam)
        B_bar = ((Lam_bar - 1.0) / Lam)[:, None] * Bmat
        Bu = torch.einsum('bld,pd->blp', x + 0j, B_bar)
        h = torch.zeros_like(Bu[:, 0, :])
        hs = []
        for t in range(L):
            h = Lam_bar[None, :] * h + Bu[:, t, :]
            hs.append(h)
        hseq = torch.stack(hs, 1)
        y = 2.0 * torch.einsum('blp,dp->bld', hseq, Cmat).real + x * Dskip[None, None, :]
        return y

    def _B_ref(x, mem0, Wq, Wk, Wv, Wo, seg_len):
        B, S, Dm = x.shape
        H, Dh = (Wq.shape[1], Wq.shape[2])
        M = mem0.shape[1]
        scale = Dh ** (-0.5)
        n_seg = S // seg_len
        L = M + seg_len
        idx = torch.arange(L)
        mask = (idx[:, None] < M) | (idx[:, None] >= idx[None, :])
        mem = mem0
        outs = []
        for s in range(n_seg):
            xs = x[:, s * seg_len:(s + 1) * seg_len, :].clone()
            h = torch.concatenate([mem, xs], axis=1)
            q = torch.einsum('btd,dhe->bhte', h, Wq)
            k = torch.einsum('btd,dhe->bhte', h, Wk)
            v = torch.einsum('btd,dhe->bhte', h, Wv)
            scores = torch.einsum('bhqe,bhke->bhqk', q, k) * scale
            scores = torch.where(mask[None, None], scores, -1000000000.0)
            p = _softmax(scores, axis=-1)
            o = torch.einsum('bhqk,bhke->bhqe', p, v)
            o = torch.einsum('bhte,hed->btd', o, Wo)
            mem = o[:, :M, :].clone()
            outs.append(o[:, M:, :])
        return torch.concatenate(outs, axis=1)
    a = _A_ref(A_x, A_Lambda_re, A_Lambda_im, A_B_re, A_B_im, A_C_re, A_C_im, A_log_dt, A_Dskip)
    b = _B_ref(B_x, B_mem0, B_Wq, B_Wk, B_Wv, B_Wo, B_seg_len)
    return torch.concatenate([a, b], axis=-1)
```

```asm
; @launch kernel=chain_kernel grid=(256,1,1) block=(256,1,1) lds=163840
.amdgcn_target "amdgcn-amd-amdhsa--gfx950"
.text
.globl chain_kernel
.p2align 8
.type chain_kernel,@function
chain_kernel:
    s_cmp_ge_u32 s2, 256
    s_cbranch_scc1 chain_kernel_end
    s_load_dwordx16 s[64:79], s[0:1], 0
    s_load_dwordx16 s[80:95], s[0:1], 64
    s_load_dwordx4 s[96:99], s[0:1], 128
    s_load_dwordx2 s[100:101], s[0:1], 144
    s_waitcnt lgkmcnt(0)
    s_add_u32 s8, s100, 0x5000000
    s_addc_u32 s9, s101, 0
    s_and_b32 s9, s9, 0xffff
    s_mov_b32 s10, 0x180000
    s_mov_b32 s11, 0x00020000
    s_lshl_b32 s3, s2, 13
    v_lshlrev_b32 v1, 4, v0
    v_mov_b32 v4, 0xff81ff81
    v_mov_b32 v5, 0xff81ff81
    v_mov_b32 v6, 0xff81ff81
    v_mov_b32 v7, 0xff81ff81
    buffer_store_dwordx4 v[4:7], v1, s[8:11], s3 offen sc1
    s_add_u32 s3, s3, 4096
    buffer_store_dwordx4 v[4:7], v1, s[8:11], s3 offen sc1
    s_add_u32 s3, s3, 4096
    s_add_u32 s8, s100, 0x8000000
    s_addc_u32 s9, s101, 0
    s_and_b32 s9, s9, 0xffff
    s_mov_b32 s10, 0x4600000
    s_mov_b32 s11, 0x00020000
    s_add_u32 s4, s8, 0x1fffff
    s_and_b32 s4, s4, 0xffe00000
    s_sub_u32 s4, s4, s8
    s_lshl_b32 s3, s2, 14
    s_add_u32 s3, s3, s4
    s_mov_b32 s5, s3
    buffer_store_dwordx4 v[4:7], v1, s[8:11], s3 offen sc1
    s_add_u32 s3, s3, 4096
    buffer_store_dwordx4 v[4:7], v1, s[8:11], s3 offen sc1
    s_add_u32 s3, s3, 4096
    buffer_store_dwordx4 v[4:7], v1, s[8:11], s3 offen sc1
    s_add_u32 s3, s3, 4096
    buffer_store_dwordx4 v[4:7], v1, s[8:11], s3 offen sc1
    s_add_u32 s3, s3, 4096
    s_add_u32 s3, s3, 0x3fc000
    s_add_u32 s8, s100, 0x5900000
    s_addc_u32 s9, s101, 0
    s_and_b32 s9, s9, 0xffff
    s_mov_b32 s10, 0x10000
    s_mov_b32 s11, 0x00020000
    s_lshl_b32 s3, s2, 12
    v_mov_b32 v8, 0
    v_mov_b32 v9, 0
    v_mov_b32 v10, 0
    v_mov_b32 v11, 0
    buffer_store_dwordx4 v[8:11], v1, s[8:11], s3 offen sc1
    s_getreg_b32 s16, hwreg(HW_REG_XCC_ID)
    s_and_b32 s16, s16, 7
    v_lshrrev_b32 v1, 6, v0
    s_nop 0
    v_readfirstlane_b32 s18, v1
    s_cmp_lg_u32 s18, 0
    s_cbranch_scc1 L_role_1
    s_lshl_b32 s3, s16, 2
    s_add_u32 s3, s3, 128
    s_mov_b32 s17, 1
    s_atomic_add s17, s[98:99], s3 glc
    v_mov_b32 v2, 0
    s_waitcnt lgkmcnt(0)
    v_mov_b32 v1, s17
    ds_write_b32 v2, v1
    s_waitcnt lgkmcnt(0)
L_role_1:
    s_barrier
    v_mov_b32 v2, 0
    ds_read_b32 v1, v2
    s_waitcnt lgkmcnt(0)
    v_readfirstlane_b32 s17, v1
    s_nop 4
    s_mov_b32 s28, 1
    s_cmp_ge_u32 s16, 4
    s_cbranch_scc1 L_novote_2
    s_cmp_lg_u32 s18, 0
    s_cbranch_scc1 L_novote_2
    s_and_b32 s5, s2, 127
    s_lshl_b32 s5, s5, 14
    s_add_u32 s5, s5, s4
    s_add_u32 s5, s5, 0xc000800
    s_add_u32 s12, s100, s5
    s_addc_u32 s13, s101, 0
    s_mov_b32 s20, -1
    s_mov_b32 s21, -1
    s_mov_b32 s7, 0
    s_memtime s[22:23]
    s_waitcnt lgkmcnt(0)
    s_atomic_add s7, s[12:13], 0x0 glc
    s_waitcnt lgkmcnt(0)
    s_memtime s[24:25]
    s_waitcnt lgkmcnt(0)
    s_mov_b32 s7, 0
    s_memtime s[22:23]
    s_waitcnt lgkmcnt(0)
    s_atomic_add s7, s[12:13], 0x2000 glc
    s_waitcnt lgkmcnt(0)
    s_memtime s[24:25]
    s_waitcnt lgkmcnt(0)
    s_sub_u32 s24, s24, s22
    s_min_u32 s21, s21, s24
    s_mov_b32 s7, 0
    s_memtime s[22:23]
    s_waitcnt lgkmcnt(0)
    s_atomic_add s7, s[12:13], 0x0 glc
    s_waitcnt lgkmcnt(0)
    s_memtime s[24:25]
    s_waitcnt lgkmcnt(0)
    s_sub_u32 s24, s24, s22
    s_min_u32 s20, s20, s24
    s_mov_b32 s7, 0
    s_memtime s[22:23]
    s_waitcnt lgkmcnt(0)
    s_atomic_add s7, s[12:13], 0x2000 glc
    s_waitcnt lgkmcnt(0)
    s_memtime s[24:25]
    s_waitcnt lgkmcnt(0)
    s_sub_u32 s24, s24, s22
    s_min_u32 s21, s21, s24
    s_mov_b32 s7, 0
    s_memtime s[22:23]
    s_waitcnt lgkmcnt(0)
    s_atomic_add s7, s[12:13], 0x0 glc
    s_waitcnt lgkmcnt(0)
    s_memtime s[24:25]
    s_waitcnt lgkmcnt(0)
    s_sub_u32 s24, s24, s22
    s_min_u32 s20, s20, s24
    s_cmp_lt_u32 s21, s20
    s_cselect_b32 s28, 0x10001, 1
L_novote_2:
    s_mov_b32 s26, 0
    s_waitcnt vmcnt(0)
    s_barrier
    s_cmp_lg_u32 s18, 0
    s_cbranch_scc1 L_nosig_3
    s_atomic_add s28, s[98:99], s26
L_nosig_3:
    s_cmp_ge_u32 s17, 32
    s_cbranch_scc1 chain_kernel_end
    s_cmp_ge_u32 s16, 4
    s_cbranch_scc1 chain_kernel_worker
    s_mov_b32 s8, s100
    s_and_b32 s9, s101, 0xffff
    s_mov_b32 s10, 0x10000000
    s_mov_b32 s11, 0x00020000
    s_mov_b32 s33, 0
    s_mov_b32 s24, 0xff00ff
    s_mov_b32 s25, 0xff00ff
    s_mov_b32 s26, 0xff00ff00
    s_mov_b32 s27, 0xff00ff00
    s_mov_b32 s28, 0x0
    s_mov_b32 s29, 0xff00ff
    s_mov_b32 s48, 0xffffffff
    s_mov_b32 s49, 0x0
    s_mov_b32 s50, 0xffff
    s_mov_b32 s51, 0x0
    s_mov_b32 s44, 0x3fb8aa3b
    s_mov_b32 s45, 0x3fb8aa3b
    s_mov_b32 s46, 0x3db504f3
    s_mov_b32 s47, 0x3db504f3
    s_mov_b32 s34, 0xff81ff81
    s_lshl_b32 s36, s16, 14
    s_add_u32 s36, s36, 0x5000000
    s_lshl_b32 s37, s16, 16
    s_add_u32 s37, s37, 0x5040000
    v_mov_b32 v36, s34
    v_mov_b32 v44, 0x3f803f80
    v_mov_b32 v37, s34
    v_mov_b32 v45, 0x3f803f80
    v_mov_b32 v38, s34
    v_mov_b32 v46, 0x3f803f80
    v_mov_b32 v39, s34
    v_mov_b32 v47, 0x3f803f80
    v_and_b32 v250, 63, v0
    v_and_b32 v248, 15, v0
    v_bfe_u32 v249, v0, 4, 2
    v_lshrrev_b32 v251, 6, v0
    v_lshlrev_b32 v1, 4, v250
    s_lshl_b32 s20, s16, 10
    s_lshl_b32 s21, s17, 5
    s_add_u32 s20, s20, s21
    s_and_b32 s30, s17, 3
    v_lshl_add_u32 v252, v251, 12, v1
    s_add_u32 s21, s30, 0
    s_and_b32 s21, s21, 3
    s_lshl_b32 s21, s21, 10
    v_add_u32 v2, s21, v252
    s_add_u32 s21, s30, 1
    s_and_b32 s21, s21, 3
    s_lshl_b32 s21, s21, 10
    v_add_u32 v3, s21, v252
    s_add_u32 s21, s30, 2
    s_and_b32 s21, s21, 3
    s_lshl_b32 s21, s21, 10
    v_add_u32 v4, s21, v252
    s_add_u32 s21, s30, 3
    s_and_b32 s21, s21, 3
    s_lshl_b32 s21, s21, 10
    v_add_u32 v5, s21, v252
    v_mov_b32 v6, 0x44444444
    v_mov_b32 v252, 0xeeeeeeee
    v_cndmask_b32 v6, v6, v252, s[26:27]
    v_bfe_u32 v252, v250, 1, 3
    v_and_b32 v253, 1, v250
    v_lshlrev_b32 v33, 11, v252
    v_lshl_add_u32 v33, v253, 3, v33
    v_lshl_add_u32 v33, v249, 4, v33
    s_lshl_b32 s21, s17, 6
    v_add_u32 v33, s21, v33
    v_lshlrev_b32 v8, 3, v250
    s_lshl_b32 s21, s17, 9
    v_add_u32 v8, s21, v8
    v_lshlrev_b32 v11, 4, v248
    v_lshl_add_u32 v11, v249, 7, v11
    v_add_u32 v11, s21, v11
    s_lshr_b32 s22, s17, 2
    s_lshl_b32 s22, s22, 13
    s_add_u32 s21, s17, 0
    s_and_b32 s21, s21, 3
    s_lshl_b32 s21, s21, 10
    s_add_u32 s21, s21, s22
    v_add_u32 v9, s21, v1
    s_add_u32 s21, s17, 1
    s_and_b32 s21, s21, 3
    s_lshl_b32 s21, s21, 10
    s_add_u32 s21, s21, s22
    v_add_u32 v13, s21, v1
    s_add_u32 s21, s17, 2
    s_and_b32 s21, s21, 3
    s_lshl_b32 s21, s21, 10
    s_add_u32 s21, s21, s22
    v_add_u32 v14, s21, v1
    s_add_u32 s21, s17, 3
    s_and_b32 s21, s21, 3
    s_lshl_b32 s21, s21, 10
    s_add_u32 s21, s21, s22
    v_add_u32 v15, s21, v1
    s_add_u32 s22, s22, 4096
    v_add_u32 v16, s22, v1
    s_and_b32 s21, s17, 3
    s_lshl_b32 s21, s21, 8
    s_add_u32 s21, s21, s22
    v_and_b32 v253, 1, v249
    v_lshlrev_b32 v10, 4, v248
    v_lshl_add_u32 v10, v253, 7, v10
    v_add_u32 v10, s21, v10
    v_lshl_add_u32 v20, v251, 11, v1
    v_lshrrev_b32 v252, 1, v249
    v_lshl_add_u32 v252, v251, 1, v252
    v_lshlrev_b32 v21, 10, v252
    v_lshl_add_u32 v21, v248, 5, v21
    v_lshl_add_u32 v21, v253, 4, v21
    v_add_u32 v21, 8192, v21
    v_lshlrev_b32 v22, 5, v248
    v_lshl_add_u32 v22, v249, 3, v22
    v_add_u32 v22, 8192, v22
    v_lshrrev_b32 v253, 2, v248
    v_and_b32 v252, 3, v248
    v_lshl_add_u32 v253, v253, 3, v252
    v_add_u32 v25, 24576, v1
    v_add_u32 v26, 26624, v1
    v_lshlrev_b32 v32, 4, v253
    v_lshl_add_u32 v29, v249, 9, v32
    v_lshl_add_u32 v32, v249, 2, v32
    v_add_u32 v32, 33792, v32
    s_add_u32 s21, s16, 0
    s_and_b32 s21, s21, 3
    s_lshl_b32 s21, s21, 18
    s_lshr_b32 s22, s17, 1
    s_lshl_b32 s22, s22, 14
    s_add_u32 s21, s21, s22
    s_and_b32 s22, s17, 1
    s_lshl_b32 s22, s22, 12
    s_add_u32 s23, s21, s22
    v_add_u32 v12, s23, v1
    s_add_u32 s21, s16, 1
    s_and_b32 s21, s21, 3
    s_lshl_b32 s21, s21, 18
    s_lshr_b32 s22, s17, 1
    s_lshl_b32 s22, s22, 14
    s_add_u32 s21, s21, s22
    s_and_b32 s22, s17, 1
    s_lshl_b32 s22, s22, 12
    s_add_u32 s21, s21, s22
    v_add_u32 v17, s21, v1
    s_add_u32 s21, s16, 2
    s_and_b32 s21, s21, 3
    s_lshl_b32 s21, s21, 18
    s_lshr_b32 s22, s17, 1
    s_lshl_b32 s22, s22, 14
    s_add_u32 s21, s21, s22
    s_and_b32 s22, s17, 1
    s_lshl_b32 s22, s22, 12
    s_add_u32 s21, s21, s22
    v_add_u32 v18, s21, v1
    s_add_u32 s21, s16, 3
    s_and_b32 s21, s21, 3
    s_lshl_b32 s21, s21, 18
    s_lshr_b32 s22, s17, 1
    s_lshl_b32 s22, s22, 14
    s_add_u32 s21, s21, s22
    s_and_b32 s22, s17, 1
    s_lshl_b32 s22, s22, 12
    s_add_u32 s21, s21, s22
    v_add_u32 v19, s21, v1
    v_add_u32 v29, s23, v29
    v_and_b32 v253, 8, v248
    v_add_u32 v253, v253, v248
    v_lshlrev_b32 v27, 4, v253
    v_lshl_add_u32 v27, v249, 9, v27
    v_add_u32 v27, s23, v27
    v_bfe_u32 v253, v248, 2, 1
    v_lshl_add_u32 v252, v252, 1, v253
    v_cndmask_b32 v252, v248, v252, s[26:27]
    v_lshlrev_b32 v30, 4, v252
    v_lshl_add_u32 v30, v249, 7, v30
    v_add_u32 v30, s23, v30
    v_and_b32 v253, 1, v252
    v_lshlrev_b32 v253, 4, v253
    v_mov_b32 v254, 0x3f80
    v_lshlrev_b32 v254, v253, v254
    v_lshrrev_b32 v253, 2, v252
    v_xor_b32 v253, v253, v249
    v_and_b32 v253, 1, v253
    v_bfe_u32 v252, v252, 1, 1
    v_lshl_add_u32 v252, v253, 2, v252
    v_lshrrev_b32 v253, 3, v248
    v_lshl_add_u32 v252, v253, 1, v252
    v_cmp_eq_u32 vcc, 0, v252
    s_nop 1
    v_cndmask_b32 v40, 0, v254, vcc
    v_cmp_eq_u32 vcc, 1, v252
    s_nop 1
    v_cndmask_b32 v41, 0, v254, vcc
    v_cmp_eq_u32 vcc, 2, v252
    s_nop 1
    v_cndmask_b32 v42, 0, v254, vcc
    v_cmp_eq_u32 vcc, 3, v252
    s_nop 1
    v_cndmask_b32 v43, 0, v254, vcc
    v_bfe_u32 v248, v0, 4, 2
    v_lshlrev_b32 v250, 1, v248
    v_bfe_u32 v248, v0, 2, 1
    v_add_u32 v250, v250, v248
    v_bfe_u32 v248, v0, 3, 1
    v_lshl_add_u32 v250, v248, 3, v250
    v_lshrrev_b32 v248, 6, v0
    v_lshl_add_u32 v250, v248, 8, v250
    v_and_b32 v249, 3, v0
    v_lshlrev_b32 v251, 13, v250
    v_lshl_add_u32 v251, v249, 4, v251
    s_lshl_b32 s21, s20, 1
    v_add_u32 v251, s21, v251
    s_lshl_b32 s21, s16, 10
    v_add_u32 v252, s21, v250
    v_lshlrev_b32 v252, 11, v252
    v_lshl_add_u32 v252, v249, 4, v252
    s_lshl_b32 s21, s17, 6
    v_add_u32 v252, s21, v252
    v_bfe_u32 v248, v0, 4, 2
    v_lshlrev_b32 v248, 3, v248
    v_bfe_u32 v242, v0, 2, 2
    v_add_u32 v248, v248, v242
    v_lshlrev_b32 v242, 6, v248
    v_lshrrev_b32 v248, 6, v0
    v_lshl_add_u32 v242, v248, 14, v242
    v_lshl_add_u32 v240, v249, 3, v242
    v_and_b32 v241, 2, v249
    v_lshl_add_u32 v240, v241, 3, v240
    v_lshl_add_u32 v242, v249, 4, v242
    v_add_u32 v241, 0x10000, v240
    v_add_u32 v243, 0x10000, v242
    v_lshl_add_u32 v244, v248, 14, v1
    v_add_u32 v245, 0x10000, v244
    s_lshl_b32 s22, s18, 14
    s_add_u32 s22, s22, 32768
    s_mov_b32 s12, s86
    s_and_b32 s13, s87, 0xffff
    s_mov_b32 s14, 0x800000
    s_mov_b32 s15, 0x00020000
    s_add_u32 m0, s22, 0
    s_add_u32 s23, s30, 0
    s_and_b32 s23, s23, 3
    s_lshl_b32 s23, s23, 2
    s_add_u32 s23, s23, 0
    s_mul_i32 s23, s23, 131072
    buffer_load_dwordx4 v251, s[12:15], s23 offen lds
    s_add_u32 m0, s22, 1024
    s_add_u32 s23, s30, 0
    s_and_b32 s23, s23, 3
    s_lshl_b32 s23, s23, 2
    s_add_u32 s23, s23, 1
    s_mul_i32 s23, s23, 131072
    buffer_load_dwordx4 v251, s[12:15], s23 offen lds
    s_add_u32 m0, s22, 2048
    s_add_u32 s23, s30, 0
    s_and_b32 s23, s23, 3
    s_lshl_b32 s23, s23, 2
    s_add_u32 s23, s23, 2
    s_mul_i32 s23, s23, 131072
    buffer_load_dwordx4 v251, s[12:15], s23 offen lds
    s_add_u32 m0, s22, 3072
    s_add_u32 s23, s30, 0
    s_and_b32 s23, s23, 3
    s_lshl_b32 s23, s23, 2
    s_add_u32 s23, s23, 3
    s_mul_i32 s23, s23, 131072
    buffer_load_dwordx4 v251, s[12:15], s23 offen lds
    s_add_u32 m0, s22, 4096
    s_add_u32 s23, s30, 1
    s_and_b32 s23, s23, 3
    s_lshl_b32 s23, s23, 2
    s_add_u32 s23, s23, 0
    s_mul_i32 s23, s23, 131072
    buffer_load_dwordx4 v251, s[12:15], s23 offen lds
    s_add_u32 m0, s22, 5120
    s_add_u32 s23, s30, 1
    s_and_b32 s23, s23, 3
    s_lshl_b32 s23, s23, 2
    s_add_u32 s23, s23, 1
    s_mul_i32 s23, s23, 131072
    buffer_load_dwordx4 v251, s[12:15], s23 offen lds
    s_add_u32 m0, s22, 6144
    s_add_u32 s23, s30, 1
    s_and_b32 s23, s23, 3
    s_lshl_b32 s23, s23, 2
    s_add_u32 s23, s23, 2
    s_mul_i32 s23, s23, 131072
    buffer_load_dwordx4 v251, s[12:15], s23 offen lds
    s_add_u32 m0, s22, 7168
    s_add_u32 s23, s30, 1
    s_and_b32 s23, s23, 3
    s_lshl_b32 s23, s23, 2
    s_add_u32 s23, s23, 3
    s_mul_i32 s23, s23, 131072
    buffer_load_dwordx4 v251, s[12:15], s23 offen lds
    s_add_u32 m0, s22, 8192
    s_add_u32 s23, s30, 2
    s_and_b32 s23, s23, 3
    s_lshl_b32 s23, s23, 2
    s_add_u32 s23, s23, 0
    s_mul_i32 s23, s23, 131072
    buffer_load_dwordx4 v251, s[12:15], s23 offen lds
    s_add_u32 m0, s22, 9216
    s_add_u32 s23, s30, 2
    s_and_b32 s23, s23, 3
    s_lshl_b32 s23, s23, 2
    s_add_u32 s23, s23, 1
    s_mul_i32 s23, s23, 131072
    buffer_load_dwordx4 v251, s[12:15], s23 offen lds
    s_add_u32 m0, s22, 10240
    s_add_u32 s23, s30, 2
    s_and_b32 s23, s23, 3
    s_lshl_b32 s23, s23, 2
    s_add_u32 s23, s23, 2
    s_mul_i32 s23, s23, 131072
    buffer_load_dwordx4 v251, s[12:15], s23 offen lds
    s_add_u32 m0, s22, 11264
    s_add_u32 s23, s30, 2
    s_and_b32 s23, s23, 3
    s_lshl_b32 s23, s23, 2
    s_add_u32 s23, s23, 3
    s_mul_i32 s23, s23, 131072
    buffer_load_dwordx4 v251, s[12:15], s23 offen lds
    s_add_u32 m0, s22, 12288
    s_add_u32 s23, s30, 3
    s_and_b32 s23, s23, 3
    s_lshl_b32 s23, s23, 2
    s_add_u32 s23, s23, 0
    s_mul_i32 s23, s23, 131072
    buffer_load_dwordx4 v251, s[12:15], s23 offen lds
    s_add_u32 m0, s22, 13312
    s_add_u32 s23, s30, 3
    s_and_b32 s23, s23, 3
    s_lshl_b32 s23, s23, 2
    s_add_u32 s23, s23, 1
    s_mul_i32 s23, s23, 131072
    buffer_load_dwordx4 v251, s[12:15], s23 offen lds
    s_add_u32 m0, s22, 14336
    s_add_u32 s23, s30, 3
    s_and_b32 s23, s23, 3
    s_lshl_b32 s23, s23, 2
    s_add_u32 s23, s23, 2
    s_mul_i32 s23, s23, 131072
    buffer_load_dwordx4 v251, s[12:15], s23 offen lds
    s_add_u32 m0, s22, 15360
    s_add_u32 s23, s30, 3
    s_and_b32 s23, s23, 3
    s_lshl_b32 s23, s23, 2
    s_add_u32 s23, s23, 3
    s_mul_i32 s23, s23, 131072
    buffer_load_dwordx4 v251, s[12:15], s23 offen lds
    s_mov_b32 s12, s88
    s_and_b32 s13, s89, 0xffff
    s_mov_b32 s14, 0x800000
    s_mov_b32 s15, 0x00020000
    s_add_u32 m0, s22, 65536
    s_add_u32 s23, s30, 0
    s_and_b32 s23, s23, 3
    s_lshl_b32 s23, s23, 2
    s_add_u32 s23, s23, 0
    s_mul_i32 s23, s23, 131072
    buffer_load_dwordx4 v251, s[12:15], s23 offen lds
    s_add_u32 m0, s22, 66560
    s_add_u32 s23, s30, 0
    s_and_b32 s23, s23, 3
    s_lshl_b32 s23, s23, 2
    s_add_u32 s23, s23, 1
    s_mul_i32 s23, s23, 131072
    buffer_load_dwordx4 v251, s[12:15], s23 offen lds
    s_add_u32 m0, s22, 67584
    s_add_u32 s23, s30, 0
    s_and_b32 s23, s23, 3
    s_lshl_b32 s23, s23, 2
    s_add_u32 s23, s23, 2
    s_mul_i32 s23, s23, 131072
    buffer_load_dwordx4 v251, s[12:15], s23 offen lds
    s_add_u32 m0, s22, 68608
    s_add_u32 s23, s30, 0
    s_and_b32 s23, s23, 3
    s_lshl_b32 s23, s23, 2
    s_add_u32 s23, s23, 3
    s_mul_i32 s23, s23, 131072
    buffer_load_dwordx4 v251, s[12:15], s23 offen lds
    s_add_u32 m0, s22, 69632
    s_add_u32 s23, s30, 1
    s_and_b32 s23, s23, 3
    s_lshl_b32 s23, s23, 2
    s_add_u32 s23, s23, 0
    s_mul_i32 s23, s23, 131072
    buffer_load_dwordx4 v251, s[12:15], s23 offen lds
    s_add_u32 m0, s22, 70656
    s_add_u32 s23, s30, 1
    s_and_b32 s23, s23, 3
    s_lshl_b32 s23, s23, 2
    s_add_u32 s23, s23, 1
    s_mul_i32 s23, s23, 131072
    buffer_load_dwordx4 v251, s[12:15], s23 offen lds
    s_add_u32 m0, s22, 71680
    s_add_u32 s23, s30, 1
    s_and_b32 s23, s23, 3
    s_lshl_b32 s23, s23, 2
    s_add_u32 s23, s23, 2
    s_mul_i32 s23, s23, 131072
    buffer_load_dwordx4 v251, s[12:15], s23 offen lds
    s_add_u32 m0, s22, 72704
    s_add_u32 s23, s30, 1
    s_and_b32 s23, s23, 3
    s_lshl_b32 s23, s23, 2
    s_add_u32 s23, s23, 3
    s_mul_i32 s23, s23, 131072
    buffer_load_dwordx4 v251, s[12:15], s23 offen lds
    s_add_u32 m0, s22, 73728
    s_add_u32 s23, s30, 2
    s_and_b32 s23, s23, 3
    s_lshl_b32 s23, s23, 2
    s_add_u32 s23, s23, 0
    s_mul_i32 s23, s23, 131072
    buffer_load_dwordx4 v251, s[12:15], s23 offen lds
    s_add_u32 m0, s22, 74752
    s_add_u32 s23, s30, 2
    s_and_b32 s23, s23, 3
    s_lshl_b32 s23, s23, 2
    s_add_u32 s23, s23, 1
    s_mul_i32 s23, s23, 131072
    buffer_load_dwordx4 v251, s[12:15], s23 offen lds
    s_add_u32 m0, s22, 75776
    s_add_u32 s23, s30, 2
    s_and_b32 s23, s23, 3
    s_lshl_b32 s23, s23, 2
    s_add_u32 s23, s23, 2
    s_mul_i32 s23, s23, 131072
    buffer_load_dwordx4 v251, s[12:15], s23 offen lds
    s_add_u32 m0, s22, 76800
    s_add_u32 s23, s30, 2
    s_and_b32 s23, s23, 3
    s_lshl_b32 s23, s23, 2
    s_add_u32 s23, s23, 3
    s_mul_i32 s23, s23, 131072
    buffer_load_dwordx4 v251, s[12:15], s23 offen lds
    s_add_u32 m0, s22, 77824
    s_add_u32 s23, s30, 3
    s_and_b32 s23, s23, 3
    s_lshl_b32 s23, s23, 2
    s_add_u32 s23, s23, 0
    s_mul_i32 s23, s23, 131072
    buffer_load_dwordx4 v251, s[12:15], s23 offen lds
    s_add_u32 m0, s22, 78848
    s_add_u32 s23, s30, 3
    s_and_b32 s23, s23, 3
    s_lshl_b32 s23, s23, 2
    s_add_u32 s23, s23, 1
    s_mul_i32 s23, s23, 131072
    buffer_load_dwordx4 v251, s[12:15], s23 offen lds
    s_add_u32 m0, s22, 79872
    s_add_u32 s23, s30, 3
    s_and_b32 s23, s23, 3
    s_lshl_b32 s23, s23, 2
    s_add_u32 s23, s23, 2
    s_mul_i32 s23, s23, 131072
    buffer_load_dwordx4 v251, s[12:15], s23 offen lds
    s_add_u32 m0, s22, 80896
    s_add_u32 s23, s30, 3
    s_and_b32 s23, s23, 3
    s_lshl_b32 s23, s23, 2
    s_add_u32 s23, s23, 3
    s_mul_i32 s23, s23, 131072
    buffer_load_dwordx4 v251, s[12:15], s23 offen lds
    s_mov_b32 s12, s90
    s_and_b32 s13, s91, 0xffff
    s_mov_b32 s14, 0x800000
    s_mov_b32 s15, 0x00020000
    s_add_u32 s23, s30, 0
    s_and_b32 s23, s23, 3
    s_lshl_b32 s23, s23, 2
    s_add_u32 s23, s23, 0
    s_mul_i32 s23, s23, 131072
    buffer_load_dwordx4 v[112:115], v251, s[12:15], s23 offen
    s_add_u32 s23, s30, 0
    s_and_b32 s23, s23, 3
    s_lshl_b32 s23, s23, 2
    s_add_u32 s23, s23, 1
    s_mul_i32 s23, s23, 131072
    buffer_load_dwordx4 v[116:119], v251, s[12:15], s23 offen
    s_add_u32 s23, s30, 0
    s_and_b32 s23, s23, 3
    s_lshl_b32 s23, s23, 2
    s_add_u32 s23, s23, 2
    s_mul_i32 s23, s23, 131072
    buffer_load_dwordx4 v[120:123], v251, s[12:15], s23 offen
    s_add_u32 s23, s30, 0
    s_and_b32 s23, s23, 3
    s_lshl_b32 s23, s23, 2
    s_add_u32 s23, s23, 3
    s_mul_i32 s23, s23, 131072
    buffer_load_dwordx4 v[124:127], v251, s[12:15], s23 offen
    s_add_u32 s23, s30, 1
    s_and_b32 s23, s23, 3
    s_lshl_b32 s23, s23, 2
    s_add_u32 s23, s23, 0
    s_mul_i32 s23, s23, 131072
    buffer_load_dwordx4 v[128:131], v251, s[12:15], s23 offen
    s_add_u32 s23, s30, 1
    s_and_b32 s23, s23, 3
    s_lshl_b32 s23, s23, 2
    s_add_u32 s23, s23, 1
    s_mul_i32 s23, s23, 131072
    buffer_load_dwordx4 v[132:135], v251, s[12:15], s23 offen
    s_add_u32 s23, s30, 1
    s_and_b32 s23, s23, 3
    s_lshl_b32 s23, s23, 2
    s_add_u32 s23, s23, 2
    s_mul_i32 s23, s23, 131072
    buffer_load_dwordx4 v[136:139], v251, s[12:15], s23 offen
    s_add_u32 s23, s30, 1
    s_and_b32 s23, s23, 3
    s_lshl_b32 s23, s23, 2
    s_add_u32 s23, s23, 3
    s_mul_i32 s23, s23, 131072
    buffer_load_dwordx4 v[140:143], v251, s[12:15], s23 offen
    s_add_u32 s23, s30, 2
    s_and_b32 s23, s23, 3
    s_lshl_b32 s23, s23, 2
    s_add_u32 s23, s23, 0
    s_mul_i32 s23, s23, 131072
    buffer_load_dwordx4 v[144:147], v251, s[12:15], s23 offen
    s_add_u32 s23, s30, 2
    s_and_b32 s23, s23, 3
    s_lshl_b32 s23, s23, 2
    s_add_u32 s23, s23, 1
    s_mul_i32 s23, s23, 131072
    buffer_load_dwordx4 v[148:151], v251, s[12:15], s23 offen
    s_add_u32 s23, s30, 2
    s_and_b32 s23, s23, 3
    s_lshl_b32 s23, s23, 2
    s_add_u32 s23, s23, 2
    s_mul_i32 s23, s23, 131072
    buffer_load_dwordx4 v[152:155], v251, s[12:15], s23 offen
    s_add_u32 s23, s30, 2
    s_and_b32 s23, s23, 3
    s_lshl_b32 s23, s23, 2
    s_add_u32 s23, s23, 3
    s_mul_i32 s23, s23, 131072
    buffer_load_dwordx4 v[156:159], v251, s[12:15], s23 offen
    s_add_u32 s23, s30, 3
    s_and_b32 s23, s23, 3
    s_lshl_b32 s23, s23, 2
    s_add_u32 s23, s23, 0
    s_mul_i32 s23, s23, 131072
    buffer_load_dwordx4 v[160:163], v251, s[12:15], s23 offen
    s_add_u32 s23, s30, 3
    s_and_b32 s23, s23, 3
    s_lshl_b32 s23, s23, 2
    s_add_u32 s23, s23, 1
    s_mul_i32 s23, s23, 131072
    buffer_load_dwordx4 v[164:167], v251, s[12:15], s23 offen
    s_add_u32 s23, s30, 3
    s_and_b32 s23, s23, 3
    s_lshl_b32 s23, s23, 2
    s_add_u32 s23, s23, 2
    s_mul_i32 s23, s23, 131072
    buffer_load_dwordx4 v[168:171], v251, s[12:15], s23 offen
    s_add_u32 s23, s30, 3
    s_and_b32 s23, s23, 3
    s_lshl_b32 s23, s23, 2
    s_add_u32 s23, s23, 3
    s_mul_i32 s23, s23, 131072
    buffer_load_dwordx4 v[172:175], v251, s[12:15], s23 offen
    s_waitcnt vmcnt(32)
    s_mov_b32 s12, s92
    s_and_b32 s13, s93, 0xffff
    s_mov_b32 s14, 0x800000
    s_mov_b32 s15, 0x00020000
    s_add_u32 s23, s30, 0
    s_and_b32 s23, s23, 3
    s_lshl_b32 s23, s23, 2
    s_add_u32 s23, s23, 0
    s_mul_i32 s23, s23, 32768
    buffer_load_dwordx4 v[48:51], v252, s[12:15], s23 offen
    s_add_u32 s23, s30, 0
    s_and_b32 s23, s23, 3
    s_lshl_b32 s23, s23, 2
    s_add_u32 s23, s23, 1
    s_mul_i32 s23, s23, 32768
    buffer_load_dwordx4 v[52:55], v252, s[12:15], s23 offen
    s_add_u32 s23, s30, 0
    s_and_b32 s23, s23, 3
    s_lshl_b32 s23, s23, 2
    s_add_u32 s23, s23, 2
    s_mul_i32 s23, s23, 32768
    buffer_load_dwordx4 v[56:59], v252, s[12:15], s23 offen
    s_add_u32 s23, s30, 0
    s_and_b32 s23, s23, 3
    s_lshl_b32 s23, s23, 2
    s_add_u32 s23, s23, 3
    s_mul_i32 s23, s23, 32768
    buffer_load_dwordx4 v[60:63], v252, s[12:15], s23 offen
    s_add_u32 s23, s30, 1
    s_and_b32 s23, s23, 3
    s_lshl_b32 s23, s23, 2
    s_add_u32 s23, s23, 0
    s_mul_i32 s23, s23, 32768
    buffer_load_dwordx4 v[64:67], v252, s[12:15], s23 offen
    s_add_u32 s23, s30, 1
    s_and_b32 s23, s23, 3
    s_lshl_b32 s23, s23, 2
    s_add_u32 s23, s23, 1
    s_mul_i32 s23, s23, 32768
    buffer_load_dwordx4 v[68:71], v252, s[12:15], s23 offen
    s_add_u32 s23, s30, 1
    s_and_b32 s23, s23, 3
    s_lshl_b32 s23, s23, 2
    s_add_u32 s23, s23, 2
    s_mul_i32 s23, s23, 32768
    buffer_load_dwordx4 v[72:75], v252, s[12:15], s23 offen
    s_add_u32 s23, s30, 1
    s_and_b32 s23, s23, 3
    s_lshl_b32 s23, s23, 2
    s_add_u32 s23, s23, 3
    s_mul_i32 s23, s23, 32768
    buffer_load_dwordx4 v[76:79], v252, s[12:15], s23 offen
    s_add_u32 s23, s30, 2
    s_and_b32 s23, s23, 3
    s_lshl_b32 s23, s23, 2
    s_add_u32 s23, s23, 0
    s_mul_i32 s23, s23, 32768
    buffer_load_dwordx4 v[80:83], v252, s[12:15], s23 offen
    s_add_u32 s23, s30, 2
    s_and_b32 s23, s23, 3
    s_lshl_b32 s23, s23, 2
    s_add_u32 s23, s23, 1
    s_mul_i32 s23, s23, 32768
    buffer_load_dwordx4 v[84:87], v252, s[12:15], s23 offen
    s_add_u32 s23, s30, 2
    s_and_b32 s23, s23, 3
    s_lshl_b32 s23, s23, 2
    s_add_u32 s23, s23, 2
    s_mul_i32 s23, s23, 32768
    buffer_load_dwordx4 v[88:91], v252, s[12:15], s23 offen
    s_add_u32 s23, s30, 2
    s_and_b32 s23, s23, 3
    s_lshl_b32 s23, s23, 2
    s_add_u32 s23, s23, 3
    s_mul_i32 s23, s23, 32768
    buffer_load_dwordx4 v[92:95], v252, s[12:15], s23 offen
    s_add_u32 s23, s30, 3
    s_and_b32 s23, s23, 3
    s_lshl_b32 s23, s23, 2
    s_add_u32 s23, s23, 0
    s_mul_i32 s23, s23, 32768
    buffer_load_dwordx4 v[96:99], v252, s[12:15], s23 offen
    s_add_u32 s23, s30, 3
    s_and_b32 s23, s23, 3
    s_lshl_b32 s23, s23, 2
    s_add_u32 s23, s23, 1
    s_mul_i32 s23, s23, 32768
    buffer_load_dwordx4 v[100:103], v252, s[12:15], s23 offen
    s_add_u32 s23, s30, 3
    s_and_b32 s23, s23, 3
    s_lshl_b32 s23, s23, 2
    s_add_u32 s23, s23, 2
    s_mul_i32 s23, s23, 32768
    buffer_load_dwordx4 v[104:107], v252, s[12:15], s23 offen
    s_add_u32 s23, s30, 3
    s_and_b32 s23, s23, 3
    s_lshl_b32 s23, s23, 2
    s_add_u32 s23, s23, 3
    s_mul_i32 s23, s23, 32768
    buffer_load_dwordx4 v[108:111], v252, s[12:15], s23 offen
    ds_read_b64_tr_b16 a[0:1], v240 offset:32768
    ds_read_b64_tr_b16 a[2:3], v240 offset:33024
    ds_read_b64_tr_b16 a[4:5], v240 offset:34816
    ds_read_b64_tr_b16 a[6:7], v240 offset:35072
    ds_read_b64_tr_b16 a[32:33], v240 offset:32784
    ds_read_b64_tr_b16 a[34:35], v240 offset:33040
    ds_read_b64_tr_b16 a[36:37], v240 offset:34832
    ds_read_b64_tr_b16 a[38:39], v240 offset:35088
    s_waitcnt lgkmcnt(0)
    ds_read_b64_tr_b16 a[8:9], v240 offset:36864
    ds_read_b64_tr_b16 a[10:11], v240 offset:37120
    ds_read_b64_tr_b16 a[12:13], v240 offset:38912
    ds_read_b64_tr_b16 a[14:15], v240 offset:39168
    ds_read_b64_tr_b16 a[40:41], v240 offset:36880
    ds_read_b64_tr_b16 a[42:43], v240 offset:37136
    ds_read_b64_tr_b16 a[44:45], v240 offset:38928
    ds_read_b64_tr_b16 a[46:47], v240 offset:39184
    s_waitcnt lgkmcnt(0)
    ds_read_b64_tr_b16 a[16:17], v240 offset:40960
    ds_read_b64_tr_b16 a[18:19], v240 offset:41216
    ds_read_b64_tr_b16 a[20:21], v240 offset:43008
    ds_read_b64_tr_b16 a[22:23], v240 offset:43264
    ds_read_b64_tr_b16 a[48:49], v240 offset:40976
    ds_read_b64_tr_b16 a[50:51], v240 offset:41232
    ds_read_b64_tr_b16 a[52:53], v240 offset:43024
    ds_read_b64_tr_b16 a[54:55], v240 offset:43280
    s_waitcnt lgkmcnt(0)
    ds_read_b64_tr_b16 a[24:25], v240 offset:45056
    ds_read_b64_tr_b16 a[26:27], v240 offset:45312
    ds_read_b64_tr_b16 a[28:29], v240 offset:47104
    ds_read_b64_tr_b16 a[30:31], v240 offset:47360
    ds_read_b64_tr_b16 a[56:57], v240 offset:45072
    ds_read_b64_tr_b16 a[58:59], v240 offset:45328
    ds_read_b64_tr_b16 a[60:61], v240 offset:47120
    ds_read_b64_tr_b16 a[62:63], v240 offset:47376
    s_waitcnt lgkmcnt(0)
    s_waitcnt vmcnt(32)
    ds_read_b64_tr_b16 a[64:65], v241 offset:32768
    ds_read_b64_tr_b16 a[66:67], v241 offset:33024
    ds_read_b64_tr_b16 a[68:69], v241 offset:34816
    ds_read_b64_tr_b16 a[70:71], v241 offset:35072
    ds_read_b64_tr_b16 a[96:97], v241 offset:32784
    ds_read_b64_tr_b16 a[98:99], v241 offset:33040
    ds_read_b64_tr_b16 a[100:101], v241 offset:34832
    ds_read_b64_tr_b16 a[102:103], v241 offset:35088
    s_waitcnt lgkmcnt(0)
    ds_read_b64_tr_b16 a[72:73], v241 offset:36864
    ds_read_b64_tr_b16 a[74:75], v241 offset:37120
    ds_read_b64_tr_b16 a[76:77], v241 offset:38912
    ds_read_b64_tr_b16 a[78:79], v241 offset:39168
    ds_read_b64_tr_b16 a[104:105], v241 offset:36880
    ds_read_b64_tr_b16 a[106:107], v241 offset:37136
    ds_read_b64_tr_b16 a[108:109], v241 offset:38928
    ds_read_b64_tr_b16 a[110:111], v241 offset:39184
    s_waitcnt lgkmcnt(0)
    ds_read_b64_tr_b16 a[80:81], v241 offset:40960
    ds_read_b64_tr_b16 a[82:83], v241 offset:41216
    ds_read_b64_tr_b16 a[84:85], v241 offset:43008
    ds_read_b64_tr_b16 a[86:87], v241 offset:43264
    ds_read_b64_tr_b16 a[112:113], v241 offset:40976
    ds_read_b64_tr_b16 a[114:115], v241 offset:41232
    ds_read_b64_tr_b16 a[116:117], v241 offset:43024
    ds_read_b64_tr_b16 a[118:119], v241 offset:43280
    s_waitcnt lgkmcnt(0)
    ds_read_b64_tr_b16 a[88:89], v241 offset:45056
    ds_read_b64_tr_b16 a[90:91], v241 offset:45312
    ds_read_b64_tr_b16 a[92:93], v241 offset:47104
    ds_read_b64_tr_b16 a[94:95], v241 offset:47360
    ds_read_b64_tr_b16 a[120:121], v241 offset:45072
    ds_read_b64_tr_b16 a[122:123], v241 offset:45328
    ds_read_b64_tr_b16 a[124:125], v241 offset:47120
    ds_read_b64_tr_b16 a[126:127], v241 offset:47376
    s_waitcnt lgkmcnt(0)
    s_waitcnt vmcnt(16)
    ds_write_b128 v244, v[112:115] offset:32768
    ds_write_b128 v244, v[116:119] offset:33792
    ds_write_b128 v244, v[120:123] offset:34816
    ds_write_b128 v244, v[124:127] offset:35840
    ds_write_b128 v244, v[128:131] offset:36864
    ds_write_b128 v244, v[132:135] offset:37888
    ds_write_b128 v244, v[136:139] offset:38912
    ds_write_b128 v244, v[140:143] offset:39936
    ds_write_b128 v244, v[144:147] offset:40960
    ds_write_b128 v244, v[148:151] offset:41984
    ds_write_b128 v244, v[152:155] offset:43008
    ds_write_b128 v244, v[156:159] offset:44032
    ds_write_b128 v244, v[160:163] offset:45056
    ds_write_b128 v244, v[164:167] offset:46080
    ds_write_b128 v244, v[168:171] offset:47104
    ds_write_b128 v244, v[172:175] offset:48128
    s_waitcnt lgkmcnt(0)
    ds_read_b64_tr_b16 a[128:129], v242 offset:32768
    ds_read_b64_tr_b16 a[130:131], v242 offset:33024
    ds_read_b64_tr_b16 a[132:133], v242 offset:34816
    ds_read_b64_tr_b16 a[134:135], v242 offset:35072
    ds_read_b64_tr_b16 a[160:161], v242 offset:32776
    ds_read_b64_tr_b16 a[162:163], v242 offset:33032
    ds_read_b64_tr_b16 a[164:165], v242 offset:34824
    ds_read_b64_tr_b16 a[166:167], v242 offset:35080
    s_waitcnt lgkmcnt(0)
    ds_read_b64_tr_b16 a[136:137], v242 offset:36864
    ds_read_b64_tr_b16 a[138:139], v242 offset:37120
    ds_read_b64_tr_b16 a[140:141], v242 offset:38912
    ds_read_b64_tr_b16 a[142:143], v242 offset:39168
    ds_read_b64_tr_b16 a[168:169], v242 offset:36872
    ds_read_b64_tr_b16 a[170:171], v242 offset:37128
    ds_read_b64_tr_b16 a[172:173], v242 offset:38920
    ds_read_b64_tr_b16 a[174:175], v242 offset:39176
    s_waitcnt lgkmcnt(0)
    ds_read_b64_tr_b16 a[144:145], v242 offset:40960
    ds_read_b64_tr_b16 a[146:147], v242 offset:41216
    ds_read_b64_tr_b16 a[148:149], v242 offset:43008
    ds_read_b64_tr_b16 a[150:151], v242 offset:43264
    ds_read_b64_tr_b16 a[176:177], v242 offset:40968
    ds_read_b64_tr_b16 a[178:179], v242 offset:41224
    ds_read_b64_tr_b16 a[180:181], v242 offset:43016
    ds_read_b64_tr_b16 a[182:183], v242 offset:43272
    s_waitcnt lgkmcnt(0)
    ds_read_b64_tr_b16 a[152:153], v242 offset:45056
    ds_read_b64_tr_b16 a[154:155], v242 offset:45312
    ds_read_b64_tr_b16 a[156:157], v242 offset:47104
    ds_read_b64_tr_b16 a[158:159], v242 offset:47360
    ds_read_b64_tr_b16 a[184:185], v242 offset:45064
    ds_read_b64_tr_b16 a[186:187], v242 offset:45320
    ds_read_b64_tr_b16 a[188:189], v242 offset:47112
    ds_read_b64_tr_b16 a[190:191], v242 offset:47368
    s_waitcnt lgkmcnt(0)
    s_waitcnt vmcnt(0)
    ds_write_b128 v245, v[48:51] offset:32768
    ds_write_b128 v245, v[52:55] offset:33792
    ds_write_b128 v245, v[56:59] offset:34816
    ds_write_b128 v245, v[60:63] offset:35840
    ds_write_b128 v245, v[64:67] offset:36864
    ds_write_b128 v245, v[68:71] offset:37888
    ds_write_b128 v245, v[72:75] offset:38912
    ds_write_b128 v245, v[76:79] offset:39936
    ds_write_b128 v245, v[80:83] offset:40960
    ds_write_b128 v245, v[84:87] offset:41984
    ds_write_b128 v245, v[88:91] offset:43008
    ds_write_b128 v245, v[92:95] offset:44032
    ds_write_b128 v245, v[96:99] offset:45056
    ds_write_b128 v245, v[100:103] offset:46080
    ds_write_b128 v245, v[104:107] offset:47104
    ds_write_b128 v245, v[108:111] offset:48128
    s_waitcnt lgkmcnt(0)
    ds_read_b64_tr_b16 a[192:193], v243 offset:32768
    ds_read_b64_tr_b16 a[194:195], v243 offset:33024
    ds_read_b64_tr_b16 a[196:197], v243 offset:34816
    ds_read_b64_tr_b16 a[198:199], v243 offset:35072
    ds_read_b64_tr_b16 a[224:225], v243 offset:32776
    ds_read_b64_tr_b16 a[226:227], v243 offset:33032
    ds_read_b64_tr_b16 a[228:229], v243 offset:34824
    ds_read_b64_tr_b16 a[230:231], v243 offset:35080
    s_waitcnt lgkmcnt(0)
    ds_read_b64_tr_b16 a[200:201], v243 offset:36864
    ds_read_b64_tr_b16 a[202:203], v243 offset:37120
    ds_read_b64_tr_b16 a[204:205], v243 offset:38912
    ds_read_b64_tr_b16 a[206:207], v243 offset:39168
    ds_read_b64_tr_b16 a[232:233], v243 offset:36872
    ds_read_b64_tr_b16 a[234:235], v243 offset:37128
    ds_read_b64_tr_b16 a[236:237], v243 offset:38920
    ds_read_b64_tr_b16 a[238:239], v243 offset:39176
    s_waitcnt lgkmcnt(0)
    ds_read_b64_tr_b16 a[208:209], v243 offset:40960
    ds_read_b64_tr_b16 a[210:211], v243 offset:41216
    ds_read_b64_tr_b16 a[212:213], v243 offset:43008
    ds_read_b64_tr_b16 a[214:215], v243 offset:43264
    ds_read_b64_tr_b16 a[240:241], v243 offset:40968
    ds_read_b64_tr_b16 a[242:243], v243 offset:41224
    ds_read_b64_tr_b16 a[244:245], v243 offset:43016
    ds_read_b64_tr_b16 a[246:247], v243 offset:43272
    s_waitcnt lgkmcnt(0)
    ds_read_b64_tr_b16 a[216:217], v243 offset:45056
    ds_read_b64_tr_b16 a[218:219], v243 offset:45312
    ds_read_b64_tr_b16 a[220:221], v243 offset:47104
    ds_read_b64_tr_b16 a[222:223], v243 offset:47360
    ds_read_b64_tr_b16 a[248:249], v243 offset:45064
    ds_read_b64_tr_b16 a[250:251], v243 offset:45320
    ds_read_b64_tr_b16 a[252:253], v243 offset:47112
    ds_read_b64_tr_b16 a[254:255], v243 offset:47368
    s_waitcnt lgkmcnt(0)
    v_bfe_u32 v249, v0, 1, 1
    v_lshlrev_b32 v249, 4, v249
    v_mov_b32 v250, 0x3f80
    v_lshlrev_b32 v250, v249, v250
    v_bfe_u32 v248, v0, 3, 1
    v_bfe_u32 v249, v0, 4, 1
    v_xor_b32 v249, v249, v248
    v_bfe_u32 v248, v0, 2, 1
    v_lshl_add_u32 v248, v249, 2, v248
    v_and_b32 v249, 1, v0
    v_lshl_add_u32 v248, v249, 1, v248
    v_cmp_eq_u32 vcc, 0, v248
    s_nop 1
    v_cndmask_b32 v252, 0, v250, vcc
    v_cmp_eq_u32 vcc, 1, v248
    s_nop 1
    v_cndmask_b32 v253, 0, v250, vcc
    v_cmp_eq_u32 vcc, 2, v248
    s_nop 1
    v_cndmask_b32 v254, 0, v250, vcc
    v_cmp_eq_u32 vcc, 3, v248
    s_nop 1
    v_cndmask_b32 v255, 0, v250, vcc
    v_mov_b32 v64, 0
    v_mov_b32 v65, 0
    v_mov_b32 v66, 0
    v_mov_b32 v67, 0
    v_mov_b32 v68, 0
    v_mov_b32 v69, 0
    v_mov_b32 v70, 0
    v_mov_b32 v71, 0
    v_mov_b32 v72, 0
    v_mov_b32 v73, 0
    v_mov_b32 v74, 0
    v_mov_b32 v75, 0
    v_mov_b32 v76, 0
    v_mov_b32 v77, 0
    v_mov_b32 v78, 0
    v_mov_b32 v79, 0
    v_mov_b32 v80, 0
    v_mov_b32 v81, 0
    v_mov_b32 v82, 0
    v_mov_b32 v83, 0
    v_mov_b32 v84, 0
    v_mov_b32 v85, 0
    v_mov_b32 v86, 0
    v_mov_b32 v87, 0
    v_mov_b32 v145, 0
    v_mov_b32 v147, 0
    v_mov_b32 v165, 0
    s_mov_b32 s12, s84
    s_and_b32 s13, s85, 0xffff
    s_mov_b32 s14, 0x4000
    s_mov_b32 s15, 0x00020000
    buffer_load_dwordx2 v[168:169], v33, s[12:15], 0 offen
    s_waitcnt vmcnt(0)
    s_mov_b32 s12, s98
    s_and_b32 s13, s99, 0xffff
    s_mov_b32 s14, 0x100
    s_mov_b32 s15, 0x00020000
    s_mov_b32 s19, 0
    s_mov_b32 s53, 1
    s_mov_b32 s43, 24576
    s_add_u32 s54, s100, 0x5900000
    s_addc_u32 s55, s101, 0
    v_mov_b32 v34, 0
L_dw_4:
    buffer_load_dword v35, v34, s[12:15], 0 offen sc1
    s_add_u32 s33, s33, 1
    s_cmp_gt_u32 s33, 0x100000
    s_waitcnt vmcnt(0)
    s_cbranch_scc1 chain_kernel_abort
    v_readfirstlane_b32 s20, v35
    s_and_b32 s22, s20, 0xffff
    s_cmp_ge_u32 s22, 256
    s_cbranch_scc1 L_dwok_5
    s_sleep 2
    s_branch L_dw_4
L_dwok_5:
    s_lshr_b32 s21, s20, 16
    s_cmp_gt_u32 s21, 64
    s_cselect_b32 s21, 0x2000, 0x0
    s_add_u32 s35, s100, 0x1fffff
    s_and_b32 s35, s35, 0xffe00000
    s_sub_u32 s52, s35, s100
    s_add_u32 s35, s52, s21
    s_xor_b32 s21, s21, 0x2000
    s_add_u32 s52, s52, s21
    s_mov_b32 s31, s35
    s_cmp_lg_u32 s18, 3
    s_cbranch_scc1 L_init3_6
    s_lshl_b32 s21, s19, 7
    s_add_u32 s21, s21, 0x5900000
    v_mov_b32 v34, 0
L_dw_7:
    buffer_load_dword v35, v34, s[8:11], s21 offen sc1
    s_add_u32 s33, s33, 1
    s_cmp_gt_u32 s33, 0x100000
    s_waitcnt vmcnt(0)
    s_cbranch_scc1 chain_kernel_abort
    v_readfirstlane_b32 s20, v35
    s_cmp_ge_u32 s20, 64
    s_cbranch_scc1 L_dwok_8
    s_sleep 2
    s_branch L_dw_7
L_dwok_8:
    s_add_u32 m0, s43, 0
    s_nop 0
    buffer_load_dwordx4 v27, s[8:11], s31 offen offset:0 lds
    s_add_u32 m0, s43, 896
    s_nop 0
    buffer_load_dwordx4 v27, s[8:11], s31 offen offset:128 lds
    s_add_u32 m0, s43, 0
    s_nop 0
    buffer_load_dwordx4 v29, s[8:11], s31 offen offset:2048 lds
    s_add_u32 m0, s43, 960
    s_nop 0
    buffer_load_dwordx4 v29, s[8:11], s31 offen offset:2112 lds
    s_xor_b32 s43, s43, 4096
    s_waitcnt vmcnt(0)
L_init3_6:
    s_and_b32 s20, s19, 3
    s_lshl_b32 s21, s20, 16
    s_add_u32 s38, s36, s21
    s_add_u32 s41, s38, 0x140000
    s_lshl_b32 s21, s20, 18
    s_add_u32 s40, s37, s21
    s_add_u32 s42, s31, 0x8000000
    s_add_u32 s21, s19, 1
    s_bitcmp1_b32 s21, 1
    s_cselect_b32 s31, s52, s35
    s_lshl_b32 s21, s21, 20
    s_add_u32 s31, s31, s21
    s_add_u32 s20, s20, 1
    s_and_b32 s20, s20, 3
    s_lshl_b32 s20, s20, 16
    s_add_u32 s39, s36, s20
    s_cmp_lg_u32 s18, 0
    s_cbranch_scc1 L_init_9
    v_cmp_eq_u32 vcc, s34, v168
    s_nop 1
    v_cndmask_b32 v168, v168, -1, vcc
    v_cmp_eq_u32 vcc, s34, v169
    s_nop 1
    v_cndmask_b32 v169, v169, -1, vcc
    buffer_store_dwordx2 v[168:169], v8, s[8:11], s38 offen
    s_xor_b32 s43, s43, 4096
    s_setprio 3
L_init_9:
    s_barrier
L_step_10:
    s_nop 15
    s_nop 7
    buffer_load_dwordx4 v[48:51], v2, s[8:11], s38 offen sc1
    v_mov_b32 v88, 0
    v_mov_b32 v89, 0
    v_mov_b32 v90, 0
    v_mov_b32 v91, 0
    v_mov_b32 v92, 0
    v_mov_b32 v93, 0
    v_mov_b32 v94, 0
    v_mov_b32 v95, 0
    ds_read_b128 v[116:119], v25
    ds_read_b128 v[120:123], v25 offset:1024
    v_xor_b32 v25, 0x1000, v25
    s_nop 0
    buffer_load_dwordx4 v[52:55], v3, s[8:11], s38 offen sc1
    s_nop 11
    buffer_load_dwordx4 v[56:59], v4, s[8:11], s38 offen sc1
    s_nop 11
    buffer_load_dwordx4 v[60:63], v5, s[8:11], s38 offen sc1
    s_waitcnt vmcnt(3)
    v_max3_u32 v7, v48, v49, v50
    v_max_u32 v7, v7, v51
    v_cmp_eq_u32 vcc, s34, v7
    s_cbranch_vccnz L_q_a_17
    v_smfmac_f32_16x16x64_bf16 v[64:67], v[48:51], a[0:7], v6
    s_waitcnt vmcnt(2)
    v_max3_u32 v7, v52, v53, v54
    v_max_u32 v7, v7, v55
    v_smfmac_f32_16x16x64_bf16 v[68:71], v[48:51], a[64:71], v6
    v_cmp_eq_u32 vcc, s34, v7
    v_smfmac_f32_16x16x64_bf16 v[72:75], v[48:51], a[32:39], v6
    v_smfmac_f32_16x16x64_bf16 v[76:79], v[48:51], a[96:103], v6
    s_cbranch_vccnz L_q_a_18
    v_smfmac_f32_16x16x64_bf16 v[64:67], v[52:55], a[8:15], v6
    s_waitcnt vmcnt(1)
    v_max3_u32 v7, v56, v57, v58
    v_max_u32 v7, v7, v59
    v_smfmac_f32_16x16x64_bf16 v[68:71], v[52:55], a[72:79], v6
    v_cmp_eq_u32 vcc, s34, v7
    v_smfmac_f32_16x16x64_bf16 v[72:75], v[52:55], a[40:47], v6
    v_smfmac_f32_16x16x64_bf16 v[76:79], v[52:55], a[104:111], v6
    s_cbranch_vccnz L_q_a_19
    v_smfmac_f32_16x16x64_bf16 v[64:67], v[56:59], a[16:23], v6
    s_waitcnt vmcnt(0)
    v_max3_u32 v7, v60, v61, v62
    v_max_u32 v7, v7, v63
    v_smfmac_f32_16x16x64_bf16 v[68:71], v[56:59], a[80:87], v6
    v_cmp_eq_u32 vcc, s34, v7
    v_smfmac_f32_16x16x64_bf16 v[72:75], v[56:59], a[48:55], v6
    v_smfmac_f32_16x16x64_bf16 v[76:79], v[56:59], a[112:119], v6
    s_cbranch_vccnz L_q_a_20
    v_smfmac_f32_16x16x64_bf16 v[64:67], v[60:63], a[24:31], v6
    v_smfmac_f32_16x16x64_bf16 v[68:71], v[60:63], a[88:95], v6
    v_smfmac_f32_16x16x64_bf16 v[72:75], v[60:63], a[56:63], v6
    v_smfmac_f32_16x16x64_bf16 v[76:79], v[60:63], a[120:127], v6
L_gd_a_16:
    v_cvt_pk_bf16_f32 v96, v64, v65
    v_cvt_pk_bf16_f32 v97, v66, v67
    v_cvt_pk_bf16_f32 v98, v68, v69
    v_cvt_pk_bf16_f32 v99, v70, v71
    s_cmp_lg_u32 s18, 0
    v_cvt_pk_bf16_f32 v100, v72, v73
    v_mfma_f32_16x16x32_bf16 v[104:107], v[96:99], v[40:43], 0
    v_cvt_pk_bf16_f32 v101, v74, v75
    v_cvt_pk_bf16_f32 v102, v76, v77
    v_cvt_pk_bf16_f32 v103, v78, v79
    s_nop 1
    v_mfma_f32_16x16x32_bf16 v[108:111], v[100:103], v[40:43], 0
    s_cbranch_scc0 L_help1_11_w0
    s_nop 0
    ds_write_b128 v20, v[104:107]
    s_nop 4
    ds_write_b128 v20, v[108:111] offset:1024
    s_waitcnt lgkmcnt(0)
    s_barrier
    s_cmp_lg_u32 s18, 2
    s_cbranch_scc1 L_poe_99
    s_sub_u32 s20, s19, 1
    s_and_b32 s20, s20, 3
    s_lshl_b32 s21, s20, 16
    s_add_u32 s21, s21, s36
    s_add_u32 s22, s21, 0x140000
    s_lshl_b32 s23, s20, 18
    s_add_u32 s23, s23, s37
    buffer_store_dwordx2 v[36:37], v8, s[8:11], s21 offen
    buffer_store_dwordx2 v[36:37], v8, s[8:11], s22 offen
    buffer_store_dwordx4 v[36:39], v9, s[8:11], s23 offen
    s_mov_b64 exec, s[28:29]
    buffer_store_dwordx4 v[36:39], v10, s[8:11], s23 offen
    s_mov_b64 exec, -1
L_poe_99:
    v_smfmac_f32_16x16x64_bf16 v[80:83], v[48:51], a[128:135], v6
    v_smfmac_f32_16x16x64_bf16 v[84:87], v[48:51], a[160:167], v6
    v_smfmac_f32_16x16x64_bf16 v[80:83], v[52:55], a[136:143], v6
    v_smfmac_f32_16x16x64_bf16 v[84:87], v[52:55], a[168:175], v6
    v_smfmac_f32_16x16x64_bf16 v[80:83], v[56:59], a[144:151], v6
    v_smfmac_f32_16x16x64_bf16 v[84:87], v[56:59], a[176:183], v6
    v_smfmac_f32_16x16x64_bf16 v[80:83], v[60:63], a[152:159], v6
    v_smfmac_f32_16x16x64_bf16 v[84:87], v[60:63], a[184:191], v6
    s_nop 4
    ds_write_b128 v21, v[80:83]
    s_nop 1
    ds_write_b128 v21, v[84:87] offset:512
    s_waitcnt lgkmcnt(0)
    s_barrier
    s_cmp_eq_u32 s18, 1
    s_cbranch_scc1 L_vred_100
L_bar2b_101:
    s_waitcnt lgkmcnt(0)
    s_barrier
    s_cmp_lg_u32 s18, 1
    s_cbranch_scc1 L_np_102
    s_add_u32 s20, s42, 0x400000
    buffer_store_dwordx4 v[36:39], v12, s[8:11], s20 offen offset:0 sc1
    buffer_store_dwordx4 v[36:39], v12, s[8:11], s20 offen offset:1024 sc1
L_np_102:
    s_cmp_lg_u32 s18, 3
    s_cbranch_scc1 L_bar3_12
    s_cmp_ge_u32 s19, 2
    s_cbranch_scc1 L_gated_103
    s_add_u32 s23, s19, 1
    s_lshl_b32 s21, s23, 7
    s_add_u32 s21, s21, 0x5900000
    v_mov_b32 v34, 0
L_dw_104:
    buffer_load_dword v35, v34, s[8:11], s21 offen sc1
    s_add_u32 s33, s33, 1
    s_cmp_gt_u32 s33, 0x100000
    s_waitcnt vmcnt(0)
    s_cbranch_scc1 chain_kernel_abort
    v_readfirstlane_b32 s20, v35
    s_cmp_ge_u32 s20, 64
    s_cbranch_scc1 L_dwok_105
    s_sleep 2
    s_branch L_dw_104
L_dwok_105:
L_gated_103:
    s_add_u32 m0, s43, 0
    s_nop 0
    buffer_load_dwordx4 v27, s[8:11], s31 offen offset:0 lds
    s_add_u32 m0, s43, 896
    s_nop 0
    buffer_load_dwordx4 v27, s[8:11], s31 offen offset:128 lds
    s_add_u32 m0, s43, 0
    s_nop 0
    buffer_load_dwordx4 v29, s[8:11], s31 offen offset:2048 lds
    s_add_u32 m0, s43, 960
    s_nop 0
    buffer_load_dwordx4 v29, s[8:11], s31 offen offset:2112 lds
    s_xor_b32 s43, s43, 4096
    s_branch L_bar3_12
L_vred_100:
    ds_read_b64 v[168:169], v22 offset:0
    ds_read_b64 v[170:171], v22 offset:512
    ds_read_b64 v[172:173], v22 offset:1024
    ds_read_b64 v[174:175], v22 offset:1536
    ds_read_b64 v[176:177], v22 offset:2048
    ds_read_b64 v[178:179], v22 offset:2560
    ds_read_b64 v[180:181], v22 offset:3072
    ds_read_b64 v[182:183], v22 offset:3584
    ds_read_b64 v[184:185], v22 offset:4096
    ds_read_b64 v[186:187], v22 offset:4608
    ds_read_b64 v[188:189], v22 offset:5120
    ds_read_b64 v[190:191], v22 offset:5632
    ds_read_b64 v[192:193], v22 offset:6144
    ds_read_b64 v[194:195], v22 offset:6656
    ds_read_b64 v[196:197], v22 offset:7168
    s_waitcnt lgkmcnt(11)
    ds_read_b64 v[198:199], v22 offset:7680
    s_waitcnt lgkmcnt(8)
    v_pk_add_f32 v[168:169], v[168:169], v[172:173]
    v_pk_add_f32 v[170:171], v[170:171], v[174:175]
    v_pk_add_f32 v[176:177], v[176:177], v[180:181]
    v_pk_add_f32 v[178:179], v[178:179], v[182:183]
    v_pk_add_f32 v[168:169], v[168:169], v[176:177]
    v_pk_add_f32 v[170:171], v[170:171], v[178:179]
    s_waitcnt lgkmcnt(0)
    v_pk_add_f32 v[184:185], v[184:185], v[188:189]
    v_pk_add_f32 v[186:187], v[186:187], v[190:191]
    v_pk_add_f32 v[192:193], v[192:193], v[196:197]
    v_pk_add_f32 v[194:195], v[194:195], v[198:199]
    v_pk_add_f32 v[168:169], v[168:169], v[184:185]
    v_pk_add_f32 v[170:171], v[170:171], v[186:187]
    v_pk_add_f32 v[168:169], v[168:169], v[192:193]
    v_pk_add_f32 v[170:171], v[170:171], v[194:195]
    v_cvt_pk_bf16_f32 v144, v168, v169
    v_cvt_pk_bf16_f32 v146, v170, v171
    ds_write2_b32 v32, v144, v146 offset0:0 offset1:16
    s_branch L_bar2b_101
L_help1_11_w0:
    v_smfmac_f32_16x16x64_bf16 v[80:83], v[48:51], a[128:135], v6
    v_smfmac_f32_16x16x64_bf16 v[84:87], v[48:51], a[160:167], v6
    v_smfmac_f32_16x16x64_bf16 v[80:83], v[52:55], a[136:143], v6
    v_smfmac_f32_16x16x64_bf16 v[84:87], v[52:55], a[168:175], v6
    v_smfmac_f32_16x16x64_bf16 v[80:83], v[56:59], a[144:151], v6
    v_smfmac_f32_16x16x64_bf16 v[84:87], v[56:59], a[176:183], v6
    v_smfmac_f32_16x16x64_bf16 v[80:83], v[60:63], a[152:159], v6
    v_smfmac_f32_16x16x64_bf16 v[84:87], v[60:63], a[184:191], v6
    s_nop 4
    ds_write_b128 v21, v[80:83]
    s_nop 1
    ds_write_b128 v21, v[84:87] offset:512
    s_barrier
    ds_read_b128 v[168:171], v1 offset:2048
    ds_read_b128 v[172:175], v1 offset:3072
    ds_read_b128 v[176:179], v1 offset:4096
    ds_read_b128 v[180:183], v1 offset:5120
    ds_read_b128 v[184:187], v1 offset:6144
    ds_read_b128 v[188:191], v1 offset:7168
    s_waitcnt lgkmcnt(4)
    v_pk_add_f32 v[104:105], v[104:105], v[168:169]
    v_pk_add_f32 v[106:107], v[106:107], v[170:171]
    v_pk_add_f32 v[108:109], v[108:109], v[172:173]
    v_pk_add_f32 v[110:111], v[110:111], v[174:175]
    s_waitcnt lgkmcnt(2)
    v_pk_add_f32 v[104:105], v[104:105], v[176:177]
    v_pk_add_f32 v[106:107], v[106:107], v[178:179]
    v_pk_add_f32 v[108:109], v[108:109], v[180:181]
    v_pk_add_f32 v[110:111], v[110:111], v[182:183]
    s_waitcnt lgkmcnt(0)
    v_pk_add_f32 v[104:105], v[104:105], v[184:185]
    v_pk_add_f32 v[106:107], v[106:107], v[186:187]
    v_pk_add_f32 v[108:109], v[108:109], v[188:189]
    v_pk_add_f32 v[110:111], v[110:111], v[190:191]
    v_cvt_pk_bf16_f32 v112, v104, v105
    v_cvt_pk_bf16_f32 v113, v106, v107
    v_cvt_pk_bf16_f32 v114, v108, v109
    v_cvt_pk_bf16_f32 v115, v110, v111
    s_mov_b64 exec, s[24:25]
    s_nop 0
    v_mfma_f32_16x16x32_bf16 v[124:127], v[116:119], v[112:115], 0
    v_mfma_f32_16x16x32_bf16 v[128:131], v[120:123], v[112:115], 0
    v_mfma_f32_16x16x32_bf16 v[132:135], v[112:115], v[112:115], 0
    s_nop 3
    buffer_store_dwordx4 v[124:127], v9, s[8:11], s40 offen
    s_nop 0
    buffer_store_dwordx4 v[128:131], v9, s[8:11], s40 offen offset:128
    s_mov_b64 exec, s[28:29]
    buffer_store_dwordx4 v[132:135], v10, s[8:11], s40 offen
    s_mov_b64 exec, -1
    s_barrier
    ds_write_b128 v1, v[112:115] offset:32768
    ds_read_b128 v[136:139], v26 offset:0
    ds_read_b128 v[140:143], v26 offset:1024
    v_mov_b32_dpp v124, v128 row_shr:8 row_mask:0xf bank_mask:0xc
    v_mov_b32_dpp v125, v129 row_shr:8 row_mask:0xf bank_mask:0xc
    v_mov_b32_dpp v126, v130 row_shr:8 row_mask:0xf bank_mask:0xc
    v_mov_b32_dpp v127, v131 row_shr:8 row_mask:0xf bank_mask:0xc
    v_xor_b32 v26, 0x1000, v26
    s_cmp_eq_u32 s19, 63
    s_cbranch_scc1 L_bar2b_101
    s_nop 3
    buffer_load_dwordx4 v[200:203], v16, s[8:11], s40 offen sc1
    buffer_load_dwordx4 v[204:207], v13, s[8:11], s40 offen sc1
    buffer_load_dwordx4 v[208:211], v14, s[8:11], s40 offen sc1
    buffer_load_dwordx4 v[212:215], v15, s[8:11], s40 offen sc1
    s_nop 15
    s_nop 7
    buffer_load_dwordx4 v[216:219], v16, s[8:11], s40 offen sc1
    buffer_load_dwordx4 v[220:223], v13, s[8:11], s40 offen sc1
    buffer_load_dwordx4 v[224:227], v14, s[8:11], s40 offen sc1
    buffer_load_dwordx4 v[228:231], v15, s[8:11], s40 offen sc1
    s_waitcnt vmcnt(7)
    v_permlane32_swap_b32 v200, v202
    v_permlane32_swap_b32 v201, v203
    s_waitcnt vmcnt(6)
    v_pk_add_f32 v[154:155], v[200:201], v[202:203]
    v_pk_add_f32 v[148:149], v[124:125], v[204:205]
    v_pk_add_f32 v[150:151], v[126:127], v[206:207]
    v_permlane16_swap_b32 v154, v155
    s_waitcnt vmcnt(5)
    v_pk_add_f32 v[148:149], v[148:149], v[208:209]
    v_pk_add_f32 v[150:151], v[150:151], v[210:211]
    v_add_f32 v152, v154, v155
    s_waitcnt vmcnt(4)
    v_pk_add_f32 v[148:149], v[148:149], v[212:213]
    v_pk_add_f32 v[150:151], v[150:151], v[214:215]
    v_pk_add_f32 v[154:155], v[148:149], v[150:151]
    v_add_f32 v154, v154, v152
    v_cmp_u_f32 vcc, v154, v155
    v_cvt_pk_bf16_f32 v160, 0, v148
    v_cvt_pk_bf16_f32 v161, 0, v149
    v_cvt_pk_bf16_f32 v162, 0, v150
    v_cvt_pk_bf16_f32 v163, 0, v151
    v_cvt_pk_bf16_f32 v176, 0, v152
    s_cbranch_vccnz L_cf_107
L_chead_109:
    s_waitcnt lgkmcnt(0)
    s_barrier
    ds_read_b32 v144, v32
    ds_read_b32 v146, v32 offset:64
    v_pk_mul_f32 v[148:149], v[160:161], s[46:47]
    v_pk_mul_f32 v[150:151], v[162:163], s[46:47]
    v_mul_f32 v152, s46, v176
    v_cvt_pk_bf16_f32 v148, 0, v148
    v_cvt_pk_bf16_f32 v149, 0, v149
    v_cvt_pk_bf16_f32 v150, 0, v150
    v_cvt_pk_bf16_f32 v151, 0, v151
    v_cvt_pk_bf16_f32 v152, 0, v152
    v_max3_f32 v154, v148, v149, v150
    v_max3_f32 v154, v154, v151, v152
    s_nop 1
    v_max_f32_dpp v154, v154, v154 row_ror:8 row_mask:0xf bank_mask:0xf
    v_mov_b32 v156, v154
    s_nop 1
    v_permlane16_swap_b32 v154, v156
    v_max_f32 v154, v154, v156
    v_mov_b32 v156, v154
    s_nop 1
    v_permlane32_swap_b32 v154, v156
    v_max_f32 v154, v154, v156
    v_mul_f32 v154, s44, v154
    v_fma_f32 v152, v152, s44, -v154
    v_exp_f32 v152, v152
    v_pk_fma_f32 v[148:149], v[148:149], s[44:45], v[154:155] op_sel_hi:[1,1,0] neg_lo:[0,0,1] neg_hi:[0,0,1]
    v_pk_fma_f32 v[150:151], v[150:151], s[44:45], v[154:155] op_sel_hi:[1,1,0] neg_lo:[0,0,1] neg_hi:[0,0,1]
    v_mov_b32_dpp v156, v152 row_ror:8 row_mask:0xf bank_mask:0xf
    v_exp_f32 v148, v148
    v_cvt_pk_bf16_f32 v164, v152, v156
    v_exp_f32 v149, v149
    v_exp_f32 v150, v150
    v_mfma_f32_16x16x16_bf16 v[176:179], v[44:45], v[164:165], 0
    v_exp_f32 v151, v151
    s_waitcnt lgkmcnt(0)
    v_cvt_pk_bf16_f32 v160, v148, v149
    v_mfma_f32_16x16x16_bf16 v[168:171], v[144:145], v[164:165], 0
    v_cvt_pk_bf16_f32 v161, v150, v151
    v_mov_b32_dpp v162, v160 row_ror:8 row_mask:0xf bank_mask:0xf
    v_mfma_f32_16x16x16_bf16 v[172:175], v[146:147], v[164:165], 0
    v_mov_b32_dpp v163, v161 row_ror:8 row_mask:0xf bank_mask:0xf
    s_nop 0
    s_mov_b64 exec, s[24:25]
    v_mfma_f32_16x16x32_bf16 v[176:179], v[44:47], v[160:163], v[176:179]
    v_mfma_f32_16x16x32_bf16 v[168:171], v[136:139], v[160:163], v[168:171]
    v_mfma_f32_16x16x32_bf16 v[172:175], v[140:143], v[160:163], v[172:175]
    s_nop 3
    v_rcp_f32 v176, v176
    s_nop 0
    v_pk_mul_f32 v[168:169], v[168:169], v[176:177] op_sel_hi:[1,0]
    v_pk_mul_f32 v[170:171], v[170:171], v[176:177] op_sel_hi:[1,0]
    v_pk_mul_f32 v[172:173], v[172:173], v[176:177] op_sel_hi:[1,0]
    v_pk_mul_f32 v[174:175], v[174:175], v[176:177] op_sel_hi:[1,0]
    v_cvt_pk_bf16_f32 v180, v168, v169
    v_cvt_pk_bf16_f32 v181, v170, v171
    v_cvt_pk_bf16_f32 v182, v172, v173
    v_cvt_pk_bf16_f32 v183, v174, v175
    buffer_store_dwordx4 v[180:183], v11, s[8:11], s41 offen
    s_mov_b64 exec, -1
    s_barrier
    s_nop 7
    s_branch L_bar3_12_e
L_bar3_12:
    s_waitcnt lgkmcnt(0)
    s_barrier
    s_cmp_eq_u32 s19, 63
    s_cbranch_scc1 L_fin_15
L_bar3_12_e:
    s_nop 15
    s_nop 3
    buffer_load_dwordx4 v[48:51], v2, s[8:11], s41 offen sc1
    v_mov_b32 v64, 0
    v_mov_b32 v65, 0
    v_mov_b32 v66, 0
    v_mov_b32 v67, 0
    v_mov_b32 v68, 0
    v_mov_b32 v69, 0
    v_mov_b32 v70, 0
    v_mov_b32 v71, 0
    v_mov_b32 v72, 0
    v_mov_b32 v73, 0
    v_mov_b32 v74, 0
    v_mov_b32 v75, 0
    buffer_load_dwordx4 v[52:55], v3, s[8:11], s41 offen sc1
    v_mov_b32 v76, 0
    v_mov_b32 v77, 0
    v_mov_b32 v78, 0
    v_mov_b32 v79, 0
    v_mov_b32 v80, 0
    v_mov_b32 v81, 0
    v_mov_b32 v82, 0
    v_mov_b32 v83, 0
    v_mov_b32 v84, 0
    v_mov_b32 v85, 0
    v_mov_b32 v86, 0
    v_mov_b32 v87, 0
    buffer_load_dwordx4 v[56:59], v4, s[8:11], s41 offen sc1
    s_nop 11
    buffer_load_dwordx4 v[60:63], v5, s[8:11], s41 offen sc1
    s_waitcnt vmcnt(3)
    v_max3_u32 v7, v48, v49, v50
    v_max_u32 v7, v7, v51
    v_cmp_eq_u32 vcc, s34, v7
    s_cbranch_vccnz L_q_e_111
    v_smfmac_f32_16x16x64_bf16 v[88:91], v[48:51], a[192:199], v6
    s_waitcnt vmcnt(2)
    v_max3_u32 v7, v52, v53, v54
    v_max_u32 v7, v7, v55
    v_cmp_eq_u32 vcc, s34, v7
    v_smfmac_f32_16x16x64_bf16 v[92:95], v[48:51], a[224:231], v6
    s_cbranch_vccnz L_q_e_112
    v_smfmac_f32_16x16x64_bf16 v[88:91], v[52:55], a[200:207], v6
    s_waitcnt vmcnt(1)
    v_max3_u32 v7, v56, v57, v58
    v_max_u32 v7, v7, v59
    v_cmp_eq_u32 vcc, s34, v7
    v_smfmac_f32_16x16x64_bf16 v[92:95], v[52:55], a[232:239], v6
    s_cbranch_vccnz L_q_e_113
    v_smfmac_f32_16x16x64_bf16 v[88:91], v[56:59], a[208:215], v6
    s_waitcnt vmcnt(0)
    v_max3_u32 v7, v60, v61, v62
    v_max_u32 v7, v7, v63
    v_cmp_eq_u32 vcc, s34, v7
    v_smfmac_f32_16x16x64_bf16 v[92:95], v[56:59], a[240:247], v6
    s_cbranch_vccnz L_q_e_114
    v_smfmac_f32_16x16x64_bf16 v[88:91], v[60:63], a[216:223], v6
    v_smfmac_f32_16x16x64_bf16 v[92:95], v[60:63], a[248:255], v6
L_gd_e_110:
    s_add_u32 s19, s19, 1
    s_cmp_lg_u32 s18, 0
    s_nop 2
    v_cvt_pk_bf16_f32 v96, v88, v89
    v_cvt_pk_bf16_f32 v97, v90, v91
    s_nop 0
    v_cvt_pk_bf16_f32 v98, v92, v93
    v_cvt_pk_bf16_f32 v99, v94, v95
    s_nop 1
    v_mfma_f32_16x16x32_bf16 v[104:107], v[96:99], v[252:255], 0
    s_cbranch_scc1 L_help2_13
    s_barrier
    ds_read_b128 v[172:175], v1 offset:18432
    ds_read_b128 v[176:179], v1 offset:20480
    ds_read_b128 v[180:183], v1 offset:22528
    s_waitcnt lgkmcnt(2)
    v_pk_add_f32 v[168:169], v[104:105], v[172:173]
    v_pk_add_f32 v[170:171], v[106:107], v[174:175]
    s_waitcnt lgkmcnt(1)
    v_pk_add_f32 v[168:169], v[168:169], v[176:177]
    v_pk_add_f32 v[170:171], v[170:171], v[178:179]
    s_waitcnt lgkmcnt(0)
    v_pk_add_f32 v[168:169], v[168:169], v[180:181]
    v_pk_add_f32 v[170:171], v[170:171], v[182:183]
    buffer_store_dwordx4 v[168:171], v12, s[8:11], s42 offen offset:0 sc1
    buffer_store_dwordx4 v[168:171], v12, s[8:11], s42 offen offset:1024 sc1
    s_mov_b32 s22, s42
    s_mov_b32 s23, s39
    s_and_b32 s20, s19, 3
    s_lshl_b32 s21, s20, 16
    s_add_u32 s38, s36, s21
    s_add_u32 s41, s38, 0x140000
    s_lshl_b32 s21, s20, 18
    s_add_u32 s40, s37, s21
    s_add_u32 s42, s31, 0x8000000
    s_add_u32 s21, s19, 1
    s_bitcmp1_b32 s21, 1
    s_cselect_b32 s31, s52, s35
    s_lshl_b32 s21, s21, 20
    s_add_u32 s31, s31, s21
    s_add_u32 s20, s20, 1
    s_and_b32 s20, s20, 3
    s_lshl_b32 s20, s20, 16
    s_add_u32 s39, s36, s20
    s_nop 15
    s_nop 15
    s_nop 15
    s_nop 13
    buffer_load_dwordx4 v[200:203], v17, s[8:11], s22 offen offset:0 sc1
    buffer_load_dwordx4 v[204:207], v18, s[8:11], s22 offen offset:0 sc1
    buffer_load_dwordx4 v[208:211], v19, s[8:11], s22 offen offset:0 sc1
    s_nop 15
    s_nop 15
    s_nop 7
    buffer_load_dwordx4 v[212:215], v17, s[8:11], s22 offen offset:1024 sc1
    buffer_load_dwordx4 v[216:219], v18, s[8:11], s22 offen offset:1024 sc1
    buffer_load_dwordx4 v[220:223], v19, s[8:11], s22 offen offset:1024 sc1
    ds_read_b128 v[172:175], v1 offset:33792
    s_mov_b64 exec, s[26:27]
    s_waitcnt lgkmcnt(1)
    buffer_store_dwordx4 v[112:115], v30, s[8:11], s22 offen offset:3072 sc1
    s_mov_b64 exec, s[48:49]
    s_waitcnt lgkmcnt(0)
    buffer_store_dwordx4 v[172:175], v12, s[8:11], s22 offen offset:3584 sc1
    s_mov_b64 exec, -1
    s_waitcnt vmcnt(7)
    v_pk_add_f32 v[148:149], v[168:169], v[200:201]
    v_pk_add_f32 v[150:151], v[170:171], v[202:203]
    s_waitcnt vmcnt(6)
    v_pk_add_f32 v[148:149], v[148:149], v[204:205]
    v_pk_add_f32 v[150:151], v[150:151], v[206:207]
    s_waitcnt vmcnt(5)
    v_pk_add_f32 v[148:149], v[148:149], v[208:209]
    v_pk_add_f32 v[150:151], v[150:151], v[210:211]
    v_pk_add_f32 v[154:155], v[148:149], v[150:151]
    v_cmp_u_f32 vcc, v154, v155
    v_cvt_pk_bf16_f32 v180, v148, v149
    v_cvt_pk_bf16_f32 v181, v150, v151
    s_cbranch_vccnz L_gf_193
L_gok_194:
    buffer_store_dwordx2 v[180:181], v8, s[8:11], s23 offen
    s_barrier
    s_nop 7
    s_branch L_step_10
L_help2_13:
    s_nop 2
    ds_write_b128 v20, v[104:107] offset:16384
    s_waitcnt lgkmcnt(0)
    s_barrier
    s_and_b32 s20, s19, 3
    s_lshl_b32 s21, s20, 16
    s_add_u32 s38, s36, s21
    s_add_u32 s41, s38, 0x140000
    s_lshl_b32 s21, s20, 18
    s_add_u32 s40, s37, s21
    s_add_u32 s42, s31, 0x8000000
    s_add_u32 s21, s19, 1
    s_bitcmp1_b32 s21, 1
    s_cselect_b32 s31, s52, s35
    s_lshl_b32 s21, s21, 20
    s_add_u32 s31, s31, s21
    s_add_u32 s20, s20, 1
    s_and_b32 s20, s20, 3
    s_lshl_b32 s20, s20, 16
    s_add_u32 s39, s36, s20
    s_cmp_eq_u32 s18, 3
    s_cbranch_scc1 L_w3_197
    s_xor_b32 s20, s18, 2
    s_or_b32 s20, s20, s16
    s_or_b32 s20, s20, s17
    s_cbranch_scc1 L_bar4_14
    s_cmp_lt_u32 s19, 3
    s_cbranch_scc1 L_bar4_14
    s_atomic_add s53, s[98:99], 0x4
    s_branch L_bar4_14
L_w3_197:
    s_or_b32 s20, s16, s17
    s_cbranch_scc1 L_bar4_14
    s_add_u32 s23, s19, 2
    s_min_u32 s23, s23, 63
    s_lshl_b32 s21, s23, 7
    v_mov_b32 v34, 0
L_dw_198:
    s_load_dword s20, s[54:55], s21 glc
    s_add_u32 s33, s33, 1
    s_cmp_gt_u32 s33, 0x100000
    s_waitcnt lgkmcnt(0)
    s_cbranch_scc1 chain_kernel_abort
    s_cmp_ge_u32 s20, 64
    s_cbranch_scc1 L_dwok_199
    s_sleep 2
    s_branch L_dw_198
L_dwok_199:
L_bar4_14:
    s_barrier
    s_branch L_step_10
L_fin_15:
    s_cmp_lg_u32 s18, 2
    s_cbranch_scc1 chain_kernel_done
    ds_read_b128 v[168:171], v1 offset:32768
    ds_read_b128 v[172:175], v1 offset:33792
    s_mov_b64 exec, s[26:27]
    s_waitcnt lgkmcnt(1)
    buffer_store_dwordx4 v[168:171], v30, s[8:11], s42 offen offset:3072 sc1
    s_mov_b64 exec, s[48:49]
    s_waitcnt lgkmcnt(0)
    buffer_store_dwordx4 v[172:175], v12, s[8:11], s42 offen offset:3584 sc1
    s_mov_b64 exec, -1
    s_lshl_b32 s20, s16, 2
    s_add_u32 s20, s20, 32
    s_waitcnt vmcnt(0)
    s_atomic_add s53, s[98:99], s20
    s_branch chain_kernel_done
L_q_a_20:
    buffer_load_dwordx4 v[60:63], v5, s[8:11], s38 offen sc1
    s_waitcnt vmcnt(2)
    v_max3_u32 v7, v60, v61, v62
    v_max_u32 v7, v7, v63
    v_cmp_eq_u32 vcc, s34, v7
    s_cbranch_vccz L_ok_a_21
    s_add_u32 s33, s33, 1
    s_cmp_gt_u32 s33, 0x100000
    s_cbranch_scc0 L_q_a_20
    s_branch chain_kernel_abort
L_ok_a_21:
    v_smfmac_f32_16x16x64_bf16 v[64:67], v[60:63], a[24:31], v6
    v_smfmac_f32_16x16x64_bf16 v[68:71], v[60:63], a[88:95], v6
    v_smfmac_f32_16x16x64_bf16 v[72:75], v[60:63], a[56:63], v6
    v_smfmac_f32_16x16x64_bf16 v[76:79], v[60:63], a[120:127], v6
    s_branch L_gd_a_16
L_q_a_19:
    buffer_load_dwordx4 v[56:59], v4, s[8:11], s38 offen sc1
    s_waitcnt vmcnt(1)
    v_max3_u32 v7, v60, v61, v62
    v_max_u32 v7, v7, v63
    v_cmp_eq_u32 vcc, s34, v7
    s_cbranch_vccnz L_q_a_22
    v_smfmac_f32_16x16x64_bf16 v[64:67], v[60:63], a[24:31], v6
    v_smfmac_f32_16x16x64_bf16 v[68:71], v[60:63], a[88:95], v6
    v_smfmac_f32_16x16x64_bf16 v[72:75], v[60:63], a[56:63], v6
    v_smfmac_f32_16x16x64_bf16 v[76:79], v[60:63], a[120:127], v6
    s_branch L_q_a_23
L_q_a_23:
    buffer_load_dwordx4 v[56:59], v4, s[8:11], s38 offen sc1
    s_waitcnt vmcnt(2)
    v_max3_u32 v7, v56, v57, v58
    v_max_u32 v7, v7, v59
    v_cmp_eq_u32 vcc, s34, v7
    s_cbranch_vccz L_ok_a_24
    s_add_u32 s33, s33, 1
    s_cmp_gt_u32 s33, 0x100000
    s_cbranch_scc0 L_q_a_23
    s_branch chain_kernel_abort
L_ok_a_24:
    v_smfmac_f32_16x16x64_bf16 v[64:67], v[56:59], a[16:23], v6
    v_smfmac_f32_16x16x64_bf16 v[68:71], v[56:59], a[80:87], v6
    v_smfmac_f32_16x16x64_bf16 v[72:75], v[56:59], a[48:55], v6
    v_smfmac_f32_16x16x64_bf16 v[76:79], v[56:59], a[112:119], v6
    s_branch L_gd_a_16
L_q_a_22:
    buffer_load_dwordx4 v[60:63], v5, s[8:11], s38 offen sc1
    s_waitcnt vmcnt(2)
    v_max3_u32 v7, v56, v57, v58
    v_max_u32 v7, v7, v59
    v_cmp_eq_u32 vcc, s34, v7
    s_cbranch_vccz L_ok_a_25
    buffer_load_dwordx4 v[56:59], v4, s[8:11], s38 offen sc1
    s_waitcnt vmcnt(2)
    v_max3_u32 v7, v60, v61, v62
    v_max_u32 v7, v7, v63
    v_cmp_eq_u32 vcc, s34, v7
    s_cbranch_vccz L_ok_a_26
    s_add_u32 s33, s33, 1
    s_cmp_gt_u32 s33, 0x100000
    s_cbranch_scc0 L_q_a_22
    s_branch chain_kernel_abort
L_ok_a_25:
    v_smfmac_f32_16x16x64_bf16 v[64:67], v[56:59], a[16:23], v6
    v_smfmac_f32_16x16x64_bf16 v[68:71], v[56:59], a[80:87], v6
    v_smfmac_f32_16x16x64_bf16 v[72:75], v[56:59], a[48:55], v6
    v_smfmac_f32_16x16x64_bf16 v[76:79], v[56:59], a[112:119], v6
    s_branch L_q_a_20
L_ok_a_26:
    v_smfmac_f32_16x16x64_bf16 v[64:67], v[60:63], a[24:31], v6
    v_smfmac_f32_16x16x64_bf16 v[68:71], v[60:63], a[88:95], v6
    v_smfmac_f32_16x16x64_bf16 v[72:75], v[60:63], a[56:63], v6
    v_smfmac_f32_16x16x64_bf16 v[76:79], v[60:63], a[120:127], v6
    s_branch L_q_a_23
L_q_a_18:
    buffer_load_dwordx4 v[52:55], v3, s[8:11], s38 offen sc1
    s_waitcnt vmcnt(2)
    v_max3_u32 v7, v56, v57, v58
    v_max_u32 v7, v7, v59
    v_cmp_eq_u32 vcc, s34, v7
    s_cbranch_vccnz L_q_a_27
    v_smfmac_f32_16x16x64_bf16 v[64:67], v[56:59], a[16:23], v6
    v_smfmac_f32_16x16x64_bf16 v[68:71], v[56:59], a[80:87], v6
    v_smfmac_f32_16x16x64_bf16 v[72:75], v[56:59], a[48:55], v6
    v_smfmac_f32_16x16x64_bf16 v[76:79], v[56:59], a[112:119], v6
    s_branch L_q_a_28
L_q_a_28:
    buffer_load_dwordx4 v[52:55], v3, s[8:11], s38 offen sc1
    s_waitcnt vmcnt(2)
    v_max3_u32 v7, v60, v61, v62
    v_max_u32 v7, v7, v63
    v_cmp_eq_u32 vcc, s34, v7
    s_cbranch_vccnz L_q_a_29
    v_smfmac_f32_16x16x64_bf16 v[64:67], v[60:63], a[24:31], v6
    v_smfmac_f32_16x16x64_bf16 v[68:71], v[60:63], a[88:95], v6
    v_smfmac_f32_16x16x64_bf16 v[72:75], v[60:63], a[56:63], v6
    v_smfmac_f32_16x16x64_bf16 v[76:79], v[60:63], a[120:127], v6
    s_branch L_q_a_30
L_q_a_30:
    buffer_load_dwordx4 v[52:55], v3, s[8:11], s38 offen sc1
    s_waitcnt vmcnt(2)
    v_max3_u32 v7, v52, v53, v54
    v_max_u32 v7, v7, v55
    v_cmp_eq_u32 vcc, s34, v7
    s_cbranch_vccz L_ok_a_31
    s_add_u32 s33, s33, 1
    s_cmp_gt_u32 s33, 0x100000
    s_cbranch_scc0 L_q_a_30
    s_branch chain_kernel_abort
L_ok_a_31:
    v_smfmac_f32_16x16x64_bf16 v[64:67], v[52:55], a[8:15], v6
    v_smfmac_f32_16x16x64_bf16 v[68:71], v[52:55], a[72:79], v6
    v_smfmac_f32_16x16x64_bf16 v[72:75], v[52:55], a[40:47], v6
    v_smfmac_f32_16x16x64_bf16 v[76:79], v[52:55], a[104:111], v6
    s_branch L_gd_a_16
L_q_a_29:
    buffer_load_dwordx4 v[60:63], v5, s[8:11], s38 offen sc1
    s_waitcnt vmcnt(2)
    v_max3_u32 v7, v52, v53, v54
    v_max_u32 v7, v7, v55
    v_cmp_eq_u32 vcc, s34, v7
    s_cbranch_vccz L_ok_a_32
    buffer_load_dwordx4 v[52:55], v3, s[8:11], s38 offen sc1
    s_waitcnt vmcnt(2)
    v_max3_u32 v7, v60, v61, v62
    v_max_u32 v7, v7, v63
    v_cmp_eq_u32 vcc, s34, v7
    s_cbranch_vccz L_ok_a_33
    s_add_u32 s33, s33, 1
    s_cmp_gt_u32 s33, 0x100000
    s_cbranch_scc0 L_q_a_29
    s_branch chain_kernel_abort
L_ok_a_32:
    v_smfmac_f32_16x16x64_bf16 v[64:67], v[52:55], a[8:15], v6
    v_smfmac_f32_16x16x64_bf16 v[68:71], v[52:55], a[72:79], v6
    v_smfmac_f32_16x16x64_bf16 v[72:75], v[52:55], a[40:47], v6
    v_smfmac_f32_16x16x64_bf16 v[76:79], v[52:55], a[104:111], v6
    s_branch L_q_a_20
L_ok_a_33:
    v_smfmac_f32_16x16x64_bf16 v[64:67], v[60:63], a[24:31], v6
    v_smfmac_f32_16x16x64_bf16 v[68:71], v[60:63], a[88:95], v6
    v_smfmac_f32_16x16x64_bf16 v[72:75], v[60:63], a[56:63], v6
    v_smfmac_f32_16x16x64_bf16 v[76:79], v[60:63], a[120:127], v6
    s_branch L_q_a_30
L_q_a_27:
    buffer_load_dwordx4 v[56:59], v4, s[8:11], s38 offen sc1
    s_waitcnt vmcnt(2)
    v_max3_u32 v7, v60, v61, v62
    v_max_u32 v7, v7, v63
    v_cmp_eq_u32 vcc, s34, v7
    s_cbranch_vccnz L_q_a_34
    v_smfmac_f32_16x16x64_bf16 v[64:67], v[60:63], a[24:31], v6
    v_smfmac_f32_16x16x64_bf16 v[68:71], v[60:63], a[88:95], v6
    v_smfmac_f32_16x16x64_bf16 v[72:75], v[60:63], a[56:63], v6
    v_smfmac_f32_16x16x64_bf16 v[76:79], v[60:63], a[120:127], v6
    s_branch L_q_a_35
L_q_a_35:
    buffer_load_dwordx4 v[52:55], v3, s[8:11], s38 offen sc1
    s_waitcnt vmcnt(2)
    v_max3_u32 v7, v56, v57, v58
    v_max_u32 v7, v7, v59
    v_cmp_eq_u32 vcc, s34, v7
    s_cbranch_vccz L_ok_a_36
    buffer_load_dwordx4 v[56:59], v4, s[8:11], s38 offen sc1
    s_waitcnt vmcnt(2)
    v_max3_u32 v7, v52, v53, v54
    v_max_u32 v7, v7, v55
    v_cmp_eq_u32 vcc, s34, v7
    s_cbranch_vccz L_ok_a_37
    s_add_u32 s33, s33, 1
    s_cmp_gt_u32 s33, 0x100000
    s_cbranch_scc0 L_q_a_35
    s_branch chain_kernel_abort
L_ok_a_36:
    v_smfmac_f32_16x16x64_bf16 v[64:67], v[56:59], a[16:23], v6
    v_smfmac_f32_16x16x64_bf16 v[68:71], v[56:59], a[80:87], v6
    v_smfmac_f32_16x16x64_bf16 v[72:75], v[56:59], a[48:55], v6
    v_smfmac_f32_16x16x64_bf16 v[76:79], v[56:59], a[112:119], v6
    s_branch L_q_a_30
L_ok_a_37:
    v_smfmac_f32_16x16x64_bf16 v[64:67], v[52:55], a[8:15], v6
    v_smfmac_f32_16x16x64_bf16 v[68:71], v[52:55], a[72:79], v6
    v_smfmac_f32_16x16x64_bf16 v[72:75], v[52:55], a[40:47], v6
    v_smfmac_f32_16x16x64_bf16 v[76:79], v[52:55], a[104:111], v6
    s_branch L_q_a_23
L_q_a_34:
    buffer_load_dwordx4 v[60:63], v5, s[8:11], s38 offen sc1
    s_waitcnt vmcnt(2)
    v_max3_u32 v7, v52, v53, v54
    v_max_u32 v7, v7, v55
    v_cmp_eq_u32 vcc, s34, v7
    s_cbranch_vccz L_ok_a_38
    buffer_load_dwordx4 v[52:55], v3, s[8:11], s38 offen sc1
    s_waitcnt vmcnt(2)
    v_max3_u32 v7, v56, v57, v58
    v_max_u32 v7, v7, v59
    v_cmp_eq_u32 vcc, s34, v7
    s_cbranch_vccz L_ok_a_39
    buffer_load_dwordx4 v[56:59], v4, s[8:11], s38 offen sc1
    s_waitcnt vmcnt(2)
    v_max3_u32 v7, v60, v61, v62
    v_max_u32 v7, v7, v63
    v_cmp_eq_u32 vcc, s34, v7
    s_cbranch_vccz L_ok_a_40
    s_add_u32 s33, s33, 1
    s_cmp_gt_u32 s33, 0x100000
    s_cbranch_scc0 L_q_a_34
    s_branch chain_kernel_abort
L_ok_a_38:
    v_smfmac_f32_16x16x64_bf16 v[64:67], v[52:55], a[8:15], v6
    v_smfmac_f32_16x16x64_bf16 v[68:71], v[52:55], a[72:79], v6
    v_smfmac_f32_16x16x64_bf16 v[72:75], v[52:55], a[40:47], v6
    v_smfmac_f32_16x16x64_bf16 v[76:79], v[52:55], a[104:111], v6
    s_branch L_q_a_41
L_ok_a_39:
    v_smfmac_f32_16x16x64_bf16 v[64:67], v[56:59], a[16:23], v6
    v_smfmac_f32_16x16x64_bf16 v[68:71], v[56:59], a[80:87], v6
    v_smfmac_f32_16x16x64_bf16 v[72:75], v[56:59], a[48:55], v6
    v_smfmac_f32_16x16x64_bf16 v[76:79], v[56:59], a[112:119], v6
    s_branch L_q_a_42
L_ok_a_40:
    v_smfmac_f32_16x16x64_bf16 v[64:67], v[60:63], a[24:31], v6
    v_smfmac_f32_16x16x64_bf16 v[68:71], v[60:63], a[88:95], v6
    v_smfmac_f32_16x16x64_bf16 v[72:75], v[60:63], a[56:63], v6
    v_smfmac_f32_16x16x64_bf16 v[76:79], v[60:63], a[120:127], v6
    s_branch L_q_a_35
L_q_a_42:
    buffer_load_dwordx4 v[52:55], v3, s[8:11], s38 offen sc1
    s_waitcnt vmcnt(2)
    v_max3_u32 v7, v60, v61, v62
    v_max_u32 v7, v7, v63
    v_cmp_eq_u32 vcc, s34, v7
    s_cbranch_vccz L_ok_a_43
    buffer_load_dwordx4 v[60:63], v5, s[8:11], s38 offen sc1
    s_waitcnt vmcnt(2)
    v_max3_u32 v7, v52, v53, v54
    v_max_u32 v7, v7, v55
    v_cmp_eq_u32 vcc, s34, v7
    s_cbranch_vccz L_ok_a_44
    s_add_u32 s33, s33, 1
    s_cmp_gt_u32 s33, 0x100000
    s_cbranch_scc0 L_q_a_42
    s_branch chain_kernel_abort
L_ok_a_43:
    v_smfmac_f32_16x16x64_bf16 v[64:67], v[60:63], a[24:31], v6
    v_smfmac_f32_16x16x64_bf16 v[68:71], v[60:63], a[88:95], v6
    v_smfmac_f32_16x16x64_bf16 v[72:75], v[60:63], a[56:63], v6
    v_smfmac_f32_16x16x64_bf16 v[76:79], v[60:63], a[120:127], v6
    s_branch L_q_a_30
L_ok_a_44:
    v_smfmac_f32_16x16x64_bf16 v[64:67], v[52:55], a[8:15], v6
    v_smfmac_f32_16x16x64_bf16 v[68:71], v[52:55], a[72:79], v6
    v_smfmac_f32_16x16x64_bf16 v[72:75], v[52:55], a[40:47], v6
    v_smfmac_f32_16x16x64_bf16 v[76:79], v[52:55], a[104:111], v6
    s_branch L_q_a_20
L_q_a_41:
    buffer_load_dwordx4 v[56:59], v4, s[8:11], s38 offen sc1
    s_waitcnt vmcnt(2)
    v_max3_u32 v7, v60, v61, v62
    v_max_u32 v7, v7, v63
    v_cmp_eq_u32 vcc, s34, v7
    s_cbranch_vccz L_ok_a_45
    buffer_load_dwordx4 v[60:63], v5, s[8:11], s38 offen sc1
    s_waitcnt vmcnt(2)
    v_max3_u32 v7, v56, v57, v58
    v_max_u32 v7, v7, v59
    v_cmp_eq_u32 vcc, s34, v7
    s_cbranch_vccz L_ok_a_46
    s_add_u32 s33, s33, 1
    s_cmp_gt_u32 s33, 0x100000
    s_cbranch_scc0 L_q_a_41
    s_branch chain_kernel_abort
L_ok_a_45:
    v_smfmac_f32_16x16x64_bf16 v[64:67], v[60:63], a[24:31], v6
    v_smfmac_f32_16x16x64_bf16 v[68:71], v[60:63], a[88:95], v6
    v_smfmac_f32_16x16x64_bf16 v[72:75], v[60:63], a[56:63], v6
    v_smfmac_f32_16x16x64_bf16 v[76:79], v[60:63], a[120:127], v6
    s_branch L_q_a_23
L_ok_a_46:
    v_smfmac_f32_16x16x64_bf16 v[64:67], v[56:59], a[16:23], v6
    v_smfmac_f32_16x16x64_bf16 v[68:71], v[56:59], a[80:87], v6
    v_smfmac_f32_16x16x64_bf16 v[72:75], v[56:59], a[48:55], v6
    v_smfmac_f32_16x16x64_bf16 v[76:79], v[56:59], a[112:119], v6
    s_branch L_q_a_20
L_q_a_17:
    buffer_load_dwordx4 v[48:51], v2, s[8:11], s38 offen sc1
    s_waitcnt vmcnt(3)
    v_max3_u32 v7, v52, v53, v54
    v_max_u32 v7, v7, v55
    v_cmp_eq_u32 vcc, s34, v7
    s_cbranch_vccnz L_q_a_47
    v_smfmac_f32_16x16x64_bf16 v[64:67], v[52:55], a[8:15], v6
    v_smfmac_f32_16x16x64_bf16 v[68:71], v[52:55], a[72:79], v6
    v_smfmac_f32_16x16x64_bf16 v[72:75], v[52:55], a[40:47], v6
    v_smfmac_f32_16x16x64_bf16 v[76:79], v[52:55], a[104:111], v6
    s_branch L_q_a_48
L_q_a_48:
    buffer_load_dwordx4 v[48:51], v2, s[8:11], s38 offen sc1
    s_waitcnt vmcnt(3)
    v_max3_u32 v7, v56, v57, v58
    v_max_u32 v7, v7, v59
    v_cmp_eq_u32 vcc, s34, v7
    s_cbranch_vccnz L_q_a_49
    v_smfmac_f32_16x16x64_bf16 v[64:67], v[56:59], a[16:23], v6
    v_smfmac_f32_16x16x64_bf16 v[68:71], v[56:59], a[80:87], v6
    v_smfmac_f32_16x16x64_bf16 v[72:75], v[56:59], a[48:55], v6
    v_smfmac_f32_16x16x64_bf16 v[76:79], v[56:59], a[112:119], v6
    s_branch L_q_a_50
L_q_a_50:
    buffer_load_dwordx4 v[48:51], v2, s[8:11], s38 offen sc1
    s_waitcnt vmcnt(3)
    v_max3_u32 v7, v60, v61, v62
    v_max_u32 v7, v7, v63
    v_cmp_eq_u32 vcc, s34, v7
    s_cbranch_vccnz L_q_a_51
    v_smfmac_f32_16x16x64_bf16 v[64:67], v[60:63], a[24:31], v6
    v_smfmac_f32_16x16x64_bf16 v[68:71], v[60:63], a[88:95], v6
    v_smfmac_f32_16x16x64_bf16 v[72:75], v[60:63], a[56:63], v6
    v_smfmac_f32_16x16x64_bf16 v[76:79], v[60:63], a[120:127], v6
    s_branch L_q_a_52
L_q_a_52:
    buffer_load_dwordx4 v[48:51], v2, s[8:11], s38 offen sc1
    s_waitcnt vmcnt(2)
    v_max3_u32 v7, v48, v49, v50
    v_max_u32 v7, v7, v51
    v_cmp_eq_u32 vcc, s34, v7
    s_cbranch_vccz L_ok_a_53
    s_add_u32 s33, s33, 1
    s_cmp_gt_u32 s33, 0x100000
    s_cbranch_scc0 L_q_a_52
    s_branch chain_kernel_abort
L_ok_a_53:
    v_smfmac_f32_16x16x64_bf16 v[64:67], v[48:51], a[0:7], v6
    v_smfmac_f32_16x16x64_bf16 v[68:71], v[48:51], a[64:71], v6
    v_smfmac_f32_16x16x64_bf16 v[72:75], v[48:51], a[32:39], v6
    v_smfmac_f32_16x16x64_bf16 v[76:79], v[48:51], a[96:103], v6
    s_branch L_gd_a_16
L_q_a_51:
    buffer_load_dwordx4 v[60:63], v5, s[8:11], s38 offen sc1
    s_waitcnt vmcnt(2)
    v_max3_u32 v7, v48, v49, v50
    v_max_u32 v7, v7, v51
    v_cmp_eq_u32 vcc, s34, v7
    s_cbranch_vccz L_ok_a_54
    buffer_load_dwordx4 v[48:51], v2, s[8:11], s38 offen sc1
    s_waitcnt vmcnt(2)
    v_max3_u32 v7, v60, v61, v62
    v_max_u32 v7, v7, v63
    v_cmp_eq_u32 vcc, s34, v7
    s_cbranch_vccz L_ok_a_55
    s_add_u32 s33, s33, 1
    s_cmp_gt_u32 s33, 0x100000
    s_cbranch_scc0 L_q_a_51
    s_branch chain_kernel_abort
L_ok_a_54:
    v_smfmac_f32_16x16x64_bf16 v[64:67], v[48:51], a[0:7], v6
    v_smfmac_f32_16x16x64_bf16 v[68:71], v[48:51], a[64:71], v6
    v_smfmac_f32_16x16x64_bf16 v[72:75], v[48:51], a[32:39], v6
    v_smfmac_f32_16x16x64_bf16 v[76:79], v[48:51], a[96:103], v6
    s_branch L_q_a_20
L_ok_a_55:
    v_smfmac_f32_16x16x64_bf16 v[64:67], v[60:63], a[24:31], v6
    v_smfmac_f32_16x16x64_bf16 v[68:71], v[60:63], a[88:95], v6
    v_smfmac_f32_16x16x64_bf16 v[72:75], v[60:63], a[56:63], v6
    v_smfmac_f32_16x16x64_bf16 v[76:79], v[60:63], a[120:127], v6
    s_branch L_q_a_52
L_q_a_49:
    buffer_load_dwordx4 v[56:59], v4, s[8:11], s38 offen sc1
    s_waitcnt vmcnt(3)
    v_max3_u32 v7, v60, v61, v62
    v_max_u32 v7, v7, v63
    v_cmp_eq_u32 vcc, s34, v7
    s_cbranch_vccnz L_q_a_56
    v_smfmac_f32_16x16x64_bf16 v[64:67], v[60:63], a[24:31], v6
    v_smfmac_f32_16x16x64_bf16 v[68:71], v[60:63], a[88:95], v6
    v_smfmac_f32_16x16x64_bf16 v[72:75], v[60:63], a[56:63], v6
    v_smfmac_f32_16x16x64_bf16 v[76:79], v[60:63], a[120:127], v6
    s_branch L_q_a_57
L_q_a_57:
    buffer_load_dwordx4 v[48:51], v2, s[8:11], s38 offen sc1
    s_waitcnt vmcnt(2)
    v_max3_u32 v7, v56, v57, v58
    v_max_u32 v7, v7, v59
    v_cmp_eq_u32 vcc, s34, v7
    s_cbranch_vccz L_ok_a_58
    buffer_load_dwordx4 v[56:59], v4, s[8:11], s38 offen sc1
    s_waitcnt vmcnt(2)
    v_max3_u32 v7, v48, v49, v50
    v_max_u32 v7, v7, v51
    v_cmp_eq_u32 vcc, s34, v7
    s_cbranch_vccz L_ok_a_59
    s_add_u32 s33, s33, 1
    s_cmp_gt_u32 s33, 0x100000
    s_cbranch_scc0 L_q_a_57
    s_branch chain_kernel_abort
L_ok_a_58:
    v_smfmac_f32_16x16x64_bf16 v[64:67], v[56:59], a[16:23], v6
    v_smfmac_f32_16x16x64_bf16 v[68:71], v[56:59], a[80:87], v6
    v_smfmac_f32_16x16x64_bf16 v[72:75], v[56:59], a[48:55], v6
    v_smfmac_f32_16x16x64_bf16 v[76:79], v[56:59], a[112:119], v6
    s_branch L_q_a_52
L_ok_a_59:
    v_smfmac_f32_16x16x64_bf16 v[64:67], v[48:51], a[0:7], v6
    v_smfmac_f32_16x16x64_bf16 v[68:71], v[48:51], a[64:71], v6
    v_smfmac_f32_16x16x64_bf16 v[72:75], v[48:51], a[32:39], v6
    v_smfmac_f32_16x16x64_bf16 v[76:79], v[48:51], a[96:103], v6
    s_branch L_q_a_23
L_q_a_56:
    buffer_load_dwordx4 v[60:63], v5, s[8:11], s38 offen sc1
    s_waitcnt vmcnt(2)
    v_max3_u32 v7, v48, v49, v50
    v_max_u32 v7, v7, v51
    v_cmp_eq_u32 vcc, s34, v7
    s_cbranch_vccz L_ok_a_60
    buffer_load_dwordx4 v[48:51], v2, s[8:11], s38 offen sc1
    s_waitcnt vmcnt(2)
    v_max3_u32 v7, v56, v57, v58
    v_max_u32 v7, v7, v59
    v_cmp_eq_u32 vcc, s34, v7
    s_cbranch_vccz L_ok_a_61
    buffer_load_dwordx4 v[56:59], v4, s[8:11], s38 offen sc1
    s_waitcnt vmcnt(2)
    v_max3_u32 v7, v60, v61, v62
    v_max_u32 v7, v7, v63
    v_cmp_eq_u32 vcc, s34, v7
    s_cbranch_vccz L_ok_a_62
    s_add_u32 s33, s33, 1
    s_cmp_gt_u32 s33, 0x100000
    s_cbranch_scc0 L_q_a_56
    s_branch chain_kernel_abort
L_ok_a_60:
    v_smfmac_f32_16x16x64_bf16 v[64:67], v[48:51], a[0:7], v6
    v_smfmac_f32_16x16x64_bf16 v[68:71], v[48:51], a[64:71], v6
    v_smfmac_f32_16x16x64_bf16 v[72:75], v[48:51], a[32:39], v6
    v_smfmac_f32_16x16x64_bf16 v[76:79], v[48:51], a[96:103], v6
    s_branch L_q_a_41
L_ok_a_61:
    v_smfmac_f32_16x16x64_bf16 v[64:67], v[56:59], a[16:23], v6
    v_smfmac_f32_16x16x64_bf16 v[68:71], v[56:59], a[80:87], v6
    v_smfmac_f32_16x16x64_bf16 v[72:75], v[56:59], a[48:55], v6
    v_smfmac_f32_16x16x64_bf16 v[76:79], v[56:59], a[112:119], v6
    s_branch L_q_a_63
L_ok_a_62:
    v_smfmac_f32_16x16x64_bf16 v[64:67], v[60:63], a[24:31], v6
    v_smfmac_f32_16x16x64_bf16 v[68:71], v[60:63], a[88:95], v6
    v_smfmac_f32_16x16x64_bf16 v[72:75], v[60:63], a[56:63], v6
    v_smfmac_f32_16x16x64_bf16 v[76:79], v[60:63], a[120:127], v6
    s_branch L_q_a_57
L_q_a_63:
    buffer_load_dwordx4 v[48:51], v2, s[8:11], s38 offen sc1
    s_waitcnt vmcnt(2)
    v_max3_u32 v7, v60, v61, v62
    v_max_u32 v7, v7, v63
    v_cmp_eq_u32 vcc, s34, v7
    s_cbranch_vccz L_ok_a_64
    buffer_load_dwordx4 v[60:63], v5, s[8:11], s38 offen sc1
    s_waitcnt vmcnt(2)
    v_max3_u32 v7, v48, v49, v50
    v_max_u32 v7, v7, v51
    v_cmp_eq_u32 vcc, s34, v7
    s_cbranch_vccz L_ok_a_65
    s_add_u32 s33, s33, 1
    s_cmp_gt_u32 s33, 0x100000
    s_cbranch_scc0 L_q_a_63
    s_branch chain_kernel_abort
L_ok_a_64:
    v_smfmac_f32_16x16x64_bf16 v[64:67], v[60:63], a[24:31], v6
    v_smfmac_f32_16x16x64_bf16 v[68:71], v[60:63], a[88:95], v6
    v_smfmac_f32_16x16x64_bf16 v[72:75], v[60:63], a[56:63], v6
    v_smfmac_f32_16x16x64_bf16 v[76:79], v[60:63], a[120:127], v6
    s_branch L_q_a_52
L_ok_a_65:
    v_smfmac_f32_16x16x64_bf16 v[64:67], v[48:51], a[0:7], v6
    v_smfmac_f32_16x16x64_bf16 v[68:71], v[48:51], a[64:71], v6
    v_smfmac_f32_16x16x64_bf16 v[72:75], v[48:51], a[32:39], v6
    v_smfmac_f32_16x16x64_bf16 v[76:79], v[48:51], a[96:103], v6
    s_branch L_q_a_20
L_q_a_47:
    buffer_load_dwordx4 v[52:55], v3, s[8:11], s38 offen sc1
    s_waitcnt vmcnt(3)
    v_max3_u32 v7, v56, v57, v58
    v_max_u32 v7, v7, v59
    v_cmp_eq_u32 vcc, s34, v7
    s_cbranch_vccnz L_q_a_66
    v_smfmac_f32_16x16x64_bf16 v[64:67], v[56:59], a[16:23], v6
    v_smfmac_f32_16x16x64_bf16 v[68:71], v[56:59], a[80:87], v6
    v_smfmac_f32_16x16x64_bf16 v[72:75], v[56:59], a[48:55], v6
    v_smfmac_f32_16x16x64_bf16 v[76:79], v[56:59], a[112:119], v6
    s_branch L_q_a_67
L_q_a_67:
    buffer_load_dwordx4 v[48:51], v2, s[8:11], s38 offen sc1
    s_waitcnt vmcnt(3)
    v_max3_u32 v7, v60, v61, v62
    v_max_u32 v7, v7, v63
    v_cmp_eq_u32 vcc, s34, v7
    s_cbranch_vccnz L_q_a_68
    v_smfmac_f32_16x16x64_bf16 v[64:67], v[60:63], a[24:31], v6
    v_smfmac_f32_16x16x64_bf16 v[68:71], v[60:63], a[88:95], v6
    v_smfmac_f32_16x16x64_bf16 v[72:75], v[60:63], a[56:63], v6
    v_smfmac_f32_16x16x64_bf16 v[76:79], v[60:63], a[120:127], v6
    s_branch L_q_a_69
L_q_a_69:
    buffer_load_dwordx4 v[52:55], v3, s[8:11], s38 offen sc1
    s_waitcnt vmcnt(2)
    v_max3_u32 v7, v48, v49, v50
    v_max_u32 v7, v7, v51
    v_cmp_eq_u32 vcc, s34, v7
    s_cbranch_vccz L_ok_a_70
    buffer_load_dwordx4 v[48:51], v2, s[8:11], s38 offen sc1
    s_waitcnt vmcnt(2)
    v_max3_u32 v7, v52, v53, v54
    v_max_u32 v7, v7, v55
    v_cmp_eq_u32 vcc, s34, v7
    s_cbranch_vccz L_ok_a_71
    s_add_u32 s33, s33, 1
    s_cmp_gt_u32 s33, 0x100000
    s_cbranch_scc0 L_q_a_69
    s_branch chain_kernel_abort
L_ok_a_70:
    v_smfmac_f32_16x16x64_bf16 v[64:67], v[48:51], a[0:7], v6
    v_smfmac_f32_16x16x64_bf16 v[68:71], v[48:51], a[64:71], v6
    v_smfmac_f32_16x16x64_bf16 v[72:75], v[48:51], a[32:39], v6
    v_smfmac_f32_16x16x64_bf16 v[76:79], v[48:51], a[96:103], v6
    s_branch L_q_a_30
L_ok_a_71:
    v_smfmac_f32_16x16x64_bf16 v[64:67], v[52:55], a[8:15], v6
    v_smfmac_f32_16x16x64_bf16 v[68:71], v[52:55], a[72:79], v6
    v_smfmac_f32_16x16x64_bf16 v[72:75], v[52:55], a[40:47], v6
    v_smfmac_f32_16x16x64_bf16 v[76:79], v[52:55], a[104:111], v6
    s_branch L_q_a_52
L_q_a_68:
    buffer_load_dwordx4 v[60:63], v5, s[8:11], s38 offen sc1
    s_waitcnt vmcnt(2)
    v_max3_u32 v7, v52, v53, v54
    v_max_u32 v7, v7, v55
    v_cmp_eq_u32 vcc, s34, v7
    s_cbranch_vccz L_ok_a_72
    buffer_load_dwordx4 v[52:55], v3, s[8:11], s38 offen sc1
    s_waitcnt vmcnt(2)
    v_max3_u32 v7, v48, v49, v50
    v_max_u32 v7, v7, v51
    v_cmp_eq_u32 vcc, s34, v7
    s_cbranch_vccz L_ok_a_73
    buffer_load_dwordx4 v[48:51], v2, s[8:11], s38 offen sc1
    s_waitcnt vmcnt(2)
    v_max3_u32 v7, v60, v61, v62
    v_max_u32 v7, v7, v63
    v_cmp_eq_u32 vcc, s34, v7
    s_cbranch_vccz L_ok_a_74
    s_add_u32 s33, s33, 1
    s_cmp_gt_u32 s33, 0x100000
    s_cbranch_scc0 L_q_a_68
    s_branch chain_kernel_abort
L_ok_a_72:
    v_smfmac_f32_16x16x64_bf16 v[64:67], v[52:55], a[8:15], v6
    v_smfmac_f32_16x16x64_bf16 v[68:71], v[52:55], a[72:79], v6
    v_smfmac_f32_16x16x64_bf16 v[72:75], v[52:55], a[40:47], v6
    v_smfmac_f32_16x16x64_bf16 v[76:79], v[52:55], a[104:111], v6
    s_branch L_q_a_63
L_ok_a_73:
    v_smfmac_f32_16x16x64_bf16 v[64:67], v[48:51], a[0:7], v6
    v_smfmac_f32_16x16x64_bf16 v[68:71], v[48:51], a[64:71], v6
    v_smfmac_f32_16x16x64_bf16 v[72:75], v[48:51], a[32:39], v6
    v_smfmac_f32_16x16x64_bf16 v[76:79], v[48:51], a[96:103], v6
    s_branch L_q_a_42
L_ok_a_74:
    v_smfmac_f32_16x16x64_bf16 v[64:67], v[60:63], a[24:31], v6
    v_smfmac_f32_16x16x64_bf16 v[68:71], v[60:63], a[88:95], v6
    v_smfmac_f32_16x16x64_bf16 v[72:75], v[60:63], a[56:63], v6
    v_smfmac_f32_16x16x64_bf16 v[76:79], v[60:63], a[120:127], v6
    s_branch L_q_a_75
L_q_a_75:
    buffer_load_dwordx4 v[48:51], v2, s[8:11], s38 offen sc1
    s_waitcnt vmcnt(2)
    v_max3_u32 v7, v52, v53, v54
    v_max_u32 v7, v7, v55
    v_cmp_eq_u32 vcc, s34, v7
    s_cbranch_vccz L_ok_a_76
    buffer_load_dwordx4 v[52:55], v3, s[8:11], s38 offen sc1
    s_waitcnt vmcnt(2)
    v_max3_u32 v7, v48, v49, v50
    v_max_u32 v7, v7, v51
    v_cmp_eq_u32 vcc, s34, v7
    s_cbranch_vccz L_ok_a_77
    s_add_u32 s33, s33, 1
    s_cmp_gt_u32 s33, 0x100000
    s_cbranch_scc0 L_q_a_75
    s_branch chain_kernel_abort
L_ok_a_76:
    v_smfmac_f32_16x16x64_bf16 v[64:67], v[52:55], a[8:15], v6
    v_smfmac_f32_16x16x64_bf16 v[68:71], v[52:55], a[72:79], v6
    v_smfmac_f32_16x16x64_bf16 v[72:75], v[52:55], a[40:47], v6
    v_smfmac_f32_16x16x64_bf16 v[76:79], v[52:55], a[104:111], v6
    s_branch L_q_a_52
L_ok_a_77:
    v_smfmac_f32_16x16x64_bf16 v[64:67], v[48:51], a[0:7], v6
    v_smfmac_f32_16x16x64_bf16 v[68:71], v[48:51], a[64:71], v6
    v_smfmac_f32_16x16x64_bf16 v[72:75], v[48:51], a[32:39], v6
    v_smfmac_f32_16x16x64_bf16 v[76:79], v[48:51], a[96:103], v6
    s_branch L_q_a_30
L_q_a_66:
    buffer_load_dwordx4 v[56:59], v4, s[8:11], s38 offen sc1
    s_waitcnt vmcnt(3)
    v_max3_u32 v7, v60, v61, v62
    v_max_u32 v7, v7, v63
    v_cmp_eq_u32 vcc, s34, v7
    s_cbranch_vccnz L_q_a_78
    v_smfmac_f32_16x16x64_bf16 v[64:67], v[60:63], a[24:31], v6
    v_smfmac_f32_16x16x64_bf16 v[68:71], v[60:63], a[88:95], v6
    v_smfmac_f32_16x16x64_bf16 v[72:75], v[60:63], a[56:63], v6
    v_smfmac_f32_16x16x64_bf16 v[76:79], v[60:63], a[120:127], v6
    s_branch L_q_a_79
L_q_a_79:
    buffer_load_dwordx4 v[48:51], v2, s[8:11], s38 offen sc1
    s_waitcnt vmcnt(2)
    v_max3_u32 v7, v52, v53, v54
    v_max_u32 v7, v7, v55
    v_cmp_eq_u32 vcc, s34, v7
    s_cbranch_vccz L_ok_a_80
    buffer_load_dwordx4 v[52:55], v3, s[8:11], s38 offen sc1
    s_waitcnt vmcnt(2)
    v_max3_u32 v7, v56, v57, v58
    v_max_u32 v7, v7, v59
    v_cmp_eq_u32 vcc, s34, v7
    s_cbranch_vccz L_ok_a_81
    buffer_load_dwordx4 v[56:59], v4, s[8:11], s38 offen sc1
    s_waitcnt vmcnt(2)
    v_max3_u32 v7, v48, v49, v50
    v_max_u32 v7, v7, v51
    v_cmp_eq_u32 vcc, s34, v7
    s_cbranch_vccz L_ok_a_82
    s_add_u32 s33, s33, 1
    s_cmp_gt_u32 s33, 0x100000
    s_cbranch_scc0 L_q_a_79
    s_branch chain_kernel_abort
L_ok_a_80:
    v_smfmac_f32_16x16x64_bf16 v[64:67], v[52:55], a[8:15], v6
    v_smfmac_f32_16x16x64_bf16 v[68:71], v[52:55], a[72:79], v6
    v_smfmac_f32_16x16x64_bf16 v[72:75], v[52:55], a[40:47], v6
    v_smfmac_f32_16x16x64_bf16 v[76:79], v[52:55], a[104:111], v6
    s_branch L_q_a_57
L_ok_a_81:
    v_smfmac_f32_16x16x64_bf16 v[64:67], v[56:59], a[16:23], v6
    v_smfmac_f32_16x16x64_bf16 v[68:71], v[56:59], a[80:87], v6
    v_smfmac_f32_16x16x64_bf16 v[72:75], v[56:59], a[48:55], v6
    v_smfmac_f32_16x16x64_bf16 v[76:79], v[56:59], a[112:119], v6
    s_branch L_q_a_75
L_ok_a_82:
    v_smfmac_f32_16x16x64_bf16 v[64:67], v[48:51], a[0:7], v6
    v_smfmac_f32_16x16x64_bf16 v[68:71], v[48:51], a[64:71], v6
    v_smfmac_f32_16x16x64_bf16 v[72:75], v[48:51], a[32:39], v6
    v_smfmac_f32_16x16x64_bf16 v[76:79], v[48:51], a[96:103], v6
    s_branch L_q_a_35
L_q_a_78:
    buffer_load_dwordx4 v[60:63], v5, s[8:11], s38 offen sc1
    s_waitcnt vmcnt(2)
    v_max3_u32 v7, v48, v49, v50
    v_max_u32 v7, v7, v51
    v_cmp_eq_u32 vcc, s34, v7
    s_cbranch_vccz L_ok_a_83
    buffer_load_dwordx4 v[48:51], v2, s[8:11], s38 offen sc1
    s_waitcnt vmcnt(2)
    v_max3_u32 v7, v52, v53, v54
    v_max_u32 v7, v7, v55
    v_cmp_eq_u32 vcc, s34, v7
    s_cbranch_vccz L_ok_a_84
    buffer_load_dwordx4 v[52:55], v3, s[8:11], s38 offen sc1
    s_waitcnt vmcnt(2)
    v_max3_u32 v7, v56, v57, v58
    v_max_u32 v7, v7, v59
    v_cmp_eq_u32 vcc, s34, v7
    s_cbranch_vccz L_ok_a_85
    buffer_load_dwordx4 v[56:59], v4, s[8:11], s38 offen sc1
    s_waitcnt vmcnt(2)
    v_max3_u32 v7, v60, v61, v62
    v_max_u32 v7, v7, v63
    v_cmp_eq_u32 vcc, s34, v7
    s_cbranch_vccz L_ok_a_86
    s_add_u32 s33, s33, 1
    s_cmp_gt_u32 s33, 0x100000
    s_cbranch_scc0 L_q_a_78
    s_branch chain_kernel_abort
L_ok_a_83:
    v_smfmac_f32_16x16x64_bf16 v[64:67], v[48:51], a[0:7], v6
    v_smfmac_f32_16x16x64_bf16 v[68:71], v[48:51], a[64:71], v6
    v_smfmac_f32_16x16x64_bf16 v[72:75], v[48:51], a[32:39], v6
    v_smfmac_f32_16x16x64_bf16 v[76:79], v[48:51], a[96:103], v6
    s_branch L_q_a_87
L_ok_a_84:
    v_smfmac_f32_16x16x64_bf16 v[64:67], v[52:55], a[8:15], v6
    v_smfmac_f32_16x16x64_bf16 v[68:71], v[52:55], a[72:79], v6
    v_smfmac_f32_16x16x64_bf16 v[72:75], v[52:55], a[40:47], v6
    v_smfmac_f32_16x16x64_bf16 v[76:79], v[52:55], a[104:111], v6
    s_branch L_q_a_88
L_ok_a_85:
    v_smfmac_f32_16x16x64_bf16 v[64:67], v[56:59], a[16:23], v6
    v_smfmac_f32_16x16x64_bf16 v[68:71], v[56:59], a[80:87], v6
    v_smfmac_f32_16x16x64_bf16 v[72:75], v[56:59], a[48:55], v6
    v_smfmac_f32_16x16x64_bf16 v[76:79], v[56:59], a[112:119], v6
    s_branch L_q_a_89
L_ok_a_86:
    v_smfmac_f32_16x16x64_bf16 v[64:67], v[60:63], a[24:31], v6
    v_smfmac_f32_16x16x64_bf16 v[68:71], v[60:63], a[88:95], v6
    v_smfmac_f32_16x16x64_bf16 v[72:75], v[60:63], a[56:63], v6
    v_smfmac_f32_16x16x64_bf16 v[76:79], v[60:63], a[120:127], v6
    s_branch L_q_a_79
L_q_a_89:
    buffer_load_dwordx4 v[48:51], v2, s[8:11], s38 offen sc1
    s_waitcnt vmcnt(2)
    v_max3_u32 v7, v52, v53, v54
    v_max_u32 v7, v7, v55
    v_cmp_eq_u32 vcc, s34, v7
    s_cbranch_vccz L_ok_a_90
    buffer_load_dwordx4 v[52:55], v3, s[8:11], s38 offen sc1
    s_waitcnt vmcnt(2)
    v_max3_u32 v7, v60, v61, v62
    v_max_u32 v7, v7, v63
    v_cmp_eq_u32 vcc, s34, v7
    s_cbranch_vccz L_ok_a_91
    buffer_load_dwordx4 v[60:63], v5, s[8:11], s38 offen sc1
    s_waitcnt vmcnt(2)
    v_max3_u32 v7, v48, v49, v50
    v_max_u32 v7, v7, v51
    v_cmp_eq_u32 vcc, s34, v7
    s_cbranch_vccz L_ok_a_92
    s_add_u32 s33, s33, 1
    s_cmp_gt_u32 s33, 0x100000
    s_cbranch_scc0 L_q_a_89
    s_branch chain_kernel_abort
L_ok_a_90:
    v_smfmac_f32_16x16x64_bf16 v[64:67], v[52:55], a[8:15], v6
    v_smfmac_f32_16x16x64_bf16 v[68:71], v[52:55], a[72:79], v6
    v_smfmac_f32_16x16x64_bf16 v[72:75], v[52:55], a[40:47], v6
    v_smfmac_f32_16x16x64_bf16 v[76:79], v[52:55], a[104:111], v6
    s_branch L_q_a_63
L_ok_a_91:
    v_smfmac_f32_16x16x64_bf16 v[64:67], v[60:63], a[24:31], v6
    v_smfmac_f32_16x16x64_bf16 v[68:71], v[60:63], a[88:95], v6
    v_smfmac_f32_16x16x64_bf16 v[72:75], v[60:63], a[56:63], v6
    v_smfmac_f32_16x16x64_bf16 v[76:79], v[60:63], a[120:127], v6
    s_branch L_q_a_75
L_ok_a_92:
    v_smfmac_f32_16x16x64_bf16 v[64:67], v[48:51], a[0:7], v6
    v_smfmac_f32_16x16x64_bf16 v[68:71], v[48:51], a[64:71], v6
    v_smfmac_f32_16x16x64_bf16 v[72:75], v[48:51], a[32:39], v6
    v_smfmac_f32_16x16x64_bf16 v[76:79], v[48:51], a[96:103], v6
    s_branch L_q_a_42
L_q_a_88:
    buffer_load_dwordx4 v[48:51], v2, s[8:11], s38 offen sc1
    s_waitcnt vmcnt(2)
    v_max3_u32 v7, v56, v57, v58
    v_max_u32 v7, v7, v59
    v_cmp_eq_u32 vcc, s34, v7
    s_cbranch_vccz L_ok_a_93
    buffer_load_dwordx4 v[56:59], v4, s[8:11], s38 offen sc1
    s_waitcnt vmcnt(2)
    v_max3_u32 v7, v60, v61, v62
    v_max_u32 v7, v7, v63
    v_cmp_eq_u32 vcc, s34, v7
    s_cbranch_vccz L_ok_a_94
    buffer_load_dwordx4 v[60:63], v5, s[8:11], s38 offen sc1
    s_waitcnt vmcnt(2)
    v_max3_u32 v7, v48, v49, v50
    v_max_u32 v7, v7, v51
    v_cmp_eq_u32 vcc, s34, v7
    s_cbranch_vccz L_ok_a_95
    s_add_u32 s33, s33, 1
    s_cmp_gt_u32 s33, 0x100000
    s_cbranch_scc0 L_q_a_88
    s_branch chain_kernel_abort
L_ok_a_93:
    v_smfmac_f32_16x16x64_bf16 v[64:67], v[56:59], a[16:23], v6
    v_smfmac_f32_16x16x64_bf16 v[68:71], v[56:59], a[80:87], v6
    v_smfmac_f32_16x16x64_bf16 v[72:75], v[56:59], a[48:55], v6
    v_smfmac_f32_16x16x64_bf16 v[76:79], v[56:59], a[112:119], v6
    s_branch L_q_a_63
L_ok_a_94:
    v_smfmac_f32_16x16x64_bf16 v[64:67], v[60:63], a[24:31], v6
    v_smfmac_f32_16x16x64_bf16 v[68:71], v[60:63], a[88:95], v6
    v_smfmac_f32_16x16x64_bf16 v[72:75], v[60:63], a[56:63], v6
    v_smfmac_f32_16x16x64_bf16 v[76:79], v[60:63], a[120:127], v6
    s_branch L_q_a_57
L_ok_a_95:
    v_smfmac_f32_16x16x64_bf16 v[64:67], v[48:51], a[0:7], v6
    v_smfmac_f32_16x16x64_bf16 v[68:71], v[48:51], a[64:71], v6
    v_smfmac_f32_16x16x64_bf16 v[72:75], v[48:51], a[32:39], v6
    v_smfmac_f32_16x16x64_bf16 v[76:79], v[48:51], a[96:103], v6
    s_branch L_q_a_41
L_q_a_87:
    buffer_load_dwordx4 v[52:55], v3, s[8:11], s38 offen sc1
    s_waitcnt vmcnt(2)
    v_max3_u32 v7, v56, v57, v58
    v_max_u32 v7, v7, v59
    v_cmp_eq_u32 vcc, s34, v7
    s_cbranch_vccz L_ok_a_96
    buffer_load_dwordx4 v[56:59], v4, s[8:11], s38 offen sc1
    s_waitcnt vmcnt(2)
    v_max3_u32 v7, v60, v61, v62
    v_max_u32 v7, v7, v63
    v_cmp_eq_u32 vcc, s34, v7
    s_cbranch_vccz L_ok_a_97
    buffer_load_dwordx4 v[60:63], v5, s[8:11], s38 offen sc1
    s_waitcnt vmcnt(2)
    v_max3_u32 v7, v52, v53, v54
    v_max_u32 v7, v7, v55
    v_cmp_eq_u32 vcc, s34, v7
    s_cbranch_vccz L_ok_a_98
    s_add_u32 s33, s33, 1
    s_cmp_gt_u32 s33, 0x100000
    s_cbranch_scc0 L_q_a_87
    s_branch chain_kernel_abort
L_ok_a_96:
    v_smfmac_f32_16x16x64_bf16 v[64:67], v[56:59], a[16:23], v6
    v_smfmac_f32_16x16x64_bf16 v[68:71], v[56:59], a[80:87], v6
    v_smfmac_f32_16x16x64_bf16 v[72:75], v[56:59], a[48:55], v6
    v_smfmac_f32_16x16x64_bf16 v[76:79], v[56:59], a[112:119], v6
    s_branch L_q_a_42
L_ok_a_97:
    v_smfmac_f32_16x16x64_bf16 v[64:67], v[60:63], a[24:31], v6
    v_smfmac_f32_16x16x64_bf16 v[68:71], v[60:63], a[88:95], v6
    v_smfmac_f32_16x16x64_bf16 v[72:75], v[60:63], a[56:63], v6
    v_smfmac_f32_16x16x64_bf16 v[76:79], v[60:63], a[120:127], v6
    s_branch L_q_a_35
L_ok_a_98:
    v_smfmac_f32_16x16x64_bf16 v[64:67], v[52:55], a[8:15], v6
    v_smfmac_f32_16x16x64_bf16 v[68:71], v[52:55], a[72:79], v6
    v_smfmac_f32_16x16x64_bf16 v[72:75], v[52:55], a[40:47], v6
    v_smfmac_f32_16x16x64_bf16 v[76:79], v[52:55], a[104:111], v6
    s_branch L_q_a_41
L_cf_107:
L_rt_108:
    buffer_load_dwordx4 v[200:203], v16, s[8:11], s40 offen sc1
    buffer_load_dwordx4 v[204:207], v13, s[8:11], s40 offen sc1
    buffer_load_dwordx4 v[208:211], v14, s[8:11], s40 offen sc1
    buffer_load_dwordx4 v[212:215], v15, s[8:11], s40 offen sc1
    s_waitcnt vmcnt(7)
    v_permlane32_swap_b32 v216, v218
    v_permlane32_swap_b32 v217, v219
    s_waitcnt vmcnt(6)
    v_pk_add_f32 v[154:155], v[216:217], v[218:219]
    v_pk_add_f32 v[148:149], v[124:125], v[220:221]
    v_pk_add_f32 v[150:151], v[126:127], v[222:223]
    v_permlane16_swap_b32 v154, v155
    s_waitcnt vmcnt(5)
    v_pk_add_f32 v[148:149], v[148:149], v[224:225]
    v_pk_add_f32 v[150:151], v[150:151], v[226:227]
    v_add_f32 v152, v154, v155
    s_waitcnt vmcnt(4)
    v_pk_add_f32 v[148:149], v[148:149], v[228:229]
    v_pk_add_f32 v[150:151], v[150:151], v[230:231]
    v_pk_add_f32 v[154:155], v[148:149], v[150:151]
    v_add_f32 v154, v154, v152
    v_cmp_u_f32 vcc, v154, v155
    s_cbranch_vccz L_cok_106
    buffer_load_dwordx4 v[216:219], v16, s[8:11], s40 offen sc1
    buffer_load_dwordx4 v[220:223], v13, s[8:11], s40 offen sc1
    buffer_load_dwordx4 v[224:227], v14, s[8:11], s40 offen sc1
    buffer_load_dwordx4 v[228:231], v15, s[8:11], s40 offen sc1
    s_waitcnt vmcnt(7)
    v_permlane32_swap_b32 v200, v202
    v_permlane32_swap_b32 v201, v203
    s_waitcnt vmcnt(6)
    v_pk_add_f32 v[154:155], v[200:201], v[202:203]
    v_pk_add_f32 v[148:149], v[124:125], v[204:205]
    v_pk_add_f32 v[150:151], v[126:127], v[206:207]
    v_permlane16_swap_b32 v154, v155
    s_waitcnt vmcnt(5)
    v_pk_add_f32 v[148:149], v[148:149], v[208:209]
    v_pk_add_f32 v[150:151], v[150:151], v[210:211]
    v_add_f32 v152, v154, v155
    s_waitcnt vmcnt(4)
    v_pk_add_f32 v[148:149], v[148:149], v[212:213]
    v_pk_add_f32 v[150:151], v[150:151], v[214:215]
    v_pk_add_f32 v[154:155], v[148:149], v[150:151]
    v_add_f32 v154, v154, v152
    v_cmp_u_f32 vcc, v154, v155
    s_cbranch_vccz L_cok_106
    s_add_u32 s33, s33, 1
    s_cmp_gt_u32 s33, 0x100000
    s_cbranch_scc1 chain_kernel_abort
    s_and_b32 s20, s33, 63
    s_cbranch_scc1 L_rt_108
    v_cmp_eq_u32 vcc, s34, v200
    v_cmp_eq_u32 s[20:21], s34, v201
    s_or_b64 vcc, vcc, s[20:21]
    v_cmp_eq_u32 s[20:21], s34, v202
    s_or_b64 vcc, vcc, s[20:21]
    v_cmp_eq_u32 s[20:21], s34, v203
    s_or_b64 vcc, vcc, s[20:21]
    v_cmp_eq_u32 s[20:21], s34, v204
    s_or_b64 vcc, vcc, s[20:21]
    v_cmp_eq_u32 s[20:21], s34, v205
    s_or_b64 vcc, vcc, s[20:21]
    v_cmp_eq_u32 s[20:21], s34, v206
    s_or_b64 vcc, vcc, s[20:21]
    v_cmp_eq_u32 s[20:21], s34, v207
    s_or_b64 vcc, vcc, s[20:21]
    v_cmp_eq_u32 s[20:21], s34, v208
    s_or_b64 vcc, vcc, s[20:21]
    v_cmp_eq_u32 s[20:21], s34, v209
    s_or_b64 vcc, vcc, s[20:21]
    v_cmp_eq_u32 s[20:21], s34, v210
    s_or_b64 vcc, vcc, s[20:21]
    v_cmp_eq_u32 s[20:21], s34, v211
    s_or_b64 vcc, vcc, s[20:21]
    v_cmp_eq_u32 s[20:21], s34, v212
    s_or_b64 vcc, vcc, s[20:21]
    v_cmp_eq_u32 s[20:21], s34, v213
    s_or_b64 vcc, vcc, s[20:21]
    v_cmp_eq_u32 s[20:21], s34, v214
    s_or_b64 vcc, vcc, s[20:21]
    v_cmp_eq_u32 s[20:21], s34, v215
    s_or_b64 vcc, vcc, s[20:21]
    s_cbranch_vccnz L_rt_108
    s_branch L_cok_106
L_cok_106:
    v_cvt_pk_bf16_f32 v160, 0, v148
    v_cvt_pk_bf16_f32 v161, 0, v149
    v_cvt_pk_bf16_f32 v162, 0, v150
    v_cvt_pk_bf16_f32 v163, 0, v151
    v_cvt_pk_bf16_f32 v176, 0, v152
    s_branch L_chead_109
L_q_e_114:
    buffer_load_dwordx4 v[60:63], v5, s[8:11], s41 offen sc1
    s_waitcnt vmcnt(2)
    v_max3_u32 v7, v60, v61, v62
    v_max_u32 v7, v7, v63
    v_cmp_eq_u32 vcc, s34, v7
    s_cbranch_vccz L_ok_e_115
    s_add_u32 s33, s33, 1
    s_cmp_gt_u32 s33, 0x100000
    s_cbranch_scc0 L_q_e_114
    s_branch chain_kernel_abort
L_ok_e_115:
    v_smfmac_f32_16x16x64_bf16 v[88:91], v[60:63], a[216:223], v6
    v_smfmac_f32_16x16x64_bf16 v[92:95], v[60:63], a[248:255], v6
    s_branch L_gd_e_110
L_q_e_113:
    buffer_load_dwordx4 v[56:59], v4, s[8:11], s41 offen sc1
    s_waitcnt vmcnt(1)
    v_max3_u32 v7, v60, v61, v62
    v_max_u32 v7, v7, v63
    v_cmp_eq_u32 vcc, s34, v7
    s_cbranch_vccnz L_q_e_116
    v_smfmac_f32_16x16x64_bf16 v[88:91], v[60:63], a[216:223], v6
    v_smfmac_f32_16x16x64_bf16 v[92:95], v[60:63], a[248:255], v6
    s_branch L_q_e_117
L_q_e_117:
    buffer_load_dwordx4 v[56:59], v4, s[8:11], s41 offen sc1
    s_waitcnt vmcnt(2)
    v_max3_u32 v7, v56, v57, v58
    v_max_u32 v7, v7, v59
    v_cmp_eq_u32 vcc, s34, v7
    s_cbranch_vccz L_ok_e_118
    s_add_u32 s33, s33, 1
    s_cmp_gt_u32 s33, 0x100000
    s_cbranch_scc0 L_q_e_117
    s_branch chain_kernel_abort
L_ok_e_118:
    v_smfmac_f32_16x16x64_bf16 v[88:91], v[56:59], a[208:215], v6
    v_smfmac_f32_16x16x64_bf16 v[92:95], v[56:59], a[240:247], v6
    s_branch L_gd_e_110
L_q_e_116:
    buffer_load_dwordx4 v[60:63], v5, s[8:11], s41 offen sc1
    s_waitcnt vmcnt(2)
    v_max3_u32 v7, v56, v57, v58
    v_max_u32 v7, v7, v59
    v_cmp_eq_u32 vcc, s34, v7
    s_cbranch_vccz L_ok_e_119
    buffer_load_dwordx4 v[56:59], v4, s[8:11], s41 offen sc1
    s_waitcnt vmcnt(2)
    v_max3_u32 v7, v60, v61, v62
    v_max_u32 v7, v7, v63
    v_cmp_eq_u32 vcc, s34, v7
    s_cbranch_vccz L_ok_e_120
    s_add_u32 s33, s33, 1
    s_cmp_gt_u32 s33, 0x100000
    s_cbranch_scc0 L_q_e_116
    s_branch chain_kernel_abort
L_ok_e_119:
    v_smfmac_f32_16x16x64_bf16 v[88:91], v[56:59], a[208:215], v6
    v_smfmac_f32_16x16x64_bf16 v[92:95], v[56:59], a[240:247], v6
    s_branch L_q_e_114
L_ok_e_120:
    v_smfmac_f32_16x16x64_bf16 v[88:91], v[60:63], a[216:223], v6
    v_smfmac_f32_16x16x64_bf16 v[92:95], v[60:63], a[248:255], v6
    s_branch L_q_e_117
L_q_e_112:
    buffer_load_dwordx4 v[52:55], v3, s[8:11], s41 offen sc1
    s_waitcnt vmcnt(2)
    v_max3_u32 v7, v56, v57, v58
    v_max_u32 v7, v7, v59
    v_cmp_eq_u32 vcc, s34, v7
    s_cbranch_vccnz L_q_e_121
    v_smfmac_f32_16x16x64_bf16 v[88:91], v[56:59], a[208:215], v6
    v_smfmac_f32_16x16x64_bf16 v[92:95], v[56:59], a[240:247], v6
    s_branch L_q_e_122
L_q_e_122:
    buffer_load_dwordx4 v[52:55], v3, s[8:11], s41 offen sc1
    s_waitcnt vmcnt(2)
    v_max3_u32 v7, v60, v61, v62
    v_max_u32 v7, v7, v63
    v_cmp_eq_u32 vcc, s34, v7
    s_cbranch_vccnz L_q_e_123
    v_smfmac_f32_16x16x64_bf16 v[88:91], v[60:63], a[216:223], v6
    v_smfmac_f32_16x16x64_bf16 v[92:95], v[60:63], a[248:255], v6
    s_branch L_q_e_124
L_q_e_124:
    buffer_load_dwordx4 v[52:55], v3, s[8:11], s41 offen sc1
    s_waitcnt vmcnt(2)
    v_max3_u32 v7, v52, v53, v54
    v_max_u32 v7, v7, v55
    v_cmp_eq_u32 vcc, s34, v7
    s_cbranch_vccz L_ok_e_125
    s_add_u32 s33, s33, 1
    s_cmp_gt_u32 s33, 0x100000
    s_cbranch_scc0 L_q_e_124
    s_branch chain_kernel_abort
L_ok_e_125:
    v_smfmac_f32_16x16x64_bf16 v[88:91], v[52:55], a[200:207], v6
    v_smfmac_f32_16x16x64_bf16 v[92:95], v[52:55], a[232:239], v6
    s_branch L_gd_e_110
L_q_e_123:
    buffer_load_dwordx4 v[60:63], v5, s[8:11], s41 offen sc1
    s_waitcnt vmcnt(2)
    v_max3_u32 v7, v52, v53, v54
    v_max_u32 v7, v7, v55
    v_cmp_eq_u32 vcc, s34, v7
    s_cbranch_vccz L_ok_e_126
    buffer_load_dwordx4 v[52:55], v3, s[8:11], s41 offen sc1
    s_waitcnt vmcnt(2)
    v_max3_u32 v7, v60, v61, v62
    v_max_u32 v7, v7, v63
    v_cmp_eq_u32 vcc, s34, v7
    s_cbranch_vccz L_ok_e_127
    s_add_u32 s33, s33, 1
    s_cmp_gt_u32 s33, 0x100000
    s_cbranch_scc0 L_q_e_123
    s_branch chain_kernel_abort
L_ok_e_126:
    v_smfmac_f32_16x16x64_bf16 v[88:91], v[52:55], a[200:207], v6
    v_smfmac_f32_16x16x64_bf16 v[92:95], v[52:55], a[232:239], v6
    s_branch L_q_e_114
L_ok_e_127:
    v_smfmac_f32_16x16x64_bf16 v[88:91], v[60:63], a[216:223], v6
    v_smfmac_f32_16x16x64_bf16 v[92:95], v[60:63], a[248:255], v6
    s_branch L_q_e_124
L_q_e_121:
    buffer_load_dwordx4 v[56:59], v4, s[8:11], s41 offen sc1
    s_waitcnt vmcnt(2)
    v_max3_u32 v7, v60, v61, v62
    v_max_u32 v7, v7, v63
    v_cmp_eq_u32 vcc, s34, v7
    s_cbranch_vccnz L_q_e_128
    v_smfmac_f32_16x16x64_bf16 v[88:91], v[60:63], a[216:223], v6
    v_smfmac_f32_16x16x64_bf16 v[92:95], v[60:63], a[248:255], v6
    s_branch L_q_e_129
L_q_e_129:
    buffer_load_dwordx4 v[52:55], v3, s[8:11], s41 offen sc1
    s_waitcnt vmcnt(2)
    v_max3_u32 v7, v56, v57, v58
    v_max_u32 v7, v7, v59
    v_cmp_eq_u32 vcc, s34, v7
    s_cbranch_vccz L_ok_e_130
    buffer_load_dwordx4 v[56:59], v4, s[8:11], s41 offen sc1
    s_waitcnt vmcnt(2)
    v_max3_u32 v7, v52, v53, v54
    v_max_u32 v7, v7, v55
    v_cmp_eq_u32 vcc, s34, v7
    s_cbranch_vccz L_ok_e_131
    s_add_u32 s33, s33, 1
    s_cmp_gt_u32 s33, 0x100000
    s_cbranch_scc0 L_q_e_129
    s_branch chain_kernel_abort
L_ok_e_130:
    v_smfmac_f32_16x16x64_bf16 v[88:91], v[56:59], a[208:215], v6
    v_smfmac_f32_16x16x64_bf16 v[92:95], v[56:59], a[240:247], v6
    s_branch L_q_e_124
L_ok_e_131:
    v_smfmac_f32_16x16x64_bf16 v[88:91], v[52:55], a[200:207], v6
    v_smfmac_f32_16x16x64_bf16 v[92:95], v[52:55], a[232:239], v6
    s_branch L_q_e_117
L_q_e_128:
    buffer_load_dwordx4 v[60:63], v5, s[8:11], s41 offen sc1
    s_waitcnt vmcnt(2)
    v_max3_u32 v7, v52, v53, v54
    v_max_u32 v7, v7, v55
    v_cmp_eq_u32 vcc, s34, v7
    s_cbranch_vccz L_ok_e_132
    buffer_load_dwordx4 v[52:55], v3, s[8:11], s41 offen sc1
    s_waitcnt vmcnt(2)
    v_max3_u32 v7, v56, v57, v58
    v_max_u32 v7, v7, v59
    v_cmp_eq_u32 vcc, s34, v7
    s_cbranch_vccz L_ok_e_133
    buffer_load_dwordx4 v[56:59], v4, s[8:11], s41 offen sc1
    s_waitcnt vmcnt(2)
    v_max3_u32 v7, v60, v61, v62
    v_max_u32 v7, v7, v63
    v_cmp_eq_u32 vcc, s34, v7
    s_cbranch_vccz L_ok_e_134
    s_add_u32 s33, s33, 1
    s_cmp_gt_u32 s33, 0x100000
    s_cbranch_scc0 L_q_e_128
    s_branch chain_kernel_abort
L_ok_e_132:
    v_smfmac_f32_16x16x64_bf16 v[88:91], v[52:55], a[200:207], v6
    v_smfmac_f32_16x16x64_bf16 v[92:95], v[52:55], a[232:239], v6
    s_branch L_q_e_135
L_ok_e_133:
    v_smfmac_f32_16x16x64_bf16 v[88:91], v[56:59], a[208:215], v6
    v_smfmac_f32_16x16x64_bf16 v[92:95], v[56:59], a[240:247], v6
    s_branch L_q_e_136
L_ok_e_134:
    v_smfmac_f32_16x16x64_bf16 v[88:91], v[60:63], a[216:223], v6
    v_smfmac_f32_16x16x64_bf16 v[92:95], v[60:63], a[248:255], v6
    s_branch L_q_e_129
L_q_e_136:
    buffer_load_dwordx4 v[52:55], v3, s[8:11], s41 offen sc1
    s_waitcnt vmcnt(2)
    v_max3_u32 v7, v60, v61, v62
    v_max_u32 v7, v7, v63
    v_cmp_eq_u32 vcc, s34, v7
    s_cbranch_vccz L_ok_e_137
    buffer_load_dwordx4 v[60:63], v5, s[8:11], s41 offen sc1
    s_waitcnt vmcnt(2)
    v_max3_u32 v7, v52, v53, v54
    v_max_u32 v7, v7, v55
    v_cmp_eq_u32 vcc, s34, v7
    s_cbranch_vccz L_ok_e_138
    s_add_u32 s33, s33, 1
    s_cmp_gt_u32 s33, 0x100000
    s_cbranch_scc0 L_q_e_136
    s_branch chain_kernel_abort
L_ok_e_137:
    v_smfmac_f32_16x16x64_bf16 v[88:91], v[60:63], a[216:223], v6
    v_smfmac_f32_16x16x64_bf16 v[92:95], v[60:63], a[248:255], v6
    s_branch L_q_e_124
L_ok_e_138:
    v_smfmac_f32_16x16x64_bf16 v[88:91], v[52:55], a[200:207], v6
    v_smfmac_f32_16x16x64_bf16 v[92:95], v[52:55], a[232:239], v6
    s_branch L_q_e_114
L_q_e_135:
    buffer_load_dwordx4 v[56:59], v4, s[8:11], s41 offen sc1
    s_waitcnt vmcnt(2)
    v_max3_u32 v7, v60, v61, v62
    v_max_u32 v7, v7, v63
    v_cmp_eq_u32 vcc, s34, v7
    s_cbranch_vccz L_ok_e_139
    buffer_load_dwordx4 v[60:63], v5, s[8:11], s41 offen sc1
    s_waitcnt vmcnt(2)
    v_max3_u32 v7, v56, v57, v58
    v_max_u32 v7, v7, v59
    v_cmp_eq_u32 vcc, s34, v7
    s_cbranch_vccz L_ok_e_140
    s_add_u32 s33, s33, 1
    s_cmp_gt_u32 s33, 0x100000
    s_cbranch_scc0 L_q_e_135
    s_branch chain_kernel_abort
L_ok_e_139:
    v_smfmac_f32_16x16x64_bf16 v[88:91], v[60:63], a[216:223], v6
    v_smfmac_f32_16x16x64_bf16 v[92:95], v[60:63], a[248:255], v6
    s_branch L_q_e_117
L_ok_e_140:
    v_smfmac_f32_16x16x64_bf16 v[88:91], v[56:59], a[208:215], v6
    v_smfmac_f32_16x16x64_bf16 v[92:95], v[56:59], a[240:247], v6
    s_branch L_q_e_114
L_q_e_111:
    buffer_load_dwordx4 v[48:51], v2, s[8:11], s41 offen sc1
    s_waitcnt vmcnt(3)
    v_max3_u32 v7, v52, v53, v54
    v_max_u32 v7, v7, v55
    v_cmp_eq_u32 vcc, s34, v7
    s_cbranch_vccnz L_q_e_141
    v_smfmac_f32_16x16x64_bf16 v[88:91], v[52:55], a[200:207], v6
    v_smfmac_f32_16x16x64_bf16 v[92:95], v[52:55], a[232:239], v6
    s_branch L_q_e_142
L_q_e_142:
    buffer_load_dwordx4 v[48:51], v2, s[8:11], s41 offen sc1
    s_waitcnt vmcnt(3)
    v_max3_u32 v7, v56, v57, v58
    v_max_u32 v7, v7, v59
    v_cmp_eq_u32 vcc, s34, v7
    s_cbranch_vccnz L_q_e_143
    v_smfmac_f32_16x16x64_bf16 v[88:91], v[56:59], a[208:215], v6
    v_smfmac_f32_16x16x64_bf16 v[92:95], v[56:59], a[240:247], v6
    s_branch L_q_e_144
L_q_e_144:
    buffer_load_dwordx4 v[48:51], v2, s[8:11], s41 offen sc1
    s_waitcnt vmcnt(3)
    v_max3_u32 v7, v60, v61, v62
    v_max_u32 v7, v7, v63
    v_cmp_eq_u32 vcc, s34, v7
    s_cbranch_vccnz L_q_e_145
    v_smfmac_f32_16x16x64_bf16 v[88:91], v[60:63], a[216:223], v6
    v_smfmac_f32_16x16x64_bf16 v[92:95], v[60:63], a[248:255], v6
    s_branch L_q_e_146
L_q_e_146:
    buffer_load_dwordx4 v[48:51], v2, s[8:11], s41 offen sc1
    s_waitcnt vmcnt(2)
    v_max3_u32 v7, v48, v49, v50
    v_max_u32 v7, v7, v51
    v_cmp_eq_u32 vcc, s34, v7
    s_cbranch_vccz L_ok_e_147
    s_add_u32 s33, s33, 1
    s_cmp_gt_u32 s33, 0x100000
    s_cbranch_scc0 L_q_e_146
    s_branch chain_kernel_abort
L_ok_e_147:
    v_smfmac_f32_16x16x64_bf16 v[88:91], v[48:51], a[192:199], v6
    v_smfmac_f32_16x16x64_bf16 v[92:95], v[48:51], a[224:231], v6
    s_branch L_gd_e_110
L_q_e_145:
    buffer_load_dwordx4 v[60:63], v5, s[8:11], s41 offen sc1
    s_waitcnt vmcnt(2)
    v_max3_u32 v7, v48, v49, v50
    v_max_u32 v7, v7, v51
    v_cmp_eq_u32 vcc, s34, v7
    s_cbranch_vccz L_ok_e_148
    buffer_load_dwordx4 v[48:51], v2, s[8:11], s41 offen sc1
    s_waitcnt vmcnt(2)
    v_max3_u32 v7, v60, v61, v62
    v_max_u32 v7, v7, v63
    v_cmp_eq_u32 vcc, s34, v7
    s_cbranch_vccz L_ok_e_149
    s_add_u32 s33, s33, 1
    s_cmp_gt_u32 s33, 0x100000
    s_cbranch_scc0 L_q_e_145
    s_branch chain_kernel_abort
L_ok_e_148:
    v_smfmac_f32_16x16x64_bf16 v[88:91], v[48:51], a[192:199], v6
    v_smfmac_f32_16x16x64_bf16 v[92:95], v[48:51], a[224:231], v6
    s_branch L_q_e_114
L_ok_e_149:
    v_smfmac_f32_16x16x64_bf16 v[88:91], v[60:63], a[216:223], v6
    v_smfmac_f32_16x16x64_bf16 v[92:95], v[60:63], a[248:255], v6
    s_branch L_q_e_146
L_q_e_143:
    buffer_load_dwordx4 v[56:59], v4, s[8:11], s41 offen sc1
    s_waitcnt vmcnt(3)
    v_max3_u32 v7, v60, v61, v62
    v_max_u32 v7, v7, v63
    v_cmp_eq_u32 vcc, s34, v7
    s_cbranch_vccnz L_q_e_150
    v_smfmac_f32_16x16x64_bf16 v[88:91], v[60:63], a[216:223], v6
    v_smfmac_f32_16x16x64_bf16 v[92:95], v[60:63], a[248:255], v6
    s_branch L_q_e_151
L_q_e_151:
    buffer_load_dwordx4 v[48:51], v2, s[8:11], s41 offen sc1
    s_waitcnt vmcnt(2)
    v_max3_u32 v7, v56, v57, v58
    v_max_u32 v7, v7, v59
    v_cmp_eq_u32 vcc, s34, v7
    s_cbranch_vccz L_ok_e_152
    buffer_load_dwordx4 v[56:59], v4, s[8:11], s41 offen sc1
    s_waitcnt vmcnt(2)
    v_max3_u32 v7, v48, v49, v50
    v_max_u32 v7, v7, v51
    v_cmp_eq_u32 vcc, s34, v7
    s_cbranch_vccz L_ok_e_153
    s_add_u32 s33, s33, 1
    s_cmp_gt_u32 s33, 0x100000
    s_cbranch_scc0 L_q_e_151
    s_branch chain_kernel_abort
L_ok_e_152:
    v_smfmac_f32_16x16x64_bf16 v[88:91], v[56:59], a[208:215], v6
    v_smfmac_f32_16x16x64_bf16 v[92:95], v[56:59], a[240:247], v6
    s_branch L_q_e_146
L_ok_e_153:
    v_smfmac_f32_16x16x64_bf16 v[88:91], v[48:51], a[192:199], v6
    v_smfmac_f32_16x16x64_bf16 v[92:95], v[48:51], a[224:231], v6
    s_branch L_q_e_117
L_q_e_150:
    buffer_load_dwordx4 v[60:63], v5, s[8:11], s41 offen sc1
    s_waitcnt vmcnt(2)
    v_max3_u32 v7, v48, v49, v50
    v_max_u32 v7, v7, v51
    v_cmp_eq_u32 vcc, s34, v7
    s_cbranch_vccz L_ok_e_154
    buffer_load_dwordx4 v[48:51], v2, s[8:11], s41 offen sc1
    s_waitcnt vmcnt(2)
    v_max3_u32 v7, v56, v57, v58
    v_max_u32 v7, v7, v59
    v_cmp_eq_u32 vcc, s34, v7
    s_cbranch_vccz L_ok_e_155
    buffer_load_dwordx4 v[56:59], v4, s[8:11], s41 offen sc1
    s_waitcnt vmcnt(2)
    v_max3_u32 v7, v60, v61, v62
    v_max_u32 v7, v7, v63
    v_cmp_eq_u32 vcc, s34, v7
    s_cbranch_vccz L_ok_e_156
    s_add_u32 s33, s33, 1
    s_cmp_gt_u32 s33, 0x100000
    s_cbranch_scc0 L_q_e_150
    s_branch chain_kernel_abort
L_ok_e_154:
    v_smfmac_f32_16x16x64_bf16 v[88:91], v[48:51], a[192:199], v6
    v_smfmac_f32_16x16x64_bf16 v[92:95], v[48:51], a[224:231], v6
    s_branch L_q_e_135
L_ok_e_155:
    v_smfmac_f32_16x16x64_bf16 v[88:91], v[56:59], a[208:215], v6
    v_smfmac_f32_16x16x64_bf16 v[92:95], v[56:59], a[240:247], v6
    s_branch L_q_e_157
L_ok_e_156:
    v_smfmac_f32_16x16x64_bf16 v[88:91], v[60:63], a[216:223], v6
    v_smfmac_f32_16x16x64_bf16 v[92:95], v[60:63], a[248:255], v6
    s_branch L_q_e_151
L_q_e_157:
    buffer_load_dwordx4 v[48:51], v2, s[8:11], s41 offen sc1
    s_waitcnt vmcnt(2)
    v_max3_u32 v7, v60, v61, v62
    v_max_u32 v7, v7, v63
    v_cmp_eq_u32 vcc, s34, v7
    s_cbranch_vccz L_ok_e_158
    buffer_load_dwordx4 v[60:63], v5, s[8:11], s41 offen sc1
    s_waitcnt vmcnt(2)
    v_max3_u32 v7, v48, v49, v50
    v_max_u32 v7, v7, v51
    v_cmp_eq_u32 vcc, s34, v7
    s_cbranch_vccz L_ok_e_159
    s_add_u32 s33, s33, 1
    s_cmp_gt_u32 s33, 0x100000
    s_cbranch_scc0 L_q_e_157
    s_branch chain_kernel_abort
L_ok_e_158:
    v_smfmac_f32_16x16x64_bf16 v[88:91], v[60:63], a[216:223], v6
    v_smfmac_f32_16x16x64_bf16 v[92:95], v[60:63], a[248:255], v6
    s_branch L_q_e_146
L_ok_e_159:
    v_smfmac_f32_16x16x64_bf16 v[88:91], v[48:51], a[192:199], v6
    v_smfmac_f32_16x16x64_bf16 v[92:95], v[48:51], a[224:231], v6
    s_branch L_q_e_114
L_q_e_141:
    buffer_load_dwordx4 v[52:55], v3, s[8:11], s41 offen sc1
    s_waitcnt vmcnt(3)
    v_max3_u32 v7, v56, v57, v58
    v_max_u32 v7, v7, v59
    v_cmp_eq_u32 vcc, s34, v7
    s_cbranch_vccnz L_q_e_160
    v_smfmac_f32_16x16x64_bf16 v[88:91], v[56:59], a[208:215], v6
    v_smfmac_f32_16x16x64_bf16 v[92:95], v[56:59], a[240:247], v6
    s_branch L_q_e_161
L_q_e_161:
    buffer_load_dwordx4 v[48:51], v2, s[8:11], s41 offen sc1
    s_waitcnt vmcnt(3)
    v_max3_u32 v7, v60, v61, v62
    v_max_u32 v7, v7, v63
    v_cmp_eq_u32 vcc, s34, v7
    s_cbranch_vccnz L_q_e_162
    v_smfmac_f32_16x16x64_bf16 v[88:91], v[60:63], a[216:223], v6
    v_smfmac_f32_16x16x64_bf16 v[92:95], v[60:63], a[248:255], v6
    s_branch L_q_e_163
L_q_e_163:
    buffer_load_dwordx4 v[52:55], v3, s[8:11], s41 offen sc1
    s_waitcnt vmcnt(2)
    v_max3_u32 v7, v48, v49, v50
    v_max_u32 v7, v7, v51
    v_cmp_eq_u32 vcc, s34, v7
    s_cbranch_vccz L_ok_e_164
    buffer_load_dwordx4 v[48:51], v2, s[8:11], s41 offen sc1
    s_waitcnt vmcnt(2)
    v_max3_u32 v7, v52, v53, v54
    v_max_u32 v7, v7, v55
    v_cmp_eq_u32 vcc, s34, v7
    s_cbranch_vccz L_ok_e_165
    s_add_u32 s33, s33, 1
    s_cmp_gt_u32 s33, 0x100000
    s_cbranch_scc0 L_q_e_163
    s_branch chain_kernel_abort
L_ok_e_164:
    v_smfmac_f32_16x16x64_bf16 v[88:91], v[48:51], a[192:199], v6
    v_smfmac_f32_16x16x64_bf16 v[92:95], v[48:51], a[224:231], v6
    s_branch L_q_e_124
L_ok_e_165:
    v_smfmac_f32_16x16x64_bf16 v[88:91], v[52:55], a[200:207], v6
    v_smfmac_f32_16x16x64_bf16 v[92:95], v[52:55], a[232:239], v6
    s_branch L_q_e_146
L_q_e_162:
    buffer_load_dwordx4 v[60:63], v5, s[8:11], s41 offen sc1
    s_waitcnt vmcnt(2)
    v_max3_u32 v7, v52, v53, v54
    v_max_u32 v7, v7, v55
    v_cmp_eq_u32 vcc, s34, v7
    s_cbranch_vccz L_ok_e_166
    buffer_load_dwordx4 v[52:55], v3, s[8:11], s41 offen sc1
    s_waitcnt vmcnt(2)
    v_max3_u32 v7, v48, v49, v50
    v_max_u32 v7, v7, v51
    v_cmp_eq_u32 vcc, s34, v7
    s_cbranch_vccz L_ok_e_167
    buffer_load_dwordx4 v[48:51], v2, s[8:11], s41 offen sc1
    s_waitcnt vmcnt(2)
    v_max3_u32 v7, v60, v61, v62
    v_max_u32 v7, v7, v63
    v_cmp_eq_u32 vcc, s34, v7
    s_cbranch_vccz L_ok_e_168
    s_add_u32 s33, s33, 1
    s_cmp_gt_u32 s33, 0x100000
    s_cbranch_scc0 L_q_e_162
    s_branch chain_kernel_abort
L_ok_e_166:
    v_smfmac_f32_16x16x64_bf16 v[88:91], v[52:55], a[200:207], v6
    v_smfmac_f32_16x16x64_bf16 v[92:95], v[52:55], a[232:239], v6
    s_branch L_q_e_157
L_ok_e_167:
    v_smfmac_f32_16x16x64_bf16 v[88:91], v[48:51], a[192:199], v6
    v_smfmac_f32_16x16x64_bf16 v[92:95], v[48:51], a[224:231], v6
    s_branch L_q_e_136
L_ok_e_168:
    v_smfmac_f32_16x16x64_bf16 v[88:91], v[60:63], a[216:223], v6
    v_smfmac_f32_16x16x64_bf16 v[92:95], v[60:63], a[248:255], v6
    s_branch L_q_e_169
L_q_e_169:
    buffer_load_dwordx4 v[48:51], v2, s[8:11], s41 offen sc1
    s_waitcnt vmcnt(2)
    v_max3_u32 v7, v52, v53, v54
    v_max_u32 v7, v7, v55
    v_cmp_eq_u32 vcc, s34, v7
    s_cbranch_vccz L_ok_e_170
    buffer_load_dwordx4 v[52:55], v3, s[8:11], s41 offen sc1
    s_waitcnt vmcnt(2)
    v_max3_u32 v7, v48, v49, v50
    v_max_u32 v7, v7, v51
    v_cmp_eq_u32 vcc, s34, v7
    s_cbranch_vccz L_ok_e_171
    s_add_u32 s33, s33, 1
    s_cmp_gt_u32 s33, 0x100000
    s_cbranch_scc0 L_q_e_169
    s_branch chain_kernel_abort
L_ok_e_170:
    v_smfmac_f32_16x16x64_bf16 v[88:91], v[52:55], a[200:207], v6
    v_smfmac_f32_16x16x64_bf16 v[92:95], v[52:55], a[232:239], v6
    s_branch L_q_e_146
L_ok_e_171:
    v_smfmac_f32_16x16x64_bf16 v[88:91], v[48:51], a[192:199], v6
    v_smfmac_f32_16x16x64_bf16 v[92:95], v[48:51], a[224:231], v6
    s_branch L_q_e_124
L_q_e_160:
    buffer_load_dwordx4 v[56:59], v4, s[8:11], s41 offen sc1
    s_waitcnt vmcnt(3)
    v_max3_u32 v7, v60, v61, v62
    v_max_u32 v7, v7, v63
    v_cmp_eq_u32 vcc, s34, v7
    s_cbranch_vccnz L_q_e_172
    v_smfmac_f32_16x16x64_bf16 v[88:91], v[60:63], a[216:223], v6
    v_smfmac_f32_16x16x64_bf16 v[92:95], v[60:63], a[248:255], v6
    s_branch L_q_e_173
L_q_e_173:
    buffer_load_dwordx4 v[48:51], v2, s[8:11], s41 offen sc1
    s_waitcnt vmcnt(2)
    v_max3_u32 v7, v52, v53, v54
    v_max_u32 v7, v7, v55
    v_cmp_eq_u32 vcc, s34, v7
    s_cbranch_vccz L_ok_e_174
    buffer_load_dwordx4 v[52:55], v3, s[8:11], s41 offen sc1
    s_waitcnt vmcnt(2)
    v_max3_u32 v7, v56, v57, v58
    v_max_u32 v7, v7, v59
    v_cmp_eq_u32 vcc, s34, v7
    s_cbranch_vccz L_ok_e_175
    buffer_load_dwordx4 v[56:59], v4, s[8:11], s41 offen sc1
    s_waitcnt vmcnt(2)
    v_max3_u32 v7, v48, v49, v50
    v_max_u32 v7, v7, v51
    v_cmp_eq_u32 vcc, s34, v7
    s_cbranch_vccz L_ok_e_176
    s_add_u32 s33, s33, 1
    s_cmp_gt_u32 s33, 0x100000
    s_cbranch_scc0 L_q_e_173
    s_branch chain_kernel_abort
L_ok_e_174:
    v_smfmac_f32_16x16x64_bf16 v[88:91], v[52:55], a[200:207], v6
    v_smfmac_f32_16x16x64_bf16 v[92:95], v[52:55], a[232:239], v6
    s_branch L_q_e_151
L_ok_e_175:
    v_smfmac_f32_16x16x64_bf16 v[88:91], v[56:59], a[208:215], v6
    v_smfmac_f32_16x16x64_bf16 v[92:95], v[56:59], a[240:247], v6
    s_branch L_q_e_169
L_ok_e_176:
    v_smfmac_f32_16x16x64_bf16 v[88:91], v[48:51], a[192:199], v6
    v_smfmac_f32_16x16x64_bf16 v[92:95], v[48:51], a[224:231], v6
    s_branch L_q_e_129
L_q_e_172:
    buffer_load_dwordx4 v[60:63], v5, s[8:11], s41 offen sc1
    s_waitcnt vmcnt(2)
    v_max3_u32 v7, v48, v49, v50
    v_max_u32 v7, v7, v51
    v_cmp_eq_u32 vcc, s34, v7
    s_cbranch_vccz L_ok_e_177
    buffer_load_dwordx4 v[48:51], v2, s[8:11], s41 offen sc1
    s_waitcnt vmcnt(2)
    v_max3_u32 v7, v52, v53, v54
    v_max_u32 v7, v7, v55
    v_cmp_eq_u32 vcc, s34, v7
    s_cbranch_vccz L_ok_e_178
    buffer_load_dwordx4 v[52:55], v3, s[8:11], s41 offen sc1
    s_waitcnt vmcnt(2)
    v_max3_u32 v7, v56, v57, v58
    v_max_u32 v7, v7, v59
    v_cmp_eq_u32 vcc, s34, v7
    s_cbranch_vccz L_ok_e_179
    buffer_load_dwordx4 v[56:59], v4, s[8:11], s41 offen sc1
    s_waitcnt vmcnt(2)
    v_max3_u32 v7, v60, v61, v62
    v_max_u32 v7, v7, v63
    v_cmp_eq_u32 vcc, s34, v7
    s_cbranch_vccz L_ok_e_180
    s_add_u32 s33, s33, 1
    s_cmp_gt_u32 s33, 0x100000
    s_cbranch_scc0 L_q_e_172
    s_branch chain_kernel_abort
L_ok_e_177:
    v_smfmac_f32_16x16x64_bf16 v[88:91], v[48:51], a[192:199], v6
    v_smfmac_f32_16x16x64_bf16 v[92:95], v[48:51], a[224:231], v6
    s_branch L_q_e_181
L_ok_e_178:
    v_smfmac_f32_16x16x64_bf16 v[88:91], v[52:55], a[200:207], v6
    v_smfmac_f32_16x16x64_bf16 v[92:95], v[52:55], a[232:239], v6
    s_branch L_q_e_182
L_ok_e_179:
    v_smfmac_f32_16x16x64_bf16 v[88:91], v[56:59], a[208:215], v6
    v_smfmac_f32_16x16x64_bf16 v[92:95], v[56:59], a[240:247], v6
    s_branch L_q_e_183
L_ok_e_180:
    v_smfmac_f32_16x16x64_bf16 v[88:91], v[60:63], a[216:223], v6
    v_smfmac_f32_16x16x64_bf16 v[92:95], v[60:63], a[248:255], v6
    s_branch L_q_e_173
L_q_e_183:
    buffer_load_dwordx4 v[48:51], v2, s[8:11], s41 offen sc1
    s_waitcnt vmcnt(2)
    v_max3_u32 v7, v52, v53, v54
    v_max_u32 v7, v7, v55
    v_cmp_eq_u32 vcc, s34, v7
    s_cbranch_vccz L_ok_e_184
    buffer_load_dwordx4 v[52:55], v3, s[8:11], s41 offen sc1
    s_waitcnt vmcnt(2)
    v_max3_u32 v7, v60, v61, v62
    v_max_u32 v7, v7, v63
    v_cmp_eq_u32 vcc, s34, v7
    s_cbranch_vccz L_ok_e_185
    buffer_load_dwordx4 v[60:63], v5, s[8:11], s41 offen sc1
    s_waitcnt vmcnt(2)
    v_max3_u32 v7, v48, v49, v50
    v_max_u32 v7, v7, v51
    v_cmp_eq_u32 vcc, s34, v7
    s_cbranch_vccz L_ok_e_186
    s_add_u32 s33, s33, 1
    s_cmp_gt_u32 s33, 0x100000
    s_cbranch_scc0 L_q_e_183
    s_branch chain_kernel_abort
L_ok_e_184:
    v_smfmac_f32_16x16x64_bf16 v[88:91], v[52:55], a[200:207], v6
    v_smfmac_f32_16x16x64_bf16 v[92:95], v[52:55], a[232:239], v6
    s_branch L_q_e_157
L_ok_e_185:
    v_smfmac_f32_16x16x64_bf16 v[88:91], v[60:63], a[216:223], v6
    v_smfmac_f32_16x16x64_bf16 v[92:95], v[60:63], a[248:255], v6
    s_branch L_q_e_169
L_ok_e_186:
    v_smfmac_f32_16x16x64_bf16 v[88:91], v[48:51], a[192:199], v6
    v_smfmac_f32_16x16x64_bf16 v[92:95], v[48:51], a[224:231], v6
    s_branch L_q_e_136
L_q_e_182:
    buffer_load_dwordx4 v[48:51], v2, s[8:11], s41 offen sc1
    s_waitcnt vmcnt(2)
    v_max3_u32 v7, v56, v57, v58
    v_max_u32 v7, v7, v59
    v_cmp_eq_u32 vcc, s34, v7
    s_cbranch_vccz L_ok_e_187
    buffer_load_dwordx4 v[56:59], v4, s[8:11], s41 offen sc1
    s_waitcnt vmcnt(2)
    v_max3_u32 v7, v60, v61, v62
    v_max_u32 v7, v7, v63
    v_cmp_eq_u32 vcc, s34, v7
    s_cbranch_vccz L_ok_e_188
    buffer_load_dwordx4 v[60:63], v5, s[8:11], s41 offen sc1
    s_waitcnt vmcnt(2)
    v_max3_u32 v7, v48, v49, v50
    v_max_u32 v7, v7, v51
    v_cmp_eq_u32 vcc, s34, v7
    s_cbranch_vccz L_ok_e_189
    s_add_u32 s33, s33, 1
    s_cmp_gt_u32 s33, 0x100000
    s_cbranch_scc0 L_q_e_182
    s_branch chain_kernel_abort
L_ok_e_187:
    v_smfmac_f32_16x16x64_bf16 v[88:91], v[56:59], a[208:215], v6
    v_smfmac_f32_16x16x64_bf16 v[92:95], v[56:59], a[240:247], v6
    s_branch L_q_e_157
L_ok_e_188:
    v_smfmac_f32_16x16x64_bf16 v[88:91], v[60:63], a[216:223], v6
    v_smfmac_f32_16x16x64_bf16 v[92:95], v[60:63], a[248:255], v6
    s_branch L_q_e_151
L_ok_e_189:
    v_smfmac_f32_16x16x64_bf16 v[88:91], v[48:51], a[192:199], v6
    v_smfmac_f32_16x16x64_bf16 v[92:95], v[48:51], a[224:231], v6
    s_branch L_q_e_135
L_q_e_181:
    buffer_load_dwordx4 v[52:55], v3, s[8:11], s41 offen sc1
    s_waitcnt vmcnt(2)
    v_max3_u32 v7, v56, v57, v58
    v_max_u32 v7, v7, v59
    v_cmp_eq_u32 vcc, s34, v7
    s_cbranch_vccz L_ok_e_190
    buffer_load_dwordx4 v[56:59], v4, s[8:11], s41 offen sc1
    s_waitcnt vmcnt(2)
    v_max3_u32 v7, v60, v61, v62
    v_max_u32 v7, v7, v63
    v_cmp_eq_u32 vcc, s34, v7
    s_cbranch_vccz L_ok_e_191
    buffer_load_dwordx4 v[60:63], v5, s[8:11], s41 offen sc1
    s_waitcnt vmcnt(2)
    v_max3_u32 v7, v52, v53, v54
    v_max_u32 v7, v7, v55
    v_cmp_eq_u32 vcc, s34, v7
    s_cbranch_vccz L_ok_e_192
    s_add_u32 s33, s33, 1
    s_cmp_gt_u32 s33, 0x100000
    s_cbranch_scc0 L_q_e_181
    s_branch chain_kernel_abort
L_ok_e_190:
    v_smfmac_f32_16x16x64_bf16 v[88:91], v[56:59], a[208:215], v6
    v_smfmac_f32_16x16x64_bf16 v[92:95], v[56:59], a[240:247], v6
    s_branch L_q_e_136
L_ok_e_191:
    v_smfmac_f32_16x16x64_bf16 v[88:91], v[60:63], a[216:223], v6
    v_smfmac_f32_16x16x64_bf16 v[92:95], v[60:63], a[248:255], v6
    s_branch L_q_e_129
L_ok_e_192:
    v_smfmac_f32_16x16x64_bf16 v[88:91], v[52:55], a[200:207], v6
    v_smfmac_f32_16x16x64_bf16 v[92:95], v[52:55], a[232:239], v6
    s_branch L_q_e_135
L_gf_193:
    s_waitcnt vmcnt(4)
    v_pk_add_f32 v[148:149], v[168:169], v[212:213]
    v_pk_add_f32 v[150:151], v[170:171], v[214:215]
    s_waitcnt vmcnt(3)
    v_pk_add_f32 v[148:149], v[148:149], v[216:217]
    v_pk_add_f32 v[150:151], v[150:151], v[218:219]
    s_waitcnt vmcnt(2)
    v_pk_add_f32 v[148:149], v[148:149], v[220:221]
    v_pk_add_f32 v[150:151], v[150:151], v[222:223]
    v_pk_add_f32 v[154:155], v[148:149], v[150:151]
    v_cmp_u_f32 vcc, v154, v155
    v_cvt_pk_bf16_f32 v180, v148, v149
    v_cvt_pk_bf16_f32 v181, v150, v151
    s_cbranch_vccz L_gok_194
    buffer_load_dwordx4 v[212:215], v17, s[8:11], s22 offen offset:1024 sc1
    buffer_load_dwordx4 v[216:219], v18, s[8:11], s22 offen offset:1024 sc1
    buffer_load_dwordx4 v[220:223], v19, s[8:11], s22 offen offset:1024 sc1
    s_nop 11
L_rt_196:
    buffer_load_dwordx4 v[200:203], v17, s[8:11], s22 offen offset:0 sc1
    buffer_load_dwordx4 v[204:207], v18, s[8:11], s22 offen offset:0 sc1
    buffer_load_dwordx4 v[208:211], v19, s[8:11], s22 offen offset:0 sc1
    s_waitcnt vmcnt(5)
    v_pk_add_f32 v[148:149], v[168:169], v[212:213]
    v_pk_add_f32 v[150:151], v[170:171], v[214:215]
    s_waitcnt vmcnt(4)
    v_pk_add_f32 v[148:149], v[148:149], v[216:217]
    v_pk_add_f32 v[150:151], v[150:151], v[218:219]
    s_waitcnt vmcnt(3)
    v_pk_add_f32 v[148:149], v[148:149], v[220:221]
    v_pk_add_f32 v[150:151], v[150:151], v[222:223]
    v_pk_add_f32 v[154:155], v[148:149], v[150:151]
    v_cmp_u_f32 vcc, v154, v155
    v_cvt_pk_bf16_f32 v180, v148, v149
    v_cvt_pk_bf16_f32 v181, v150, v151
    s_cbranch_vccz L_gok_194
    buffer_load_dwordx4 v[212:215], v17, s[8:11], s22 offen offset:1024 sc1
    buffer_load_dwordx4 v[216:219], v18, s[8:11], s22 offen offset:1024 sc1
    buffer_load_dwordx4 v[220:223], v19, s[8:11], s22 offen offset:1024 sc1
    s_waitcnt vmcnt(5)
    v_pk_add_f32 v[148:149], v[168:169], v[200:201]
    v_pk_add_f32 v[150:151], v[170:171], v[202:203]
    s_waitcnt vmcnt(4)
    v_pk_add_f32 v[148:149], v[148:149], v[204:205]
    v_pk_add_f32 v[150:151], v[150:151], v[206:207]
    s_waitcnt vmcnt(3)
    v_pk_add_f32 v[148:149], v[148:149], v[208:209]
    v_pk_add_f32 v[150:151], v[150:151], v[210:211]
    v_pk_add_f32 v[154:155], v[148:149], v[150:151]
    v_cmp_u_f32 vcc, v154, v155
    v_cvt_pk_bf16_f32 v180, v148, v149
    v_cvt_pk_bf16_f32 v181, v150, v151
    s_cbranch_vccz L_gok_194
    s_add_u32 s33, s33, 1
    s_cmp_gt_u32 s33, 0x100000
    s_cbranch_scc1 chain_kernel_abort
    s_and_b32 s20, s33, 63
    s_cbranch_scc1 L_rt_196
    v_cmp_eq_u32 vcc, s34, v200
    v_cmp_eq_u32 s[20:21], s34, v201
    s_or_b64 vcc, vcc, s[20:21]
    v_cmp_eq_u32 s[20:21], s34, v202
    s_or_b64 vcc, vcc, s[20:21]
    v_cmp_eq_u32 s[20:21], s34, v203
    s_or_b64 vcc, vcc, s[20:21]
    v_cmp_eq_u32 s[20:21], s34, v204
    s_or_b64 vcc, vcc, s[20:21]
    v_cmp_eq_u32 s[20:21], s34, v205
    s_or_b64 vcc, vcc, s[20:21]
    v_cmp_eq_u32 s[20:21], s34, v206
    s_or_b64 vcc, vcc, s[20:21]
    v_cmp_eq_u32 s[20:21], s34, v207
    s_or_b64 vcc, vcc, s[20:21]
    v_cmp_eq_u32 s[20:21], s34, v208
    s_or_b64 vcc, vcc, s[20:21]
    v_cmp_eq_u32 s[20:21], s34, v209
    s_or_b64 vcc, vcc, s[20:21]
    v_cmp_eq_u32 s[20:21], s34, v210
    s_or_b64 vcc, vcc, s[20:21]
    v_cmp_eq_u32 s[20:21], s34, v211
    s_or_b64 vcc, vcc, s[20:21]
    s_cbranch_vccnz L_rt_196
    s_branch L_gok_194
chain_kernel_abort:
    s_mov_b64 exec, 1
    v_mov_b32 v1, s19
    v_or_b32 v1, 0xdead0000, v1
    v_mov_b32 v2, 124
    buffer_store_dword v1, v2, s[12:15], 0 offen
chain_kernel_done:
    s_endpgm
chain_kernel_worker:
    s_sub_u32 s40, s16, 4
    s_mov_b32 s41, s17
    s_mov_b32 s49, s18
    s_mov_b32 s12, s100
    s_and_b32 s13, s101, 0xffff
    s_mov_b32 s14, 0x10000000
    s_mov_b32 s15, 0x00020000
    s_mov_b32 s36, 0
    v_mov_b32 v84, 1
    v_min_u32 v85, 1, v0
    v_lshlrev_b32 v85, 30, v85
    s_cmp_eq_u32 s40, 3
    s_cbranch_scc1 L_g1_202
    s_mov_b32 s25, s40
    s_cmp_eq_u32 s25, 1
    s_cselect_b32 s16, s90, s88
    s_cselect_b32 s17, s91, s89
    s_cmp_eq_u32 s25, 2
    s_cselect_b32 s16, s86, s16
    s_cselect_b32 s17, s87, s17
    s_and_b32 s17, s17, 0xffff
    s_mov_b32 s18, 0x800000
    s_mov_b32 s19, 0x00020000
    s_mov_b32 s46, s41
    s_lshl_b32 s44, s46, 8
    v_and_b32 v1, 15, v0
    v_bfe_u32 v2, v0, 4, 2
    v_lshrrev_b32 v3, 6, v0
    v_lshlrev_b32 v4, 2, v2
    v_xor_b32 v4, v4, v1
    v_lshlrev_b32 v4, 4, v4
    v_lshl_add_u32 v5, v3, 5, v2
    s_mov_b32 s25, 8192
    v_mul_lo_u32 v5, v5, s25
    v_add_u32 v20, v5, v4
    v_bfe_u32 v4, v0, 2, 2
    v_lshl_add_u32 v5, v2, 3, v4
    v_lshlrev_b32 v5, 8, v5
    v_xor_b32 v4, v4, v3
    v_lshl_add_u32 v5, v4, 6, v5
    v_and_b32 v4, 3, v0
    v_lshl_add_u32 v5, v4, 3, v5
    v_and_b32 v4, 2, v4
    v_lshl_add_u32 v21, v4, 3, v5
    v_add_u32 v22, 16, v21
    v_add_u32 v23, 0x10000, v21
    v_add_u32 v24, 0x10000, v22
    s_lshl_b32 s26, s49, 13
    s_mov_b32 s25, s44
    s_barrier
    s_add_u32 m0, s26, 0
    s_add_u32 s27, s25, 0
    buffer_load_dwordx4 v20, s[16:19], s27 offen lds
    s_add_u32 m0, s26, 1024
    s_add_u32 s27, s25, 32768
    buffer_load_dwordx4 v20, s[16:19], s27 offen lds
    s_add_u32 m0, s26, 2048
    s_add_u32 s27, s25, 65536
    buffer_load_dwordx4 v20, s[16:19], s27 offen lds
    s_add_u32 m0, s26, 3072
    s_add_u32 s27, s25, 98304
    buffer_load_dwordx4 v20, s[16:19], s27 offen lds
    s_add_u32 m0, s26, 4096
    s_add_u32 s27, s25, 131072
    buffer_load_dwordx4 v20, s[16:19], s27 offen lds
    s_add_u32 m0, s26, 5120
    s_add_u32 s27, s25, 163840
    buffer_load_dwordx4 v20, s[16:19], s27 offen lds
    s_add_u32 m0, s26, 6144
    s_add_u32 s27, s25, 196608
    buffer_load_dwordx4 v20, s[16:19], s27 offen lds
    s_add_u32 m0, s26, 7168
    s_add_u32 s27, s25, 229376
    buffer_load_dwordx4 v20, s[16:19], s27 offen lds
    s_add_u32 m0, s26, 32768
    s_add_u32 s27, s25, 1048576
    buffer_load_dwordx4 v20, s[16:19], s27 offen lds
    s_add_u32 m0, s26, 33792
    s_add_u32 s27, s25, 1081344
    buffer_load_dwordx4 v20, s[16:19], s27 offen lds
    s_add_u32 m0, s26, 34816
    s_add_u32 s27, s25, 1114112
    buffer_load_dwordx4 v20, s[16:19], s27 offen lds
    s_add_u32 m0, s26, 35840
    s_add_u32 s27, s25, 1146880
    buffer_load_dwordx4 v20, s[16:19], s27 offen lds
    s_add_u32 m0, s26, 36864
    s_add_u32 s27, s25, 1179648
    buffer_load_dwordx4 v20, s[16:19], s27 offen lds
    s_add_u32 m0, s26, 37888
    s_add_u32 s27, s25, 1212416
    buffer_load_dwordx4 v20, s[16:19], s27 offen lds
    s_add_u32 m0, s26, 38912
    s_add_u32 s27, s25, 1245184
    buffer_load_dwordx4 v20, s[16:19], s27 offen lds
    s_add_u32 m0, s26, 39936
    s_add_u32 s27, s25, 1277952
    buffer_load_dwordx4 v20, s[16:19], s27 offen lds
    s_add_u32 m0, s26, 65536
    s_add_u32 s27, s25, 2097152
    buffer_load_dwordx4 v20, s[16:19], s27 offen lds
    s_add_u32 m0, s26, 66560
    s_add_u32 s27, s25, 2129920
    buffer_load_dwordx4 v20, s[16:19], s27 offen lds
    s_add_u32 m0, s26, 67584
    s_add_u32 s27, s25, 2162688
    buffer_load_dwordx4 v20, s[16:19], s27 offen lds
    s_add_u32 m0, s26, 68608
    s_add_u32 s27, s25, 2195456
    buffer_load_dwordx4 v20, s[16:19], s27 offen lds
    s_add_u32 m0, s26, 69632
    s_add_u32 s27, s25, 2228224
    buffer_load_dwordx4 v20, s[16:19], s27 offen lds
    s_add_u32 m0, s26, 70656
    s_add_u32 s27, s25, 2260992
    buffer_load_dwordx4 v20, s[16:19], s27 offen lds
    s_add_u32 m0, s26, 71680
    s_add_u32 s27, s25, 2293760
    buffer_load_dwordx4 v20, s[16:19], s27 offen lds
    s_add_u32 m0, s26, 72704
    s_add_u32 s27, s25, 2326528
    buffer_load_dwordx4 v20, s[16:19], s27 offen lds
    s_add_u32 m0, s26, 98304
    s_add_u32 s27, s25, 3145728
    buffer_load_dwordx4 v20, s[16:19], s27 offen lds
    s_add_u32 m0, s26, 99328
    s_add_u32 s27, s25, 3178496
    buffer_load_dwordx4 v20, s[16:19], s27 offen lds
    s_add_u32 m0, s26, 100352
    s_add_u32 s27, s25, 3211264
    buffer_load_dwordx4 v20, s[16:19], s27 offen lds
    s_add_u32 m0, s26, 101376
    s_add_u32 s27, s25, 3244032
    buffer_load_dwordx4 v20, s[16:19], s27 offen lds
    s_add_u32 m0, s26, 102400
    s_add_u32 s27, s25, 3276800
    buffer_load_dwordx4 v20, s[16:19], s27 offen lds
    s_add_u32 m0, s26, 103424
    s_add_u32 s27, s25, 3309568
    buffer_load_dwordx4 v20, s[16:19], s27 offen lds
    s_add_u32 m0, s26, 104448
    s_add_u32 s27, s25, 3342336
    buffer_load_dwordx4 v20, s[16:19], s27 offen lds
    s_add_u32 m0, s26, 105472
    s_add_u32 s27, s25, 3375104
    buffer_load_dwordx4 v20, s[16:19], s27 offen lds
    s_waitcnt vmcnt(24)
    s_barrier
    ds_read_b64_tr_b16 a[0:1], v21 offset:0
    ds_read_b64_tr_b16 a[2:3], v21 offset:1024
    ds_read_b64_tr_b16 a[4:5], v22 offset:0
    ds_read_b64_tr_b16 a[6:7], v22 offset:1024
    ds_read_b64_tr_b16 a[8:9], v21 offset:8192
    ds_read_b64_tr_b16 a[10:11], v21 offset:9216
    ds_read_b64_tr_b16 a[12:13], v22 offset:8192
    ds_read_b64_tr_b16 a[14:15], v22 offset:9216
    s_waitcnt lgkmcnt(0)
    ds_read_b64_tr_b16 a[16:17], v21 offset:16384
    ds_read_b64_tr_b16 a[18:19], v21 offset:17408
    ds_read_b64_tr_b16 a[20:21], v22 offset:16384
    ds_read_b64_tr_b16 a[22:23], v22 offset:17408
    ds_read_b64_tr_b16 a[24:25], v21 offset:24576
    ds_read_b64_tr_b16 a[26:27], v21 offset:25600
    ds_read_b64_tr_b16 a[28:29], v22 offset:24576
    ds_read_b64_tr_b16 a[30:31], v22 offset:25600
    s_waitcnt lgkmcnt(0)
    s_barrier
    s_add_u32 m0, s26, 0
    s_add_u32 s27, s25, 4194304
    buffer_load_dwordx4 v20, s[16:19], s27 offen lds
    s_add_u32 m0, s26, 1024
    s_add_u32 s27, s25, 4227072
    buffer_load_dwordx4 v20, s[16:19], s27 offen lds
    s_add_u32 m0, s26, 2048
    s_add_u32 s27, s25, 4259840
    buffer_load_dwordx4 v20, s[16:19], s27 offen lds
    s_add_u32 m0, s26, 3072
    s_add_u32 s27, s25, 4292608
    buffer_load_dwordx4 v20, s[16:19], s27 offen lds
    s_add_u32 m0, s26, 4096
    s_add_u32 s27, s25, 4325376
    buffer_load_dwordx4 v20, s[16:19], s27 offen lds
    s_add_u32 m0, s26, 5120
    s_add_u32 s27, s25, 4358144
    buffer_load_dwordx4 v20, s[16:19], s27 offen lds
    s_add_u32 m0, s26, 6144
    s_add_u32 s27, s25, 4390912
    buffer_load_dwordx4 v20, s[16:19], s27 offen lds
    s_add_u32 m0, s26, 7168
    s_add_u32 s27, s25, 4423680
    buffer_load_dwordx4 v20, s[16:19], s27 offen lds
    s_waitcnt vmcnt(24)
    s_barrier
    ds_read_b64_tr_b16 a[32:33], v21 offset:32768
    ds_read_b64_tr_b16 a[34:35], v21 offset:33792
    ds_read_b64_tr_b16 a[36:37], v22 offset:32768
    ds_read_b64_tr_b16 a[38:39], v22 offset:33792
    ds_read_b64_tr_b16 a[40:41], v21 offset:40960
    ds_read_b64_tr_b16 a[42:43], v21 offset:41984
    ds_read_b64_tr_b16 a[44:45], v22 offset:40960
    ds_read_b64_tr_b16 a[46:47], v22 offset:41984
    s_waitcnt lgkmcnt(0)
    ds_read_b64_tr_b16 a[48:49], v21 offset:49152
    ds_read_b64_tr_b16 a[50:51], v21 offset:50176
    ds_read_b64_tr_b16 a[52:53], v22 offset:49152
    ds_read_b64_tr_b16 a[54:55], v22 offset:50176
    ds_read_b64_tr_b16 a[56:57], v21 offset:57344
    ds_read_b64_tr_b16 a[58:59], v21 offset:58368
    ds_read_b64_tr_b16 a[60:61], v22 offset:57344
    ds_read_b64_tr_b16 a[62:63], v22 offset:58368
    s_waitcnt lgkmcnt(0)
    s_barrier
    s_add_u32 m0, s26, 32768
    s_add_u32 s27, s25, 5242880
    buffer_load_dwordx4 v20, s[16:19], s27 offen lds
    s_add_u32 m0, s26, 33792
    s_add_u32 s27, s25, 5275648
    buffer_load_dwordx4 v20, s[16:19], s27 offen lds
    s_add_u32 m0, s26, 34816
    s_add_u32 s27, s25, 5308416
    buffer_load_dwordx4 v20, s[16:19], s27 offen lds
    s_add_u32 m0, s26, 35840
    s_add_u32 s27, s25, 5341184
    buffer_load_dwordx4 v20, s[16:19], s27 offen lds
    s_add_u32 m0, s26, 36864
    s_add_u32 s27, s25, 5373952
    buffer_load_dwordx4 v20, s[16:19], s27 offen lds
    s_add_u32 m0, s26, 37888
    s_add_u32 s27, s25, 5406720
    buffer_load_dwordx4 v20, s[16:19], s27 offen lds
    s_add_u32 m0, s26, 38912
    s_add_u32 s27, s25, 5439488
    buffer_load_dwordx4 v20, s[16:19], s27 offen lds
    s_add_u32 m0, s26, 39936
    s_add_u32 s27, s25, 5472256
    buffer_load_dwordx4 v20, s[16:19], s27 offen lds
    s_waitcnt vmcnt(24)
    s_barrier
    ds_read_b64_tr_b16 a[64:65], v23 offset:0
    ds_read_b64_tr_b16 a[66:67], v23 offset:1024
    ds_read_b64_tr_b16 a[68:69], v24 offset:0
    ds_read_b64_tr_b16 a[70:71], v24 offset:1024
    ds_read_b64_tr_b16 a[72:73], v23 offset:8192
    ds_read_b64_tr_b16 a[74:75], v23 offset:9216
    ds_read_b64_tr_b16 a[76:77], v24 offset:8192
    ds_read_b64_tr_b16 a[78:79], v24 offset:9216
    s_waitcnt lgkmcnt(0)
    ds_read_b64_tr_b16 a[80:81], v23 offset:16384
    ds_read_b64_tr_b16 a[82:83], v23 offset:17408
    ds_read_b64_tr_b16 a[84:85], v24 offset:16384
    ds_read_b64_tr_b16 a[86:87], v24 offset:17408
    ds_read_b64_tr_b16 a[88:89], v23 offset:24576
    ds_read_b64_tr_b16 a[90:91], v23 offset:25600
    ds_read_b64_tr_b16 a[92:93], v24 offset:24576
    ds_read_b64_tr_b16 a[94:95], v24 offset:25600
    s_waitcnt lgkmcnt(0)
    s_barrier
    s_add_u32 m0, s26, 65536
    s_add_u32 s27, s25, 6291456
    buffer_load_dwordx4 v20, s[16:19], s27 offen lds
    s_add_u32 m0, s26, 66560
    s_add_u32 s27, s25, 6324224
    buffer_load_dwordx4 v20, s[16:19], s27 offen lds
    s_add_u32 m0, s26, 67584
    s_add_u32 s27, s25, 6356992
    buffer_load_dwordx4 v20, s[16:19], s27 offen lds
    s_add_u32 m0, s26, 68608
    s_add_u32 s27, s25, 6389760
    buffer_load_dwordx4 v20, s[16:19], s27 offen lds
    s_add_u32 m0, s26, 69632
    s_add_u32 s27, s25, 6422528
    buffer_load_dwordx4 v20, s[16:19], s27 offen lds
    s_add_u32 m0, s26, 70656
    s_add_u32 s27, s25, 6455296
    buffer_load_dwordx4 v20, s[16:19], s27 offen lds
    s_add_u32 m0, s26, 71680
    s_add_u32 s27, s25, 6488064
    buffer_load_dwordx4 v20, s[16:19], s27 offen lds
    s_add_u32 m0, s26, 72704
    s_add_u32 s27, s25, 6520832
    buffer_load_dwordx4 v20, s[16:19], s27 offen lds
    s_waitcnt vmcnt(24)
    s_barrier
    ds_read_b64_tr_b16 a[96:97], v23 offset:32768
    ds_read_b64_tr_b16 a[98:99], v23 offset:33792
    ds_read_b64_tr_b16 a[100:101], v24 offset:32768
    ds_read_b64_tr_b16 a[102:103], v24 offset:33792
    ds_read_b64_tr_b16 a[104:105], v23 offset:40960
    ds_read_b64_tr_b16 a[106:107], v23 offset:41984
    ds_read_b64_tr_b16 a[108:109], v24 offset:40960
    ds_read_b64_tr_b16 a[110:111], v24 offset:41984
    s_waitcnt lgkmcnt(0)
    ds_read_b64_tr_b16 a[112:113], v23 offset:49152
    ds_read_b64_tr_b16 a[114:115], v23 offset:50176
    ds_read_b64_tr_b16 a[116:117], v24 offset:49152
    ds_read_b64_tr_b16 a[118:119], v24 offset:50176
    ds_read_b64_tr_b16 a[120:121], v23 offset:57344
    ds_read_b64_tr_b16 a[122:123], v23 offset:58368
    ds_read_b64_tr_b16 a[124:125], v24 offset:57344
    ds_read_b64_tr_b16 a[126:127], v24 offset:58368
    s_waitcnt lgkmcnt(0)
    s_barrier
    s_add_u32 m0, s26, 98304
    s_add_u32 s27, s25, 7340032
    buffer_load_dwordx4 v20, s[16:19], s27 offen lds
    s_add_u32 m0, s26, 99328
    s_add_u32 s27, s25, 7372800
    buffer_load_dwordx4 v20, s[16:19], s27 offen lds
    s_add_u32 m0, s26, 100352
    s_add_u32 s27, s25, 7405568
    buffer_load_dwordx4 v20, s[16:19], s27 offen lds
    s_add_u32 m0, s26, 101376
    s_add_u32 s27, s25, 7438336
    buffer_load_dwordx4 v20, s[16:19], s27 offen lds
    s_add_u32 m0, s26, 102400
    s_add_u32 s27, s25, 7471104
    buffer_load_dwordx4 v20, s[16:19], s27 offen lds
    s_add_u32 m0, s26, 103424
    s_add_u32 s27, s25, 7503872
    buffer_load_dwordx4 v20, s[16:19], s27 offen lds
    s_add_u32 m0, s26, 104448
    s_add_u32 s27, s25, 7536640
    buffer_load_dwordx4 v20, s[16:19], s27 offen lds
    s_add_u32 m0, s26, 105472
    s_add_u32 s27, s25, 7569408
    buffer_load_dwordx4 v20, s[16:19], s27 offen lds
    s_waitcnt vmcnt(24)
    s_barrier
    ds_read_b64_tr_b16 a[128:129], v21 offset:0
    ds_read_b64_tr_b16 a[130:131], v21 offset:1024
    ds_read_b64_tr_b16 a[132:133], v22 offset:0
    ds_read_b64_tr_b16 a[134:135], v22 offset:1024
    ds_read_b64_tr_b16 a[136:137], v21 offset:8192
    ds_read_b64_tr_b16 a[138:139], v21 offset:9216
    ds_read_b64_tr_b16 a[140:141], v22 offset:8192
    ds_read_b64_tr_b16 a[142:143], v22 offset:9216
    s_waitcnt lgkmcnt(0)
    ds_read_b64_tr_b16 a[144:145], v21 offset:16384
    ds_read_b64_tr_b16 a[146:147], v21 offset:17408
    ds_read_b64_tr_b16 a[148:149], v22 offset:16384
    ds_read_b64_tr_b16 a[150:151], v22 offset:17408
    ds_read_b64_tr_b16 a[152:153], v21 offset:24576
    ds_read_b64_tr_b16 a[154:155], v21 offset:25600
    ds_read_b64_tr_b16 a[156:157], v22 offset:24576
    ds_read_b64_tr_b16 a[158:159], v22 offset:25600
    s_waitcnt lgkmcnt(0)
    s_waitcnt vmcnt(16)
    s_barrier
    ds_read_b64_tr_b16 a[160:161], v21 offset:32768
    ds_read_b64_tr_b16 a[162:163], v21 offset:33792
    ds_read_b64_tr_b16 a[164:165], v22 offset:32768
    ds_read_b64_tr_b16 a[166:167], v22 offset:33792
    ds_read_b64_tr_b16 a[168:169], v21 offset:40960
    ds_read_b64_tr_b16 a[170:171], v21 offset:41984
    ds_read_b64_tr_b16 a[172:173], v22 offset:40960
    ds_read_b64_tr_b16 a[174:175], v22 offset:41984
    s_waitcnt lgkmcnt(0)
    ds_read_b64_tr_b16 a[176:177], v21 offset:49152
    ds_read_b64_tr_b16 a[178:179], v21 offset:50176
    ds_read_b64_tr_b16 a[180:181], v22 offset:49152
    ds_read_b64_tr_b16 a[182:183], v22 offset:50176
    ds_read_b64_tr_b16 a[184:185], v21 offset:57344
    ds_read_b64_tr_b16 a[186:187], v21 offset:58368
    ds_read_b64_tr_b16 a[188:189], v22 offset:57344
    ds_read_b64_tr_b16 a[190:191], v22 offset:58368
    s_waitcnt lgkmcnt(0)
    s_waitcnt vmcnt(8)
    s_barrier
    ds_read_b64_tr_b16 a[192:193], v23 offset:0
    ds_read_b64_tr_b16 a[194:195], v23 offset:1024
    ds_read_b64_tr_b16 a[196:197], v24 offset:0
    ds_read_b64_tr_b16 a[198:199], v24 offset:1024
    ds_read_b64_tr_b16 a[200:201], v23 offset:8192
    ds_read_b64_tr_b16 a[202:203], v23 offset:9216
    ds_read_b64_tr_b16 a[204:205], v24 offset:8192
    ds_read_b64_tr_b16 a[206:207], v24 offset:9216
    s_waitcnt lgkmcnt(0)
    ds_read_b64_tr_b16 a[208:209], v23 offset:16384
    ds_read_b64_tr_b16 a[210:211], v23 offset:17408
    ds_read_b64_tr_b16 a[212:213], v24 offset:16384
    ds_read_b64_tr_b16 a[214:215], v24 offset:17408
    ds_read_b64_tr_b16 a[216:217], v23 offset:24576
    ds_read_b64_tr_b16 a[218:219], v23 offset:25600
    ds_read_b64_tr_b16 a[220:221], v24 offset:24576
    ds_read_b64_tr_b16 a[222:223], v24 offset:25600
    s_waitcnt lgkmcnt(0)
    s_waitcnt vmcnt(0)
    s_barrier
    ds_read_b64_tr_b16 a[224:225], v23 offset:32768
    ds_read_b64_tr_b16 a[226:227], v23 offset:33792
    ds_read_b64_tr_b16 a[228:229], v24 offset:32768
    ds_read_b64_tr_b16 a[230:231], v24 offset:33792
    ds_read_b64_tr_b16 a[232:233], v23 offset:40960
    ds_read_b64_tr_b16 a[234:235], v23 offset:41984
    ds_read_b64_tr_b16 a[236:237], v24 offset:40960
    ds_read_b64_tr_b16 a[238:239], v24 offset:41984
    s_waitcnt lgkmcnt(0)
    ds_read_b64_tr_b16 a[240:241], v23 offset:49152
    ds_read_b64_tr_b16 a[242:243], v23 offset:50176
    ds_read_b64_tr_b16 a[244:245], v24 offset:49152
    ds_read_b64_tr_b16 a[246:247], v24 offset:50176
    ds_read_b64_tr_b16 a[248:249], v23 offset:57344
    ds_read_b64_tr_b16 a[250:251], v23 offset:58368
    ds_read_b64_tr_b16 a[252:253], v24 offset:57344
    ds_read_b64_tr_b16 a[254:255], v24 offset:58368
    s_waitcnt lgkmcnt(0)
    s_mov_b32 s8, s82
    s_and_b32 s9, s83, 0xffff
    s_mov_b32 s10, 0x400000
    s_mov_b32 s11, 0x00020000
    s_lshl_b32 s21, s49, 12
    v_and_b32 v1, 63, v0
    v_and_b32 v2, 15, v0
    v_bfe_u32 v3, v0, 4, 2
    v_lshrrev_b32 v4, 6, v0
    v_lshrrev_b32 v5, 5, v1
    v_lshl_add_u32 v5, v4, 3, v5
    v_add_u32 v5, 0, v5
    v_and_b32 v6, 7, v5
    v_lshrrev_b32 v7, 4, v5
    v_lshl_add_u32 v6, v7, 3, v6
    v_and_b32 v7, 31, v1
    v_xor_b32 v6, v6, v7
    v_lshlrev_b32 v6, 4, v6
    v_lshl_add_u32 v8, v5, 11, v6
    v_lshrrev_b32 v5, 5, v1
    v_lshl_add_u32 v5, v4, 3, v5
    v_add_u32 v5, 2, v5
    v_and_b32 v6, 7, v5
    v_lshrrev_b32 v7, 4, v5
    v_lshl_add_u32 v6, v7, 3, v6
    v_and_b32 v7, 31, v1
    v_xor_b32 v6, v6, v7
    v_lshlrev_b32 v6, 4, v6
    v_lshl_add_u32 v9, v5, 11, v6
    v_lshrrev_b32 v5, 5, v1
    v_lshl_add_u32 v5, v4, 3, v5
    v_add_u32 v5, 4, v5
    v_and_b32 v6, 7, v5
    v_lshrrev_b32 v7, 4, v5
    v_lshl_add_u32 v6, v7, 3, v6
    v_and_b32 v7, 31, v1
    v_xor_b32 v6, v6, v7
    v_lshlrev_b32 v6, 4, v6
    v_lshl_add_u32 v10, v5, 11, v6
    v_lshrrev_b32 v5, 5, v1
    v_lshl_add_u32 v5, v4, 3, v5
    v_add_u32 v5, 6, v5
    v_and_b32 v6, 7, v5
    v_lshrrev_b32 v7, 4, v5
    v_lshl_add_u32 v6, v7, 3, v6
    v_and_b32 v7, 31, v1
    v_xor_b32 v6, v6, v7
    v_lshlrev_b32 v6, 4, v6
    v_lshl_add_u32 v11, v5, 11, v6
    v_and_b32 v5, 8, v2
    v_add_u32 v5, v5, v2
    v_add_u32 v6, 0, v3
    v_xor_b32 v6, v6, v2
    v_lshlrev_b32 v6, 4, v6
    v_lshl_add_u32 v12, v5, 9, v6
    v_add_u32 v6, 4, v3
    v_xor_b32 v6, v6, v2
    v_lshlrev_b32 v6, 4, v6
    v_lshl_add_u32 v13, v5, 9, v6
    v_add_u32 v6, 8, v3
    v_xor_b32 v6, v6, v2
    v_lshlrev_b32 v6, 4, v6
    v_lshl_add_u32 v14, v5, 9, v6
    v_add_u32 v6, 12, v3
    v_xor_b32 v6, v6, v2
    v_lshlrev_b32 v6, 4, v6
    v_lshl_add_u32 v15, v5, 9, v6
    v_add_u32 v16, 0x10000, v12
    v_add_u32 v17, 0x10000, v13
    v_add_u32 v18, 0x10000, v14
    v_add_u32 v19, 0x10000, v15
    v_lshlrev_b32 v86, 4, v5
    v_lshl_add_u32 v86, v3, 9, v86
    s_lshl_b32 s44, s46, 15
    s_lshr_b32 s25, s49, 1
    s_lshl_b32 s25, s25, 14
    s_add_u32 s44, s44, s25
    s_and_b32 s25, s49, 1
    s_lshl_b32 s25, s25, 12
    s_add_u32 s44, s44, s25
    s_mov_b32 s22, 0
    s_mov_b32 s24, 0
    s_mov_b32 s20, 0
    s_mov_b32 s37, 0
    s_mov_b32 s23, 64
    s_mov_b32 s32, s98
    s_and_b32 s33, s99, 0xffff
    s_mov_b32 s34, 0x100
    s_mov_b32 s35, 0x00020000
    s_mov_b32 s25, 0
    v_mov_b32 v2, 0
L_pl_205:
    buffer_load_dword v1, v2, s[32:35], s25 offen sc1
    s_add_u32 s36, s36, 1
    s_cmp_gt_u32 s36, 0x100000
    s_cbranch_scc1 chain_kernel_wend
    s_waitcnt vmcnt(0)
    v_readfirstlane_b32 s26, v1
    s_and_b32 s27, s26, 0xffff
    s_cmp_ge_u32 s27, 256
    s_cbranch_scc1 L_plok_206
    s_sleep 4
    s_branch L_pl_205
L_plok_206:
    s_lshr_b32 s25, s26, 16
    s_cmp_gt_u32 s25, 64
    s_cselect_b32 s25, 0x2000, 0x0
    s_add_u32 s54, s100, 0x1fffff
    s_and_b32 s54, s54, 0xffe00000
    s_sub_u32 s55, s54, s100
    s_add_u32 s54, s55, s25
    s_xor_b32 s25, s25, 0x2000
    s_add_u32 s55, s55, s25
    s_cmp_eq_u32 s40, 2
    s_cbranch_scc1 L_q_201
    s_cmp_eq_u32 s40, 1
    s_cbranch_scc1 L_v_200
    s_barrier
    s_add_u32 m0, s21, 0
    s_nop 0
    buffer_load_dwordx4 v8, s[8:11], s20 offen lds
    s_add_u32 m0, s21, 1024
    s_nop 0
    buffer_load_dwordx4 v9, s[8:11], s20 offen lds
    s_add_u32 m0, s21, 2048
    s_nop 0
    buffer_load_dwordx4 v10, s[8:11], s20 offen lds
    s_add_u32 m0, s21, 3072
    s_nop 0
    buffer_load_dwordx4 v11, s[8:11], s20 offen lds
    s_add_u32 s20, s20, 512
    s_add_u32 m0, s21, 16384
    s_nop 0
    buffer_load_dwordx4 v8, s[8:11], s20 offen lds
    s_add_u32 m0, s21, 17408
    s_nop 0
    buffer_load_dwordx4 v9, s[8:11], s20 offen lds
    s_add_u32 m0, s21, 18432
    s_nop 0
    buffer_load_dwordx4 v10, s[8:11], s20 offen lds
    s_add_u32 m0, s21, 19456
    s_nop 0
    buffer_load_dwordx4 v11, s[8:11], s20 offen lds
    s_add_u32 s20, s20, 512
    s_add_u32 m0, s21, 32768
    s_nop 0
    buffer_load_dwordx4 v8, s[8:11], s20 offen lds
    s_add_u32 m0, s21, 33792
    s_nop 0
    buffer_load_dwordx4 v9, s[8:11], s20 offen lds
    s_add_u32 m0, s21, 34816
    s_nop 0
    buffer_load_dwordx4 v10, s[8:11], s20 offen lds
    s_add_u32 m0, s21, 35840
    s_nop 0
    buffer_load_dwordx4 v11, s[8:11], s20 offen lds
    s_add_u32 s20, s20, 512
    s_add_u32 m0, s21, 49152
    s_nop 0
    buffer_load_dwordx4 v8, s[8:11], s20 offen lds
    s_add_u32 m0, s21, 50176
    s_nop 0
    buffer_load_dwordx4 v9, s[8:11], s20 offen lds
    s_add_u32 m0, s21, 51200
    s_nop 0
    buffer_load_dwordx4 v10, s[8:11], s20 offen lds
    s_add_u32 m0, s21, 52224
    s_nop 0
    buffer_load_dwordx4 v11, s[8:11], s20 offen lds
    s_add_u32 s24, s24, 1
    s_min_u32 s24, s24, 63
    s_lshl_b32 s53, s24, 16
    s_mov_b32 s20, s53
    s_add_u32 m0, s21, 65536
    s_nop 0
    buffer_load_dwordx4 v8, s[8:11], s20 offen lds
    s_add_u32 m0, s21, 66560
    s_nop 0
    buffer_load_dwordx4 v9, s[8:11], s20 offen lds
    s_add_u32 m0, s21, 67584
    s_nop 0
    buffer_load_dwordx4 v10, s[8:11], s20 offen lds
    s_add_u32 m0, s21, 68608
    s_nop 0
    buffer_load_dwordx4 v11, s[8:11], s20 offen lds
    s_add_u32 s20, s20, 512
    s_add_u32 m0, s21, 81920
    s_nop 0
    buffer_load_dwordx4 v8, s[8:11], s20 offen lds
    s_add_u32 m0, s21, 82944
    s_nop 0
    buffer_load_dwordx4 v9, s[8:11], s20 offen lds
    s_add_u32 m0, s21, 83968
    s_nop 0
    buffer_load_dwordx4 v10, s[8:11], s20 offen lds
    s_add_u32 m0, s21, 84992
    s_nop 0
    buffer_load_dwordx4 v11, s[8:11], s20 offen lds
    s_add_u32 s20, s20, 512
    s_add_u32 m0, s21, 98304
    s_nop 0
    buffer_load_dwordx4 v8, s[8:11], s20 offen lds
    s_waitcnt vmcnt(21)
    s_barrier
    ds_read_b128 v[20:23], v12 offset:0
    ds_read_b128 v[24:27], v12 offset:4096
    ds_read_b128 v[28:31], v13 offset:0
    ds_read_b128 v[32:35], v13 offset:4096
    ds_read_b128 v[36:39], v14 offset:0
    ds_read_b128 v[40:43], v14 offset:4096
    s_waitcnt lgkmcnt(4)
L_st_207:
    v_mfma_f32_16x16x32_bf16 v[52:55], a[0:3], v[20:23], 0
    ds_read_b128 v[44:47], v15 offset:0
    s_add_u32 m0, s21, 99328
    s_sub_u32 s39, s22, 1
    v_mfma_f32_16x16x32_bf16 v[56:59], a[4:7], v[20:23], 0
    buffer_load_dwordx4 v9, s[8:11], s20 offen lds
    s_bitcmp1_b32 s39, 1
    s_cselect_b32 s38, s55, s54
    v_mfma_f32_16x16x32_bf16 v[60:63], a[0:3], v[24:27], 0
    ds_read_b128 v[48:51], v15 offset:4096
    v_mfma_f32_16x16x32_bf16 v[64:67], a[4:7], v[24:27], 0
    s_waitcnt lgkmcnt(4)
    s_add_u32 s38, s38, s44
    v_mfma_f32_16x16x32_bf16 v[52:55], a[8:11], v[28:31], v[52:55]
    ds_read_b128 v[20:23], v12 offset:256
    s_lshl_b32 s42, s39, 20
    v_mfma_f32_16x16x32_bf16 v[56:59], a[12:15], v[28:31], v[56:59]
    s_add_u32 s38, s38, s42
    v_mfma_f32_16x16x32_bf16 v[60:63], a[8:11], v[32:35], v[60:63]
    ds_read_b128 v[24:27], v12 offset:4352
    s_lshl_b32 s39, s39, 7
    v_mfma_f32_16x16x32_bf16 v[64:67], a[12:15], v[32:35], v[64:67]
    s_waitcnt lgkmcnt(4)
    s_add_u32 s39, s39, 0x5900000
    v_mfma_f32_16x16x32_bf16 v[52:55], a[16:19], v[36:39], v[52:55]
    ds_read_b128 v[28:31], v13 offset:256
    s_add_u32 m0, s21, 100352
    s_cmp_eq_u32 s37, 0
    s_cselect_b32 s38, 0x7ff00000, s38
    s_cselect_b32 s39, 0x7ff00000, s39
    v_mfma_f32_16x16x32_bf16 v[56:59], a[20:23], v[36:39], v[56:59]
    buffer_load_dwordx4 v10, s[8:11], s20 offen lds
    v_mfma_f32_16x16x32_bf16 v[60:63], a[16:19], v[40:43], v[60:63]
    ds_read_b128 v[32:35], v13 offset:4352
    v_mfma_f32_16x16x32_bf16 v[64:67], a[20:23], v[40:43], v[64:67]
    s_waitcnt lgkmcnt(4)
    v_cvt_pk_bf16_f32 v88, v68, v69
    v_mfma_f32_16x16x32_bf16 v[52:55], a[24:27], v[44:47], v[52:55]
    ds_read_b128 v[36:39], v14 offset:256
    v_cvt_pk_bf16_f32 v89, v70, v71
    v_mfma_f32_16x16x32_bf16 v[56:59], a[28:31], v[44:47], v[56:59]
    v_cvt_pk_bf16_f32 v90, v72, v73
    v_cvt_pk_bf16_f32 v91, v74, v75
    buffer_store_dwordx4 v[88:91], v86, s[12:15], s38 offen offset:0 sc1
    v_mfma_f32_16x16x32_bf16 v[60:63], a[24:27], v[48:51], v[60:63]
    ds_read_b128 v[40:43], v14 offset:4352
    v_mfma_f32_16x16x32_bf16 v[64:67], a[28:31], v[48:51], v[64:67]
    s_waitcnt lgkmcnt(4)
    v_mfma_f32_16x16x32_bf16 v[52:55], a[32:35], v[20:23], v[52:55]
    ds_read_b128 v[44:47], v15 offset:256
    s_add_u32 m0, s21, 101376
    v_cvt_pk_bf16_f32 v92, v76, v77
    v_mfma_f32_16x16x32_bf16 v[56:59], a[36:39], v[20:23], v[56:59]
    buffer_load_dwordx4 v11, s[8:11], s20 offen lds
    v_cvt_pk_bf16_f32 v93, v78, v79
    v_mfma_f32_16x16x32_bf16 v[60:63], a[32:35], v[24:27], v[60:63]
    ds_read_b128 v[48:51], v15 offset:4352
    v_cvt_pk_bf16_f32 v94, v80, v81
    v_mfma_f32_16x16x32_bf16 v[64:67], a[36:39], v[24:27], v[64:67]
    s_waitcnt lgkmcnt(4)
    v_cvt_pk_bf16_f32 v95, v82, v83
    v_mfma_f32_16x16x32_bf16 v[52:55], a[40:43], v[28:31], v[52:55]
    s_waitcnt vmcnt(20)
    s_barrier
    ds_read_b128 v[20:23], v12 offset:16384
    v_mfma_f32_16x16x32_bf16 v[56:59], a[44:47], v[28:31], v[56:59]
    s_add_u32 s20, s20, 512
    buffer_store_dwordx4 v[92:95], v86, s[12:15], s38 offen offset:128 sc1
    v_mfma_f32_16x16x32_bf16 v[60:63], a[40:43], v[32:35], v[60:63]
    ds_read_b128 v[24:27], v12 offset:20480
    v_mfma_f32_16x16x32_bf16 v[64:67], a[44:47], v[32:35], v[64:67]
    s_waitcnt lgkmcnt(4)
    v_mfma_f32_16x16x32_bf16 v[52:55], a[48:51], v[36:39], v[52:55]
    ds_read_b128 v[28:31], v13 offset:16384
    s_add_u32 m0, s21, 114688
    v_mfma_f32_16x16x32_bf16 v[56:59], a[52:55], v[36:39], v[56:59]
    buffer_load_dwordx4 v8, s[8:11], s20 offen lds
    v_mfma_f32_16x16x32_bf16 v[60:63], a[48:51], v[40:43], v[60:63]
    ds_read_b128 v[32:35], v13 offset:20480
    v_mfma_f32_16x16x32_bf16 v[64:67], a[52:55], v[40:43], v[64:67]
    s_waitcnt lgkmcnt(4)
    v_mfma_f32_16x16x32_bf16 v[52:55], a[56:59], v[44:47], v[52:55]
    ds_read_b128 v[36:39], v14 offset:16384
    v_mfma_f32_16x16x32_bf16 v[56:59], a[60:63], v[44:47], v[56:59]
    v_mfma_f32_16x16x32_bf16 v[60:63], a[56:59], v[48:51], v[60:63]
    ds_read_b128 v[40:43], v14 offset:20480
    v_mfma_f32_16x16x32_bf16 v[64:67], a[60:63], v[48:51], v[64:67]
    s_waitcnt lgkmcnt(4)
    v_mfma_f32_16x16x32_bf16 v[52:55], a[64:67], v[20:23], v[52:55]
    ds_read_b128 v[44:47], v15 offset:16384
    s_add_u32 m0, s21, 115712
    v_mfma_f32_16x16x32_bf16 v[56:59], a[68:71], v[20:23], v[56:59]
    buffer_load_dwordx4 v9, s[8:11], s20 offen lds
    v_mfma_f32_16x16x32_bf16 v[60:63], a[64:67], v[24:27], v[60:63]
    ds_read_b128 v[48:51], v15 offset:20480
    v_mfma_f32_16x16x32_bf16 v[64:67], a[68:71], v[24:27], v[64:67]
    s_waitcnt lgkmcnt(4)
    v_mfma_f32_16x16x32_bf16 v[52:55], a[72:75], v[28:31], v[52:55]
    ds_read_b128 v[20:23], v12 offset:16640
    v_mfma_f32_16x16x32_bf16 v[56:59], a[76:79], v[28:31], v[56:59]
    v_mfma_f32_16x16x32_bf16 v[60:63], a[72:75], v[32:35], v[60:63]
    ds_read_b128 v[24:27], v12 offset:20736
    s_add_u32 s24, s24, 1
    v_mfma_f32_16x16x32_bf16 v[64:67], a[76:79], v[32:35], v[64:67]
    s_waitcnt lgkmcnt(4)
    v_mfma_f32_16x16x32_bf16 v[52:55], a[80:83], v[36:39], v[52:55]
    ds_read_b128 v[28:31], v13 offset:16640
    s_add_u32 m0, s21, 116736
    v_mfma_f32_16x16x32_bf16 v[56:59], a[84:87], v[36:39], v[56:59]
    buffer_load_dwordx4 v10, s[8:11], s20 offen lds
    v_mfma_f32_16x16x32_bf16 v[60:63], a[80:83], v[40:43], v[60:63]
    ds_read_b128 v[32:35], v13 offset:20736
    v_mfma_f32_16x16x32_bf16 v[64:67], a[84:87], v[40:43], v[64:67]
    s_waitcnt lgkmcnt(4)
    s_min_u32 s24, s24, 63
    v_mfma_f32_16x16x32_bf16 v[52:55], a[88:91], v[44:47], v[52:55]
    ds_read_b128 v[36:39], v14 offset:16640
    v_mfma_f32_16x16x32_bf16 v[56:59], a[92:95], v[44:47], v[56:59]
    v_mfma_f32_16x16x32_bf16 v[60:63], a[88:91], v[48:51], v[60:63]
    ds_read_b128 v[40:43], v14 offset:20736
    s_lshl_b32 s53, s24, 16
    v_mfma_f32_16x16x32_bf16 v[64:67], a[92:95], v[48:51], v[64:67]
    s_waitcnt lgkmcnt(4)
    v_mfma_f32_16x16x32_bf16 v[52:55], a[96:99], v[20:23], v[52:55]
    ds_read_b128 v[44:47], v15 offset:16640
    s_add_u32 m0, s21, 117760
    v_mfma_f32_16x16x32_bf16 v[56:59], a[100:103], v[20:23], v[56:59]
    buffer_load_dwordx4 v11, s[8:11], s20 offen lds
    v_mfma_f32_16x16x32_bf16 v[60:63], a[96:99], v[24:27], v[60:63]
    ds_read_b128 v[48:51], v15 offset:20736
    v_mfma_f32_16x16x32_bf16 v[64:67], a[100:103], v[24:27], v[64:67]
    s_waitcnt lgkmcnt(4)
    v_mfma_f32_16x16x32_bf16 v[52:55], a[104:107], v[28:31], v[52:55]
    s_waitcnt vmcnt(20)
    s_barrier
    ds_read_b128 v[20:23], v12 offset:32768
    v_mfma_f32_16x16x32_bf16 v[56:59], a[108:111], v[28:31], v[56:59]
    s_mov_b32 s20, s53
    v_mfma_f32_16x16x32_bf16 v[60:63], a[104:107], v[32:35], v[60:63]
    ds_read_b128 v[24:27], v12 offset:36864
    v_mfma_f32_16x16x32_bf16 v[64:67], a[108:111], v[32:35], v[64:67]
    s_waitcnt lgkmcnt(4)
    v_mfma_f32_16x16x32_bf16 v[52:55], a[112:115], v[36:39], v[52:55]
    ds_read_b128 v[28:31], v13 offset:32768
    s_add_u32 m0, s21, 0
    v_mfma_f32_16x16x32_bf16 v[56:59], a[116:119], v[36:39], v[56:59]
    buffer_load_dwordx4 v8, s[8:11], s20 offen lds
    v_mfma_f32_16x16x32_bf16 v[60:63], a[112:115], v[40:43], v[60:63]
    ds_read_b128 v[32:35], v13 offset:36864
    v_mfma_f32_16x16x32_bf16 v[64:67], a[116:119], v[40:43], v[64:67]
    s_waitcnt lgkmcnt(4)
    v_mfma_f32_16x16x32_bf16 v[52:55], a[120:123], v[44:47], v[52:55]
    ds_read_b128 v[36:39], v14 offset:32768
    v_mfma_f32_16x16x32_bf16 v[56:59], a[124:127], v[44:47], v[56:59]
    v_mfma_f32_16x16x32_bf16 v[60:63], a[120:123], v[48:51], v[60:63]
    ds_read_b128 v[40:43], v14 offset:36864
    v_mfma_f32_16x16x32_bf16 v[64:67], a[124:127], v[48:51], v[64:67]
    s_waitcnt lgkmcnt(4)
    v_mfma_f32_16x16x32_bf16 v[52:55], a[128:131], v[20:23], v[52:55]
    ds_read_b128 v[44:47], v15 offset:32768
    s_add_u32 m0, s21, 1024
    v_mfma_f32_16x16x32_bf16 v[56:59], a[132:135], v[20:23], v[56:59]
    buffer_load_dwordx4 v9, s[8:11], s20 offen lds
    v_mfma_f32_16x16x32_bf16 v[60:63], a[128:131], v[24:27], v[60:63]
    ds_read_b128 v[48:51], v15 offset:36864
    v_mfma_f32_16x16x32_bf16 v[64:67], a[132:135], v[24:27], v[64:67]
    s_waitcnt lgkmcnt(4)
    v_mfma_f32_16x16x32_bf16 v[52:55], a[136:139], v[28:31], v[52:55]
    ds_read_b128 v[20:23], v12 offset:33024
    v_mfma_f32_16x16x32_bf16 v[56:59], a[140:143], v[28:31], v[56:59]
    v_mfma_f32_16x16x32_bf16 v[60:63], a[136:139], v[32:35], v[60:63]
    ds_read_b128 v[24:27], v12 offset:37120
    v_mfma_f32_16x16x32_bf16 v[64:67], a[140:143], v[32:35], v[64:67]
    s_waitcnt lgkmcnt(4)
    v_mfma_f32_16x16x32_bf16 v[52:55], a[144:147], v[36:39], v[52:55]
    ds_read_b128 v[28:31], v13 offset:33024
    s_add_u32 m0, s21, 2048
    v_mfma_f32_16x16x32_bf16 v[56:59], a[148:151], v[36:39], v[56:59]
    buffer_load_dwordx4 v10, s[8:11], s20 offen lds
    v_mfma_f32_16x16x32_bf16 v[60:63], a[144:147], v[40:43], v[60:63]
    ds_read_b128 v[32:35], v13 offset:37120
    v_mfma_f32_16x16x32_bf16 v[64:67], a[148:151], v[40:43], v[64:67]
    s_waitcnt lgkmcnt(4)
    v_mfma_f32_16x16x32_bf16 v[52:55], a[152:155], v[44:47], v[52:55]
    ds_read_b128 v[36:39], v14 offset:33024
    v_mfma_f32_16x16x32_bf16 v[56:59], a[156:159], v[44:47], v[56:59]
    v_mfma_f32_16x16x32_bf16 v[60:63], a[152:155], v[48:51], v[60:63]
    ds_read_b128 v[40:43], v14 offset:37120
    v_mfma_f32_16x16x32_bf16 v[64:67], a[156:159], v[48:51], v[64:67]
    s_waitcnt lgkmcnt(4)
    v_mfma_f32_16x16x32_bf16 v[52:55], a[160:163], v[20:23], v[52:55]
    ds_read_b128 v[44:47], v15 offset:33024
    s_add_u32 m0, s21, 3072
    v_mfma_f32_16x16x32_bf16 v[56:59], a[164:167], v[20:23], v[56:59]
    buffer_load_dwordx4 v11, s[8:11], s20 offen lds
    v_mfma_f32_16x16x32_bf16 v[60:63], a[160:163], v[24:27], v[60:63]
    ds_read_b128 v[48:51], v15 offset:37120
    v_mfma_f32_16x16x32_bf16 v[64:67], a[164:167], v[24:27], v[64:67]
    s_waitcnt lgkmcnt(4)
    v_mfma_f32_16x16x32_bf16 v[52:55], a[168:171], v[28:31], v[52:55]
    s_waitcnt vmcnt(8)
    s_barrier
    ds_read_b128 v[20:23], v12 offset:49152
    v_mfma_f32_16x16x32_bf16 v[56:59], a[172:175], v[28:31], v[56:59]
    s_add_u32 s20, s20, 512
    buffer_atomic_add v84, v85, s[12:15], s39 offen sc1
    v_mfma_f32_16x16x32_bf16 v[60:63], a[168:171], v[32:35], v[60:63]
    ds_read_b128 v[24:27], v12 offset:53248
    v_mfma_f32_16x16x32_bf16 v[64:67], a[172:175], v[32:35], v[64:67]
    s_waitcnt lgkmcnt(4)
    v_mfma_f32_16x16x32_bf16 v[52:55], a[176:179], v[36:39], v[52:55]
    ds_read_b128 v[28:31], v13 offset:49152
    s_add_u32 m0, s21, 16384
    v_mfma_f32_16x16x32_bf16 v[56:59], a[180:183], v[36:39], v[56:59]
    buffer_load_dwordx4 v8, s[8:11], s20 offen lds
    v_mfma_f32_16x16x32_bf16 v[60:63], a[176:179], v[40:43], v[60:63]
    ds_read_b128 v[32:35], v13 offset:53248
    v_mfma_f32_16x16x32_bf16 v[64:67], a[180:183], v[40:43], v[64:67]
    s_waitcnt lgkmcnt(4)
    s_mov_b32 s37, 1
    v_mfma_f32_16x16x32_bf16 v[52:55], a[184:187], v[44:47], v[52:55]
    ds_read_b128 v[36:39], v14 offset:49152
    v_mfma_f32_16x16x32_bf16 v[56:59], a[188:191], v[44:47], v[56:59]
    v_mfma_f32_16x16x32_bf16 v[60:63], a[184:187], v[48:51], v[60:63]
    ds_read_b128 v[40:43], v14 offset:53248
    v_mfma_f32_16x16x32_bf16 v[64:67], a[188:191], v[48:51], v[64:67]
    s_waitcnt lgkmcnt(4)
    v_mfma_f32_16x16x32_bf16 v[52:55], a[192:195], v[20:23], v[52:55]
    ds_read_b128 v[44:47], v15 offset:49152
    s_add_u32 m0, s21, 17408
    v_mfma_f32_16x16x32_bf16 v[56:59], a[196:199], v[20:23], v[56:59]
    buffer_load_dwordx4 v9, s[8:11], s20 offen lds
    v_mfma_f32_16x16x32_bf16 v[60:63], a[192:195], v[24:27], v[60:63]
    ds_read_b128 v[48:51], v15 offset:53248
    v_mfma_f32_16x16x32_bf16 v[64:67], a[196:199], v[24:27], v[64:67]
    s_waitcnt lgkmcnt(4)
    v_mfma_f32_16x16x32_bf16 v[52:55], a[200:203], v[28:31], v[52:55]
    ds_read_b128 v[20:23], v12 offset:49408
    v_mfma_f32_16x16x32_bf16 v[56:59], a[204:207], v[28:31], v[56:59]
    v_mfma_f32_16x16x32_bf16 v[60:63], a[200:203], v[32:35], v[60:63]
    ds_read_b128 v[24:27], v12 offset:53504
    v_mfma_f32_16x16x32_bf16 v[64:67], a[204:207], v[32:35], v[64:67]
    s_waitcnt lgkmcnt(4)
    v_mfma_f32_16x16x32_bf16 v[52:55], a[208:211], v[36:39], v[52:55]
    ds_read_b128 v[28:31], v13 offset:49408
    s_add_u32 m0, s21, 18432
    v_mfma_f32_16x16x32_bf16 v[56:59], a[212:215], v[36:39], v[56:59]
    buffer_load_dwordx4 v10, s[8:11], s20 offen lds
    v_mfma_f32_16x16x32_bf16 v[60:63], a[208:211], v[40:43], v[60:63]
    ds_read_b128 v[32:35], v13 offset:53504
    v_mfma_f32_16x16x32_bf16 v[64:67], a[212:215], v[40:43], v[64:67]
    s_waitcnt lgkmcnt(4)
    v_mfma_f32_16x16x32_bf16 v[52:55], a[216:219], v[44:47], v[52:55]
    ds_read_b128 v[36:39], v14 offset:49408
    v_mfma_f32_16x16x32_bf16 v[56:59], a[220:223], v[44:47], v[56:59]
    v_mfma_f32_16x16x32_bf16 v[60:63], a[216:219], v[48:51], v[60:63]
    ds_read_b128 v[40:43], v14 offset:53504
    v_mfma_f32_16x16x32_bf16 v[64:67], a[220:223], v[48:51], v[64:67]
    s_waitcnt lgkmcnt(4)
    v_mfma_f32_16x16x32_bf16 v[52:55], a[224:227], v[20:23], v[52:55]
    ds_read_b128 v[44:47], v15 offset:49408
    s_add_u32 m0, s21, 19456
    v_mfma_f32_16x16x32_bf16 v[56:59], a[228:231], v[20:23], v[56:59]
    buffer_load_dwordx4 v11, s[8:11], s20 offen lds
    v_mfma_f32_16x16x32_bf16 v[60:63], a[224:227], v[24:27], v[60:63]
    ds_read_b128 v[48:51], v15 offset:53504
    v_mfma_f32_16x16x32_bf16 v[64:67], a[228:231], v[24:27], v[64:67]
    s_waitcnt lgkmcnt(4)
    v_mfma_f32_16x16x32_bf16 v[52:55], a[232:235], v[28:31], v[52:55]
    s_waitcnt vmcnt(20)
    s_barrier
    ds_read_b128 v[20:23], v16 offset:0
    v_mfma_f32_16x16x32_bf16 v[56:59], a[236:239], v[28:31], v[56:59]
    s_add_u32 s20, s20, 512
    v_mfma_f32_16x16x32_bf16 v[60:63], a[232:235], v[32:35], v[60:63]
    ds_read_b128 v[24:27], v16 offset:4096
    v_mfma_f32_16x16x32_bf16 v[64:67], a[236:239], v[32:35], v[64:67]
    s_waitcnt lgkmcnt(4)
    v_mfma_f32_16x16x32_bf16 v[52:55], a[240:243], v[36:39], v[52:55]
    ds_read_b128 v[28:31], v17 offset:0
    s_add_u32 m0, s21, 32768
    v_mfma_f32_16x16x32_bf16 v[56:59], a[244:247], v[36:39], v[56:59]
    buffer_load_dwordx4 v8, s[8:11], s20 offen lds
    v_mfma_f32_16x16x32_bf16 v[60:63], a[240:243], v[40:43], v[60:63]
    ds_read_b128 v[32:35], v17 offset:4096
    v_mfma_f32_16x16x32_bf16 v[64:67], a[244:247], v[40:43], v[64:67]
    s_waitcnt lgkmcnt(4)
    v_mfma_f32_16x16x32_bf16 v[52:55], a[248:251], v[44:47], v[52:55]
    ds_read_b128 v[36:39], v18 offset:0
    v_mfma_f32_16x16x32_bf16 v[56:59], a[252:255], v[44:47], v[56:59]
    v_mfma_f32_16x16x32_bf16 v[60:63], a[248:251], v[48:51], v[60:63]
    ds_read_b128 v[40:43], v18 offset:4096
    v_mfma_f32_16x16x32_bf16 v[64:67], a[252:255], v[48:51], v[64:67]
    s_waitcnt lgkmcnt(4)
    s_add_u32 s22, s22, 1
    s_cmp_ge_u32 s22, s23
    s_cbranch_scc1 L_fl0_208
    v_mfma_f32_16x16x32_bf16 v[68:71], a[0:3], v[20:23], 0
    ds_read_b128 v[44:47], v19 offset:0
    s_add_u32 m0, s21, 33792
    s_sub_u32 s39, s22, 1
    v_mfma_f32_16x16x32_bf16 v[72:75], a[4:7], v[20:23], 0
    buffer_load_dwordx4 v9, s[8:11], s20 offen lds
    s_bitcmp1_b32 s39, 1
    s_cselect_b32 s38, s55, s54
    v_mfma_f32_16x16x32_bf16 v[76:79], a[0:3], v[24:27], 0
    ds_read_b128 v[48:51], v19 offset:4096
    v_mfma_f32_16x16x32_bf16 v[80:83], a[4:7], v[24:27], 0
    s_waitcnt lgkmcnt(4)
    s_add_u32 s38, s38, s44
    v_mfma_f32_16x16x32_bf16 v[68:71], a[8:11], v[28:31], v[68:71]
    ds_read_b128 v[20:23], v16 offset:256
    s_lshl_b32 s42, s39, 20
    v_mfma_f32_16x16x32_bf16 v[72:75], a[12:15], v[28:31], v[72:75]
    s_add_u32 s38, s38, s42
    v_mfma_f32_16x16x32_bf16 v[76:79], a[8:11], v[32:35], v[76:79]
    ds_read_b128 v[24:27], v16 offset:4352
    s_lshl_b32 s39, s39, 7
    v_mfma_f32_16x16x32_bf16 v[80:83], a[12:15], v[32:35], v[80:83]
    s_waitcnt lgkmcnt(4)
    s_add_u32 s39, s39, 0x5900000
    v_mfma_f32_16x16x32_bf16 v[68:71], a[16:19], v[36:39], v[68:71]
    ds_read_b128 v[28:31], v17 offset:256
    s_add_u32 m0, s21, 34816
    s_cmp_eq_u32 s37, 0
    s_cselect_b32 s38, 0x7ff00000, s38
    s_cselect_b32 s39, 0x7ff00000, s39
    v_mfma_f32_16x16x32_bf16 v[72:75], a[20:23], v[36:39], v[72:75]
    buffer_load_dwordx4 v10, s[8:11], s20 offen lds
    v_mfma_f32_16x16x32_bf16 v[76:79], a[16:19], v[40:43], v[76:79]
    ds_read_b128 v[32:35], v17 offset:4352
    v_mfma_f32_16x16x32_bf16 v[80:83], a[20:23], v[40:43], v[80:83]
    s_waitcnt lgkmcnt(4)
    v_cvt_pk_bf16_f32 v88, v52, v53
    v_mfma_f32_16x16x32_bf16 v[68:71], a[24:27], v[44:47], v[68:71]
    ds_read_b128 v[36:39], v18 offset:256
    v_cvt_pk_bf16_f32 v89, v54, v55
    v_mfma_f32_16x16x32_bf16 v[72:75], a[28:31], v[44:47], v[72:75]
    v_cvt_pk_bf16_f32 v90, v56, v57
    v_cvt_pk_bf16_f32 v91, v58, v59
    buffer_store_dwordx4 v[88:91], v86, s[12:15], s38 offen offset:0 sc1
    v_mfma_f32_16x16x32_bf16 v[76:79], a[24:27], v[48:51], v[76:79]
    ds_read_b128 v[40:43], v18 offset:4352
    v_mfma_f32_16x16x32_bf16 v[80:83], a[28:31], v[48:51], v[80:83]
    s_waitcnt lgkmcnt(4)
    v_mfma_f32_16x16x32_bf16 v[68:71], a[32:35], v[20:23], v[68:71]
    ds_read_b128 v[44:47], v19 offset:256
    s_add_u32 m0, s21, 35840
    v_cvt_pk_bf16_f32 v92, v60, v61
    v_mfma_f32_16x16x32_bf16 v[72:75], a[36:39], v[20:23], v[72:75]
    buffer_load_dwordx4 v11, s[8:11], s20 offen lds
    v_cvt_pk_bf16_f32 v93, v62, v63
    v_mfma_f32_16x16x32_bf16 v[76:79], a[32:35], v[24:27], v[76:79]
    ds_read_b128 v[48:51], v19 offset:4352
    v_cvt_pk_bf16_f32 v94, v64, v65
    v_mfma_f32_16x16x32_bf16 v[80:83], a[36:39], v[24:27], v[80:83]
    s_waitcnt lgkmcnt(4)
    v_cvt_pk_bf16_f32 v95, v66, v67
    v_mfma_f32_16x16x32_bf16 v[68:71], a[40:43], v[28:31], v[68:71]
    s_waitcnt vmcnt(20)
    s_barrier
    ds_read_b128 v[20:23], v16 offset:16384
    v_mfma_f32_16x16x32_bf16 v[72:75], a[44:47], v[28:31], v[72:75]
    s_add_u32 s20, s20, 512
    buffer_store_dwordx4 v[92:95], v86, s[12:15], s38 offen offset:128 sc1
    v_mfma_f32_16x16x32_bf16 v[76:79], a[40:43], v[32:35], v[76:79]
    ds_read_b128 v[24:27], v16 offset:20480
    v_mfma_f32_16x16x32_bf16 v[80:83], a[44:47], v[32:35], v[80:83]
    s_waitcnt lgkmcnt(4)
    v_mfma_f32_16x16x32_bf16 v[68:71], a[48:51], v[36:39], v[68:71]
    ds_read_b128 v[28:31], v17 offset:16384
    s_add_u32 m0, s21, 49152
    v_mfma_f32_16x16x32_bf16 v[72:75], a[52:55], v[36:39], v[72:75]
    buffer_load_dwordx4 v8, s[8:11], s20 offen lds
    v_mfma_f32_16x16x32_bf16 v[76:79], a[48:51], v[40:43], v[76:79]
    ds_read_b128 v[32:35], v17 offset:20480
    v_mfma_f32_16x16x32_bf16 v[80:83], a[52:55], v[40:43], v[80:83]
    s_waitcnt lgkmcnt(4)
    v_mfma_f32_16x16x32_bf16 v[68:71], a[56:59], v[44:47], v[68:71]
    ds_read_b128 v[36:39], v18 offset:16384
    v_mfma_f32_16x16x32_bf16 v[72:75], a[60:63], v[44:47], v[72:75]
    v_mfma_f32_16x16x32_bf16 v[76:79], a[56:59], v[48:51], v[76:79]
    ds_read_b128 v[40:43], v18 offset:20480
    v_mfma_f32_16x16x32_bf16 v[80:83], a[60:63], v[48:51], v[80:83]
    s_waitcnt lgkmcnt(4)
    v_mfma_f32_16x16x32_bf16 v[68:71], a[64:67], v[20:23], v[68:71]
    ds_read_b128 v[44:47], v19 offset:16384
    s_add_u32 m0, s21, 50176
    v_mfma_f32_16x16x32_bf16 v[72:75], a[68:71], v[20:23], v[72:75]
    buffer_load_dwordx4 v9, s[8:11], s20 offen lds
    v_mfma_f32_16x16x32_bf16 v[76:79], a[64:67], v[24:27], v[76:79]
    ds_read_b128 v[48:51], v19 offset:20480
    v_mfma_f32_16x16x32_bf16 v[80:83], a[68:71], v[24:27], v[80:83]
    s_waitcnt lgkmcnt(4)
    v_mfma_f32_16x16x32_bf16 v[68:71], a[72:75], v[28:31], v[68:71]
    ds_read_b128 v[20:23], v16 offset:16640
    v_mfma_f32_16x16x32_bf16 v[72:75], a[76:79], v[28:31], v[72:75]
    v_mfma_f32_16x16x32_bf16 v[76:79], a[72:75], v[32:35], v[76:79]
    ds_read_b128 v[24:27], v16 offset:20736
    s_add_u32 s24, s24, 1
    v_mfma_f32_16x16x32_bf16 v[80:83], a[76:79], v[32:35], v[80:83]
    s_waitcnt lgkmcnt(4)
    v_mfma_f32_16x16x32_bf16 v[68:71], a[80:83], v[36:39], v[68:71]
    ds_read_b128 v[28:31], v17 offset:16640
    s_add_u32 m0, s21, 51200
    v_mfma_f32_16x16x32_bf16 v[72:75], a[84:87], v[36:39], v[72:75]
    buffer_load_dwordx4 v10, s[8:11], s20 offen lds
    v_mfma_f32_16x16x32_bf16 v[76:79], a[80:83], v[40:43], v[76:79]
    ds_read_b128 v[32:35], v17 offset:20736
    v_mfma_f32_16x16x32_bf16 v[80:83], a[84:87], v[40:43], v[80:83]
    s_waitcnt lgkmcnt(4)
    s_min_u32 s24, s24, 63
    v_mfma_f32_16x16x32_bf16 v[68:71], a[88:91], v[44:47], v[68:71]
    ds_read_b128 v[36:39], v18 offset:16640
    v_mfma_f32_16x16x32_bf16 v[72:75], a[92:95], v[44:47], v[72:75]
    v_mfma_f32_16x16x32_bf16 v[76:79], a[88:91], v[48:51], v[76:79]
    ds_read_b128 v[40:43], v18 offset:20736
    s_lshl_b32 s53, s24, 16
    v_mfma_f32_16x16x32_bf16 v[80:83], a[92:95], v[48:51], v[80:83]
    s_waitcnt lgkmcnt(4)
    v_mfma_f32_16x16x32_bf16 v[68:71], a[96:99], v[20:23], v[68:71]
    ds_read_b128 v[44:47], v19 offset:16640
    s_add_u32 m0, s21, 52224
    v_mfma_f32_16x16x32_bf16 v[72:75], a[100:103], v[20:23], v[72:75]
    buffer_load_dwordx4 v11, s[8:11], s20 offen lds
    v_mfma_f32_16x16x32_bf16 v[76:79], a[96:99], v[24:27], v[76:79]
    ds_read_b128 v[48:51], v19 offset:20736
    v_mfma_f32_16x16x32_bf16 v[80:83], a[100:103], v[24:27], v[80:83]
    s_waitcnt lgkmcnt(4)
    v_mfma_f32_16x16x32_bf16 v[68:71], a[104:107], v[28:31], v[68:71]
    s_waitcnt vmcnt(20)
    s_barrier
    ds_read_b128 v[20:23], v16 offset:32768
    v_mfma_f32_16x16x32_bf16 v[72:75], a[108:111], v[28:31], v[72:75]
    s_mov_b32 s20, s53
    v_mfma_f32_16x16x32_bf16 v[76:79], a[104:107], v[32:35], v[76:79]
    ds_read_b128 v[24:27], v16 offset:36864
    v_mfma_f32_16x16x32_bf16 v[80:83], a[108:111], v[32:35], v[80:83]
    s_waitcnt lgkmcnt(4)
    v_mfma_f32_16x16x32_bf16 v[68:71], a[112:115], v[36:39], v[68:71]
    ds_read_b128 v[28:31], v17 offset:32768
    s_add_u32 m0, s21, 65536
    v_mfma_f32_16x16x32_bf16 v[72:75], a[116:119], v[36:39], v[72:75]
    buffer_load_dwordx4 v8, s[8:11], s20 offen lds
    v_mfma_f32_16x16x32_bf16 v[76:79], a[112:115], v[40:43], v[76:79]
    ds_read_b128 v[32:35], v17 offset:36864
    v_mfma_f32_16x16x32_bf16 v[80:83], a[116:119], v[40:43], v[80:83]
    s_waitcnt lgkmcnt(4)
    v_mfma_f32_16x16x32_bf16 v[68:71], a[120:123], v[44:47], v[68:71]
    ds_read_b128 v[36:39], v18 offset:32768
    v_mfma_f32_16x16x32_bf16 v[72:75], a[124:127], v[44:47], v[72:75]
    v_mfma_f32_16x16x32_bf16 v[76:79], a[120:123], v[48:51], v[76:79]
    ds_read_b128 v[40:43], v18 offset:36864
    v_mfma_f32_16x16x32_bf16 v[80:83], a[124:127], v[48:51], v[80:83]
    s_waitcnt lgkmcnt(4)
    v_mfma_f32_16x16x32_bf16 v[68:71], a[128:131], v[20:23], v[68:71]
    ds_read_b128 v[44:47], v19 offset:32768
    s_add_u32 m0, s21, 66560
    v_mfma_f32_16x16x32_bf16 v[72:75], a[132:135], v[20:23], v[72:75]
    buffer_load_dwordx4 v9, s[8:11], s20 offen lds
    v_mfma_f32_16x16x32_bf16 v[76:79], a[128:131], v[24:27], v[76:79]
    ds_read_b128 v[48:51], v19 offset:36864
    v_mfma_f32_16x16x32_bf16 v[80:83], a[132:135], v[24:27], v[80:83]
    s_waitcnt lgkmcnt(4)
    v_mfma_f32_16x16x32_bf16 v[68:71], a[136:139], v[28:31], v[68:71]
    ds_read_b128 v[20:23], v16 offset:33024
    v_mfma_f32_16x16x32_bf16 v[72:75], a[140:143], v[28:31], v[72:75]
    v_mfma_f32_16x16x32_bf16 v[76:79], a[136:139], v[32:35], v[76:79]
    ds_read_b128 v[24:27], v16 offset:37120
    v_mfma_f32_16x16x32_bf16 v[80:83], a[140:143], v[32:35], v[80:83]
    s_waitcnt lgkmcnt(4)
    v_mfma_f32_16x16x32_bf16 v[68:71], a[144:147], v[36:39], v[68:71]
    ds_read_b128 v[28:31], v17 offset:33024
    s_add_u32 m0, s21, 67584
    v_mfma_f32_16x16x32_bf16 v[72:75], a[148:151], v[36:39], v[72:75]
    buffer_load_dwordx4 v10, s[8:11], s20 offen lds
    v_mfma_f32_16x16x32_bf16 v[76:79], a[144:147], v[40:43], v[76:79]
    ds_read_b128 v[32:35], v17 offset:37120
    v_mfma_f32_16x16x32_bf16 v[80:83], a[148:151], v[40:43], v[80:83]
    s_waitcnt lgkmcnt(4)
    v_mfma_f32_16x16x32_bf16 v[68:71], a[152:155], v[44:47], v[68:71]
    ds_read_b128 v[36:39], v18 offset:33024
    v_mfma_f32_16x16x32_bf16 v[72:75], a[156:159], v[44:47], v[72:75]
    v_mfma_f32_16x16x32_bf16 v[76:79], a[152:155], v[48:51], v[76:79]
    ds_read_b128 v[40:43], v18 offset:37120
    v_mfma_f32_16x16x32_bf16 v[80:83], a[156:159], v[48:51], v[80:83]
    s_waitcnt lgkmcnt(4)
    v_mfma_f32_16x16x32_bf16 v[68:71], a[160:163], v[20:23], v[68:71]
    ds_read_b128 v[44:47], v19 offset:33024
    s_add_u32 m0, s21, 68608
    v_mfma_f32_16x16x32_bf16 v[72:75], a[164:167], v[20:23], v[72:75]
    buffer_load_dwordx4 v11, s[8:11], s20 offen lds
    v_mfma_f32_16x16x32_bf16 v[76:79], a[160:163], v[24:27], v[76:79]
    ds_read_b128 v[48:51], v19 offset:37120
    v_mfma_f32_16x16x32_bf16 v[80:83], a[164:167], v[24:27], v[80:83]
    s_waitcnt lgkmcnt(4)
    v_mfma_f32_16x16x32_bf16 v[68:71], a[168:171], v[28:31], v[68:71]
    s_waitcnt vmcnt(8)
    s_barrier
    ds_read_b128 v[20:23], v16 offset:49152
    v_mfma_f32_16x16x32_bf16 v[72:75], a[172:175], v[28:31], v[72:75]
    s_add_u32 s20, s20, 512
    buffer_atomic_add v84, v85, s[12:15], s39 offen sc1
    v_mfma_f32_16x16x32_bf16 v[76:79], a[168:171], v[32:35], v[76:79]
    ds_read_b128 v[24:27], v16 offset:53248
    v_mfma_f32_16x16x32_bf16 v[80:83], a[172:175], v[32:35], v[80:83]
    s_waitcnt lgkmcnt(4)
    v_mfma_f32_16x16x32_bf16 v[68:71], a[176:179], v[36:39], v[68:71]
    ds_read_b128 v[28:31], v17 offset:49152
    s_add_u32 m0, s21, 81920
    v_mfma_f32_16x16x32_bf16 v[72:75], a[180:183], v[36:39], v[72:75]
    buffer_load_dwordx4 v8, s[8:11], s20 offen lds
    v_mfma_f32_16x16x32_bf16 v[76:79], a[176:179], v[40:43], v[76:79]
    ds_read_b128 v[32:35], v17 offset:53248
    v_mfma_f32_16x16x32_bf16 v[80:83], a[180:183], v[40:43], v[80:83]
    s_waitcnt lgkmcnt(4)
    s_mov_b32 s37, 1
    v_mfma_f32_16x16x32_bf16 v[68:71], a[184:187], v[44:47], v[68:71]
    ds_read_b128 v[36:39], v18 offset:49152
    v_mfma_f32_16x16x32_bf16 v[72:75], a[188:191], v[44:47], v[72:75]
    v_mfma_f32_16x16x32_bf16 v[76:79], a[184:187], v[48:51], v[76:79]
    ds_read_b128 v[40:43], v18 offset:53248
    v_mfma_f32_16x16x32_bf16 v[80:83], a[188:191], v[48:51], v[80:83]
    s_waitcnt lgkmcnt(4)
    v_mfma_f32_16x16x32_bf16 v[68:71], a[192:195], v[20:23], v[68:71]
    ds_read_b128 v[44:47], v19 offset:49152
    s_add_u32 m0, s21, 82944
    v_mfma_f32_16x16x32_bf16 v[72:75], a[196:199], v[20:23], v[72:75]
    buffer_load_dwordx4 v9, s[8:11], s20 offen lds
    v_mfma_f32_16x16x32_bf16 v[76:79], a[192:195], v[24:27], v[76:79]
    ds_read_b128 v[48:51], v19 offset:53248
    v_mfma_f32_16x16x32_bf16 v[80:83], a[196:199], v[24:27], v[80:83]
    s_waitcnt lgkmcnt(4)
    v_mfma_f32_16x16x32_bf16 v[68:71], a[200:203], v[28:31], v[68:71]
    ds_read_b128 v[20:23], v16 offset:49408
    v_mfma_f32_16x16x32_bf16 v[72:75], a[204:207], v[28:31], v[72:75]
    v_mfma_f32_16x16x32_bf16 v[76:79], a[200:203], v[32:35], v[76:79]
    ds_read_b128 v[24:27], v16 offset:53504
    v_mfma_f32_16x16x32_bf16 v[80:83], a[204:207], v[32:35], v[80:83]
    s_waitcnt lgkmcnt(4)
    v_mfma_f32_16x16x32_bf16 v[68:71], a[208:211], v[36:39], v[68:71]
    ds_read_b128 v[28:31], v17 offset:49408
    s_add_u32 m0, s21, 83968
    v_mfma_f32_16x16x32_bf16 v[72:75], a[212:215], v[36:39], v[72:75]
    buffer_load_dwordx4 v10, s[8:11], s20 offen lds
    v_mfma_f32_16x16x32_bf16 v[76:79], a[208:211], v[40:43], v[76:79]
    ds_read_b128 v[32:35], v17 offset:53504
    v_mfma_f32_16x16x32_bf16 v[80:83], a[212:215], v[40:43], v[80:83]
    s_waitcnt lgkmcnt(4)
    v_mfma_f32_16x16x32_bf16 v[68:71], a[216:219], v[44:47], v[68:71]
    ds_read_b128 v[36:39], v18 offset:49408
    v_mfma_f32_16x16x32_bf16 v[72:75], a[220:223], v[44:47], v[72:75]
    v_mfma_f32_16x16x32_bf16 v[76:79], a[216:219], v[48:51], v[76:79]
    ds_read_b128 v[40:43], v18 offset:53504
    v_mfma_f32_16x16x32_bf16 v[80:83], a[220:223], v[48:51], v[80:83]
    s_waitcnt lgkmcnt(4)
    v_mfma_f32_16x16x32_bf16 v[68:71], a[224:227], v[20:23], v[68:71]
    ds_read_b128 v[44:47], v19 offset:49408
    s_add_u32 m0, s21, 84992
    v_mfma_f32_16x16x32_bf16 v[72:75], a[228:231], v[20:23], v[72:75]
    buffer_load_dwordx4 v11, s[8:11], s20 offen lds
    v_mfma_f32_16x16x32_bf16 v[76:79], a[224:227], v[24:27], v[76:79]
    ds_read_b128 v[48:51], v19 offset:53504
    v_mfma_f32_16x16x32_bf16 v[80:83], a[228:231], v[24:27], v[80:83]
    s_waitcnt lgkmcnt(4)
    v_mfma_f32_16x16x32_bf16 v[68:71], a[232:235], v[28:31], v[68:71]
    s_waitcnt vmcnt(20)
    s_barrier
    ds_read_b128 v[20:23], v12 offset:0
    v_mfma_f32_16x16x32_bf16 v[72:75], a[236:239], v[28:31], v[72:75]
    s_add_u32 s20, s20, 512
    v_mfma_f32_16x16x32_bf16 v[76:79], a[232:235], v[32:35], v[76:79]
    ds_read_b128 v[24:27], v12 offset:4096
    v_mfma_f32_16x16x32_bf16 v[80:83], a[236:239], v[32:35], v[80:83]
    s_waitcnt lgkmcnt(4)
    v_mfma_f32_16x16x32_bf16 v[68:71], a[240:243], v[36:39], v[68:71]
    ds_read_b128 v[28:31], v13 offset:0
    s_add_u32 m0, s21, 98304
    v_mfma_f32_16x16x32_bf16 v[72:75], a[244:247], v[36:39], v[72:75]
    buffer_load_dwordx4 v8, s[8:11], s20 offen lds
    v_mfma_f32_16x16x32_bf16 v[76:79], a[240:243], v[40:43], v[76:79]
    ds_read_b128 v[32:35], v13 offset:4096
    v_mfma_f32_16x16x32_bf16 v[80:83], a[244:247], v[40:43], v[80:83]
    s_waitcnt lgkmcnt(4)
    v_mfma_f32_16x16x32_bf16 v[68:71], a[248:251], v[44:47], v[68:71]
    ds_read_b128 v[36:39], v14 offset:0
    v_mfma_f32_16x16x32_bf16 v[72:75], a[252:255], v[44:47], v[72:75]
    v_mfma_f32_16x16x32_bf16 v[76:79], a[248:251], v[48:51], v[76:79]
    ds_read_b128 v[40:43], v14 offset:4096
    v_mfma_f32_16x16x32_bf16 v[80:83], a[252:255], v[48:51], v[80:83]
    s_waitcnt lgkmcnt(4)
    s_add_u32 s22, s22, 1
    s_cmp_ge_u32 s22, s23
    s_cbranch_scc0 L_st_207
    s_waitcnt lgkmcnt(0)
    s_nop 7
    s_sub_u32 s39, s22, 1
    s_bitcmp1_b32 s39, 1
    s_cselect_b32 s38, s55, s54
    s_add_u32 s38, s38, s44
    s_lshl_b32 s42, s39, 20
    s_add_u32 s38, s38, s42
    s_lshl_b32 s39, s39, 7
    s_add_u32 s39, s39, 0x5900000
    s_cmp_eq_u32 s37, 0
    s_cselect_b32 s38, 0x7ff00000, s38
    s_cselect_b32 s39, 0x7ff00000, s39
    v_cvt_pk_bf16_f32 v88, v68, v69
    v_cvt_pk_bf16_f32 v89, v70, v71
    v_cvt_pk_bf16_f32 v90, v72, v73
    v_cvt_pk_bf16_f32 v91, v74, v75
    buffer_store_dwordx4 v[88:91], v86, s[12:15], s38 offen offset:0 sc1
    v_cvt_pk_bf16_f32 v92, v76, v77
    v_cvt_pk_bf16_f32 v93, v78, v79
    v_cvt_pk_bf16_f32 v94, v80, v81
    v_cvt_pk_bf16_f32 v95, v82, v83
    buffer_store_dwordx4 v[92:95], v86, s[12:15], s38 offen offset:128 sc1
    s_waitcnt vmcnt(0)
    s_barrier
    buffer_atomic_add v84, v85, s[12:15], s39 offen sc1
    s_mov_b32 s37, 1
    s_branch L_ste_209
L_fl0_208:
    s_waitcnt lgkmcnt(0)
    s_nop 7
    s_sub_u32 s39, s22, 1
    s_bitcmp1_b32 s39, 1
    s_cselect_b32 s38, s55, s54
    s_add_u32 s38, s38, s44
    s_lshl_b32 s42, s39, 20
    s_add_u32 s38, s38, s42
    s_lshl_b32 s39, s39, 7
    s_add_u32 s39, s39, 0x5900000
    s_cmp_eq_u32 s37, 0
    s_cselect_b32 s38, 0x7ff00000, s38
    s_cselect_b32 s39, 0x7ff00000, s39
    v_cvt_pk_bf16_f32 v88, v52, v53
    v_cvt_pk_bf16_f32 v89, v54, v55
    v_cvt_pk_bf16_f32 v90, v56, v57
    v_cvt_pk_bf16_f32 v91, v58, v59
    buffer_store_dwordx4 v[88:91], v86, s[12:15], s38 offen offset:0 sc1
    v_cvt_pk_bf16_f32 v92, v60, v61
    v_cvt_pk_bf16_f32 v93, v62, v63
    v_cvt_pk_bf16_f32 v94, v64, v65
    v_cvt_pk_bf16_f32 v95, v66, v67
    buffer_store_dwordx4 v[92:95], v86, s[12:15], s38 offen offset:128 sc1
    s_waitcnt vmcnt(0)
    s_barrier
    buffer_atomic_add v84, v85, s[12:15], s39 offen sc1
    s_mov_b32 s37, 1
L_ste_209:
    s_branch L_op_204
L_v_200:
    s_barrier
    s_add_u32 m0, s21, 0
    s_nop 0
    buffer_load_dwordx4 v8, s[8:11], s20 offen lds
    s_add_u32 m0, s21, 1024
    s_nop 0
    buffer_load_dwordx4 v9, s[8:11], s20 offen lds
    s_add_u32 m0, s21, 2048
    s_nop 0
    buffer_load_dwordx4 v10, s[8:11], s20 offen lds
    s_add_u32 m0, s21, 3072
    s_nop 0
    buffer_load_dwordx4 v11, s[8:11], s20 offen lds
    s_add_u32 s20, s20, 512
    s_add_u32 m0, s21, 16384
    s_nop 0
    buffer_load_dwordx4 v8, s[8:11], s20 offen lds
    s_add_u32 m0, s21, 17408
    s_nop 0
    buffer_load_dwordx4 v9, s[8:11], s20 offen lds
    s_add_u32 m0, s21, 18432
    s_nop 0
    buffer_load_dwordx4 v10, s[8:11], s20 offen lds
    s_add_u32 m0, s21, 19456
    s_nop 0
    buffer_load_dwordx4 v11, s[8:11], s20 offen lds
    s_add_u32 s20, s20, 512
    s_add_u32 m0, s21, 32768
    s_nop 0
    buffer_load_dwordx4 v8, s[8:11], s20 offen lds
    s_add_u32 m0, s21, 33792
    s_nop 0
    buffer_load_dwordx4 v9, s[8:11], s20 offen lds
    s_add_u32 m0, s21, 34816
    s_nop 0
    buffer_load_dwordx4 v10, s[8:11], s20 offen lds
    s_add_u32 m0, s21, 35840
    s_nop 0
    buffer_load_dwordx4 v11, s[8:11], s20 offen lds
    s_add_u32 s20, s20, 512
    s_add_u32 m0, s21, 49152
    s_nop 0
    buffer_load_dwordx4 v8, s[8:11], s20 offen lds
    s_add_u32 m0, s21, 50176
    s_nop 0
    buffer_load_dwordx4 v9, s[8:11], s20 offen lds
    s_add_u32 m0, s21, 51200
    s_nop 0
    buffer_load_dwordx4 v10, s[8:11], s20 offen lds
    s_add_u32 m0, s21, 52224
    s_nop 0
    buffer_load_dwordx4 v11, s[8:11], s20 offen lds
    s_add_u32 s24, s24, 1
    s_min_u32 s24, s24, 63
    s_lshl_b32 s53, s24, 16
    s_mov_b32 s20, s53
    s_add_u32 m0, s21, 65536
    s_nop 0
    buffer_load_dwordx4 v8, s[8:11], s20 offen lds
    s_add_u32 m0, s21, 66560
    s_nop 0
    buffer_load_dwordx4 v9, s[8:11], s20 offen lds
    s_add_u32 m0, s21, 67584
    s_nop 0
    buffer_load_dwordx4 v10, s[8:11], s20 offen lds
    s_add_u32 m0, s21, 68608
    s_nop 0
    buffer_load_dwordx4 v11, s[8:11], s20 offen lds
    s_add_u32 s20, s20, 512
    s_add_u32 m0, s21, 81920
    s_nop 0
    buffer_load_dwordx4 v8, s[8:11], s20 offen lds
    s_add_u32 m0, s21, 82944
    s_nop 0
    buffer_load_dwordx4 v9, s[8:11], s20 offen lds
    s_add_u32 m0, s21, 83968
    s_nop 0
    buffer_load_dwordx4 v10, s[8:11], s20 offen lds
    s_add_u32 m0, s21, 84992
    s_nop 0
    buffer_load_dwordx4 v11, s[8:11], s20 offen lds
    s_add_u32 s20, s20, 512
    s_add_u32 m0, s21, 98304
    s_nop 0
    buffer_load_dwordx4 v8, s[8:11], s20 offen lds
    s_waitcnt vmcnt(21)
    s_barrier
    ds_read_b128 v[20:23], v12 offset:0
    ds_read_b128 v[24:27], v12 offset:4096
    ds_read_b128 v[28:31], v13 offset:0
    ds_read_b128 v[32:35], v13 offset:4096
    ds_read_b128 v[36:39], v14 offset:0
    ds_read_b128 v[40:43], v14 offset:4096
    s_waitcnt lgkmcnt(4)
L_st_210:
    v_mfma_f32_16x16x32_bf16 v[52:55], v[20:23], a[0:3], 0
    ds_read_b128 v[44:47], v15 offset:0
    s_add_u32 m0, s21, 99328
    s_sub_u32 s39, s22, 1
    v_mfma_f32_16x16x32_bf16 v[56:59], v[20:23], a[4:7], 0
    buffer_load_dwordx4 v9, s[8:11], s20 offen lds
    s_bitcmp1_b32 s39, 1
    s_cselect_b32 s38, s55, s54
    v_mfma_f32_16x16x32_bf16 v[60:63], v[24:27], a[0:3], 0
    ds_read_b128 v[48:51], v15 offset:4096
    v_mfma_f32_16x16x32_bf16 v[64:67], v[24:27], a[4:7], 0
    s_waitcnt lgkmcnt(4)
    s_add_u32 s38, s38, s44
    v_mfma_f32_16x16x32_bf16 v[52:55], v[28:31], a[8:11], v[52:55]
    ds_read_b128 v[20:23], v12 offset:256
    s_lshl_b32 s42, s39, 20
    v_mfma_f32_16x16x32_bf16 v[56:59], v[28:31], a[12:15], v[56:59]
    s_add_u32 s38, s38, s42
    v_mfma_f32_16x16x32_bf16 v[60:63], v[32:35], a[8:11], v[60:63]
    ds_read_b128 v[24:27], v12 offset:4352
    s_lshl_b32 s39, s39, 7
    v_mfma_f32_16x16x32_bf16 v[64:67], v[32:35], a[12:15], v[64:67]
    s_waitcnt lgkmcnt(4)
    s_add_u32 s39, s39, 0x5900000
    v_mfma_f32_16x16x32_bf16 v[52:55], v[36:39], a[16:19], v[52:55]
    ds_read_b128 v[28:31], v13 offset:256
    s_add_u32 m0, s21, 100352
    s_cmp_eq_u32 s37, 0
    s_cselect_b32 s38, 0x7ff00000, s38
    s_cselect_b32 s39, 0x7ff00000, s39
    v_mfma_f32_16x16x32_bf16 v[56:59], v[36:39], a[20:23], v[56:59]
    buffer_load_dwordx4 v10, s[8:11], s20 offen lds
    v_mfma_f32_16x16x32_bf16 v[60:63], v[40:43], a[16:19], v[60:63]
    ds_read_b128 v[32:35], v13 offset:4352
    v_mfma_f32_16x16x32_bf16 v[64:67], v[40:43], a[20:23], v[64:67]
    s_waitcnt lgkmcnt(4)
    v_cvt_pk_bf16_f32 v88, v68, v69
    v_mfma_f32_16x16x32_bf16 v[52:55], v[44:47], a[24:27], v[52:55]
    ds_read_b128 v[36:39], v14 offset:256
    v_cvt_pk_bf16_f32 v89, v70, v71
    v_mfma_f32_16x16x32_bf16 v[56:59], v[44:47], a[28:31], v[56:59]
    v_cvt_pk_bf16_f32 v90, v76, v77
    v_cvt_pk_bf16_f32 v91, v78, v79
    buffer_store_dwordx4 v[88:91], v86, s[12:15], s38 offen offset:2048 sc1
    v_mfma_f32_16x16x32_bf16 v[60:63], v[48:51], a[24:27], v[60:63]
    ds_read_b128 v[40:43], v14 offset:4352
    v_mfma_f32_16x16x32_bf16 v[64:67], v[48:51], a[28:31], v[64:67]
    s_waitcnt lgkmcnt(4)
    v_mfma_f32_16x16x32_bf16 v[52:55], v[20:23], a[32:35], v[52:55]
    ds_read_b128 v[44:47], v15 offset:256
    s_add_u32 m0, s21, 101376
    v_cvt_pk_bf16_f32 v92, v72, v73
    v_mfma_f32_16x16x32_bf16 v[56:59], v[20:23], a[36:39], v[56:59]
    buffer_load_dwordx4 v11, s[8:11], s20 offen lds
    v_cvt_pk_bf16_f32 v93, v74, v75
    v_mfma_f32_16x16x32_bf16 v[60:63], v[24:27], a[32:35], v[60:63]
    ds_read_b128 v[48:51], v15 offset:4352
    v_cvt_pk_bf16_f32 v94, v80, v81
    v_mfma_f32_16x16x32_bf16 v[64:67], v[24:27], a[36:39], v[64:67]
    s_waitcnt lgkmcnt(4)
    v_cvt_pk_bf16_f32 v95, v82, v83
    v_mfma_f32_16x16x32_bf16 v[52:55], v[28:31], a[40:43], v[52:55]
    s_waitcnt vmcnt(20)
    s_barrier
    ds_read_b128 v[20:23], v12 offset:16384
    v_mfma_f32_16x16x32_bf16 v[56:59], v[28:31], a[44:47], v[56:59]
    s_add_u32 s20, s20, 512
    buffer_store_dwordx4 v[92:95], v86, s[12:15], s38 offen offset:2176 sc1
    v_mfma_f32_16x16x32_bf16 v[60:63], v[32:35], a[40:43], v[60:63]
    ds_read_b128 v[24:27], v12 offset:20480
    v_mfma_f32_16x16x32_bf16 v[64:67], v[32:35], a[44:47], v[64:67]
    s_waitcnt lgkmcnt(4)
    v_mfma_f32_16x16x32_bf16 v[52:55], v[36:39], a[48:51], v[52:55]
    ds_read_b128 v[28:31], v13 offset:16384
    s_add_u32 m0, s21, 114688
    v_mfma_f32_16x16x32_bf16 v[56:59], v[36:39], a[52:55], v[56:59]
    buffer_load_dwordx4 v8, s[8:11], s20 offen lds
    v_mfma_f32_16x16x32_bf16 v[60:63], v[40:43], a[48:51], v[60:63]
    ds_read_b128 v[32:35], v13 offset:20480
    v_mfma_f32_16x16x32_bf16 v[64:67], v[40:43], a[52:55], v[64:67]
    s_waitcnt lgkmcnt(4)
    v_mfma_f32_16x16x32_bf16 v[52:55], v[44:47], a[56:59], v[52:55]
    ds_read_b128 v[36:39], v14 offset:16384
    v_mfma_f32_16x16x32_bf16 v[56:59], v[44:47], a[60:63], v[56:59]
    v_mfma_f32_16x16x32_bf16 v[60:63], v[48:51], a[56:59], v[60:63]
    ds_read_b128 v[40:43], v14 offset:20480
    v_mfma_f32_16x16x32_bf16 v[64:67], v[48:51], a[60:63], v[64:67]
    s_waitcnt lgkmcnt(4)
    v_mfma_f32_16x16x32_bf16 v[52:55], v[20:23], a[64:67], v[52:55]
    ds_read_b128 v[44:47], v15 offset:16384
    s_add_u32 m0, s21, 115712
    v_mfma_f32_16x16x32_bf16 v[56:59], v[20:23], a[68:71], v[56:59]
    buffer_load_dwordx4 v9, s[8:11], s20 offen lds
    v_mfma_f32_16x16x32_bf16 v[60:63], v[24:27], a[64:67], v[60:63]
    ds_read_b128 v[48:51], v15 offset:20480
    v_mfma_f32_16x16x32_bf16 v[64:67], v[24:27], a[68:71], v[64:67]
    s_waitcnt lgkmcnt(4)
    v_mfma_f32_16x16x32_bf16 v[52:55], v[28:31], a[72:75], v[52:55]
    ds_read_b128 v[20:23], v12 offset:16640
    v_mfma_f32_16x16x32_bf16 v[56:59], v[28:31], a[76:79], v[56:59]
    v_mfma_f32_16x16x32_bf16 v[60:63], v[32:35], a[72:75], v[60:63]
    ds_read_b128 v[24:27], v12 offset:20736
    s_add_u32 s24, s24, 1
    v_mfma_f32_16x16x32_bf16 v[64:67], v[32:35], a[76:79], v[64:67]
    s_waitcnt lgkmcnt(4)
    v_mfma_f32_16x16x32_bf16 v[52:55], v[36:39], a[80:83], v[52:55]
    ds_read_b128 v[28:31], v13 offset:16640
    s_add_u32 m0, s21, 116736
    v_mfma_f32_16x16x32_bf16 v[56:59], v[36:39], a[84:87], v[56:59]
    buffer_load_dwordx4 v10, s[8:11], s20 offen lds
    v_mfma_f32_16x16x32_bf16 v[60:63], v[40:43], a[80:83], v[60:63]
    ds_read_b128 v[32:35], v13 offset:20736
    v_mfma_f32_16x16x32_bf16 v[64:67], v[40:43], a[84:87], v[64:67]
    s_waitcnt lgkmcnt(4)
    s_min_u32 s24, s24, 63
    v_mfma_f32_16x16x32_bf16 v[52:55], v[44:47], a[88:91], v[52:55]
    ds_read_b128 v[36:39], v14 offset:16640
    v_mfma_f32_16x16x32_bf16 v[56:59], v[44:47], a[92:95], v[56:59]
    v_mfma_f32_16x16x32_bf16 v[60:63], v[48:51], a[88:91], v[60:63]
    ds_read_b128 v[40:43], v14 offset:20736
    s_lshl_b32 s53, s24, 16
    v_mfma_f32_16x16x32_bf16 v[64:67], v[48:51], a[92:95], v[64:67]
    s_waitcnt lgkmcnt(4)
    v_mfma_f32_16x16x32_bf16 v[52:55], v[20:23], a[96:99], v[52:55]
    ds_read_b128 v[44:47], v15 offset:16640
    s_add_u32 m0, s21, 117760
    v_mfma_f32_16x16x32_bf16 v[56:59], v[20:23], a[100:103], v[56:59]
    buffer_load_dwordx4 v11, s[8:11], s20 offen lds
    v_mfma_f32_16x16x32_bf16 v[60:63], v[24:27], a[96:99], v[60:63]
    ds_read_b128 v[48:51], v15 offset:20736
    v_mfma_f32_16x16x32_bf16 v[64:67], v[24:27], a[100:103], v[64:67]
    s_waitcnt lgkmcnt(4)
    v_mfma_f32_16x16x32_bf16 v[52:55], v[28:31], a[104:107], v[52:55]
    s_waitcnt vmcnt(20)
    s_barrier
    ds_read_b128 v[20:23], v12 offset:32768
    v_mfma_f32_16x16x32_bf16 v[56:59], v[28:31], a[108:111], v[56:59]
    s_mov_b32 s20, s53
    v_mfma_f32_16x16x32_bf16 v[60:63], v[32:35], a[104:107], v[60:63]
    ds_read_b128 v[24:27], v12 offset:36864
    v_mfma_f32_16x16x32_bf16 v[64:67], v[32:35], a[108:111], v[64:67]
    s_waitcnt lgkmcnt(4)
    v_mfma_f32_16x16x32_bf16 v[52:55], v[36:39], a[112:115], v[52:55]
    ds_read_b128 v[28:31], v13 offset:32768
    s_add_u32 m0, s21, 0
    v_mfma_f32_16x16x32_bf16 v[56:59], v[36:39], a[116:119], v[56:59]
    buffer_load_dwordx4 v8, s[8:11], s20 offen lds
    v_mfma_f32_16x16x32_bf16 v[60:63], v[40:43], a[112:115], v[60:63]
    ds_read_b128 v[32:35], v13 offset:36864
    v_mfma_f32_16x16x32_bf16 v[64:67], v[40:43], a[116:119], v[64:67]
    s_waitcnt lgkmcnt(4)
    v_mfma_f32_16x16x32_bf16 v[52:55], v[44:47], a[120:123], v[52:55]
    ds_read_b128 v[36:39], v14 offset:32768
    v_mfma_f32_16x16x32_bf16 v[56:59], v[44:47], a[124:127], v[56:59]
    v_mfma_f32_16x16x32_bf16 v[60:63], v[48:51], a[120:123], v[60:63]
    ds_read_b128 v[40:43], v14 offset:36864
    v_mfma_f32_16x16x32_bf16 v[64:67], v[48:51], a[124:127], v[64:67]
    s_waitcnt lgkmcnt(4)
    v_mfma_f32_16x16x32_bf16 v[52:55], v[20:23], a[128:131], v[52:55]
    ds_read_b128 v[44:47], v15 offset:32768
    s_add_u32 m0, s21, 1024
    v_mfma_f32_16x16x32_bf16 v[56:59], v[20:23], a[132:135], v[56:59]
    buffer_load_dwordx4 v9, s[8:11], s20 offen lds
    v_mfma_f32_16x16x32_bf16 v[60:63], v[24:27], a[128:131], v[60:63]
    ds_read_b128 v[48:51], v15 offset:36864
    v_mfma_f32_16x16x32_bf16 v[64:67], v[24:27], a[132:135], v[64:67]
    s_waitcnt lgkmcnt(4)
    v_mfma_f32_16x16x32_bf16 v[52:55], v[28:31], a[136:139], v[52:55]
    ds_read_b128 v[20:23], v12 offset:33024
    v_mfma_f32_16x16x32_bf16 v[56:59], v[28:31], a[140:143], v[56:59]
    v_mfma_f32_16x16x32_bf16 v[60:63], v[32:35], a[136:139], v[60:63]
    ds_read_b128 v[24:27], v12 offset:37120
    v_mfma_f32_16x16x32_bf16 v[64:67], v[32:35], a[140:143], v[64:67]
    s_waitcnt lgkmcnt(4)
    v_mfma_f32_16x16x32_bf16 v[52:55], v[36:39], a[144:147], v[52:55]
    ds_read_b128 v[28:31], v13 offset:33024
    s_add_u32 m0, s21, 2048
    v_mfma_f32_16x16x32_bf16 v[56:59], v[36:39], a[148:151], v[56:59]
    buffer_load_dwordx4 v10, s[8:11], s20 offen lds
    v_mfma_f32_16x16x32_bf16 v[60:63], v[40:43], a[144:147], v[60:63]
    ds_read_b128 v[32:35], v13 offset:37120
    v_mfma_f32_16x16x32_bf16 v[64:67], v[40:43], a[148:151], v[64:67]
    s_waitcnt lgkmcnt(4)
    v_mfma_f32_16x16x32_bf16 v[52:55], v[44:47], a[152:155], v[52:55]
    ds_read_b128 v[36:39], v14 offset:33024
    v_mfma_f32_16x16x32_bf16 v[56:59], v[44:47], a[156:159], v[56:59]
    v_mfma_f32_16x16x32_bf16 v[60:63], v[48:51], a[152:155], v[60:63]
    ds_read_b128 v[40:43], v14 offset:37120
    v_mfma_f32_16x16x32_bf16 v[64:67], v[48:51], a[156:159], v[64:67]
    s_waitcnt lgkmcnt(4)
    v_mfma_f32_16x16x32_bf16 v[52:55], v[20:23], a[160:163], v[52:55]
    ds_read_b128 v[44:47], v15 offset:33024
    s_add_u32 m0, s21, 3072
    v_mfma_f32_16x16x32_bf16 v[56:59], v[20:23], a[164:167], v[56:59]
    buffer_load_dwordx4 v11, s[8:11], s20 offen lds
    v_mfma_f32_16x16x32_bf16 v[60:63], v[24:27], a[160:163], v[60:63]
    ds_read_b128 v[48:51], v15 offset:37120
    v_mfma_f32_16x16x32_bf16 v[64:67], v[24:27], a[164:167], v[64:67]
    s_waitcnt lgkmcnt(4)
    v_mfma_f32_16x16x32_bf16 v[52:55], v[28:31], a[168:171], v[52:55]
    s_waitcnt vmcnt(8)
    s_barrier
    ds_read_b128 v[20:23], v12 offset:49152
    v_mfma_f32_16x16x32_bf16 v[56:59], v[28:31], a[172:175], v[56:59]
    s_add_u32 s20, s20, 512
    buffer_atomic_add v84, v85, s[12:15], s39 offen sc1
    v_mfma_f32_16x16x32_bf16 v[60:63], v[32:35], a[168:171], v[60:63]
    ds_read_b128 v[24:27], v12 offset:53248
    v_mfma_f32_16x16x32_bf16 v[64:67], v[32:35], a[172:175], v[64:67]
    s_waitcnt lgkmcnt(4)
    v_mfma_f32_16x16x32_bf16 v[52:55], v[36:39], a[176:179], v[52:55]
    ds_read_b128 v[28:31], v13 offset:49152
    s_add_u32 m0, s21, 16384
    v_mfma_f32_16x16x32_bf16 v[56:59], v[36:39], a[180:183], v[56:59]
    buffer_load_dwordx4 v8, s[8:11], s20 offen lds
    v_mfma_f32_16x16x32_bf16 v[60:63], v[40:43], a[176:179], v[60:63]
    ds_read_b128 v[32:35], v13 offset:53248
    v_mfma_f32_16x16x32_bf16 v[64:67], v[40:43], a[180:183], v[64:67]
    s_waitcnt lgkmcnt(4)
    s_mov_b32 s37, 1
    v_mfma_f32_16x16x32_bf16 v[52:55], v[44:47], a[184:187], v[52:55]
    ds_read_b128 v[36:39], v14 offset:49152
    v_mfma_f32_16x16x32_bf16 v[56:59], v[44:47], a[188:191], v[56:59]
    v_mfma_f32_16x16x32_bf16 v[60:63], v[48:51], a[184:187], v[60:63]
    ds_read_b128 v[40:43], v14 offset:53248
    v_mfma_f32_16x16x32_bf16 v[64:67], v[48:51], a[188:191], v[64:67]
    s_waitcnt lgkmcnt(4)
    v_mfma_f32_16x16x32_bf16 v[52:55], v[20:23], a[192:195], v[52:55]
    ds_read_b128 v[44:47], v15 offset:49152
    s_add_u32 m0, s21, 17408
    v_mfma_f32_16x16x32_bf16 v[56:59], v[20:23], a[196:199], v[56:59]
    buffer_load_dwordx4 v9, s[8:11], s20 offen lds
    v_mfma_f32_16x16x32_bf16 v[60:63], v[24:27], a[192:195], v[60:63]
    ds_read_b128 v[48:51], v15 offset:53248
    v_mfma_f32_16x16x32_bf16 v[64:67], v[24:27], a[196:199], v[64:67]
    s_waitcnt lgkmcnt(4)
    v_mfma_f32_16x16x32_bf16 v[52:55], v[28:31], a[200:203], v[52:55]
    ds_read_b128 v[20:23], v12 offset:49408
    v_mfma_f32_16x16x32_bf16 v[56:59], v[28:31], a[204:207], v[56:59]
    v_mfma_f32_16x16x32_bf16 v[60:63], v[32:35], a[200:203], v[60:63]
    ds_read_b128 v[24:27], v12 offset:53504
    v_mfma_f32_16x16x32_bf16 v[64:67], v[32:35], a[204:207], v[64:67]
    s_waitcnt lgkmcnt(4)
    v_mfma_f32_16x16x32_bf16 v[52:55], v[36:39], a[208:211], v[52:55]
    ds_read_b128 v[28:31], v13 offset:49408
    s_add_u32 m0, s21, 18432
    v_mfma_f32_16x16x32_bf16 v[56:59], v[36:39], a[212:215], v[56:59]
    buffer_load_dwordx4 v10, s[8:11], s20 offen lds
    v_mfma_f32_16x16x32_bf16 v[60:63], v[40:43], a[208:211], v[60:63]
    ds_read_b128 v[32:35], v13 offset:53504
    v_mfma_f32_16x16x32_bf16 v[64:67], v[40:43], a[212:215], v[64:67]
    s_waitcnt lgkmcnt(4)
    v_mfma_f32_16x16x32_bf16 v[52:55], v[44:47], a[216:219], v[52:55]
    ds_read_b128 v[36:39], v14 offset:49408
    v_mfma_f32_16x16x32_bf16 v[56:59], v[44:47], a[220:223], v[56:59]
    v_mfma_f32_16x16x32_bf16 v[60:63], v[48:51], a[216:219], v[60:63]
    ds_read_b128 v[40:43], v14 offset:53504
    v_mfma_f32_16x16x32_bf16 v[64:67], v[48:51], a[220:223], v[64:67]
    s_waitcnt lgkmcnt(4)
    v_mfma_f32_16x16x32_bf16 v[52:55], v[20:23], a[224:227], v[52:55]
    ds_read_b128 v[44:47], v15 offset:49408
    s_add_u32 m0, s21, 19456
    v_mfma_f32_16x16x32_bf16 v[56:59], v[20:23], a[228:231], v[56:59]
    buffer_load_dwordx4 v11, s[8:11], s20 offen lds
    v_mfma_f32_16x16x32_bf16 v[60:63], v[24:27], a[224:227], v[60:63]
    ds_read_b128 v[48:51], v15 offset:53504
    v_mfma_f32_16x16x32_bf16 v[64:67], v[24:27], a[228:231], v[64:67]
    s_waitcnt lgkmcnt(4)
    v_mfma_f32_16x16x32_bf16 v[52:55], v[28:31], a[232:235], v[52:55]
    s_waitcnt vmcnt(20)
    s_barrier
    ds_read_b128 v[20:23], v16 offset:0
    v_mfma_f32_16x16x32_bf16 v[56:59], v[28:31], a[236:239], v[56:59]
    s_add_u32 s20, s20, 512
    v_mfma_f32_16x16x32_bf16 v[60:63], v[32:35], a[232:235], v[60:63]
    ds_read_b128 v[24:27], v16 offset:4096
    v_mfma_f32_16x16x32_bf16 v[64:67], v[32:35], a[236:239], v[64:67]
    s_waitcnt lgkmcnt(4)
    v_mfma_f32_16x16x32_bf16 v[52:55], v[36:39], a[240:243], v[52:55]
    ds_read_b128 v[28:31], v17 offset:0
    s_add_u32 m0, s21, 32768
    v_mfma_f32_16x16x32_bf16 v[56:59], v[36:39], a[244:247], v[56:59]
    buffer_load_dwordx4 v8, s[8:11], s20 offen lds
    v_mfma_f32_16x16x32_bf16 v[60:63], v[40:43], a[240:243], v[60:63]
    ds_read_b128 v[32:35], v17 offset:4096
    v_mfma_f32_16x16x32_bf16 v[64:67], v[40:43], a[244:247], v[64:67]
    s_waitcnt lgkmcnt(4)
    v_mfma_f32_16x16x32_bf16 v[52:55], v[44:47], a[248:251], v[52:55]
    ds_read_b128 v[36:39], v18 offset:0
    v_mfma_f32_16x16x32_bf16 v[56:59], v[44:47], a[252:255], v[56:59]
    v_mfma_f32_16x16x32_bf16 v[60:63], v[48:51], a[248:251], v[60:63]
    ds_read_b128 v[40:43], v18 offset:4096
    v_mfma_f32_16x16x32_bf16 v[64:67], v[48:51], a[252:255], v[64:67]
    s_waitcnt lgkmcnt(4)
    s_add_u32 s22, s22, 1
    s_cmp_ge_u32 s22, s23
    s_cbranch_scc1 L_fl0_211
    v_mfma_f32_16x16x32_bf16 v[68:71], v[20:23], a[0:3], 0
    ds_read_b128 v[44:47], v19 offset:0
    s_add_u32 m0, s21, 33792
    s_sub_u32 s39, s22, 1
    v_mfma_f32_16x16x32_bf16 v[72:75], v[20:23], a[4:7], 0
    buffer_load_dwordx4 v9, s[8:11], s20 offen lds
    s_bitcmp1_b32 s39, 1
    s_cselect_b32 s38, s55, s54
    v_mfma_f32_16x16x32_bf16 v[76:79], v[24:27], a[0:3], 0
    ds_read_b128 v[48:51], v19 offset:4096
    v_mfma_f32_16x16x32_bf16 v[80:83], v[24:27], a[4:7], 0
    s_waitcnt lgkmcnt(4)
    s_add_u32 s38, s38, s44
    v_mfma_f32_16x16x32_bf16 v[68:71], v[28:31], a[8:11], v[68:71]
    ds_read_b128 v[20:23], v16 offset:256
    s_lshl_b32 s42, s39, 20
    v_mfma_f32_16x16x32_bf16 v[72:75], v[28:31], a[12:15], v[72:75]
    s_add_u32 s38, s38, s42
    v_mfma_f32_16x16x32_bf16 v[76:79], v[32:35], a[8:11], v[76:79]
    ds_read_b128 v[24:27], v16 offset:4352
    s_lshl_b32 s39, s39, 7
    v_mfma_f32_16x16x32_bf16 v[80:83], v[32:35], a[12:15], v[80:83]
    s_waitcnt lgkmcnt(4)
    s_add_u32 s39, s39, 0x5900000
    v_mfma_f32_16x16x32_bf16 v[68:71], v[36:39], a[16:19], v[68:71]
    ds_read_b128 v[28:31], v17 offset:256
    s_add_u32 m0, s21, 34816
    s_cmp_eq_u32 s37, 0
    s_cselect_b32 s38, 0x7ff00000, s38
    s_cselect_b32 s39, 0x7ff00000, s39
    v_mfma_f32_16x16x32_bf16 v[72:75], v[36:39], a[20:23], v[72:75]
    buffer_load_dwordx4 v10, s[8:11], s20 offen lds
    v_mfma_f32_16x16x32_bf16 v[76:79], v[40:43], a[16:19], v[76:79]
    ds_read_b128 v[32:35], v17 offset:4352
    v_mfma_f32_16x16x32_bf16 v[80:83], v[40:43], a[20:23], v[80:83]
    s_waitcnt lgkmcnt(4)
    v_cvt_pk_bf16_f32 v88, v52, v53
    v_mfma_f32_16x16x32_bf16 v[68:71], v[44:47], a[24:27], v[68:71]
    ds_read_b128 v[36:39], v18 offset:256
    v_cvt_pk_bf16_f32 v89, v54, v55
    v_mfma_f32_16x16x32_bf16 v[72:75], v[44:47], a[28:31], v[72:75]
    v_cvt_pk_bf16_f32 v90, v60, v61
    v_cvt_pk_bf16_f32 v91, v62, v63
    buffer_store_dwordx4 v[88:91], v86, s[12:15], s38 offen offset:2048 sc1
    v_mfma_f32_16x16x32_bf16 v[76:79], v[48:51], a[24:27], v[76:79]
    ds_read_b128 v[40:43], v18 offset:4352
    v_mfma_f32_16x16x32_bf16 v[80:83], v[48:51], a[28:31], v[80:83]
    s_waitcnt lgkmcnt(4)
    v_mfma_f32_16x16x32_bf16 v[68:71], v[20:23], a[32:35], v[68:71]
    ds_read_b128 v[44:47], v19 offset:256
    s_add_u32 m0, s21, 35840
    v_cvt_pk_bf16_f32 v92, v56, v57
    v_mfma_f32_16x16x32_bf16 v[72:75], v[20:23], a[36:39], v[72:75]
    buffer_load_dwordx4 v11, s[8:11], s20 offen lds
    v_cvt_pk_bf16_f32 v93, v58, v59
    v_mfma_f32_16x16x32_bf16 v[76:79], v[24:27], a[32:35], v[76:79]
    ds_read_b128 v[48:51], v19 offset:4352
    v_cvt_pk_bf16_f32 v94, v64, v65
    v_mfma_f32_16x16x32_bf16 v[80:83], v[24:27], a[36:39], v[80:83]
    s_waitcnt lgkmcnt(4)
    v_cvt_pk_bf16_f32 v95, v66, v67
    v_mfma_f32_16x16x32_bf16 v[68:71], v[28:31], a[40:43], v[68:71]
    s_waitcnt vmcnt(20)
    s_barrier
    ds_read_b128 v[20:23], v16 offset:16384
    v_mfma_f32_16x16x32_bf16 v[72:75], v[28:31], a[44:47], v[72:75]
    s_add_u32 s20, s20, 512
    buffer_store_dwordx4 v[92:95], v86, s[12:15], s38 offen offset:2176 sc1
    v_mfma_f32_16x16x32_bf16 v[76:79], v[32:35], a[40:43], v[76:79]
    ds_read_b128 v[24:27], v16 offset:20480
    v_mfma_f32_16x16x32_bf16 v[80:83], v[32:35], a[44:47], v[80:83]
    s_waitcnt lgkmcnt(4)
    v_mfma_f32_16x16x32_bf16 v[68:71], v[36:39], a[48:51], v[68:71]
    ds_read_b128 v[28:31], v17 offset:16384
    s_add_u32 m0, s21, 49152
    v_mfma_f32_16x16x32_bf16 v[72:75], v[36:39], a[52:55], v[72:75]
    buffer_load_dwordx4 v8, s[8:11], s20 offen lds
    v_mfma_f32_16x16x32_bf16 v[76:79], v[40:43], a[48:51], v[76:79]
    ds_read_b128 v[32:35], v17 offset:20480
    v_mfma_f32_16x16x32_bf16 v[80:83], v[40:43], a[52:55], v[80:83]
    s_waitcnt lgkmcnt(4)
    v_mfma_f32_16x16x32_bf16 v[68:71], v[44:47], a[56:59], v[68:71]
    ds_read_b128 v[36:39], v18 offset:16384
    v_mfma_f32_16x16x32_bf16 v[72:75], v[44:47], a[60:63], v[72:75]
    v_mfma_f32_16x16x32_bf16 v[76:79], v[48:51], a[56:59], v[76:79]
    ds_read_b128 v[40:43], v18 offset:20480
    v_mfma_f32_16x16x32_bf16 v[80:83], v[48:51], a[60:63], v[80:83]
    s_waitcnt lgkmcnt(4)
    v_mfma_f32_16x16x32_bf16 v[68:71], v[20:23], a[64:67], v[68:71]
    ds_read_b128 v[44:47], v19 offset:16384
    s_add_u32 m0, s21, 50176
    v_mfma_f32_16x16x32_bf16 v[72:75], v[20:23], a[68:71], v[72:75]
    buffer_load_dwordx4 v9, s[8:11], s20 offen lds
    v_mfma_f32_16x16x32_bf16 v[76:79], v[24:27], a[64:67], v[76:79]
    ds_read_b128 v[48:51], v19 offset:20480
    v_mfma_f32_16x16x32_bf16 v[80:83], v[24:27], a[68:71], v[80:83]
    s_waitcnt lgkmcnt(4)
    v_mfma_f32_16x16x32_bf16 v[68:71], v[28:31], a[72:75], v[68:71]
    ds_read_b128 v[20:23], v16 offset:16640
    v_mfma_f32_16x16x32_bf16 v[72:75], v[28:31], a[76:79], v[72:75]
    v_mfma_f32_16x16x32_bf16 v[76:79], v[32:35], a[72:75], v[76:79]
    ds_read_b128 v[24:27], v16 offset:20736
    s_add_u32 s24, s24, 1
    v_mfma_f32_16x16x32_bf16 v[80:83], v[32:35], a[76:79], v[80:83]
    s_waitcnt lgkmcnt(4)
    v_mfma_f32_16x16x32_bf16 v[68:71], v[36:39], a[80:83], v[68:71]
    ds_read_b128 v[28:31], v17 offset:16640
    s_add_u32 m0, s21, 51200
    v_mfma_f32_16x16x32_bf16 v[72:75], v[36:39], a[84:87], v[72:75]
    buffer_load_dwordx4 v10, s[8:11], s20 offen lds
    v_mfma_f32_16x16x32_bf16 v[76:79], v[40:43], a[80:83], v[76:79]
    ds_read_b128 v[32:35], v17 offset:20736
    v_mfma_f32_16x16x32_bf16 v[80:83], v[40:43], a[84:87], v[80:83]
    s_waitcnt lgkmcnt(4)
    s_min_u32 s24, s24, 63
    v_mfma_f32_16x16x32_bf16 v[68:71], v[44:47], a[88:91], v[68:71]
    ds_read_b128 v[36:39], v18 offset:16640
    v_mfma_f32_16x16x32_bf16 v[72:75], v[44:47], a[92:95], v[72:75]
    v_mfma_f32_16x16x32_bf16 v[76:79], v[48:51], a[88:91], v[76:79]
    ds_read_b128 v[40:43], v18 offset:20736
    s_lshl_b32 s53, s24, 16
    v_mfma_f32_16x16x32_bf16 v[80:83], v[48:51], a[92:95], v[80:83]
    s_waitcnt lgkmcnt(4)
    v_mfma_f32_16x16x32_bf16 v[68:71], v[20:23], a[96:99], v[68:71]
    ds_read_b128 v[44:47], v19 offset:16640
    s_add_u32 m0, s21, 52224
    v_mfma_f32_16x16x32_bf16 v[72:75], v[20:23], a[100:103], v[72:75]
    buffer_load_dwordx4 v11, s[8:11], s20 offen lds
    v_mfma_f32_16x16x32_bf16 v[76:79], v[24:27], a[96:99], v[76:79]
    ds_read_b128 v[48:51], v19 offset:20736
    v_mfma_f32_16x16x32_bf16 v[80:83], v[24:27], a[100:103], v[80:83]
    s_waitcnt lgkmcnt(4)
    v_mfma_f32_16x16x32_bf16 v[68:71], v[28:31], a[104:107], v[68:71]
    s_waitcnt vmcnt(20)
    s_barrier
    ds_read_b128 v[20:23], v16 offset:32768
    v_mfma_f32_16x16x32_bf16 v[72:75], v[28:31], a[108:111], v[72:75]
    s_mov_b32 s20, s53
    v_mfma_f32_16x16x32_bf16 v[76:79], v[32:35], a[104:107], v[76:79]
    ds_read_b128 v[24:27], v16 offset:36864
    v_mfma_f32_16x16x32_bf16 v[80:83], v[32:35], a[108:111], v[80:83]
    s_waitcnt lgkmcnt(4)
    v_mfma_f32_16x16x32_bf16 v[68:71], v[36:39], a[112:115], v[68:71]
    ds_read_b128 v[28:31], v17 offset:32768
    s_add_u32 m0, s21, 65536
    v_mfma_f32_16x16x32_bf16 v[72:75], v[36:39], a[116:119], v[72:75]
    buffer_load_dwordx4 v8, s[8:11], s20 offen lds
    v_mfma_f32_16x16x32_bf16 v[76:79], v[40:43], a[112:115], v[76:79]
    ds_read_b128 v[32:35], v17 offset:36864
    v_mfma_f32_16x16x32_bf16 v[80:83], v[40:43], a[116:119], v[80:83]
    s_waitcnt lgkmcnt(4)
    v_mfma_f32_16x16x32_bf16 v[68:71], v[44:47], a[120:123], v[68:71]
    ds_read_b128 v[36:39], v18 offset:32768
    v_mfma_f32_16x16x32_bf16 v[72:75], v[44:47], a[124:127], v[72:75]
    v_mfma_f32_16x16x32_bf16 v[76:79], v[48:51], a[120:123], v[76:79]
    ds_read_b128 v[40:43], v18 offset:36864
    v_mfma_f32_16x16x32_bf16 v[80:83], v[48:51], a[124:127], v[80:83]
    s_waitcnt lgkmcnt(4)
    v_mfma_f32_16x16x32_bf16 v[68:71], v[20:23], a[128:131], v[68:71]
    ds_read_b128 v[44:47], v19 offset:32768
    s_add_u32 m0, s21, 66560
    v_mfma_f32_16x16x32_bf16 v[72:75], v[20:23], a[132:135], v[72:75]
    buffer_load_dwordx4 v9, s[8:11], s20 offen lds
    v_mfma_f32_16x16x32_bf16 v[76:79], v[24:27], a[128:131], v[76:79]
    ds_read_b128 v[48:51], v19 offset:36864
    v_mfma_f32_16x16x32_bf16 v[80:83], v[24:27], a[132:135], v[80:83]
    s_waitcnt lgkmcnt(4)
    v_mfma_f32_16x16x32_bf16 v[68:71], v[28:31], a[136:139], v[68:71]
    ds_read_b128 v[20:23], v16 offset:33024
    v_mfma_f32_16x16x32_bf16 v[72:75], v[28:31], a[140:143], v[72:75]
    v_mfma_f32_16x16x32_bf16 v[76:79], v[32:35], a[136:139], v[76:79]
    ds_read_b128 v[24:27], v16 offset:37120
    v_mfma_f32_16x16x32_bf16 v[80:83], v[32:35], a[140:143], v[80:83]
    s_waitcnt lgkmcnt(4)
    v_mfma_f32_16x16x32_bf16 v[68:71], v[36:39], a[144:147], v[68:71]
    ds_read_b128 v[28:31], v17 offset:33024
    s_add_u32 m0, s21, 67584
    v_mfma_f32_16x16x32_bf16 v[72:75], v[36:39], a[148:151], v[72:75]
    buffer_load_dwordx4 v10, s[8:11], s20 offen lds
    v_mfma_f32_16x16x32_bf16 v[76:79], v[40:43], a[144:147], v[76:79]
    ds_read_b128 v[32:35], v17 offset:37120
    v_mfma_f32_16x16x32_bf16 v[80:83], v[40:43], a[148:151], v[80:83]
    s_waitcnt lgkmcnt(4)
    v_mfma_f32_16x16x32_bf16 v[68:71], v[44:47], a[152:155], v[68:71]
    ds_read_b128 v[36:39], v18 offset:33024
    v_mfma_f32_16x16x32_bf16 v[72:75], v[44:47], a[156:159], v[72:75]
    v_mfma_f32_16x16x32_bf16 v[76:79], v[48:51], a[152:155], v[76:79]
    ds_read_b128 v[40:43], v18 offset:37120
    v_mfma_f32_16x16x32_bf16 v[80:83], v[48:51], a[156:159], v[80:83]
    s_waitcnt lgkmcnt(4)
    v_mfma_f32_16x16x32_bf16 v[68:71], v[20:23], a[160:163], v[68:71]
    ds_read_b128 v[44:47], v19 offset:33024
    s_add_u32 m0, s21, 68608
    v_mfma_f32_16x16x32_bf16 v[72:75], v[20:23], a[164:167], v[72:75]
    buffer_load_dwordx4 v11, s[8:11], s20 offen lds
    v_mfma_f32_16x16x32_bf16 v[76:79], v[24:27], a[160:163], v[76:79]
    ds_read_b128 v[48:51], v19 offset:37120
    v_mfma_f32_16x16x32_bf16 v[80:83], v[24:27], a[164:167], v[80:83]
    s_waitcnt lgkmcnt(4)
    v_mfma_f32_16x16x32_bf16 v[68:71], v[28:31], a[168:171], v[68:71]
    s_waitcnt vmcnt(8)
    s_barrier
    ds_read_b128 v[20:23], v16 offset:49152
    v_mfma_f32_16x16x32_bf16 v[72:75], v[28:31], a[172:175], v[72:75]
    s_add_u32 s20, s20, 512
    buffer_atomic_add v84, v85, s[12:15], s39 offen sc1
    v_mfma_f32_16x16x32_bf16 v[76:79], v[32:35], a[168:171], v[76:79]
    ds_read_b128 v[24:27], v16 offset:53248
    v_mfma_f32_16x16x32_bf16 v[80:83], v[32:35], a[172:175], v[80:83]
    s_waitcnt lgkmcnt(4)
    v_mfma_f32_16x16x32_bf16 v[68:71], v[36:39], a[176:179], v[68:71]
    ds_read_b128 v[28:31], v17 offset:49152
    s_add_u32 m0, s21, 81920
    v_mfma_f32_16x16x32_bf16 v[72:75], v[36:39], a[180:183], v[72:75]
    buffer_load_dwordx4 v8, s[8:11], s20 offen lds
    v_mfma_f32_16x16x32_bf16 v[76:79], v[40:43], a[176:179], v[76:79]
    ds_read_b128 v[32:35], v17 offset:53248
    v_mfma_f32_16x16x32_bf16 v[80:83], v[40:43], a[180:183], v[80:83]
    s_waitcnt lgkmcnt(4)
    s_mov_b32 s37, 1
    v_mfma_f32_16x16x32_bf16 v[68:71], v[44:47], a[184:187], v[68:71]
    ds_read_b128 v[36:39], v18 offset:49152
    v_mfma_f32_16x16x32_bf16 v[72:75], v[44:47], a[188:191], v[72:75]
    v_mfma_f32_16x16x32_bf16 v[76:79], v[48:51], a[184:187], v[76:79]
    ds_read_b128 v[40:43], v18 offset:53248
    v_mfma_f32_16x16x32_bf16 v[80:83], v[48:51], a[188:191], v[80:83]
    s_waitcnt lgkmcnt(4)
    v_mfma_f32_16x16x32_bf16 v[68:71], v[20:23], a[192:195], v[68:71]
    ds_read_b128 v[44:47], v19 offset:49152
    s_add_u32 m0, s21, 82944
    v_mfma_f32_16x16x32_bf16 v[72:75], v[20:23], a[196:199], v[72:75]
    buffer_load_dwordx4 v9, s[8:11], s20 offen lds
    v_mfma_f32_16x16x32_bf16 v[76:79], v[24:27], a[192:195], v[76:79]
    ds_read_b128 v[48:51], v19 offset:53248
    v_mfma_f32_16x16x32_bf16 v[80:83], v[24:27], a[196:199], v[80:83]
    s_waitcnt lgkmcnt(4)
    v_mfma_f32_16x16x32_bf16 v[68:71], v[28:31], a[200:203], v[68:71]
    ds_read_b128 v[20:23], v16 offset:49408
    v_mfma_f32_16x16x32_bf16 v[72:75], v[28:31], a[204:207], v[72:75]
    v_mfma_f32_16x16x32_bf16 v[76:79], v[32:35], a[200:203], v[76:79]
    ds_read_b128 v[24:27], v16 offset:53504
    v_mfma_f32_16x16x32_bf16 v[80:83], v[32:35], a[204:207], v[80:83]
    s_waitcnt lgkmcnt(4)
    v_mfma_f32_16x16x32_bf16 v[68:71], v[36:39], a[208:211], v[68:71]
    ds_read_b128 v[28:31], v17 offset:49408
    s_add_u32 m0, s21, 83968
    v_mfma_f32_16x16x32_bf16 v[72:75], v[36:39], a[212:215], v[72:75]
    buffer_load_dwordx4 v10, s[8:11], s20 offen lds
    v_mfma_f32_16x16x32_bf16 v[76:79], v[40:43], a[208:211], v[76:79]
    ds_read_b128 v[32:35], v17 offset:53504
    v_mfma_f32_16x16x32_bf16 v[80:83], v[40:43], a[212:215], v[80:83]
    s_waitcnt lgkmcnt(4)
    v_mfma_f32_16x16x32_bf16 v[68:71], v[44:47], a[216:219], v[68:71]
    ds_read_b128 v[36:39], v18 offset:49408
    v_mfma_f32_16x16x32_bf16 v[72:75], v[44:47], a[220:223], v[72:75]
    v_mfma_f32_16x16x32_bf16 v[76:79], v[48:51], a[216:219], v[76:79]
    ds_read_b128 v[40:43], v18 offset:53504
    v_mfma_f32_16x16x32_bf16 v[80:83], v[48:51], a[220:223], v[80:83]
    s_waitcnt lgkmcnt(4)
    v_mfma_f32_16x16x32_bf16 v[68:71], v[20:23], a[224:227], v[68:71]
    ds_read_b128 v[44:47], v19 offset:49408
    s_add_u32 m0, s21, 84992
    v_mfma_f32_16x16x32_bf16 v[72:75], v[20:23], a[228:231], v[72:75]
    buffer_load_dwordx4 v11, s[8:11], s20 offen lds
    v_mfma_f32_16x16x32_bf16 v[76:79], v[24:27], a[224:227], v[76:79]
    ds_read_b128 v[48:51], v19 offset:53504
    v_mfma_f32_16x16x32_bf16 v[80:83], v[24:27], a[228:231], v[80:83]
    s_waitcnt lgkmcnt(4)
    v_mfma_f32_16x16x32_bf16 v[68:71], v[28:31], a[232:235], v[68:71]
    s_waitcnt vmcnt(20)
    s_barrier
    ds_read_b128 v[20:23], v12 offset:0
    v_mfma_f32_16x16x32_bf16 v[72:75], v[28:31], a[236:239], v[72:75]
    s_add_u32 s20, s20, 512
    v_mfma_f32_16x16x32_bf16 v[76:79], v[32:35], a[232:235], v[76:79]
    ds_read_b128 v[24:27], v12 offset:4096
    v_mfma_f32_16x16x32_bf16 v[80:83], v[32:35], a[236:239], v[80:83]
    s_waitcnt lgkmcnt(4)
    v_mfma_f32_16x16x32_bf16 v[68:71], v[36:39], a[240:243], v[68:71]
    ds_read_b128 v[28:31], v13 offset:0
    s_add_u32 m0, s21, 98304
    v_mfma_f32_16x16x32_bf16 v[72:75], v[36:39], a[244:247], v[72:75]
    buffer_load_dwordx4 v8, s[8:11], s20 offen lds
    v_mfma_f32_16x16x32_bf16 v[76:79], v[40:43], a[240:243], v[76:79]
    ds_read_b128 v[32:35], v13 offset:4096
    v_mfma_f32_16x16x32_bf16 v[80:83], v[40:43], a[244:247], v[80:83]
    s_waitcnt lgkmcnt(4)
    v_mfma_f32_16x16x32_bf16 v[68:71], v[44:47], a[248:251], v[68:71]
    ds_read_b128 v[36:39], v14 offset:0
    v_mfma_f32_16x16x32_bf16 v[72:75], v[44:47], a[252:255], v[72:75]
    v_mfma_f32_16x16x32_bf16 v[76:79], v[48:51], a[248:251], v[76:79]
    ds_read_b128 v[40:43], v14 offset:4096
    v_mfma_f32_16x16x32_bf16 v[80:83], v[48:51], a[252:255], v[80:83]
    s_waitcnt lgkmcnt(4)
    s_add_u32 s22, s22, 1
    s_cmp_ge_u32 s22, s23
    s_cbranch_scc0 L_st_210
    s_waitcnt lgkmcnt(0)
    s_nop 7
    s_sub_u32 s39, s22, 1
    s_bitcmp1_b32 s39, 1
    s_cselect_b32 s38, s55, s54
    s_add_u32 s38, s38, s44
    s_lshl_b32 s42, s39, 20
    s_add_u32 s38, s38, s42
    s_lshl_b32 s39, s39, 7
    s_add_u32 s39, s39, 0x5900000
    s_cmp_eq_u32 s37, 0
    s_cselect_b32 s38, 0x7ff00000, s38
    s_cselect_b32 s39, 0x7ff00000, s39
    v_cvt_pk_bf16_f32 v88, v68, v69
    v_cvt_pk_bf16_f32 v89, v70, v71
    v_cvt_pk_bf16_f32 v90, v76, v77
    v_cvt_pk_bf16_f32 v91, v78, v79
    buffer_store_dwordx4 v[88:91], v86, s[12:15], s38 offen offset:2048 sc1
    v_cvt_pk_bf16_f32 v92, v72, v73
    v_cvt_pk_bf16_f32 v93, v74, v75
    v_cvt_pk_bf16_f32 v94, v80, v81
    v_cvt_pk_bf16_f32 v95, v82, v83
    buffer_store_dwordx4 v[92:95], v86, s[12:15], s38 offen offset:2176 sc1
    s_waitcnt vmcnt(0)
    s_barrier
    buffer_atomic_add v84, v85, s[12:15], s39 offen sc1
    s_mov_b32 s37, 1
    s_branch L_ste_212
L_fl0_211:
    s_waitcnt lgkmcnt(0)
    s_nop 7
    s_sub_u32 s39, s22, 1
    s_bitcmp1_b32 s39, 1
    s_cselect_b32 s38, s55, s54
    s_add_u32 s38, s38, s44
    s_lshl_b32 s42, s39, 20
    s_add_u32 s38, s38, s42
    s_lshl_b32 s39, s39, 7
    s_add_u32 s39, s39, 0x5900000
    s_cmp_eq_u32 s37, 0
    s_cselect_b32 s38, 0x7ff00000, s38
    s_cselect_b32 s39, 0x7ff00000, s39
    v_cvt_pk_bf16_f32 v88, v52, v53
    v_cvt_pk_bf16_f32 v89, v54, v55
    v_cvt_pk_bf16_f32 v90, v60, v61
    v_cvt_pk_bf16_f32 v91, v62, v63
    buffer_store_dwordx4 v[88:91], v86, s[12:15], s38 offen offset:2048 sc1
    v_cvt_pk_bf16_f32 v92, v56, v57
    v_cvt_pk_bf16_f32 v93, v58, v59
    v_cvt_pk_bf16_f32 v94, v64, v65
    v_cvt_pk_bf16_f32 v95, v66, v67
    buffer_store_dwordx4 v[92:95], v86, s[12:15], s38 offen offset:2176 sc1
    s_waitcnt vmcnt(0)
    s_barrier
    buffer_atomic_add v84, v85, s[12:15], s39 offen sc1
    s_mov_b32 s37, 1
L_ste_212:
    s_branch L_op_204
L_q_201:
    s_mov_b32 s16, s64
    s_and_b32 s17, s65, 0xffff
    s_mov_b32 s18, 0x400000
    s_mov_b32 s19, 0x00020000
    v_lshlrev_b32 v1, 4, v0
    s_lshl_b32 s25, s46, 12
L_warm_213:
    buffer_load_dwordx4 v[104:107], v1, s[8:11], s25 offen
    buffer_load_dwordx4 v[108:111], v1, s[16:19], s25 offen
    s_add_u32 s25, s25, 0x20000
    buffer_load_dwordx4 v[112:115], v1, s[8:11], s25 offen
    buffer_load_dwordx4 v[116:119], v1, s[16:19], s25 offen
    s_add_u32 s25, s25, 0x20000
    buffer_load_dwordx4 v[120:123], v1, s[8:11], s25 offen
    buffer_load_dwordx4 v[124:127], v1, s[16:19], s25 offen
    s_add_u32 s25, s25, 0x20000
    buffer_load_dwordx4 v[128:131], v1, s[8:11], s25 offen
    buffer_load_dwordx4 v[132:135], v1, s[16:19], s25 offen
    s_add_u32 s25, s25, 0x20000
    buffer_load_dwordx4 v[136:139], v1, s[8:11], s25 offen
    buffer_load_dwordx4 v[140:143], v1, s[16:19], s25 offen
    s_add_u32 s25, s25, 0x20000
    buffer_load_dwordx4 v[144:147], v1, s[8:11], s25 offen
    buffer_load_dwordx4 v[148:151], v1, s[16:19], s25 offen
    s_add_u32 s25, s25, 0x20000
    buffer_load_dwordx4 v[152:155], v1, s[8:11], s25 offen
    buffer_load_dwordx4 v[156:159], v1, s[16:19], s25 offen
    s_add_u32 s25, s25, 0x20000
    buffer_load_dwordx4 v[160:163], v1, s[8:11], s25 offen
    buffer_load_dwordx4 v[164:167], v1, s[16:19], s25 offen
    s_add_u32 s25, s25, 0x20000
    s_waitcnt vmcnt(16)
    s_cmp_lt_u32 s25, 0x400000
    s_cbranch_scc1 L_warm_213
    s_waitcnt vmcnt(0)
    v_and_b32 v1, 31, v0
    v_bfe_u32 v2, v0, 5, 1
    v_and_b32 v96, 63, v0
    v_lshlrev_b32 v96, 4, v96
    v_and_b32 v4, 7, v1
    v_lshlrev_b32 v4, 4, v4
    v_lshl_add_u32 v97, v2, 7, v4
    v_bfe_u32 v5, v1, 2, 1
    v_lshlrev_b32 v5, 4, v5
    v_lshrrev_b32 v6, 3, v1
    v_lshl_add_u32 v5, v6, 2, v5
    v_and_b32 v6, 3, v1
    v_add_u32 v5, v5, v6
    v_lshlrev_b32 v5, 4, v5
    v_lshl_add_u32 v98, v2, 9, v5
    v_lshl_add_u32 v99, v2, 3, v5
    v_lshlrev_b32 v4, 4, v1
    v_lshl_add_u32 v100, v2, 10, v4
    v_lshrrev_b32 v4, 6, v0
    v_lshl_add_u32 v101, v4, 13, v96
    v_add_u32 v101, 0x20000, v101
    v_lshl_add_u32 v86, v4, 11, v86
    v_add_u32 v86, 0x20000, v86
    v_and_b32 v85, 63, v0
    v_min_u32 v85, 1, v85
    v_lshlrev_b32 v85, 30, v85
    v_lshlrev_b32 v4, 2, v2
    v_sub_u32 v4, v1, v4
    v_mov_b32 v5, 0xff800000
    v_cmp_gt_i32 vcc, 0, v4
    s_nop 1
    v_cndmask_b32 v240, 0, v5, vcc
    v_cmp_gt_i32 vcc, 1, v4
    s_nop 1
    v_cndmask_b32 v241, 0, v5, vcc
    v_cmp_gt_i32 vcc, 2, v4
    s_nop 1
    v_cndmask_b32 v242, 0, v5, vcc
    v_cmp_gt_i32 vcc, 3, v4
    s_nop 1
    v_cndmask_b32 v243, 0, v5, vcc
    v_cmp_gt_i32 vcc, 8, v4
    s_nop 1
    v_cndmask_b32 v244, 0, v5, vcc
    v_cmp_gt_i32 vcc, 9, v4
    s_nop 1
    v_cndmask_b32 v245, 0, v5, vcc
    v_cmp_gt_i32 vcc, 10, v4
    s_nop 1
    v_cndmask_b32 v246, 0, v5, vcc
    v_cmp_gt_i32 vcc, 11, v4
    s_nop 1
    v_cndmask_b32 v247, 0, v5, vcc
    v_cmp_gt_i32 vcc, 16, v4
    s_nop 1
    v_cndmask_b32 v248, 0, v5, vcc
    v_cmp_gt_i32 vcc, 17, v4
    s_nop 1
    v_cndmask_b32 v249, 0, v5, vcc
    v_cmp_gt_i32 vcc, 18, v4
    s_nop 1
    v_cndmask_b32 v250, 0, v5, vcc
    v_cmp_gt_i32 vcc, 19, v4
    s_nop 1
    v_cndmask_b32 v251, 0, v5, vcc
    v_cmp_gt_i32 vcc, 24, v4
    s_nop 1
    v_cndmask_b32 v252, 0, v5, vcc
    v_cmp_gt_i32 vcc, 25, v4
    s_nop 1
    v_cndmask_b32 v253, 0, v5, vcc
    v_cmp_gt_i32 vcc, 26, v4
    s_nop 1
    v_cndmask_b32 v254, 0, v5, vcc
    v_cmp_gt_i32 vcc, 27, v4
    s_nop 1
    v_cndmask_b32 v255, 0, v5, vcc
    s_barrier
    s_add_u32 m0, s21, 0
    s_nop 0
    buffer_load_dwordx4 v8, s[8:11], s20 offen lds
    s_add_u32 m0, s21, 1024
    s_nop 0
    buffer_load_dwordx4 v9, s[8:11], s20 offen lds
    s_add_u32 m0, s21, 2048
    s_nop 0
    buffer_load_dwordx4 v10, s[8:11], s20 offen lds
    s_add_u32 m0, s21, 3072
    s_nop 0
    buffer_load_dwordx4 v11, s[8:11], s20 offen lds
    s_add_u32 s20, s20, 512
    s_add_u32 m0, s21, 16384
    s_nop 0
    buffer_load_dwordx4 v8, s[8:11], s20 offen lds
    s_add_u32 m0, s21, 17408
    s_nop 0
    buffer_load_dwordx4 v9, s[8:11], s20 offen lds
    s_add_u32 m0, s21, 18432
    s_nop 0
    buffer_load_dwordx4 v10, s[8:11], s20 offen lds
    s_add_u32 m0, s21, 19456
    s_nop 0
    buffer_load_dwordx4 v11, s[8:11], s20 offen lds
    s_add_u32 s20, s20, 512
    s_add_u32 m0, s21, 32768
    s_nop 0
    buffer_load_dwordx4 v8, s[8:11], s20 offen lds
    s_add_u32 m0, s21, 33792
    s_nop 0
    buffer_load_dwordx4 v9, s[8:11], s20 offen lds
    s_add_u32 m0, s21, 34816
    s_nop 0
    buffer_load_dwordx4 v10, s[8:11], s20 offen lds
    s_add_u32 m0, s21, 35840
    s_nop 0
    buffer_load_dwordx4 v11, s[8:11], s20 offen lds
    s_add_u32 s20, s20, 512
    s_add_u32 m0, s21, 49152
    s_nop 0
    buffer_load_dwordx4 v8, s[8:11], s20 offen lds
    s_add_u32 m0, s21, 50176
    s_nop 0
    buffer_load_dwordx4 v9, s[8:11], s20 offen lds
    s_add_u32 m0, s21, 51200
    s_nop 0
    buffer_load_dwordx4 v10, s[8:11], s20 offen lds
    s_add_u32 m0, s21, 52224
    s_nop 0
    buffer_load_dwordx4 v11, s[8:11], s20 offen lds
    s_add_u32 s24, s24, 1
    s_min_u32 s24, s24, 63
    s_lshl_b32 s53, s24, 16
    s_mov_b32 s20, s53
    s_add_u32 m0, s21, 65536
    s_nop 0
    buffer_load_dwordx4 v8, s[8:11], s20 offen lds
    s_add_u32 m0, s21, 66560
    s_nop 0
    buffer_load_dwordx4 v9, s[8:11], s20 offen lds
    s_add_u32 m0, s21, 67584
    s_nop 0
    buffer_load_dwordx4 v10, s[8:11], s20 offen lds
    s_add_u32 m0, s21, 68608
    s_nop 0
    buffer_load_dwordx4 v11, s[8:11], s20 offen lds
    s_add_u32 s20, s20, 512
    s_add_u32 m0, s21, 81920
    s_nop 0
    buffer_load_dwordx4 v8, s[8:11], s20 offen lds
    s_add_u32 m0, s21, 82944
    s_nop 0
    buffer_load_dwordx4 v9, s[8:11], s20 offen lds
    s_add_u32 m0, s21, 83968
    s_nop 0
    buffer_load_dwordx4 v10, s[8:11], s20 offen lds
    s_add_u32 m0, s21, 84992
    s_nop 0
    buffer_load_dwordx4 v11, s[8:11], s20 offen lds
    s_add_u32 s20, s20, 512
    s_add_u32 m0, s21, 98304
    s_nop 0
    buffer_load_dwordx4 v8, s[8:11], s20 offen lds
    s_waitcnt vmcnt(21)
    s_barrier
    ds_read_b128 v[20:23], v12 offset:0
    ds_read_b128 v[24:27], v12 offset:4096
    ds_read_b128 v[28:31], v13 offset:0
    ds_read_b128 v[32:35], v13 offset:4096
    ds_read_b128 v[36:39], v14 offset:0
    ds_read_b128 v[40:43], v14 offset:4096
    s_waitcnt lgkmcnt(4)
L_st_217:
    v_mfma_f32_16x16x32_bf16 v[52:55], a[0:3], v[20:23], 0
    ds_read_b128 v[44:47], v15 offset:0
    s_add_u32 m0, s21, 99328
    v_mfma_f32_16x16x32_bf16 v[56:59], a[4:7], v[20:23], 0
    buffer_load_dwordx4 v9, s[8:11], s20 offen lds
    s_sub_u32 s39, s22, 1
    v_mfma_f32_16x16x32_bf16 v[60:63], a[0:3], v[24:27], 0
    ds_read_b128 v[48:51], v15 offset:4096
    s_and_b32 s39, s39, 3
    s_lshl_b32 s39, s39, 13
    v_mfma_f32_16x16x32_bf16 v[64:67], a[4:7], v[24:27], 0
    s_waitcnt lgkmcnt(4)
    v_add_u32 v87, s39, v86
    v_mfma_f32_16x16x32_bf16 v[52:55], a[8:11], v[28:31], v[52:55]
    ds_read_b128 v[20:23], v12 offset:256
    s_nop 0
    s_nop 0
    v_mfma_f32_16x16x32_bf16 v[56:59], a[12:15], v[28:31], v[56:59]
    v_cvt_pk_bf16_f32 v88, v68, v69
    v_mfma_f32_16x16x32_bf16 v[60:63], a[8:11], v[32:35], v[60:63]
    ds_read_b128 v[24:27], v12 offset:4352
    v_cvt_pk_bf16_f32 v89, v70, v71
    v_mfma_f32_16x16x32_bf16 v[64:67], a[12:15], v[32:35], v[64:67]
    s_waitcnt lgkmcnt(4)
    v_cvt_pk_bf16_f32 v90, v72, v73
    v_cvt_pk_bf16_f32 v91, v74, v75
    v_mfma_f32_16x16x32_bf16 v[52:55], a[16:19], v[36:39], v[52:55]
    ds_read_b128 v[28:31], v13 offset:256
    s_add_u32 m0, s21, 100352
    ds_write_b128 v87, v[88:91] offset:0
    v_mfma_f32_16x16x32_bf16 v[56:59], a[20:23], v[36:39], v[56:59]
    buffer_load_dwordx4 v10, s[8:11], s20 offen lds
    v_mfma_f32_16x16x32_bf16 v[60:63], a[16:19], v[40:43], v[60:63]
    ds_read_b128 v[32:35], v13 offset:4352
    v_cvt_pk_bf16_f32 v92, v76, v77
    v_cvt_pk_bf16_f32 v93, v78, v79
    v_mfma_f32_16x16x32_bf16 v[64:67], a[20:23], v[40:43], v[64:67]
    s_waitcnt lgkmcnt(4)
    v_cvt_pk_bf16_f32 v94, v80, v81
    v_mfma_f32_16x16x32_bf16 v[52:55], a[24:27], v[44:47], v[52:55]
    ds_read_b128 v[36:39], v14 offset:256
    v_cvt_pk_bf16_f32 v95, v82, v83
    ds_write_b128 v87, v[92:95] offset:128
    v_mfma_f32_16x16x32_bf16 v[56:59], a[28:31], v[44:47], v[56:59]
    s_and_b32 s39, s22, 3
    s_cselect_b32 s39, 0, s22
    s_cmp_lg_u32 s39, 0
    s_cbranch_scc1 L_att_214
L_attr_215:
    v_mfma_f32_16x16x32_bf16 v[60:63], a[24:27], v[48:51], v[60:63]
    ds_read_b128 v[40:43], v14 offset:4352
    v_mfma_f32_16x16x32_bf16 v[64:67], a[28:31], v[48:51], v[64:67]
    s_waitcnt lgkmcnt(4)
    v_mfma_f32_16x16x32_bf16 v[52:55], a[32:35], v[20:23], v[52:55]
    ds_read_b128 v[44:47], v15 offset:256
    s_add_u32 m0, s21, 101376
    v_mfma_f32_16x16x32_bf16 v[56:59], a[36:39], v[20:23], v[56:59]
    buffer_load_dwordx4 v11, s[8:11], s20 offen lds
    v_mfma_f32_16x16x32_bf16 v[60:63], a[32:35], v[24:27], v[60:63]
    ds_read_b128 v[48:51], v15 offset:4352
    v_mfma_f32_16x16x32_bf16 v[64:67], a[36:39], v[24:27], v[64:67]
    s_waitcnt lgkmcnt(4)
    v_mfma_f32_16x16x32_bf16 v[52:55], a[40:43], v[28:31], v[52:55]
    s_waitcnt vmcnt(20)
    s_barrier
    ds_read_b128 v[20:23], v12 offset:16384
    v_mfma_f32_16x16x32_bf16 v[56:59], a[44:47], v[28:31], v[56:59]
    s_add_u32 s20, s20, 512
    v_mfma_f32_16x16x32_bf16 v[60:63], a[40:43], v[32:35], v[60:63]
    ds_read_b128 v[24:27], v12 offset:20480
    v_mfma_f32_16x16x32_bf16 v[64:67], a[44:47], v[32:35], v[64:67]
    s_waitcnt lgkmcnt(4)
    v_mfma_f32_16x16x32_bf16 v[52:55], a[48:51], v[36:39], v[52:55]
    ds_read_b128 v[28:31], v13 offset:16384
    s_add_u32 m0, s21, 114688
    v_mfma_f32_16x16x32_bf16 v[56:59], a[52:55], v[36:39], v[56:59]
    buffer_load_dwordx4 v8, s[8:11], s20 offen lds
    v_mfma_f32_16x16x32_bf16 v[60:63], a[48:51], v[40:43], v[60:63]
    ds_read_b128 v[32:35], v13 offset:20480
    v_mfma_f32_16x16x32_bf16 v[64:67], a[52:55], v[40:43], v[64:67]
    s_waitcnt lgkmcnt(4)
    v_mfma_f32_16x16x32_bf16 v[52:55], a[56:59], v[44:47], v[52:55]
    ds_read_b128 v[36:39], v14 offset:16384
    v_mfma_f32_16x16x32_bf16 v[56:59], a[60:63], v[44:47], v[56:59]
    v_mfma_f32_16x16x32_bf16 v[60:63], a[56:59], v[48:51], v[60:63]
    ds_read_b128 v[40:43], v14 offset:20480
    v_mfma_f32_16x16x32_bf16 v[64:67], a[60:63], v[48:51], v[64:67]
    s_waitcnt lgkmcnt(4)
    v_mfma_f32_16x16x32_bf16 v[52:55], a[64:67], v[20:23], v[52:55]
    ds_read_b128 v[44:47], v15 offset:16384
    s_add_u32 m0, s21, 115712
    v_mfma_f32_16x16x32_bf16 v[56:59], a[68:71], v[20:23], v[56:59]
    buffer_load_dwordx4 v9, s[8:11], s20 offen lds
    v_mfma_f32_16x16x32_bf16 v[60:63], a[64:67], v[24:27], v[60:63]
    ds_read_b128 v[48:51], v15 offset:20480
    v_mfma_f32_16x16x32_bf16 v[64:67], a[68:71], v[24:27], v[64:67]
    s_waitcnt lgkmcnt(4)
    v_mfma_f32_16x16x32_bf16 v[52:55], a[72:75], v[28:31], v[52:55]
    ds_read_b128 v[20:23], v12 offset:16640
    v_mfma_f32_16x16x32_bf16 v[56:59], a[76:79], v[28:31], v[56:59]
    v_mfma_f32_16x16x32_bf16 v[60:63], a[72:75], v[32:35], v[60:63]
    ds_read_b128 v[24:27], v12 offset:20736
    s_add_u32 s24, s24, 1
    v_mfma_f32_16x16x32_bf16 v[64:67], a[76:79], v[32:35], v[64:67]
    s_waitcnt lgkmcnt(4)
    v_mfma_f32_16x16x32_bf16 v[52:55], a[80:83], v[36:39], v[52:55]
    ds_read_b128 v[28:31], v13 offset:16640
    s_add_u32 m0, s21, 116736
    v_mfma_f32_16x16x32_bf16 v[56:59], a[84:87], v[36:39], v[56:59]
    buffer_load_dwordx4 v10, s[8:11], s20 offen lds
    v_mfma_f32_16x16x32_bf16 v[60:63], a[80:83], v[40:43], v[60:63]
    ds_read_b128 v[32:35], v13 offset:20736
    v_mfma_f32_16x16x32_bf16 v[64:67], a[84:87], v[40:43], v[64:67]
    s_waitcnt lgkmcnt(4)
    s_min_u32 s24, s24, 63
    v_mfma_f32_16x16x32_bf16 v[52:55], a[88:91], v[44:47], v[52:55]
    ds_read_b128 v[36:39], v14 offset:16640
    v_mfma_f32_16x16x32_bf16 v[56:59], a[92:95], v[44:47], v[56:59]
    v_mfma_f32_16x16x32_bf16 v[60:63], a[88:91], v[48:51], v[60:63]
    ds_read_b128 v[40:43], v14 offset:20736
    s_lshl_b32 s53, s24, 16
    v_mfma_f32_16x16x32_bf16 v[64:67], a[92:95], v[48:51], v[64:67]
    s_waitcnt lgkmcnt(4)
    v_mfma_f32_16x16x32_bf16 v[52:55], a[96:99], v[20:23], v[52:55]
    ds_read_b128 v[44:47], v15 offset:16640
    s_add_u32 m0, s21, 117760
    v_mfma_f32_16x16x32_bf16 v[56:59], a[100:103], v[20:23], v[56:59]
    buffer_load_dwordx4 v11, s[8:11], s20 offen lds
    v_mfma_f32_16x16x32_bf16 v[60:63], a[96:99], v[24:27], v[60:63]
    ds_read_b128 v[48:51], v15 offset:20736
    v_mfma_f32_16x16x32_bf16 v[64:67], a[100:103], v[24:27], v[64:67]
    s_waitcnt lgkmcnt(4)
    v_mfma_f32_16x16x32_bf16 v[52:55], a[104:107], v[28:31], v[52:55]
    s_waitcnt vmcnt(20)
    s_barrier
    ds_read_b128 v[20:23], v12 offset:32768
    v_mfma_f32_16x16x32_bf16 v[56:59], a[108:111], v[28:31], v[56:59]
    s_mov_b32 s20, s53
    v_mfma_f32_16x16x32_bf16 v[60:63], a[104:107], v[32:35], v[60:63]
    ds_read_b128 v[24:27], v12 offset:36864
    v_mfma_f32_16x16x32_bf16 v[64:67], a[108:111], v[32:35], v[64:67]
    s_waitcnt lgkmcnt(4)
    v_mfma_f32_16x16x32_bf16 v[52:55], a[112:115], v[36:39], v[52:55]
    ds_read_b128 v[28:31], v13 offset:32768
    s_add_u32 m0, s21, 0
    v_mfma_f32_16x16x32_bf16 v[56:59], a[116:119], v[36:39], v[56:59]
    buffer_load_dwordx4 v8, s[8:11], s20 offen lds
    v_mfma_f32_16x16x32_bf16 v[60:63], a[112:115], v[40:43], v[60:63]
    ds_read_b128 v[32:35], v13 offset:36864
    v_mfma_f32_16x16x32_bf16 v[64:67], a[116:119], v[40:43], v[64:67]
    s_waitcnt lgkmcnt(4)
    v_mfma_f32_16x16x32_bf16 v[52:55], a[120:123], v[44:47], v[52:55]
    ds_read_b128 v[36:39], v14 offset:32768
    v_mfma_f32_16x16x32_bf16 v[56:59], a[124:127], v[44:47], v[56:59]
    v_mfma_f32_16x16x32_bf16 v[60:63], a[120:123], v[48:51], v[60:63]
    ds_read_b128 v[40:43], v14 offset:36864
    v_mfma_f32_16x16x32_bf16 v[64:67], a[124:127], v[48:51], v[64:67]
    s_waitcnt lgkmcnt(4)
    v_mfma_f32_16x16x32_bf16 v[52:55], a[128:131], v[20:23], v[52:55]
    ds_read_b128 v[44:47], v15 offset:32768
    s_add_u32 m0, s21, 1024
    v_mfma_f32_16x16x32_bf16 v[56:59], a[132:135], v[20:23], v[56:59]
    buffer_load_dwordx4 v9, s[8:11], s20 offen lds
    v_mfma_f32_16x16x32_bf16 v[60:63], a[128:131], v[24:27], v[60:63]
    ds_read_b128 v[48:51], v15 offset:36864
    v_mfma_f32_16x16x32_bf16 v[64:67], a[132:135], v[24:27], v[64:67]
    s_waitcnt lgkmcnt(4)
    v_mfma_f32_16x16x32_bf16 v[52:55], a[136:139], v[28:31], v[52:55]
    ds_read_b128 v[20:23], v12 offset:33024
    v_mfma_f32_16x16x32_bf16 v[56:59], a[140:143], v[28:31], v[56:59]
    v_mfma_f32_16x16x32_bf16 v[60:63], a[136:139], v[32:35], v[60:63]
    ds_read_b128 v[24:27], v12 offset:37120
    v_mfma_f32_16x16x32_bf16 v[64:67], a[140:143], v[32:35], v[64:67]
    s_waitcnt lgkmcnt(4)
    v_mfma_f32_16x16x32_bf16 v[52:55], a[144:147], v[36:39], v[52:55]
    ds_read_b128 v[28:31], v13 offset:33024
    s_add_u32 m0, s21, 2048
    v_mfma_f32_16x16x32_bf16 v[56:59], a[148:151], v[36:39], v[56:59]
    buffer_load_dwordx4 v10, s[8:11], s20 offen lds
    v_mfma_f32_16x16x32_bf16 v[60:63], a[144:147], v[40:43], v[60:63]
    ds_read_b128 v[32:35], v13 offset:37120
    v_mfma_f32_16x16x32_bf16 v[64:67], a[148:151], v[40:43], v[64:67]
    s_waitcnt lgkmcnt(4)
    v_mfma_f32_16x16x32_bf16 v[52:55], a[152:155], v[44:47], v[52:55]
    ds_read_b128 v[36:39], v14 offset:33024
    v_mfma_f32_16x16x32_bf16 v[56:59], a[156:159], v[44:47], v[56:59]
    v_mfma_f32_16x16x32_bf16 v[60:63], a[152:155], v[48:51], v[60:63]
    ds_read_b128 v[40:43], v14 offset:37120
    v_mfma_f32_16x16x32_bf16 v[64:67], a[156:159], v[48:51], v[64:67]
    s_waitcnt lgkmcnt(4)
    v_mfma_f32_16x16x32_bf16 v[52:55], a[160:163], v[20:23], v[52:55]
    ds_read_b128 v[44:47], v15 offset:33024
    s_add_u32 m0, s21, 3072
    v_mfma_f32_16x16x32_bf16 v[56:59], a[164:167], v[20:23], v[56:59]
    buffer_load_dwordx4 v11, s[8:11], s20 offen lds
    v_mfma_f32_16x16x32_bf16 v[60:63], a[160:163], v[24:27], v[60:63]
    ds_read_b128 v[48:51], v15 offset:37120
    v_mfma_f32_16x16x32_bf16 v[64:67], a[164:167], v[24:27], v[64:67]
    s_waitcnt lgkmcnt(4)
    v_mfma_f32_16x16x32_bf16 v[52:55], a[168:171], v[28:31], v[52:55]
    s_waitcnt vmcnt(20)
    s_barrier
    ds_read_b128 v[20:23], v12 offset:49152
    v_mfma_f32_16x16x32_bf16 v[56:59], a[172:175], v[28:31], v[56:59]
    s_add_u32 s20, s20, 512
    v_mfma_f32_16x16x32_bf16 v[60:63], a[168:171], v[32:35], v[60:63]
    ds_read_b128 v[24:27], v12 offset:53248
    v_mfma_f32_16x16x32_bf16 v[64:67], a[172:175], v[32:35], v[64:67]
    s_waitcnt lgkmcnt(4)
    v_mfma_f32_16x16x32_bf16 v[52:55], a[176:179], v[36:39], v[52:55]
    ds_read_b128 v[28:31], v13 offset:49152
    s_add_u32 m0, s21, 16384
    v_mfma_f32_16x16x32_bf16 v[56:59], a[180:183], v[36:39], v[56:59]
    buffer_load_dwordx4 v8, s[8:11], s20 offen lds
    v_mfma_f32_16x16x32_bf16 v[60:63], a[176:179], v[40:43], v[60:63]
    ds_read_b128 v[32:35], v13 offset:53248
    v_mfma_f32_16x16x32_bf16 v[64:67], a[180:183], v[40:43], v[64:67]
    s_waitcnt lgkmcnt(4)
    v_mfma_f32_16x16x32_bf16 v[52:55], a[184:187], v[44:47], v[52:55]
    ds_read_b128 v[36:39], v14 offset:49152
    v_mfma_f32_16x16x32_bf16 v[56:59], a[188:191], v[44:47], v[56:59]
    v_mfma_f32_16x16x32_bf16 v[60:63], a[184:187], v[48:51], v[60:63]
    ds_read_b128 v[40:43], v14 offset:53248
    v_mfma_f32_16x16x32_bf16 v[64:67], a[188:191], v[48:51], v[64:67]
    s_waitcnt lgkmcnt(4)
    v_mfma_f32_16x16x32_bf16 v[52:55], a[192:195], v[20:23], v[52:55]
    ds_read_b128 v[44:47], v15 offset:49152
    s_add_u32 m0, s21, 17408
    v_mfma_f32_16x16x32_bf16 v[56:59], a[196:199], v[20:23], v[56:59]
    buffer_load_dwordx4 v9, s[8:11], s20 offen lds
    v_mfma_f32_16x16x32_bf16 v[60:63], a[192:195], v[24:27], v[60:63]
    ds_read_b128 v[48:51], v15 offset:53248
    v_mfma_f32_16x16x32_bf16 v[64:67], a[196:199], v[24:27], v[64:67]
    s_waitcnt lgkmcnt(4)
    v_mfma_f32_16x16x32_bf16 v[52:55], a[200:203], v[28:31], v[52:55]
    ds_read_b128 v[20:23], v12 offset:49408
    v_mfma_f32_16x16x32_bf16 v[56:59], a[204:207], v[28:31], v[56:59]
    v_mfma_f32_16x16x32_bf16 v[60:63], a[200:203], v[32:35], v[60:63]
    ds_read_b128 v[24:27], v12 offset:53504
    v_mfma_f32_16x16x32_bf16 v[64:67], a[204:207], v[32:35], v[64:67]
    s_waitcnt lgkmcnt(4)
    v_mfma_f32_16x16x32_bf16 v[52:55], a[208:211], v[36:39], v[52:55]
    ds_read_b128 v[28:31], v13 offset:49408
    s_add_u32 m0, s21, 18432
    v_mfma_f32_16x16x32_bf16 v[56:59], a[212:215], v[36:39], v[56:59]
    buffer_load_dwordx4 v10, s[8:11], s20 offen lds
    v_mfma_f32_16x16x32_bf16 v[60:63], a[208:211], v[40:43], v[60:63]
    ds_read_b128 v[32:35], v13 offset:53504
    v_mfma_f32_16x16x32_bf16 v[64:67], a[212:215], v[40:43], v[64:67]
    s_waitcnt lgkmcnt(4)
    v_mfma_f32_16x16x32_bf16 v[52:55], a[216:219], v[44:47], v[52:55]
    ds_read_b128 v[36:39], v14 offset:49408
    v_mfma_f32_16x16x32_bf16 v[56:59], a[220:223], v[44:47], v[56:59]
    v_mfma_f32_16x16x32_bf16 v[60:63], a[216:219], v[48:51], v[60:63]
    ds_read_b128 v[40:43], v14 offset:53504
    v_mfma_f32_16x16x32_bf16 v[64:67], a[220:223], v[48:51], v[64:67]
    s_waitcnt lgkmcnt(4)
    v_mfma_f32_16x16x32_bf16 v[52:55], a[224:227], v[20:23], v[52:55]
    ds_read_b128 v[44:47], v15 offset:49408
    s_add_u32 m0, s21, 19456
    v_mfma_f32_16x16x32_bf16 v[56:59], a[228:231], v[20:23], v[56:59]
    buffer_load_dwordx4 v11, s[8:11], s20 offen lds
    v_mfma_f32_16x16x32_bf16 v[60:63], a[224:227], v[24:27], v[60:63]
    ds_read_b128 v[48:51], v15 offset:53504
    v_mfma_f32_16x16x32_bf16 v[64:67], a[228:231], v[24:27], v[64:67]
    s_waitcnt lgkmcnt(4)
    v_mfma_f32_16x16x32_bf16 v[52:55], a[232:235], v[28:31], v[52:55]
    s_waitcnt vmcnt(20)
    s_barrier
    ds_read_b128 v[20:23], v16 offset:0
    v_mfma_f32_16x16x32_bf16 v[56:59], a[236:239], v[28:31], v[56:59]
    s_add_u32 s20, s20, 512
    v_mfma_f32_16x16x32_bf16 v[60:63], a[232:235], v[32:35], v[60:63]
    ds_read_b128 v[24:27], v16 offset:4096
    v_mfma_f32_16x16x32_bf16 v[64:67], a[236:239], v[32:35], v[64:67]
    s_waitcnt lgkmcnt(4)
    v_mfma_f32_16x16x32_bf16 v[52:55], a[240:243], v[36:39], v[52:55]
    ds_read_b128 v[28:31], v17 offset:0
    s_add_u32 m0, s21, 32768
    v_mfma_f32_16x16x32_bf16 v[56:59], a[244:247], v[36:39], v[56:59]
    buffer_load_dwordx4 v8, s[8:11], s20 offen lds
    v_mfma_f32_16x16x32_bf16 v[60:63], a[240:243], v[40:43], v[60:63]
    ds_read_b128 v[32:35], v17 offset:4096
    v_mfma_f32_16x16x32_bf16 v[64:67], a[244:247], v[40:43], v[64:67]
    s_waitcnt lgkmcnt(4)
    v_mfma_f32_16x16x32_bf16 v[52:55], a[248:251], v[44:47], v[52:55]
    ds_read_b128 v[36:39], v18 offset:0
    v_mfma_f32_16x16x32_bf16 v[56:59], a[252:255], v[44:47], v[56:59]
    v_mfma_f32_16x16x32_bf16 v[60:63], a[248:251], v[48:51], v[60:63]
    ds_read_b128 v[40:43], v18 offset:4096
    v_mfma_f32_16x16x32_bf16 v[64:67], a[252:255], v[48:51], v[64:67]
    s_waitcnt lgkmcnt(4)
    s_add_u32 s22, s22, 1
    s_cmp_ge_u32 s22, s23
    s_cbranch_scc1 L_fl0_218
    v_mfma_f32_16x16x32_bf16 v[68:71], a[0:3], v[20:23], 0
    ds_read_b128 v[44:47], v19 offset:0
    s_add_u32 m0, s21, 33792
    v_mfma_f32_16x16x32_bf16 v[72:75], a[4:7], v[20:23], 0
    buffer_load_dwordx4 v9, s[8:11], s20 offen lds
    s_sub_u32 s39, s22, 1
    v_mfma_f32_16x16x32_bf16 v[76:79], a[0:3], v[24:27], 0
    ds_read_b128 v[48:51], v19 offset:4096
    s_and_b32 s39, s39, 3
    v_mfma_f32_16x16x32_bf16 v[80:83], a[4:7], v[24:27], 0
    s_waitcnt lgkmcnt(4)
    s_lshl_b32 s39, s39, 13
    v_mfma_f32_16x16x32_bf16 v[68:71], a[8:11], v[28:31], v[68:71]
    ds_read_b128 v[20:23], v16 offset:256
    v_add_u32 v87, s39, v86
    v_mfma_f32_16x16x32_bf16 v[72:75], a[12:15], v[28:31], v[72:75]
    s_nop 0
    v_mfma_f32_16x16x32_bf16 v[76:79], a[8:11], v[32:35], v[76:79]
    ds_read_b128 v[24:27], v16 offset:4352
    s_nop 0
    v_cvt_pk_bf16_f32 v88, v52, v53
    v_mfma_f32_16x16x32_bf16 v[80:83], a[12:15], v[32:35], v[80:83]
    s_waitcnt lgkmcnt(4)
    v_cvt_pk_bf16_f32 v89, v54, v55
    v_mfma_f32_16x16x32_bf16 v[68:71], a[16:19], v[36:39], v[68:71]
    ds_read_b128 v[28:31], v17 offset:256
    s_add_u32 m0, s21, 34816
    v_mfma_f32_16x16x32_bf16 v[72:75], a[20:23], v[36:39], v[72:75]
    buffer_load_dwordx4 v10, s[8:11], s20 offen lds
    v_cvt_pk_bf16_f32 v90, v56, v57
    v_mfma_f32_16x16x32_bf16 v[76:79], a[16:19], v[40:43], v[76:79]
    ds_read_b128 v[32:35], v17 offset:4352
    v_cvt_pk_bf16_f32 v91, v58, v59
    v_mfma_f32_16x16x32_bf16 v[80:83], a[20:23], v[40:43], v[80:83]
    s_waitcnt lgkmcnt(4)
    ds_write_b128 v87, v[88:91] offset:0
    v_mfma_f32_16x16x32_bf16 v[68:71], a[24:27], v[44:47], v[68:71]
    ds_read_b128 v[36:39], v18 offset:256
    v_cvt_pk_bf16_f32 v92, v60, v61
    v_mfma_f32_16x16x32_bf16 v[72:75], a[28:31], v[44:47], v[72:75]
    v_cvt_pk_bf16_f32 v93, v62, v63
    v_mfma_f32_16x16x32_bf16 v[76:79], a[24:27], v[48:51], v[76:79]
    ds_read_b128 v[40:43], v18 offset:4352
    v_cvt_pk_bf16_f32 v94, v64, v65
    v_mfma_f32_16x16x32_bf16 v[80:83], a[28:31], v[48:51], v[80:83]
    s_waitcnt lgkmcnt(4)
    v_cvt_pk_bf16_f32 v95, v66, v67
    v_mfma_f32_16x16x32_bf16 v[68:71], a[32:35], v[20:23], v[68:71]
    ds_read_b128 v[44:47], v19 offset:256
    s_add_u32 m0, s21, 35840
    ds_write_b128 v87, v[92:95] offset:128
    v_mfma_f32_16x16x32_bf16 v[72:75], a[36:39], v[20:23], v[72:75]
    buffer_load_dwordx4 v11, s[8:11], s20 offen lds
    v_mfma_f32_16x16x32_bf16 v[76:79], a[32:35], v[24:27], v[76:79]
    ds_read_b128 v[48:51], v19 offset:4352
    v_mfma_f32_16x16x32_bf16 v[80:83], a[36:39], v[24:27], v[80:83]
    s_waitcnt lgkmcnt(4)
    v_mfma_f32_16x16x32_bf16 v[68:71], a[40:43], v[28:31], v[68:71]
    s_waitcnt vmcnt(20)
    s_barrier
    ds_read_b128 v[20:23], v16 offset:16384
    v_mfma_f32_16x16x32_bf16 v[72:75], a[44:47], v[28:31], v[72:75]
    s_add_u32 s20, s20, 512
    v_mfma_f32_16x16x32_bf16 v[76:79], a[40:43], v[32:35], v[76:79]
    ds_read_b128 v[24:27], v16 offset:20480
    v_mfma_f32_16x16x32_bf16 v[80:83], a[44:47], v[32:35], v[80:83]
    s_waitcnt lgkmcnt(4)
    v_mfma_f32_16x16x32_bf16 v[68:71], a[48:51], v[36:39], v[68:71]
    ds_read_b128 v[28:31], v17 offset:16384
    s_add_u32 m0, s21, 49152
    v_mfma_f32_16x16x32_bf16 v[72:75], a[52:55], v[36:39], v[72:75]
    buffer_load_dwordx4 v8, s[8:11], s20 offen lds
    v_mfma_f32_16x16x32_bf16 v[76:79], a[48:51], v[40:43], v[76:79]
    ds_read_b128 v[32:35], v17 offset:20480
    v_mfma_f32_16x16x32_bf16 v[80:83], a[52:55], v[40:43], v[80:83]
    s_waitcnt lgkmcnt(4)
    v_mfma_f32_16x16x32_bf16 v[68:71], a[56:59], v[44:47], v[68:71]
    ds_read_b128 v[36:39], v18 offset:16384
    v_mfma_f32_16x16x32_bf16 v[72:75], a[60:63], v[44:47], v[72:75]
    v_mfma_f32_16x16x32_bf16 v[76:79], a[56:59], v[48:51], v[76:79]
    ds_read_b128 v[40:43], v18 offset:20480
    v_mfma_f32_16x16x32_bf16 v[80:83], a[60:63], v[48:51], v[80:83]
    s_waitcnt lgkmcnt(4)
    v_mfma_f32_16x16x32_bf16 v[68:71], a[64:67], v[20:23], v[68:71]
    ds_read_b128 v[44:47], v19 offset:16384
    s_add_u32 m0, s21, 50176
    v_mfma_f32_16x16x32_bf16 v[72:75], a[68:71], v[20:23], v[72:75]
    buffer_load_dwordx4 v9, s[8:11], s20 offen lds
    v_mfma_f32_16x16x32_bf16 v[76:79], a[64:67], v[24:27], v[76:79]
    ds_read_b128 v[48:51], v19 offset:20480
    v_mfma_f32_16x16x32_bf16 v[80:83], a[68:71], v[24:27], v[80:83]
    s_waitcnt lgkmcnt(4)
    v_mfma_f32_16x16x32_bf16 v[68:71], a[72:75], v[28:31], v[68:71]
    ds_read_b128 v[20:23], v16 offset:16640
    v_mfma_f32_16x16x32_bf16 v[72:75], a[76:79], v[28:31], v[72:75]
    v_mfma_f32_16x16x32_bf16 v[76:79], a[72:75], v[32:35], v[76:79]
    ds_read_b128 v[24:27], v16 offset:20736
    s_add_u32 s24, s24, 1
    v_mfma_f32_16x16x32_bf16 v[80:83], a[76:79], v[32:35], v[80:83]
    s_waitcnt lgkmcnt(4)
    v_mfma_f32_16x16x32_bf16 v[68:71], a[80:83], v[36:39], v[68:71]
    ds_read_b128 v[28:31], v17 offset:16640
    s_add_u32 m0, s21, 51200
    v_mfma_f32_16x16x32_bf16 v[72:75], a[84:87], v[36:39], v[72:75]
    buffer_load_dwordx4 v10, s[8:11], s20 offen lds
    v_mfma_f32_16x16x32_bf16 v[76:79], a[80:83], v[40:43], v[76:79]
    ds_read_b128 v[32:35], v17 offset:20736
    v_mfma_f32_16x16x32_bf16 v[80:83], a[84:87], v[40:43], v[80:83]
    s_waitcnt lgkmcnt(4)
    s_min_u32 s24, s24, 63
    v_mfma_f32_16x16x32_bf16 v[68:71], a[88:91], v[44:47], v[68:71]
    ds_read_b128 v[36:39], v18 offset:16640
    v_mfma_f32_16x16x32_bf16 v[72:75], a[92:95], v[44:47], v[72:75]
    v_mfma_f32_16x16x32_bf16 v[76:79], a[88:91], v[48:51], v[76:79]
    ds_read_b128 v[40:43], v18 offset:20736
    s_lshl_b32 s53, s24, 16
    v_mfma_f32_16x16x32_bf16 v[80:83], a[92:95], v[48:51], v[80:83]
    s_waitcnt lgkmcnt(4)
    v_mfma_f32_16x16x32_bf16 v[68:71], a[96:99], v[20:23], v[68:71]
    ds_read_b128 v[44:47], v19 offset:16640
    s_add_u32 m0, s21, 52224
    v_mfma_f32_16x16x32_bf16 v[72:75], a[100:103], v[20:23], v[72:75]
    buffer_load_dwordx4 v11, s[8:11], s20 offen lds
    v_mfma_f32_16x16x32_bf16 v[76:79], a[96:99], v[24:27], v[76:79]
    ds_read_b128 v[48:51], v19 offset:20736
    v_mfma_f32_16x16x32_bf16 v[80:83], a[100:103], v[24:27], v[80:83]
    s_waitcnt lgkmcnt(4)
    v_mfma_f32_16x16x32_bf16 v[68:71], a[104:107], v[28:31], v[68:71]
    s_waitcnt vmcnt(20)
    s_barrier
    ds_read_b128 v[20:23], v16 offset:32768
    v_mfma_f32_16x16x32_bf16 v[72:75], a[108:111], v[28:31], v[72:75]
    s_mov_b32 s20, s53
    v_mfma_f32_16x16x32_bf16 v[76:79], a[104:107], v[32:35], v[76:79]
    ds_read_b128 v[24:27], v16 offset:36864
    v_mfma_f32_16x16x32_bf16 v[80:83], a[108:111], v[32:35], v[80:83]
    s_waitcnt lgkmcnt(4)
    v_mfma_f32_16x16x32_bf16 v[68:71], a[112:115], v[36:39], v[68:71]
    ds_read_b128 v[28:31], v17 offset:32768
    s_add_u32 m0, s21, 65536
    v_mfma_f32_16x16x32_bf16 v[72:75], a[116:119], v[36:39], v[72:75]
    buffer_load_dwordx4 v8, s[8:11], s20 offen lds
    v_mfma_f32_16x16x32_bf16 v[76:79], a[112:115], v[40:43], v[76:79]
    ds_read_b128 v[32:35], v17 offset:36864
    v_mfma_f32_16x16x32_bf16 v[80:83], a[116:119], v[40:43], v[80:83]
    s_waitcnt lgkmcnt(4)
    v_mfma_f32_16x16x32_bf16 v[68:71], a[120:123], v[44:47], v[68:71]
    ds_read_b128 v[36:39], v18 offset:32768
    v_mfma_f32_16x16x32_bf16 v[72:75], a[124:127], v[44:47], v[72:75]
    v_mfma_f32_16x16x32_bf16 v[76:79], a[120:123], v[48:51], v[76:79]
    ds_read_b128 v[40:43], v18 offset:36864
    v_mfma_f32_16x16x32_bf16 v[80:83], a[124:127], v[48:51], v[80:83]
    s_waitcnt lgkmcnt(4)
    v_mfma_f32_16x16x32_bf16 v[68:71], a[128:131], v[20:23], v[68:71]
    ds_read_b128 v[44:47], v19 offset:32768
    s_add_u32 m0, s21, 66560
    v_mfma_f32_16x16x32_bf16 v[72:75], a[132:135], v[20:23], v[72:75]
    buffer_load_dwordx4 v9, s[8:11], s20 offen lds
    v_mfma_f32_16x16x32_bf16 v[76:79], a[128:131], v[24:27], v[76:79]
    ds_read_b128 v[48:51], v19 offset:36864
    v_mfma_f32_16x16x32_bf16 v[80:83], a[132:135], v[24:27], v[80:83]
    s_waitcnt lgkmcnt(4)
    v_mfma_f32_16x16x32_bf16 v[68:71], a[136:139], v[28:31], v[68:71]
    ds_read_b128 v[20:23], v16 offset:33024
    v_mfma_f32_16x16x32_bf16 v[72:75], a[140:143], v[28:31], v[72:75]
    v_mfma_f32_16x16x32_bf16 v[76:79], a[136:139], v[32:35], v[76:79]
    ds_read_b128 v[24:27], v16 offset:37120
    v_mfma_f32_16x16x32_bf16 v[80:83], a[140:143], v[32:35], v[80:83]
    s_waitcnt lgkmcnt(4)
    v_mfma_f32_16x16x32_bf16 v[68:71], a[144:147], v[36:39], v[68:71]
    ds_read_b128 v[28:31], v17 offset:33024
    s_add_u32 m0, s21, 67584
    v_mfma_f32_16x16x32_bf16 v[72:75], a[148:151], v[36:39], v[72:75]
    buffer_load_dwordx4 v10, s[8:11], s20 offen lds
    v_mfma_f32_16x16x32_bf16 v[76:79], a[144:147], v[40:43], v[76:79]
    ds_read_b128 v[32:35], v17 offset:37120
    v_mfma_f32_16x16x32_bf16 v[80:83], a[148:151], v[40:43], v[80:83]
    s_waitcnt lgkmcnt(4)
    v_mfma_f32_16x16x32_bf16 v[68:71], a[152:155], v[44:47], v[68:71]
    ds_read_b128 v[36:39], v18 offset:33024
    v_mfma_f32_16x16x32_bf16 v[72:75], a[156:159], v[44:47], v[72:75]
    v_mfma_f32_16x16x32_bf16 v[76:79], a[152:155], v[48:51], v[76:79]
    ds_read_b128 v[40:43], v18 offset:37120
    v_mfma_f32_16x16x32_bf16 v[80:83], a[156:159], v[48:51], v[80:83]
    s_waitcnt lgkmcnt(4)
    v_mfma_f32_16x16x32_bf16 v[68:71], a[160:163], v[20:23], v[68:71]
    ds_read_b128 v[44:47], v19 offset:33024
    s_add_u32 m0, s21, 68608
    v_mfma_f32_16x16x32_bf16 v[72:75], a[164:167], v[20:23], v[72:75]
    buffer_load_dwordx4 v11, s[8:11], s20 offen lds
    v_mfma_f32_16x16x32_bf16 v[76:79], a[160:163], v[24:27], v[76:79]
    ds_read_b128 v[48:51], v19 offset:37120
    v_mfma_f32_16x16x32_bf16 v[80:83], a[164:167], v[24:27], v[80:83]
    s_waitcnt lgkmcnt(4)
    v_mfma_f32_16x16x32_bf16 v[68:71], a[168:171], v[28:31], v[68:71]
    s_waitcnt vmcnt(20)
    s_barrier
    ds_read_b128 v[20:23], v16 offset:49152
    v_mfma_f32_16x16x32_bf16 v[72:75], a[172:175], v[28:31], v[72:75]
    s_add_u32 s20, s20, 512
    v_mfma_f32_16x16x32_bf16 v[76:79], a[168:171], v[32:35], v[76:79]
    ds_read_b128 v[24:27], v16 offset:53248
    v_mfma_f32_16x16x32_bf16 v[80:83], a[172:175], v[32:35], v[80:83]
    s_waitcnt lgkmcnt(4)
    v_mfma_f32_16x16x32_bf16 v[68:71], a[176:179], v[36:39], v[68:71]
    ds_read_b128 v[28:31], v17 offset:49152
    s_add_u32 m0, s21, 81920
    v_mfma_f32_16x16x32_bf16 v[72:75], a[180:183], v[36:39], v[72:75]
    buffer_load_dwordx4 v8, s[8:11], s20 offen lds
    v_mfma_f32_16x16x32_bf16 v[76:79], a[176:179], v[40:43], v[76:79]
    ds_read_b128 v[32:35], v17 offset:53248
    v_mfma_f32_16x16x32_bf16 v[80:83], a[180:183], v[40:43], v[80:83]
    s_waitcnt lgkmcnt(4)
    v_mfma_f32_16x16x32_bf16 v[68:71], a[184:187], v[44:47], v[68:71]
    ds_read_b128 v[36:39], v18 offset:49152
    v_mfma_f32_16x16x32_bf16 v[72:75], a[188:191], v[44:47], v[72:75]
    v_mfma_f32_16x16x32_bf16 v[76:79], a[184:187], v[48:51], v[76:79]
    ds_read_b128 v[40:43], v18 offset:53248
    v_mfma_f32_16x16x32_bf16 v[80:83], a[188:191], v[48:51], v[80:83]
    s_waitcnt lgkmcnt(4)
    v_mfma_f32_16x16x32_bf16 v[68:71], a[192:195], v[20:23], v[68:71]
    ds_read_b128 v[44:47], v19 offset:49152
    s_add_u32 m0, s21, 82944
    v_mfma_f32_16x16x32_bf16 v[72:75], a[196:199], v[20:23], v[72:75]
    buffer_load_dwordx4 v9, s[8:11], s20 offen lds
    v_mfma_f32_16x16x32_bf16 v[76:79], a[192:195], v[24:27], v[76:79]
    ds_read_b128 v[48:51], v19 offset:53248
    v_mfma_f32_16x16x32_bf16 v[80:83], a[196:199], v[24:27], v[80:83]
    s_waitcnt lgkmcnt(4)
    v_mfma_f32_16x16x32_bf16 v[68:71], a[200:203], v[28:31], v[68:71]
    ds_read_b128 v[20:23], v16 offset:49408
    v_mfma_f32_16x16x32_bf16 v[72:75], a[204:207], v[28:31], v[72:75]
    v_mfma_f32_16x16x32_bf16 v[76:79], a[200:203], v[32:35], v[76:79]
    ds_read_b128 v[24:27], v16 offset:53504
    v_mfma_f32_16x16x32_bf16 v[80:83], a[204:207], v[32:35], v[80:83]
    s_waitcnt lgkmcnt(4)
    v_mfma_f32_16x16x32_bf16 v[68:71], a[208:211], v[36:39], v[68:71]
    ds_read_b128 v[28:31], v17 offset:49408
    s_add_u32 m0, s21, 83968
    v_mfma_f32_16x16x32_bf16 v[72:75], a[212:215], v[36:39], v[72:75]
    buffer_load_dwordx4 v10, s[8:11], s20 offen lds
    v_mfma_f32_16x16x32_bf16 v[76:79], a[208:211], v[40:43], v[76:79]
    ds_read_b128 v[32:35], v17 offset:53504
    v_mfma_f32_16x16x32_bf16 v[80:83], a[212:215], v[40:43], v[80:83]
    s_waitcnt lgkmcnt(4)
    v_mfma_f32_16x16x32_bf16 v[68:71], a[216:219], v[44:47], v[68:71]
    ds_read_b128 v[36:39], v18 offset:49408
    v_mfma_f32_16x16x32_bf16 v[72:75], a[220:223], v[44:47], v[72:75]
    v_mfma_f32_16x16x32_bf16 v[76:79], a[216:219], v[48:51], v[76:79]
    ds_read_b128 v[40:43], v18 offset:53504
    v_mfma_f32_16x16x32_bf16 v[80:83], a[220:223], v[48:51], v[80:83]
    s_waitcnt lgkmcnt(4)
    v_mfma_f32_16x16x32_bf16 v[68:71], a[224:227], v[20:23], v[68:71]
    ds_read_b128 v[44:47], v19 offset:49408
    s_add_u32 m0, s21, 84992
    v_mfma_f32_16x16x32_bf16 v[72:75], a[228:231], v[20:23], v[72:75]
    buffer_load_dwordx4 v11, s[8:11], s20 offen lds
    v_mfma_f32_16x16x32_bf16 v[76:79], a[224:227], v[24:27], v[76:79]
    ds_read_b128 v[48:51], v19 offset:53504
    v_mfma_f32_16x16x32_bf16 v[80:83], a[228:231], v[24:27], v[80:83]
    s_waitcnt lgkmcnt(4)
    v_mfma_f32_16x16x32_bf16 v[68:71], a[232:235], v[28:31], v[68:71]
    s_waitcnt vmcnt(20)
    s_barrier
    ds_read_b128 v[20:23], v12 offset:0
    v_mfma_f32_16x16x32_bf16 v[72:75], a[236:239], v[28:31], v[72:75]
    s_add_u32 s20, s20, 512
    v_mfma_f32_16x16x32_bf16 v[76:79], a[232:235], v[32:35], v[76:79]
    ds_read_b128 v[24:27], v12 offset:4096
    v_mfma_f32_16x16x32_bf16 v[80:83], a[236:239], v[32:35], v[80:83]
    s_waitcnt lgkmcnt(4)
    v_mfma_f32_16x16x32_bf16 v[68:71], a[240:243], v[36:39], v[68:71]
    ds_read_b128 v[28:31], v13 offset:0
    s_add_u32 m0, s21, 98304
    v_mfma_f32_16x16x32_bf16 v[72:75], a[244:247], v[36:39], v[72:75]
    buffer_load_dwordx4 v8, s[8:11], s20 offen lds
    v_mfma_f32_16x16x32_bf16 v[76:79], a[240:243], v[40:43], v[76:79]
    ds_read_b128 v[32:35], v13 offset:4096
    v_mfma_f32_16x16x32_bf16 v[80:83], a[244:247], v[40:43], v[80:83]
    s_waitcnt lgkmcnt(4)
    v_mfma_f32_16x16x32_bf16 v[68:71], a[248:251], v[44:47], v[68:71]
    ds_read_b128 v[36:39], v14 offset:0
    v_mfma_f32_16x16x32_bf16 v[72:75], a[252:255], v[44:47], v[72:75]
    v_mfma_f32_16x16x32_bf16 v[76:79], a[248:251], v[48:51], v[76:79]
    ds_read_b128 v[40:43], v14 offset:4096
    v_mfma_f32_16x16x32_bf16 v[80:83], a[252:255], v[48:51], v[80:83]
    s_waitcnt lgkmcnt(4)
    s_add_u32 s22, s22, 1
    s_cmp_ge_u32 s22, s23
    s_cbranch_scc0 L_st_217
    s_waitcnt lgkmcnt(0)
    s_nop 7
    s_sub_u32 s39, s22, 1
    s_and_b32 s39, s39, 3
    s_lshl_b32 s39, s39, 13
    v_add_u32 v87, s39, v86
    s_nop 0
    s_nop 0
    v_cvt_pk_bf16_f32 v88, v68, v69
    v_cvt_pk_bf16_f32 v89, v70, v71
    v_cvt_pk_bf16_f32 v90, v72, v73
    v_cvt_pk_bf16_f32 v91, v74, v75
    ds_write_b128 v87, v[88:91] offset:0
    v_cvt_pk_bf16_f32 v92, v76, v77
    v_cvt_pk_bf16_f32 v93, v78, v79
    v_cvt_pk_bf16_f32 v94, v80, v81
    v_cvt_pk_bf16_f32 v95, v82, v83
    ds_write_b128 v87, v[92:95] offset:128
L_att_214:
    s_waitcnt lgkmcnt(0)
    s_barrier
    ds_read_b128 v[136:139], v101 offset:0
    ds_read_b128 v[140:143], v101 offset:1024
    ds_read_b128 v[144:147], v101 offset:2048
    ds_read_b128 v[148:151], v101 offset:3072
    ds_read_b128 v[152:155], v101 offset:4096
    ds_read_b128 v[156:159], v101 offset:5120
    ds_read_b128 v[160:163], v101 offset:6144
    ds_read_b128 v[164:167], v101 offset:7168
    s_add_u32 s38, s22, s49
    s_sub_u32 s38, s38, 4
    s_lshl_b32 s25, s38, 7
    s_add_u32 s25, s25, 0x5900000
    v_mov_b32 v2, 0
L_pl_220:
    buffer_load_dword v1, v2, s[12:15], s25 offen sc1
    s_add_u32 s36, s36, 1
    s_cmp_gt_u32 s36, 0x100000
    s_cbranch_scc1 chain_kernel_wend
    s_waitcnt vmcnt(0)
    v_readfirstlane_b32 s26, v1
    s_cmp_ge_u32 s26, 64
    s_cbranch_scc1 L_plok_221
    s_sleep 4
    s_branch L_pl_220
L_plok_221:
    s_lshl_b32 s25, s38, 20
    s_lshl_b32 s26, s46, 15
    s_add_u32 s25, s25, s26
    s_bitcmp1_b32 s38, 1
    s_cselect_b32 s39, s55, s54
    s_cselect_b32 s42, s54, s55
    s_add_u32 s39, s39, s25
    s_add_u32 s42, s42, s25
    s_add_u32 s43, s39, 0
    buffer_load_dwordx4 v[104:107], v96, s[12:15], s43 offen offset:0
    buffer_load_dwordx4 v[108:111], v96, s[12:15], s43 offen offset:1024
    s_add_u32 s43, s39, 4096
    buffer_load_dwordx4 v[112:115], v96, s[12:15], s43 offen offset:0
    buffer_load_dwordx4 v[116:119], v96, s[12:15], s43 offen offset:1024
    s_add_u32 s43, s39, 16384
    buffer_load_dwordx4 v[120:123], v96, s[12:15], s43 offen offset:0
    buffer_load_dwordx4 v[124:127], v96, s[12:15], s43 offen offset:1024
    s_add_u32 s43, s39, 20480
    buffer_load_dwordx4 v[128:131], v96, s[12:15], s43 offen offset:0
    buffer_load_dwordx4 v[132:135], v96, s[12:15], s43 offen offset:1024
    s_add_u32 s43, s39, 0
    buffer_load_dwordx4 v[168:171], v98, s[12:15], s43 offen offset:2048
    buffer_load_dwordx4 v[172:175], v98, s[12:15], s43 offen offset:3072
    s_add_u32 s43, s39, 4096
    buffer_load_dwordx4 v[176:179], v98, s[12:15], s43 offen offset:2048
    buffer_load_dwordx4 v[180:183], v98, s[12:15], s43 offen offset:3072
    s_add_u32 s43, s39, 16384
    buffer_load_dwordx4 v[184:187], v98, s[12:15], s43 offen offset:2048
    buffer_load_dwordx4 v[188:191], v98, s[12:15], s43 offen offset:3072
    s_add_u32 s43, s39, 20480
    buffer_load_dwordx4 v[192:195], v98, s[12:15], s43 offen offset:2048
    buffer_load_dwordx4 v[196:199], v98, s[12:15], s43 offen offset:3072
    s_waitcnt lgkmcnt(0)
    s_waitcnt vmcnt(15)
    v_mfma_f32_32x32x16_bf16 v[200:215], v[104:107], v[136:139], 0
    s_waitcnt vmcnt(14)
    v_mfma_f32_32x32x16_bf16 v[200:215], v[108:111], v[140:143], v[200:215]
    s_waitcnt vmcnt(13)
    v_mfma_f32_32x32x16_bf16 v[200:215], v[112:115], v[144:147], v[200:215]
    s_waitcnt vmcnt(12)
    v_mfma_f32_32x32x16_bf16 v[200:215], v[116:119], v[148:151], v[200:215]
    s_waitcnt vmcnt(11)
    v_mfma_f32_32x32x16_bf16 v[200:215], v[120:123], v[152:155], v[200:215]
    s_waitcnt vmcnt(10)
    v_mfma_f32_32x32x16_bf16 v[200:215], v[124:127], v[156:159], v[200:215]
    s_waitcnt vmcnt(9)
    v_mfma_f32_32x32x16_bf16 v[200:215], v[128:131], v[160:163], v[200:215]
    s_waitcnt vmcnt(8)
    v_mfma_f32_32x32x16_bf16 v[200:215], v[132:135], v[164:167], v[200:215]
    s_lshr_b32 s25, s46, 3
    s_lshl_b32 s25, s25, 2
    s_add_u32 s25, s25, 32
    v_mov_b32 v2, s25
    v_writelane_b32 v2, 4, 0
L_cw_222:
    buffer_load_dword v1, v2, s[32:35], 0 offen sc1
    s_add_u32 s36, s36, 1
    s_cmp_gt_u32 s36, 0x100000
    s_cbranch_scc1 chain_kernel_wend
    s_waitcnt vmcnt(0)
    v_readlane_b32 s25, v1, 0
    v_readlane_b32 s26, v1, 1
    s_cmp_gt_u32 s25, s38
    s_cbranch_scc1 L_cwok_223
    s_cmp_ge_u32 s26, 32
    s_cbranch_scc1 L_cwok_223
    s_sleep 4
    s_branch L_cw_222
L_cwok_223:
    s_add_u32 s43, s39, 0x8000000
    buffer_load_dwordx4 v[104:107], v97, s[12:15], s43 offen offset:3072
    buffer_load_dwordx4 v[108:111], v97, s[12:15], s43 offen offset:3328
    s_add_u32 s43, s39, 0x8001000
    buffer_load_dwordx4 v[112:115], v97, s[12:15], s43 offen offset:3072
    buffer_load_dwordx4 v[116:119], v97, s[12:15], s43 offen offset:3328
    s_add_u32 s43, s39, 0x8004000
    buffer_load_dwordx4 v[120:123], v97, s[12:15], s43 offen offset:3072
    buffer_load_dwordx4 v[124:127], v97, s[12:15], s43 offen offset:3328
    s_add_u32 s43, s39, 0x8005000
    buffer_load_dwordx4 v[128:131], v97, s[12:15], s43 offen offset:3072
    buffer_load_dwordx4 v[132:135], v97, s[12:15], s43 offen offset:3328
    s_add_u32 s43, s39, 0x8000000
    buffer_load_dwordx2 v[216:217], v99, s[12:15], s43 offen offset:3584
    s_add_u32 s43, s39, 0x8001000
    buffer_load_dwordx2 v[218:219], v99, s[12:15], s43 offen offset:3584
    s_add_u32 s43, s39, 0x8004000
    buffer_load_dwordx2 v[220:221], v99, s[12:15], s43 offen offset:3584
    s_add_u32 s43, s39, 0x8005000
    buffer_load_dwordx2 v[222:223], v99, s[12:15], s43 offen offset:3584
    s_mov_b32 s28, 0x3fb8aa3b
    s_mov_b32 s29, 0x3db504f3
    v_cvt_pk_bf16_f32 v200, 0, v200
    v_cvt_pk_bf16_f32 v201, 0, v201
    v_cvt_pk_bf16_f32 v202, 0, v202
    v_cvt_pk_bf16_f32 v203, 0, v203
    v_cvt_pk_bf16_f32 v204, 0, v204
    v_cvt_pk_bf16_f32 v205, 0, v205
    v_cvt_pk_bf16_f32 v206, 0, v206
    v_cvt_pk_bf16_f32 v207, 0, v207
    v_cvt_pk_bf16_f32 v208, 0, v208
    v_cvt_pk_bf16_f32 v209, 0, v209
    v_cvt_pk_bf16_f32 v210, 0, v210
    v_cvt_pk_bf16_f32 v211, 0, v211
    v_cvt_pk_bf16_f32 v212, 0, v212
    v_cvt_pk_bf16_f32 v213, 0, v213
    v_cvt_pk_bf16_f32 v214, 0, v214
    v_cvt_pk_bf16_f32 v215, 0, v215
    v_mul_f32 v200, s29, v200
    v_mul_f32 v201, s29, v201
    v_mul_f32 v202, s29, v202
    v_mul_f32 v203, s29, v203
    v_mul_f32 v204, s29, v204
    v_mul_f32 v205, s29, v205
    v_mul_f32 v206, s29, v206
    v_mul_f32 v207, s29, v207
    v_mul_f32 v208, s29, v208
    v_mul_f32 v209, s29, v209
    v_mul_f32 v210, s29, v210
    v_mul_f32 v211, s29, v211
    v_mul_f32 v212, s29, v212
    v_mul_f32 v213, s29, v213
    v_mul_f32 v214, s29, v214
    v_mul_f32 v215, s29, v215
    v_cvt_pk_bf16_f32 v200, 0, v200
    v_cvt_pk_bf16_f32 v201, 0, v201
    v_cvt_pk_bf16_f32 v202, 0, v202
    v_cvt_pk_bf16_f32 v203, 0, v203
    v_cvt_pk_bf16_f32 v204, 0, v204
    v_cvt_pk_bf16_f32 v205, 0, v205
    v_cvt_pk_bf16_f32 v206, 0, v206
    v_cvt_pk_bf16_f32 v207, 0, v207
    v_cvt_pk_bf16_f32 v208, 0, v208
    v_cvt_pk_bf16_f32 v209, 0, v209
    v_cvt_pk_bf16_f32 v210, 0, v210
    v_cvt_pk_bf16_f32 v211, 0, v211
    v_cvt_pk_bf16_f32 v212, 0, v212
    v_cvt_pk_bf16_f32 v213, 0, v213
    v_cvt_pk_bf16_f32 v214, 0, v214
    v_cvt_pk_bf16_f32 v215, 0, v215
    v_add_f32 v200, v200, v240
    v_add_f32 v201, v201, v241
    v_add_f32 v202, v202, v242
    v_add_f32 v203, v203, v243
    v_add_f32 v204, v204, v244
    v_add_f32 v205, v205, v245
    v_add_f32 v206, v206, v246
    v_add_f32 v207, v207, v247
    v_add_f32 v208, v208, v248
    v_add_f32 v209, v209, v249
    v_add_f32 v210, v210, v250
    v_add_f32 v211, v211, v251
    v_add_f32 v212, v212, v252
    v_add_f32 v213, v213, v253
    v_add_f32 v214, v214, v254
    v_add_f32 v215, v215, v255
    v_max3_f32 v234, v200, v201, v202
    v_max3_f32 v235, v203, v204, v205
    v_max3_f32 v234, v234, v206, v207
    v_max3_f32 v235, v235, v208, v209
    v_max3_f32 v234, v234, v210, v211
    v_max3_f32 v235, v235, v212, v213
    v_max3_f32 v234, v234, v214, v215
    s_waitcnt vmcnt(11)
    v_mfma_f32_32x32x16_bf16 v[68:83], v[104:107], v[136:139], 0
    s_waitcnt vmcnt(10)
    v_mfma_f32_32x32x16_bf16 v[68:83], v[108:111], v[140:143], v[68:83]
    s_waitcnt vmcnt(9)
    v_mfma_f32_32x32x16_bf16 v[68:83], v[112:115], v[144:147], v[68:83]
    s_waitcnt vmcnt(8)
    v_mfma_f32_32x32x16_bf16 v[68:83], v[116:119], v[148:151], v[68:83]
    s_waitcnt vmcnt(7)
    v_mfma_f32_32x32x16_bf16 v[68:83], v[120:123], v[152:155], v[68:83]
    s_waitcnt vmcnt(6)
    v_mfma_f32_32x32x16_bf16 v[68:83], v[124:127], v[156:159], v[68:83]
    s_waitcnt vmcnt(5)
    v_mfma_f32_32x32x16_bf16 v[68:83], v[128:131], v[160:163], v[68:83]
    s_waitcnt vmcnt(4)
    v_mfma_f32_32x32x16_bf16 v[68:83], v[132:135], v[164:167], v[68:83]
    s_nop 11
    v_cvt_pk_bf16_f32 v68, 0, v68
    v_cvt_pk_bf16_f32 v69, 0, v69
    v_cvt_pk_bf16_f32 v70, 0, v70
    v_cvt_pk_bf16_f32 v71, 0, v71
    v_mul_f32 v68, s29, v68
    v_mul_f32 v69, s29, v69
    v_mul_f32 v70, s29, v70
    v_mul_f32 v71, s29, v71
    v_cvt_pk_bf16_f32 v68, 0, v68
    v_cvt_pk_bf16_f32 v69, 0, v69
    v_cvt_pk_bf16_f32 v70, 0, v70
    v_cvt_pk_bf16_f32 v71, 0, v71
    v_max3_f32 v235, v235, v68, v69
    v_max3_f32 v234, v234, v70, v71
    v_max_f32 v234, v234, v235
    v_mov_b32 v235, v234
    s_nop 1
    v_permlane32_swap_b32 v234, v235
    s_nop 0
    v_max_f32 v234, v234, v235
    v_mul_f32 v234, s28, v234
    v_fma_f32 v200, v200, s28, -v234
    v_fma_f32 v201, v201, s28, -v234
    v_fma_f32 v202, v202, s28, -v234
    v_fma_f32 v203, v203, s28, -v234
    v_fma_f32 v204, v204, s28, -v234
    v_fma_f32 v205, v205, s28, -v234
    v_fma_f32 v206, v206, s28, -v234
    v_fma_f32 v207, v207, s28, -v234
    v_fma_f32 v208, v208, s28, -v234
    v_fma_f32 v209, v209, s28, -v234
    v_fma_f32 v210, v210, s28, -v234
    v_fma_f32 v211, v211, s28, -v234
    v_fma_f32 v212, v212, s28, -v234
    v_fma_f32 v213, v213, s28, -v234
    v_fma_f32 v214, v214, s28, -v234
    v_fma_f32 v215, v215, s28, -v234
    v_fma_f32 v68, v68, s28, -v234
    v_fma_f32 v69, v69, s28, -v234
    v_fma_f32 v70, v70, s28, -v234
    v_fma_f32 v71, v71, s28, -v234
    v_exp_f32 v200, v200
    v_exp_f32 v201, v201
    v_exp_f32 v202, v202
    v_exp_f32 v203, v203
    v_exp_f32 v204, v204
    v_exp_f32 v205, v205
    v_exp_f32 v206, v206
    v_exp_f32 v207, v207
    v_exp_f32 v208, v208
    v_exp_f32 v209, v209
    v_exp_f32 v210, v210
    v_exp_f32 v211, v211
    v_exp_f32 v212, v212
    v_exp_f32 v213, v213
    v_exp_f32 v214, v214
    v_exp_f32 v215, v215
    v_exp_f32 v68, v68
    v_exp_f32 v69, v69
    v_exp_f32 v70, v70
    v_exp_f32 v71, v71
    v_pk_add_f32 v[236:237], v[200:201], v[202:203]
    v_pk_add_f32 v[236:237], v[236:237], v[204:205]
    v_pk_add_f32 v[236:237], v[236:237], v[206:207]
    v_pk_add_f32 v[236:237], v[236:237], v[208:209]
    v_pk_add_f32 v[236:237], v[236:237], v[210:211]
    v_pk_add_f32 v[236:237], v[236:237], v[212:213]
    v_pk_add_f32 v[236:237], v[236:237], v[214:215]
    v_pk_add_f32 v[236:237], v[236:237], v[68:69]
    v_pk_add_f32 v[236:237], v[236:237], v[70:71]
    v_add_f32 v236, v236, v237
    v_mov_b32 v235, v236
    s_nop 1
    v_permlane32_swap_b32 v236, v235
    s_nop 0
    v_add_f32 v236, v236, v235
    v_rcp_f32 v236, v236
    s_nop 0
    v_pk_mul_f32 v[200:201], v[200:201], v[236:237] op_sel_hi:[1,0]
    v_pk_mul_f32 v[202:203], v[202:203], v[236:237] op_sel_hi:[1,0]
    v_pk_mul_f32 v[204:205], v[204:205], v[236:237] op_sel_hi:[1,0]
    v_pk_mul_f32 v[206:207], v[206:207], v[236:237] op_sel_hi:[1,0]
    v_pk_mul_f32 v[208:209], v[208:209], v[236:237] op_sel_hi:[1,0]
    v_pk_mul_f32 v[210:211], v[210:211], v[236:237] op_sel_hi:[1,0]
    v_pk_mul_f32 v[212:213], v[212:213], v[236:237] op_sel_hi:[1,0]
    v_pk_mul_f32 v[214:215], v[214:215], v[236:237] op_sel_hi:[1,0]
    v_pk_mul_f32 v[68:69], v[68:69], v[236:237] op_sel_hi:[1,0]
    v_pk_mul_f32 v[70:71], v[70:71], v[236:237] op_sel_hi:[1,0]
    v_cvt_pk_bf16_f32 v224, v200, v201
    v_cvt_pk_bf16_f32 v225, v202, v203
    v_cvt_pk_bf16_f32 v226, v204, v205
    v_cvt_pk_bf16_f32 v227, v206, v207
    v_cvt_pk_bf16_f32 v228, v208, v209
    v_cvt_pk_bf16_f32 v229, v210, v211
    v_cvt_pk_bf16_f32 v230, v212, v213
    v_cvt_pk_bf16_f32 v231, v214, v215
    v_cvt_pk_bf16_f32 v232, v68, v69
    v_cvt_pk_bf16_f32 v233, v70, v71
    s_waitcnt vmcnt(0)
    s_nop 0
    v_mfma_f32_32x32x8_bf16 v[104:119], v[216:217], v[232:233], 0
    v_mfma_f32_32x32x8_bf16 v[120:135], v[218:219], v[232:233], 0
    v_mfma_f32_32x32x8_bf16 v[136:151], v[220:221], v[232:233], 0
    v_mfma_f32_32x32x8_bf16 v[152:167], v[222:223], v[232:233], 0
    v_mfma_f32_32x32x16_bf16 v[104:119], v[168:171], v[224:227], v[104:119]
    v_mfma_f32_32x32x16_bf16 v[120:135], v[176:179], v[224:227], v[120:135]
    v_mfma_f32_32x32x16_bf16 v[136:151], v[184:187], v[224:227], v[136:151]
    v_mfma_f32_32x32x16_bf16 v[152:167], v[192:195], v[224:227], v[152:167]
    v_mfma_f32_32x32x16_bf16 v[104:119], v[172:175], v[228:231], v[104:119]
    v_mfma_f32_32x32x16_bf16 v[120:135], v[180:183], v[228:231], v[120:135]
    v_mfma_f32_32x32x16_bf16 v[136:151], v[188:191], v[228:231], v[136:151]
    v_mfma_f32_32x32x16_bf16 v[152:167], v[196:199], v[228:231], v[152:167]
    s_lshl_b32 s25, s38, 9
    s_lshr_b32 s26, s46, 3
    s_lshl_b32 s26, s26, 7
    s_add_u32 s25, s25, s26
    s_add_u32 s25, s25, 0x5904000
    s_nop 4
    v_cvt_pk_bf16_f32 v168, v104, v105
    v_cvt_pk_bf16_f32 v169, v106, v107
    v_cvt_pk_bf16_f32 v170, v108, v109
    v_cvt_pk_bf16_f32 v171, v110, v111
    v_cvt_pk_bf16_f32 v172, v112, v113
    v_cvt_pk_bf16_f32 v173, v114, v115
    v_cvt_pk_bf16_f32 v174, v116, v117
    v_cvt_pk_bf16_f32 v175, v118, v119
    s_add_u32 s43, s42, 0
    buffer_store_dwordx4 v[168:171], v100, s[12:15], s43 offen offset:2048 sc1
    buffer_store_dwordx4 v[172:175], v100, s[12:15], s43 offen offset:2560 sc1
    v_cvt_pk_bf16_f32 v176, v120, v121
    v_cvt_pk_bf16_f32 v177, v122, v123
    v_cvt_pk_bf16_f32 v178, v124, v125
    v_cvt_pk_bf16_f32 v179, v126, v127
    v_cvt_pk_bf16_f32 v180, v128, v129
    v_cvt_pk_bf16_f32 v181, v130, v131
    v_cvt_pk_bf16_f32 v182, v132, v133
    v_cvt_pk_bf16_f32 v183, v134, v135
    s_add_u32 s43, s42, 4096
    buffer_store_dwordx4 v[176:179], v100, s[12:15], s43 offen offset:2048 sc1
    buffer_store_dwordx4 v[180:183], v100, s[12:15], s43 offen offset:2560 sc1
    v_cvt_pk_bf16_f32 v184, v136, v137
    v_cvt_pk_bf16_f32 v185, v138, v139
    v_cvt_pk_bf16_f32 v186, v140, v141
    v_cvt_pk_bf16_f32 v187, v142, v143
    v_cvt_pk_bf16_f32 v188, v144, v145
    v_cvt_pk_bf16_f32 v189, v146, v147
    v_cvt_pk_bf16_f32 v190, v148, v149
    v_cvt_pk_bf16_f32 v191, v150, v151
    s_add_u32 s43, s42, 16384
    buffer_store_dwordx4 v[184:187], v100, s[12:15], s43 offen offset:2048 sc1
    buffer_store_dwordx4 v[188:191], v100, s[12:15], s43 offen offset:2560 sc1
    v_cvt_pk_bf16_f32 v192, v152, v153
    v_cvt_pk_bf16_f32 v193, v154, v155
    v_cvt_pk_bf16_f32 v194, v156, v157
    v_cvt_pk_bf16_f32 v195, v158, v159
    v_cvt_pk_bf16_f32 v196, v160, v161
    v_cvt_pk_bf16_f32 v197, v162, v163
    v_cvt_pk_bf16_f32 v198, v164, v165
    v_cvt_pk_bf16_f32 v199, v166, v167
    s_add_u32 s43, s42, 20480
    buffer_store_dwordx4 v[192:195], v100, s[12:15], s43 offen offset:2048 sc1
    buffer_store_dwordx4 v[196:199], v100, s[12:15], s43 offen offset:2560 sc1
    s_waitcnt vmcnt(0)
    buffer_atomic_add v84, v85, s[12:15], s25 offen sc1
    s_cmp_lt_u32 s22, 64
    s_cbranch_scc1 L_attr_215
    s_branch L_ste_219
L_fl0_218:
    s_waitcnt lgkmcnt(0)
    s_nop 7
L_ste_219:
    s_branch chain_kernel_wend
L_g1_202:
    s_cmp_ge_u32 s41, 16
    s_cbranch_scc1 L_g2_203
    s_lshl_b32 s46, s41, 6
    s_lshl_b32 s25, s49, 4
    s_add_u32 s46, s46, s25
    v_and_b32 v1, 15, v0
    v_add_u32 v1, s46, v1
    v_bfe_u32 v2, v0, 4, 2
    v_lshlrev_b32 v3, 1, v1
    s_mov_b32 s16, s66
    s_and_b32 s17, s67, 0xffff
    s_mov_b32 s18, 0x800
    s_mov_b32 s19, 0x00020000
    buffer_load_ushort v128, v3, s[16:19], 0 offen
    s_mov_b32 s16, s68
    s_and_b32 s17, s69, 0xffff
    s_mov_b32 s18, 0x800
    s_mov_b32 s19, 0x00020000
    buffer_load_ushort v129, v3, s[16:19], 0 offen
    s_mov_b32 s16, s78
    s_and_b32 s17, s79, 0xffff
    s_mov_b32 s18, 0x800
    s_mov_b32 s19, 0x00020000
    buffer_load_ushort v130, v3, s[16:19], 0 offen
    v_lshlrev_b32 v4, 4, v2
    v_lshl_add_u32 v4, v1, 11, v4
    s_mov_b32 s16, s70
    s_and_b32 s17, s71, 0xffff
    s_mov_b32 s18, 0x200000
    s_mov_b32 s19, 0x00020000
    s_mov_b32 s32, s72
    s_and_b32 s33, s73, 0xffff
    s_mov_b32 s34, 0x200000
    s_mov_b32 s35, 0x00020000
    s_lshl_b32 s25, s49, 11
    s_add_u32 s25, s25, 0x20000
    v_bfe_u32 v5, v0, 1, 2
    v_xor_b32 v5, v5, v2
    v_lshlrev_b32 v5, 4, v5
    v_and_b32 v6, 15, v0
    v_lshl_add_u32 v5, v6, 6, v5
    v_add_u32 v116, s25, v5
    v_bfe_u32 v5, v0, 5, 1
    v_bfe_u32 v6, v0, 2, 2
    v_lshl_add_u32 v5, v5, 3, v6
    v_lshlrev_b32 v5, 6, v5
    v_bfe_u32 v7, v0, 4, 1
    v_lshlrev_b32 v7, 1, v7
    v_bfe_u32 v117, v0, 1, 1
    v_add_u32 v7, v7, v117
    v_lshrrev_b32 v6, 1, v6
    v_xor_b32 v7, v7, v6
    v_lshl_add_u32 v5, v7, 4, v5
    v_and_b32 v6, 1, v0
    v_lshl_add_u32 v5, v6, 3, v5
    v_add_u32 v117, s25, v5
    v_xor_b32 v118, 32, v117
    s_lshl_b32 s25, s46, 6
    v_and_b32 v5, 63, v0
    v_lshlrev_b32 v5, 4, v5
    v_add_u32 v86, s25, v5
    buffer_load_dwordx4 a[0:3], v4, s[16:19], 0 offen offset:0
    buffer_load_dwordx4 a[4:7], v4, s[32:35], 0 offen offset:0
    buffer_load_dwordx4 a[8:11], v4, s[16:19], 0 offen offset:64
    buffer_load_dwordx4 a[12:15], v4, s[32:35], 0 offen offset:64
    buffer_load_dwordx4 a[16:19], v4, s[16:19], 0 offen offset:128
    buffer_load_dwordx4 a[20:23], v4, s[32:35], 0 offen offset:128
    buffer_load_dwordx4 a[24:27], v4, s[16:19], 0 offen offset:192
    buffer_load_dwordx4 a[28:31], v4, s[32:35], 0 offen offset:192
    buffer_load_dwordx4 a[32:35], v4, s[16:19], 0 offen offset:256
    buffer_load_dwordx4 a[36:39], v4, s[32:35], 0 offen offset:256
    buffer_load_dwordx4 a[40:43], v4, s[16:19], 0 offen offset:320
    buffer_load_dwordx4 a[44:47], v4, s[32:35], 0 offen offset:320
    buffer_load_dwordx4 a[48:51], v4, s[16:19], 0 offen offset:384
    buffer_load_dwordx4 a[52:55], v4, s[32:35], 0 offen offset:384
    buffer_load_dwordx4 a[56:59], v4, s[16:19], 0 offen offset:448
    buffer_load_dwordx4 a[60:63], v4, s[32:35], 0 offen offset:448
    buffer_load_dwordx4 a[64:67], v4, s[16:19], 0 offen offset:512
    buffer_load_dwordx4 a[68:71], v4, s[32:35], 0 offen offset:512
    buffer_load_dwordx4 a[72:75], v4, s[16:19], 0 offen offset:576
    buffer_load_dwordx4 a[76:79], v4, s[32:35], 0 offen offset:576
    buffer_load_dwordx4 a[80:83], v4, s[16:19], 0 offen offset:640
    buffer_load_dwordx4 a[84:87], v4, s[32:35], 0 offen offset:640
    buffer_load_dwordx4 a[88:91], v4, s[16:19], 0 offen offset:704
    buffer_load_dwordx4 a[92:95], v4, s[32:35], 0 offen offset:704
    buffer_load_dwordx4 a[96:99], v4, s[16:19], 0 offen offset:768
    buffer_load_dwordx4 a[100:103], v4, s[32:35], 0 offen offset:768
    buffer_load_dwordx4 a[104:107], v4, s[16:19], 0 offen offset:832
    buffer_load_dwordx4 a[108:111], v4, s[32:35], 0 offen offset:832
    buffer_load_dwordx4 a[112:115], v4, s[16:19], 0 offen offset:896
    buffer_load_dwordx4 a[116:119], v4, s[32:35], 0 offen offset:896
    buffer_load_dwordx4 a[120:123], v4, s[16:19], 0 offen offset:960
    buffer_load_dwordx4 a[124:127], v4, s[32:35], 0 offen offset:960
    buffer_load_dwordx4 a[128:131], v4, s[16:19], 0 offen offset:1024
    buffer_load_dwordx4 a[132:135], v4, s[32:35], 0 offen offset:1024
    buffer_load_dwordx4 a[136:139], v4, s[16:19], 0 offen offset:1088
    buffer_load_dwordx4 a[140:143], v4, s[32:35], 0 offen offset:1088
    buffer_load_dwordx4 a[144:147], v4, s[16:19], 0 offen offset:1152
    buffer_load_dwordx4 a[148:151], v4, s[32:35], 0 offen offset:1152
    buffer_load_dwordx4 a[152:155], v4, s[16:19], 0 offen offset:1216
    buffer_load_dwordx4 a[156:159], v4, s[32:35], 0 offen offset:1216
    buffer_load_dwordx4 a[160:163], v4, s[16:19], 0 offen offset:1280
    buffer_load_dwordx4 a[164:167], v4, s[32:35], 0 offen offset:1280
    buffer_load_dwordx4 a[168:171], v4, s[16:19], 0 offen offset:1344
    buffer_load_dwordx4 a[172:175], v4, s[32:35], 0 offen offset:1344
    buffer_load_dwordx4 a[176:179], v4, s[16:19], 0 offen offset:1408
    buffer_load_dwordx4 a[180:183], v4, s[32:35], 0 offen offset:1408
    buffer_load_dwordx4 a[184:187], v4, s[16:19], 0 offen offset:1472
    buffer_load_dwordx4 a[188:191], v4, s[32:35], 0 offen offset:1472
    buffer_load_dwordx4 a[192:195], v4, s[16:19], 0 offen offset:1536
    buffer_load_dwordx4 a[196:199], v4, s[32:35], 0 offen offset:1536
    buffer_load_dwordx4 a[200:203], v4, s[16:19], 0 offen offset:1600
    buffer_load_dwordx4 a[204:207], v4, s[32:35], 0 offen offset:1600
    buffer_load_dwordx4 a[208:211], v4, s[16:19], 0 offen offset:1664
    buffer_load_dwordx4 a[212:215], v4, s[32:35], 0 offen offset:1664
    buffer_load_dwordx4 a[216:219], v4, s[16:19], 0 offen offset:1728
    buffer_load_dwordx4 a[220:223], v4, s[32:35], 0 offen offset:1728
    s_waitcnt vmcnt(55)
    buffer_load_dwordx4 a[224:227], v4, s[16:19], 0 offen offset:1792
    s_waitcnt vmcnt(55)
    buffer_load_dwordx4 a[228:231], v4, s[32:35], 0 offen offset:1792
    s_waitcnt vmcnt(55)
    buffer_load_dwordx4 a[232:235], v4, s[16:19], 0 offen offset:1856
    s_waitcnt vmcnt(55)
    buffer_load_dwordx4 a[236:239], v4, s[32:35], 0 offen offset:1856
    s_waitcnt vmcnt(55)
    buffer_load_dwordx4 a[240:243], v4, s[16:19], 0 offen offset:1920
    s_waitcnt vmcnt(55)
    buffer_load_dwordx4 a[244:247], v4, s[32:35], 0 offen offset:1920
    s_waitcnt vmcnt(55)
    buffer_load_dwordx4 a[248:251], v4, s[16:19], 0 offen offset:1984
    s_waitcnt vmcnt(55)
    buffer_load_dwordx4 a[252:255], v4, s[32:35], 0 offen offset:1984
    s_waitcnt vmcnt(0)
    v_lshlrev_b32 v128, 16, v128
    v_lshlrev_b32 v129, 16, v129
    v_lshlrev_b32 v130, 16, v130
    v_mul_f32 v131, 0x3fb8aa3b, v130
    v_exp_f32 v131, v131
    s_nop 0
    v_cvt_pk_bf16_f32 v131, 0, v131
    v_mul_f32 v132, v131, v128
    v_mul_f32 v133, v131, v129
    v_mul_f32 v132, 0x3fb8aa3b, v132
    v_exp_f32 v132, v132
    v_mul_f32 v133, 0x3e22f983, v133
    v_fract_f32 v133, v133
    v_cos_f32 v134, v133
    v_sin_f32 v133, v133
    s_nop 0
    v_mul_f32 v88, v132, v134
    v_mul_f32 v89, v132, v133
    v_add_f32 v131, -1.0, v88
    v_mul_f32 v132, v131, v128
    v_fma_f32 v132, v89, v129, v132
    v_mul_f32 v133, v89, v128
    v_fma_f32 v133, -v131, v129, v133
    v_mul_f32 v134, v128, v128
    v_fma_f32 v134, v129, v129, v134
    v_rcp_f32 v134, v134
    s_nop 0
    v_add_f32 v134, v134, v134
    v_mul_f32 v90, v132, v134
    v_mul_f32 v91, v133, v134
    v_mov_b32 v92, v88
    v_mov_b32 v93, v89
    v_mul_f32 v131, v93, v93
    v_mul_f32 v93, v92, v93
    v_fma_f32 v92, v92, v92, -v131
    v_add_f32 v93, v93, v93
    v_mul_f32 v131, v93, v93
    v_mul_f32 v93, v92, v93
    v_fma_f32 v92, v92, v92, -v131
    v_add_f32 v93, v93, v93
    v_mul_f32 v131, v93, v93
    v_mul_f32 v93, v92, v93
    v_fma_f32 v92, v92, v92, -v131
    v_add_f32 v93, v93, v93
    v_mov_b32 v94, 0
    v_mov_b32 v95, 0
    v_mov_b32 v68, 0
    v_mov_b32 v69, 0
    v_mov_b32 v70, 0
    v_mov_b32 v71, 0
    v_mov_b32 v72, 0
    v_mov_b32 v73, 0
    v_mov_b32 v74, 0
    v_mov_b32 v75, 0
    v_mov_b32 v76, 0
    v_mov_b32 v77, 0
    v_mov_b32 v78, 0
    v_mov_b32 v79, 0
    v_mov_b32 v80, 0
    v_mov_b32 v81, 0
    v_mov_b32 v82, 0
    v_mov_b32 v83, 0
    s_mov_b32 s8, s64
    s_and_b32 s9, s65, 0xffff
    s_mov_b32 s10, 0x400000
    s_mov_b32 s11, 0x00020000
    s_lshl_b32 s21, s49, 12
    v_and_b32 v1, 63, v0
    v_and_b32 v2, 15, v0
    v_bfe_u32 v3, v0, 4, 2
    v_lshrrev_b32 v4, 6, v0
    v_lshrrev_b32 v5, 5, v1
    v_lshl_add_u32 v5, v4, 3, v5
    v_add_u32 v5, 0, v5
    v_and_b32 v6, 3, v5
    v_lshrrev_b32 v7, 3, v5
    v_lshl_add_u32 v6, v7, 2, v6
    v_and_b32 v7, 31, v1
    v_xor_b32 v6, v6, v7
    v_lshlrev_b32 v6, 4, v6
    v_lshl_add_u32 v8, v5, 11, v6
    v_lshrrev_b32 v5, 5, v1
    v_lshl_add_u32 v5, v4, 3, v5
    v_add_u32 v5, 2, v5
    v_and_b32 v6, 3, v5
    v_lshrrev_b32 v7, 3, v5
    v_lshl_add_u32 v6, v7, 2, v6
    v_and_b32 v7, 31, v1
    v_xor_b32 v6, v6, v7
    v_lshlrev_b32 v6, 4, v6
    v_lshl_add_u32 v9, v5, 11, v6
    v_lshrrev_b32 v5, 5, v1
    v_lshl_add_u32 v5, v4, 3, v5
    v_add_u32 v5, 4, v5
    v_and_b32 v6, 3, v5
    v_lshrrev_b32 v7, 3, v5
    v_lshl_add_u32 v6, v7, 2, v6
    v_and_b32 v7, 31, v1
    v_xor_b32 v6, v6, v7
    v_lshlrev_b32 v6, 4, v6
    v_lshl_add_u32 v10, v5, 11, v6
    v_lshrrev_b32 v5, 5, v1
    v_lshl_add_u32 v5, v4, 3, v5
    v_add_u32 v5, 6, v5
    v_and_b32 v6, 3, v5
    v_lshrrev_b32 v7, 3, v5
    v_lshl_add_u32 v6, v7, 2, v6
    v_and_b32 v7, 31, v1
    v_xor_b32 v6, v6, v7
    v_lshlrev_b32 v6, 4, v6
    v_lshl_add_u32 v11, v5, 11, v6
    v_and_b32 v5, 12, v2
    v_add_u32 v5, v5, v2
    v_add_u32 v6, 0, v3
    v_xor_b32 v6, v6, v2
    v_lshlrev_b32 v6, 4, v6
    v_lshl_add_u32 v12, v5, 9, v6
    v_add_u32 v6, 4, v3
    v_xor_b32 v6, v6, v2
    v_lshlrev_b32 v6, 4, v6
    v_lshl_add_u32 v13, v5, 9, v6
    v_add_u32 v6, 8, v3
    v_xor_b32 v6, v6, v2
    v_lshlrev_b32 v6, 4, v6
    v_lshl_add_u32 v14, v5, 9, v6
    v_add_u32 v6, 12, v3
    v_xor_b32 v6, v6, v2
    v_lshlrev_b32 v6, 4, v6
    v_lshl_add_u32 v15, v5, 9, v6
    v_add_u32 v16, 0x10000, v12
    v_add_u32 v17, 0x10000, v13
    v_add_u32 v18, 0x10000, v14
    v_add_u32 v19, 0x10000, v15
    s_mov_b32 s32, s98
    s_and_b32 s33, s99, 0xffff
    s_mov_b32 s34, 0x100
    s_mov_b32 s35, 0x00020000
    s_mov_b32 s25, 0
    v_mov_b32 v2, 0
L_pl_224:
    buffer_load_dword v1, v2, s[32:35], s25 offen sc1
    s_add_u32 s36, s36, 1
    s_cmp_gt_u32 s36, 0x100000
    s_cbranch_scc1 chain_kernel_wend
    s_waitcnt vmcnt(0)
    v_readfirstlane_b32 s26, v1
    s_and_b32 s27, s26, 0xffff
    s_cmp_ge_u32 s27, 256
    s_cbranch_scc1 L_plok_225
    s_sleep 4
    s_branch L_pl_224
L_plok_225:
    s_lshr_b32 s25, s26, 16
    s_cmp_gt_u32 s25, 64
    s_cselect_b32 s25, 0x2000, 0x0
    s_add_u32 s54, s100, 0x1fffff
    s_and_b32 s54, s54, 0xffe00000
    s_sub_u32 s55, s54, s100
    s_add_u32 s54, s55, s25
    s_xor_b32 s25, s25, 0x2000
    s_add_u32 s55, s55, s25
    s_mov_b32 s56, 0xffff0000
    s_mov_b32 s57, 0xffffffff
    s_mov_b32 s58, 0x0
    s_mov_b32 s59, 0xffffffff
    s_mov_b32 s60, 0x0
    s_mov_b32 s61, 0xffff0000
    s_mov_b32 s22, 0
    s_mov_b32 s24, 0
    s_mov_b32 s20, 0
    s_mov_b32 s37, 0
    s_mov_b32 s23, 64
    s_mov_b32 s38, 0x7ff00000
    s_mov_b32 s39, 0x7ff00000
    s_mov_b32 s43, 0x7ff00000
    s_barrier
    s_add_u32 m0, s21, 0
    s_nop 0
    buffer_load_dwordx4 v8, s[8:11], s20 offen lds
    s_add_u32 m0, s21, 1024
    s_nop 0
    buffer_load_dwordx4 v9, s[8:11], s20 offen lds
    s_add_u32 m0, s21, 2048
    s_nop 0
    buffer_load_dwordx4 v10, s[8:11], s20 offen lds
    s_add_u32 m0, s21, 3072
    s_nop 0
    buffer_load_dwordx4 v11, s[8:11], s20 offen lds
    s_add_u32 s20, s20, 512
    s_add_u32 m0, s21, 16384
    s_nop 0
    buffer_load_dwordx4 v8, s[8:11], s20 offen lds
    s_add_u32 m0, s21, 17408
    s_nop 0
    buffer_load_dwordx4 v9, s[8:11], s20 offen lds
    s_add_u32 m0, s21, 18432
    s_nop 0
    buffer_load_dwordx4 v10, s[8:11], s20 offen lds
    s_add_u32 m0, s21, 19456
    s_nop 0
    buffer_load_dwordx4 v11, s[8:11], s20 offen lds
    s_add_u32 s20, s20, 512
    s_add_u32 m0, s21, 32768
    s_nop 0
    buffer_load_dwordx4 v8, s[8:11], s20 offen lds
    s_add_u32 m0, s21, 33792
    s_nop 0
    buffer_load_dwordx4 v9, s[8:11], s20 offen lds
    s_add_u32 m0, s21, 34816
    s_nop 0
    buffer_load_dwordx4 v10, s[8:11], s20 offen lds
    s_add_u32 m0, s21, 35840
    s_nop 0
    buffer_load_dwordx4 v11, s[8:11], s20 offen lds
    s_add_u32 s20, s20, 512
    s_add_u32 m0, s21, 49152
    s_nop 0
    buffer_load_dwordx4 v8, s[8:11], s20 offen lds
    s_add_u32 m0, s21, 50176
    s_nop 0
    buffer_load_dwordx4 v9, s[8:11], s20 offen lds
    s_add_u32 m0, s21, 51200
    s_nop 0
    buffer_load_dwordx4 v10, s[8:11], s20 offen lds
    s_add_u32 m0, s21, 52224
    s_nop 0
    buffer_load_dwordx4 v11, s[8:11], s20 offen lds
    s_add_u32 s24, s24, 1
    s_min_u32 s24, s24, 63
    s_lshl_b32 s53, s24, 16
    s_mov_b32 s20, s53
    s_add_u32 m0, s21, 65536
    s_nop 0
    buffer_load_dwordx4 v8, s[8:11], s20 offen lds
    s_add_u32 m0, s21, 66560
    s_nop 0
    buffer_load_dwordx4 v9, s[8:11], s20 offen lds
    s_add_u32 m0, s21, 67584
    s_nop 0
    buffer_load_dwordx4 v10, s[8:11], s20 offen lds
    s_add_u32 m0, s21, 68608
    s_nop 0
    buffer_load_dwordx4 v11, s[8:11], s20 offen lds
    s_add_u32 s20, s20, 512
    s_add_u32 m0, s21, 81920
    s_nop 0
    buffer_load_dwordx4 v8, s[8:11], s20 offen lds
    s_add_u32 m0, s21, 82944
    s_nop 0
    buffer_load_dwordx4 v9, s[8:11], s20 offen lds
    s_add_u32 m0, s21, 83968
    s_nop 0
    buffer_load_dwordx4 v10, s[8:11], s20 offen lds
    s_add_u32 m0, s21, 84992
    s_nop 0
    buffer_load_dwordx4 v11, s[8:11], s20 offen lds
    s_add_u32 s20, s20, 512
    s_add_u32 m0, s21, 98304
    s_nop 0
    buffer_load_dwordx4 v8, s[8:11], s20 offen lds
    s_waitcnt vmcnt(21)
    s_barrier
    ds_read_b128 v[20:23], v12 offset:0
    ds_read_b128 v[24:27], v12 offset:2048
    ds_read_b128 v[28:31], v13 offset:0
    ds_read_b128 v[32:35], v13 offset:2048
    ds_read_b128 v[36:39], v14 offset:0
    ds_read_b128 v[40:43], v14 offset:2048
    s_waitcnt lgkmcnt(4)
L_st_226:
    v_mfma_f32_16x16x32_bf16 v[52:55], v[20:23], a[0:3], 0
    ds_read_b128 v[44:47], v15 offset:0
    s_add_u32 m0, s21, 99328
    v_mfma_f32_16x16x32_bf16 v[56:59], v[20:23], a[4:7], 0
    buffer_load_dwordx4 v9, s[8:11], s20 offen lds
    v_mfma_f32_16x16x32_bf16 v[60:63], v[24:27], a[0:3], 0
    ds_read_b128 v[48:51], v15 offset:2048
    v_mfma_f32_16x16x32_bf16 v[64:67], v[24:27], a[4:7], 0
    s_waitcnt lgkmcnt(4)
    v_fma_f32 v100, v88, v68, v69
    v_fma_f32 v101, v88, v72, v73
    v_mfma_f32_16x16x32_bf16 v[52:55], v[28:31], a[8:11], v[52:55]
    ds_read_b128 v[20:23], v12 offset:256
    s_waitcnt lgkmcnt(7)
    v_fma_f32 v96, -v89, v72, v100
    v_mfma_f32_16x16x32_bf16 v[56:59], v[28:31], a[12:15], v[56:59]
    buffer_store_dwordx4 v[144:147], v86, s[12:15], s38 offen sc1
    v_fma_f32 v97, v89, v68, v101
    v_mfma_f32_16x16x32_bf16 v[60:63], v[32:35], a[8:11], v[60:63]
    ds_read_b128 v[24:27], v12 offset:2304
    v_fma_f32 v100, v88, v96, v70
    v_mfma_f32_16x16x32_bf16 v[64:67], v[32:35], a[12:15], v[64:67]
    s_waitcnt lgkmcnt(4)
    v_fma_f32 v101, v88, v97, v74
    v_fma_f32 v98, -v89, v97, v100
    v_mfma_f32_16x16x32_bf16 v[52:55], v[36:39], a[16:19], v[52:55]
    ds_read_b128 v[28:31], v13 offset:256
    s_add_u32 m0, s21, 100352
    v_mfma_f32_16x16x32_bf16 v[56:59], v[36:39], a[20:23], v[56:59]
    buffer_load_dwordx4 v10, s[8:11], s20 offen lds
    v_fma_f32 v99, v89, v96, v101
    v_mfma_f32_16x16x32_bf16 v[60:63], v[40:43], a[16:19], v[60:63]
    ds_read_b128 v[32:35], v13 offset:2304
    v_fma_f32 v100, v88, v98, v71
    v_fma_f32 v101, v88, v99, v75
    v_mfma_f32_16x16x32_bf16 v[64:67], v[40:43], a[20:23], v[64:67]
    s_waitcnt lgkmcnt(4)
    v_fma_f32 v96, -v89, v99, v100
    v_mfma_f32_16x16x32_bf16 v[52:55], v[44:47], a[24:27], v[52:55]
    ds_read_b128 v[36:39], v14 offset:256
    v_fma_f32 v97, v89, v98, v101
    v_fma_f32 v100, v88, v96, v76
    v_mfma_f32_16x16x32_bf16 v[56:59], v[44:47], a[28:31], v[56:59]
    buffer_store_dwordx4 v[148:151], v86, s[12:15], s43 offen sc1
    v_mfma_f32_16x16x32_bf16 v[60:63], v[48:51], a[24:27], v[60:63]
    ds_read_b128 v[40:43], v14 offset:2304
    v_fma_f32 v101, v88, v97, v80
    v_fma_f32 v98, -v89, v97, v100
    v_mfma_f32_16x16x32_bf16 v[64:67], v[48:51], a[28:31], v[64:67]
    s_waitcnt lgkmcnt(4)
    v_fma_f32 v99, v89, v96, v101
    v_mfma_f32_16x16x32_bf16 v[52:55], v[20:23], a[32:35], v[52:55]
    ds_read_b128 v[44:47], v15 offset:256
    s_add_u32 m0, s21, 101376
    v_fma_f32 v100, v88, v98, v77
    v_mfma_f32_16x16x32_bf16 v[56:59], v[20:23], a[36:39], v[56:59]
    buffer_load_dwordx4 v11, s[8:11], s20 offen lds
    v_fma_f32 v101, v88, v99, v81
    v_mfma_f32_16x16x32_bf16 v[60:63], v[24:27], a[32:35], v[60:63]
    ds_read_b128 v[48:51], v15 offset:2304
    v_fma_f32 v96, -v89, v99, v100
    v_fma_f32 v97, v89, v98, v101
    v_mfma_f32_16x16x32_bf16 v[64:67], v[24:27], a[36:39], v[64:67]
    s_waitcnt lgkmcnt(4)
    v_fma_f32 v100, v88, v96, v78
    v_mfma_f32_16x16x32_bf16 v[52:55], v[28:31], a[40:43], v[52:55]
    s_waitcnt vmcnt(20)
    s_barrier
    ds_read_b128 v[20:23], v12 offset:16384
    v_mfma_f32_16x16x32_bf16 v[56:59], v[28:31], a[44:47], v[56:59]
    s_add_u32 s20, s20, 512
    v_fma_f32 v101, v88, v97, v82
    v_mfma_f32_16x16x32_bf16 v[60:63], v[32:35], a[40:43], v[60:63]
    ds_read_b128 v[24:27], v12 offset:18432
    v_fma_f32 v98, -v89, v97, v100
    v_mfma_f32_16x16x32_bf16 v[64:67], v[32:35], a[44:47], v[64:67]
    s_waitcnt lgkmcnt(4)
    v_fma_f32 v99, v89, v96, v101
    v_fma_f32 v100, v88, v98, v79
    v_mfma_f32_16x16x32_bf16 v[52:55], v[36:39], a[48:51], v[52:55]
    ds_read_b128 v[28:31], v13 offset:16384
    s_add_u32 m0, s21, 114688
    v_fma_f32 v101, v88, v99, v83
    v_mfma_f32_16x16x32_bf16 v[56:59], v[36:39], a[52:55], v[56:59]
    buffer_load_dwordx4 v8, s[8:11], s20 offen lds
    v_mfma_f32_16x16x32_bf16 v[60:63], v[40:43], a[48:51], v[60:63]
    ds_read_b128 v[32:35], v13 offset:18432
    v_fma_f32 v102, -v89, v99, v100
    v_fma_f32 v106, v89, v98, v101
    v_mfma_f32_16x16x32_bf16 v[64:67], v[40:43], a[52:55], v[64:67]
    s_waitcnt lgkmcnt(4)
    v_mov_b32 v103, v102
    v_mfma_f32_16x16x32_bf16 v[52:55], v[44:47], a[56:59], v[52:55]
    ds_read_b128 v[36:39], v14 offset:16384
    v_mov_b32 v107, v106
    s_nop 1
    v_mfma_f32_16x16x32_bf16 v[56:59], v[44:47], a[60:63], v[56:59]
    v_permlane16_swap_b32 v102, v103
    v_mfma_f32_16x16x32_bf16 v[60:63], v[48:51], a[56:59], v[60:63]
    ds_read_b128 v[40:43], v14 offset:18432
    v_permlane16_swap_b32 v106, v107
    v_mov_b32 v104, v102
    v_mfma_f32_16x16x32_bf16 v[64:67], v[48:51], a[60:63], v[64:67]
    s_waitcnt lgkmcnt(4)
    v_mov_b32 v105, v103
    v_mov_b32 v108, v106
    v_mfma_f32_16x16x32_bf16 v[52:55], v[20:23], a[64:67], v[52:55]
    ds_read_b128 v[44:47], v15 offset:16384
    s_add_u32 m0, s21, 115712
    v_mfma_f32_16x16x32_bf16 v[56:59], v[20:23], a[68:71], v[56:59]
    buffer_load_dwordx4 v9, s[8:11], s20 offen lds
    v_mov_b32 v109, v107
    v_mfma_f32_16x16x32_bf16 v[60:63], v[24:27], a[64:67], v[60:63]
    ds_read_b128 v[48:51], v15 offset:18432
    s_nop 0
    v_permlane32_swap_b32 v102, v104
    v_mfma_f32_16x16x32_bf16 v[64:67], v[24:27], a[68:71], v[64:67]
    s_waitcnt lgkmcnt(4)
    v_permlane32_swap_b32 v103, v105
    v_mfma_f32_16x16x32_bf16 v[52:55], v[28:31], a[72:75], v[52:55]
    ds_read_b128 v[20:23], v12 offset:16640
    v_permlane32_swap_b32 v106, v108
    v_permlane32_swap_b32 v107, v109
    v_mfma_f32_16x16x32_bf16 v[56:59], v[28:31], a[76:79], v[56:59]
    v_fma_f32 v100, v92, v94, v102
    v_mfma_f32_16x16x32_bf16 v[60:63], v[32:35], a[72:75], v[60:63]
    ds_read_b128 v[24:27], v12 offset:18688
    s_add_u32 s24, s24, 1
    v_fma_f32 v101, v92, v95, v106
    v_mfma_f32_16x16x32_bf16 v[64:67], v[32:35], a[76:79], v[64:67]
    s_waitcnt lgkmcnt(4)
    v_fma_f32 v110, -v93, v95, v100
    v_mfma_f32_16x16x32_bf16 v[52:55], v[36:39], a[80:83], v[52:55]
    ds_read_b128 v[28:31], v13 offset:16640
    s_add_u32 m0, s21, 116736
    v_fma_f32 v111, v93, v94, v101
    v_mfma_f32_16x16x32_bf16 v[56:59], v[36:39], a[84:87], v[56:59]
    buffer_load_dwordx4 v10, s[8:11], s20 offen lds
    v_cndmask_b32 v98, v94, v110, s[56:57]
    v_mfma_f32_16x16x32_bf16 v[60:63], v[40:43], a[80:83], v[60:63]
    ds_read_b128 v[32:35], v13 offset:18688
    v_cndmask_b32 v99, v95, v111, s[56:57]
    v_mfma_f32_16x16x32_bf16 v[64:67], v[40:43], a[84:87], v[64:67]
    s_waitcnt lgkmcnt(4)
    s_min_u32 s24, s24, 63
    v_fma_f32 v100, v92, v110, v103
    v_mfma_f32_16x16x32_bf16 v[52:55], v[44:47], a[88:91], v[52:55]
    ds_read_b128 v[36:39], v14 offset:16640
    v_fma_f32 v101, v92, v111, v107
    v_fma_f32 v112, -v93, v111, v100
    v_mfma_f32_16x16x32_bf16 v[56:59], v[44:47], a[92:95], v[56:59]
    v_fma_f32 v113, v93, v110, v101
    v_mfma_f32_16x16x32_bf16 v[60:63], v[48:51], a[88:91], v[60:63]
    ds_read_b128 v[40:43], v14 offset:18688
    s_lshl_b32 s53, s24, 16
    v_cndmask_b32 v98, v98, v112, s[58:59]
    v_mfma_f32_16x16x32_bf16 v[64:67], v[48:51], a[92:95], v[64:67]
    s_waitcnt lgkmcnt(4)
    v_cndmask_b32 v99, v99, v113, s[58:59]
    v_fma_f32 v100, v92, v112, v104
    v_mfma_f32_16x16x32_bf16 v[52:55], v[20:23], a[96:99], v[52:55]
    ds_read_b128 v[44:47], v15 offset:16640
    s_add_u32 m0, s21, 117760
    v_mfma_f32_16x16x32_bf16 v[56:59], v[20:23], a[100:103], v[56:59]
    buffer_load_dwordx4 v11, s[8:11], s20 offen lds
    v_fma_f32 v101, v92, v113, v108
    v_mfma_f32_16x16x32_bf16 v[60:63], v[24:27], a[96:99], v[60:63]
    ds_read_b128 v[48:51], v15 offset:18688
    v_fma_f32 v114, -v93, v113, v100
    v_fma_f32 v115, v93, v112, v101
    v_mfma_f32_16x16x32_bf16 v[64:67], v[24:27], a[100:103], v[64:67]
    s_waitcnt lgkmcnt(4)
    v_cndmask_b32 v98, v98, v114, s[60:61]
    v_mfma_f32_16x16x32_bf16 v[52:55], v[28:31], a[104:107], v[52:55]
    s_waitcnt vmcnt(20)
    s_barrier
    ds_read_b128 v[20:23], v12 offset:32768
    v_mfma_f32_16x16x32_bf16 v[56:59], v[28:31], a[108:111], v[56:59]
    s_mov_b32 s20, s53
    v_cndmask_b32 v99, v99, v115, s[60:61]
    v_mfma_f32_16x16x32_bf16 v[60:63], v[32:35], a[104:107], v[60:63]
    ds_read_b128 v[24:27], v12 offset:34816
    v_fma_f32 v100, v92, v114, v105
    v_mfma_f32_16x16x32_bf16 v[64:67], v[32:35], a[108:111], v[64:67]
    s_waitcnt lgkmcnt(4)
    v_fma_f32 v101, v92, v115, v109
    v_fma_f32 v94, -v93, v115, v100
    v_mfma_f32_16x16x32_bf16 v[52:55], v[36:39], a[112:115], v[52:55]
    ds_read_b128 v[28:31], v13 offset:32768
    s_add_u32 m0, s21, 0
    v_fma_f32 v95, v93, v114, v101
    v_mfma_f32_16x16x32_bf16 v[56:59], v[36:39], a[116:119], v[56:59]
    buffer_load_dwordx4 v8, s[8:11], s20 offen lds
    v_mfma_f32_16x16x32_bf16 v[60:63], v[40:43], a[112:115], v[60:63]
    ds_read_b128 v[32:35], v13 offset:34816
    v_fma_f32 v100, v88, v98, v68
    v_fma_f32 v101, v88, v99, v72
    v_mfma_f32_16x16x32_bf16 v[64:67], v[40:43], a[116:119], v[64:67]
    s_waitcnt lgkmcnt(4)
    v_fma_f32 v96, -v89, v99, v100
    v_mfma_f32_16x16x32_bf16 v[52:55], v[44:47], a[120:123], v[52:55]
    ds_read_b128 v[36:39], v14 offset:32768
    v_fma_f32 v97, v89, v98, v101
    v_mul_f32 v128, v90, v96
    v_mfma_f32_16x16x32_bf16 v[56:59], v[44:47], a[124:127], v[56:59]
    v_mul_f32 v136, v90, v97
    v_fma_f32 v128, -v91, v97, v128
    v_mfma_f32_16x16x32_bf16 v[60:63], v[48:51], a[120:123], v[60:63]
    ds_read_b128 v[40:43], v14 offset:34816
    v_fma_f32 v136, -v91, v96, -v136
    v_mfma_f32_16x16x32_bf16 v[64:67], v[48:51], a[124:127], v[64:67]
    s_waitcnt lgkmcnt(4)
    v_fma_f32 v100, v88, v96, v69
    v_fma_f32 v101, v88, v97, v73
    v_mfma_f32_16x16x32_bf16 v[52:55], v[20:23], a[128:131], v[52:55]
    ds_read_b128 v[44:47], v15 offset:32768
    s_add_u32 m0, s21, 1024
    v_mfma_f32_16x16x32_bf16 v[56:59], v[20:23], a[132:135], v[56:59]
    buffer_load_dwordx4 v9, s[8:11], s20 offen lds
    v_fma_f32 v98, -v89, v97, v100
    v_mfma_f32_16x16x32_bf16 v[60:63], v[24:27], a[128:131], v[60:63]
    ds_read_b128 v[48:51], v15 offset:34816
    v_fma_f32 v99, v89, v96, v101
    v_mul_f32 v129, v90, v98
    v_mfma_f32_16x16x32_bf16 v[64:67], v[24:27], a[132:135], v[64:67]
    s_waitcnt lgkmcnt(4)
    v_mul_f32 v137, v90, v99
    v_mfma_f32_16x16x32_bf16 v[52:55], v[28:31], a[136:139], v[52:55]
    ds_read_b128 v[20:23], v12 offset:33024
    v_fma_f32 v129, -v91, v99, v129
    v_fma_f32 v137, -v91, v98, -v137
    v_mfma_f32_16x16x32_bf16 v[56:59], v[28:31], a[140:143], v[56:59]
    v_cvt_pk_bf16_f32 v120, v128, v129
    v_mfma_f32_16x16x32_bf16 v[60:63], v[32:35], a[136:139], v[60:63]
    ds_read_b128 v[24:27], v12 offset:35072
    v_cvt_pk_bf16_f32 v124, v136, v137
    v_fma_f32 v100, v88, v98, v70
    v_mfma_f32_16x16x32_bf16 v[64:67], v[32:35], a[140:143], v[64:67]
    s_waitcnt lgkmcnt(4)
    v_fma_f32 v101, v88, v99, v74
    v_mfma_f32_16x16x32_bf16 v[52:55], v[36:39], a[144:147], v[52:55]
    ds_read_b128 v[28:31], v13 offset:33024
    s_add_u32 m0, s21, 2048
    v_fma_f32 v96, -v89, v99, v100
    v_mfma_f32_16x16x32_bf16 v[56:59], v[36:39], a[148:151], v[56:59]
    buffer_load_dwordx4 v10, s[8:11], s20 offen lds
    v_fma_f32 v97, v89, v98, v101
    v_mfma_f32_16x16x32_bf16 v[60:63], v[40:43], a[144:147], v[60:63]
    ds_read_b128 v[32:35], v13 offset:35072
    v_mul_f32 v130, v90, v96
    v_mfma_f32_16x16x32_bf16 v[64:67], v[40:43], a[148:151], v[64:67]
    s_waitcnt lgkmcnt(4)
    v_mul_f32 v138, v90, v97
    v_fma_f32 v130, -v91, v97, v130
    v_mfma_f32_16x16x32_bf16 v[52:55], v[44:47], a[152:155], v[52:55]
    ds_read_b128 v[36:39], v14 offset:33024
    v_fma_f32 v138, -v91, v96, -v138
    v_mfma_f32_16x16x32_bf16 v[56:59], v[44:47], a[156:159], v[56:59]
    v_fma_f32 v100, v88, v96, v71
    v_fma_f32 v101, v88, v97, v75
    v_mfma_f32_16x16x32_bf16 v[60:63], v[48:51], a[152:155], v[60:63]
    ds_read_b128 v[40:43], v14 offset:35072
    v_fma_f32 v98, -v89, v97, v100
    v_mfma_f32_16x16x32_bf16 v[64:67], v[48:51], a[156:159], v[64:67]
    s_waitcnt lgkmcnt(4)
    v_fma_f32 v99, v89, v96, v101
    v_mul_f32 v131, v90, v98
    v_mfma_f32_16x16x32_bf16 v[52:55], v[20:23], a[160:163], v[52:55]
    ds_read_b128 v[44:47], v15 offset:33024
    s_add_u32 m0, s21, 3072
    v_mul_f32 v139, v90, v99
    v_mfma_f32_16x16x32_bf16 v[56:59], v[20:23], a[164:167], v[56:59]
    buffer_load_dwordx4 v11, s[8:11], s20 offen lds
    v_mfma_f32_16x16x32_bf16 v[60:63], v[24:27], a[160:163], v[60:63]
    ds_read_b128 v[48:51], v15 offset:35072
    v_fma_f32 v131, -v91, v99, v131
    v_fma_f32 v139, -v91, v98, -v139
    v_mfma_f32_16x16x32_bf16 v[64:67], v[24:27], a[164:167], v[64:67]
    s_waitcnt lgkmcnt(4)
    v_cvt_pk_bf16_f32 v121, v130, v131
    v_mfma_f32_16x16x32_bf16 v[52:55], v[28:31], a[168:171], v[52:55]
    s_waitcnt vmcnt(9)
    s_barrier
    ds_read_b128 v[20:23], v12 offset:49152
    v_mfma_f32_16x16x32_bf16 v[56:59], v[28:31], a[172:175], v[56:59]
    s_add_u32 s20, s20, 512
    buffer_atomic_add v84, v85, s[12:15], s39 offen sc1
    v_mfma_f32_16x16x32_bf16 v[60:63], v[32:35], a[168:171], v[60:63]
    ds_read_b128 v[24:27], v12 offset:51200
    v_cvt_pk_bf16_f32 v125, v138, v139
    v_fma_f32 v100, v88, v98, v76
    v_mfma_f32_16x16x32_bf16 v[64:67], v[32:35], a[172:175], v[64:67]
    s_waitcnt lgkmcnt(4)
    v_fma_f32 v101, v88, v99, v80
    v_mfma_f32_16x16x32_bf16 v[52:55], v[36:39], a[176:179], v[52:55]
    ds_read_b128 v[28:31], v13 offset:49152
    s_add_u32 m0, s21, 16384
    v_fma_f32 v96, -v89, v99, v100
    v_mfma_f32_16x16x32_bf16 v[56:59], v[36:39], a[180:183], v[56:59]
    buffer_load_dwordx4 v8, s[8:11], s20 offen lds
    v_fma_f32 v97, v89, v98, v101
    v_mfma_f32_16x16x32_bf16 v[60:63], v[40:43], a[176:179], v[60:63]
    ds_read_b128 v[32:35], v13 offset:51200
    v_mul_f32 v132, v90, v96
    v_mul_f32 v140, v90, v97
    v_mfma_f32_16x16x32_bf16 v[64:67], v[40:43], a[180:183], v[64:67]
    s_waitcnt lgkmcnt(4)
    v_fma_f32 v132, -v91, v97, v132
    v_mfma_f32_16x16x32_bf16 v[52:55], v[44:47], a[184:187], v[52:55]
    ds_read_b128 v[36:39], v14 offset:49152
    v_fma_f32 v140, -v91, v96, -v140
    v_fma_f32 v100, v88, v96, v77
    v_mfma_f32_16x16x32_bf16 v[56:59], v[44:47], a[188:191], v[56:59]
    v_fma_f32 v101, v88, v97, v81
    v_mfma_f32_16x16x32_bf16 v[60:63], v[48:51], a[184:187], v[60:63]
    ds_read_b128 v[40:43], v14 offset:51200
    v_fma_f32 v98, -v89, v97, v100
    v_fma_f32 v99, v89, v96, v101
    v_mfma_f32_16x16x32_bf16 v[64:67], v[48:51], a[188:191], v[64:67]
    s_waitcnt lgkmcnt(4)
    v_mul_f32 v133, v90, v98
    v_mfma_f32_16x16x32_bf16 v[52:55], v[20:23], a[192:195], v[52:55]
    ds_read_b128 v[44:47], v15 offset:49152
    s_add_u32 m0, s21, 17408
    v_mul_f32 v141, v90, v99
    v_mfma_f32_16x16x32_bf16 v[56:59], v[20:23], a[196:199], v[56:59]
    buffer_load_dwordx4 v9, s[8:11], s20 offen lds
    v_fma_f32 v133, -v91, v99, v133
    v_mfma_f32_16x16x32_bf16 v[60:63], v[24:27], a[192:195], v[60:63]
    ds_read_b128 v[48:51], v15 offset:51200
    v_fma_f32 v141, -v91, v98, -v141
    v_mfma_f32_16x16x32_bf16 v[64:67], v[24:27], a[196:199], v[64:67]
    s_waitcnt lgkmcnt(4)
    v_cvt_pk_bf16_f32 v122, v132, v133
    v_cvt_pk_bf16_f32 v126, v140, v141
    v_mfma_f32_16x16x32_bf16 v[52:55], v[28:31], a[200:203], v[52:55]
    ds_read_b128 v[20:23], v12 offset:49408
    v_fma_f32 v100, v88, v98, v78
    v_mfma_f32_16x16x32_bf16 v[56:59], v[28:31], a[204:207], v[56:59]
    v_fma_f32 v101, v88, v99, v82
    v_fma_f32 v96, -v89, v99, v100
    v_mfma_f32_16x16x32_bf16 v[60:63], v[32:35], a[200:203], v[60:63]
    ds_read_b128 v[24:27], v12 offset:51456
    v_fma_f32 v97, v89, v98, v101
    v_mfma_f32_16x16x32_bf16 v[64:67], v[32:35], a[204:207], v[64:67]
    s_waitcnt lgkmcnt(4)
    v_mul_f32 v134, v90, v96
    v_mul_f32 v142, v90, v97
    v_mfma_f32_16x16x32_bf16 v[52:55], v[36:39], a[208:211], v[52:55]
    ds_read_b128 v[28:31], v13 offset:49408
    s_add_u32 m0, s21, 18432
    v_fma_f32 v134, -v91, v97, v134
    v_mfma_f32_16x16x32_bf16 v[56:59], v[36:39], a[212:215], v[56:59]
    buffer_load_dwordx4 v10, s[8:11], s20 offen lds
    v_mfma_f32_16x16x32_bf16 v[60:63], v[40:43], a[208:211], v[60:63]
    ds_read_b128 v[32:35], v13 offset:51456
    v_fma_f32 v142, -v91, v96, -v142
    v_fma_f32 v100, v88, v96, v79
    v_mfma_f32_16x16x32_bf16 v[64:67], v[40:43], a[212:215], v[64:67]
    s_waitcnt lgkmcnt(4)
    v_fma_f32 v101, v88, v97, v83
    v_mfma_f32_16x16x32_bf16 v[52:55], v[44:47], a[216:219], v[52:55]
    ds_read_b128 v[36:39], v14 offset:49408
    v_fma_f32 v98, -v89, v97, v100
    v_fma_f32 v99, v89, v96, v101
    v_mfma_f32_16x16x32_bf16 v[56:59], v[44:47], a[220:223], v[56:59]
    v_mul_f32 v135, v90, v98
    v_mfma_f32_16x16x32_bf16 v[60:63], v[48:51], a[216:219], v[60:63]
    ds_read_b128 v[40:43], v14 offset:51456
    v_mul_f32 v143, v90, v99
    v_fma_f32 v135, -v91, v99, v135
    v_mfma_f32_16x16x32_bf16 v[64:67], v[48:51], a[220:223], v[64:67]
    s_waitcnt lgkmcnt(4)
    v_fma_f32 v143, -v91, v98, -v143
    v_mfma_f32_16x16x32_bf16 v[52:55], v[20:23], a[224:227], v[52:55]
    ds_read_b128 v[44:47], v15 offset:49408
    s_add_u32 m0, s21, 19456
    v_cvt_pk_bf16_f32 v123, v134, v135
    v_mfma_f32_16x16x32_bf16 v[56:59], v[20:23], a[228:231], v[56:59]
    buffer_load_dwordx4 v11, s[8:11], s20 offen lds
    v_cvt_pk_bf16_f32 v127, v142, v143
    v_mfma_f32_16x16x32_bf16 v[60:63], v[24:27], a[224:227], v[60:63]
    ds_read_b128 v[48:51], v15 offset:51456
    ds_write_b128 v116, v[120:123] offset:0
    ds_write_b128 v116, v[124:127] offset:1024
    v_mfma_f32_16x16x32_bf16 v[64:67], v[24:27], a[228:231], v[64:67]
    s_waitcnt lgkmcnt(4)
    ds_read_b64_tr_b16 v[144:145], v117 offset:0
    v_mfma_f32_16x16x32_bf16 v[52:55], v[28:31], a[232:235], v[52:55]
    s_waitcnt vmcnt(20)
    s_barrier
    ds_read_b128 v[20:23], v16 offset:0
    v_mfma_f32_16x16x32_bf16 v[56:59], v[28:31], a[236:239], v[56:59]
    s_add_u32 s20, s20, 512
    ds_read_b64_tr_b16 v[146:147], v118 offset:256
    v_mfma_f32_16x16x32_bf16 v[60:63], v[32:35], a[232:235], v[60:63]
    ds_read_b128 v[24:27], v16 offset:2048
    ds_read_b64_tr_b16 v[148:149], v117 offset:1024
    v_mfma_f32_16x16x32_bf16 v[64:67], v[32:35], a[236:239], v[64:67]
    s_waitcnt lgkmcnt(4)
    ds_read_b64_tr_b16 v[150:151], v118 offset:1280
    s_sub_u32 s39, s22, 1
    v_mfma_f32_16x16x32_bf16 v[52:55], v[36:39], a[240:243], v[52:55]
    ds_read_b128 v[28:31], v17 offset:0
    s_add_u32 m0, s21, 32768
    s_lshl_b32 s38, s39, 17
    v_mfma_f32_16x16x32_bf16 v[56:59], v[36:39], a[244:247], v[56:59]
    buffer_load_dwordx4 v8, s[8:11], s20 offen lds
    v_mfma_f32_16x16x32_bf16 v[60:63], v[40:43], a[240:243], v[60:63]
    ds_read_b128 v[32:35], v17 offset:2048
    s_add_u32 s38, s38, 0x4400000
    s_add_u32 s43, s38, 0x10000
    v_mfma_f32_16x16x32_bf16 v[64:67], v[40:43], a[244:247], v[64:67]
    s_waitcnt lgkmcnt(4)
    s_lshl_b32 s39, s39, 7
    v_mfma_f32_16x16x32_bf16 v[52:55], v[44:47], a[248:251], v[52:55]
    ds_read_b128 v[36:39], v18 offset:0
    s_add_u32 s39, s39, 0x5902000
    s_cmp_eq_u32 s37, 0
    s_cselect_b32 s38, 0x7ff00000, s38
    s_cselect_b32 s39, 0x7ff00000, s39
    s_cselect_b32 s43, 0x7ff00000, s43
    v_mfma_f32_16x16x32_bf16 v[56:59], v[44:47], a[252:255], v[56:59]
    v_mfma_f32_16x16x32_bf16 v[60:63], v[48:51], a[248:251], v[60:63]
    ds_read_b128 v[40:43], v18 offset:2048
    v_mfma_f32_16x16x32_bf16 v[64:67], v[48:51], a[252:255], v[64:67]
    s_waitcnt lgkmcnt(4)
    s_mov_b32 s37, 1
    s_add_u32 s22, s22, 1
    s_cmp_ge_u32 s22, s23
    s_cbranch_scc1 L_fl0_227
    v_mfma_f32_16x16x32_bf16 v[68:71], v[20:23], a[0:3], 0
    ds_read_b128 v[44:47], v19 offset:0
    s_add_u32 m0, s21, 33792
    v_mfma_f32_16x16x32_bf16 v[72:75], v[20:23], a[4:7], 0
    buffer_load_dwordx4 v9, s[8:11], s20 offen lds
    v_mfma_f32_16x16x32_bf16 v[76:79], v[24:27], a[0:3], 0
    ds_read_b128 v[48:51], v19 offset:2048
    v_mfma_f32_16x16x32_bf16 v[80:83], v[24:27], a[4:7], 0
    s_waitcnt lgkmcnt(4)
    v_fma_f32 v100, v88, v52, v53
    v_fma_f32 v101, v88, v56, v57
    v_mfma_f32_16x16x32_bf16 v[68:71], v[28:31], a[8:11], v[68:71]
    ds_read_b128 v[20:23], v16 offset:256
    s_waitcnt lgkmcnt(7)
    v_fma_f32 v96, -v89, v56, v100
    v_mfma_f32_16x16x32_bf16 v[72:75], v[28:31], a[12:15], v[72:75]
    buffer_store_dwordx4 v[144:147], v86, s[12:15], s38 offen sc1
    v_fma_f32 v97, v89, v52, v101
    v_mfma_f32_16x16x32_bf16 v[76:79], v[32:35], a[8:11], v[76:79]
    ds_read_b128 v[24:27], v16 offset:2304
    v_fma_f32 v100, v88, v96, v54
    v_mfma_f32_16x16x32_bf16 v[80:83], v[32:35], a[12:15], v[80:83]
    s_waitcnt lgkmcnt(4)
    v_fma_f32 v101, v88, v97, v58
    v_fma_f32 v98, -v89, v97, v100
    v_mfma_f32_16x16x32_bf16 v[68:71], v[36:39], a[16:19], v[68:71]
    ds_read_b128 v[28:31], v17 offset:256
    s_add_u32 m0, s21, 34816
    v_mfma_f32_16x16x32_bf16 v[72:75], v[36:39], a[20:23], v[72:75]
    buffer_load_dwordx4 v10, s[8:11], s20 offen lds
    v_fma_f32 v99, v89, v96, v101
    v_mfma_f32_16x16x32_bf16 v[76:79], v[40:43], a[16:19], v[76:79]
    ds_read_b128 v[32:35], v17 offset:2304
    v_fma_f32 v100, v88, v98, v55
    v_fma_f32 v101, v88, v99, v59
    v_mfma_f32_16x16x32_bf16 v[80:83], v[40:43], a[20:23], v[80:83]
    s_waitcnt lgkmcnt(4)
    v_fma_f32 v96, -v89, v99, v100
    v_mfma_f32_16x16x32_bf16 v[68:71], v[44:47], a[24:27], v[68:71]
    ds_read_b128 v[36:39], v18 offset:256
    v_fma_f32 v97, v89, v98, v101
    v_fma_f32 v100, v88, v96, v60
    v_mfma_f32_16x16x32_bf16 v[72:75], v[44:47], a[28:31], v[72:75]
    buffer_store_dwordx4 v[148:151], v86, s[12:15], s43 offen sc1
    v_mfma_f32_16x16x32_bf16 v[76:79], v[48:51], a[24:27], v[76:79]
    ds_read_b128 v[40:43], v18 offset:2304
    v_fma_f32 v101, v88, v97, v64
    v_fma_f32 v98, -v89, v97, v100
    v_mfma_f32_16x16x32_bf16 v[80:83], v[48:51], a[28:31], v[80:83]
    s_waitcnt lgkmcnt(4)
    v_fma_f32 v99, v89, v96, v101
    v_mfma_f32_16x16x32_bf16 v[68:71], v[20:23], a[32:35], v[68:71]
    ds_read_b128 v[44:47], v19 offset:256
    s_add_u32 m0, s21, 35840
    v_fma_f32 v100, v88, v98, v61
    v_mfma_f32_16x16x32_bf16 v[72:75], v[20:23], a[36:39], v[72:75]
    buffer_load_dwordx4 v11, s[8:11], s20 offen lds
    v_fma_f32 v101, v88, v99, v65
    v_mfma_f32_16x16x32_bf16 v[76:79], v[24:27], a[32:35], v[76:79]
    ds_read_b128 v[48:51], v19 offset:2304
    v_fma_f32 v96, -v89, v99, v100
    v_fma_f32 v97, v89, v98, v101
    v_mfma_f32_16x16x32_bf16 v[80:83], v[24:27], a[36:39], v[80:83]
    s_waitcnt lgkmcnt(4)
    v_fma_f32 v100, v88, v96, v62
    v_mfma_f32_16x16x32_bf16 v[68:71], v[28:31], a[40:43], v[68:71]
    s_waitcnt vmcnt(20)
    s_barrier
    ds_read_b128 v[20:23], v16 offset:16384
    v_mfma_f32_16x16x32_bf16 v[72:75], v[28:31], a[44:47], v[72:75]
    s_add_u32 s20, s20, 512
    v_fma_f32 v101, v88, v97, v66
    v_mfma_f32_16x16x32_bf16 v[76:79], v[32:35], a[40:43], v[76:79]
    ds_read_b128 v[24:27], v16 offset:18432
    v_fma_f32 v98, -v89, v97, v100
    v_mfma_f32_16x16x32_bf16 v[80:83], v[32:35], a[44:47], v[80:83]
    s_waitcnt lgkmcnt(4)
    v_fma_f32 v99, v89, v96, v101
    v_fma_f32 v100, v88, v98, v63
    v_mfma_f32_16x16x32_bf16 v[68:71], v[36:39], a[48:51], v[68:71]
    ds_read_b128 v[28:31], v17 offset:16384
    s_add_u32 m0, s21, 49152
    v_fma_f32 v101, v88, v99, v67
    v_mfma_f32_16x16x32_bf16 v[72:75], v[36:39], a[52:55], v[72:75]
    buffer_load_dwordx4 v8, s[8:11], s20 offen lds
    v_mfma_f32_16x16x32_bf16 v[76:79], v[40:43], a[48:51], v[76:79]
    ds_read_b128 v[32:35], v17 offset:18432
    v_fma_f32 v102, -v89, v99, v100
    v_fma_f32 v106, v89, v98, v101
    v_mfma_f32_16x16x32_bf16 v[80:83], v[40:43], a[52:55], v[80:83]
    s_waitcnt lgkmcnt(4)
    v_mov_b32 v103, v102
    v_mfma_f32_16x16x32_bf16 v[68:71], v[44:47], a[56:59], v[68:71]
    ds_read_b128 v[36:39], v18 offset:16384
    v_mov_b32 v107, v106
    s_nop 1
    v_mfma_f32_16x16x32_bf16 v[72:75], v[44:47], a[60:63], v[72:75]
    v_permlane16_swap_b32 v102, v103
    v_mfma_f32_16x16x32_bf16 v[76:79], v[48:51], a[56:59], v[76:79]
    ds_read_b128 v[40:43], v18 offset:18432
    v_permlane16_swap_b32 v106, v107
    v_mov_b32 v104, v102
    v_mfma_f32_16x16x32_bf16 v[80:83], v[48:51], a[60:63], v[80:83]
    s_waitcnt lgkmcnt(4)
    v_mov_b32 v105, v103
    v_mov_b32 v108, v106
    v_mfma_f32_16x16x32_bf16 v[68:71], v[20:23], a[64:67], v[68:71]
    ds_read_b128 v[44:47], v19 offset:16384
    s_add_u32 m0, s21, 50176
    v_mfma_f32_16x16x32_bf16 v[72:75], v[20:23], a[68:71], v[72:75]
    buffer_load_dwordx4 v9, s[8:11], s20 offen lds
    v_mov_b32 v109, v107
    v_mfma_f32_16x16x32_bf16 v[76:79], v[24:27], a[64:67], v[76:79]
    ds_read_b128 v[48:51], v19 offset:18432
    s_nop 0
    v_permlane32_swap_b32 v102, v104
    v_mfma_f32_16x16x32_bf16 v[80:83], v[24:27], a[68:71], v[80:83]
    s_waitcnt lgkmcnt(4)
    v_permlane32_swap_b32 v103, v105
    v_mfma_f32_16x16x32_bf16 v[68:71], v[28:31], a[72:75], v[68:71]
    ds_read_b128 v[20:23], v16 offset:16640
    v_permlane32_swap_b32 v106, v108
    v_permlane32_swap_b32 v107, v109
    v_mfma_f32_16x16x32_bf16 v[72:75], v[28:31], a[76:79], v[72:75]
    v_fma_f32 v100, v92, v94, v102
    v_mfma_f32_16x16x32_bf16 v[76:79], v[32:35], a[72:75], v[76:79]
    ds_read_b128 v[24:27], v16 offset:18688
    s_add_u32 s24, s24, 1
    v_fma_f32 v101, v92, v95, v106
    v_mfma_f32_16x16x32_bf16 v[80:83], v[32:35], a[76:79], v[80:83]
    s_waitcnt lgkmcnt(4)
    v_fma_f32 v110, -v93, v95, v100
    v_mfma_f32_16x16x32_bf16 v[68:71], v[36:39], a[80:83], v[68:71]
    ds_read_b128 v[28:31], v17 offset:16640
    s_add_u32 m0, s21, 51200
    v_fma_f32 v111, v93, v94, v101
    v_mfma_f32_16x16x32_bf16 v[72:75], v[36:39], a[84:87], v[72:75]
    buffer_load_dwordx4 v10, s[8:11], s20 offen lds
    v_cndmask_b32 v98, v94, v110, s[56:57]
    v_mfma_f32_16x16x32_bf16 v[76:79], v[40:43], a[80:83], v[76:79]
    ds_read_b128 v[32:35], v17 offset:18688
    v_cndmask_b32 v99, v95, v111, s[56:57]
    v_mfma_f32_16x16x32_bf16 v[80:83], v[40:43], a[84:87], v[80:83]
    s_waitcnt lgkmcnt(4)
    s_min_u32 s24, s24, 63
    v_fma_f32 v100, v92, v110, v103
    v_mfma_f32_16x16x32_bf16 v[68:71], v[44:47], a[88:91], v[68:71]
    ds_read_b128 v[36:39], v18 offset:16640
    v_fma_f32 v101, v92, v111, v107
    v_fma_f32 v112, -v93, v111, v100
    v_mfma_f32_16x16x32_bf16 v[72:75], v[44:47], a[92:95], v[72:75]
    v_fma_f32 v113, v93, v110, v101
    v_mfma_f32_16x16x32_bf16 v[76:79], v[48:51], a[88:91], v[76:79]
    ds_read_b128 v[40:43], v18 offset:18688
    s_lshl_b32 s53, s24, 16
    v_cndmask_b32 v98, v98, v112, s[58:59]
    v_mfma_f32_16x16x32_bf16 v[80:83], v[48:51], a[92:95], v[80:83]
    s_waitcnt lgkmcnt(4)
    v_cndmask_b32 v99, v99, v113, s[58:59]
    v_fma_f32 v100, v92, v112, v104
    v_mfma_f32_16x16x32_bf16 v[68:71], v[20:23], a[96:99], v[68:71]
    ds_read_b128 v[44:47], v19 offset:16640
    s_add_u32 m0, s21, 52224
    v_mfma_f32_16x16x32_bf16 v[72:75], v[20:23], a[100:103], v[72:75]
    buffer_load_dwordx4 v11, s[8:11], s20 offen lds
    v_fma_f32 v101, v92, v113, v108
    v_mfma_f32_16x16x32_bf16 v[76:79], v[24:27], a[96:99], v[76:79]
    ds_read_b128 v[48:51], v19 offset:18688
    v_fma_f32 v114, -v93, v113, v100
    v_fma_f32 v115, v93, v112, v101
    v_mfma_f32_16x16x32_bf16 v[80:83], v[24:27], a[100:103], v[80:83]
    s_waitcnt lgkmcnt(4)
    v_cndmask_b32 v98, v98, v114, s[60:61]
    v_mfma_f32_16x16x32_bf16 v[68:71], v[28:31], a[104:107], v[68:71]
    s_waitcnt vmcnt(20)
    s_barrier
    ds_read_b128 v[20:23], v16 offset:32768
    v_mfma_f32_16x16x32_bf16 v[72:75], v[28:31], a[108:111], v[72:75]
    s_mov_b32 s20, s53
    v_cndmask_b32 v99, v99, v115, s[60:61]
    v_mfma_f32_16x16x32_bf16 v[76:79], v[32:35], a[104:107], v[76:79]
    ds_read_b128 v[24:27], v16 offset:34816
    v_fma_f32 v100, v92, v114, v105
    v_mfma_f32_16x16x32_bf16 v[80:83], v[32:35], a[108:111], v[80:83]
    s_waitcnt lgkmcnt(4)
    v_fma_f32 v101, v92, v115, v109
    v_fma_f32 v94, -v93, v115, v100
    v_mfma_f32_16x16x32_bf16 v[68:71], v[36:39], a[112:115], v[68:71]
    ds_read_b128 v[28:31], v17 offset:32768
    s_add_u32 m0, s21, 65536
    v_fma_f32 v95, v93, v114, v101
    v_mfma_f32_16x16x32_bf16 v[72:75], v[36:39], a[116:119], v[72:75]
    buffer_load_dwordx4 v8, s[8:11], s20 offen lds
    v_mfma_f32_16x16x32_bf16 v[76:79], v[40:43], a[112:115], v[76:79]
    ds_read_b128 v[32:35], v17 offset:34816
    v_fma_f32 v100, v88, v98, v52
    v_fma_f32 v101, v88, v99, v56
    v_mfma_f32_16x16x32_bf16 v[80:83], v[40:43], a[116:119], v[80:83]
    s_waitcnt lgkmcnt(4)
    v_fma_f32 v96, -v89, v99, v100
    v_mfma_f32_16x16x32_bf16 v[68:71], v[44:47], a[120:123], v[68:71]
    ds_read_b128 v[36:39], v18 offset:32768
    v_fma_f32 v97, v89, v98, v101
    v_mul_f32 v128, v90, v96
    v_mfma_f32_16x16x32_bf16 v[72:75], v[44:47], a[124:127], v[72:75]
    v_mul_f32 v136, v90, v97
    v_fma_f32 v128, -v91, v97, v128
    v_mfma_f32_16x16x32_bf16 v[76:79], v[48:51], a[120:123], v[76:79]
    ds_read_b128 v[40:43], v18 offset:34816
    v_fma_f32 v136, -v91, v96, -v136
    v_mfma_f32_16x16x32_bf16 v[80:83], v[48:51], a[124:127], v[80:83]
    s_waitcnt lgkmcnt(4)
    v_fma_f32 v100, v88, v96, v53
    v_fma_f32 v101, v88, v97, v57
    v_mfma_f32_16x16x32_bf16 v[68:71], v[20:23], a[128:131], v[68:71]
    ds_read_b128 v[44:47], v19 offset:32768
    s_add_u32 m0, s21, 66560
    v_mfma_f32_16x16x32_bf16 v[72:75], v[20:23], a[132:135], v[72:75]
    buffer_load_dwordx4 v9, s[8:11], s20 offen lds
    v_fma_f32 v98, -v89, v97, v100
    v_mfma_f32_16x16x32_bf16 v[76:79], v[24:27], a[128:131], v[76:79]
    ds_read_b128 v[48:51], v19 offset:34816
    v_fma_f32 v99, v89, v96, v101
    v_mul_f32 v129, v90, v98
    v_mfma_f32_16x16x32_bf16 v[80:83], v[24:27], a[132:135], v[80:83]
    s_waitcnt lgkmcnt(4)
    v_mul_f32 v137, v90, v99
    v_mfma_f32_16x16x32_bf16 v[68:71], v[28:31], a[136:139], v[68:71]
    ds_read_b128 v[20:23], v16 offset:33024
    v_fma_f32 v129, -v91, v99, v129
    v_fma_f32 v137, -v91, v98, -v137
    v_mfma_f32_16x16x32_bf16 v[72:75], v[28:31], a[140:143], v[72:75]
    v_cvt_pk_bf16_f32 v120, v128, v129
    v_mfma_f32_16x16x32_bf16 v[76:79], v[32:35], a[136:139], v[76:79]
    ds_read_b128 v[24:27], v16 offset:35072
    v_cvt_pk_bf16_f32 v124, v136, v137
    v_fma_f32 v100, v88, v98, v54
    v_mfma_f32_16x16x32_bf16 v[80:83], v[32:35], a[140:143], v[80:83]
    s_waitcnt lgkmcnt(4)
    v_fma_f32 v101, v88, v99, v58
    v_mfma_f32_16x16x32_bf16 v[68:71], v[36:39], a[144:147], v[68:71]
    ds_read_b128 v[28:31], v17 offset:33024
    s_add_u32 m0, s21, 67584
    v_fma_f32 v96, -v89, v99, v100
    v_mfma_f32_16x16x32_bf16 v[72:75], v[36:39], a[148:151], v[72:75]
    buffer_load_dwordx4 v10, s[8:11], s20 offen lds
    v_fma_f32 v97, v89, v98, v101
    v_mfma_f32_16x16x32_bf16 v[76:79], v[40:43], a[144:147], v[76:79]
    ds_read_b128 v[32:35], v17 offset:35072
    v_mul_f32 v130, v90, v96
    v_mfma_f32_16x16x32_bf16 v[80:83], v[40:43], a[148:151], v[80:83]
    s_waitcnt lgkmcnt(4)
    v_mul_f32 v138, v90, v97
    v_fma_f32 v130, -v91, v97, v130
    v_mfma_f32_16x16x32_bf16 v[68:71], v[44:47], a[152:155], v[68:71]
    ds_read_b128 v[36:39], v18 offset:33024
    v_fma_f32 v138, -v91, v96, -v138
    v_mfma_f32_16x16x32_bf16 v[72:75], v[44:47], a[156:159], v[72:75]
    v_fma_f32 v100, v88, v96, v55
    v_fma_f32 v101, v88, v97, v59
    v_mfma_f32_16x16x32_bf16 v[76:79], v[48:51], a[152:155], v[76:79]
    ds_read_b128 v[40:43], v18 offset:35072
    v_fma_f32 v98, -v89, v97, v100
    v_mfma_f32_16x16x32_bf16 v[80:83], v[48:51], a[156:159], v[80:83]
    s_waitcnt lgkmcnt(4)
    v_fma_f32 v99, v89, v96, v101
    v_mul_f32 v131, v90, v98
    v_mfma_f32_16x16x32_bf16 v[68:71], v[20:23], a[160:163], v[68:71]
    ds_read_b128 v[44:47], v19 offset:33024
    s_add_u32 m0, s21, 68608
    v_mul_f32 v139, v90, v99
    v_mfma_f32_16x16x32_bf16 v[72:75], v[20:23], a[164:167], v[72:75]
    buffer_load_dwordx4 v11, s[8:11], s20 offen lds
    v_mfma_f32_16x16x32_bf16 v[76:79], v[24:27], a[160:163], v[76:79]
    ds_read_b128 v[48:51], v19 offset:35072
    v_fma_f32 v131, -v91, v99, v131
    v_fma_f32 v139, -v91, v98, -v139
    v_mfma_f32_16x16x32_bf16 v[80:83], v[24:27], a[164:167], v[80:83]
    s_waitcnt lgkmcnt(4)
    v_cvt_pk_bf16_f32 v121, v130, v131
    v_mfma_f32_16x16x32_bf16 v[68:71], v[28:31], a[168:171], v[68:71]
    s_waitcnt vmcnt(9)
    s_barrier
    ds_read_b128 v[20:23], v16 offset:49152
    v_mfma_f32_16x16x32_bf16 v[72:75], v[28:31], a[172:175], v[72:75]
    s_add_u32 s20, s20, 512
    buffer_atomic_add v84, v85, s[12:15], s39 offen sc1
    v_mfma_f32_16x16x32_bf16 v[76:79], v[32:35], a[168:171], v[76:79]
    ds_read_b128 v[24:27], v16 offset:51200
    v_cvt_pk_bf16_f32 v125, v138, v139
    v_fma_f32 v100, v88, v98, v60
    v_mfma_f32_16x16x32_bf16 v[80:83], v[32:35], a[172:175], v[80:83]
    s_waitcnt lgkmcnt(4)
    v_fma_f32 v101, v88, v99, v64
    v_mfma_f32_16x16x32_bf16 v[68:71], v[36:39], a[176:179], v[68:71]
    ds_read_b128 v[28:31], v17 offset:49152
    s_add_u32 m0, s21, 81920
    v_fma_f32 v96, -v89, v99, v100
    v_mfma_f32_16x16x32_bf16 v[72:75], v[36:39], a[180:183], v[72:75]
    buffer_load_dwordx4 v8, s[8:11], s20 offen lds
    v_fma_f32 v97, v89, v98, v101
    v_mfma_f32_16x16x32_bf16 v[76:79], v[40:43], a[176:179], v[76:79]
    ds_read_b128 v[32:35], v17 offset:51200
    v_mul_f32 v132, v90, v96
    v_mul_f32 v140, v90, v97
    v_mfma_f32_16x16x32_bf16 v[80:83], v[40:43], a[180:183], v[80:83]
    s_waitcnt lgkmcnt(4)
    v_fma_f32 v132, -v91, v97, v132
    v_mfma_f32_16x16x32_bf16 v[68:71], v[44:47], a[184:187], v[68:71]
    ds_read_b128 v[36:39], v18 offset:49152
    v_fma_f32 v140, -v91, v96, -v140
    v_fma_f32 v100, v88, v96, v61
    v_mfma_f32_16x16x32_bf16 v[72:75], v[44:47], a[188:191], v[72:75]
    v_fma_f32 v101, v88, v97, v65
    v_mfma_f32_16x16x32_bf16 v[76:79], v[48:51], a[184:187], v[76:79]
    ds_read_b128 v[40:43], v18 offset:51200
    v_fma_f32 v98, -v89, v97, v100
    v_fma_f32 v99, v89, v96, v101
    v_mfma_f32_16x16x32_bf16 v[80:83], v[48:51], a[188:191], v[80:83]
    s_waitcnt lgkmcnt(4)
    v_mul_f32 v133, v90, v98
    v_mfma_f32_16x16x32_bf16 v[68:71], v[20:23], a[192:195], v[68:71]
    ds_read_b128 v[44:47], v19 offset:49152
    s_add_u32 m0, s21, 82944
    v_mul_f32 v141, v90, v99
    v_mfma_f32_16x16x32_bf16 v[72:75], v[20:23], a[196:199], v[72:75]
    buffer_load_dwordx4 v9, s[8:11], s20 offen lds
    v_fma_f32 v133, -v91, v99, v133
    v_mfma_f32_16x16x32_bf16 v[76:79], v[24:27], a[192:195], v[76:79]
    ds_read_b128 v[48:51], v19 offset:51200
    v_fma_f32 v141, -v91, v98, -v141
    v_mfma_f32_16x16x32_bf16 v[80:83], v[24:27], a[196:199], v[80:83]
    s_waitcnt lgkmcnt(4)
    v_cvt_pk_bf16_f32 v122, v132, v133
    v_cvt_pk_bf16_f32 v126, v140, v141
    v_mfma_f32_16x16x32_bf16 v[68:71], v[28:31], a[200:203], v[68:71]
    ds_read_b128 v[20:23], v16 offset:49408
    v_fma_f32 v100, v88, v98, v62
    v_mfma_f32_16x16x32_bf16 v[72:75], v[28:31], a[204:207], v[72:75]
    v_fma_f32 v101, v88, v99, v66
    v_fma_f32 v96, -v89, v99, v100
    v_mfma_f32_16x16x32_bf16 v[76:79], v[32:35], a[200:203], v[76:79]
    ds_read_b128 v[24:27], v16 offset:51456
    v_fma_f32 v97, v89, v98, v101
    v_mfma_f32_16x16x32_bf16 v[80:83], v[32:35], a[204:207], v[80:83]
    s_waitcnt lgkmcnt(4)
    v_mul_f32 v134, v90, v96
    v_mul_f32 v142, v90, v97
    v_mfma_f32_16x16x32_bf16 v[68:71], v[36:39], a[208:211], v[68:71]
    ds_read_b128 v[28:31], v17 offset:49408
    s_add_u32 m0, s21, 83968
    v_fma_f32 v134, -v91, v97, v134
    v_mfma_f32_16x16x32_bf16 v[72:75], v[36:39], a[212:215], v[72:75]
    buffer_load_dwordx4 v10, s[8:11], s20 offen lds
    v_mfma_f32_16x16x32_bf16 v[76:79], v[40:43], a[208:211], v[76:79]
    ds_read_b128 v[32:35], v17 offset:51456
    v_fma_f32 v142, -v91, v96, -v142
    v_fma_f32 v100, v88, v96, v63
    v_mfma_f32_16x16x32_bf16 v[80:83], v[40:43], a[212:215], v[80:83]
    s_waitcnt lgkmcnt(4)
    v_fma_f32 v101, v88, v97, v67
    v_mfma_f32_16x16x32_bf16 v[68:71], v[44:47], a[216:219], v[68:71]
    ds_read_b128 v[36:39], v18 offset:49408
    v_fma_f32 v98, -v89, v97, v100
    v_fma_f32 v99, v89, v96, v101
    v_mfma_f32_16x16x32_bf16 v[72:75], v[44:47], a[220:223], v[72:75]
    v_mul_f32 v135, v90, v98
    v_mfma_f32_16x16x32_bf16 v[76:79], v[48:51], a[216:219], v[76:79]
    ds_read_b128 v[40:43], v18 offset:51456
    v_mul_f32 v143, v90, v99
    v_fma_f32 v135, -v91, v99, v135
    v_mfma_f32_16x16x32_bf16 v[80:83], v[48:51], a[220:223], v[80:83]
    s_waitcnt lgkmcnt(4)
    v_fma_f32 v143, -v91, v98, -v143
    v_mfma_f32_16x16x32_bf16 v[68:71], v[20:23], a[224:227], v[68:71]
    ds_read_b128 v[44:47], v19 offset:49408
    s_add_u32 m0, s21, 84992
    v_cvt_pk_bf16_f32 v123, v134, v135
    v_mfma_f32_16x16x32_bf16 v[72:75], v[20:23], a[228:231], v[72:75]
    buffer_load_dwordx4 v11, s[8:11], s20 offen lds
    v_cvt_pk_bf16_f32 v127, v142, v143
    v_mfma_f32_16x16x32_bf16 v[76:79], v[24:27], a[224:227], v[76:79]
    ds_read_b128 v[48:51], v19 offset:51456
    ds_write_b128 v116, v[120:123] offset:0
    ds_write_b128 v116, v[124:127] offset:1024
    v_mfma_f32_16x16x32_bf16 v[80:83], v[24:27], a[228:231], v[80:83]
    s_waitcnt lgkmcnt(4)
    ds_read_b64_tr_b16 v[144:145], v117 offset:0
    v_mfma_f32_16x16x32_bf16 v[68:71], v[28:31], a[232:235], v[68:71]
    s_waitcnt vmcnt(20)
    s_barrier
    ds_read_b128 v[20:23], v12 offset:0
    v_mfma_f32_16x16x32_bf16 v[72:75], v[28:31], a[236:239], v[72:75]
    s_add_u32 s20, s20, 512
    ds_read_b64_tr_b16 v[146:147], v118 offset:256
    v_mfma_f32_16x16x32_bf16 v[76:79], v[32:35], a[232:235], v[76:79]
    ds_read_b128 v[24:27], v12 offset:2048
    ds_read_b64_tr_b16 v[148:149], v117 offset:1024
    v_mfma_f32_16x16x32_bf16 v[80:83], v[32:35], a[236:239], v[80:83]
    s_waitcnt lgkmcnt(4)
    ds_read_b64_tr_b16 v[150:151], v118 offset:1280
    s_sub_u32 s39, s22, 1
    v_mfma_f32_16x16x32_bf16 v[68:71], v[36:39], a[240:243], v[68:71]
    ds_read_b128 v[28:31], v13 offset:0
    s_add_u32 m0, s21, 98304
    s_lshl_b32 s38, s39, 17
    v_mfma_f32_16x16x32_bf16 v[72:75], v[36:39], a[244:247], v[72:75]
    buffer_load_dwordx4 v8, s[8:11], s20 offen lds
    v_mfma_f32_16x16x32_bf16 v[76:79], v[40:43], a[240:243], v[76:79]
    ds_read_b128 v[32:35], v13 offset:2048
    s_add_u32 s38, s38, 0x4400000
    s_add_u32 s43, s38, 0x10000
    v_mfma_f32_16x16x32_bf16 v[80:83], v[40:43], a[244:247], v[80:83]
    s_waitcnt lgkmcnt(4)
    s_lshl_b32 s39, s39, 7
    v_mfma_f32_16x16x32_bf16 v[68:71], v[44:47], a[248:251], v[68:71]
    ds_read_b128 v[36:39], v14 offset:0
    s_add_u32 s39, s39, 0x5902000
    s_cmp_eq_u32 s37, 0
    s_cselect_b32 s38, 0x7ff00000, s38
    s_cselect_b32 s39, 0x7ff00000, s39
    s_cselect_b32 s43, 0x7ff00000, s43
    v_mfma_f32_16x16x32_bf16 v[72:75], v[44:47], a[252:255], v[72:75]
    v_mfma_f32_16x16x32_bf16 v[76:79], v[48:51], a[248:251], v[76:79]
    ds_read_b128 v[40:43], v14 offset:2048
    v_mfma_f32_16x16x32_bf16 v[80:83], v[48:51], a[252:255], v[80:83]
    s_waitcnt lgkmcnt(4)
    s_mov_b32 s37, 1
    s_add_u32 s22, s22, 1
    s_cmp_ge_u32 s22, s23
    s_cbranch_scc0 L_st_226
    s_waitcnt lgkmcnt(0)
    s_nop 7
    s_waitcnt lgkmcnt(0)
    buffer_store_dwordx4 v[144:147], v86, s[12:15], s38 offen sc1
    buffer_store_dwordx4 v[148:151], v86, s[12:15], s43 offen sc1
    s_waitcnt vmcnt(0)
    s_barrier
    buffer_atomic_add v84, v85, s[12:15], s39 offen sc1
    v_fma_f32 v100, v88, v68, v69
    v_fma_f32 v101, v88, v72, v73
    v_fma_f32 v96, -v89, v72, v100
    v_fma_f32 v97, v89, v68, v101
    v_fma_f32 v100, v88, v96, v70
    v_fma_f32 v101, v88, v97, v74
    v_fma_f32 v98, -v89, v97, v100
    v_fma_f32 v99, v89, v96, v101
    v_fma_f32 v100, v88, v98, v71
    v_fma_f32 v101, v88, v99, v75
    v_fma_f32 v96, -v89, v99, v100
    v_fma_f32 v97, v89, v98, v101
    v_fma_f32 v100, v88, v96, v76
    v_fma_f32 v101, v88, v97, v80
    v_fma_f32 v98, -v89, v97, v100
    v_fma_f32 v99, v89, v96, v101
    v_fma_f32 v100, v88, v98, v77
    v_fma_f32 v101, v88, v99, v81
    v_fma_f32 v96, -v89, v99, v100
    v_fma_f32 v97, v89, v98, v101
    v_fma_f32 v100, v88, v96, v78
    v_fma_f32 v101, v88, v97, v82
    v_fma_f32 v98, -v89, v97, v100
    v_fma_f32 v99, v89, v96, v101
    v_fma_f32 v100, v88, v98, v79
    v_fma_f32 v101, v88, v99, v83
    v_fma_f32 v102, -v89, v99, v100
    v_fma_f32 v106, v89, v98, v101
    v_mov_b32 v103, v102
    v_mov_b32 v107, v106
    s_nop 1
    v_permlane16_swap_b32 v102, v103
    v_permlane16_swap_b32 v106, v107
    v_mov_b32 v104, v102
    v_mov_b32 v105, v103
    v_mov_b32 v108, v106
    v_mov_b32 v109, v107
    s_nop 0
    v_permlane32_swap_b32 v102, v104
    v_permlane32_swap_b32 v103, v105
    v_permlane32_swap_b32 v106, v108
    v_permlane32_swap_b32 v107, v109
    v_fma_f32 v100, v92, v94, v102
    v_fma_f32 v101, v92, v95, v106
    v_fma_f32 v110, -v93, v95, v100
    v_fma_f32 v111, v93, v94, v101
    v_cndmask_b32 v98, v94, v110, s[56:57]
    v_cndmask_b32 v99, v95, v111, s[56:57]
    v_fma_f32 v100, v92, v110, v103
    v_fma_f32 v101, v92, v111, v107
    v_fma_f32 v112, -v93, v111, v100
    v_fma_f32 v113, v93, v110, v101
    v_cndmask_b32 v98, v98, v112, s[58:59]
    v_cndmask_b32 v99, v99, v113, s[58:59]
    v_fma_f32 v100, v92, v112, v104
    v_fma_f32 v101, v92, v113, v108
    v_fma_f32 v114, -v93, v113, v100
    v_fma_f32 v115, v93, v112, v101
    v_cndmask_b32 v98, v98, v114, s[60:61]
    v_cndmask_b32 v99, v99, v115, s[60:61]
    v_fma_f32 v100, v92, v114, v105
    v_fma_f32 v101, v92, v115, v109
    v_fma_f32 v94, -v93, v115, v100
    v_fma_f32 v95, v93, v114, v101
    v_fma_f32 v100, v88, v98, v68
    v_fma_f32 v101, v88, v99, v72
    v_fma_f32 v96, -v89, v99, v100
    v_fma_f32 v97, v89, v98, v101
    v_mul_f32 v128, v90, v96
    v_mul_f32 v136, v90, v97
    v_fma_f32 v128, -v91, v97, v128
    v_fma_f32 v136, -v91, v96, -v136
    v_fma_f32 v100, v88, v96, v69
    v_fma_f32 v101, v88, v97, v73
    v_fma_f32 v98, -v89, v97, v100
    v_fma_f32 v99, v89, v96, v101
    v_mul_f32 v129, v90, v98
    v_mul_f32 v137, v90, v99
    v_fma_f32 v129, -v91, v99, v129
    v_fma_f32 v137, -v91, v98, -v137
    v_cvt_pk_bf16_f32 v120, v128, v129
    v_cvt_pk_bf16_f32 v124, v136, v137
    v_fma_f32 v100, v88, v98, v70
    v_fma_f32 v101, v88, v99, v74
    v_fma_f32 v96, -v89, v99, v100
    v_fma_f32 v97, v89, v98, v101
    v_mul_f32 v130, v90, v96
    v_mul_f32 v138, v90, v97
    v_fma_f32 v130, -v91, v97, v130
    v_fma_f32 v138, -v91, v96, -v138
    v_fma_f32 v100, v88, v96, v71
    v_fma_f32 v101, v88, v97, v75
    v_fma_f32 v98, -v89, v97, v100
    v_fma_f32 v99, v89, v96, v101
    v_mul_f32 v131, v90, v98
    v_mul_f32 v139, v90, v99
    v_fma_f32 v131, -v91, v99, v131
    v_fma_f32 v139, -v91, v98, -v139
    v_cvt_pk_bf16_f32 v121, v130, v131
    v_cvt_pk_bf16_f32 v125, v138, v139
    v_fma_f32 v100, v88, v98, v76
    v_fma_f32 v101, v88, v99, v80
    v_fma_f32 v96, -v89, v99, v100
    v_fma_f32 v97, v89, v98, v101
    v_mul_f32 v132, v90, v96
    v_mul_f32 v140, v90, v97
    v_fma_f32 v132, -v91, v97, v132
    v_fma_f32 v140, -v91, v96, -v140
    v_fma_f32 v100, v88, v96, v77
    v_fma_f32 v101, v88, v97, v81
    v_fma_f32 v98, -v89, v97, v100
    v_fma_f32 v99, v89, v96, v101
    v_mul_f32 v133, v90, v98
    v_mul_f32 v141, v90, v99
    v_fma_f32 v133, -v91, v99, v133
    v_fma_f32 v141, -v91, v98, -v141
    v_cvt_pk_bf16_f32 v122, v132, v133
    v_cvt_pk_bf16_f32 v126, v140, v141
    v_fma_f32 v100, v88, v98, v78
    v_fma_f32 v101, v88, v99, v82
    v_fma_f32 v96, -v89, v99, v100
    v_fma_f32 v97, v89, v98, v101
    v_mul_f32 v134, v90, v96
    v_mul_f32 v142, v90, v97
    v_fma_f32 v134, -v91, v97, v134
    v_fma_f32 v142, -v91, v96, -v142
    v_fma_f32 v100, v88, v96, v79
    v_fma_f32 v101, v88, v97, v83
    v_fma_f32 v98, -v89, v97, v100
    v_fma_f32 v99, v89, v96, v101
    v_mul_f32 v135, v90, v98
    v_mul_f32 v143, v90, v99
    v_fma_f32 v135, -v91, v99, v135
    v_fma_f32 v143, -v91, v98, -v143
    v_cvt_pk_bf16_f32 v123, v134, v135
    v_cvt_pk_bf16_f32 v127, v142, v143
    ds_write_b128 v116, v[120:123] offset:0
    ds_write_b128 v116, v[124:127] offset:1024
    ds_read_b64_tr_b16 v[144:145], v117 offset:0
    ds_read_b64_tr_b16 v[146:147], v118 offset:256
    ds_read_b64_tr_b16 v[148:149], v117 offset:1024
    ds_read_b64_tr_b16 v[150:151], v118 offset:1280
    s_sub_u32 s39, s22, 1
    s_lshl_b32 s38, s39, 17
    s_add_u32 s38, s38, 0x4400000
    s_add_u32 s43, s38, 0x10000
    s_lshl_b32 s39, s39, 7
    s_add_u32 s39, s39, 0x5902000
    s_cmp_eq_u32 s37, 0
    s_cselect_b32 s38, 0x7ff00000, s38
    s_cselect_b32 s39, 0x7ff00000, s39
    s_cselect_b32 s43, 0x7ff00000, s43
    s_mov_b32 s37, 1
    s_waitcnt lgkmcnt(0)
    buffer_store_dwordx4 v[144:147], v86, s[12:15], s38 offen sc1
    buffer_store_dwordx4 v[148:151], v86, s[12:15], s43 offen sc1
    s_waitcnt vmcnt(0)
    s_barrier
    buffer_atomic_add v84, v85, s[12:15], s39 offen sc1
    s_branch L_ste_228
L_fl0_227:
    s_waitcnt lgkmcnt(0)
    s_nop 7
    s_waitcnt lgkmcnt(0)
    buffer_store_dwordx4 v[144:147], v86, s[12:15], s38 offen sc1
    buffer_store_dwordx4 v[148:151], v86, s[12:15], s43 offen sc1
    s_waitcnt vmcnt(0)
    s_barrier
    buffer_atomic_add v84, v85, s[12:15], s39 offen sc1
    v_fma_f32 v100, v88, v52, v53
    v_fma_f32 v101, v88, v56, v57
    v_fma_f32 v96, -v89, v56, v100
    v_fma_f32 v97, v89, v52, v101
    v_fma_f32 v100, v88, v96, v54
    v_fma_f32 v101, v88, v97, v58
    v_fma_f32 v98, -v89, v97, v100
    v_fma_f32 v99, v89, v96, v101
    v_fma_f32 v100, v88, v98, v55
    v_fma_f32 v101, v88, v99, v59
    v_fma_f32 v96, -v89, v99, v100
    v_fma_f32 v97, v89, v98, v101
    v_fma_f32 v100, v88, v96, v60
    v_fma_f32 v101, v88, v97, v64
    v_fma_f32 v98, -v89, v97, v100
    v_fma_f32 v99, v89, v96, v101
    v_fma_f32 v100, v88, v98, v61
    v_fma_f32 v101, v88, v99, v65
    v_fma_f32 v96, -v89, v99, v100
    v_fma_f32 v97, v89, v98, v101
    v_fma_f32 v100, v88, v96, v62
    v_fma_f32 v101, v88, v97, v66
    v_fma_f32 v98, -v89, v97, v100
    v_fma_f32 v99, v89, v96, v101
    v_fma_f32 v100, v88, v98, v63
    v_fma_f32 v101, v88, v99, v67
    v_fma_f32 v102, -v89, v99, v100
    v_fma_f32 v106, v89, v98, v101
    v_mov_b32 v103, v102
    v_mov_b32 v107, v106
    s_nop 1
    v_permlane16_swap_b32 v102, v103
    v_permlane16_swap_b32 v106, v107
    v_mov_b32 v104, v102
    v_mov_b32 v105, v103
    v_mov_b32 v108, v106
    v_mov_b32 v109, v107
    s_nop 0
    v_permlane32_swap_b32 v102, v104
    v_permlane32_swap_b32 v103, v105
    v_permlane32_swap_b32 v106, v108
    v_permlane32_swap_b32 v107, v109
    v_fma_f32 v100, v92, v94, v102
    v_fma_f32 v101, v92, v95, v106
    v_fma_f32 v110, -v93, v95, v100
    v_fma_f32 v111, v93, v94, v101
    v_cndmask_b32 v98, v94, v110, s[56:57]
    v_cndmask_b32 v99, v95, v111, s[56:57]
    v_fma_f32 v100, v92, v110, v103
    v_fma_f32 v101, v92, v111, v107
    v_fma_f32 v112, -v93, v111, v100
    v_fma_f32 v113, v93, v110, v101
    v_cndmask_b32 v98, v98, v112, s[58:59]
    v_cndmask_b32 v99, v99, v113, s[58:59]
    v_fma_f32 v100, v92, v112, v104
    v_fma_f32 v101, v92, v113, v108
    v_fma_f32 v114, -v93, v113, v100
    v_fma_f32 v115, v93, v112, v101
    v_cndmask_b32 v98, v98, v114, s[60:61]
    v_cndmask_b32 v99, v99, v115, s[60:61]
    v_fma_f32 v100, v92, v114, v105
    v_fma_f32 v101, v92, v115, v109
    v_fma_f32 v94, -v93, v115, v100
    v_fma_f32 v95, v93, v114, v101
    v_fma_f32 v100, v88, v98, v52
    v_fma_f32 v101, v88, v99, v56
    v_fma_f32 v96, -v89, v99, v100
    v_fma_f32 v97, v89, v98, v101
    v_mul_f32 v128, v90, v96
    v_mul_f32 v136, v90, v97
    v_fma_f32 v128, -v91, v97, v128
    v_fma_f32 v136, -v91, v96, -v136
    v_fma_f32 v100, v88, v96, v53
    v_fma_f32 v101, v88, v97, v57
    v_fma_f32 v98, -v89, v97, v100
    v_fma_f32 v99, v89, v96, v101
    v_mul_f32 v129, v90, v98
    v_mul_f32 v137, v90, v99
    v_fma_f32 v129, -v91, v99, v129
    v_fma_f32 v137, -v91, v98, -v137
    v_cvt_pk_bf16_f32 v120, v128, v129
    v_cvt_pk_bf16_f32 v124, v136, v137
    v_fma_f32 v100, v88, v98, v54
    v_fma_f32 v101, v88, v99, v58
    v_fma_f32 v96, -v89, v99, v100
    v_fma_f32 v97, v89, v98, v101
    v_mul_f32 v130, v90, v96
    v_mul_f32 v138, v90, v97
    v_fma_f32 v130, -v91, v97, v130
    v_fma_f32 v138, -v91, v96, -v138
    v_fma_f32 v100, v88, v96, v55
    v_fma_f32 v101, v88, v97, v59
    v_fma_f32 v98, -v89, v97, v100
    v_fma_f32 v99, v89, v96, v101
    v_mul_f32 v131, v90, v98
    v_mul_f32 v139, v90, v99
    v_fma_f32 v131, -v91, v99, v131
    v_fma_f32 v139, -v91, v98, -v139
    v_cvt_pk_bf16_f32 v121, v130, v131
    v_cvt_pk_bf16_f32 v125, v138, v139
    v_fma_f32 v100, v88, v98, v60
    v_fma_f32 v101, v88, v99, v64
    v_fma_f32 v96, -v89, v99, v100
    v_fma_f32 v97, v89, v98, v101
    v_mul_f32 v132, v90, v96
    v_mul_f32 v140, v90, v97
    v_fma_f32 v132, -v91, v97, v132
    v_fma_f32 v140, -v91, v96, -v140
    v_fma_f32 v100, v88, v96, v61
    v_fma_f32 v101, v88, v97, v65
    v_fma_f32 v98, -v89, v97, v100
    v_fma_f32 v99, v89, v96, v101
    v_mul_f32 v133, v90, v98
    v_mul_f32 v141, v90, v99
    v_fma_f32 v133, -v91, v99, v133
    v_fma_f32 v141, -v91, v98, -v141
    v_cvt_pk_bf16_f32 v122, v132, v133
    v_cvt_pk_bf16_f32 v126, v140, v141
    v_fma_f32 v100, v88, v98, v62
    v_fma_f32 v101, v88, v99, v66
    v_fma_f32 v96, -v89, v99, v100
    v_fma_f32 v97, v89, v98, v101
    v_mul_f32 v134, v90, v96
    v_mul_f32 v142, v90, v97
    v_fma_f32 v134, -v91, v97, v134
    v_fma_f32 v142, -v91, v96, -v142
    v_fma_f32 v100, v88, v96, v63
    v_fma_f32 v101, v88, v97, v67
    v_fma_f32 v98, -v89, v97, v100
    v_fma_f32 v99, v89, v96, v101
    v_mul_f32 v135, v90, v98
    v_mul_f32 v143, v90, v99
    v_fma_f32 v135, -v91, v99, v135
    v_fma_f32 v143, -v91, v98, -v143
    v_cvt_pk_bf16_f32 v123, v134, v135
    v_cvt_pk_bf16_f32 v127, v142, v143
    ds_write_b128 v116, v[120:123] offset:0
    ds_write_b128 v116, v[124:127] offset:1024
    ds_read_b64_tr_b16 v[144:145], v117 offset:0
    ds_read_b64_tr_b16 v[146:147], v118 offset:256
    ds_read_b64_tr_b16 v[148:149], v117 offset:1024
    ds_read_b64_tr_b16 v[150:151], v118 offset:1280
    s_sub_u32 s39, s22, 1
    s_lshl_b32 s38, s39, 17
    s_add_u32 s38, s38, 0x4400000
    s_add_u32 s43, s38, 0x10000
    s_lshl_b32 s39, s39, 7
    s_add_u32 s39, s39, 0x5902000
    s_cmp_eq_u32 s37, 0
    s_cselect_b32 s38, 0x7ff00000, s38
    s_cselect_b32 s39, 0x7ff00000, s39
    s_cselect_b32 s43, 0x7ff00000, s43
    s_mov_b32 s37, 1
    s_waitcnt lgkmcnt(0)
    buffer_store_dwordx4 v[144:147], v86, s[12:15], s38 offen sc1
    buffer_store_dwordx4 v[148:151], v86, s[12:15], s43 offen sc1
    s_waitcnt vmcnt(0)
    s_barrier
    buffer_atomic_add v84, v85, s[12:15], s39 offen sc1
L_ste_228:
    s_branch L_op_204
L_g2_203:
    s_and_b32 s46, s41, 15
    s_and_b32 s47, s46, 1
    s_cmp_eq_u32 s47, 1
    s_cselect_b32 s16, s76, s74
    s_cselect_b32 s17, s77, s75
    s_and_b32 s17, s17, 0xffff
    s_mov_b32 s18, 0x200000
    s_mov_b32 s19, 0x00020000
    s_lshr_b32 s25, s46, 1
    s_lshl_b32 s25, s25, 7
    s_lshl_b32 s26, s49, 5
    s_add_u32 s25, s25, s26
    v_and_b32 v1, 15, v0
    v_bfe_u32 v2, v0, 4, 2
    v_and_b32 v3, 12, v1
    v_add3_u32 v3, v3, v1, s25
    v_lshlrev_b32 v4, 4, v2
    v_lshl_add_u32 v4, v3, 11, v4
    v_and_b32 v5, 7, v0
    v_lshl_add_u32 v5, v5, 2, s25
    s_lshl_b32 s26, s47, 4
    v_bfe_u32 v6, v0, 3, 3
    v_add_u32 v6, s26, v6
    v_lshlrev_b32 v7, 1, v5
    v_lshl_add_u32 v132, v6, 11, v7
    v_add_u32 v133, 0x4000, v132
    v_lshlrev_b32 v5, 2, v5
    v_lshl_add_u32 v134, v6, 13, v5
    v_add_u32 v135, 0x10000, v134
    s_mov_b32 s32, s80
    s_and_b32 s33, s81, 0xffff
    s_mov_b32 s34, 0x800
    s_mov_b32 s35, 0x00020000
    buffer_load_dwordx2 v[128:129], v7, s[32:35], 0 offen
    s_mov_b32 s27, 8192
    buffer_load_dwordx4 a[0:3], v4, s[16:19], 0 offen offset:0
    buffer_load_dwordx4 a[4:7], v4, s[16:19], s27 offen offset:0
    buffer_load_dwordx4 a[8:11], v4, s[16:19], 0 offen offset:64
    buffer_load_dwordx4 a[12:15], v4, s[16:19], s27 offen offset:64
    buffer_load_dwordx4 a[16:19], v4, s[16:19], 0 offen offset:128
    buffer_load_dwordx4 a[20:23], v4, s[16:19], s27 offen offset:128
    buffer_load_dwordx4 a[24:27], v4, s[16:19], 0 offen offset:192
    buffer_load_dwordx4 a[28:31], v4, s[16:19], s27 offen offset:192
    buffer_load_dwordx4 a[32:35], v4, s[16:19], 0 offen offset:256
    buffer_load_dwordx4 a[36:39], v4, s[16:19], s27 offen offset:256
    buffer_load_dwordx4 a[40:43], v4, s[16:19], 0 offen offset:320
    buffer_load_dwordx4 a[44:47], v4, s[16:19], s27 offen offset:320
    buffer_load_dwordx4 a[48:51], v4, s[16:19], 0 offen offset:384
    buffer_load_dwordx4 a[52:55], v4, s[16:19], s27 offen offset:384
    buffer_load_dwordx4 a[56:59], v4, s[16:19], 0 offen offset:448
    buffer_load_dwordx4 a[60:63], v4, s[16:19], s27 offen offset:448
    buffer_load_dwordx4 a[64:67], v4, s[16:19], 0 offen offset:512
    buffer_load_dwordx4 a[68:71], v4, s[16:19], s27 offen offset:512
    buffer_load_dwordx4 a[72:75], v4, s[16:19], 0 offen offset:576
    buffer_load_dwordx4 a[76:79], v4, s[16:19], s27 offen offset:576
    buffer_load_dwordx4 a[80:83], v4, s[16:19], 0 offen offset:640
    buffer_load_dwordx4 a[84:87], v4, s[16:19], s27 offen offset:640
    buffer_load_dwordx4 a[88:91], v4, s[16:19], 0 offen offset:704
    buffer_load_dwordx4 a[92:95], v4, s[16:19], s27 offen offset:704
    buffer_load_dwordx4 a[96:99], v4, s[16:19], 0 offen offset:768
    buffer_load_dwordx4 a[100:103], v4, s[16:19], s27 offen offset:768
    buffer_load_dwordx4 a[104:107], v4, s[16:19], 0 offen offset:832
    buffer_load_dwordx4 a[108:111], v4, s[16:19], s27 offen offset:832
    buffer_load_dwordx4 a[112:115], v4, s[16:19], 0 offen offset:896
    buffer_load_dwordx4 a[116:119], v4, s[16:19], s27 offen offset:896
    buffer_load_dwordx4 a[120:123], v4, s[16:19], 0 offen offset:960
    buffer_load_dwordx4 a[124:127], v4, s[16:19], s27 offen offset:960
    buffer_load_dwordx4 a[128:131], v4, s[16:19], 0 offen offset:1024
    buffer_load_dwordx4 a[132:135], v4, s[16:19], s27 offen offset:1024
    buffer_load_dwordx4 a[136:139], v4, s[16:19], 0 offen offset:1088
    buffer_load_dwordx4 a[140:143], v4, s[16:19], s27 offen offset:1088
    buffer_load_dwordx4 a[144:147], v4, s[16:19], 0 offen offset:1152
    buffer_load_dwordx4 a[148:151], v4, s[16:19], s27 offen offset:1152
    buffer_load_dwordx4 a[152:155], v4, s[16:19], 0 offen offset:1216
    buffer_load_dwordx4 a[156:159], v4, s[16:19], s27 offen offset:1216
    buffer_load_dwordx4 a[160:163], v4, s[16:19], 0 offen offset:1280
    buffer_load_dwordx4 a[164:167], v4, s[16:19], s27 offen offset:1280
    buffer_load_dwordx4 a[168:171], v4, s[16:19], 0 offen offset:1344
    buffer_load_dwordx4 a[172:175], v4, s[16:19], s27 offen offset:1344
    buffer_load_dwordx4 a[176:179], v4, s[16:19], 0 offen offset:1408
    buffer_load_dwordx4 a[180:183], v4, s[16:19], s27 offen offset:1408
    buffer_load_dwordx4 a[184:187], v4, s[16:19], 0 offen offset:1472
    buffer_load_dwordx4 a[188:191], v4, s[16:19], s27 offen offset:1472
    buffer_load_dwordx4 a[192:195], v4, s[16:19], 0 offen offset:1536
    buffer_load_dwordx4 a[196:199], v4, s[16:19], s27 offen offset:1536
    buffer_load_dwordx4 a[200:203], v4, s[16:19], 0 offen offset:1600
    buffer_load_dwordx4 a[204:207], v4, s[16:19], s27 offen offset:1600
    buffer_load_dwordx4 a[208:211], v4, s[16:19], 0 offen offset:1664
    buffer_load_dwordx4 a[212:215], v4, s[16:19], s27 offen offset:1664
    buffer_load_dwordx4 a[216:219], v4, s[16:19], 0 offen offset:1728
    buffer_load_dwordx4 a[220:223], v4, s[16:19], s27 offen offset:1728
    s_waitcnt vmcnt(55)
    buffer_load_dwordx4 a[224:227], v4, s[16:19], 0 offen offset:1792
    s_waitcnt vmcnt(55)
    buffer_load_dwordx4 a[228:231], v4, s[16:19], s27 offen offset:1792
    s_waitcnt vmcnt(55)
    buffer_load_dwordx4 a[232:235], v4, s[16:19], 0 offen offset:1856
    s_waitcnt vmcnt(55)
    buffer_load_dwordx4 a[236:239], v4, s[16:19], s27 offen offset:1856
    s_waitcnt vmcnt(55)
    buffer_load_dwordx4 a[240:243], v4, s[16:19], 0 offen offset:1920
    s_waitcnt vmcnt(55)
    buffer_load_dwordx4 a[244:247], v4, s[16:19], s27 offen offset:1920
    s_waitcnt vmcnt(55)
    buffer_load_dwordx4 a[248:251], v4, s[16:19], 0 offen offset:1984
    s_waitcnt vmcnt(55)
    buffer_load_dwordx4 a[252:255], v4, s[16:19], s27 offen offset:1984
    s_waitcnt vmcnt(0)
    v_lshlrev_b32 v124, 16, v128
    v_and_b32 v125, 0xffff0000, v128
    v_lshlrev_b32 v126, 16, v129
    v_and_b32 v127, 0xffff0000, v129
    s_mov_b32 s32, s98
    s_and_b32 s33, s99, 0xffff
    s_mov_b32 s34, 0x100
    s_mov_b32 s35, 0x00020000
    s_mov_b32 s25, 0
    v_mov_b32 v2, 0
L_pl_229:
    buffer_load_dword v1, v2, s[32:35], s25 offen sc1
    s_add_u32 s36, s36, 1
    s_cmp_gt_u32 s36, 0x100000
    s_cbranch_scc1 chain_kernel_wend
    s_waitcnt vmcnt(0)
    v_readfirstlane_b32 s26, v1
    s_and_b32 s27, s26, 0xffff
    s_cmp_ge_u32 s27, 256
    s_cbranch_scc1 L_plok_230
    s_sleep 4
    s_branch L_pl_229
L_plok_230:
    s_lshr_b32 s25, s26, 16
    s_cmp_gt_u32 s25, 64
    s_cselect_b32 s25, 0x2000, 0x0
    s_add_u32 s54, s100, 0x1fffff
    s_and_b32 s54, s54, 0xffe00000
    s_sub_u32 s55, s54, s100
    s_add_u32 s54, s55, s25
    s_xor_b32 s25, s25, 0x2000
    s_add_u32 s55, s55, s25
    s_lshl_b32 s44, s46, 17
    s_lshl_b32 s25, s49, 15
    s_add_u32 s44, s44, s25
    s_xor_b32 s45, s44, 0x20000
    s_add_u32 s44, s44, 0x6800000
    s_add_u32 s45, s45, 0x6800000
    s_lshr_b32 s48, s46, 1
    s_lshl_b32 s48, s48, 7
    s_add_u32 s48, s48, 0x590d000
    v_mov_b32 v108, 0xff81ff81
    v_mov_b32 v109, 0xff81ff81
    v_mov_b32 v110, 0xff81ff81
    v_mov_b32 v111, 0xff81ff81
    v_and_b32 v112, 63, v0
    v_lshlrev_b32 v112, 4, v112
    v_lshrrev_b32 v1, 6, v0
    v_lshlrev_b32 v1, 11, v1
    v_add_u32 v1, 0x21000, v1
    v_bfe_u32 v2, v0, 3, 3
    v_lshlrev_b32 v2, 4, v2
    v_xor_b32 v2, v2, v112
    v_add_u32 v113, v1, v2
    v_and_b32 v2, 15, v0
    v_lshl_add_u32 v1, v2, 7, v1
    v_bfe_u32 v2, v0, 4, 2
    v_lshlrev_b32 v2, 1, v2
    v_bfe_u32 v3, v0, 0, 3
    v_xor_b32 v2, v2, v3
    v_lshl_add_u32 v114, v2, 4, v1
    v_xor_b32 v115, 16, v114
    s_add_u32 s25, s44, 0
    buffer_store_dwordx4 v[108:111], v112, s[12:15], s25 offen offset:1024 sc1
    buffer_store_dwordx4 v[108:111], v112, s[12:15], s25 offen offset:2048 sc1
    s_add_u32 s25, s44, 4096
    buffer_store_dwordx4 v[108:111], v112, s[12:15], s25 offen offset:1024 sc1
    buffer_store_dwordx4 v[108:111], v112, s[12:15], s25 offen offset:2048 sc1
    s_add_u32 s25, s44, 8192
    buffer_store_dwordx4 v[108:111], v112, s[12:15], s25 offen offset:1024 sc1
    buffer_store_dwordx4 v[108:111], v112, s[12:15], s25 offen offset:2048 sc1
    s_add_u32 s25, s44, 12288
    buffer_store_dwordx4 v[108:111], v112, s[12:15], s25 offen offset:1024 sc1
    buffer_store_dwordx4 v[108:111], v112, s[12:15], s25 offen offset:2048 sc1
    s_add_u32 s25, s44, 16384
    buffer_store_dwordx4 v[108:111], v112, s[12:15], s25 offen offset:1024 sc1
    buffer_store_dwordx4 v[108:111], v112, s[12:15], s25 offen offset:2048 sc1
    s_add_u32 s25, s44, 20480
    buffer_store_dwordx4 v[108:111], v112, s[12:15], s25 offen offset:1024 sc1
    buffer_store_dwordx4 v[108:111], v112, s[12:15], s25 offen offset:2048 sc1
    s_add_u32 s25, s44, 24576
    buffer_store_dwordx4 v[108:111], v112, s[12:15], s25 offen offset:1024 sc1
    buffer_store_dwordx4 v[108:111], v112, s[12:15], s25 offen offset:2048 sc1
    s_add_u32 s25, s44, 28672
    buffer_store_dwordx4 v[108:111], v112, s[12:15], s25 offen offset:1024 sc1
    buffer_store_dwordx4 v[108:111], v112, s[12:15], s25 offen offset:2048 sc1
    s_waitcnt vmcnt(0)
    s_barrier
    buffer_atomic_add v84, v85, s[12:15], s48 offen sc1
    v_mov_b32 v2, 0
L_pl_231:
    buffer_load_dword v1, v2, s[12:15], s48 offen sc1
    s_add_u32 s36, s36, 1
    s_cmp_gt_u32 s36, 0x100000
    s_cbranch_scc1 chain_kernel_wend
    s_waitcnt vmcnt(0)
    v_readfirstlane_b32 s26, v1
    s_cmp_ge_u32 s26, 2
    s_cbranch_scc1 L_plok_232
    s_sleep 4
    s_branch L_pl_231
L_plok_232:
    s_mov_b32 s48, 0x5902000
    s_lshl_b32 s50, s47, 16
    s_add_u32 s50, s50, 0x4400000
    s_mov_b32 s8, s100
    s_and_b32 s9, s101, 0xffff
    s_mov_b32 s10, 0x10000000
    s_mov_b32 s11, 0x00020000
    s_mov_b32 s16, s96
    s_and_b32 s17, s97, 0xffff
    s_mov_b32 s18, 0x1000000
    s_mov_b32 s19, 0x00020000
    s_mov_b32 s32, s64
    s_and_b32 s33, s65, 0xffff
    s_mov_b32 s34, 0x400000
    s_mov_b32 s35, 0x00020000
    s_lshl_b32 s21, s49, 12
    v_and_b32 v1, 63, v0
    v_and_b32 v2, 15, v0
    v_bfe_u32 v3, v0, 4, 2
    v_lshrrev_b32 v4, 6, v0
    v_lshlrev_b32 v5, 4, v1
    v_lshl_add_u32 v5, v4, 12, v5
    v_add_u32 v8, 0, v5
    v_add_u32 v9, 1024, v5
    v_add_u32 v10, 2048, v5
    v_add_u32 v11, 3072, v5
    v_lshlrev_b32 v5, 4, v2
    v_lshl_add_u32 v5, v3, 9, v5
    s_lshl_b32 s25, s47, 8
    v_add_u32 v12, s25, v5
    v_xor_b32 v13, 0x100, v12
    v_add_u32 v16, 0x10000, v12
    v_add_u32 v17, 0x10000, v13
    s_mov_b32 s22, 0
    s_mov_b32 s38, 0
    s_mov_b32 s52, 0
    v_mov_b32 v2, 0x20000
    v_lshl_add_u32 v3, v0, 2, v2
    v_mov_b32 v4, 0
L_run_233:
    s_cmp_ge_u32 s22, 64
    s_cbranch_scc1 L_rdone_236
    s_add_u32 s28, s22, 3
    s_min_u32 s28, s28, 63
    s_add_u32 s25, s28, 0
    s_cmp_lt_u32 s25, 64
    s_cselect_b32 s25, s25, 0x800000
    s_lshl_b32 s25, s25, 7
    s_add_u32 s25, s25, s48
    s_add_u32 s26, s22, 1
    s_cmp_lt_u32 s26, 64
    s_cselect_b32 s26, s26, 0x800000
    s_lshl_b32 s26, s26, 7
    s_add_u32 s26, s26, s48
    s_add_u32 s27, s22, 2
    s_cmp_lt_u32 s27, 64
    s_cselect_b32 s27, s27, 0x800000
    s_lshl_b32 s27, s27, 7
    s_add_u32 s27, s27, s48
L_rw_234:
    buffer_load_dword v88, v4, s[12:15], s25 offen sc1
    buffer_load_dword v89, v4, s[12:15], s26 offen sc1
    buffer_load_dword v90, v4, s[12:15], s27 offen sc1
    s_add_u32 s36, s36, 1
    s_cmp_gt_u32 s36, 0x100000
    s_cbranch_scc1 chain_kernel_wend
    s_waitcnt vmcnt(0)
    s_barrier
    v_lshl_add_u32 v1, v0, 4, v2
    ds_write_b128 v1, v[88:91]
    s_waitcnt lgkmcnt(0)
    s_barrier
    ds_read_b128 v[88:91], v2
    s_waitcnt lgkmcnt(0)
    v_readfirstlane_b32 s28, v88
    s_cmp_ge_u32 s28, 16
    s_cbranch_scc1 L_rgo_235
    s_sleep 2
    s_branch L_rw_234
L_rgo_235:
    v_readfirstlane_b32 s51, v89
    v_mov_b32 v87, v90
    s_mov_b32 s24, s22
    s_add_u32 s23, s22, 1
    s_mov_b32 s37, 0
    s_sub_u32 s38, s38, 0x1000
    s_lshl_b32 s53, s24, 17
    s_add_u32 s53, s53, s50
    s_mov_b32 s20, s53
    s_mov_b32 s39, 0x7ff00000
    s_mov_b32 s42, 0x7ff00000
    s_mov_b32 s43, 0x7ff00000
    s_mov_b32 s7, 0x7ff00000
    s_barrier
    s_add_u32 m0, s21, 0
    s_nop 0
    buffer_load_dwordx4 v8, s[8:11], s20 offen lds
    s_add_u32 m0, s21, 1024
    s_nop 0
    buffer_load_dwordx4 v9, s[8:11], s20 offen lds
    s_add_u32 m0, s21, 2048
    s_nop 0
    buffer_load_dwordx4 v10, s[8:11], s20 offen lds
    s_add_u32 m0, s21, 3072
    s_nop 0
    buffer_load_dwordx4 v11, s[8:11], s20 offen lds
    s_add_u32 s20, s20, 16384
    s_add_u32 m0, s21, 16384
    s_nop 0
    buffer_load_dwordx4 v8, s[8:11], s20 offen lds
    s_add_u32 m0, s21, 17408
    s_nop 0
    buffer_load_dwordx4 v9, s[8:11], s20 offen lds
    s_add_u32 m0, s21, 18432
    s_nop 0
    buffer_load_dwordx4 v10, s[8:11], s20 offen lds
    s_add_u32 m0, s21, 19456
    s_nop 0
    buffer_load_dwordx4 v11, s[8:11], s20 offen lds
    s_add_u32 s20, s20, 16384
    s_add_u32 m0, s21, 32768
    s_nop 0
    buffer_load_dwordx4 v8, s[8:11], s20 offen lds
    s_add_u32 m0, s21, 33792
    s_nop 0
    buffer_load_dwordx4 v9, s[8:11], s20 offen lds
    s_add_u32 m0, s21, 34816
    s_nop 0
    buffer_load_dwordx4 v10, s[8:11], s20 offen lds
    s_add_u32 m0, s21, 35840
    s_nop 0
    buffer_load_dwordx4 v11, s[8:11], s20 offen lds
    s_add_u32 s20, s20, 16384
    s_add_u32 m0, s21, 49152
    s_nop 0
    buffer_load_dwordx4 v8, s[8:11], s20 offen lds
    s_add_u32 m0, s21, 50176
    s_nop 0
    buffer_load_dwordx4 v9, s[8:11], s20 offen lds
    s_add_u32 m0, s21, 51200
    s_nop 0
    buffer_load_dwordx4 v10, s[8:11], s20 offen lds
    s_add_u32 m0, s21, 52224
    s_nop 0
    buffer_load_dwordx4 v11, s[8:11], s20 offen lds
    s_cmp_ge_u32 s51, 16
    s_cselect_b32 s30, 1, 0
    s_add_u32 s24, s24, s30
    s_add_u32 s23, s23, s30
    s_lshl_b32 s53, s24, 17
    s_add_u32 s53, s53, s50
    s_mov_b32 s20, s53
    s_add_u32 m0, s21, 65536
    s_nop 0
    buffer_load_dwordx4 v8, s[8:11], s20 offen lds
    s_add_u32 m0, s21, 66560
    s_nop 0
    buffer_load_dwordx4 v9, s[8:11], s20 offen lds
    s_add_u32 m0, s21, 67584
    s_nop 0
    buffer_load_dwordx4 v10, s[8:11], s20 offen lds
    s_add_u32 m0, s21, 68608
    s_nop 0
    buffer_load_dwordx4 v11, s[8:11], s20 offen lds
    s_add_u32 s20, s20, 16384
    s_add_u32 m0, s21, 81920
    s_nop 0
    buffer_load_dwordx4 v8, s[8:11], s20 offen lds
    s_add_u32 m0, s21, 82944
    s_nop 0
    buffer_load_dwordx4 v9, s[8:11], s20 offen lds
    s_add_u32 m0, s21, 83968
    s_nop 0
    buffer_load_dwordx4 v10, s[8:11], s20 offen lds
    s_add_u32 m0, s21, 84992
    s_nop 0
    buffer_load_dwordx4 v11, s[8:11], s20 offen lds
    s_add_u32 s20, s20, 16384
    s_add_u32 m0, s21, 98304
    s_nop 0
    buffer_load_dwordx4 v8, s[8:11], s20 offen lds
    s_waitcnt vmcnt(21)
    s_barrier
    ds_read_b128 v[20:23], v12 offset:0
    ds_read_b128 v[24:27], v13 offset:0
    ds_read_b128 v[28:31], v12 offset:2048
    ds_read_b128 v[32:35], v13 offset:2048
    ds_read_b128 v[36:39], v12 offset:4096
    ds_read_b128 v[40:43], v13 offset:4096
    s_waitcnt lgkmcnt(4)
L_st_241:
    v_mfma_f32_16x16x32_bf16 v[52:55], a[0:3], v[20:23], 0
    ds_read_b128 v[44:47], v12 offset:6144
    s_add_u32 m0, s21, 99328
    v_mfma_f32_16x16x32_bf16 v[56:59], a[4:7], v[20:23], 0
    buffer_load_dwordx4 v9, s[8:11], s20 offen lds
    v_mfma_f32_16x16x32_bf16 v[60:63], a[0:3], v[24:27], 0
    ds_read_b128 v[48:51], v13 offset:6144
    s_add_u32 s38, s38, 0x1000
    v_mfma_f32_16x16x32_bf16 v[64:67], a[4:7], v[24:27], 0
    s_waitcnt lgkmcnt(4)
    s_and_b32 s38, s38, 0x7000
    v_mfma_f32_16x16x32_bf16 v[52:55], a[8:11], v[28:31], v[52:55]
    ds_read_b128 v[20:23], v12 offset:8192
    s_waitcnt vmcnt(13)
    v_mfma_f32_16x16x32_bf16 v[56:59], a[12:15], v[28:31], v[56:59]
    ds_write_b32 v3, v87
    v_mfma_f32_16x16x32_bf16 v[60:63], a[8:11], v[32:35], v[60:63]
    ds_read_b128 v[24:27], v13 offset:8192
    s_cmp_eq_u32 s37, 0
    s_cselect_b32 s31, 0x40000000, s38
    v_mfma_f32_16x16x32_bf16 v[64:67], a[12:15], v[32:35], v[64:67]
    s_waitcnt lgkmcnt(4)
    v_mfma_f32_16x16x32_bf16 v[52:55], a[16:19], v[36:39], v[52:55]
    ds_read_b128 v[28:31], v12 offset:10240
    s_add_u32 m0, s21, 100352
    v_mfma_f32_16x16x32_bf16 v[56:59], a[20:23], v[36:39], v[56:59]
    buffer_load_dwordx4 v10, s[8:11], s20 offen lds
    v_mfma_f32_16x16x32_bf16 v[60:63], a[16:19], v[40:43], v[60:63]
    ds_read_b128 v[32:35], v13 offset:10240
    v_mfma_f32_16x16x32_bf16 v[64:67], a[20:23], v[40:43], v[64:67]
    s_waitcnt lgkmcnt(4)
    s_nop 0
    v_mfma_f32_16x16x32_bf16 v[52:55], a[24:27], v[44:47], v[52:55]
    ds_read_b128 v[36:39], v12 offset:12288
    s_add_u32 s29, s45, s31
    v_mfma_f32_16x16x32_bf16 v[56:59], a[28:31], v[44:47], v[56:59]
    buffer_store_dwordx4 v[76:79], v112, s[12:15], s29 offen offset:1024 sc1
    v_mfma_f32_16x16x32_bf16 v[60:63], a[24:27], v[48:51], v[60:63]
    ds_read_b128 v[40:43], v13 offset:12288
    v_mfma_f32_16x16x32_bf16 v[64:67], a[28:31], v[48:51], v[64:67]
    s_waitcnt lgkmcnt(4)
    s_add_u32 s29, s45, s31
    v_mfma_f32_16x16x32_bf16 v[52:55], a[32:35], v[20:23], v[52:55]
    ds_read_b128 v[44:47], v12 offset:14336
    s_add_u32 m0, s21, 101376
    v_mfma_f32_16x16x32_bf16 v[56:59], a[36:39], v[20:23], v[56:59]
    buffer_load_dwordx4 v11, s[8:11], s20 offen lds
    v_mfma_f32_16x16x32_bf16 v[60:63], a[32:35], v[24:27], v[60:63]
    ds_read_b128 v[48:51], v13 offset:14336
    v_mfma_f32_16x16x32_bf16 v[64:67], a[36:39], v[24:27], v[64:67]
    s_waitcnt lgkmcnt(4)
    v_mfma_f32_16x16x32_bf16 v[52:55], a[40:43], v[28:31], v[52:55]
    s_waitcnt vmcnt(20)
    s_barrier
    ds_read_b128 v[20:23], v12 offset:16384
    v_mfma_f32_16x16x32_bf16 v[56:59], a[44:47], v[28:31], v[56:59]
    s_add_u32 s20, s20, 16384
    buffer_store_dwordx4 v[80:83], v112, s[12:15], s29 offen offset:2048 sc1
    v_mfma_f32_16x16x32_bf16 v[60:63], a[40:43], v[32:35], v[60:63]
    ds_read_b128 v[24:27], v13 offset:16384
    ds_read_b32 v1, v2
    v_mfma_f32_16x16x32_bf16 v[64:67], a[44:47], v[32:35], v[64:67]
    s_waitcnt lgkmcnt(4)
    v_mfma_f32_16x16x32_bf16 v[52:55], a[48:51], v[36:39], v[52:55]
    ds_read_b128 v[28:31], v12 offset:18432
    s_add_u32 m0, s21, 114688
    v_mfma_f32_16x16x32_bf16 v[56:59], a[52:55], v[36:39], v[56:59]
    buffer_load_dwordx4 v8, s[8:11], s20 offen lds
    v_mfma_f32_16x16x32_bf16 v[60:63], a[48:51], v[40:43], v[60:63]
    ds_read_b128 v[32:35], v13 offset:18432
    v_mfma_f32_16x16x32_bf16 v[64:67], a[52:55], v[40:43], v[64:67]
    s_waitcnt lgkmcnt(4)
    v_mfma_f32_16x16x32_bf16 v[52:55], a[56:59], v[44:47], v[52:55]
    ds_read_b128 v[36:39], v12 offset:20480
    v_mfma_f32_16x16x32_bf16 v[56:59], a[60:63], v[44:47], v[56:59]
    buffer_load_dwordx2 v[128:129], v132, s[32:35], s42 offen
    v_mfma_f32_16x16x32_bf16 v[60:63], a[56:59], v[48:51], v[60:63]
    ds_read_b128 v[40:43], v13 offset:20480
    v_mfma_f32_16x16x32_bf16 v[64:67], a[60:63], v[48:51], v[64:67]
    s_waitcnt lgkmcnt(4)
    v_mfma_f32_16x16x32_bf16 v[52:55], a[64:67], v[20:23], v[52:55]
    ds_read_b128 v[44:47], v12 offset:22528
    s_add_u32 m0, s21, 115712
    v_mfma_f32_16x16x32_bf16 v[56:59], a[68:71], v[20:23], v[56:59]
    buffer_load_dwordx4 v9, s[8:11], s20 offen lds
    v_mfma_f32_16x16x32_bf16 v[60:63], a[64:67], v[24:27], v[60:63]
    ds_read_b128 v[48:51], v13 offset:22528
    v_mfma_f32_16x16x32_bf16 v[64:67], a[68:71], v[24:27], v[64:67]
    s_waitcnt lgkmcnt(4)
    v_mfma_f32_16x16x32_bf16 v[52:55], a[72:75], v[28:31], v[52:55]
    ds_read_b128 v[20:23], v12 offset:24576
    v_mfma_f32_16x16x32_bf16 v[56:59], a[76:79], v[28:31], v[56:59]
    buffer_load_dwordx2 v[130:131], v133, s[32:35], s42 offen
    v_mfma_f32_16x16x32_bf16 v[60:63], a[72:75], v[32:35], v[60:63]
    ds_read_b128 v[24:27], v13 offset:24576
    v_readfirstlane_b32 s51, v1
    v_mfma_f32_16x16x32_bf16 v[64:67], a[76:79], v[32:35], v[64:67]
    s_waitcnt lgkmcnt(4)
    s_add_u32 s30, s22, 1
    v_mfma_f32_16x16x32_bf16 v[52:55], a[80:83], v[36:39], v[52:55]
    ds_read_b128 v[28:31], v12 offset:26624
    s_add_u32 m0, s21, 116736
    v_mfma_f32_16x16x32_bf16 v[56:59], a[84:87], v[36:39], v[56:59]
    buffer_load_dwordx4 v10, s[8:11], s20 offen lds
    v_mfma_f32_16x16x32_bf16 v[60:63], a[80:83], v[40:43], v[60:63]
    ds_read_b128 v[32:35], v13 offset:26624
    s_cmp_eq_u32 s30, s24
    s_cselect_b32 s51, s51, 0
    v_mfma_f32_16x16x32_bf16 v[64:67], a[84:87], v[40:43], v[64:67]
    s_waitcnt lgkmcnt(4)
    v_mfma_f32_16x16x32_bf16 v[52:55], a[88:91], v[44:47], v[52:55]
    ds_read_b128 v[36:39], v12 offset:28672
    s_cmp_ge_u32 s51, 16
    s_cselect_b32 s30, 1, 0
    v_mfma_f32_16x16x32_bf16 v[56:59], a[92:95], v[44:47], v[56:59]
    buffer_store_dwordx4 v[108:111], v112, s[12:15], s7 offen offset:1024 sc1
    v_mfma_f32_16x16x32_bf16 v[60:63], a[88:91], v[48:51], v[60:63]
    ds_read_b128 v[40:43], v13 offset:28672
    s_add_u32 s24, s24, s30
    v_mfma_f32_16x16x32_bf16 v[64:67], a[92:95], v[48:51], v[64:67]
    s_waitcnt lgkmcnt(4)
    s_add_u32 s23, s23, s30
    v_mfma_f32_16x16x32_bf16 v[52:55], a[96:99], v[20:23], v[52:55]
    ds_read_b128 v[44:47], v12 offset:30720
    s_add_u32 m0, s21, 117760
    v_mfma_f32_16x16x32_bf16 v[56:59], a[100:103], v[20:23], v[56:59]
    buffer_load_dwordx4 v11, s[8:11], s20 offen lds
    v_mfma_f32_16x16x32_bf16 v[60:63], a[96:99], v[24:27], v[60:63]
    ds_read_b128 v[48:51], v13 offset:30720
    s_lshl_b32 s53, s24, 17
    v_mfma_f32_16x16x32_bf16 v[64:67], a[100:103], v[24:27], v[64:67]
    s_waitcnt lgkmcnt(4)
    s_add_u32 s53, s53, s50
    v_mfma_f32_16x16x32_bf16 v[52:55], a[104:107], v[28:31], v[52:55]
    s_waitcnt vmcnt(20)
    s_barrier
    ds_read_b128 v[20:23], v12 offset:32768
    v_mfma_f32_16x16x32_bf16 v[56:59], a[108:111], v[28:31], v[56:59]
    s_mov_b32 s20, s53
    buffer_store_dwordx4 v[108:111], v112, s[12:15], s7 offen offset:2048 sc1
    v_mfma_f32_16x16x32_bf16 v[60:63], a[104:107], v[32:35], v[60:63]
    ds_read_b128 v[24:27], v13 offset:32768
    s_add_u32 s30, s24, 1
    v_mfma_f32_16x16x32_bf16 v[64:67], a[108:111], v[32:35], v[64:67]
    s_waitcnt lgkmcnt(4)
    s_cmp_lt_u32 s30, 64
    s_cselect_b32 s30, s30, 0x800000
    v_mfma_f32_16x16x32_bf16 v[52:55], a[112:115], v[36:39], v[52:55]
    ds_read_b128 v[28:31], v12 offset:34816
    s_add_u32 m0, s21, 0
    v_mfma_f32_16x16x32_bf16 v[56:59], a[116:119], v[36:39], v[56:59]
    buffer_load_dwordx4 v8, s[8:11], s20 offen lds
    v_mfma_f32_16x16x32_bf16 v[60:63], a[112:115], v[40:43], v[60:63]
    ds_read_b128 v[32:35], v13 offset:34816
    v_mfma_f32_16x16x32_bf16 v[64:67], a[116:119], v[40:43], v[64:67]
    s_waitcnt lgkmcnt(4)
    s_lshl_b32 s30, s30, 7
    v_mfma_f32_16x16x32_bf16 v[52:55], a[120:123], v[44:47], v[52:55]
    ds_read_b128 v[36:39], v12 offset:36864
    s_add_u32 s30, s30, s48
    v_mfma_f32_16x16x32_bf16 v[56:59], a[124:127], v[44:47], v[56:59]
    buffer_load_dword v87, v4, s[12:15], s30 offen sc1
    v_mfma_f32_16x16x32_bf16 v[60:63], a[120:123], v[48:51], v[60:63]
    ds_read_b128 v[40:43], v13 offset:36864
    s_waitcnt vmcnt(15)
    v_add_f32 v100, v116, v88
    v_mfma_f32_16x16x32_bf16 v[64:67], a[124:127], v[48:51], v[64:67]
    s_waitcnt lgkmcnt(4)
    v_add_f32 v101, v117, v89
    v_add_f32 v102, v118, v90
    v_mfma_f32_16x16x32_bf16 v[52:55], a[128:131], v[20:23], v[52:55]
    ds_read_b128 v[44:47], v12 offset:38912
    s_add_u32 m0, s21, 1024
    v_add_f32 v103, v119, v91
    v_mfma_f32_16x16x32_bf16 v[56:59], a[132:135], v[20:23], v[56:59]
    buffer_load_dwordx4 v9, s[8:11], s20 offen lds
    v_add_f32 v104, v120, v92
    v_mfma_f32_16x16x32_bf16 v[60:63], a[128:131], v[24:27], v[60:63]
    ds_read_b128 v[48:51], v13 offset:38912
    v_add_f32 v105, v121, v93
    v_add_f32 v106, v122, v94
    v_mfma_f32_16x16x32_bf16 v[64:67], a[132:135], v[24:27], v[64:67]
    s_waitcnt lgkmcnt(4)
    v_add_f32 v107, v123, v95
    v_add_f32 v96, v100, v104
    v_mfma_f32_16x16x32_bf16 v[52:55], a[136:139], v[28:31], v[52:55]
    ds_read_b128 v[20:23], v12 offset:40960
    v_add_f32 v97, v101, v105
    v_add_f32 v98, v102, v106
    v_mfma_f32_16x16x32_bf16 v[56:59], a[140:143], v[28:31], v[56:59]
    v_add_f32 v99, v103, v107
    v_mfma_f32_16x16x32_bf16 v[60:63], a[136:139], v[32:35], v[60:63]
    ds_read_b128 v[24:27], v13 offset:40960
    v_add_f32 v96, v96, v97
    v_add_f32 v98, v98, v99
    v_mfma_f32_16x16x32_bf16 v[64:67], a[140:143], v[32:35], v[64:67]
    s_waitcnt lgkmcnt(4)
    v_cmp_u_f32 vcc, v96, v98
    s_nop 0
    v_mfma_f32_16x16x32_bf16 v[52:55], a[144:147], v[36:39], v[52:55]
    ds_read_b128 v[28:31], v12 offset:43008
    s_add_u32 m0, s21, 2048
    s_nop 0
    v_mfma_f32_16x16x32_bf16 v[56:59], a[148:151], v[36:39], v[56:59]
    buffer_load_dwordx4 v10, s[8:11], s20 offen lds
    s_cbranch_vccnz L_rbad_237
L_rok_238:
    v_mfma_f32_16x16x32_bf16 v[60:63], a[144:147], v[40:43], v[60:63]
    ds_read_b128 v[32:35], v13 offset:43008
    ds_write_b128 v114, v[100:103]
    v_mfma_f32_16x16x32_bf16 v[64:67], a[148:151], v[40:43], v[64:67]
    s_waitcnt lgkmcnt(4)
    ds_write_b128 v115, v[104:107]
    ds_read_b128 v[88:91], v113 offset:0
    v_mfma_f32_16x16x32_bf16 v[52:55], a[152:155], v[44:47], v[52:55]
    ds_read_b128 v[36:39], v12 offset:45056
    ds_read_b128 v[92:95], v113 offset:1024
    v_mfma_f32_16x16x32_bf16 v[56:59], a[156:159], v[44:47], v[56:59]
    v_mfma_f32_16x16x32_bf16 v[60:63], a[152:155], v[48:51], v[60:63]
    ds_read_b128 v[40:43], v13 offset:45056
    v_mfma_f32_16x16x32_bf16 v[64:67], a[156:159], v[48:51], v[64:67]
    s_waitcnt lgkmcnt(4)
    v_mfma_f32_16x16x32_bf16 v[52:55], a[160:163], v[20:23], v[52:55]
    ds_read_b128 v[44:47], v12 offset:47104
    s_add_u32 m0, s21, 3072
    s_waitcnt lgkmcnt(2)
    v_mfma_f32_16x16x32_bf16 v[56:59], a[164:167], v[20:23], v[56:59]
    buffer_load_dwordx4 v11, s[8:11], s20 offen lds
    s_waitcnt vmcnt(9)
    v_mfma_f32_16x16x32_bf16 v[60:63], a[160:163], v[24:27], v[60:63]
    ds_read_b128 v[48:51], v13 offset:47104
    v_lshlrev_b32 v136, 16, v128
    v_and_b32 v137, 0xffff0000, v128
    v_mfma_f32_16x16x32_bf16 v[64:67], a[164:167], v[24:27], v[64:67]
    s_waitcnt lgkmcnt(4)
    v_mul_f32 v136, v136, v124
    v_mul_f32 v137, v137, v125
    v_mfma_f32_16x16x32_bf16 v[52:55], a[168:171], v[28:31], v[52:55]
    s_waitcnt vmcnt(20)
    s_barrier
    ds_read_b128 v[20:23], v12 offset:49152
    v_mfma_f32_16x16x32_bf16 v[56:59], a[172:175], v[28:31], v[56:59]
    s_add_u32 s20, s20, 16384
    v_cvt_pk_bf16_f32 v136, 0, v136
    v_mfma_f32_16x16x32_bf16 v[60:63], a[168:171], v[32:35], v[60:63]
    ds_read_b128 v[24:27], v13 offset:49152
    v_cvt_pk_bf16_f32 v137, 0, v137
    v_add_f32 v100, v88, v136
    v_mfma_f32_16x16x32_bf16 v[64:67], a[172:175], v[32:35], v[64:67]
    s_waitcnt lgkmcnt(4)
    v_add_f32 v101, v89, v137
    v_lshlrev_b32 v136, 16, v129
    v_mfma_f32_16x16x32_bf16 v[52:55], a[176:179], v[36:39], v[52:55]
    ds_read_b128 v[28:31], v12 offset:51200
    s_add_u32 m0, s21, 16384
    v_and_b32 v137, 0xffff0000, v129
    v_mfma_f32_16x16x32_bf16 v[56:59], a[180:183], v[36:39], v[56:59]
    buffer_load_dwordx4 v8, s[8:11], s20 offen lds
    v_mfma_f32_16x16x32_bf16 v[60:63], a[176:179], v[40:43], v[60:63]
    ds_read_b128 v[32:35], v13 offset:51200
    v_mul_f32 v136, v136, v126
    v_mul_f32 v137, v137, v127
    v_mfma_f32_16x16x32_bf16 v[64:67], a[180:183], v[40:43], v[64:67]
    s_waitcnt lgkmcnt(4)
    v_cvt_pk_bf16_f32 v136, 0, v136
    v_cvt_pk_bf16_f32 v137, 0, v137
    v_mfma_f32_16x16x32_bf16 v[52:55], a[184:187], v[44:47], v[52:55]
    ds_read_b128 v[36:39], v12 offset:53248
    v_add_f32 v102, v90, v136
    v_add_f32 v103, v91, v137
    v_mfma_f32_16x16x32_bf16 v[56:59], a[188:191], v[44:47], v[56:59]
    buffer_store_dwordx4 v[100:103], v134, s[16:19], s43 offen
    v_lshlrev_b32 v136, 16, v130
    v_mfma_f32_16x16x32_bf16 v[60:63], a[184:187], v[48:51], v[60:63]
    ds_read_b128 v[40:43], v13 offset:53248
    v_and_b32 v137, 0xffff0000, v130
    v_mul_f32 v136, v136, v124
    v_mfma_f32_16x16x32_bf16 v[64:67], a[188:191], v[48:51], v[64:67]
    s_waitcnt lgkmcnt(4)
    v_mul_f32 v137, v137, v125
    v_cvt_pk_bf16_f32 v136, 0, v136
    v_mfma_f32_16x16x32_bf16 v[52:55], a[192:195], v[20:23], v[52:55]
    ds_read_b128 v[44:47], v12 offset:55296
    s_add_u32 m0, s21, 17408
    v_mfma_f32_16x16x32_bf16 v[56:59], a[196:199], v[20:23], v[56:59]
    buffer_load_dwordx4 v9, s[8:11], s20 offen lds
    v_cvt_pk_bf16_f32 v137, 0, v137
    v_mfma_f32_16x16x32_bf16 v[60:63], a[192:195], v[24:27], v[60:63]
    ds_read_b128 v[48:51], v13 offset:55296
    v_add_f32 v104, v92, v136
    v_add_f32 v105, v93, v137
    v_mfma_f32_16x16x32_bf16 v[64:67], a[196:199], v[24:27], v[64:67]
    s_waitcnt lgkmcnt(4)
    v_lshlrev_b32 v136, 16, v131
    v_and_b32 v137, 0xffff0000, v131
    v_mfma_f32_16x16x32_bf16 v[52:55], a[200:203], v[28:31], v[52:55]
    ds_read_b128 v[20:23], v12 offset:57344
    v_mul_f32 v136, v136, v126
    v_mul_f32 v137, v137, v127
    v_mfma_f32_16x16x32_bf16 v[56:59], a[204:207], v[28:31], v[56:59]
    v_cvt_pk_bf16_f32 v136, 0, v136
    v_cvt_pk_bf16_f32 v137, 0, v137
    v_add_f32 v106, v94, v136
    v_add_f32 v107, v95, v137
    buffer_store_dwordx4 v[104:107], v135, s[16:19], s43 offen
    v_mfma_f32_16x16x32_bf16 v[60:63], a[200:203], v[32:35], v[60:63]
    ds_read_b128 v[24:27], v13 offset:57344
    v_mfma_f32_16x16x32_bf16 v[64:67], a[204:207], v[32:35], v[64:67]
    s_waitcnt lgkmcnt(4)
    v_mfma_f32_16x16x32_bf16 v[52:55], a[208:211], v[36:39], v[52:55]
    ds_read_b128 v[28:31], v12 offset:59392
    s_add_u32 m0, s21, 18432
    v_mov_b32 v116, v68
    v_mfma_f32_16x16x32_bf16 v[56:59], a[212:215], v[36:39], v[56:59]
    buffer_load_dwordx4 v10, s[8:11], s20 offen lds
    v_mfma_f32_16x16x32_bf16 v[60:63], a[208:211], v[40:43], v[60:63]
    ds_read_b128 v[32:35], v13 offset:59392
    v_mov_b32 v117, v69
    v_mfma_f32_16x16x32_bf16 v[64:67], a[212:215], v[40:43], v[64:67]
    s_waitcnt lgkmcnt(4)
    v_mov_b32 v118, v70
    v_mfma_f32_16x16x32_bf16 v[52:55], a[216:219], v[44:47], v[52:55]
    ds_read_b128 v[36:39], v12 offset:61440
    v_mov_b32 v119, v71
    v_mfma_f32_16x16x32_bf16 v[56:59], a[220:223], v[44:47], v[56:59]
    v_mov_b32 v120, v72
    v_mfma_f32_16x16x32_bf16 v[60:63], a[216:219], v[48:51], v[60:63]
    ds_read_b128 v[40:43], v13 offset:61440
    v_mov_b32 v121, v73
    v_mfma_f32_16x16x32_bf16 v[64:67], a[220:223], v[48:51], v[64:67]
    s_waitcnt lgkmcnt(4)
    v_mov_b32 v122, v74
    v_mfma_f32_16x16x32_bf16 v[52:55], a[224:227], v[20:23], v[52:55]
    ds_read_b128 v[44:47], v12 offset:63488
    s_add_u32 m0, s21, 19456
    v_mov_b32 v123, v75
    v_mfma_f32_16x16x32_bf16 v[56:59], a[228:231], v[20:23], v[56:59]
    buffer_load_dwordx4 v11, s[8:11], s20 offen lds
    v_mfma_f32_16x16x32_bf16 v[60:63], a[224:227], v[24:27], v[60:63]
    ds_read_b128 v[48:51], v13 offset:63488
    s_mov_b32 s7, s39
    v_mfma_f32_16x16x32_bf16 v[64:67], a[228:231], v[24:27], v[64:67]
    s_waitcnt lgkmcnt(4)
    s_add_u32 s39, s44, s31
    v_mfma_f32_16x16x32_bf16 v[52:55], a[232:235], v[28:31], v[52:55]
    s_waitcnt vmcnt(20)
    s_barrier
    ds_read_b128 v[20:23], v16 offset:0
    v_mfma_f32_16x16x32_bf16 v[56:59], a[236:239], v[28:31], v[56:59]
    s_add_u32 s20, s20, 16384
    s_sub_u32 s43, s22, 1
    s_lshl_b32 s42, s43, 16
    s_lshl_b32 s43, s43, 18
    s_cmp_eq_u32 s37, 0
    s_cselect_b32 s42, 0x7ff00000, s42
    s_cselect_b32 s43, 0x7ff00000, s43
    buffer_load_dwordx4 v[88:91], v112, s[12:15], s39 offen offset:1024 sc1
    v_mfma_f32_16x16x32_bf16 v[60:63], a[232:235], v[32:35], v[60:63]
    ds_read_b128 v[24:27], v17 offset:0
    v_mfma_f32_16x16x32_bf16 v[64:67], a[236:239], v[32:35], v[64:67]
    s_waitcnt lgkmcnt(4)
    v_mfma_f32_16x16x32_bf16 v[52:55], a[240:243], v[36:39], v[52:55]
    ds_read_b128 v[28:31], v16 offset:2048
    s_add_u32 m0, s21, 32768
    v_mfma_f32_16x16x32_bf16 v[56:59], a[244:247], v[36:39], v[56:59]
    buffer_load_dwordx4 v8, s[8:11], s20 offen lds
    v_mfma_f32_16x16x32_bf16 v[60:63], a[240:243], v[40:43], v[60:63]
    ds_read_b128 v[32:35], v17 offset:2048
    v_mfma_f32_16x16x32_bf16 v[64:67], a[244:247], v[40:43], v[64:67]
    s_waitcnt lgkmcnt(4)
    v_mfma_f32_16x16x32_bf16 v[52:55], a[248:251], v[44:47], v[52:55]
    ds_read_b128 v[36:39], v16 offset:4096
    v_mfma_f32_16x16x32_bf16 v[56:59], a[252:255], v[44:47], v[56:59]
    buffer_load_dwordx4 v[92:95], v112, s[12:15], s39 offen offset:2048 sc1
    v_mfma_f32_16x16x32_bf16 v[60:63], a[248:251], v[48:51], v[60:63]
    ds_read_b128 v[40:43], v17 offset:4096
    s_mov_b32 s37, 1
    v_mfma_f32_16x16x32_bf16 v[64:67], a[252:255], v[48:51], v[64:67]
    s_waitcnt lgkmcnt(4)
    s_add_u32 s22, s22, 1
    s_cmp_ge_u32 s22, s23
    s_cbranch_scc1 L_fl0_242
    v_mfma_f32_16x16x32_bf16 v[68:71], a[0:3], v[20:23], 0
    ds_read_b128 v[44:47], v16 offset:6144
    s_add_u32 m0, s21, 33792
    v_mfma_f32_16x16x32_bf16 v[72:75], a[4:7], v[20:23], 0
    buffer_load_dwordx4 v9, s[8:11], s20 offen lds
    v_mfma_f32_16x16x32_bf16 v[76:79], a[0:3], v[24:27], 0
    ds_read_b128 v[48:51], v17 offset:6144
    s_add_u32 s38, s38, 0x1000
    v_mfma_f32_16x16x32_bf16 v[80:83], a[4:7], v[24:27], 0
    s_waitcnt lgkmcnt(4)
    s_and_b32 s38, s38, 0x7000
    v_mfma_f32_16x16x32_bf16 v[68:71], a[8:11], v[28:31], v[68:71]
    ds_read_b128 v[20:23], v16 offset:8192
    s_waitcnt vmcnt(13)
    v_mfma_f32_16x16x32_bf16 v[72:75], a[12:15], v[28:31], v[72:75]
    ds_write_b32 v3, v87
    v_mfma_f32_16x16x32_bf16 v[76:79], a[8:11], v[32:35], v[76:79]
    ds_read_b128 v[24:27], v17 offset:8192
    s_cmp_eq_u32 s37, 0
    s_cselect_b32 s31, 0x40000000, s38
    v_mfma_f32_16x16x32_bf16 v[80:83], a[12:15], v[32:35], v[80:83]
    s_waitcnt lgkmcnt(4)
    v_mfma_f32_16x16x32_bf16 v[68:71], a[16:19], v[36:39], v[68:71]
    ds_read_b128 v[28:31], v16 offset:10240
    s_add_u32 m0, s21, 34816
    v_mfma_f32_16x16x32_bf16 v[72:75], a[20:23], v[36:39], v[72:75]
    buffer_load_dwordx4 v10, s[8:11], s20 offen lds
    v_mfma_f32_16x16x32_bf16 v[76:79], a[16:19], v[40:43], v[76:79]
    ds_read_b128 v[32:35], v17 offset:10240
    v_mfma_f32_16x16x32_bf16 v[80:83], a[20:23], v[40:43], v[80:83]
    s_waitcnt lgkmcnt(4)
    s_nop 0
    v_mfma_f32_16x16x32_bf16 v[68:71], a[24:27], v[44:47], v[68:71]
    ds_read_b128 v[36:39], v16 offset:12288
    s_add_u32 s29, s45, s31
    v_mfma_f32_16x16x32_bf16 v[72:75], a[28:31], v[44:47], v[72:75]
    buffer_store_dwordx4 v[60:63], v112, s[12:15], s29 offen offset:1024 sc1
    v_mfma_f32_16x16x32_bf16 v[76:79], a[24:27], v[48:51], v[76:79]
    ds_read_b128 v[40:43], v17 offset:12288
    v_mfma_f32_16x16x32_bf16 v[80:83], a[28:31], v[48:51], v[80:83]
    s_waitcnt lgkmcnt(4)
    s_add_u32 s29, s45, s31
    v_mfma_f32_16x16x32_bf16 v[68:71], a[32:35], v[20:23], v[68:71]
    ds_read_b128 v[44:47], v16 offset:14336
    s_add_u32 m0, s21, 35840
    v_mfma_f32_16x16x32_bf16 v[72:75], a[36:39], v[20:23], v[72:75]
    buffer_load_dwordx4 v11, s[8:11], s20 offen lds
    v_mfma_f32_16x16x32_bf16 v[76:79], a[32:35], v[24:27], v[76:79]
    ds_read_b128 v[48:51], v17 offset:14336
    v_mfma_f32_16x16x32_bf16 v[80:83], a[36:39], v[24:27], v[80:83]
    s_waitcnt lgkmcnt(4)
    v_mfma_f32_16x16x32_bf16 v[68:71], a[40:43], v[28:31], v[68:71]
    s_waitcnt vmcnt(20)
    s_barrier
    ds_read_b128 v[20:23], v16 offset:16384
    v_mfma_f32_16x16x32_bf16 v[72:75], a[44:47], v[28:31], v[72:75]
    s_add_u32 s20, s20, 16384
    buffer_store_dwordx4 v[64:67], v112, s[12:15], s29 offen offset:2048 sc1
    v_mfma_f32_16x16x32_bf16 v[76:79], a[40:43], v[32:35], v[76:79]
    ds_read_b128 v[24:27], v17 offset:16384
    ds_read_b32 v1, v2
    v_mfma_f32_16x16x32_bf16 v[80:83], a[44:47], v[32:35], v[80:83]
    s_waitcnt lgkmcnt(4)
    v_mfma_f32_16x16x32_bf16 v[68:71], a[48:51], v[36:39], v[68:71]
    ds_read_b128 v[28:31], v16 offset:18432
    s_add_u32 m0, s21, 49152
    v_mfma_f32_16x16x32_bf16 v[72:75], a[52:55], v[36:39], v[72:75]
    buffer_load_dwordx4 v8, s[8:11], s20 offen lds
    v_mfma_f32_16x16x32_bf16 v[76:79], a[48:51], v[40:43], v[76:79]
    ds_read_b128 v[32:35], v17 offset:18432
    v_mfma_f32_16x16x32_bf16 v[80:83], a[52:55], v[40:43], v[80:83]
    s_waitcnt lgkmcnt(4)
    v_mfma_f32_16x16x32_bf16 v[68:71], a[56:59], v[44:47], v[68:71]
    ds_read_b128 v[36:39], v16 offset:20480
    v_mfma_f32_16x16x32_bf16 v[72:75], a[60:63], v[44:47], v[72:75]
    buffer_load_dwordx2 v[128:129], v132, s[32:35], s42 offen
    v_mfma_f32_16x16x32_bf16 v[76:79], a[56:59], v[48:51], v[76:79]
    ds_read_b128 v[40:43], v17 offset:20480
    v_mfma_f32_16x16x32_bf16 v[80:83], a[60:63], v[48:51], v[80:83]
    s_waitcnt lgkmcnt(4)
    v_mfma_f32_16x16x32_bf16 v[68:71], a[64:67], v[20:23], v[68:71]
    ds_read_b128 v[44:47], v16 offset:22528
    s_add_u32 m0, s21, 50176
    v_mfma_f32_16x16x32_bf16 v[72:75], a[68:71], v[20:23], v[72:75]
    buffer_load_dwordx4 v9, s[8:11], s20 offen lds
    v_mfma_f32_16x16x32_bf16 v[76:79], a[64:67], v[24:27], v[76:79]
    ds_read_b128 v[48:51], v17 offset:22528
    v_mfma_f32_16x16x32_bf16 v[80:83], a[68:71], v[24:27], v[80:83]
    s_waitcnt lgkmcnt(4)
    v_mfma_f32_16x16x32_bf16 v[68:71], a[72:75], v[28:31], v[68:71]
    ds_read_b128 v[20:23], v16 offset:24576
    v_mfma_f32_16x16x32_bf16 v[72:75], a[76:79], v[28:31], v[72:75]
    buffer_load_dwordx2 v[130:131], v133, s[32:35], s42 offen
    v_mfma_f32_16x16x32_bf16 v[76:79], a[72:75], v[32:35], v[76:79]
    ds_read_b128 v[24:27], v17 offset:24576
    v_readfirstlane_b32 s51, v1
    v_mfma_f32_16x16x32_bf16 v[80:83], a[76:79], v[32:35], v[80:83]
    s_waitcnt lgkmcnt(4)
    s_add_u32 s30, s22, 1
    v_mfma_f32_16x16x32_bf16 v[68:71], a[80:83], v[36:39], v[68:71]
    ds_read_b128 v[28:31], v16 offset:26624
    s_add_u32 m0, s21, 51200
    v_mfma_f32_16x16x32_bf16 v[72:75], a[84:87], v[36:39], v[72:75]
    buffer_load_dwordx4 v10, s[8:11], s20 offen lds
    v_mfma_f32_16x16x32_bf16 v[76:79], a[80:83], v[40:43], v[76:79]
    ds_read_b128 v[32:35], v17 offset:26624
    s_cmp_eq_u32 s30, s24
    s_cselect_b32 s51, s51, 0
    v_mfma_f32_16x16x32_bf16 v[80:83], a[84:87], v[40:43], v[80:83]
    s_waitcnt lgkmcnt(4)
    v_mfma_f32_16x16x32_bf16 v[68:71], a[88:91], v[44:47], v[68:71]
    ds_read_b128 v[36:39], v16 offset:28672
    s_cmp_ge_u32 s51, 16
    s_cselect_b32 s30, 1, 0
    v_mfma_f32_16x16x32_bf16 v[72:75], a[92:95], v[44:47], v[72:75]
    buffer_store_dwordx4 v[108:111], v112, s[12:15], s7 offen offset:1024 sc1
    v_mfma_f32_16x16x32_bf16 v[76:79], a[88:91], v[48:51], v[76:79]
    ds_read_b128 v[40:43], v17 offset:28672
    s_add_u32 s24, s24, s30
    v_mfma_f32_16x16x32_bf16 v[80:83], a[92:95], v[48:51], v[80:83]
    s_waitcnt lgkmcnt(4)
    s_add_u32 s23, s23, s30
    v_mfma_f32_16x16x32_bf16 v[68:71], a[96:99], v[20:23], v[68:71]
    ds_read_b128 v[44:47], v16 offset:30720
    s_add_u32 m0, s21, 52224
    v_mfma_f32_16x16x32_bf16 v[72:75], a[100:103], v[20:23], v[72:75]
    buffer_load_dwordx4 v11, s[8:11], s20 offen lds
    v_mfma_f32_16x16x32_bf16 v[76:79], a[96:99], v[24:27], v[76:79]
    ds_read_b128 v[48:51], v17 offset:30720
    s_lshl_b32 s53, s24, 17
    v_mfma_f32_16x16x32_bf16 v[80:83], a[100:103], v[24:27], v[80:83]
    s_waitcnt lgkmcnt(4)
    s_add_u32 s53, s53, s50
    v_mfma_f32_16x16x32_bf16 v[68:71], a[104:107], v[28:31], v[68:71]
    s_waitcnt vmcnt(20)
    s_barrier
    ds_read_b128 v[20:23], v16 offset:32768
    v_mfma_f32_16x16x32_bf16 v[72:75], a[108:111], v[28:31], v[72:75]
    s_mov_b32 s20, s53
    buffer_store_dwordx4 v[108:111], v112, s[12:15], s7 offen offset:2048 sc1
    v_mfma_f32_16x16x32_bf16 v[76:79], a[104:107], v[32:35], v[76:79]
    ds_read_b128 v[24:27], v17 offset:32768
    s_add_u32 s30, s24, 1
    v_mfma_f32_16x16x32_bf16 v[80:83], a[108:111], v[32:35], v[80:83]
    s_waitcnt lgkmcnt(4)
    s_cmp_lt_u32 s30, 64
    s_cselect_b32 s30, s30, 0x800000
    v_mfma_f32_16x16x32_bf16 v[68:71], a[112:115], v[36:39], v[68:71]
    ds_read_b128 v[28:31], v16 offset:34816
    s_add_u32 m0, s21, 65536
    v_mfma_f32_16x16x32_bf16 v[72:75], a[116:119], v[36:39], v[72:75]
    buffer_load_dwordx4 v8, s[8:11], s20 offen lds
    v_mfma_f32_16x16x32_bf16 v[76:79], a[112:115], v[40:43], v[76:79]
    ds_read_b128 v[32:35], v17 offset:34816
    v_mfma_f32_16x16x32_bf16 v[80:83], a[116:119], v[40:43], v[80:83]
    s_waitcnt lgkmcnt(4)
    s_lshl_b32 s30, s30, 7
    v_mfma_f32_16x16x32_bf16 v[68:71], a[120:123], v[44:47], v[68:71]
    ds_read_b128 v[36:39], v16 offset:36864
    s_add_u32 s30, s30, s48
    v_mfma_f32_16x16x32_bf16 v[72:75], a[124:127], v[44:47], v[72:75]
    buffer_load_dword v87, v4, s[12:15], s30 offen sc1
    v_mfma_f32_16x16x32_bf16 v[76:79], a[120:123], v[48:51], v[76:79]
    ds_read_b128 v[40:43], v17 offset:36864
    s_waitcnt vmcnt(15)
    v_add_f32 v100, v116, v88
    v_mfma_f32_16x16x32_bf16 v[80:83], a[124:127], v[48:51], v[80:83]
    s_waitcnt lgkmcnt(4)
    v_add_f32 v101, v117, v89
    v_add_f32 v102, v118, v90
    v_mfma_f32_16x16x32_bf16 v[68:71], a[128:131], v[20:23], v[68:71]
    ds_read_b128 v[44:47], v16 offset:38912
    s_add_u32 m0, s21, 66560
    v_add_f32 v103, v119, v91
    v_mfma_f32_16x16x32_bf16 v[72:75], a[132:135], v[20:23], v[72:75]
    buffer_load_dwordx4 v9, s[8:11], s20 offen lds
    v_add_f32 v104, v120, v92
    v_mfma_f32_16x16x32_bf16 v[76:79], a[128:131], v[24:27], v[76:79]
    ds_read_b128 v[48:51], v17 offset:38912
    v_add_f32 v105, v121, v93
    v_add_f32 v106, v122, v94
    v_mfma_f32_16x16x32_bf16 v[80:83], a[132:135], v[24:27], v[80:83]
    s_waitcnt lgkmcnt(4)
    v_add_f32 v107, v123, v95
    v_add_f32 v96, v100, v104
    v_mfma_f32_16x16x32_bf16 v[68:71], a[136:139], v[28:31], v[68:71]
    ds_read_b128 v[20:23], v16 offset:40960
    v_add_f32 v97, v101, v105
    v_add_f32 v98, v102, v106
    v_mfma_f32_16x16x32_bf16 v[72:75], a[140:143], v[28:31], v[72:75]
    v_add_f32 v99, v103, v107
    v_mfma_f32_16x16x32_bf16 v[76:79], a[136:139], v[32:35], v[76:79]
    ds_read_b128 v[24:27], v17 offset:40960
    v_add_f32 v96, v96, v97
    v_add_f32 v98, v98, v99
    v_mfma_f32_16x16x32_bf16 v[80:83], a[140:143], v[32:35], v[80:83]
    s_waitcnt lgkmcnt(4)
    v_cmp_u_f32 vcc, v96, v98
    s_nop 0
    v_mfma_f32_16x16x32_bf16 v[68:71], a[144:147], v[36:39], v[68:71]
    ds_read_b128 v[28:31], v16 offset:43008
    s_add_u32 m0, s21, 67584
    s_nop 0
    v_mfma_f32_16x16x32_bf16 v[72:75], a[148:151], v[36:39], v[72:75]
    buffer_load_dwordx4 v10, s[8:11], s20 offen lds
    s_cbranch_vccnz L_rbad_239
L_rok_240:
    v_mfma_f32_16x16x32_bf16 v[76:79], a[144:147], v[40:43], v[76:79]
    ds_read_b128 v[32:35], v17 offset:43008
    ds_write_b128 v114, v[100:103]
    v_mfma_f32_16x16x32_bf16 v[80:83], a[148:151], v[40:43], v[80:83]
    s_waitcnt lgkmcnt(4)
    ds_write_b128 v115, v[104:107]
    ds_read_b128 v[88:91], v113 offset:0
    v_mfma_f32_16x16x32_bf16 v[68:71], a[152:155], v[44:47], v[68:71]
    ds_read_b128 v[36:39], v16 offset:45056
    ds_read_b128 v[92:95], v113 offset:1024
    v_mfma_f32_16x16x32_bf16 v[72:75], a[156:159], v[44:47], v[72:75]
    v_mfma_f32_16x16x32_bf16 v[76:79], a[152:155], v[48:51], v[76:79]
    ds_read_b128 v[40:43], v17 offset:45056
    v_mfma_f32_16x16x32_bf16 v[80:83], a[156:159], v[48:51], v[80:83]
    s_waitcnt lgkmcnt(4)
    v_mfma_f32_16x16x32_bf16 v[68:71], a[160:163], v[20:23], v[68:71]
    ds_read_b128 v[44:47], v16 offset:47104
    s_add_u32 m0, s21, 68608
    s_waitcnt lgkmcnt(2)
    v_mfma_f32_16x16x32_bf16 v[72:75], a[164:167], v[20:23], v[72:75]
    buffer_load_dwordx4 v11, s[8:11], s20 offen lds
    s_waitcnt vmcnt(9)
    v_mfma_f32_16x16x32_bf16 v[76:79], a[160:163], v[24:27], v[76:79]
    ds_read_b128 v[48:51], v17 offset:47104
    v_lshlrev_b32 v136, 16, v128
    v_and_b32 v137, 0xffff0000, v128
    v_mfma_f32_16x16x32_bf16 v[80:83], a[164:167], v[24:27], v[80:83]
    s_waitcnt lgkmcnt(4)
    v_mul_f32 v136, v136, v124
    v_mul_f32 v137, v137, v125
    v_mfma_f32_16x16x32_bf16 v[68:71], a[168:171], v[28:31], v[68:71]
    s_waitcnt vmcnt(20)
    s_barrier
    ds_read_b128 v[20:23], v16 offset:49152
    v_mfma_f32_16x16x32_bf16 v[72:75], a[172:175], v[28:31], v[72:75]
    s_add_u32 s20, s20, 16384
    v_cvt_pk_bf16_f32 v136, 0, v136
    v_mfma_f32_16x16x32_bf16 v[76:79], a[168:171], v[32:35], v[76:79]
    ds_read_b128 v[24:27], v17 offset:49152
    v_cvt_pk_bf16_f32 v137, 0, v137
    v_add_f32 v100, v88, v136
    v_mfma_f32_16x16x32_bf16 v[80:83], a[172:175], v[32:35], v[80:83]
    s_waitcnt lgkmcnt(4)
    v_add_f32 v101, v89, v137
    v_lshlrev_b32 v136, 16, v129
    v_mfma_f32_16x16x32_bf16 v[68:71], a[176:179], v[36:39], v[68:71]
    ds_read_b128 v[28:31], v16 offset:51200
    s_add_u32 m0, s21, 81920
    v_and_b32 v137, 0xffff0000, v129
    v_mfma_f32_16x16x32_bf16 v[72:75], a[180:183], v[36:39], v[72:75]
    buffer_load_dwordx4 v8, s[8:11], s20 offen lds
    v_mfma_f32_16x16x32_bf16 v[76:79], a[176:179], v[40:43], v[76:79]
    ds_read_b128 v[32:35], v17 offset:51200
    v_mul_f32 v136, v136, v126
    v_mul_f32 v137, v137, v127
    v_mfma_f32_16x16x32_bf16 v[80:83], a[180:183], v[40:43], v[80:83]
    s_waitcnt lgkmcnt(4)
    v_cvt_pk_bf16_f32 v136, 0, v136
    v_cvt_pk_bf16_f32 v137, 0, v137
    v_mfma_f32_16x16x32_bf16 v[68:71], a[184:187], v[44:47], v[68:71]
    ds_read_b128 v[36:39], v16 offset:53248
    v_add_f32 v102, v90, v136
    v_add_f32 v103, v91, v137
    v_mfma_f32_16x16x32_bf16 v[72:75], a[188:191], v[44:47], v[72:75]
    buffer_store_dwordx4 v[100:103], v134, s[16:19], s43 offen
    v_lshlrev_b32 v136, 16, v130
    v_mfma_f32_16x16x32_bf16 v[76:79], a[184:187], v[48:51], v[76:79]
    ds_read_b128 v[40:43], v17 offset:53248
    v_and_b32 v137, 0xffff0000, v130
    v_mul_f32 v136, v136, v124
    v_mfma_f32_16x16x32_bf16 v[80:83], a[188:191], v[48:51], v[80:83]
    s_waitcnt lgkmcnt(4)
    v_mul_f32 v137, v137, v125
    v_cvt_pk_bf16_f32 v136, 0, v136
    v_mfma_f32_16x16x32_bf16 v[68:71], a[192:195], v[20:23], v[68:71]
    ds_read_b128 v[44:47], v16 offset:55296
    s_add_u32 m0, s21, 82944
    v_mfma_f32_16x16x32_bf16 v[72:75], a[196:199], v[20:23], v[72:75]
    buffer_load_dwordx4 v9, s[8:11], s20 offen lds
    v_cvt_pk_bf16_f32 v137, 0, v137
    v_mfma_f32_16x16x32_bf16 v[76:79], a[192:195], v[24:27], v[76:79]
    ds_read_b128 v[48:51], v17 offset:55296
    v_add_f32 v104, v92, v136
    v_add_f32 v105, v93, v137
    v_mfma_f32_16x16x32_bf16 v[80:83], a[196:199], v[24:27], v[80:83]
    s_waitcnt lgkmcnt(4)
    v_lshlrev_b32 v136, 16, v131
    v_and_b32 v137, 0xffff0000, v131
    v_mfma_f32_16x16x32_bf16 v[68:71], a[200:203], v[28:31], v[68:71]
    ds_read_b128 v[20:23], v16 offset:57344
    v_mul_f32 v136, v136, v126
    v_mul_f32 v137, v137, v127
    v_mfma_f32_16x16x32_bf16 v[72:75], a[204:207], v[28:31], v[72:75]
    v_cvt_pk_bf16_f32 v136, 0, v136
    v_cvt_pk_bf16_f32 v137, 0, v137
    v_add_f32 v106, v94, v136
    v_add_f32 v107, v95, v137
    buffer_store_dwordx4 v[104:107], v135, s[16:19], s43 offen
    v_mfma_f32_16x16x32_bf16 v[76:79], a[200:203], v[32:35], v[76:79]
    ds_read_b128 v[24:27], v17 offset:57344
    v_mfma_f32_16x16x32_bf16 v[80:83], a[204:207], v[32:35], v[80:83]
    s_waitcnt lgkmcnt(4)
    v_mfma_f32_16x16x32_bf16 v[68:71], a[208:211], v[36:39], v[68:71]
    ds_read_b128 v[28:31], v16 offset:59392
    s_add_u32 m0, s21, 83968
    v_mov_b32 v116, v52
    v_mfma_f32_16x16x32_bf16 v[72:75], a[212:215], v[36:39], v[72:75]
    buffer_load_dwordx4 v10, s[8:11], s20 offen lds
    v_mfma_f32_16x16x32_bf16 v[76:79], a[208:211], v[40:43], v[76:79]
    ds_read_b128 v[32:35], v17 offset:59392
    v_mov_b32 v117, v53
    v_mfma_f32_16x16x32_bf16 v[80:83], a[212:215], v[40:43], v[80:83]
    s_waitcnt lgkmcnt(4)
    v_mov_b32 v118, v54
    v_mfma_f32_16x16x32_bf16 v[68:71], a[216:219], v[44:47], v[68:71]
    ds_read_b128 v[36:39], v16 offset:61440
    v_mov_b32 v119, v55
    v_mfma_f32_16x16x32_bf16 v[72:75], a[220:223], v[44:47], v[72:75]
    v_mov_b32 v120, v56
    v_mfma_f32_16x16x32_bf16 v[76:79], a[216:219], v[48:51], v[76:79]
    ds_read_b128 v[40:43], v17 offset:61440
    v_mov_b32 v121, v57
    v_mfma_f32_16x16x32_bf16 v[80:83], a[220:223], v[48:51], v[80:83]
    s_waitcnt lgkmcnt(4)
    v_mov_b32 v122, v58
    v_mfma_f32_16x16x32_bf16 v[68:71], a[224:227], v[20:23], v[68:71]
    ds_read_b128 v[44:47], v16 offset:63488
    s_add_u32 m0, s21, 84992
    v_mov_b32 v123, v59
    v_mfma_f32_16x16x32_bf16 v[72:75], a[228:231], v[20:23], v[72:75]
    buffer_load_dwordx4 v11, s[8:11], s20 offen lds
    v_mfma_f32_16x16x32_bf16 v[76:79], a[224:227], v[24:27], v[76:79]
    ds_read_b128 v[48:51], v17 offset:63488
    s_mov_b32 s7, s39
    v_mfma_f32_16x16x32_bf16 v[80:83], a[228:231], v[24:27], v[80:83]
    s_waitcnt lgkmcnt(4)
    s_add_u32 s39, s44, s31
    v_mfma_f32_16x16x32_bf16 v[68:71], a[232:235], v[28:31], v[68:71]
    s_waitcnt vmcnt(20)
    s_barrier
    ds_read_b128 v[20:23], v12 offset:0
    v_mfma_f32_16x16x32_bf16 v[72:75], a[236:239], v[28:31], v[72:75]
    s_add_u32 s20, s20, 16384
    s_sub_u32 s43, s22, 1
    s_lshl_b32 s42, s43, 16
    s_lshl_b32 s43, s43, 18
    s_cmp_eq_u32 s37, 0
    s_cselect_b32 s42, 0x7ff00000, s42
    s_cselect_b32 s43, 0x7ff00000, s43
    buffer_load_dwordx4 v[88:91], v112, s[12:15], s39 offen offset:1024 sc1
    v_mfma_f32_16x16x32_bf16 v[76:79], a[232:235], v[32:35], v[76:79]
    ds_read_b128 v[24:27], v13 offset:0
    v_mfma_f32_16x16x32_bf16 v[80:83], a[236:239], v[32:35], v[80:83]
    s_waitcnt lgkmcnt(4)
    v_mfma_f32_16x16x32_bf16 v[68:71], a[240:243], v[36:39], v[68:71]
    ds_read_b128 v[28:31], v12 offset:2048
    s_add_u32 m0, s21, 98304
    v_mfma_f32_16x16x32_bf16 v[72:75], a[244:247], v[36:39], v[72:75]
    buffer_load_dwordx4 v8, s[8:11], s20 offen lds
    v_mfma_f32_16x16x32_bf16 v[76:79], a[240:243], v[40:43], v[76:79]
    ds_read_b128 v[32:35], v13 offset:2048
    v_mfma_f32_16x16x32_bf16 v[80:83], a[244:247], v[40:43], v[80:83]
    s_waitcnt lgkmcnt(4)
    v_mfma_f32_16x16x32_bf16 v[68:71], a[248:251], v[44:47], v[68:71]
    ds_read_b128 v[36:39], v12 offset:4096
    v_mfma_f32_16x16x32_bf16 v[72:75], a[252:255], v[44:47], v[72:75]
    buffer_load_dwordx4 v[92:95], v112, s[12:15], s39 offen offset:2048 sc1
    v_mfma_f32_16x16x32_bf16 v[76:79], a[248:251], v[48:51], v[76:79]
    ds_read_b128 v[40:43], v13 offset:4096
    s_mov_b32 s37, 1
    v_mfma_f32_16x16x32_bf16 v[80:83], a[252:255], v[48:51], v[80:83]
    s_waitcnt lgkmcnt(4)
    s_add_u32 s22, s22, 1
    s_cmp_ge_u32 s22, s23
    s_cbranch_scc0 L_st_241
    s_waitcnt lgkmcnt(0)
    s_nop 7
    s_add_u32 s38, s38, 0x1000
    s_and_b32 s38, s38, 0x7000
    s_cmp_eq_u32 s37, 0
    s_cselect_b32 s31, 0x40000000, s38
    s_nop 0
    s_add_u32 s29, s45, s31
    buffer_store_dwordx4 v[76:79], v112, s[12:15], s29 offen offset:1024 sc1
    s_add_u32 s29, s45, s31
    buffer_store_dwordx4 v[80:83], v112, s[12:15], s29 offen offset:2048 sc1
    buffer_load_dwordx2 v[128:129], v132, s[32:35], s42 offen
    buffer_load_dwordx2 v[130:131], v133, s[32:35], s42 offen
    buffer_store_dwordx4 v[108:111], v112, s[12:15], s7 offen offset:1024 sc1
    buffer_store_dwordx4 v[108:111], v112, s[12:15], s7 offen offset:2048 sc1
    s_waitcnt vmcnt(0)
    v_add_f32 v100, v116, v88
    v_add_f32 v101, v117, v89
    v_add_f32 v102, v118, v90
    v_add_f32 v103, v119, v91
    v_add_f32 v104, v120, v92
    v_add_f32 v105, v121, v93
    v_add_f32 v106, v122, v94
    v_add_f32 v107, v123, v95
    v_add_f32 v96, v100, v104
    v_add_f32 v97, v101, v105
    v_add_f32 v98, v102, v106
    v_add_f32 v99, v103, v107
    v_add_f32 v96, v96, v97
    v_add_f32 v98, v98, v99
    v_cmp_u_f32 vcc, v96, v98
    s_nop 0
    s_nop 0
    s_cbranch_vccnz L_rbad_244
L_rok_245:
    ds_write_b128 v114, v[100:103]
    ds_write_b128 v115, v[104:107]
    ds_read_b128 v[88:91], v113 offset:0
    ds_read_b128 v[92:95], v113 offset:1024
    s_waitcnt lgkmcnt(0)
    s_waitcnt vmcnt(0)
    v_lshlrev_b32 v136, 16, v128
    v_and_b32 v137, 0xffff0000, v128
    v_mul_f32 v136, v136, v124
    v_mul_f32 v137, v137, v125
    v_cvt_pk_bf16_f32 v136, 0, v136
    v_cvt_pk_bf16_f32 v137, 0, v137
    v_add_f32 v100, v88, v136
    v_add_f32 v101, v89, v137
    v_lshlrev_b32 v136, 16, v129
    v_and_b32 v137, 0xffff0000, v129
    v_mul_f32 v136, v136, v126
    v_mul_f32 v137, v137, v127
    v_cvt_pk_bf16_f32 v136, 0, v136
    v_cvt_pk_bf16_f32 v137, 0, v137
    v_add_f32 v102, v90, v136
    v_add_f32 v103, v91, v137
    buffer_store_dwordx4 v[100:103], v134, s[16:19], s43 offen
    v_lshlrev_b32 v136, 16, v130
    v_and_b32 v137, 0xffff0000, v130
    v_mul_f32 v136, v136, v124
    v_mul_f32 v137, v137, v125
    v_cvt_pk_bf16_f32 v136, 0, v136
    v_cvt_pk_bf16_f32 v137, 0, v137
    v_add_f32 v104, v92, v136
    v_add_f32 v105, v93, v137
    v_lshlrev_b32 v136, 16, v131
    v_and_b32 v137, 0xffff0000, v131
    v_mul_f32 v136, v136, v126
    v_mul_f32 v137, v137, v127
    v_cvt_pk_bf16_f32 v136, 0, v136
    v_cvt_pk_bf16_f32 v137, 0, v137
    v_add_f32 v106, v94, v136
    v_add_f32 v107, v95, v137
    buffer_store_dwordx4 v[104:107], v135, s[16:19], s43 offen
    v_mov_b32 v116, v68
    v_mov_b32 v117, v69
    v_mov_b32 v118, v70
    v_mov_b32 v119, v71
    v_mov_b32 v120, v72
    v_mov_b32 v121, v73
    v_mov_b32 v122, v74
    v_mov_b32 v123, v75
    s_mov_b32 s7, s39
    s_add_u32 s39, s44, s31
    s_sub_u32 s43, s22, 1
    s_lshl_b32 s42, s43, 16
    s_lshl_b32 s43, s43, 18
    s_cmp_eq_u32 s37, 0
    s_cselect_b32 s42, 0x7ff00000, s42
    s_cselect_b32 s43, 0x7ff00000, s43
    buffer_load_dwordx4 v[88:91], v112, s[12:15], s39 offen offset:1024 sc1
    buffer_load_dwordx4 v[92:95], v112, s[12:15], s39 offen offset:2048 sc1
    s_mov_b32 s37, 1
    buffer_load_dwordx2 v[128:129], v132, s[32:35], s42 offen
    buffer_load_dwordx2 v[130:131], v133, s[32:35], s42 offen
    buffer_store_dwordx4 v[108:111], v112, s[12:15], s7 offen offset:1024 sc1
    buffer_store_dwordx4 v[108:111], v112, s[12:15], s7 offen offset:2048 sc1
    s_waitcnt vmcnt(0)
    v_add_f32 v100, v116, v88
    v_add_f32 v101, v117, v89
    v_add_f32 v102, v118, v90
    v_add_f32 v103, v119, v91
    v_add_f32 v104, v120, v92
    v_add_f32 v105, v121, v93
    v_add_f32 v106, v122, v94
    v_add_f32 v107, v123, v95
    v_add_f32 v96, v100, v104
    v_add_f32 v97, v101, v105
    v_add_f32 v98, v102, v106
    v_add_f32 v99, v103, v107
    v_add_f32 v96, v96, v97
    v_add_f32 v98, v98, v99
    v_cmp_u_f32 vcc, v96, v98
    s_nop 0
    s_nop 0
    s_cbranch_vccnz L_rbad_246
L_rok_247:
    ds_write_b128 v114, v[100:103]
    ds_write_b128 v115, v[104:107]
    ds_read_b128 v[88:91], v113 offset:0
    ds_read_b128 v[92:95], v113 offset:1024
    s_waitcnt lgkmcnt(0)
    s_waitcnt vmcnt(0)
    v_lshlrev_b32 v136, 16, v128
    v_and_b32 v137, 0xffff0000, v128
    v_mul_f32 v136, v136, v124
    v_mul_f32 v137, v137, v125
    v_cvt_pk_bf16_f32 v136, 0, v136
    v_cvt_pk_bf16_f32 v137, 0, v137
    v_add_f32 v100, v88, v136
    v_add_f32 v101, v89, v137
    v_lshlrev_b32 v136, 16, v129
    v_and_b32 v137, 0xffff0000, v129
    v_mul_f32 v136, v136, v126
    v_mul_f32 v137, v137, v127
    v_cvt_pk_bf16_f32 v136, 0, v136
    v_cvt_pk_bf16_f32 v137, 0, v137
    v_add_f32 v102, v90, v136
    v_add_f32 v103, v91, v137
    buffer_store_dwordx4 v[100:103], v134, s[16:19], s43 offen
    v_lshlrev_b32 v136, 16, v130
    v_and_b32 v137, 0xffff0000, v130
    v_mul_f32 v136, v136, v124
    v_mul_f32 v137, v137, v125
    v_cvt_pk_bf16_f32 v136, 0, v136
    v_cvt_pk_bf16_f32 v137, 0, v137
    v_add_f32 v104, v92, v136
    v_add_f32 v105, v93, v137
    v_lshlrev_b32 v136, 16, v131
    v_and_b32 v137, 0xffff0000, v131
    v_mul_f32 v136, v136, v126
    v_mul_f32 v137, v137, v127
    v_cvt_pk_bf16_f32 v136, 0, v136
    v_cvt_pk_bf16_f32 v137, 0, v137
    v_add_f32 v106, v94, v136
    v_add_f32 v107, v95, v137
    buffer_store_dwordx4 v[104:107], v135, s[16:19], s43 offen
    s_mov_b32 s7, s39
    buffer_store_dwordx4 v[108:111], v112, s[12:15], s7 offen offset:1024 sc1
    buffer_store_dwordx4 v[108:111], v112, s[12:15], s7 offen offset:2048 sc1
    s_branch L_ste_243
L_rbad_237:
    buffer_load_dwordx4 v[88:91], v112, s[12:15], s39 offen offset:1024 sc1
    buffer_load_dwordx4 v[92:95], v112, s[12:15], s39 offen offset:2048 sc1
    s_add_u32 s36, s36, 1
    s_cmp_gt_u32 s36, 0x100000
    s_cbranch_scc1 chain_kernel_wend
    s_waitcnt vmcnt(0)
    v_max_u32 v100, v88, v89
    v_max3_u32 v100, v100, v90, v91
    v_max3_u32 v100, v100, v92, v93
    v_max3_u32 v100, v100, v94, v95
    v_cmp_eq_u32 vcc, v108, v100
    s_cbranch_vccnz L_rbad_237
    v_add_f32 v100, v116, v88
    v_add_f32 v101, v117, v89
    v_add_f32 v102, v118, v90
    v_add_f32 v103, v119, v91
    v_add_f32 v104, v120, v92
    v_add_f32 v105, v121, v93
    v_add_f32 v106, v122, v94
    v_add_f32 v107, v123, v95
    v_add_f32 v96, v100, v104
    v_add_f32 v97, v101, v105
    v_add_f32 v98, v102, v106
    v_add_f32 v99, v103, v107
    v_add_f32 v96, v96, v97
    v_add_f32 v98, v98, v99
    v_cmp_u_f32 vcc, v96, v98
    s_branch L_rok_238
L_rbad_239:
    buffer_load_dwordx4 v[88:91], v112, s[12:15], s39 offen offset:1024 sc1
    buffer_load_dwordx4 v[92:95], v112, s[12:15], s39 offen offset:2048 sc1
    s_add_u32 s36, s36, 1
    s_cmp_gt_u32 s36, 0x100000
    s_cbranch_scc1 chain_kernel_wend
    s_waitcnt vmcnt(0)
    v_max_u32 v100, v88, v89
    v_max3_u32 v100, v100, v90, v91
    v_max3_u32 v100, v100, v92, v93
    v_max3_u32 v100, v100, v94, v95
    v_cmp_eq_u32 vcc, v108, v100
    s_cbranch_vccnz L_rbad_239
    v_add_f32 v100, v116, v88
    v_add_f32 v101, v117, v89
    v_add_f32 v102, v118, v90
    v_add_f32 v103, v119, v91
    v_add_f32 v104, v120, v92
    v_add_f32 v105, v121, v93
    v_add_f32 v106, v122, v94
    v_add_f32 v107, v123, v95
    v_add_f32 v96, v100, v104
    v_add_f32 v97, v101, v105
    v_add_f32 v98, v102, v106
    v_add_f32 v99, v103, v107
    v_add_f32 v96, v96, v97
    v_add_f32 v98, v98, v99
    v_cmp_u_f32 vcc, v96, v98
    s_branch L_rok_240
L_rbad_244:
    buffer_load_dwordx4 v[88:91], v112, s[12:15], s39 offen offset:1024 sc1
    buffer_load_dwordx4 v[92:95], v112, s[12:15], s39 offen offset:2048 sc1
    s_add_u32 s36, s36, 1
    s_cmp_gt_u32 s36, 0x100000
    s_cbranch_scc1 chain_kernel_wend
    s_waitcnt vmcnt(0)
    v_max_u32 v100, v88, v89
    v_max3_u32 v100, v100, v90, v91
    v_max3_u32 v100, v100, v92, v93
    v_max3_u32 v100, v100, v94, v95
    v_cmp_eq_u32 vcc, v108, v100
    s_cbranch_vccnz L_rbad_244
    v_add_f32 v100, v116, v88
    v_add_f32 v101, v117, v89
    v_add_f32 v102, v118, v90
    v_add_f32 v103, v119, v91
    v_add_f32 v104, v120, v92
    v_add_f32 v105, v121, v93
    v_add_f32 v106, v122, v94
    v_add_f32 v107, v123, v95
    v_add_f32 v96, v100, v104
    v_add_f32 v97, v101, v105
    v_add_f32 v98, v102, v106
    v_add_f32 v99, v103, v107
    v_add_f32 v96, v96, v97
    v_add_f32 v98, v98, v99
    v_cmp_u_f32 vcc, v96, v98
    s_branch L_rok_245
L_rbad_246:
    buffer_load_dwordx4 v[88:91], v112, s[12:15], s39 offen offset:1024 sc1
    buffer_load_dwordx4 v[92:95], v112, s[12:15], s39 offen offset:2048 sc1
    s_add_u32 s36, s36, 1
    s_cmp_gt_u32 s36, 0x100000
    s_cbranch_scc1 chain_kernel_wend
    s_waitcnt vmcnt(0)
    v_max_u32 v100, v88, v89
    v_max3_u32 v100, v100, v90, v91
    v_max3_u32 v100, v100, v92, v93
    v_max3_u32 v100, v100, v94, v95
    v_cmp_eq_u32 vcc, v108, v100
    s_cbranch_vccnz L_rbad_246
    v_add_f32 v100, v116, v88
    v_add_f32 v101, v117, v89
    v_add_f32 v102, v118, v90
    v_add_f32 v103, v119, v91
    v_add_f32 v104, v120, v92
    v_add_f32 v105, v121, v93
    v_add_f32 v106, v122, v94
    v_add_f32 v107, v123, v95
    v_add_f32 v96, v100, v104
    v_add_f32 v97, v101, v105
    v_add_f32 v98, v102, v106
    v_add_f32 v99, v103, v107
    v_add_f32 v96, v96, v97
    v_add_f32 v98, v98, v99
    v_cmp_u_f32 vcc, v96, v98
    s_branch L_rok_247
L_fl0_242:
    s_waitcnt lgkmcnt(0)
    s_nop 7
    s_add_u32 s38, s38, 0x1000
    s_and_b32 s38, s38, 0x7000
    s_cmp_eq_u32 s37, 0
    s_cselect_b32 s31, 0x40000000, s38
    s_nop 0
    s_add_u32 s29, s45, s31
    buffer_store_dwordx4 v[60:63], v112, s[12:15], s29 offen offset:1024 sc1
    s_add_u32 s29, s45, s31
    buffer_store_dwordx4 v[64:67], v112, s[12:15], s29 offen offset:2048 sc1
    buffer_load_dwordx2 v[128:129], v132, s[32:35], s42 offen
    buffer_load_dwordx2 v[130:131], v133, s[32:35], s42 offen
    buffer_store_dwordx4 v[108:111], v112, s[12:15], s7 offen offset:1024 sc1
    buffer_store_dwordx4 v[108:111], v112, s[12:15], s7 offen offset:2048 sc1
    s_waitcnt vmcnt(0)
    v_add_f32 v100, v116, v88
    v_add_f32 v101, v117, v89
    v_add_f32 v102, v118, v90
    v_add_f32 v103, v119, v91
    v_add_f32 v104, v120, v92
    v_add_f32 v105, v121, v93
    v_add_f32 v106, v122, v94
    v_add_f32 v107, v123, v95
    v_add_f32 v96, v100, v104
    v_add_f32 v97, v101, v105
    v_add_f32 v98, v102, v106
    v_add_f32 v99, v103, v107
    v_add_f32 v96, v96, v97
    v_add_f32 v98, v98, v99
    v_cmp_u_f32 vcc, v96, v98
    s_nop 0
    s_nop 0
    s_cbranch_vccnz L_rbad_248
L_rok_249:
    ds_write_b128 v114, v[100:103]
    ds_write_b128 v115, v[104:107]
    ds_read_b128 v[88:91], v113 offset:0
    ds_read_b128 v[92:95], v113 offset:1024
    s_waitcnt lgkmcnt(0)
    s_waitcnt vmcnt(0)
    v_lshlrev_b32 v136, 16, v128
    v_and_b32 v137, 0xffff0000, v128
    v_mul_f32 v136, v136, v124
    v_mul_f32 v137, v137, v125
    v_cvt_pk_bf16_f32 v136, 0, v136
    v_cvt_pk_bf16_f32 v137, 0, v137
    v_add_f32 v100, v88, v136
    v_add_f32 v101, v89, v137
    v_lshlrev_b32 v136, 16, v129
    v_and_b32 v137, 0xffff0000, v129
    v_mul_f32 v136, v136, v126
    v_mul_f32 v137, v137, v127
    v_cvt_pk_bf16_f32 v136, 0, v136
    v_cvt_pk_bf16_f32 v137, 0, v137
    v_add_f32 v102, v90, v136
    v_add_f32 v103, v91, v137
    buffer_store_dwordx4 v[100:103], v134, s[16:19], s43 offen
    v_lshlrev_b32 v136, 16, v130
    v_and_b32 v137, 0xffff0000, v130
    v_mul_f32 v136, v136, v124
    v_mul_f32 v137, v137, v125
    v_cvt_pk_bf16_f32 v136, 0, v136
    v_cvt_pk_bf16_f32 v137, 0, v137
    v_add_f32 v104, v92, v136
    v_add_f32 v105, v93, v137
    v_lshlrev_b32 v136, 16, v131
    v_and_b32 v137, 0xffff0000, v131
    v_mul_f32 v136, v136, v126
    v_mul_f32 v137, v137, v127
    v_cvt_pk_bf16_f32 v136, 0, v136
    v_cvt_pk_bf16_f32 v137, 0, v137
    v_add_f32 v106, v94, v136
    v_add_f32 v107, v95, v137
    buffer_store_dwordx4 v[104:107], v135, s[16:19], s43 offen
    v_mov_b32 v116, v52
    v_mov_b32 v117, v53
    v_mov_b32 v118, v54
    v_mov_b32 v119, v55
    v_mov_b32 v120, v56
    v_mov_b32 v121, v57
    v_mov_b32 v122, v58
    v_mov_b32 v123, v59
    s_mov_b32 s7, s39
    s_add_u32 s39, s44, s31
    s_sub_u32 s43, s22, 1
    s_lshl_b32 s42, s43, 16
    s_lshl_b32 s43, s43, 18
    s_cmp_eq_u32 s37, 0
    s_cselect_b32 s42, 0x7ff00000, s42
    s_cselect_b32 s43, 0x7ff00000, s43
    buffer_load_dwordx4 v[88:91], v112, s[12:15], s39 offen offset:1024 sc1
    buffer_load_dwordx4 v[92:95], v112, s[12:15], s39 offen offset:2048 sc1
    s_mov_b32 s37, 1
    buffer_load_dwordx2 v[128:129], v132, s[32:35], s42 offen
    buffer_load_dwordx2 v[130:131], v133, s[32:35], s42 offen
    buffer_store_dwordx4 v[108:111], v112, s[12:15], s7 offen offset:1024 sc1
    buffer_store_dwordx4 v[108:111], v112, s[12:15], s7 offen offset:2048 sc1
    s_waitcnt vmcnt(0)
    v_add_f32 v100, v116, v88
    v_add_f32 v101, v117, v89
    v_add_f32 v102, v118, v90
    v_add_f32 v103, v119, v91
    v_add_f32 v104, v120, v92
    v_add_f32 v105, v121, v93
    v_add_f32 v106, v122, v94
    v_add_f32 v107, v123, v95
    v_add_f32 v96, v100, v104
    v_add_f32 v97, v101, v105
    v_add_f32 v98, v102, v106
    v_add_f32 v99, v103, v107
    v_add_f32 v96, v96, v97
    v_add_f32 v98, v98, v99
    v_cmp_u_f32 vcc, v96, v98
    s_nop 0
    s_nop 0
    s_cbranch_vccnz L_rbad_250
L_rok_251:
    ds_write_b128 v114, v[100:103]
    ds_write_b128 v115, v[104:107]
    ds_read_b128 v[88:91], v113 offset:0
    ds_read_b128 v[92:95], v113 offset:1024
    s_waitcnt lgkmcnt(0)
    s_waitcnt vmcnt(0)
    v_lshlrev_b32 v136, 16, v128
    v_and_b32 v137, 0xffff0000, v128
    v_mul_f32 v136, v136, v124
    v_mul_f32 v137, v137, v125
    v_cvt_pk_bf16_f32 v136, 0, v136
    v_cvt_pk_bf16_f32 v137, 0, v137
    v_add_f32 v100, v88, v136
    v_add_f32 v101, v89, v137
    v_lshlrev_b32 v136, 16, v129
    v_and_b32 v137, 0xffff0000, v129
    v_mul_f32 v136, v136, v126
    v_mul_f32 v137, v137, v127
    v_cvt_pk_bf16_f32 v136, 0, v136
    v_cvt_pk_bf16_f32 v137, 0, v137
    v_add_f32 v102, v90, v136
    v_add_f32 v103, v91, v137
    buffer_store_dwordx4 v[100:103], v134, s[16:19], s43 offen
    v_lshlrev_b32 v136, 16, v130
    v_and_b32 v137, 0xffff0000, v130
    v_mul_f32 v136, v136, v124
    v_mul_f32 v137, v137, v125
    v_cvt_pk_bf16_f32 v136, 0, v136
    v_cvt_pk_bf16_f32 v137, 0, v137
    v_add_f32 v104, v92, v136
    v_add_f32 v105, v93, v137
    v_lshlrev_b32 v136, 16, v131
    v_and_b32 v137, 0xffff0000, v131
    v_mul_f32 v136, v136, v126
    v_mul_f32 v137, v137, v127
    v_cvt_pk_bf16_f32 v136, 0, v136
    v_cvt_pk_bf16_f32 v137, 0, v137
    v_add_f32 v106, v94, v136
    v_add_f32 v107, v95, v137
    buffer_store_dwordx4 v[104:107], v135, s[16:19], s43 offen
    s_mov_b32 s7, s39
    buffer_store_dwordx4 v[108:111], v112, s[12:15], s7 offen offset:1024 sc1
    buffer_store_dwordx4 v[108:111], v112, s[12:15], s7 offen offset:2048 sc1
    s_branch L_ste_243
L_rbad_248:
    buffer_load_dwordx4 v[88:91], v112, s[12:15], s39 offen offset:1024 sc1
    buffer_load_dwordx4 v[92:95], v112, s[12:15], s39 offen offset:2048 sc1
    s_add_u32 s36, s36, 1
    s_cmp_gt_u32 s36, 0x100000
    s_cbranch_scc1 chain_kernel_wend
    s_waitcnt vmcnt(0)
    v_max_u32 v100, v88, v89
    v_max3_u32 v100, v100, v90, v91
    v_max3_u32 v100, v100, v92, v93
    v_max3_u32 v100, v100, v94, v95
    v_cmp_eq_u32 vcc, v108, v100
    s_cbranch_vccnz L_rbad_248
    v_add_f32 v100, v116, v88
    v_add_f32 v101, v117, v89
    v_add_f32 v102, v118, v90
    v_add_f32 v103, v119, v91
    v_add_f32 v104, v120, v92
    v_add_f32 v105, v121, v93
    v_add_f32 v106, v122, v94
    v_add_f32 v107, v123, v95
    v_add_f32 v96, v100, v104
    v_add_f32 v97, v101, v105
    v_add_f32 v98, v102, v106
    v_add_f32 v99, v103, v107
    v_add_f32 v96, v96, v97
    v_add_f32 v98, v98, v99
    v_cmp_u_f32 vcc, v96, v98
    s_branch L_rok_249
L_rbad_250:
    buffer_load_dwordx4 v[88:91], v112, s[12:15], s39 offen offset:1024 sc1
    buffer_load_dwordx4 v[92:95], v112, s[12:15], s39 offen offset:2048 sc1
    s_add_u32 s36, s36, 1
    s_cmp_gt_u32 s36, 0x100000
    s_cbranch_scc1 chain_kernel_wend
    s_waitcnt vmcnt(0)
    v_max_u32 v100, v88, v89
    v_max3_u32 v100, v100, v90, v91
    v_max3_u32 v100, v100, v92, v93
    v_max3_u32 v100, v100, v94, v95
    v_cmp_eq_u32 vcc, v108, v100
    s_cbranch_vccnz L_rbad_250
    v_add_f32 v100, v116, v88
    v_add_f32 v101, v117, v89
    v_add_f32 v102, v118, v90
    v_add_f32 v103, v119, v91
    v_add_f32 v104, v120, v92
    v_add_f32 v105, v121, v93
    v_add_f32 v106, v122, v94
    v_add_f32 v107, v123, v95
    v_add_f32 v96, v100, v104
    v_add_f32 v97, v101, v105
    v_add_f32 v98, v102, v106
    v_add_f32 v99, v103, v107
    v_add_f32 v96, v96, v97
    v_add_f32 v98, v98, v99
    v_cmp_u_f32 vcc, v96, v98
    s_branch L_rok_251
L_ste_243:
    s_branch L_run_233
L_rdone_236:
L_op_204:
    s_mov_b32 s38, s41
    s_and_b32 s39, s38, 3
    s_lshr_b32 s42, s38, 2
    s_lshr_b32 s43, s39, 1
    s_and_b32 s51, s39, 1
    s_min_u32 s22, s40, 2
    s_lshl_b32 s44, s40, 5
    s_add_u32 s44, s44, s38
    s_lshl_b32 s44, s44, 17
    s_lshl_b32 s25, s49, 15
    s_add_u32 s44, s44, s25
    s_xor_b32 s45, s44, 0x20000
    s_add_u32 s45, s45, 0x6a00000
    s_xor_b32 s46, s44, 0x40000
    s_add_u32 s46, s46, 0x6a00000
    s_xor_b32 s47, s44, 0x60000
    s_add_u32 s47, s47, 0x6a00000
    s_add_u32 s44, s44, 0x6a00000
    s_lshl_b32 s48, s40, 3
    s_lshr_b32 s25, s38, 2
    s_add_u32 s48, s48, s25
    s_lshl_b32 s48, s48, 7
    s_add_u32 s48, s48, 0x590c000
    v_mov_b32 v108, 0xff81ff81
    v_mov_b32 v109, 0xff81ff81
    v_mov_b32 v110, 0xff81ff81
    v_mov_b32 v111, 0xff81ff81
    v_and_b32 v112, 63, v0
    v_lshlrev_b32 v112, 4, v112
    v_lshrrev_b32 v1, 6, v0
    v_lshlrev_b32 v1, 11, v1
    v_add_u32 v1, 0x21000, v1
    v_bfe_u32 v2, v0, 3, 2
    v_lshlrev_b32 v2, 4, v2
    v_xor_b32 v2, v2, v112
    v_add_u32 v113, v1, v2
    v_and_b32 v2, 15, v0
    v_lshl_add_u32 v1, v2, 6, v1
    v_bfe_u32 v2, v0, 4, 2
    v_lshlrev_b32 v2, 0, v2
    v_bfe_u32 v3, v0, 1, 2
    v_xor_b32 v2, v2, v3
    v_lshl_add_u32 v114, v2, 4, v1
    v_xor_b32 v115, 16, v114
    s_add_u32 s25, s44, 0
    buffer_store_dwordx4 v[108:111], v112, s[12:15], s25 offen offset:1024 sc1
    buffer_store_dwordx4 v[108:111], v112, s[12:15], s25 offen offset:2048 sc1
    buffer_store_dwordx4 v[108:111], v112, s[12:15], s25 offen offset:3072 sc1
    s_add_u32 s25, s44, 4096
    buffer_store_dwordx4 v[108:111], v112, s[12:15], s25 offen offset:1024 sc1
    buffer_store_dwordx4 v[108:111], v112, s[12:15], s25 offen offset:2048 sc1
    buffer_store_dwordx4 v[108:111], v112, s[12:15], s25 offen offset:3072 sc1
    s_add_u32 s25, s44, 8192
    buffer_store_dwordx4 v[108:111], v112, s[12:15], s25 offen offset:1024 sc1
    buffer_store_dwordx4 v[108:111], v112, s[12:15], s25 offen offset:2048 sc1
    buffer_store_dwordx4 v[108:111], v112, s[12:15], s25 offen offset:3072 sc1
    s_add_u32 s25, s44, 12288
    buffer_store_dwordx4 v[108:111], v112, s[12:15], s25 offen offset:1024 sc1
    buffer_store_dwordx4 v[108:111], v112, s[12:15], s25 offen offset:2048 sc1
    buffer_store_dwordx4 v[108:111], v112, s[12:15], s25 offen offset:3072 sc1
    s_add_u32 s25, s44, 16384
    buffer_store_dwordx4 v[108:111], v112, s[12:15], s25 offen offset:1024 sc1
    buffer_store_dwordx4 v[108:111], v112, s[12:15], s25 offen offset:2048 sc1
    buffer_store_dwordx4 v[108:111], v112, s[12:15], s25 offen offset:3072 sc1
    s_add_u32 s25, s44, 20480
    buffer_store_dwordx4 v[108:111], v112, s[12:15], s25 offen offset:1024 sc1
    buffer_store_dwordx4 v[108:111], v112, s[12:15], s25 offen offset:2048 sc1
    buffer_store_dwordx4 v[108:111], v112, s[12:15], s25 offen offset:3072 sc1
    s_add_u32 s25, s44, 24576
    buffer_store_dwordx4 v[108:111], v112, s[12:15], s25 offen offset:1024 sc1
    buffer_store_dwordx4 v[108:111], v112, s[12:15], s25 offen offset:2048 sc1
    buffer_store_dwordx4 v[108:111], v112, s[12:15], s25 offen offset:3072 sc1
    s_add_u32 s25, s44, 28672
    buffer_store_dwordx4 v[108:111], v112, s[12:15], s25 offen offset:1024 sc1
    buffer_store_dwordx4 v[108:111], v112, s[12:15], s25 offen offset:2048 sc1
    buffer_store_dwordx4 v[108:111], v112, s[12:15], s25 offen offset:3072 sc1
    s_waitcnt vmcnt(0)
    s_barrier
    buffer_atomic_add v84, v85, s[12:15], s48 offen sc1
    s_mov_b32 s16, s92
    s_and_b32 s17, s93, 0xffff
    s_mov_b32 s18, 0x800000
    s_mov_b32 s19, 0x00020000
    s_lshl_b32 s50, s39, 21
    s_lshl_b32 s25, s42, 8
    s_add_u32 s50, s50, s25
    v_and_b32 v1, 15, v0
    v_bfe_u32 v2, v0, 4, 2
    v_lshrrev_b32 v3, 6, v0
    v_lshlrev_b32 v4, 2, v2
    v_xor_b32 v4, v4, v1
    v_lshlrev_b32 v4, 4, v4
    v_lshl_add_u32 v5, v3, 5, v2
    s_mov_b32 s25, 2048
    v_mul_lo_u32 v5, v5, s25
    v_add_u32 v20, v5, v4
    v_bfe_u32 v4, v0, 2, 2
    v_lshl_add_u32 v5, v2, 3, v4
    v_lshlrev_b32 v5, 8, v5
    v_xor_b32 v4, v4, v3
    v_lshl_add_u32 v5, v4, 6, v5
    v_and_b32 v4, 3, v0
    v_lshl_add_u32 v5, v4, 3, v5
    s_lshl_b32 s25, s51, 5
    v_add_u32 v21, s25, v5
    v_xor_b32 v22, 32, v21
    v_add_u32 v23, 0x10000, v21
    v_add_u32 v24, 0x10000, v22
    s_lshl_b32 s26, s49, 13
    s_mov_b32 s25, s50
    s_barrier
    s_add_u32 m0, s26, 0
    s_add_u32 s27, s25, 0
    buffer_load_dwordx4 v20, s[16:19], s27 offen lds
    s_add_u32 m0, s26, 1024
    s_add_u32 s27, s25, 8192
    buffer_load_dwordx4 v20, s[16:19], s27 offen lds
    s_add_u32 m0, s26, 2048
    s_add_u32 s27, s25, 16384
    buffer_load_dwordx4 v20, s[16:19], s27 offen lds
    s_add_u32 m0, s26, 3072
    s_add_u32 s27, s25, 24576
    buffer_load_dwordx4 v20, s[16:19], s27 offen lds
    s_add_u32 m0, s26, 4096
    s_add_u32 s27, s25, 32768
    buffer_load_dwordx4 v20, s[16:19], s27 offen lds
    s_add_u32 m0, s26, 5120
    s_add_u32 s27, s25, 40960
    buffer_load_dwordx4 v20, s[16:19], s27 offen lds
    s_add_u32 m0, s26, 6144
    s_add_u32 s27, s25, 49152
    buffer_load_dwordx4 v20, s[16:19], s27 offen lds
    s_add_u32 m0, s26, 7168
    s_add_u32 s27, s25, 57344
    buffer_load_dwordx4 v20, s[16:19], s27 offen lds
    s_add_u32 m0, s26, 32768
    s_add_u32 s27, s25, 262144
    buffer_load_dwordx4 v20, s[16:19], s27 offen lds
    s_add_u32 m0, s26, 33792
    s_add_u32 s27, s25, 270336
    buffer_load_dwordx4 v20, s[16:19], s27 offen lds
    s_add_u32 m0, s26, 34816
    s_add_u32 s27, s25, 278528
    buffer_load_dwordx4 v20, s[16:19], s27 offen lds
    s_add_u32 m0, s26, 35840
    s_add_u32 s27, s25, 286720
    buffer_load_dwordx4 v20, s[16:19], s27 offen lds
    s_add_u32 m0, s26, 36864
    s_add_u32 s27, s25, 294912
    buffer_load_dwordx4 v20, s[16:19], s27 offen lds
    s_add_u32 m0, s26, 37888
    s_add_u32 s27, s25, 303104
    buffer_load_dwordx4 v20, s[16:19], s27 offen lds
    s_add_u32 m0, s26, 38912
    s_add_u32 s27, s25, 311296
    buffer_load_dwordx4 v20, s[16:19], s27 offen lds
    s_add_u32 m0, s26, 39936
    s_add_u32 s27, s25, 319488
    buffer_load_dwordx4 v20, s[16:19], s27 offen lds
    s_add_u32 m0, s26, 65536
    s_add_u32 s27, s25, 524288
    buffer_load_dwordx4 v20, s[16:19], s27 offen lds
    s_add_u32 m0, s26, 66560
    s_add_u32 s27, s25, 532480
    buffer_load_dwordx4 v20, s[16:19], s27 offen lds
    s_add_u32 m0, s26, 67584
    s_add_u32 s27, s25, 540672
    buffer_load_dwordx4 v20, s[16:19], s27 offen lds
    s_add_u32 m0, s26, 68608
    s_add_u32 s27, s25, 548864
    buffer_load_dwordx4 v20, s[16:19], s27 offen lds
    s_add_u32 m0, s26, 69632
    s_add_u32 s27, s25, 557056
    buffer_load_dwordx4 v20, s[16:19], s27 offen lds
    s_add_u32 m0, s26, 70656
    s_add_u32 s27, s25, 565248
    buffer_load_dwordx4 v20, s[16:19], s27 offen lds
    s_add_u32 m0, s26, 71680
    s_add_u32 s27, s25, 573440
    buffer_load_dwordx4 v20, s[16:19], s27 offen lds
    s_add_u32 m0, s26, 72704
    s_add_u32 s27, s25, 581632
    buffer_load_dwordx4 v20, s[16:19], s27 offen lds
    s_add_u32 m0, s26, 98304
    s_add_u32 s27, s25, 786432
    buffer_load_dwordx4 v20, s[16:19], s27 offen lds
    s_add_u32 m0, s26, 99328
    s_add_u32 s27, s25, 794624
    buffer_load_dwordx4 v20, s[16:19], s27 offen lds
    s_add_u32 m0, s26, 100352
    s_add_u32 s27, s25, 802816
    buffer_load_dwordx4 v20, s[16:19], s27 offen lds
    s_add_u32 m0, s26, 101376
    s_add_u32 s27, s25, 811008
    buffer_load_dwordx4 v20, s[16:19], s27 offen lds
    s_add_u32 m0, s26, 102400
    s_add_u32 s27, s25, 819200
    buffer_load_dwordx4 v20, s[16:19], s27 offen lds
    s_add_u32 m0, s26, 103424
    s_add_u32 s27, s25, 827392
    buffer_load_dwordx4 v20, s[16:19], s27 offen lds
    s_add_u32 m0, s26, 104448
    s_add_u32 s27, s25, 835584
    buffer_load_dwordx4 v20, s[16:19], s27 offen lds
    s_add_u32 m0, s26, 105472
    s_add_u32 s27, s25, 843776
    buffer_load_dwordx4 v20, s[16:19], s27 offen lds
    s_waitcnt vmcnt(24)
    s_barrier
    ds_read_b64_tr_b16 a[0:1], v21 offset:0
    ds_read_b64_tr_b16 a[2:3], v21 offset:1024
    ds_read_b64_tr_b16 a[4:5], v22 offset:0
    ds_read_b64_tr_b16 a[6:7], v22 offset:1024
    ds_read_b64_tr_b16 a[8:9], v21 offset:8192
    ds_read_b64_tr_b16 a[10:11], v21 offset:9216
    ds_read_b64_tr_b16 a[12:13], v22 offset:8192
    ds_read_b64_tr_b16 a[14:15], v22 offset:9216
    s_waitcnt lgkmcnt(0)
    ds_read_b64_tr_b16 a[16:17], v21 offset:16384
    ds_read_b64_tr_b16 a[18:19], v21 offset:17408
    ds_read_b64_tr_b16 a[20:21], v22 offset:16384
    ds_read_b64_tr_b16 a[22:23], v22 offset:17408
    ds_read_b64_tr_b16 a[24:25], v21 offset:24576
    ds_read_b64_tr_b16 a[26:27], v21 offset:25600
    ds_read_b64_tr_b16 a[28:29], v22 offset:24576
    ds_read_b64_tr_b16 a[30:31], v22 offset:25600
    s_waitcnt lgkmcnt(0)
    s_barrier
    s_add_u32 m0, s26, 0
    s_add_u32 s27, s25, 1048576
    buffer_load_dwordx4 v20, s[16:19], s27 offen lds
    s_add_u32 m0, s26, 1024
    s_add_u32 s27, s25, 1056768
    buffer_load_dwordx4 v20, s[16:19], s27 offen lds
    s_add_u32 m0, s26, 2048
    s_add_u32 s27, s25, 1064960
    buffer_load_dwordx4 v20, s[16:19], s27 offen lds
    s_add_u32 m0, s26, 3072
    s_add_u32 s27, s25, 1073152
    buffer_load_dwordx4 v20, s[16:19], s27 offen lds
    s_add_u32 m0, s26, 4096
    s_add_u32 s27, s25, 1081344
    buffer_load_dwordx4 v20, s[16:19], s27 offen lds
    s_add_u32 m0, s26, 5120
    s_add_u32 s27, s25, 1089536
    buffer_load_dwordx4 v20, s[16:19], s27 offen lds
    s_add_u32 m0, s26, 6144
    s_add_u32 s27, s25, 1097728
    buffer_load_dwordx4 v20, s[16:19], s27 offen lds
    s_add_u32 m0, s26, 7168
    s_add_u32 s27, s25, 1105920
    buffer_load_dwordx4 v20, s[16:19], s27 offen lds
    s_waitcnt vmcnt(24)
    s_barrier
    ds_read_b64_tr_b16 a[32:33], v21 offset:32768
    ds_read_b64_tr_b16 a[34:35], v21 offset:33792
    ds_read_b64_tr_b16 a[36:37], v22 offset:32768
    ds_read_b64_tr_b16 a[38:39], v22 offset:33792
    ds_read_b64_tr_b16 a[40:41], v21 offset:40960
    ds_read_b64_tr_b16 a[42:43], v21 offset:41984
    ds_read_b64_tr_b16 a[44:45], v22 offset:40960
    ds_read_b64_tr_b16 a[46:47], v22 offset:41984
    s_waitcnt lgkmcnt(0)
    ds_read_b64_tr_b16 a[48:49], v21 offset:49152
    ds_read_b64_tr_b16 a[50:51], v21 offset:50176
    ds_read_b64_tr_b16 a[52:53], v22 offset:49152
    ds_read_b64_tr_b16 a[54:55], v22 offset:50176
    ds_read_b64_tr_b16 a[56:57], v21 offset:57344
    ds_read_b64_tr_b16 a[58:59], v21 offset:58368
    ds_read_b64_tr_b16 a[60:61], v22 offset:57344
    ds_read_b64_tr_b16 a[62:63], v22 offset:58368
    s_waitcnt lgkmcnt(0)
    s_barrier
    s_add_u32 m0, s26, 32768
    s_add_u32 s27, s25, 1310720
    buffer_load_dwordx4 v20, s[16:19], s27 offen lds
    s_add_u32 m0, s26, 33792
    s_add_u32 s27, s25, 1318912
    buffer_load_dwordx4 v20, s[16:19], s27 offen lds
    s_add_u32 m0, s26, 34816
    s_add_u32 s27, s25, 1327104
    buffer_load_dwordx4 v20, s[16:19], s27 offen lds
    s_add_u32 m0, s26, 35840
    s_add_u32 s27, s25, 1335296
    buffer_load_dwordx4 v20, s[16:19], s27 offen lds
    s_add_u32 m0, s26, 36864
    s_add_u32 s27, s25, 1343488
    buffer_load_dwordx4 v20, s[16:19], s27 offen lds
    s_add_u32 m0, s26, 37888
    s_add_u32 s27, s25, 1351680
    buffer_load_dwordx4 v20, s[16:19], s27 offen lds
    s_add_u32 m0, s26, 38912
    s_add_u32 s27, s25, 1359872
    buffer_load_dwordx4 v20, s[16:19], s27 offen lds
    s_add_u32 m0, s26, 39936
    s_add_u32 s27, s25, 1368064
    buffer_load_dwordx4 v20, s[16:19], s27 offen lds
    s_waitcnt vmcnt(24)
    s_barrier
    ds_read_b64_tr_b16 a[64:65], v23 offset:0
    ds_read_b64_tr_b16 a[66:67], v23 offset:1024
    ds_read_b64_tr_b16 a[68:69], v24 offset:0
    ds_read_b64_tr_b16 a[70:71], v24 offset:1024
    ds_read_b64_tr_b16 a[72:73], v23 offset:8192
    ds_read_b64_tr_b16 a[74:75], v23 offset:9216
    ds_read_b64_tr_b16 a[76:77], v24 offset:8192
    ds_read_b64_tr_b16 a[78:79], v24 offset:9216
    s_waitcnt lgkmcnt(0)
    ds_read_b64_tr_b16 a[80:81], v23 offset:16384
    ds_read_b64_tr_b16 a[82:83], v23 offset:17408
    ds_read_b64_tr_b16 a[84:85], v24 offset:16384
    ds_read_b64_tr_b16 a[86:87], v24 offset:17408
    ds_read_b64_tr_b16 a[88:89], v23 offset:24576
    ds_read_b64_tr_b16 a[90:91], v23 offset:25600
    ds_read_b64_tr_b16 a[92:93], v24 offset:24576
    ds_read_b64_tr_b16 a[94:95], v24 offset:25600
    s_waitcnt lgkmcnt(0)
    s_barrier
    s_add_u32 m0, s26, 65536
    s_add_u32 s27, s25, 1572864
    buffer_load_dwordx4 v20, s[16:19], s27 offen lds
    s_add_u32 m0, s26, 66560
    s_add_u32 s27, s25, 1581056
    buffer_load_dwordx4 v20, s[16:19], s27 offen lds
    s_add_u32 m0, s26, 67584
    s_add_u32 s27, s25, 1589248
    buffer_load_dwordx4 v20, s[16:19], s27 offen lds
    s_add_u32 m0, s26, 68608
    s_add_u32 s27, s25, 1597440
    buffer_load_dwordx4 v20, s[16:19], s27 offen lds
    s_add_u32 m0, s26, 69632
    s_add_u32 s27, s25, 1605632
    buffer_load_dwordx4 v20, s[16:19], s27 offen lds
    s_add_u32 m0, s26, 70656
    s_add_u32 s27, s25, 1613824
    buffer_load_dwordx4 v20, s[16:19], s27 offen lds
    s_add_u32 m0, s26, 71680
    s_add_u32 s27, s25, 1622016
    buffer_load_dwordx4 v20, s[16:19], s27 offen lds
    s_add_u32 m0, s26, 72704
    s_add_u32 s27, s25, 1630208
    buffer_load_dwordx4 v20, s[16:19], s27 offen lds
    s_waitcnt vmcnt(24)
    s_barrier
    ds_read_b64_tr_b16 a[96:97], v23 offset:32768
    ds_read_b64_tr_b16 a[98:99], v23 offset:33792
    ds_read_b64_tr_b16 a[100:101], v24 offset:32768
    ds_read_b64_tr_b16 a[102:103], v24 offset:33792
    ds_read_b64_tr_b16 a[104:105], v23 offset:40960
    ds_read_b64_tr_b16 a[106:107], v23 offset:41984
    ds_read_b64_tr_b16 a[108:109], v24 offset:40960
    ds_read_b64_tr_b16 a[110:111], v24 offset:41984
    s_waitcnt lgkmcnt(0)
    ds_read_b64_tr_b16 a[112:113], v23 offset:49152
    ds_read_b64_tr_b16 a[114:115], v23 offset:50176
    ds_read_b64_tr_b16 a[116:117], v24 offset:49152
    ds_read_b64_tr_b16 a[118:119], v24 offset:50176
    ds_read_b64_tr_b16 a[120:121], v23 offset:57344
    ds_read_b64_tr_b16 a[122:123], v23 offset:58368
    ds_read_b64_tr_b16 a[124:125], v24 offset:57344
    ds_read_b64_tr_b16 a[126:127], v24 offset:58368
    s_waitcnt lgkmcnt(0)
    s_barrier
    s_add_u32 m0, s26, 98304
    s_add_u32 s27, s25, 1835008
    buffer_load_dwordx4 v20, s[16:19], s27 offen lds
    s_add_u32 m0, s26, 99328
    s_add_u32 s27, s25, 1843200
    buffer_load_dwordx4 v20, s[16:19], s27 offen lds
    s_add_u32 m0, s26, 100352
    s_add_u32 s27, s25, 1851392
    buffer_load_dwordx4 v20, s[16:19], s27 offen lds
    s_add_u32 m0, s26, 101376
    s_add_u32 s27, s25, 1859584
    buffer_load_dwordx4 v20, s[16:19], s27 offen lds
    s_add_u32 m0, s26, 102400
    s_add_u32 s27, s25, 1867776
    buffer_load_dwordx4 v20, s[16:19], s27 offen lds
    s_add_u32 m0, s26, 103424
    s_add_u32 s27, s25, 1875968
    buffer_load_dwordx4 v20, s[16:19], s27 offen lds
    s_add_u32 m0, s26, 104448
    s_add_u32 s27, s25, 1884160
    buffer_load_dwordx4 v20, s[16:19], s27 offen lds
    s_add_u32 m0, s26, 105472
    s_add_u32 s27, s25, 1892352
    buffer_load_dwordx4 v20, s[16:19], s27 offen lds
    s_waitcnt vmcnt(24)
    s_barrier
    ds_read_b64_tr_b16 a[128:129], v21 offset:0
    ds_read_b64_tr_b16 a[130:131], v21 offset:1024
    ds_read_b64_tr_b16 a[132:133], v22 offset:0
    ds_read_b64_tr_b16 a[134:135], v22 offset:1024
    ds_read_b64_tr_b16 a[136:137], v21 offset:8192
    ds_read_b64_tr_b16 a[138:139], v21 offset:9216
    ds_read_b64_tr_b16 a[140:141], v22 offset:8192
    ds_read_b64_tr_b16 a[142:143], v22 offset:9216
    s_waitcnt lgkmcnt(0)
    ds_read_b64_tr_b16 a[144:145], v21 offset:16384
    ds_read_b64_tr_b16 a[146:147], v21 offset:17408
    ds_read_b64_tr_b16 a[148:149], v22 offset:16384
    ds_read_b64_tr_b16 a[150:151], v22 offset:17408
    ds_read_b64_tr_b16 a[152:153], v21 offset:24576
    ds_read_b64_tr_b16 a[154:155], v21 offset:25600
    ds_read_b64_tr_b16 a[156:157], v22 offset:24576
    ds_read_b64_tr_b16 a[158:159], v22 offset:25600
    s_waitcnt lgkmcnt(0)
    s_waitcnt vmcnt(16)
    s_barrier
    ds_read_b64_tr_b16 a[160:161], v21 offset:32768
    ds_read_b64_tr_b16 a[162:163], v21 offset:33792
    ds_read_b64_tr_b16 a[164:165], v22 offset:32768
    ds_read_b64_tr_b16 a[166:167], v22 offset:33792
    ds_read_b64_tr_b16 a[168:169], v21 offset:40960
    ds_read_b64_tr_b16 a[170:171], v21 offset:41984
    ds_read_b64_tr_b16 a[172:173], v22 offset:40960
    ds_read_b64_tr_b16 a[174:175], v22 offset:41984
    s_waitcnt lgkmcnt(0)
    ds_read_b64_tr_b16 a[176:177], v21 offset:49152
    ds_read_b64_tr_b16 a[178:179], v21 offset:50176
    ds_read_b64_tr_b16 a[180:181], v22 offset:49152
    ds_read_b64_tr_b16 a[182:183], v22 offset:50176
    ds_read_b64_tr_b16 a[184:185], v21 offset:57344
    ds_read_b64_tr_b16 a[186:187], v21 offset:58368
    ds_read_b64_tr_b16 a[188:189], v22 offset:57344
    ds_read_b64_tr_b16 a[190:191], v22 offset:58368
    s_waitcnt lgkmcnt(0)
    s_waitcnt vmcnt(8)
    s_barrier
    ds_read_b64_tr_b16 a[192:193], v23 offset:0
    ds_read_b64_tr_b16 a[194:195], v23 offset:1024
    ds_read_b64_tr_b16 a[196:197], v24 offset:0
    ds_read_b64_tr_b16 a[198:199], v24 offset:1024
    ds_read_b64_tr_b16 a[200:201], v23 offset:8192
    ds_read_b64_tr_b16 a[202:203], v23 offset:9216
    ds_read_b64_tr_b16 a[204:205], v24 offset:8192
    ds_read_b64_tr_b16 a[206:207], v24 offset:9216
    s_waitcnt lgkmcnt(0)
    ds_read_b64_tr_b16 a[208:209], v23 offset:16384
    ds_read_b64_tr_b16 a[210:211], v23 offset:17408
    ds_read_b64_tr_b16 a[212:213], v24 offset:16384
    ds_read_b64_tr_b16 a[214:215], v24 offset:17408
    ds_read_b64_tr_b16 a[216:217], v23 offset:24576
    ds_read_b64_tr_b16 a[218:219], v23 offset:25600
    ds_read_b64_tr_b16 a[220:221], v24 offset:24576
    ds_read_b64_tr_b16 a[222:223], v24 offset:25600
    s_waitcnt lgkmcnt(0)
    s_waitcnt vmcnt(0)
    s_barrier
    ds_read_b64_tr_b16 a[224:225], v23 offset:32768
    ds_read_b64_tr_b16 a[226:227], v23 offset:33792
    ds_read_b64_tr_b16 a[228:229], v24 offset:32768
    ds_read_b64_tr_b16 a[230:231], v24 offset:33792
    ds_read_b64_tr_b16 a[232:233], v23 offset:40960
    ds_read_b64_tr_b16 a[234:235], v23 offset:41984
    ds_read_b64_tr_b16 a[236:237], v24 offset:40960
    ds_read_b64_tr_b16 a[238:239], v24 offset:41984
    s_waitcnt lgkmcnt(0)
    ds_read_b64_tr_b16 a[240:241], v23 offset:49152
    ds_read_b64_tr_b16 a[242:243], v23 offset:50176
    ds_read_b64_tr_b16 a[244:245], v24 offset:49152
    ds_read_b64_tr_b16 a[246:247], v24 offset:50176
    ds_read_b64_tr_b16 a[248:249], v23 offset:57344
    ds_read_b64_tr_b16 a[250:251], v23 offset:58368
    ds_read_b64_tr_b16 a[252:253], v24 offset:57344
    ds_read_b64_tr_b16 a[254:255], v24 offset:58368
    s_waitcnt lgkmcnt(0)
    v_mov_b32 v2, 0
L_pl_252:
    buffer_load_dword v1, v2, s[12:15], s48 offen sc1
    s_add_u32 s36, s36, 1
    s_cmp_gt_u32 s36, 0x100000
    s_cbranch_scc1 chain_kernel_wend
    s_waitcnt vmcnt(0)
    v_readfirstlane_b32 s26, v1
    s_cmp_ge_u32 s26, 4
    s_cbranch_scc1 L_plok_253
    s_sleep 4
    s_branch L_pl_252
L_plok_253:
    s_lshl_b32 s25, s42, 9
    s_lshl_b32 s26, s49, 7
    s_add_u32 s25, s25, s26
    s_lshl_b32 s26, s51, 6
    s_add_u32 s25, s25, s26
    s_lshl_b32 s26, s43, 17
    s_add_u32 s25, s25, s26
    s_add_u32 s25, s25, 4096
    v_bfe_u32 v1, v0, 2, 4
    v_and_b32 v2, 3, v0
    v_lshlrev_b32 v1, 13, v1
    v_lshl_add_u32 v1, v2, 4, v1
    v_add_u32 v124, s25, v1
    s_lshl_b32 s48, s39, 7
    s_add_u32 s48, s48, 0x5904000
    s_lshl_b32 s50, s39, 18
    s_add_u32 s50, s50, 2048
    s_mov_b32 s8, s100
    s_and_b32 s9, s101, 0xffff
    s_mov_b32 s10, 0x10000000
    s_mov_b32 s11, 0x00020000
    s_mov_b32 s16, s96
    s_and_b32 s17, s97, 0xffff
    s_mov_b32 s18, 0x1000000
    s_mov_b32 s19, 0x00020000
    s_lshl_b32 s21, s49, 12
    v_and_b32 v1, 63, v0
    v_and_b32 v2, 15, v0
    v_bfe_u32 v3, v0, 4, 2
    v_lshrrev_b32 v4, 6, v0
    v_lshlrev_b32 v5, 4, v1
    v_lshl_add_u32 v5, v4, 14, v5
    v_add_u32 v8, 0, v5
    v_add_u32 v9, 1024, v5
    v_add_u32 v10, 4096, v5
    v_add_u32 v11, 5120, v5
    v_lshlrev_b32 v5, 4, v2
    v_lshl_add_u32 v5, v3, 9, v5
    s_lshl_b32 s25, s43, 8
    v_add_u32 v12, s25, v5
    v_xor_b32 v13, 0x100, v12
    v_add_u32 v16, 0x10000, v12
    v_add_u32 v17, 0x10000, v13
    s_mov_b32 s38, 0
    s_mov_b32 s52, 0
    v_mov_b32 v2, 0x20000
    v_lshl_add_u32 v3, v0, 2, v2
    v_mov_b32 v4, 0
L_run_254:
    s_cmp_ge_u32 s22, 64
    s_cbranch_scc1 L_rdone_257
    s_add_u32 s28, s22, 0
    s_min_u32 s28, s28, 63
    s_add_u32 s25, s28, 0
    s_cmp_lt_u32 s25, 64
    s_cselect_b32 s25, s25, 0x200000
    s_lshl_b32 s25, s25, 9
    s_add_u32 s25, s25, s48
    s_add_u32 s26, s22, 3
    s_cmp_lt_u32 s26, 64
    s_cselect_b32 s26, s26, 0x200000
    s_lshl_b32 s26, s26, 9
    s_add_u32 s26, s26, s48
    s_add_u32 s27, s22, 6
    s_cmp_lt_u32 s27, 64
    s_cselect_b32 s27, s27, 0x200000
    s_lshl_b32 s27, s27, 9
    s_add_u32 s27, s27, s48
L_rw_255:
    buffer_load_dword v88, v4, s[12:15], s25 offen sc1
    buffer_load_dword v89, v4, s[12:15], s26 offen sc1
    buffer_load_dword v90, v4, s[12:15], s27 offen sc1
    s_add_u32 s36, s36, 1
    s_cmp_gt_u32 s36, 0x100000
    s_cbranch_scc1 chain_kernel_wend
    s_waitcnt vmcnt(0)
    s_barrier
    v_lshl_add_u32 v1, v0, 4, v2
    ds_write_b128 v1, v[88:91]
    s_waitcnt lgkmcnt(0)
    s_barrier
    ds_read_b128 v[88:91], v2
    s_waitcnt lgkmcnt(0)
    v_readfirstlane_b32 s28, v88
    s_cmp_ge_u32 s28, 8
    s_cbranch_scc1 L_rgo_256
    s_sleep 2
    s_branch L_rw_255
L_rgo_256:
    v_readfirstlane_b32 s51, v89
    v_mov_b32 v87, v90
    s_mov_b32 s24, s22
    s_add_u32 s23, s22, 3
    s_mov_b32 s37, 0
    s_sub_u32 s38, s38, 0x1000
    s_bitcmp1_b32 s24, 1
    s_cselect_b32 s53, s54, s55
    s_lshl_b32 s30, s24, 20
    s_add_u32 s53, s53, s30
    s_add_u32 s53, s53, s50
    s_mov_b32 s20, s53
    s_mov_b32 s39, 0x7ff00000
    s_mov_b32 s42, 0x7ff00000
    s_mov_b32 s43, 0x7ff00000
    s_mov_b32 s7, 0x7ff00000
    s_barrier
    s_add_u32 m0, s21, 0
    s_nop 0
    buffer_load_dwordx4 v8, s[8:11], s20 offen lds
    s_add_u32 m0, s21, 1024
    s_nop 0
    buffer_load_dwordx4 v9, s[8:11], s20 offen lds
    s_add_u32 m0, s21, 2048
    s_nop 0
    buffer_load_dwordx4 v10, s[8:11], s20 offen lds
    s_add_u32 m0, s21, 3072
    s_nop 0
    buffer_load_dwordx4 v11, s[8:11], s20 offen lds
    s_add_u32 s20, s20, 65536
    s_add_u32 m0, s21, 16384
    s_nop 0
    buffer_load_dwordx4 v8, s[8:11], s20 offen lds
    s_add_u32 m0, s21, 17408
    s_nop 0
    buffer_load_dwordx4 v9, s[8:11], s20 offen lds
    s_add_u32 m0, s21, 18432
    s_nop 0
    buffer_load_dwordx4 v10, s[8:11], s20 offen lds
    s_add_u32 m0, s21, 19456
    s_nop 0
    buffer_load_dwordx4 v11, s[8:11], s20 offen lds
    s_add_u32 s20, s20, 65536
    s_add_u32 m0, s21, 32768
    s_nop 0
    buffer_load_dwordx4 v8, s[8:11], s20 offen lds
    s_add_u32 m0, s21, 33792
    s_nop 0
    buffer_load_dwordx4 v9, s[8:11], s20 offen lds
    s_add_u32 m0, s21, 34816
    s_nop 0
    buffer_load_dwordx4 v10, s[8:11], s20 offen lds
    s_add_u32 m0, s21, 35840
    s_nop 0
    buffer_load_dwordx4 v11, s[8:11], s20 offen lds
    s_add_u32 s20, s20, 65536
    s_add_u32 m0, s21, 49152
    s_nop 0
    buffer_load_dwordx4 v8, s[8:11], s20 offen lds
    s_add_u32 m0, s21, 50176
    s_nop 0
    buffer_load_dwordx4 v9, s[8:11], s20 offen lds
    s_add_u32 m0, s21, 51200
    s_nop 0
    buffer_load_dwordx4 v10, s[8:11], s20 offen lds
    s_add_u32 m0, s21, 52224
    s_nop 0
    buffer_load_dwordx4 v11, s[8:11], s20 offen lds
    s_cmp_ge_u32 s51, 8
    s_cselect_b32 s30, 3, 0
    s_add_u32 s24, s24, s30
    s_add_u32 s23, s23, s30
    s_bitcmp1_b32 s24, 1
    s_cselect_b32 s53, s54, s55
    s_lshl_b32 s30, s24, 20
    s_add_u32 s53, s53, s30
    s_add_u32 s53, s53, s50
    s_mov_b32 s20, s53
    s_add_u32 m0, s21, 65536
    s_nop 0
    buffer_load_dwordx4 v8, s[8:11], s20 offen lds
    s_add_u32 m0, s21, 66560
    s_nop 0
    buffer_load_dwordx4 v9, s[8:11], s20 offen lds
    s_add_u32 m0, s21, 67584
    s_nop 0
    buffer_load_dwordx4 v10, s[8:11], s20 offen lds
    s_add_u32 m0, s21, 68608
    s_nop 0
    buffer_load_dwordx4 v11, s[8:11], s20 offen lds
    s_add_u32 s20, s20, 65536
    s_add_u32 m0, s21, 81920
    s_nop 0
    buffer_load_dwordx4 v8, s[8:11], s20 offen lds
    s_add_u32 m0, s21, 82944
    s_nop 0
    buffer_load_dwordx4 v9, s[8:11], s20 offen lds
    s_add_u32 m0, s21, 83968
    s_nop 0
    buffer_load_dwordx4 v10, s[8:11], s20 offen lds
    s_add_u32 m0, s21, 84992
    s_nop 0
    buffer_load_dwordx4 v11, s[8:11], s20 offen lds
    s_add_u32 s20, s20, 65536
    s_add_u32 m0, s21, 98304
    s_nop 0
    buffer_load_dwordx4 v8, s[8:11], s20 offen lds
    s_waitcnt vmcnt(21)
    s_barrier
    ds_read_b128 v[20:23], v12 offset:0
    ds_read_b128 v[24:27], v13 offset:0
    ds_read_b128 v[28:31], v12 offset:2048
    ds_read_b128 v[32:35], v13 offset:2048
    ds_read_b128 v[36:39], v12 offset:4096
    ds_read_b128 v[40:43], v13 offset:4096
    s_waitcnt lgkmcnt(4)
L_st_262:
    v_mfma_f32_16x16x32_bf16 v[52:55], a[0:3], v[20:23], 0
    ds_read_b128 v[44:47], v12 offset:6144
    s_add_u32 m0, s21, 99328
    v_mfma_f32_16x16x32_bf16 v[56:59], a[4:7], v[20:23], 0
    buffer_load_dwordx4 v9, s[8:11], s20 offen lds
    v_mfma_f32_16x16x32_bf16 v[60:63], a[0:3], v[24:27], 0
    ds_read_b128 v[48:51], v13 offset:6144
    s_add_u32 s38, s38, 0x1000
    v_mfma_f32_16x16x32_bf16 v[64:67], a[4:7], v[24:27], 0
    s_waitcnt lgkmcnt(4)
    s_and_b32 s38, s38, 0x7000
    v_mfma_f32_16x16x32_bf16 v[52:55], a[8:11], v[28:31], v[52:55]
    ds_read_b128 v[20:23], v12 offset:8192
    s_waitcnt vmcnt(13)
    v_mfma_f32_16x16x32_bf16 v[56:59], a[12:15], v[28:31], v[56:59]
    ds_write_b32 v3, v87
    s_cmp_eq_u32 s37, 0
    s_cselect_b32 s31, 0x40000000, s38
    s_nop 0
    s_add_u32 s29, s45, s31
    buffer_store_dwordx4 v[72:75], v112, s[12:15], s29 offen offset:1024 sc1
    v_mfma_f32_16x16x32_bf16 v[60:63], a[8:11], v[32:35], v[60:63]
    ds_read_b128 v[24:27], v13 offset:8192
    v_mfma_f32_16x16x32_bf16 v[64:67], a[12:15], v[32:35], v[64:67]
    s_waitcnt lgkmcnt(4)
    v_mfma_f32_16x16x32_bf16 v[52:55], a[16:19], v[36:39], v[52:55]
    ds_read_b128 v[28:31], v12 offset:10240
    s_add_u32 m0, s21, 100352
    v_mfma_f32_16x16x32_bf16 v[56:59], a[20:23], v[36:39], v[56:59]
    buffer_load_dwordx4 v10, s[8:11], s20 offen lds
    v_mfma_f32_16x16x32_bf16 v[60:63], a[16:19], v[40:43], v[60:63]
    ds_read_b128 v[32:35], v13 offset:10240
    v_mfma_f32_16x16x32_bf16 v[64:67], a[20:23], v[40:43], v[64:67]
    s_waitcnt lgkmcnt(4)
    v_mfma_f32_16x16x32_bf16 v[52:55], a[24:27], v[44:47], v[52:55]
    ds_read_b128 v[36:39], v12 offset:12288
    v_mfma_f32_16x16x32_bf16 v[56:59], a[28:31], v[44:47], v[56:59]
    s_add_u32 s29, s46, s31
    buffer_store_dwordx4 v[76:79], v112, s[12:15], s29 offen offset:2048 sc1
    v_mfma_f32_16x16x32_bf16 v[60:63], a[24:27], v[48:51], v[60:63]
    ds_read_b128 v[40:43], v13 offset:12288
    v_mfma_f32_16x16x32_bf16 v[64:67], a[28:31], v[48:51], v[64:67]
    s_waitcnt lgkmcnt(4)
    s_add_u32 s29, s47, s31
    v_mfma_f32_16x16x32_bf16 v[52:55], a[32:35], v[20:23], v[52:55]
    ds_read_b128 v[44:47], v12 offset:14336
    s_add_u32 m0, s21, 101376
    v_mfma_f32_16x16x32_bf16 v[56:59], a[36:39], v[20:23], v[56:59]
    buffer_load_dwordx4 v11, s[8:11], s20 offen lds
    v_mfma_f32_16x16x32_bf16 v[60:63], a[32:35], v[24:27], v[60:63]
    ds_read_b128 v[48:51], v13 offset:14336
    v_mfma_f32_16x16x32_bf16 v[64:67], a[36:39], v[24:27], v[64:67]
    s_waitcnt lgkmcnt(4)
    v_mfma_f32_16x16x32_bf16 v[52:55], a[40:43], v[28:31], v[52:55]
    s_waitcnt vmcnt(20)
    s_barrier
    ds_read_b128 v[20:23], v12 offset:16384
    v_mfma_f32_16x16x32_bf16 v[56:59], a[44:47], v[28:31], v[56:59]
    s_add_u32 s20, s20, 65536
    buffer_store_dwordx4 v[80:83], v112, s[12:15], s29 offen offset:3072 sc1
    v_mfma_f32_16x16x32_bf16 v[60:63], a[40:43], v[32:35], v[60:63]
    ds_read_b128 v[24:27], v13 offset:16384
    ds_read_b32 v1, v2
    v_mfma_f32_16x16x32_bf16 v[64:67], a[44:47], v[32:35], v[64:67]
    s_waitcnt lgkmcnt(4)
    v_mfma_f32_16x16x32_bf16 v[52:55], a[48:51], v[36:39], v[52:55]
    ds_read_b128 v[28:31], v12 offset:18432
    s_add_u32 m0, s21, 114688
    v_mfma_f32_16x16x32_bf16 v[56:59], a[52:55], v[36:39], v[56:59]
    buffer_load_dwordx4 v8, s[8:11], s20 offen lds
    v_mfma_f32_16x16x32_bf16 v[60:63], a[48:51], v[40:43], v[60:63]
    ds_read_b128 v[32:35], v13 offset:18432
    v_mfma_f32_16x16x32_bf16 v[64:67], a[52:55], v[40:43], v[64:67]
    s_waitcnt lgkmcnt(4)
    v_mfma_f32_16x16x32_bf16 v[52:55], a[56:59], v[44:47], v[52:55]
    ds_read_b128 v[36:39], v12 offset:20480
    v_mfma_f32_16x16x32_bf16 v[56:59], a[60:63], v[44:47], v[56:59]
    buffer_store_dwordx4 v[108:111], v112, s[12:15], s7 offen offset:1024 sc1
    v_mfma_f32_16x16x32_bf16 v[60:63], a[56:59], v[48:51], v[60:63]
    ds_read_b128 v[40:43], v13 offset:20480
    v_mfma_f32_16x16x32_bf16 v[64:67], a[60:63], v[48:51], v[64:67]
    s_waitcnt lgkmcnt(4)
    v_mfma_f32_16x16x32_bf16 v[52:55], a[64:67], v[20:23], v[52:55]
    ds_read_b128 v[44:47], v12 offset:22528
    s_add_u32 m0, s21, 115712
    v_mfma_f32_16x16x32_bf16 v[56:59], a[68:71], v[20:23], v[56:59]
    buffer_load_dwordx4 v9, s[8:11], s20 offen lds
    v_mfma_f32_16x16x32_bf16 v[60:63], a[64:67], v[24:27], v[60:63]
    ds_read_b128 v[48:51], v13 offset:22528
    v_mfma_f32_16x16x32_bf16 v[64:67], a[68:71], v[24:27], v[64:67]
    s_waitcnt lgkmcnt(4)
    v_mfma_f32_16x16x32_bf16 v[52:55], a[72:75], v[28:31], v[52:55]
    ds_read_b128 v[20:23], v12 offset:24576
    v_mfma_f32_16x16x32_bf16 v[56:59], a[76:79], v[28:31], v[56:59]
    buffer_store_dwordx4 v[108:111], v112, s[12:15], s7 offen offset:2048 sc1
    v_mfma_f32_16x16x32_bf16 v[60:63], a[72:75], v[32:35], v[60:63]
    ds_read_b128 v[24:27], v13 offset:24576
    v_readfirstlane_b32 s51, v1
    s_add_u32 s30, s22, 3
    v_mfma_f32_16x16x32_bf16 v[64:67], a[76:79], v[32:35], v[64:67]
    s_waitcnt lgkmcnt(4)
    s_cmp_eq_u32 s30, s24
    s_cselect_b32 s51, s51, 0
    v_mfma_f32_16x16x32_bf16 v[52:55], a[80:83], v[36:39], v[52:55]
    ds_read_b128 v[28:31], v12 offset:26624
    s_add_u32 m0, s21, 116736
    v_mfma_f32_16x16x32_bf16 v[56:59], a[84:87], v[36:39], v[56:59]
    buffer_load_dwordx4 v10, s[8:11], s20 offen lds
    v_mfma_f32_16x16x32_bf16 v[60:63], a[80:83], v[40:43], v[60:63]
    ds_read_b128 v[32:35], v13 offset:26624
    s_cmp_ge_u32 s51, 8
    s_cselect_b32 s30, 3, 0
    v_mfma_f32_16x16x32_bf16 v[64:67], a[84:87], v[40:43], v[64:67]
    s_waitcnt lgkmcnt(4)
    v_mfma_f32_16x16x32_bf16 v[52:55], a[88:91], v[44:47], v[52:55]
    ds_read_b128 v[36:39], v12 offset:28672
    s_add_u32 s24, s24, s30
    v_mfma_f32_16x16x32_bf16 v[56:59], a[92:95], v[44:47], v[56:59]
    s_add_u32 s23, s23, s30
    buffer_store_dwordx4 v[108:111], v112, s[12:15], s7 offen offset:3072 sc1
    v_mfma_f32_16x16x32_bf16 v[60:63], a[88:91], v[48:51], v[60:63]
    ds_read_b128 v[40:43], v13 offset:28672
    s_bitcmp1_b32 s24, 1
    s_cselect_b32 s53, s54, s55
    v_mfma_f32_16x16x32_bf16 v[64:67], a[92:95], v[48:51], v[64:67]
    s_waitcnt lgkmcnt(4)
    v_mfma_f32_16x16x32_bf16 v[52:55], a[96:99], v[20:23], v[52:55]
    ds_read_b128 v[44:47], v12 offset:30720
    s_add_u32 m0, s21, 117760
    s_lshl_b32 s30, s24, 20
    v_mfma_f32_16x16x32_bf16 v[56:59], a[100:103], v[20:23], v[56:59]
    buffer_load_dwordx4 v11, s[8:11], s20 offen lds
    v_mfma_f32_16x16x32_bf16 v[60:63], a[96:99], v[24:27], v[60:63]
    ds_read_b128 v[48:51], v13 offset:30720
    s_add_u32 s53, s53, s30
    v_mfma_f32_16x16x32_bf16 v[64:67], a[100:103], v[24:27], v[64:67]
    s_waitcnt lgkmcnt(4)
    s_add_u32 s53, s53, s50
    v_mfma_f32_16x16x32_bf16 v[52:55], a[104:107], v[28:31], v[52:55]
    s_waitcnt vmcnt(20)
    s_barrier
    ds_read_b128 v[20:23], v12 offset:32768
    v_mfma_f32_16x16x32_bf16 v[56:59], a[108:111], v[28:31], v[56:59]
    s_mov_b32 s20, s53
    v_mfma_f32_16x16x32_bf16 v[60:63], a[104:107], v[32:35], v[60:63]
    ds_read_b128 v[24:27], v13 offset:32768
    s_add_u32 s30, s24, 3
    v_mfma_f32_16x16x32_bf16 v[64:67], a[108:111], v[32:35], v[64:67]
    s_waitcnt lgkmcnt(4)
    s_cmp_lt_u32 s30, 64
    s_cselect_b32 s30, s30, 0x200000
    v_mfma_f32_16x16x32_bf16 v[52:55], a[112:115], v[36:39], v[52:55]
    ds_read_b128 v[28:31], v12 offset:34816
    s_add_u32 m0, s21, 0
    v_mfma_f32_16x16x32_bf16 v[56:59], a[116:119], v[36:39], v[56:59]
    buffer_load_dwordx4 v8, s[8:11], s20 offen lds
    v_mfma_f32_16x16x32_bf16 v[60:63], a[112:115], v[40:43], v[60:63]
    ds_read_b128 v[32:35], v13 offset:34816
    v_mfma_f32_16x16x32_bf16 v[64:67], a[116:119], v[40:43], v[64:67]
    s_waitcnt lgkmcnt(4)
    s_lshl_b32 s30, s30, 9
    v_mfma_f32_16x16x32_bf16 v[52:55], a[120:123], v[44:47], v[52:55]
    ds_read_b128 v[36:39], v12 offset:36864
    s_add_u32 s30, s30, s48
    v_mfma_f32_16x16x32_bf16 v[56:59], a[124:127], v[44:47], v[56:59]
    buffer_load_dword v87, v4, s[12:15], s30 offen sc1
    v_mfma_f32_16x16x32_bf16 v[60:63], a[120:123], v[48:51], v[60:63]
    ds_read_b128 v[40:43], v13 offset:36864
    s_waitcnt vmcnt(15)
    v_add_f32 v100, v116, v88
    v_mfma_f32_16x16x32_bf16 v[64:67], a[124:127], v[48:51], v[64:67]
    s_waitcnt lgkmcnt(4)
    v_add_f32 v104, v92, v96
    v_add_f32 v101, v117, v89
    v_mfma_f32_16x16x32_bf16 v[52:55], a[128:131], v[20:23], v[52:55]
    ds_read_b128 v[44:47], v12 offset:38912
    s_add_u32 m0, s21, 1024
    v_add_f32 v105, v93, v97
    v_mfma_f32_16x16x32_bf16 v[56:59], a[132:135], v[20:23], v[56:59]
    buffer_load_dwordx4 v9, s[8:11], s20 offen lds
    v_add_f32 v102, v118, v90
    v_mfma_f32_16x16x32_bf16 v[60:63], a[128:131], v[24:27], v[60:63]
    ds_read_b128 v[48:51], v13 offset:38912
    v_add_f32 v106, v94, v98
    v_mfma_f32_16x16x32_bf16 v[64:67], a[132:135], v[24:27], v[64:67]
    s_waitcnt lgkmcnt(4)
    v_add_f32 v103, v119, v91
    v_add_f32 v107, v95, v99
    v_mfma_f32_16x16x32_bf16 v[52:55], a[136:139], v[28:31], v[52:55]
    ds_read_b128 v[20:23], v12 offset:40960
    v_add_f32 v100, v100, v104
    v_add_f32 v101, v101, v105
    v_mfma_f32_16x16x32_bf16 v[56:59], a[140:143], v[28:31], v[56:59]
    v_add_f32 v102, v102, v106
    v_mfma_f32_16x16x32_bf16 v[60:63], a[136:139], v[32:35], v[60:63]
    ds_read_b128 v[24:27], v13 offset:40960
    v_add_f32 v103, v103, v107
    v_add_f32 v104, v100, v101
    v_mfma_f32_16x16x32_bf16 v[64:67], a[140:143], v[32:35], v[64:67]
    s_waitcnt lgkmcnt(4)
    v_add_f32 v105, v102, v103
    v_cmp_u_f32 vcc, v104, v105
    v_mfma_f32_16x16x32_bf16 v[52:55], a[144:147], v[36:39], v[52:55]
    ds_read_b128 v[28:31], v12 offset:43008
    s_add_u32 m0, s21, 2048
    s_nop 0
    v_mfma_f32_16x16x32_bf16 v[56:59], a[148:151], v[36:39], v[56:59]
    buffer_load_dwordx4 v10, s[8:11], s20 offen lds
    v_mfma_f32_16x16x32_bf16 v[60:63], a[144:147], v[40:43], v[60:63]
    ds_read_b128 v[32:35], v13 offset:43008
    s_nop 0
    s_cbranch_vccnz L_rbad_258
L_rok_259:
    v_mfma_f32_16x16x32_bf16 v[64:67], a[148:151], v[40:43], v[64:67]
    s_waitcnt lgkmcnt(4)
    ds_write_b128 v114, v[100:103]
    v_mfma_f32_16x16x32_bf16 v[52:55], a[152:155], v[44:47], v[52:55]
    ds_read_b128 v[36:39], v12 offset:45056
    ds_read_b128 v[88:91], v113 offset:0
    v_mfma_f32_16x16x32_bf16 v[56:59], a[156:159], v[44:47], v[56:59]
    v_mfma_f32_16x16x32_bf16 v[60:63], a[152:155], v[48:51], v[60:63]
    ds_read_b128 v[40:43], v13 offset:45056
    v_mfma_f32_16x16x32_bf16 v[64:67], a[156:159], v[48:51], v[64:67]
    s_waitcnt lgkmcnt(4)
    v_mfma_f32_16x16x32_bf16 v[52:55], a[160:163], v[20:23], v[52:55]
    ds_read_b128 v[44:47], v12 offset:47104
    s_add_u32 m0, s21, 3072
    v_mfma_f32_16x16x32_bf16 v[56:59], a[164:167], v[20:23], v[56:59]
    buffer_load_dwordx4 v11, s[8:11], s20 offen lds
    v_mfma_f32_16x16x32_bf16 v[60:63], a[160:163], v[24:27], v[60:63]
    ds_read_b128 v[48:51], v13 offset:47104
    s_waitcnt lgkmcnt(3)
    v_mfma_f32_16x16x32_bf16 v[64:67], a[164:167], v[24:27], v[64:67]
    s_waitcnt lgkmcnt(4)
    v_mfma_f32_16x16x32_bf16 v[52:55], a[168:171], v[28:31], v[52:55]
    s_waitcnt vmcnt(20)
    s_barrier
    ds_read_b128 v[20:23], v12 offset:49152
    v_mfma_f32_16x16x32_bf16 v[56:59], a[172:175], v[28:31], v[56:59]
    s_add_u32 s20, s20, 65536
    v_mfma_f32_16x16x32_bf16 v[60:63], a[168:171], v[32:35], v[60:63]
    ds_read_b128 v[24:27], v13 offset:49152
    v_cvt_pk_bf16_f32 v100, 0, v88
    v_mfma_f32_16x16x32_bf16 v[64:67], a[172:175], v[32:35], v[64:67]
    s_waitcnt lgkmcnt(4)
    v_mfma_f32_16x16x32_bf16 v[52:55], a[176:179], v[36:39], v[52:55]
    ds_read_b128 v[28:31], v12 offset:51200
    s_add_u32 m0, s21, 16384
    v_mfma_f32_16x16x32_bf16 v[56:59], a[180:183], v[36:39], v[56:59]
    buffer_load_dwordx4 v8, s[8:11], s20 offen lds
    v_mfma_f32_16x16x32_bf16 v[60:63], a[176:179], v[40:43], v[60:63]
    ds_read_b128 v[32:35], v13 offset:51200
    v_mfma_f32_16x16x32_bf16 v[64:67], a[180:183], v[40:43], v[64:67]
    s_waitcnt lgkmcnt(4)
    v_cvt_pk_bf16_f32 v101, 0, v89
    v_mfma_f32_16x16x32_bf16 v[52:55], a[184:187], v[44:47], v[52:55]
    ds_read_b128 v[36:39], v12 offset:53248
    v_mfma_f32_16x16x32_bf16 v[56:59], a[188:191], v[44:47], v[56:59]
    v_mfma_f32_16x16x32_bf16 v[60:63], a[184:187], v[48:51], v[60:63]
    ds_read_b128 v[40:43], v13 offset:53248
    v_cvt_pk_bf16_f32 v102, 0, v90
    v_mfma_f32_16x16x32_bf16 v[64:67], a[188:191], v[48:51], v[64:67]
    s_waitcnt lgkmcnt(4)
    v_mfma_f32_16x16x32_bf16 v[52:55], a[192:195], v[20:23], v[52:55]
    ds_read_b128 v[44:47], v12 offset:55296
    s_add_u32 m0, s21, 17408
    v_mfma_f32_16x16x32_bf16 v[56:59], a[196:199], v[20:23], v[56:59]
    buffer_load_dwordx4 v9, s[8:11], s20 offen lds
    v_mfma_f32_16x16x32_bf16 v[60:63], a[192:195], v[24:27], v[60:63]
    ds_read_b128 v[48:51], v13 offset:55296
    v_cvt_pk_bf16_f32 v103, 0, v91
    v_mfma_f32_16x16x32_bf16 v[64:67], a[196:199], v[24:27], v[64:67]
    s_waitcnt lgkmcnt(4)
    v_mfma_f32_16x16x32_bf16 v[52:55], a[200:203], v[28:31], v[52:55]
    ds_read_b128 v[20:23], v12 offset:57344
    v_mfma_f32_16x16x32_bf16 v[56:59], a[204:207], v[28:31], v[56:59]
    buffer_store_dwordx4 v[100:103], v124, s[16:19], s43 offen
    v_mfma_f32_16x16x32_bf16 v[60:63], a[200:203], v[32:35], v[60:63]
    ds_read_b128 v[24:27], v13 offset:57344
    v_mfma_f32_16x16x32_bf16 v[64:67], a[204:207], v[32:35], v[64:67]
    s_waitcnt lgkmcnt(4)
    v_mfma_f32_16x16x32_bf16 v[52:55], a[208:211], v[36:39], v[52:55]
    ds_read_b128 v[28:31], v12 offset:59392
    s_add_u32 m0, s21, 18432
    v_mfma_f32_16x16x32_bf16 v[56:59], a[212:215], v[36:39], v[56:59]
    buffer_load_dwordx4 v10, s[8:11], s20 offen lds
    v_mfma_f32_16x16x32_bf16 v[60:63], a[208:211], v[40:43], v[60:63]
    ds_read_b128 v[32:35], v13 offset:59392
    v_mov_b32 v116, v68
    v_mfma_f32_16x16x32_bf16 v[64:67], a[212:215], v[40:43], v[64:67]
    s_waitcnt lgkmcnt(4)
    v_mov_b32 v117, v69
    v_mfma_f32_16x16x32_bf16 v[52:55], a[216:219], v[44:47], v[52:55]
    ds_read_b128 v[36:39], v12 offset:61440
    v_mov_b32 v118, v70
    v_mfma_f32_16x16x32_bf16 v[56:59], a[220:223], v[44:47], v[56:59]
    v_mov_b32 v119, v71
    s_mov_b32 s7, s39
    s_add_u32 s39, s44, s31
    s_sub_u32 s43, s22, 3
    s_lshl_b32 s43, s43, 18
    s_cmp_eq_u32 s37, 0
    s_cselect_b32 s43, 0x7ff00000, s43
    buffer_load_dwordx4 v[88:91], v112, s[12:15], s39 offen offset:1024 sc1
    v_mfma_f32_16x16x32_bf16 v[60:63], a[216:219], v[48:51], v[60:63]
    ds_read_b128 v[40:43], v13 offset:61440
    v_mfma_f32_16x16x32_bf16 v[64:67], a[220:223], v[48:51], v[64:67]
    s_waitcnt lgkmcnt(4)
    v_mfma_f32_16x16x32_bf16 v[52:55], a[224:227], v[20:23], v[52:55]
    ds_read_b128 v[44:47], v12 offset:63488
    s_add_u32 m0, s21, 19456
    v_mfma_f32_16x16x32_bf16 v[56:59], a[228:231], v[20:23], v[56:59]
    buffer_load_dwordx4 v11, s[8:11], s20 offen lds
    v_mfma_f32_16x16x32_bf16 v[60:63], a[224:227], v[24:27], v[60:63]
    ds_read_b128 v[48:51], v13 offset:63488
    v_mfma_f32_16x16x32_bf16 v[64:67], a[228:231], v[24:27], v[64:67]
    s_waitcnt lgkmcnt(4)
    v_mfma_f32_16x16x32_bf16 v[52:55], a[232:235], v[28:31], v[52:55]
    s_waitcnt vmcnt(20)
    s_barrier
    ds_read_b128 v[20:23], v16 offset:0
    v_mfma_f32_16x16x32_bf16 v[56:59], a[236:239], v[28:31], v[56:59]
    s_add_u32 s20, s20, 65536
    buffer_load_dwordx4 v[92:95], v112, s[12:15], s39 offen offset:2048 sc1
    v_mfma_f32_16x16x32_bf16 v[60:63], a[232:235], v[32:35], v[60:63]
    ds_read_b128 v[24:27], v17 offset:0
    v_mfma_f32_16x16x32_bf16 v[64:67], a[236:239], v[32:35], v[64:67]
    s_waitcnt lgkmcnt(4)
    v_mfma_f32_16x16x32_bf16 v[52:55], a[240:243], v[36:39], v[52:55]
    ds_read_b128 v[28:31], v16 offset:2048
    s_add_u32 m0, s21, 32768
    v_mfma_f32_16x16x32_bf16 v[56:59], a[244:247], v[36:39], v[56:59]
    buffer_load_dwordx4 v8, s[8:11], s20 offen lds
    v_mfma_f32_16x16x32_bf16 v[60:63], a[240:243], v[40:43], v[60:63]
    ds_read_b128 v[32:35], v17 offset:2048
    v_mfma_f32_16x16x32_bf16 v[64:67], a[244:247], v[40:43], v[64:67]
    s_waitcnt lgkmcnt(4)
    v_mfma_f32_16x16x32_bf16 v[52:55], a[248:251], v[44:47], v[52:55]
    ds_read_b128 v[36:39], v16 offset:4096
    v_mfma_f32_16x16x32_bf16 v[56:59], a[252:255], v[44:47], v[56:59]
    buffer_load_dwordx4 v[96:99], v112, s[12:15], s39 offen offset:3072 sc1
    v_mfma_f32_16x16x32_bf16 v[60:63], a[248:251], v[48:51], v[60:63]
    ds_read_b128 v[40:43], v17 offset:4096
    s_mov_b32 s37, 1
    v_mfma_f32_16x16x32_bf16 v[64:67], a[252:255], v[48:51], v[64:67]
    s_waitcnt lgkmcnt(4)
    s_add_u32 s22, s22, 3
    s_cmp_ge_u32 s22, s23
    s_cbranch_scc1 L_fl0_263
    v_mfma_f32_16x16x32_bf16 v[68:71], a[0:3], v[20:23], 0
    ds_read_b128 v[44:47], v16 offset:6144
    s_add_u32 m0, s21, 33792
    v_mfma_f32_16x16x32_bf16 v[72:75], a[4:7], v[20:23], 0
    buffer_load_dwordx4 v9, s[8:11], s20 offen lds
    v_mfma_f32_16x16x32_bf16 v[76:79], a[0:3], v[24:27], 0
    ds_read_b128 v[48:51], v17 offset:6144
    s_add_u32 s38, s38, 0x1000
    v_mfma_f32_16x16x32_bf16 v[80:83], a[4:7], v[24:27], 0
    s_waitcnt lgkmcnt(4)
    s_and_b32 s38, s38, 0x7000
    v_mfma_f32_16x16x32_bf16 v[68:71], a[8:11], v[28:31], v[68:71]
    ds_read_b128 v[20:23], v16 offset:8192
    s_waitcnt vmcnt(13)
    v_mfma_f32_16x16x32_bf16 v[72:75], a[12:15], v[28:31], v[72:75]
    ds_write_b32 v3, v87
    s_cmp_eq_u32 s37, 0
    s_cselect_b32 s31, 0x40000000, s38
    s_nop 0
    s_add_u32 s29, s45, s31
    buffer_store_dwordx4 v[56:59], v112, s[12:15], s29 offen offset:1024 sc1
    v_mfma_f32_16x16x32_bf16 v[76:79], a[8:11], v[32:35], v[76:79]
    ds_read_b128 v[24:27], v17 offset:8192
    v_mfma_f32_16x16x32_bf16 v[80:83], a[12:15], v[32:35], v[80:83]
    s_waitcnt lgkmcnt(4)
    v_mfma_f32_16x16x32_bf16 v[68:71], a[16:19], v[36:39], v[68:71]
    ds_read_b128 v[28:31], v16 offset:10240
    s_add_u32 m0, s21, 34816
    v_mfma_f32_16x16x32_bf16 v[72:75], a[20:23], v[36:39], v[72:75]
    buffer_load_dwordx4 v10, s[8:11], s20 offen lds
    v_mfma_f32_16x16x32_bf16 v[76:79], a[16:19], v[40:43], v[76:79]
    ds_read_b128 v[32:35], v17 offset:10240
    v_mfma_f32_16x16x32_bf16 v[80:83], a[20:23], v[40:43], v[80:83]
    s_waitcnt lgkmcnt(4)
    v_mfma_f32_16x16x32_bf16 v[68:71], a[24:27], v[44:47], v[68:71]
    ds_read_b128 v[36:39], v16 offset:12288
    v_mfma_f32_16x16x32_bf16 v[72:75], a[28:31], v[44:47], v[72:75]
    s_add_u32 s29, s46, s31
    buffer_store_dwordx4 v[60:63], v112, s[12:15], s29 offen offset:2048 sc1
    v_mfma_f32_16x16x32_bf16 v[76:79], a[24:27], v[48:51], v[76:79]
    ds_read_b128 v[40:43], v17 offset:12288
    v_mfma_f32_16x16x32_bf16 v[80:83], a[28:31], v[48:51], v[80:83]
    s_waitcnt lgkmcnt(4)
    s_add_u32 s29, s47, s31
    v_mfma_f32_16x16x32_bf16 v[68:71], a[32:35], v[20:23], v[68:71]
    ds_read_b128 v[44:47], v16 offset:14336
    s_add_u32 m0, s21, 35840
    v_mfma_f32_16x16x32_bf16 v[72:75], a[36:39], v[20:23], v[72:75]
    buffer_load_dwordx4 v11, s[8:11], s20 offen lds
    v_mfma_f32_16x16x32_bf16 v[76:79], a[32:35], v[24:27], v[76:79]
    ds_read_b128 v[48:51], v17 offset:14336
    v_mfma_f32_16x16x32_bf16 v[80:83], a[36:39], v[24:27], v[80:83]
    s_waitcnt lgkmcnt(4)
    v_mfma_f32_16x16x32_bf16 v[68:71], a[40:43], v[28:31], v[68:71]
    s_waitcnt vmcnt(20)
    s_barrier
    ds_read_b128 v[20:23], v16 offset:16384
    v_mfma_f32_16x16x32_bf16 v[72:75], a[44:47], v[28:31], v[72:75]
    s_add_u32 s20, s20, 65536
    buffer_store_dwordx4 v[64:67], v112, s[12:15], s29 offen offset:3072 sc1
    v_mfma_f32_16x16x32_bf16 v[76:79], a[40:43], v[32:35], v[76:79]
    ds_read_b128 v[24:27], v17 offset:16384
    ds_read_b32 v1, v2
    v_mfma_f32_16x16x32_bf16 v[80:83], a[44:47], v[32:35], v[80:83]
    s_waitcnt lgkmcnt(4)
    v_mfma_f32_16x16x32_bf16 v[68:71], a[48:51], v[36:39], v[68:71]
    ds_read_b128 v[28:31], v16 offset:18432
    s_add_u32 m0, s21, 49152
    v_mfma_f32_16x16x32_bf16 v[72:75], a[52:55], v[36:39], v[72:75]
    buffer_load_dwordx4 v8, s[8:11], s20 offen lds
    v_mfma_f32_16x16x32_bf16 v[76:79], a[48:51], v[40:43], v[76:79]
    ds_read_b128 v[32:35], v17 offset:18432
    v_mfma_f32_16x16x32_bf16 v[80:83], a[52:55], v[40:43], v[80:83]
    s_waitcnt lgkmcnt(4)
    v_mfma_f32_16x16x32_bf16 v[68:71], a[56:59], v[44:47], v[68:71]
    ds_read_b128 v[36:39], v16 offset:20480
    v_mfma_f32_16x16x32_bf16 v[72:75], a[60:63], v[44:47], v[72:75]
    buffer_store_dwordx4 v[108:111], v112, s[12:15], s7 offen offset:1024 sc1
    v_mfma_f32_16x16x32_bf16 v[76:79], a[56:59], v[48:51], v[76:79]
    ds_read_b128 v[40:43], v17 offset:20480
    v_mfma_f32_16x16x32_bf16 v[80:83], a[60:63], v[48:51], v[80:83]
    s_waitcnt lgkmcnt(4)
    v_mfma_f32_16x16x32_bf16 v[68:71], a[64:67], v[20:23], v[68:71]
    ds_read_b128 v[44:47], v16 offset:22528
    s_add_u32 m0, s21, 50176
    v_mfma_f32_16x16x32_bf16 v[72:75], a[68:71], v[20:23], v[72:75]
    buffer_load_dwordx4 v9, s[8:11], s20 offen lds
    v_mfma_f32_16x16x32_bf16 v[76:79], a[64:67], v[24:27], v[76:79]
    ds_read_b128 v[48:51], v17 offset:22528
    v_mfma_f32_16x16x32_bf16 v[80:83], a[68:71], v[24:27], v[80:83]
    s_waitcnt lgkmcnt(4)
    v_mfma_f32_16x16x32_bf16 v[68:71], a[72:75], v[28:31], v[68:71]
    ds_read_b128 v[20:23], v16 offset:24576
    v_mfma_f32_16x16x32_bf16 v[72:75], a[76:79], v[28:31], v[72:75]
    buffer_store_dwordx4 v[108:111], v112, s[12:15], s7 offen offset:2048 sc1
    v_mfma_f32_16x16x32_bf16 v[76:79], a[72:75], v[32:35], v[76:79]
    ds_read_b128 v[24:27], v17 offset:24576
    v_readfirstlane_b32 s51, v1
    s_add_u32 s30, s22, 3
    v_mfma_f32_16x16x32_bf16 v[80:83], a[76:79], v[32:35], v[80:83]
    s_waitcnt lgkmcnt(4)
    s_cmp_eq_u32 s30, s24
    s_cselect_b32 s51, s51, 0
    v_mfma_f32_16x16x32_bf16 v[68:71], a[80:83], v[36:39], v[68:71]
    ds_read_b128 v[28:31], v16 offset:26624
    s_add_u32 m0, s21, 51200
    v_mfma_f32_16x16x32_bf16 v[72:75], a[84:87], v[36:39], v[72:75]
    buffer_load_dwordx4 v10, s[8:11], s20 offen lds
    v_mfma_f32_16x16x32_bf16 v[76:79], a[80:83], v[40:43], v[76:79]
    ds_read_b128 v[32:35], v17 offset:26624
    s_cmp_ge_u32 s51, 8
    s_cselect_b32 s30, 3, 0
    v_mfma_f32_16x16x32_bf16 v[80:83], a[84:87], v[40:43], v[80:83]
    s_waitcnt lgkmcnt(4)
    v_mfma_f32_16x16x32_bf16 v[68:71], a[88:91], v[44:47], v[68:71]
    ds_read_b128 v[36:39], v16 offset:28672
    s_add_u32 s24, s24, s30
    v_mfma_f32_16x16x32_bf16 v[72:75], a[92:95], v[44:47], v[72:75]
    s_add_u32 s23, s23, s30
    buffer_store_dwordx4 v[108:111], v112, s[12:15], s7 offen offset:3072 sc1
    v_mfma_f32_16x16x32_bf16 v[76:79], a[88:91], v[48:51], v[76:79]
    ds_read_b128 v[40:43], v17 offset:28672
    s_bitcmp1_b32 s24, 1
    s_cselect_b32 s53, s54, s55
    v_mfma_f32_16x16x32_bf16 v[80:83], a[92:95], v[48:51], v[80:83]
    s_waitcnt lgkmcnt(4)
    v_mfma_f32_16x16x32_bf16 v[68:71], a[96:99], v[20:23], v[68:71]
    ds_read_b128 v[44:47], v16 offset:30720
    s_add_u32 m0, s21, 52224
    s_lshl_b32 s30, s24, 20
    v_mfma_f32_16x16x32_bf16 v[72:75], a[100:103], v[20:23], v[72:75]
    buffer_load_dwordx4 v11, s[8:11], s20 offen lds
    v_mfma_f32_16x16x32_bf16 v[76:79], a[96:99], v[24:27], v[76:79]
    ds_read_b128 v[48:51], v17 offset:30720
    s_add_u32 s53, s53, s30
    v_mfma_f32_16x16x32_bf16 v[80:83], a[100:103], v[24:27], v[80:83]
    s_waitcnt lgkmcnt(4)
    s_add_u32 s53, s53, s50
    v_mfma_f32_16x16x32_bf16 v[68:71], a[104:107], v[28:31], v[68:71]
    s_waitcnt vmcnt(20)
    s_barrier
    ds_read_b128 v[20:23], v16 offset:32768
    v_mfma_f32_16x16x32_bf16 v[72:75], a[108:111], v[28:31], v[72:75]
    s_mov_b32 s20, s53
    v_mfma_f32_16x16x32_bf16 v[76:79], a[104:107], v[32:35], v[76:79]
    ds_read_b128 v[24:27], v17 offset:32768
    s_add_u32 s30, s24, 3
    v_mfma_f32_16x16x32_bf16 v[80:83], a[108:111], v[32:35], v[80:83]
    s_waitcnt lgkmcnt(4)
    s_cmp_lt_u32 s30, 64
    s_cselect_b32 s30, s30, 0x200000
    v_mfma_f32_16x16x32_bf16 v[68:71], a[112:115], v[36:39], v[68:71]
    ds_read_b128 v[28:31], v16 offset:34816
    s_add_u32 m0, s21, 65536
    v_mfma_f32_16x16x32_bf16 v[72:75], a[116:119], v[36:39], v[72:75]
    buffer_load_dwordx4 v8, s[8:11], s20 offen lds
    v_mfma_f32_16x16x32_bf16 v[76:79], a[112:115], v[40:43], v[76:79]
    ds_read_b128 v[32:35], v17 offset:34816
    v_mfma_f32_16x16x32_bf16 v[80:83], a[116:119], v[40:43], v[80:83]
    s_waitcnt lgkmcnt(4)
    s_lshl_b32 s30, s30, 9
    v_mfma_f32_16x16x32_bf16 v[68:71], a[120:123], v[44:47], v[68:71]
    ds_read_b128 v[36:39], v16 offset:36864
    s_add_u32 s30, s30, s48
    v_mfma_f32_16x16x32_bf16 v[72:75], a[124:127], v[44:47], v[72:75]
    buffer_load_dword v87, v4, s[12:15], s30 offen sc1
    v_mfma_f32_16x16x32_bf16 v[76:79], a[120:123], v[48:51], v[76:79]
    ds_read_b128 v[40:43], v17 offset:36864
    s_waitcnt vmcnt(15)
    v_add_f32 v100, v116, v88
    v_mfma_f32_16x16x32_bf16 v[80:83], a[124:127], v[48:51], v[80:83]
    s_waitcnt lgkmcnt(4)
    v_add_f32 v104, v92, v96
    v_add_f32 v101, v117, v89
    v_mfma_f32_16x16x32_bf16 v[68:71], a[128:131], v[20:23], v[68:71]
    ds_read_b128 v[44:47], v16 offset:38912
    s_add_u32 m0, s21, 66560
    v_add_f32 v105, v93, v97
    v_mfma_f32_16x16x32_bf16 v[72:75], a[132:135], v[20:23], v[72:75]
    buffer_load_dwordx4 v9, s[8:11], s20 offen lds
    v_add_f32 v102, v118, v90
    v_mfma_f32_16x16x32_bf16 v[76:79], a[128:131], v[24:27], v[76:79]
    ds_read_b128 v[48:51], v17 offset:38912
    v_add_f32 v106, v94, v98
    v_mfma_f32_16x16x32_bf16 v[80:83], a[132:135], v[24:27], v[80:83]
    s_waitcnt lgkmcnt(4)
    v_add_f32 v103, v119, v91
    v_add_f32 v107, v95, v99
    v_mfma_f32_16x16x32_bf16 v[68:71], a[136:139], v[28:31], v[68:71]
    ds_read_b128 v[20:23], v16 offset:40960
    v_add_f32 v100, v100, v104
    v_add_f32 v101, v101, v105
    v_mfma_f32_16x16x32_bf16 v[72:75], a[140:143], v[28:31], v[72:75]
    v_add_f32 v102, v102, v106
    v_mfma_f32_16x16x32_bf16 v[76:79], a[136:139], v[32:35], v[76:79]
    ds_read_b128 v[24:27], v17 offset:40960
    v_add_f32 v103, v103, v107
    v_add_f32 v104, v100, v101
    v_mfma_f32_16x16x32_bf16 v[80:83], a[140:143], v[32:35], v[80:83]
    s_waitcnt lgkmcnt(4)
    v_add_f32 v105, v102, v103
    v_cmp_u_f32 vcc, v104, v105
    v_mfma_f32_16x16x32_bf16 v[68:71], a[144:147], v[36:39], v[68:71]
    ds_read_b128 v[28:31], v16 offset:43008
    s_add_u32 m0, s21, 67584
    s_nop 0
    v_mfma_f32_16x16x32_bf16 v[72:75], a[148:151], v[36:39], v[72:75]
    buffer_load_dwordx4 v10, s[8:11], s20 offen lds
    v_mfma_f32_16x16x32_bf16 v[76:79], a[144:147], v[40:43], v[76:79]
    ds_read_b128 v[32:35], v17 offset:43008
    s_nop 0
    s_cbranch_vccnz L_rbad_260
L_rok_261:
    v_mfma_f32_16x16x32_bf16 v[80:83], a[148:151], v[40:43], v[80:83]
    s_waitcnt lgkmcnt(4)
    ds_write_b128 v114, v[100:103]
    v_mfma_f32_16x16x32_bf16 v[68:71], a[152:155], v[44:47], v[68:71]
    ds_read_b128 v[36:39], v16 offset:45056
    ds_read_b128 v[88:91], v113 offset:0
    v_mfma_f32_16x16x32_bf16 v[72:75], a[156:159], v[44:47], v[72:75]
    v_mfma_f32_16x16x32_bf16 v[76:79], a[152:155], v[48:51], v[76:79]
    ds_read_b128 v[40:43], v17 offset:45056
    v_mfma_f32_16x16x32_bf16 v[80:83], a[156:159], v[48:51], v[80:83]
    s_waitcnt lgkmcnt(4)
    v_mfma_f32_16x16x32_bf16 v[68:71], a[160:163], v[20:23], v[68:71]
    ds_read_b128 v[44:47], v16 offset:47104
    s_add_u32 m0, s21, 68608
    v_mfma_f32_16x16x32_bf16 v[72:75], a[164:167], v[20:23], v[72:75]
    buffer_load_dwordx4 v11, s[8:11], s20 offen lds
    v_mfma_f32_16x16x32_bf16 v[76:79], a[160:163], v[24:27], v[76:79]
    ds_read_b128 v[48:51], v17 offset:47104
    s_waitcnt lgkmcnt(3)
    v_mfma_f32_16x16x32_bf16 v[80:83], a[164:167], v[24:27], v[80:83]
    s_waitcnt lgkmcnt(4)
    v_mfma_f32_16x16x32_bf16 v[68:71], a[168:171], v[28:31], v[68:71]
    s_waitcnt vmcnt(20)
    s_barrier
    ds_read_b128 v[20:23], v16 offset:49152
    v_mfma_f32_16x16x32_bf16 v[72:75], a[172:175], v[28:31], v[72:75]
    s_add_u32 s20, s20, 65536
    v_mfma_f32_16x16x32_bf16 v[76:79], a[168:171], v[32:35], v[76:79]
    ds_read_b128 v[24:27], v17 offset:49152
    v_cvt_pk_bf16_f32 v100, 0, v88
    v_mfma_f32_16x16x32_bf16 v[80:83], a[172:175], v[32:35], v[80:83]
    s_waitcnt lgkmcnt(4)
    v_mfma_f32_16x16x32_bf16 v[68:71], a[176:179], v[36:39], v[68:71]
    ds_read_b128 v[28:31], v16 offset:51200
    s_add_u32 m0, s21, 81920
    v_mfma_f32_16x16x32_bf16 v[72:75], a[180:183], v[36:39], v[72:75]
    buffer_load_dwordx4 v8, s[8:11], s20 offen lds
    v_mfma_f32_16x16x32_bf16 v[76:79], a[176:179], v[40:43], v[76:79]
    ds_read_b128 v[32:35], v17 offset:51200
    v_mfma_f32_16x16x32_bf16 v[80:83], a[180:183], v[40:43], v[80:83]
    s_waitcnt lgkmcnt(4)
    v_cvt_pk_bf16_f32 v101, 0, v89
    v_mfma_f32_16x16x32_bf16 v[68:71], a[184:187], v[44:47], v[68:71]
    ds_read_b128 v[36:39], v16 offset:53248
    v_mfma_f32_16x16x32_bf16 v[72:75], a[188:191], v[44:47], v[72:75]
    v_mfma_f32_16x16x32_bf16 v[76:79], a[184:187], v[48:51], v[76:79]
    ds_read_b128 v[40:43], v17 offset:53248
    v_cvt_pk_bf16_f32 v102, 0, v90
    v_mfma_f32_16x16x32_bf16 v[80:83], a[188:191], v[48:51], v[80:83]
    s_waitcnt lgkmcnt(4)
    v_mfma_f32_16x16x32_bf16 v[68:71], a[192:195], v[20:23], v[68:71]
    ds_read_b128 v[44:47], v16 offset:55296
    s_add_u32 m0, s21, 82944
    v_mfma_f32_16x16x32_bf16 v[72:75], a[196:199], v[20:23], v[72:75]
    buffer_load_dwordx4 v9, s[8:11], s20 offen lds
    v_mfma_f32_16x16x32_bf16 v[76:79], a[192:195], v[24:27], v[76:79]
    ds_read_b128 v[48:51], v17 offset:55296
    v_cvt_pk_bf16_f32 v103, 0, v91
    v_mfma_f32_16x16x32_bf16 v[80:83], a[196:199], v[24:27], v[80:83]
    s_waitcnt lgkmcnt(4)
    v_mfma_f32_16x16x32_bf16 v[68:71], a[200:203], v[28:31], v[68:71]
    ds_read_b128 v[20:23], v16 offset:57344
    v_mfma_f32_16x16x32_bf16 v[72:75], a[204:207], v[28:31], v[72:75]
    buffer_store_dwordx4 v[100:103], v124, s[16:19], s43 offen
    v_mfma_f32_16x16x32_bf16 v[76:79], a[200:203], v[32:35], v[76:79]
    ds_read_b128 v[24:27], v17 offset:57344
    v_mfma_f32_16x16x32_bf16 v[80:83], a[204:207], v[32:35], v[80:83]
    s_waitcnt lgkmcnt(4)
    v_mfma_f32_16x16x32_bf16 v[68:71], a[208:211], v[36:39], v[68:71]
    ds_read_b128 v[28:31], v16 offset:59392
    s_add_u32 m0, s21, 83968
    v_mfma_f32_16x16x32_bf16 v[72:75], a[212:215], v[36:39], v[72:75]
    buffer_load_dwordx4 v10, s[8:11], s20 offen lds
    v_mfma_f32_16x16x32_bf16 v[76:79], a[208:211], v[40:43], v[76:79]
    ds_read_b128 v[32:35], v17 offset:59392
    v_mov_b32 v116, v52
    v_mfma_f32_16x16x32_bf16 v[80:83], a[212:215], v[40:43], v[80:83]
    s_waitcnt lgkmcnt(4)
    v_mov_b32 v117, v53
    v_mfma_f32_16x16x32_bf16 v[68:71], a[216:219], v[44:47], v[68:71]
    ds_read_b128 v[36:39], v16 offset:61440
    v_mov_b32 v118, v54
    v_mfma_f32_16x16x32_bf16 v[72:75], a[220:223], v[44:47], v[72:75]
    v_mov_b32 v119, v55
    s_mov_b32 s7, s39
    s_add_u32 s39, s44, s31
    s_sub_u32 s43, s22, 3
    s_lshl_b32 s43, s43, 18
    s_cmp_eq_u32 s37, 0
    s_cselect_b32 s43, 0x7ff00000, s43
    buffer_load_dwordx4 v[88:91], v112, s[12:15], s39 offen offset:1024 sc1
    v_mfma_f32_16x16x32_bf16 v[76:79], a[216:219], v[48:51], v[76:79]
    ds_read_b128 v[40:43], v17 offset:61440
    v_mfma_f32_16x16x32_bf16 v[80:83], a[220:223], v[48:51], v[80:83]
    s_waitcnt lgkmcnt(4)
    v_mfma_f32_16x16x32_bf16 v[68:71], a[224:227], v[20:23], v[68:71]
    ds_read_b128 v[44:47], v16 offset:63488
    s_add_u32 m0, s21, 84992
    v_mfma_f32_16x16x32_bf16 v[72:75], a[228:231], v[20:23], v[72:75]
    buffer_load_dwordx4 v11, s[8:11], s20 offen lds
    v_mfma_f32_16x16x32_bf16 v[76:79], a[224:227], v[24:27], v[76:79]
    ds_read_b128 v[48:51], v17 offset:63488
    v_mfma_f32_16x16x32_bf16 v[80:83], a[228:231], v[24:27], v[80:83]
    s_waitcnt lgkmcnt(4)
    v_mfma_f32_16x16x32_bf16 v[68:71], a[232:235], v[28:31], v[68:71]
    s_waitcnt vmcnt(20)
    s_barrier
    ds_read_b128 v[20:23], v12 offset:0
    v_mfma_f32_16x16x32_bf16 v[72:75], a[236:239], v[28:31], v[72:75]
    s_add_u32 s20, s20, 65536
    buffer_load_dwordx4 v[92:95], v112, s[12:15], s39 offen offset:2048 sc1
    v_mfma_f32_16x16x32_bf16 v[76:79], a[232:235], v[32:35], v[76:79]
    ds_read_b128 v[24:27], v13 offset:0
    v_mfma_f32_16x16x32_bf16 v[80:83], a[236:239], v[32:35], v[80:83]
    s_waitcnt lgkmcnt(4)
    v_mfma_f32_16x16x32_bf16 v[68:71], a[240:243], v[36:39], v[68:71]
    ds_read_b128 v[28:31], v12 offset:2048
    s_add_u32 m0, s21, 98304
    v_mfma_f32_16x16x32_bf16 v[72:75], a[244:247], v[36:39], v[72:75]
    buffer_load_dwordx4 v8, s[8:11], s20 offen lds
    v_mfma_f32_16x16x32_bf16 v[76:79], a[240:243], v[40:43], v[76:79]
    ds_read_b128 v[32:35], v13 offset:2048
    v_mfma_f32_16x16x32_bf16 v[80:83], a[244:247], v[40:43], v[80:83]
    s_waitcnt lgkmcnt(4)
    v_mfma_f32_16x16x32_bf16 v[68:71], a[248:251], v[44:47], v[68:71]
    ds_read_b128 v[36:39], v12 offset:4096
    v_mfma_f32_16x16x32_bf16 v[72:75], a[252:255], v[44:47], v[72:75]
    buffer_load_dwordx4 v[96:99], v112, s[12:15], s39 offen offset:3072 sc1
    v_mfma_f32_16x16x32_bf16 v[76:79], a[248:251], v[48:51], v[76:79]
    ds_read_b128 v[40:43], v13 offset:4096
    s_mov_b32 s37, 1
    v_mfma_f32_16x16x32_bf16 v[80:83], a[252:255], v[48:51], v[80:83]
    s_waitcnt lgkmcnt(4)
    s_add_u32 s22, s22, 3
    s_cmp_ge_u32 s22, s23
    s_cbranch_scc0 L_st_262
    s_waitcnt lgkmcnt(0)
    s_nop 7
    s_add_u32 s38, s38, 0x1000
    s_and_b32 s38, s38, 0x7000
    s_cmp_eq_u32 s37, 0
    s_cselect_b32 s31, 0x40000000, s38
    s_nop 0
    s_add_u32 s29, s45, s31
    buffer_store_dwordx4 v[72:75], v112, s[12:15], s29 offen offset:1024 sc1
    s_add_u32 s29, s46, s31
    buffer_store_dwordx4 v[76:79], v112, s[12:15], s29 offen offset:2048 sc1
    s_add_u32 s29, s47, s31
    buffer_store_dwordx4 v[80:83], v112, s[12:15], s29 offen offset:3072 sc1
    buffer_store_dwordx4 v[108:111], v112, s[12:15], s7 offen offset:1024 sc1
    buffer_store_dwordx4 v[108:111], v112, s[12:15], s7 offen offset:2048 sc1
    buffer_store_dwordx4 v[108:111], v112, s[12:15], s7 offen offset:3072 sc1
    s_waitcnt vmcnt(0)
    v_add_f32 v100, v116, v88
    v_add_f32 v104, v92, v96
    v_add_f32 v101, v117, v89
    v_add_f32 v105, v93, v97
    v_add_f32 v102, v118, v90
    v_add_f32 v106, v94, v98
    v_add_f32 v103, v119, v91
    v_add_f32 v107, v95, v99
    v_add_f32 v100, v100, v104
    v_add_f32 v101, v101, v105
    v_add_f32 v102, v102, v106
    v_add_f32 v103, v103, v107
    v_add_f32 v104, v100, v101
    v_add_f32 v105, v102, v103
    v_cmp_u_f32 vcc, v104, v105
    s_nop 0
    s_nop 0
    s_cbranch_vccnz L_rbad_265
L_rok_266:
    ds_write_b128 v114, v[100:103]
    ds_read_b128 v[88:91], v113 offset:0
    s_waitcnt lgkmcnt(0)
    v_cvt_pk_bf16_f32 v100, 0, v88
    v_cvt_pk_bf16_f32 v101, 0, v89
    v_cvt_pk_bf16_f32 v102, 0, v90
    v_cvt_pk_bf16_f32 v103, 0, v91
    buffer_store_dwordx4 v[100:103], v124, s[16:19], s43 offen
    v_mov_b32 v116, v68
    v_mov_b32 v117, v69
    v_mov_b32 v118, v70
    v_mov_b32 v119, v71
    s_mov_b32 s7, s39
    s_add_u32 s39, s44, s31
    s_sub_u32 s43, s22, 3
    s_lshl_b32 s43, s43, 18
    s_cmp_eq_u32 s37, 0
    s_cselect_b32 s43, 0x7ff00000, s43
    buffer_load_dwordx4 v[88:91], v112, s[12:15], s39 offen offset:1024 sc1
    buffer_load_dwordx4 v[92:95], v112, s[12:15], s39 offen offset:2048 sc1
    buffer_load_dwordx4 v[96:99], v112, s[12:15], s39 offen offset:3072 sc1
    s_mov_b32 s37, 1
    buffer_store_dwordx4 v[108:111], v112, s[12:15], s7 offen offset:1024 sc1
    buffer_store_dwordx4 v[108:111], v112, s[12:15], s7 offen offset:2048 sc1
    buffer_store_dwordx4 v[108:111], v112, s[12:15], s7 offen offset:3072 sc1
    s_waitcnt vmcnt(0)
    v_add_f32 v100, v116, v88
    v_add_f32 v104, v92, v96
    v_add_f32 v101, v117, v89
    v_add_f32 v105, v93, v97
    v_add_f32 v102, v118, v90
    v_add_f32 v106, v94, v98
    v_add_f32 v103, v119, v91
    v_add_f32 v107, v95, v99
    v_add_f32 v100, v100, v104
    v_add_f32 v101, v101, v105
    v_add_f32 v102, v102, v106
    v_add_f32 v103, v103, v107
    v_add_f32 v104, v100, v101
    v_add_f32 v105, v102, v103
    v_cmp_u_f32 vcc, v104, v105
    s_nop 0
    s_nop 0
    s_cbranch_vccnz L_rbad_267
L_rok_268:
    ds_write_b128 v114, v[100:103]
    ds_read_b128 v[88:91], v113 offset:0
    s_waitcnt lgkmcnt(0)
    v_cvt_pk_bf16_f32 v100, 0, v88
    v_cvt_pk_bf16_f32 v101, 0, v89
    v_cvt_pk_bf16_f32 v102, 0, v90
    v_cvt_pk_bf16_f32 v103, 0, v91
    buffer_store_dwordx4 v[100:103], v124, s[16:19], s43 offen
    s_mov_b32 s7, s39
    buffer_store_dwordx4 v[108:111], v112, s[12:15], s7 offen offset:1024 sc1
    buffer_store_dwordx4 v[108:111], v112, s[12:15], s7 offen offset:2048 sc1
    buffer_store_dwordx4 v[108:111], v112, s[12:15], s7 offen offset:3072 sc1
    s_branch L_ste_264
L_rbad_258:
    buffer_load_dwordx4 v[88:91], v112, s[12:15], s39 offen offset:1024 sc1
    buffer_load_dwordx4 v[92:95], v112, s[12:15], s39 offen offset:2048 sc1
    buffer_load_dwordx4 v[96:99], v112, s[12:15], s39 offen offset:3072 sc1
    s_add_u32 s36, s36, 1
    s_cmp_gt_u32 s36, 0x100000
    s_cbranch_scc1 chain_kernel_wend
    s_waitcnt vmcnt(0)
    v_max_u32 v100, v88, v89
    v_max3_u32 v100, v100, v90, v91
    v_max3_u32 v100, v100, v92, v93
    v_max3_u32 v100, v100, v94, v95
    v_max3_u32 v100, v100, v96, v97
    v_max3_u32 v100, v100, v98, v99
    v_cmp_eq_u32 vcc, v108, v100
    s_cbranch_vccnz L_rbad_258
    v_add_f32 v100, v116, v88
    v_add_f32 v104, v92, v96
    v_add_f32 v101, v117, v89
    v_add_f32 v105, v93, v97
    v_add_f32 v102, v118, v90
    v_add_f32 v106, v94, v98
    v_add_f32 v103, v119, v91
    v_add_f32 v107, v95, v99
    v_add_f32 v100, v100, v104
    v_add_f32 v101, v101, v105
    v_add_f32 v102, v102, v106
    v_add_f32 v103, v103, v107
    v_add_f32 v104, v100, v101
    v_add_f32 v105, v102, v103
    v_cmp_u_f32 vcc, v104, v105
    s_branch L_rok_259
L_rbad_260:
    buffer_load_dwordx4 v[88:91], v112, s[12:15], s39 offen offset:1024 sc1
    buffer_load_dwordx4 v[92:95], v112, s[12:15], s39 offen offset:2048 sc1
    buffer_load_dwordx4 v[96:99], v112, s[12:15], s39 offen offset:3072 sc1
    s_add_u32 s36, s36, 1
    s_cmp_gt_u32 s36, 0x100000
    s_cbranch_scc1 chain_kernel_wend
    s_waitcnt vmcnt(0)
    v_max_u32 v100, v88, v89
    v_max3_u32 v100, v100, v90, v91
    v_max3_u32 v100, v100, v92, v93
    v_max3_u32 v100, v100, v94, v95
    v_max3_u32 v100, v100, v96, v97
    v_max3_u32 v100, v100, v98, v99
    v_cmp_eq_u32 vcc, v108, v100
    s_cbranch_vccnz L_rbad_260
    v_add_f32 v100, v116, v88
    v_add_f32 v104, v92, v96
    v_add_f32 v101, v117, v89
    v_add_f32 v105, v93, v97
    v_add_f32 v102, v118, v90
    v_add_f32 v106, v94, v98
    v_add_f32 v103, v119, v91
    v_add_f32 v107, v95, v99
    v_add_f32 v100, v100, v104
    v_add_f32 v101, v101, v105
    v_add_f32 v102, v102, v106
    v_add_f32 v103, v103, v107
    v_add_f32 v104, v100, v101
    v_add_f32 v105, v102, v103
    v_cmp_u_f32 vcc, v104, v105
    s_branch L_rok_261
L_rbad_265:
    buffer_load_dwordx4 v[88:91], v112, s[12:15], s39 offen offset:1024 sc1
    buffer_load_dwordx4 v[92:95], v112, s[12:15], s39 offen offset:2048 sc1
    buffer_load_dwordx4 v[96:99], v112, s[12:15], s39 offen offset:3072 sc1
    s_add_u32 s36, s36, 1
    s_cmp_gt_u32 s36, 0x100000
    s_cbranch_scc1 chain_kernel_wend
    s_waitcnt vmcnt(0)
    v_max_u32 v100, v88, v89
    v_max3_u32 v100, v100, v90, v91
    v_max3_u32 v100, v100, v92, v93
    v_max3_u32 v100, v100, v94, v95
    v_max3_u32 v100, v100, v96, v97
    v_max3_u32 v100, v100, v98, v99
    v_cmp_eq_u32 vcc, v108, v100
    s_cbranch_vccnz L_rbad_265
    v_add_f32 v100, v116, v88
    v_add_f32 v104, v92, v96
    v_add_f32 v101, v117, v89
    v_add_f32 v105, v93, v97
    v_add_f32 v102, v118, v90
    v_add_f32 v106, v94, v98
    v_add_f32 v103, v119, v91
    v_add_f32 v107, v95, v99
    v_add_f32 v100, v100, v104
    v_add_f32 v101, v101, v105
    v_add_f32 v102, v102, v106
    v_add_f32 v103, v103, v107
    v_add_f32 v104, v100, v101
    v_add_f32 v105, v102, v103
    v_cmp_u_f32 vcc, v104, v105
    s_branch L_rok_266
L_rbad_267:
    buffer_load_dwordx4 v[88:91], v112, s[12:15], s39 offen offset:1024 sc1
    buffer_load_dwordx4 v[92:95], v112, s[12:15], s39 offen offset:2048 sc1
    buffer_load_dwordx4 v[96:99], v112, s[12:15], s39 offen offset:3072 sc1
    s_add_u32 s36, s36, 1
    s_cmp_gt_u32 s36, 0x100000
    s_cbranch_scc1 chain_kernel_wend
    s_waitcnt vmcnt(0)
    v_max_u32 v100, v88, v89
    v_max3_u32 v100, v100, v90, v91
    v_max3_u32 v100, v100, v92, v93
    v_max3_u32 v100, v100, v94, v95
    v_max3_u32 v100, v100, v96, v97
    v_max3_u32 v100, v100, v98, v99
    v_cmp_eq_u32 vcc, v108, v100
    s_cbranch_vccnz L_rbad_267
    v_add_f32 v100, v116, v88
    v_add_f32 v104, v92, v96
    v_add_f32 v101, v117, v89
    v_add_f32 v105, v93, v97
    v_add_f32 v102, v118, v90
    v_add_f32 v106, v94, v98
    v_add_f32 v103, v119, v91
    v_add_f32 v107, v95, v99
    v_add_f32 v100, v100, v104
    v_add_f32 v101, v101, v105
    v_add_f32 v102, v102, v106
    v_add_f32 v103, v103, v107
    v_add_f32 v104, v100, v101
    v_add_f32 v105, v102, v103
    v_cmp_u_f32 vcc, v104, v105
    s_branch L_rok_268
L_fl0_263:
    s_waitcnt lgkmcnt(0)
    s_nop 7
    s_add_u32 s38, s38, 0x1000
    s_and_b32 s38, s38, 0x7000
    s_cmp_eq_u32 s37, 0
    s_cselect_b32 s31, 0x40000000, s38
    s_nop 0
    s_add_u32 s29, s45, s31
    buffer_store_dwordx4 v[56:59], v112, s[12:15], s29 offen offset:1024 sc1
    s_add_u32 s29, s46, s31
    buffer_store_dwordx4 v[60:63], v112, s[12:15], s29 offen offset:2048 sc1
    s_add_u32 s29, s47, s31
    buffer_store_dwordx4 v[64:67], v112, s[12:15], s29 offen offset:3072 sc1
    buffer_store_dwordx4 v[108:111], v112, s[12:15], s7 offen offset:1024 sc1
    buffer_store_dwordx4 v[108:111], v112, s[12:15], s7 offen offset:2048 sc1
    buffer_store_dwordx4 v[108:111], v112, s[12:15], s7 offen offset:3072 sc1
    s_waitcnt vmcnt(0)
    v_add_f32 v100, v116, v88
    v_add_f32 v104, v92, v96
    v_add_f32 v101, v117, v89
    v_add_f32 v105, v93, v97
    v_add_f32 v102, v118, v90
    v_add_f32 v106, v94, v98
    v_add_f32 v103, v119, v91
    v_add_f32 v107, v95, v99
    v_add_f32 v100, v100, v104
    v_add_f32 v101, v101, v105
    v_add_f32 v102, v102, v106
    v_add_f32 v103, v103, v107
    v_add_f32 v104, v100, v101
    v_add_f32 v105, v102, v103
    v_cmp_u_f32 vcc, v104, v105
    s_nop 0
    s_nop 0
    s_cbranch_vccnz L_rbad_269
L_rok_270:
    ds_write_b128 v114, v[100:103]
    ds_read_b128 v[88:91], v113 offset:0
    s_waitcnt lgkmcnt(0)
    v_cvt_pk_bf16_f32 v100, 0, v88
    v_cvt_pk_bf16_f32 v101, 0, v89
    v_cvt_pk_bf16_f32 v102, 0, v90
    v_cvt_pk_bf16_f32 v103, 0, v91
    buffer_store_dwordx4 v[100:103], v124, s[16:19], s43 offen
    v_mov_b32 v116, v52
    v_mov_b32 v117, v53
    v_mov_b32 v118, v54
    v_mov_b32 v119, v55
    s_mov_b32 s7, s39
    s_add_u32 s39, s44, s31
    s_sub_u32 s43, s22, 3
    s_lshl_b32 s43, s43, 18
    s_cmp_eq_u32 s37, 0
    s_cselect_b32 s43, 0x7ff00000, s43
    buffer_load_dwordx4 v[88:91], v112, s[12:15], s39 offen offset:1024 sc1
    buffer_load_dwordx4 v[92:95], v112, s[12:15], s39 offen offset:2048 sc1
    buffer_load_dwordx4 v[96:99], v112, s[12:15], s39 offen offset:3072 sc1
    s_mov_b32 s37, 1
    buffer_store_dwordx4 v[108:111], v112, s[12:15], s7 offen offset:1024 sc1
    buffer_store_dwordx4 v[108:111], v112, s[12:15], s7 offen offset:2048 sc1
    buffer_store_dwordx4 v[108:111], v112, s[12:15], s7 offen offset:3072 sc1
    s_waitcnt vmcnt(0)
    v_add_f32 v100, v116, v88
    v_add_f32 v104, v92, v96
    v_add_f32 v101, v117, v89
    v_add_f32 v105, v93, v97
    v_add_f32 v102, v118, v90
    v_add_f32 v106, v94, v98
    v_add_f32 v103, v119, v91
    v_add_f32 v107, v95, v99
    v_add_f32 v100, v100, v104
    v_add_f32 v101, v101, v105
    v_add_f32 v102, v102, v106
    v_add_f32 v103, v103, v107
    v_add_f32 v104, v100, v101
    v_add_f32 v105, v102, v103
    v_cmp_u_f32 vcc, v104, v105
    s_nop 0
    s_nop 0
    s_cbranch_vccnz L_rbad_271
L_rok_272:
    ds_write_b128 v114, v[100:103]
    ds_read_b128 v[88:91], v113 offset:0
    s_waitcnt lgkmcnt(0)
    v_cvt_pk_bf16_f32 v100, 0, v88
    v_cvt_pk_bf16_f32 v101, 0, v89
    v_cvt_pk_bf16_f32 v102, 0, v90
    v_cvt_pk_bf16_f32 v103, 0, v91
    buffer_store_dwordx4 v[100:103], v124, s[16:19], s43 offen
    s_mov_b32 s7, s39
    buffer_store_dwordx4 v[108:111], v112, s[12:15], s7 offen offset:1024 sc1
    buffer_store_dwordx4 v[108:111], v112, s[12:15], s7 offen offset:2048 sc1
    buffer_store_dwordx4 v[108:111], v112, s[12:15], s7 offen offset:3072 sc1
    s_branch L_ste_264
L_rbad_269:
    buffer_load_dwordx4 v[88:91], v112, s[12:15], s39 offen offset:1024 sc1
    buffer_load_dwordx4 v[92:95], v112, s[12:15], s39 offen offset:2048 sc1
    buffer_load_dwordx4 v[96:99], v112, s[12:15], s39 offen offset:3072 sc1
    s_add_u32 s36, s36, 1
    s_cmp_gt_u32 s36, 0x100000
    s_cbranch_scc1 chain_kernel_wend
    s_waitcnt vmcnt(0)
    v_max_u32 v100, v88, v89
    v_max3_u32 v100, v100, v90, v91
    v_max3_u32 v100, v100, v92, v93
    v_max3_u32 v100, v100, v94, v95
    v_max3_u32 v100, v100, v96, v97
    v_max3_u32 v100, v100, v98, v99
    v_cmp_eq_u32 vcc, v108, v100
    s_cbranch_vccnz L_rbad_269
    v_add_f32 v100, v116, v88
    v_add_f32 v104, v92, v96
    v_add_f32 v101, v117, v89
    v_add_f32 v105, v93, v97
    v_add_f32 v102, v118, v90
    v_add_f32 v106, v94, v98
    v_add_f32 v103, v119, v91
    v_add_f32 v107, v95, v99
    v_add_f32 v100, v100, v104
    v_add_f32 v101, v101, v105
    v_add_f32 v102, v102, v106
    v_add_f32 v103, v103, v107
    v_add_f32 v104, v100, v101
    v_add_f32 v105, v102, v103
    v_cmp_u_f32 vcc, v104, v105
    s_branch L_rok_270
L_rbad_271:
    buffer_load_dwordx4 v[88:91], v112, s[12:15], s39 offen offset:1024 sc1
    buffer_load_dwordx4 v[92:95], v112, s[12:15], s39 offen offset:2048 sc1
    buffer_load_dwordx4 v[96:99], v112, s[12:15], s39 offen offset:3072 sc1
    s_add_u32 s36, s36, 1
    s_cmp_gt_u32 s36, 0x100000
    s_cbranch_scc1 chain_kernel_wend
    s_waitcnt vmcnt(0)
    v_max_u32 v100, v88, v89
    v_max3_u32 v100, v100, v90, v91
    v_max3_u32 v100, v100, v92, v93
    v_max3_u32 v100, v100, v94, v95
    v_max3_u32 v100, v100, v96, v97
    v_max3_u32 v100, v100, v98, v99
    v_cmp_eq_u32 vcc, v108, v100
    s_cbranch_vccnz L_rbad_271
    v_add_f32 v100, v116, v88
    v_add_f32 v104, v92, v96
    v_add_f32 v101, v117, v89
    v_add_f32 v105, v93, v97
    v_add_f32 v102, v118, v90
    v_add_f32 v106, v94, v98
    v_add_f32 v103, v119, v91
    v_add_f32 v107, v95, v99
    v_add_f32 v100, v100, v104
    v_add_f32 v101, v101, v105
    v_add_f32 v102, v102, v106
    v_add_f32 v103, v103, v107
    v_add_f32 v104, v100, v101
    v_add_f32 v105, v102, v103
    v_cmp_u_f32 vcc, v104, v105
    s_branch L_rok_272
L_ste_264:
    s_branch L_run_254
L_rdone_257:
chain_kernel_wend:
chain_kernel_end:
    s_endpgm
.section .rodata,"a"
.p2align 6
.amdhsa_kernel chain_kernel
  .amdhsa_next_free_vgpr 512
  .amdhsa_next_free_sgpr 102
  .amdhsa_accum_offset 256
  .amdhsa_group_segment_fixed_size 0
  .amdhsa_kernarg_size 152
  .amdhsa_user_sgpr_count 2
  .amdhsa_user_sgpr_kernarg_segment_ptr 1
  .amdhsa_system_sgpr_workgroup_id_x 1
  .amdhsa_float_denorm_mode_32 3
  .amdhsa_float_denorm_mode_16_64 3
.end_amdhsa_kernel
```

```asm
; @launch kernel=chain_kernel grid=(256,1,1) block=(256,1,1) lds=163840
.amdgcn_target "amdgcn-amd-amdhsa--gfx950"
.text
.globl chain_kernel
.p2align 8
.type chain_kernel,@function
chain_kernel:
    s_cmp_ge_u32 s2, 256
    s_cbranch_scc1 chain_kernel_end
    s_load_dwordx16 s[64:79], s[0:1], 0
    s_load_dwordx16 s[80:95], s[0:1], 64
    s_load_dwordx4 s[96:99], s[0:1], 128
    s_load_dwordx2 s[100:101], s[0:1], 144
    s_waitcnt lgkmcnt(0)
    s_getreg_b32 s16, hwreg(HW_REG_XCC_ID)
    s_and_b32 s16, s16, 7
    v_lshrrev_b32 v3, 6, v0
    s_mov_b32 s12, s98
    s_and_b32 s13, s99, 0xffff
    s_mov_b32 s14, 0x100
    s_mov_b32 s15, 0x00020000
    v_readfirstlane_b32 s18, v3
    s_lshl_b32 s3, s16, 5
    v_mov_b32 v12, 1
    v_lshlrev_b32 v13, 8, v0
    buffer_atomic_add v12, v13, s[12:15], s3 offen offset:24 sc0 sc1
    s_add_u32 s8, s100, 0x5000000
    s_addc_u32 s9, s101, 0
    s_and_b32 s9, s9, 0xffff
    s_mov_b32 s10, 0x180000
    s_mov_b32 s11, 0x00020000
    s_lshl_b32 s3, s2, 13
    v_lshlrev_b32 v1, 4, v0
    v_mov_b32 v4, 0xff81ff81
    v_mov_b32 v5, 0xff81ff81
    v_mov_b32 v6, 0xff81ff81
    v_mov_b32 v7, 0xff81ff81
    buffer_store_dwordx4 v[4:7], v1, s[8:11], s3 offen sc1
    s_add_u32 s3, s3, 4096
    buffer_store_dwordx4 v[4:7], v1, s[8:11], s3 offen sc1
    s_add_u32 s3, s3, 4096
    s_add_u32 s8, s100, 0x8000000
    s_addc_u32 s9, s101, 0
    s_and_b32 s9, s9, 0xffff
    s_mov_b32 s10, 0x4600000
    s_mov_b32 s11, 0x00020000
    s_add_u32 s4, s8, 0x1fffff
    s_and_b32 s4, s4, 0xffe00000
    s_sub_u32 s4, s4, s8
    s_add_u32 s8, s100, 0x5900000
    s_addc_u32 s9, s101, 0
    s_and_b32 s9, s9, 0xffff
    s_mov_b32 s10, 0x10000
    s_mov_b32 s11, 0x00020000
    s_lshl_b32 s3, s2, 12
    v_mov_b32 v8, 0
    v_mov_b32 v9, 0
    v_mov_b32 v10, 0
    v_mov_b32 v11, 0
    buffer_store_dwordx4 v[8:11], v1, s[8:11], s3 offen sc1
    s_cmp_lg_u32 s18, 1
    s_cbranch_scc1 L_role_1
    s_mov_b32 s7, 1
    s_cmp_ge_u32 s16, 4
    s_cbranch_scc1 L_rolew_2
    s_lshr_b32 s6, s2, 7
    s_lshl_b32 s6, s6, 8
    s_add_u32 s4, s4, s6
    s_and_b32 s5, s2, 127
    s_lshl_b32 s5, s5, 14
    s_add_u32 s5, s5, s4
    s_add_u32 s5, s5, 0xc000800
    s_add_u32 s12, s100, s5
    s_addc_u32 s13, s101, 0
    s_mov_b32 s5, 0
    s_mov_b32 s6, 0
    s_atomic_add s5, s[12:13], 0x0 glc
    s_atomic_add s6, s[12:13], 0x2000 glc
    s_mov_b32 s24, -1
    s_mov_b32 s25, -1
    s_waitcnt lgkmcnt(0)
    s_mov_b32 s5, 0
    s_memtime s[20:21]
    s_waitcnt lgkmcnt(0)
    s_atomic_add s5, s[12:13], 0x0 glc
    s_waitcnt lgkmcnt(0)
    s_memtime s[22:23]
    s_waitcnt lgkmcnt(0)
    s_sub_u32 s22, s22, s20
    s_min_u32 s24, s24, s22
    s_mov_b32 s5, 0
    s_memtime s[20:21]
    s_waitcnt lgkmcnt(0)
    s_atomic_add s5, s[12:13], 0x2000 glc
    s_waitcnt lgkmcnt(0)
    s_memtime s[22:23]
    s_waitcnt lgkmcnt(0)
    s_sub_u32 s22, s22, s20
    s_min_u32 s25, s25, s22
    s_cmp_lt_u32 s25, s24
    s_cselect_b32 s7, 0x10001, 1
L_rolew_2:
L_role_1:
    v_lshlrev_b32 v2, 2, v0
    s_waitcnt vmcnt(0)
    ds_write_b32 v2, v12 offset:0
    s_waitcnt lgkmcnt(0)
    s_barrier
    v_mov_b32 v2, 0
    ds_read_b32 v4, v2 offset:0
    s_waitcnt lgkmcnt(0)
    v_readfirstlane_b32 s17, v4
    s_cmp_lg_u32 s18, 1
    s_cbranch_scc1 L_nosig_3
    s_atomic_add s7, s[98:99], 0x0
L_nosig_3:
    s_cmp_ge_u32 s17, 32
    s_cbranch_scc1 chain_kernel_end
    s_cmp_ge_u32 s16, 4
    s_cbranch_scc1 chain_kernel_worker
    s_mov_b32 s8, s100
    s_and_b32 s9, s101, 0xffff
    s_mov_b32 s10, 0x10000000
    s_mov_b32 s11, 0x00020000
    s_mov_b32 s33, 0
    s_mov_b32 s24, 0xff00ff
    s_mov_b32 s25, 0xff00ff
    s_mov_b32 s26, 0xff00ff00
    s_mov_b32 s27, 0xff00ff00
    s_mov_b32 s28, 0x0
    s_mov_b32 s29, 0xff00ff
    s_mov_b32 s48, 0xffffffff
    s_mov_b32 s49, 0x0
    s_mov_b32 s50, 0xffff
    s_mov_b32 s51, 0x0
    s_mov_b32 s44, 0x3fb8aa3b
    s_mov_b32 s45, 0x3fb8aa3b
    s_mov_b32 s46, 0x3db504f3
    s_mov_b32 s47, 0x3db504f3
    s_mov_b32 s34, 0xff81ff81
    s_lshl_b32 s36, s16, 14
    s_add_u32 s36, s36, 0x5000000
    s_lshl_b32 s37, s16, 16
    s_add_u32 s37, s37, 0x5040000
    v_mov_b32 v36, s34
    v_mov_b32 v44, 0x3f803f80
    v_mov_b32 v37, s34
    v_mov_b32 v45, 0x3f803f80
    v_mov_b32 v38, s34
    v_mov_b32 v46, 0x3f803f80
    v_mov_b32 v39, s34
    v_mov_b32 v47, 0x3f803f80
    v_and_b32 v250, 63, v0
    v_and_b32 v248, 15, v0
    v_bfe_u32 v249, v0, 4, 2
    v_lshrrev_b32 v251, 6, v0
    v_lshlrev_b32 v1, 4, v250
    s_lshl_b32 s20, s16, 10
    s_lshl_b32 s21, s17, 5
    s_add_u32 s20, s20, s21
    s_and_b32 s30, s17, 3
    v_lshl_add_u32 v252, v251, 12, v1
    s_add_u32 s21, s30, 0
    s_and_b32 s21, s21, 3
    s_lshl_b32 s21, s21, 10
    v_add_u32 v2, s21, v252
    s_add_u32 s21, s30, 1
    s_and_b32 s21, s21, 3
    s_lshl_b32 s21, s21, 10
    v_add_u32 v3, s21, v252
    s_add_u32 s21, s30, 2
    s_and_b32 s21, s21, 3
    s_lshl_b32 s21, s21, 10
    v_add_u32 v4, s21, v252
    s_add_u32 s21, s30, 3
    s_and_b32 s21, s21, 3
    s_lshl_b32 s21, s21, 10
    v_add_u32 v5, s21, v252
    v_mov_b32 v6, 0x44444444
    v_mov_b32 v252, 0xeeeeeeee
    v_cndmask_b32 v6, v6, v252, s[26:27]
    v_bfe_u32 v252, v250, 1, 3
    v_and_b32 v253, 1, v250
    v_lshlrev_b32 v33, 11, v252
    v_lshl_add_u32 v33, v253, 3, v33
    v_lshl_add_u32 v33, v249, 4, v33
    s_xor_b32 s22, s17, 8
    s_lshl_b32 s21, s22, 6
    v_add_u32 v33, s21, v33
    v_lshlrev_b32 v8, 3, v250
    s_xor_b32 s21, s17, 2
    s_lshl_b32 s21, s21, 9
    v_add_u32 v28, s21, v8
    s_lshl_b32 s22, s22, 9
    v_add_u32 v8, s22, v8
    v_lshlrev_b32 v11, 4, v248
    v_lshl_add_u32 v11, v249, 7, v11
    v_add_u32 v11, s21, v11
    s_lshr_b32 s22, s17, 2
    s_lshl_b32 s22, s22, 13
    s_add_u32 s21, s17, 0
    s_and_b32 s21, s21, 3
    s_lshl_b32 s21, s21, 10
    s_add_u32 s21, s21, s22
    v_add_u32 v9, s21, v1
    s_add_u32 s21, s17, 1
    s_and_b32 s21, s21, 3
    s_lshl_b32 s21, s21, 10
    s_add_u32 s21, s21, s22
    v_add_u32 v13, s21, v1
    s_add_u32 s21, s17, 2
    s_and_b32 s21, s21, 3
    s_lshl_b32 s21, s21, 10
    s_add_u32 s21, s21, s22
    v_add_u32 v14, s21, v1
    s_add_u32 s21, s17, 3
    s_and_b32 s21, s21, 3
    s_lshl_b32 s21, s21, 10
    s_add_u32 s21, s21, s22
    v_add_u32 v15, s21, v1
    s_add_u32 s22, s22, 4096
    v_add_u32 v16, s22, v1
    s_and_b32 s21, s17, 3
    s_lshl_b32 s21, s21, 8
    s_add_u32 s21, s21, s22
    v_and_b32 v253, 1, v249
    v_lshlrev_b32 v10, 4, v248
    v_lshl_add_u32 v10, v253, 7, v10
    v_add_u32 v10, s21, v10
    v_lshl_add_u32 v20, v251, 11, v1
    v_lshrrev_b32 v252, 1, v249
    v_lshl_add_u32 v252, v251, 1, v252
    v_lshlrev_b32 v21, 10, v252
    v_lshl_add_u32 v21, v248, 5, v21
    v_lshl_add_u32 v21, v253, 4, v21
    v_add_u32 v21, 8192, v21
    v_lshlrev_b32 v22, 5, v248
    v_lshl_add_u32 v22, v249, 3, v22
    v_add_u32 v22, 8192, v22
    v_lshrrev_b32 v253, 2, v248
    v_and_b32 v252, 3, v248
    v_lshl_add_u32 v253, v253, 3, v252
    v_add_u32 v25, 24576, v1
    v_add_u32 v26, 26624, v1
    v_lshlrev_b32 v32, 4, v253
    v_lshl_add_u32 v29, v249, 9, v32
    v_lshl_add_u32 v32, v249, 2, v32
    v_add_u32 v32, 33792, v32
    s_add_u32 s21, s16, 0
    s_and_b32 s21, s21, 3
    s_lshl_b32 s21, s21, 18
    s_lshr_b32 s22, s17, 1
    s_lshl_b32 s22, s22, 14
    s_add_u32 s21, s21, s22
    s_and_b32 s22, s17, 1
    s_lshl_b32 s22, s22, 12
    s_add_u32 s23, s21, s22
    v_add_u32 v12, s23, v1
    s_add_u32 s21, s16, 1
    s_and_b32 s21, s21, 3
    s_lshl_b32 s21, s21, 18
    s_lshr_b32 s22, s17, 1
    s_lshl_b32 s22, s22, 14
    s_add_u32 s21, s21, s22
    s_and_b32 s22, s17, 1
    s_lshl_b32 s22, s22, 12
    s_add_u32 s21, s21, s22
    v_add_u32 v17, s21, v1
    s_add_u32 s21, s16, 2
    s_and_b32 s21, s21, 3
    s_lshl_b32 s21, s21, 18
    s_lshr_b32 s22, s17, 1
    s_lshl_b32 s22, s22, 14
    s_add_u32 s21, s21, s22
    s_and_b32 s22, s17, 1
    s_lshl_b32 s22, s22, 12
    s_add_u32 s21, s21, s22
    v_add_u32 v18, s21, v1
    s_add_u32 s21, s16, 3
    s_and_b32 s21, s21, 3
    s_lshl_b32 s21, s21, 18
    s_lshr_b32 s22, s17, 1
    s_lshl_b32 s22, s22, 14
    s_add_u32 s21, s21, s22
    s_and_b32 s22, s17, 1
    s_lshl_b32 s22, s22, 12
    s_add_u32 s21, s21, s22
    v_add_u32 v19, s21, v1
    s_xor_b32 s21, s23, 0x4000
    v_add_u32 v29, s21, v29
    v_add_u32 v31, s21, v1
    v_and_b32 v253, 8, v248
    v_add_u32 v253, v253, v248
    v_lshlrev_b32 v27, 4, v253
    v_lshl_add_u32 v27, v249, 9, v27
    v_add_u32 v27, s23, v27
    v_bfe_u32 v253, v248, 2, 1
    v_lshl_add_u32 v252, v252, 1, v253
    v_cndmask_b32 v252, v248, v252, s[26:27]
    v_lshlrev_b32 v30, 4, v252
    v_lshl_add_u32 v30, v249, 7, v30
    v_add_u32 v30, s23, v30
    v_and_b32 v253, 1, v252
    v_lshlrev_b32 v253, 4, v253
    v_mov_b32 v254, 0x3f80
    v_lshlrev_b32 v254, v253, v254
    v_lshrrev_b32 v253, 2, v252
    v_xor_b32 v253, v253, v249
    v_and_b32 v253, 1, v253
    v_bfe_u32 v252, v252, 1, 1
    v_lshl_add_u32 v252, v253, 2, v252
    v_lshrrev_b32 v253, 3, v248
    v_lshl_add_u32 v252, v253, 1, v252
    v_cmp_eq_u32 vcc, 0, v252
    s_nop 1
    v_cndmask_b32 v40, 0, v254, vcc
    v_cmp_eq_u32 vcc, 1, v252
    s_nop 1
    v_cndmask_b32 v41, 0, v254, vcc
    v_cmp_eq_u32 vcc, 2, v252
    s_nop 1
    v_cndmask_b32 v42, 0, v254, vcc
    v_cmp_eq_u32 vcc, 3, v252
    s_nop 1
    v_cndmask_b32 v43, 0, v254, vcc
    v_bfe_u32 v248, v0, 4, 2
    v_lshlrev_b32 v250, 1, v248
    v_bfe_u32 v248, v0, 2, 1
    v_add_u32 v250, v250, v248
    v_bfe_u32 v248, v0, 3, 1
    v_lshl_add_u32 v250, v248, 3, v250
    v_lshrrev_b32 v248, 6, v0
    v_lshl_add_u32 v250, v248, 8, v250
    v_and_b32 v249, 3, v0
    v_lshlrev_b32 v251, 13, v250
    v_lshl_add_u32 v251, v249, 4, v251
    s_lshl_b32 s21, s20, 1
    v_add_u32 v251, s21, v251
    s_lshl_b32 s21, s16, 10
    v_add_u32 v252, s21, v250
    v_lshlrev_b32 v252, 11, v252
    v_lshl_add_u32 v252, v249, 4, v252
    s_xor_b32 s21, s17, 8
    s_lshl_b32 s21, s21, 6
    v_add_u32 v252, s21, v252
    v_bfe_u32 v248, v0, 4, 2
    v_lshlrev_b32 v248, 3, v248
    v_bfe_u32 v242, v0, 2, 2
    v_add_u32 v248, v248, v242
    v_lshlrev_b32 v242, 6, v248
    v_lshrrev_b32 v248, 6, v0
    v_lshl_add_u32 v242, v248, 14, v242
    v_lshl_add_u32 v240, v249, 3, v242
    v_and_b32 v241, 2, v249
    v_lshl_add_u32 v240, v241, 3, v240
    v_lshl_add_u32 v242, v249, 4, v242
    v_add_u32 v241, 0x10000, v240
    v_add_u32 v243, 0x10000, v242
    v_lshl_add_u32 v244, v248, 14, v1
    v_add_u32 v245, 0x10000, v244
    s_lshl_b32 s22, s18, 14
    s_add_u32 s22, s22, 32768
    v_xor_b32 v253, 128, v251
    s_mov_b32 s12, s88
    s_and_b32 s13, s89, 0xffff
    s_mov_b32 s14, 0x800000
    s_mov_b32 s15, 0x00020000
    s_add_u32 m0, s22, 0
    s_add_u32 s23, s30, 0
    s_and_b32 s23, s23, 3
    s_lshl_b32 s23, s23, 2
    s_add_u32 s23, s23, 0
    s_mul_i32 s23, s23, 131072
    buffer_load_dwordx4 v251, s[12:15], s23 offen lds
    s_add_u32 m0, s22, 1024
    s_add_u32 s23, s30, 0
    s_and_b32 s23, s23, 3
    s_lshl_b32 s23, s23, 2
    s_add_u32 s23, s23, 1
    s_mul_i32 s23, s23, 131072
    buffer_load_dwordx4 v251, s[12:15], s23 offen lds
    s_add_u32 m0, s22, 2048
    s_add_u32 s23, s30, 0
    s_and_b32 s23, s23, 3
    s_lshl_b32 s23, s23, 2
    s_add_u32 s23, s23, 2
    s_mul_i32 s23, s23, 131072
    buffer_load_dwordx4 v251, s[12:15], s23 offen lds
    s_add_u32 m0, s22, 3072
    s_add_u32 s23, s30, 0
    s_and_b32 s23, s23, 3
    s_lshl_b32 s23, s23, 2
    s_add_u32 s23, s23, 3
    s_mul_i32 s23, s23, 131072
    buffer_load_dwordx4 v251, s[12:15], s23 offen lds
    s_add_u32 m0, s22, 4096
    s_add_u32 s23, s30, 1
    s_and_b32 s23, s23, 3
    s_lshl_b32 s23, s23, 2
    s_add_u32 s23, s23, 0
    s_mul_i32 s23, s23, 131072
    buffer_load_dwordx4 v251, s[12:15], s23 offen lds
    s_add_u32 m0, s22, 5120
    s_add_u32 s23, s30, 1
    s_and_b32 s23, s23, 3
    s_lshl_b32 s23, s23, 2
    s_add_u32 s23, s23, 1
    s_mul_i32 s23, s23, 131072
    buffer_load_dwordx4 v251, s[12:15], s23 offen lds
    s_add_u32 m0, s22, 6144
    s_add_u32 s23, s30, 1
    s_and_b32 s23, s23, 3
    s_lshl_b32 s23, s23, 2
    s_add_u32 s23, s23, 2
    s_mul_i32 s23, s23, 131072
    buffer_load_dwordx4 v251, s[12:15], s23 offen lds
    s_add_u32 m0, s22, 7168
    s_add_u32 s23, s30, 1
    s_and_b32 s23, s23, 3
    s_lshl_b32 s23, s23, 2
    s_add_u32 s23, s23, 3
    s_mul_i32 s23, s23, 131072
    buffer_load_dwordx4 v251, s[12:15], s23 offen lds
    s_add_u32 m0, s22, 8192
    s_add_u32 s23, s30, 2
    s_and_b32 s23, s23, 3
    s_lshl_b32 s23, s23, 2
    s_add_u32 s23, s23, 0
    s_mul_i32 s23, s23, 131072
    buffer_load_dwordx4 v251, s[12:15], s23 offen lds
    s_add_u32 m0, s22, 9216
    s_add_u32 s23, s30, 2
    s_and_b32 s23, s23, 3
    s_lshl_b32 s23, s23, 2
    s_add_u32 s23, s23, 1
    s_mul_i32 s23, s23, 131072
    buffer_load_dwordx4 v251, s[12:15], s23 offen lds
    s_add_u32 m0, s22, 10240
    s_add_u32 s23, s30, 2
    s_and_b32 s23, s23, 3
    s_lshl_b32 s23, s23, 2
    s_add_u32 s23, s23, 2
    s_mul_i32 s23, s23, 131072
    buffer_load_dwordx4 v251, s[12:15], s23 offen lds
    s_add_u32 m0, s22, 11264
    s_add_u32 s23, s30, 2
    s_and_b32 s23, s23, 3
    s_lshl_b32 s23, s23, 2
    s_add_u32 s23, s23, 3
    s_mul_i32 s23, s23, 131072
    buffer_load_dwordx4 v251, s[12:15], s23 offen lds
    s_add_u32 m0, s22, 12288
    s_add_u32 s23, s30, 3
    s_and_b32 s23, s23, 3
    s_lshl_b32 s23, s23, 2
    s_add_u32 s23, s23, 0
    s_mul_i32 s23, s23, 131072
    buffer_load_dwordx4 v251, s[12:15], s23 offen lds
    s_add_u32 m0, s22, 13312
    s_add_u32 s23, s30, 3
    s_and_b32 s23, s23, 3
    s_lshl_b32 s23, s23, 2
    s_add_u32 s23, s23, 1
    s_mul_i32 s23, s23, 131072
    buffer_load_dwordx4 v251, s[12:15], s23 offen lds
    s_add_u32 m0, s22, 14336
    s_add_u32 s23, s30, 3
    s_and_b32 s23, s23, 3
    s_lshl_b32 s23, s23, 2
    s_add_u32 s23, s23, 2
    s_mul_i32 s23, s23, 131072
    buffer_load_dwordx4 v251, s[12:15], s23 offen lds
    s_add_u32 m0, s22, 15360
    s_add_u32 s23, s30, 3
    s_and_b32 s23, s23, 3
    s_lshl_b32 s23, s23, 2
    s_add_u32 s23, s23, 3
    s_mul_i32 s23, s23, 131072
    buffer_load_dwordx4 v251, s[12:15], s23 offen lds
    s_mov_b32 s12, s90
    s_and_b32 s13, s91, 0xffff
    s_mov_b32 s14, 0x800000
    s_mov_b32 s15, 0x00020000
    s_add_u32 m0, s22, 65536
    s_add_u32 s23, s30, 0
    s_and_b32 s23, s23, 3
    s_lshl_b32 s23, s23, 2
    s_add_u32 s23, s23, 0
    s_mul_i32 s23, s23, 131072
    buffer_load_dwordx4 v253, s[12:15], s23 offen lds
    s_add_u32 m0, s22, 66560
    s_add_u32 s23, s30, 0
    s_and_b32 s23, s23, 3
    s_lshl_b32 s23, s23, 2
    s_add_u32 s23, s23, 1
    s_mul_i32 s23, s23, 131072
    buffer_load_dwordx4 v253, s[12:15], s23 offen lds
    s_add_u32 m0, s22, 67584
    s_add_u32 s23, s30, 0
    s_and_b32 s23, s23, 3
    s_lshl_b32 s23, s23, 2
    s_add_u32 s23, s23, 2
    s_mul_i32 s23, s23, 131072
    buffer_load_dwordx4 v253, s[12:15], s23 offen lds
    s_add_u32 m0, s22, 68608
    s_add_u32 s23, s30, 0
    s_and_b32 s23, s23, 3
    s_lshl_b32 s23, s23, 2
    s_add_u32 s23, s23, 3
    s_mul_i32 s23, s23, 131072
    buffer_load_dwordx4 v253, s[12:15], s23 offen lds
    s_add_u32 m0, s22, 69632
    s_add_u32 s23, s30, 1
    s_and_b32 s23, s23, 3
    s_lshl_b32 s23, s23, 2
    s_add_u32 s23, s23, 0
    s_mul_i32 s23, s23, 131072
    buffer_load_dwordx4 v253, s[12:15], s23 offen lds
    s_add_u32 m0, s22, 70656
    s_add_u32 s23, s30, 1
    s_and_b32 s23, s23, 3
    s_lshl_b32 s23, s23, 2
    s_add_u32 s23, s23, 1
    s_mul_i32 s23, s23, 131072
    buffer_load_dwordx4 v253, s[12:15], s23 offen lds
    s_add_u32 m0, s22, 71680
    s_add_u32 s23, s30, 1
    s_and_b32 s23, s23, 3
    s_lshl_b32 s23, s23, 2
    s_add_u32 s23, s23, 2
    s_mul_i32 s23, s23, 131072
    buffer_load_dwordx4 v253, s[12:15], s23 offen lds
    s_add_u32 m0, s22, 72704
    s_add_u32 s23, s30, 1
    s_and_b32 s23, s23, 3
    s_lshl_b32 s23, s23, 2
    s_add_u32 s23, s23, 3
    s_mul_i32 s23, s23, 131072
    buffer_load_dwordx4 v253, s[12:15], s23 offen lds
    s_add_u32 m0, s22, 73728
    s_add_u32 s23, s30, 2
    s_and_b32 s23, s23, 3
    s_lshl_b32 s23, s23, 2
    s_add_u32 s23, s23, 0
    s_mul_i32 s23, s23, 131072
    buffer_load_dwordx4 v253, s[12:15], s23 offen lds
    s_add_u32 m0, s22, 74752
    s_add_u32 s23, s30, 2
    s_and_b32 s23, s23, 3
    s_lshl_b32 s23, s23, 2
    s_add_u32 s23, s23, 1
    s_mul_i32 s23, s23, 131072
    buffer_load_dwordx4 v253, s[12:15], s23 offen lds
    s_add_u32 m0, s22, 75776
    s_add_u32 s23, s30, 2
    s_and_b32 s23, s23, 3
    s_lshl_b32 s23, s23, 2
    s_add_u32 s23, s23, 2
    s_mul_i32 s23, s23, 131072
    buffer_load_dwordx4 v253, s[12:15], s23 offen lds
    s_add_u32 m0, s22, 76800
    s_add_u32 s23, s30, 2
    s_and_b32 s23, s23, 3
    s_lshl_b32 s23, s23, 2
    s_add_u32 s23, s23, 3
    s_mul_i32 s23, s23, 131072
    buffer_load_dwordx4 v253, s[12:15], s23 offen lds
    s_add_u32 m0, s22, 77824
    s_add_u32 s23, s30, 3
    s_and_b32 s23, s23, 3
    s_lshl_b32 s23, s23, 2
    s_add_u32 s23, s23, 0
    s_mul_i32 s23, s23, 131072
    buffer_load_dwordx4 v253, s[12:15], s23 offen lds
    s_add_u32 m0, s22, 78848
    s_add_u32 s23, s30, 3
    s_and_b32 s23, s23, 3
    s_lshl_b32 s23, s23, 2
    s_add_u32 s23, s23, 1
    s_mul_i32 s23, s23, 131072
    buffer_load_dwordx4 v253, s[12:15], s23 offen lds
    s_add_u32 m0, s22, 79872
    s_add_u32 s23, s30, 3
    s_and_b32 s23, s23, 3
    s_lshl_b32 s23, s23, 2
    s_add_u32 s23, s23, 2
    s_mul_i32 s23, s23, 131072
    buffer_load_dwordx4 v253, s[12:15], s23 offen lds
    s_add_u32 m0, s22, 80896
    s_add_u32 s23, s30, 3
    s_and_b32 s23, s23, 3
    s_lshl_b32 s23, s23, 2
    s_add_u32 s23, s23, 3
    s_mul_i32 s23, s23, 131072
    buffer_load_dwordx4 v253, s[12:15], s23 offen lds
    s_mov_b32 s12, s86
    s_and_b32 s13, s87, 0xffff
    s_mov_b32 s14, 0x800000
    s_mov_b32 s15, 0x00020000
    s_add_u32 s23, s30, 0
    s_and_b32 s23, s23, 3
    s_lshl_b32 s23, s23, 2
    s_add_u32 s23, s23, 0
    s_mul_i32 s23, s23, 131072
    buffer_load_dwordx4 v[112:115], v251, s[12:15], s23 offen
    s_add_u32 s23, s30, 0
    s_and_b32 s23, s23, 3
    s_lshl_b32 s23, s23, 2
    s_add_u32 s23, s23, 1
    s_mul_i32 s23, s23, 131072
    buffer_load_dwordx4 v[116:119], v251, s[12:15], s23 offen
    s_add_u32 s23, s30, 0
    s_and_b32 s23, s23, 3
    s_lshl_b32 s23, s23, 2
    s_add_u32 s23, s23, 2
    s_mul_i32 s23, s23, 131072
    buffer_load_dwordx4 v[120:123], v251, s[12:15], s23 offen
    s_add_u32 s23, s30, 0
    s_and_b32 s23, s23, 3
    s_lshl_b32 s23, s23, 2
    s_add_u32 s23, s23, 3
    s_mul_i32 s23, s23, 131072
    buffer_load_dwordx4 v[124:127], v251, s[12:15], s23 offen
    s_add_u32 s23, s30, 1
    s_and_b32 s23, s23, 3
    s_lshl_b32 s23, s23, 2
    s_add_u32 s23, s23, 0
    s_mul_i32 s23, s23, 131072
    buffer_load_dwordx4 v[128:131], v251, s[12:15], s23 offen
    s_add_u32 s23, s30, 1
    s_and_b32 s23, s23, 3
    s_lshl_b32 s23, s23, 2
    s_add_u32 s23, s23, 1
    s_mul_i32 s23, s23, 131072
    buffer_load_dwordx4 v[132:135], v251, s[12:15], s23 offen
    s_add_u32 s23, s30, 1
    s_and_b32 s23, s23, 3
    s_lshl_b32 s23, s23, 2
    s_add_u32 s23, s23, 2
    s_mul_i32 s23, s23, 131072
    buffer_load_dwordx4 v[136:139], v251, s[12:15], s23 offen
    s_add_u32 s23, s30, 1
    s_and_b32 s23, s23, 3
    s_lshl_b32 s23, s23, 2
    s_add_u32 s23, s23, 3
    s_mul_i32 s23, s23, 131072
    buffer_load_dwordx4 v[140:143], v251, s[12:15], s23 offen
    s_add_u32 s23, s30, 2
    s_and_b32 s23, s23, 3
    s_lshl_b32 s23, s23, 2
    s_add_u32 s23, s23, 0
    s_mul_i32 s23, s23, 131072
    buffer_load_dwordx4 v[144:147], v251, s[12:15], s23 offen
    s_add_u32 s23, s30, 2
    s_and_b32 s23, s23, 3
    s_lshl_b32 s23, s23, 2
    s_add_u32 s23, s23, 1
    s_mul_i32 s23, s23, 131072
    buffer_load_dwordx4 v[148:151], v251, s[12:15], s23 offen
    s_add_u32 s23, s30, 2
    s_and_b32 s23, s23, 3
    s_lshl_b32 s23, s23, 2
    s_add_u32 s23, s23, 2
    s_mul_i32 s23, s23, 131072
    buffer_load_dwordx4 v[152:155], v251, s[12:15], s23 offen
    s_add_u32 s23, s30, 2
    s_and_b32 s23, s23, 3
    s_lshl_b32 s23, s23, 2
    s_add_u32 s23, s23, 3
    s_mul_i32 s23, s23, 131072
    buffer_load_dwordx4 v[156:159], v251, s[12:15], s23 offen
    s_add_u32 s23, s30, 3
    s_and_b32 s23, s23, 3
    s_lshl_b32 s23, s23, 2
    s_add_u32 s23, s23, 0
    s_mul_i32 s23, s23, 131072
    buffer_load_dwordx4 v[160:163], v251, s[12:15], s23 offen
    s_add_u32 s23, s30, 3
    s_and_b32 s23, s23, 3
    s_lshl_b32 s23, s23, 2
    s_add_u32 s23, s23, 1
    s_mul_i32 s23, s23, 131072
    buffer_load_dwordx4 v[164:167], v251, s[12:15], s23 offen
    s_add_u32 s23, s30, 3
    s_and_b32 s23, s23, 3
    s_lshl_b32 s23, s23, 2
    s_add_u32 s23, s23, 2
    s_mul_i32 s23, s23, 131072
    buffer_load_dwordx4 v[168:171], v251, s[12:15], s23 offen
    s_add_u32 s23, s30, 3
    s_and_b32 s23, s23, 3
    s_lshl_b32 s23, s23, 2
    s_add_u32 s23, s23, 3
    s_mul_i32 s23, s23, 131072
    buffer_load_dwordx4 v[172:175], v251, s[12:15], s23 offen
    s_waitcnt vmcnt(32)
    s_mov_b32 s12, s92
    s_and_b32 s13, s93, 0xffff
    s_mov_b32 s14, 0x800000
    s_mov_b32 s15, 0x00020000
    s_add_u32 s23, s30, 0
    s_and_b32 s23, s23, 3
    s_lshl_b32 s23, s23, 2
    s_add_u32 s23, s23, 0
    s_mul_i32 s23, s23, 32768
    buffer_load_dwordx4 v[48:51], v252, s[12:15], s23 offen
    s_add_u32 s23, s30, 0
    s_and_b32 s23, s23, 3
    s_lshl_b32 s23, s23, 2
    s_add_u32 s23, s23, 1
    s_mul_i32 s23, s23, 32768
    buffer_load_dwordx4 v[52:55], v252, s[12:15], s23 offen
    s_add_u32 s23, s30, 0
    s_and_b32 s23, s23, 3
    s_lshl_b32 s23, s23, 2
    s_add_u32 s23, s23, 2
    s_mul_i32 s23, s23, 32768
    buffer_load_dwordx4 v[56:59], v252, s[12:15], s23 offen
    s_add_u32 s23, s30, 0
    s_and_b32 s23, s23, 3
    s_lshl_b32 s23, s23, 2
    s_add_u32 s23, s23, 3
    s_mul_i32 s23, s23, 32768
    buffer_load_dwordx4 v[60:63], v252, s[12:15], s23 offen
    s_add_u32 s23, s30, 1
    s_and_b32 s23, s23, 3
    s_lshl_b32 s23, s23, 2
    s_add_u32 s23, s23, 0
    s_mul_i32 s23, s23, 32768
    buffer_load_dwordx4 v[64:67], v252, s[12:15], s23 offen
    s_add_u32 s23, s30, 1
    s_and_b32 s23, s23, 3
    s_lshl_b32 s23, s23, 2
    s_add_u32 s23, s23, 1
    s_mul_i32 s23, s23, 32768
    buffer_load_dwordx4 v[68:71], v252, s[12:15], s23 offen
    s_add_u32 s23, s30, 1
    s_and_b32 s23, s23, 3
    s_lshl_b32 s23, s23, 2
    s_add_u32 s23, s23, 2
    s_mul_i32 s23, s23, 32768
    buffer_load_dwordx4 v[72:75], v252, s[12:15], s23 offen
    s_add_u32 s23, s30, 1
    s_and_b32 s23, s23, 3
    s_lshl_b32 s23, s23, 2
    s_add_u32 s23, s23, 3
    s_mul_i32 s23, s23, 32768
    buffer_load_dwordx4 v[76:79], v252, s[12:15], s23 offen
    s_add_u32 s23, s30, 2
    s_and_b32 s23, s23, 3
    s_lshl_b32 s23, s23, 2
    s_add_u32 s23, s23, 0
    s_mul_i32 s23, s23, 32768
    buffer_load_dwordx4 v[80:83], v252, s[12:15], s23 offen
    s_add_u32 s23, s30, 2
    s_and_b32 s23, s23, 3
    s_lshl_b32 s23, s23, 2
    s_add_u32 s23, s23, 1
    s_mul_i32 s23, s23, 32768
    buffer_load_dwordx4 v[84:87], v252, s[12:15], s23 offen
    s_add_u32 s23, s30, 2
    s_and_b32 s23, s23, 3
    s_lshl_b32 s23, s23, 2
    s_add_u32 s23, s23, 2
    s_mul_i32 s23, s23, 32768
    buffer_load_dwordx4 v[88:91], v252, s[12:15], s23 offen
    s_add_u32 s23, s30, 2
    s_and_b32 s23, s23, 3
    s_lshl_b32 s23, s23, 2
    s_add_u32 s23, s23, 3
    s_mul_i32 s23, s23, 32768
    buffer_load_dwordx4 v[92:95], v252, s[12:15], s23 offen
    s_add_u32 s23, s30, 3
    s_and_b32 s23, s23, 3
    s_lshl_b32 s23, s23, 2
    s_add_u32 s23, s23, 0
    s_mul_i32 s23, s23, 32768
    buffer_load_dwordx4 v[96:99], v252, s[12:15], s23 offen
    s_add_u32 s23, s30, 3
    s_and_b32 s23, s23, 3
    s_lshl_b32 s23, s23, 2
    s_add_u32 s23, s23, 1
    s_mul_i32 s23, s23, 32768
    buffer_load_dwordx4 v[100:103], v252, s[12:15], s23 offen
    s_add_u32 s23, s30, 3
    s_and_b32 s23, s23, 3
    s_lshl_b32 s23, s23, 2
    s_add_u32 s23, s23, 2
    s_mul_i32 s23, s23, 32768
    buffer_load_dwordx4 v[104:107], v252, s[12:15], s23 offen
    s_add_u32 s23, s30, 3
    s_and_b32 s23, s23, 3
    s_lshl_b32 s23, s23, 2
    s_add_u32 s23, s23, 3
    s_mul_i32 s23, s23, 32768
    buffer_load_dwordx4 v[108:111], v252, s[12:15], s23 offen
    ds_read_b64_tr_b16 a[64:65], v240 offset:32768
    ds_read_b64_tr_b16 a[66:67], v240 offset:33024
    ds_read_b64_tr_b16 a[68:69], v240 offset:34816
    ds_read_b64_tr_b16 a[70:71], v240 offset:35072
    ds_read_b64_tr_b16 a[96:97], v240 offset:32784
    ds_read_b64_tr_b16 a[98:99], v240 offset:33040
    ds_read_b64_tr_b16 a[100:101], v240 offset:34832
    ds_read_b64_tr_b16 a[102:103], v240 offset:35088
    s_waitcnt lgkmcnt(0)
    ds_read_b64_tr_b16 a[72:73], v240 offset:36864
    ds_read_b64_tr_b16 a[74:75], v240 offset:37120
    ds_read_b64_tr_b16 a[76:77], v240 offset:38912
    ds_read_b64_tr_b16 a[78:79], v240 offset:39168
    ds_read_b64_tr_b16 a[104:105], v240 offset:36880
    ds_read_b64_tr_b16 a[106:107], v240 offset:37136
    ds_read_b64_tr_b16 a[108:109], v240 offset:38928
    ds_read_b64_tr_b16 a[110:111], v240 offset:39184
    s_waitcnt lgkmcnt(0)
    ds_read_b64_tr_b16 a[80:81], v240 offset:40960
    ds_read_b64_tr_b16 a[82:83], v240 offset:41216
    ds_read_b64_tr_b16 a[84:85], v240 offset:43008
    ds_read_b64_tr_b16 a[86:87], v240 offset:43264
    ds_read_b64_tr_b16 a[112:113], v240 offset:40976
    ds_read_b64_tr_b16 a[114:115], v240 offset:41232
    ds_read_b64_tr_b16 a[116:117], v240 offset:43024
    ds_read_b64_tr_b16 a[118:119], v240 offset:43280
    s_waitcnt lgkmcnt(0)
    ds_read_b64_tr_b16 a[88:89], v240 offset:45056
    ds_read_b64_tr_b16 a[90:91], v240 offset:45312
    ds_read_b64_tr_b16 a[92:93], v240 offset:47104
    ds_read_b64_tr_b16 a[94:95], v240 offset:47360
    ds_read_b64_tr_b16 a[120:121], v240 offset:45072
    ds_read_b64_tr_b16 a[122:123], v240 offset:45328
    ds_read_b64_tr_b16 a[124:125], v240 offset:47120
    ds_read_b64_tr_b16 a[126:127], v240 offset:47376
    s_waitcnt lgkmcnt(0)
    s_waitcnt vmcnt(32)
    ds_read_b64_tr_b16 a[128:129], v243 offset:32768
    ds_read_b64_tr_b16 a[130:131], v243 offset:33024
    ds_read_b64_tr_b16 a[132:133], v243 offset:34816
    ds_read_b64_tr_b16 a[134:135], v243 offset:35072
    ds_read_b64_tr_b16 a[160:161], v243 offset:32776
    ds_read_b64_tr_b16 a[162:163], v243 offset:33032
    ds_read_b64_tr_b16 a[164:165], v243 offset:34824
    ds_read_b64_tr_b16 a[166:167], v243 offset:35080
    s_waitcnt lgkmcnt(0)
    ds_read_b64_tr_b16 a[136:137], v243 offset:36864
    ds_read_b64_tr_b16 a[138:139], v243 offset:37120
    ds_read_b64_tr_b16 a[140:141], v243 offset:38912
    ds_read_b64_tr_b16 a[142:143], v243 offset:39168
    ds_read_b64_tr_b16 a[168:169], v243 offset:36872
    ds_read_b64_tr_b16 a[170:171], v243 offset:37128
    ds_read_b64_tr_b16 a[172:173], v243 offset:38920
    ds_read_b64_tr_b16 a[174:175], v243 offset:39176
    s_waitcnt lgkmcnt(0)
    ds_read_b64_tr_b16 a[144:145], v243 offset:40960
    ds_read_b64_tr_b16 a[146:147], v243 offset:41216
    ds_read_b64_tr_b16 a[148:149], v243 offset:43008
    ds_read_b64_tr_b16 a[150:151], v243 offset:43264
    ds_read_b64_tr_b16 a[176:177], v243 offset:40968
    ds_read_b64_tr_b16 a[178:179], v243 offset:41224
    ds_read_b64_tr_b16 a[180:181], v243 offset:43016
    ds_read_b64_tr_b16 a[182:183], v243 offset:43272
    s_waitcnt lgkmcnt(0)
    ds_read_b64_tr_b16 a[152:153], v243 offset:45056
    ds_read_b64_tr_b16 a[154:155], v243 offset:45312
    ds_read_b64_tr_b16 a[156:157], v243 offset:47104
    ds_read_b64_tr_b16 a[158:159], v243 offset:47360
    ds_read_b64_tr_b16 a[184:185], v243 offset:45064
    ds_read_b64_tr_b16 a[186:187], v243 offset:45320
    ds_read_b64_tr_b16 a[188:189], v243 offset:47112
    ds_read_b64_tr_b16 a[190:191], v243 offset:47368
    s_waitcnt lgkmcnt(0)
    s_waitcnt vmcnt(16)
    ds_write_b128 v244, v[112:115] offset:32768
    ds_write_b128 v244, v[116:119] offset:33792
    ds_write_b128 v244, v[120:123] offset:34816
    ds_write_b128 v244, v[124:127] offset:35840
    ds_write_b128 v244, v[128:131] offset:36864
    ds_write_b128 v244, v[132:135] offset:37888
    ds_write_b128 v244, v[136:139] offset:38912
    ds_write_b128 v244, v[140:143] offset:39936
    ds_write_b128 v244, v[144:147] offset:40960
    ds_write_b128 v244, v[148:151] offset:41984
    ds_write_b128 v244, v[152:155] offset:43008
    ds_write_b128 v244, v[156:159] offset:44032
    ds_write_b128 v244, v[160:163] offset:45056
    ds_write_b128 v244, v[164:167] offset:46080
    ds_write_b128 v244, v[168:171] offset:47104
    ds_write_b128 v244, v[172:175] offset:48128
    s_waitcnt lgkmcnt(0)
    ds_read_b64_tr_b16 a[0:1], v240 offset:32768
    ds_read_b64_tr_b16 a[2:3], v240 offset:33024
    ds_read_b64_tr_b16 a[4:5], v240 offset:34816
    ds_read_b64_tr_b16 a[6:7], v240 offset:35072
    ds_read_b64_tr_b16 a[32:33], v240 offset:32784
    ds_read_b64_tr_b16 a[34:35], v240 offset:33040
    ds_read_b64_tr_b16 a[36:37], v240 offset:34832
    ds_read_b64_tr_b16 a[38:39], v240 offset:35088
    s_waitcnt lgkmcnt(0)
    ds_read_b64_tr_b16 a[8:9], v240 offset:36864
    ds_read_b64_tr_b16 a[10:11], v240 offset:37120
    ds_read_b64_tr_b16 a[12:13], v240 offset:38912
    ds_read_b64_tr_b16 a[14:15], v240 offset:39168
    ds_read_b64_tr_b16 a[40:41], v240 offset:36880
    ds_read_b64_tr_b16 a[42:43], v240 offset:37136
    ds_read_b64_tr_b16 a[44:45], v240 offset:38928
    ds_read_b64_tr_b16 a[46:47], v240 offset:39184
    s_waitcnt lgkmcnt(0)
    ds_read_b64_tr_b16 a[16:17], v240 offset:40960
    ds_read_b64_tr_b16 a[18:19], v240 offset:41216
    ds_read_b64_tr_b16 a[20:21], v240 offset:43008
    ds_read_b64_tr_b16 a[22:23], v240 offset:43264
    ds_read_b64_tr_b16 a[48:49], v240 offset:40976
    ds_read_b64_tr_b16 a[50:51], v240 offset:41232
    ds_read_b64_tr_b16 a[52:53], v240 offset:43024
    ds_read_b64_tr_b16 a[54:55], v240 offset:43280
    s_waitcnt lgkmcnt(0)
    ds_read_b64_tr_b16 a[24:25], v240 offset:45056
    ds_read_b64_tr_b16 a[26:27], v240 offset:45312
    ds_read_b64_tr_b16 a[28:29], v240 offset:47104
    ds_read_b64_tr_b16 a[30:31], v240 offset:47360
    ds_read_b64_tr_b16 a[56:57], v240 offset:45072
    ds_read_b64_tr_b16 a[58:59], v240 offset:45328
    ds_read_b64_tr_b16 a[60:61], v240 offset:47120
    ds_read_b64_tr_b16 a[62:63], v240 offset:47376
    s_waitcnt lgkmcnt(0)
    s_waitcnt vmcnt(0)
    ds_write_b128 v245, v[48:51] offset:32768
    ds_write_b128 v245, v[52:55] offset:33792
    ds_write_b128 v245, v[56:59] offset:34816
    ds_write_b128 v245, v[60:63] offset:35840
    ds_write_b128 v245, v[64:67] offset:36864
    ds_write_b128 v245, v[68:71] offset:37888
    ds_write_b128 v245, v[72:75] offset:38912
    ds_write_b128 v245, v[76:79] offset:39936
    ds_write_b128 v245, v[80:83] offset:40960
    ds_write_b128 v245, v[84:87] offset:41984
    ds_write_b128 v245, v[88:91] offset:43008
    ds_write_b128 v245, v[92:95] offset:44032
    ds_write_b128 v245, v[96:99] offset:45056
    ds_write_b128 v245, v[100:103] offset:46080
    ds_write_b128 v245, v[104:107] offset:47104
    ds_write_b128 v245, v[108:111] offset:48128
    s_waitcnt lgkmcnt(0)
    ds_read_b64_tr_b16 a[192:193], v243 offset:32768
    ds_read_b64_tr_b16 a[194:195], v243 offset:33024
    ds_read_b64_tr_b16 a[196:197], v243 offset:34816
    ds_read_b64_tr_b16 a[198:199], v243 offset:35072
    ds_read_b64_tr_b16 a[224:225], v243 offset:32776
    ds_read_b64_tr_b16 a[226:227], v243 offset:33032
    ds_read_b64_tr_b16 a[228:229], v243 offset:34824
    ds_read_b64_tr_b16 a[230:231], v243 offset:35080
    s_waitcnt lgkmcnt(0)
    ds_read_b64_tr_b16 a[200:201], v243 offset:36864
    ds_read_b64_tr_b16 a[202:203], v243 offset:37120
    ds_read_b64_tr_b16 a[204:205], v243 offset:38912
    ds_read_b64_tr_b16 a[206:207], v243 offset:39168
    ds_read_b64_tr_b16 a[232:233], v243 offset:36872
    ds_read_b64_tr_b16 a[234:235], v243 offset:37128
    ds_read_b64_tr_b16 a[236:237], v243 offset:38920
    ds_read_b64_tr_b16 a[238:239], v243 offset:39176
    s_waitcnt lgkmcnt(0)
    ds_read_b64_tr_b16 a[208:209], v243 offset:40960
    ds_read_b64_tr_b16 a[210:211], v243 offset:41216
    ds_read_b64_tr_b16 a[212:213], v243 offset:43008
    ds_read_b64_tr_b16 a[214:215], v243 offset:43264
    ds_read_b64_tr_b16 a[240:241], v243 offset:40968
    ds_read_b64_tr_b16 a[242:243], v243 offset:41224
    ds_read_b64_tr_b16 a[244:245], v243 offset:43016
    ds_read_b64_tr_b16 a[246:247], v243 offset:43272
    s_waitcnt lgkmcnt(0)
    ds_read_b64_tr_b16 a[216:217], v243 offset:45056
    ds_read_b64_tr_b16 a[218:219], v243 offset:45312
    ds_read_b64_tr_b16 a[220:221], v243 offset:47104
    ds_read_b64_tr_b16 a[222:223], v243 offset:47360
    ds_read_b64_tr_b16 a[248:249], v243 offset:45064
    ds_read_b64_tr_b16 a[250:251], v243 offset:45320
    ds_read_b64_tr_b16 a[252:253], v243 offset:47112
    ds_read_b64_tr_b16 a[254:255], v243 offset:47368
    s_waitcnt lgkmcnt(0)
    v_bfe_u32 v249, v0, 1, 1
    v_lshlrev_b32 v249, 4, v249
    v_mov_b32 v250, 0x3f80
    v_lshlrev_b32 v250, v249, v250
    v_bfe_u32 v248, v0, 3, 1
    v_bfe_u32 v249, v0, 4, 1
    v_xor_b32 v249, v249, v248
    v_bfe_u32 v248, v0, 2, 1
    v_lshl_add_u32 v248, v249, 2, v248
    v_and_b32 v249, 1, v0
    v_lshl_add_u32 v248, v249, 1, v248
    v_cmp_eq_u32 vcc, 0, v248
    s_nop 1
    v_cndmask_b32 v252, 0, v250, vcc
    v_cmp_eq_u32 vcc, 1, v248
    s_nop 1
    v_cndmask_b32 v253, 0, v250, vcc
    v_cmp_eq_u32 vcc, 2, v248
    s_nop 1
    v_cndmask_b32 v254, 0, v250, vcc
    v_cmp_eq_u32 vcc, 3, v248
    s_nop 1
    v_cndmask_b32 v255, 0, v250, vcc
    v_mov_b32 v64, 0
    v_mov_b32 v65, 0
    v_mov_b32 v66, 0
    v_mov_b32 v67, 0
    v_mov_b32 v68, 0
    v_mov_b32 v69, 0
    v_mov_b32 v70, 0
    v_mov_b32 v71, 0
    v_mov_b32 v72, 0
    v_mov_b32 v73, 0
    v_mov_b32 v74, 0
    v_mov_b32 v75, 0
    v_mov_b32 v76, 0
    v_mov_b32 v77, 0
    v_mov_b32 v78, 0
    v_mov_b32 v79, 0
    v_mov_b32 v80, 0
    v_mov_b32 v81, 0
    v_mov_b32 v82, 0
    v_mov_b32 v83, 0
    v_mov_b32 v84, 0
    v_mov_b32 v85, 0
    v_mov_b32 v86, 0
    v_mov_b32 v87, 0
    v_mov_b32 v145, 0
    v_mov_b32 v147, 0
    v_mov_b32 v165, 0
    s_bitcmp1_b32 s17, 2
    s_cbranch_scc1 L_cwarme_5
    s_lshr_b32 s20, s17, 3
    s_lshl_b32 s20, s20, 2
    s_and_b32 s21, s17, 3
    s_add_u32 s20, s20, s21
    s_lshl_b32 s21, s16, 4
    s_add_u32 s20, s20, s21
    s_lshl_b32 s20, s20, 12
    v_lshlrev_b32 v34, 4, v0
    s_mov_b32 s12, s82
    s_and_b32 s13, s83, 0xffff
    s_mov_b32 s14, 0x400000
    s_mov_b32 s15, 0x00020000
    s_mov_b32 s56, s64
    s_and_b32 s57, s65, 0xffff
    s_mov_b32 s58, 0x400000
    s_mov_b32 s59, 0x00020000
    buffer_load_dwordx4 v[168:171], v34, s[12:15], s20 offen
    buffer_load_dwordx4 v[168:171], v34, s[56:59], s20 offen
    s_add_u32 s20, s20, 0x40000
    buffer_load_dwordx4 v[168:171], v34, s[12:15], s20 offen
    buffer_load_dwordx4 v[168:171], v34, s[56:59], s20 offen
    s_add_u32 s20, s20, 0x40000
    buffer_load_dwordx4 v[168:171], v34, s[12:15], s20 offen
    buffer_load_dwordx4 v[168:171], v34, s[56:59], s20 offen
    s_add_u32 s20, s20, 0x40000
    buffer_load_dwordx4 v[168:171], v34, s[12:15], s20 offen
    buffer_load_dwordx4 v[168:171], v34, s[56:59], s20 offen
    s_add_u32 s20, s20, 0x40000
    buffer_load_dwordx4 v[168:171], v34, s[12:15], s20 offen
    buffer_load_dwordx4 v[168:171], v34, s[56:59], s20 offen
    s_add_u32 s20, s20, 0x40000
    buffer_load_dwordx4 v[168:171], v34, s[12:15], s20 offen
    buffer_load_dwordx4 v[168:171], v34, s[56:59], s20 offen
    s_add_u32 s20, s20, 0x40000
    buffer_load_dwordx4 v[168:171], v34, s[12:15], s20 offen
    buffer_load_dwordx4 v[168:171], v34, s[56:59], s20 offen
    s_add_u32 s20, s20, 0x40000
    buffer_load_dwordx4 v[168:171], v34, s[12:15], s20 offen
    buffer_load_dwordx4 v[168:171], v34, s[56:59], s20 offen
    s_add_u32 s20, s20, 0x40000
    buffer_load_dwordx4 v[168:171], v34, s[12:15], s20 offen
    buffer_load_dwordx4 v[168:171], v34, s[56:59], s20 offen
    s_add_u32 s20, s20, 0x40000
    buffer_load_dwordx4 v[168:171], v34, s[12:15], s20 offen
    buffer_load_dwordx4 v[168:171], v34, s[56:59], s20 offen
    s_add_u32 s20, s20, 0x40000
    buffer_load_dwordx4 v[168:171], v34, s[12:15], s20 offen
    buffer_load_dwordx4 v[168:171], v34, s[56:59], s20 offen
    s_add_u32 s20, s20, 0x40000
    buffer_load_dwordx4 v[168:171], v34, s[12:15], s20 offen
    buffer_load_dwordx4 v[168:171], v34, s[56:59], s20 offen
    s_add_u32 s20, s20, 0x40000
    buffer_load_dwordx4 v[168:171], v34, s[12:15], s20 offen
    buffer_load_dwordx4 v[168:171], v34, s[56:59], s20 offen
    s_add_u32 s20, s20, 0x40000
    buffer_load_dwordx4 v[168:171], v34, s[12:15], s20 offen
    buffer_load_dwordx4 v[168:171], v34, s[56:59], s20 offen
    s_add_u32 s20, s20, 0x40000
    buffer_load_dwordx4 v[168:171], v34, s[12:15], s20 offen
    buffer_load_dwordx4 v[168:171], v34, s[56:59], s20 offen
    s_add_u32 s20, s20, 0x40000
    buffer_load_dwordx4 v[168:171], v34, s[12:15], s20 offen
    buffer_load_dwordx4 v[168:171], v34, s[56:59], s20 offen
    s_add_u32 s20, s20, 0x40000
L_cwarme_5:
    s_mov_b32 s12, s84
    s_and_b32 s13, s85, 0xffff
    s_mov_b32 s14, 0x4000
    s_mov_b32 s15, 0x00020000
    buffer_load_dwordx2 v[168:169], v33, s[12:15], 0 offen
    s_waitcnt vmcnt(0)
    s_mov_b32 s12, s98
    s_and_b32 s13, s99, 0xffff
    s_mov_b32 s14, 0x100
    s_mov_b32 s15, 0x00020000
    s_mov_b32 s19, 0
    s_mov_b32 s53, 1
    s_mov_b32 s43, 24576
    s_add_u32 s54, s100, 0x5900000
    s_addc_u32 s55, s101, 0
    v_mov_b32 v34, 0
L_dw_6:
    buffer_load_dword v35, v34, s[12:15], 0 offen sc1
    s_add_u32 s33, s33, 1
    s_cmp_gt_u32 s33, 0x100000
    s_waitcnt vmcnt(0)
    s_cbranch_scc1 chain_kernel_abort
    v_readfirstlane_b32 s20, v35
    s_and_b32 s22, s20, 0xffff
    s_cmp_ge_u32 s22, 256
    s_cbranch_scc1 L_dwok_7
    s_sleep 2
    s_branch L_dw_6
L_dwok_7:
    s_lshr_b32 s21, s20, 16
    s_cmp_gt_u32 s21, 64
    s_cselect_b32 s21, 0x2000, 0x0
    s_add_u32 s35, s100, 0x1fffff
    s_and_b32 s35, s35, 0xffe00000
    s_sub_u32 s52, s35, s100
    s_add_u32 s35, s52, s21
    s_xor_b32 s21, s21, 0x2000
    s_add_u32 s52, s52, s21
    s_mov_b32 s31, s35
    s_cmp_lg_u32 s18, 3
    s_cbranch_scc1 L_init3_8
    s_lshl_b32 s21, s19, 7
    s_add_u32 s21, s21, 0x5900000
    v_mov_b32 v34, 0
L_dw_9:
    buffer_load_dword v35, v34, s[8:11], s21 offen sc1
    s_add_u32 s33, s33, 1
    s_cmp_gt_u32 s33, 0x100000
    s_waitcnt vmcnt(0)
    s_cbranch_scc1 chain_kernel_abort
    v_readfirstlane_b32 s20, v35
    s_cmp_ge_u32 s20, 64
    s_cbranch_scc1 L_dwok_10
    s_sleep 2
    s_branch L_dw_9
L_dwok_10:
    s_add_u32 m0, s43, 0
    s_nop 0
    buffer_load_dwordx4 v27, s[8:11], s31 offen offset:0 lds
    s_add_u32 m0, s43, 896
    s_nop 0
    buffer_load_dwordx4 v27, s[8:11], s31 offen offset:128 lds
    s_add_u32 m0, s43, 0
    s_nop 0
    buffer_load_dwordx4 v29, s[8:11], s31 offen offset:2048 lds
    s_add_u32 m0, s43, 960
    s_nop 0
    buffer_load_dwordx4 v29, s[8:11], s31 offen offset:2112 lds
    s_xor_b32 s43, s43, 4096
    s_waitcnt vmcnt(0)
L_init3_8:
    s_and_b32 s20, s19, 3
    s_lshl_b32 s21, s20, 16
    s_add_u32 s38, s36, s21
    s_add_u32 s41, s38, 0x140000
    s_lshl_b32 s21, s20, 18
    s_add_u32 s40, s37, s21
    s_add_u32 s42, s31, 0x8000000
    s_add_u32 s21, s19, 1
    s_bitcmp1_b32 s21, 1
    s_cselect_b32 s31, s52, s35
    s_lshl_b32 s21, s21, 20
    s_add_u32 s31, s31, s21
    s_add_u32 s20, s20, 1
    s_and_b32 s20, s20, 3
    s_lshl_b32 s20, s20, 16
    s_add_u32 s39, s36, s20
    s_cmp_lg_u32 s18, 0
    s_cbranch_scc1 L_init_11
    v_cmp_eq_u32 vcc, s34, v168
    s_nop 1
    v_cndmask_b32 v168, v168, -1, vcc
    v_cmp_eq_u32 vcc, s34, v169
    s_nop 1
    v_cndmask_b32 v169, v169, -1, vcc
    buffer_store_dwordx2 v[168:169], v8, s[8:11], s38 offen
    s_xor_b32 s43, s43, 4096
    s_setprio 3
L_init_11:
    s_barrier
L_step_12:
    s_nop 15
    s_nop 7
    buffer_load_dwordx4 v[48:51], v2, s[8:11], s38 offen sc1
    v_mov_b32 v88, 0
    v_mov_b32 v89, 0
    v_mov_b32 v90, 0
    v_mov_b32 v91, 0
    v_mov_b32 v92, 0
    v_mov_b32 v93, 0
    v_mov_b32 v94, 0
    v_mov_b32 v95, 0
    ds_read_b128 v[116:119], v25
    ds_read_b128 v[120:123], v25 offset:1024
    v_xor_b32 v25, 0x1000, v25
    s_nop 0
    buffer_load_dwordx4 v[52:55], v3, s[8:11], s38 offen sc1
    s_nop 11
    buffer_load_dwordx4 v[56:59], v4, s[8:11], s38 offen sc1
    s_nop 11
    buffer_load_dwordx4 v[60:63], v5, s[8:11], s38 offen sc1
    s_waitcnt vmcnt(3)
    v_max3_u32 v7, v48, v49, v50
    v_max_u32 v7, v7, v51
    v_cmp_eq_u32 vcc, s34, v7
    s_cbranch_vccnz L_q_a_19
    v_smfmac_f32_16x16x64_bf16 v[64:67], v[48:51], a[0:7], v6
    s_waitcnt vmcnt(2)
    v_max3_u32 v7, v52, v53, v54
    v_max_u32 v7, v7, v55
    v_smfmac_f32_16x16x64_bf16 v[68:71], v[48:51], a[64:71], v6
    v_cmp_eq_u32 vcc, s34, v7
    v_smfmac_f32_16x16x64_bf16 v[72:75], v[48:51], a[32:39], v6
    v_smfmac_f32_16x16x64_bf16 v[76:79], v[48:51], a[96:103], v6
    s_cbranch_vccnz L_q_a_20
    v_smfmac_f32_16x16x64_bf16 v[64:67], v[52:55], a[8:15], v6
    s_waitcnt vmcnt(1)
    v_max3_u32 v7, v56, v57, v58
    v_max_u32 v7, v7, v59
    v_smfmac_f32_16x16x64_bf16 v[68:71], v[52:55], a[72:79], v6
    v_cmp_eq_u32 vcc, s34, v7
    v_smfmac_f32_16x16x64_bf16 v[72:75], v[52:55], a[40:47], v6
    v_smfmac_f32_16x16x64_bf16 v[76:79], v[52:55], a[104:111], v6
    s_cbranch_vccnz L_q_a_21
    v_smfmac_f32_16x16x64_bf16 v[64:67], v[56:59], a[16:23], v6
    s_waitcnt vmcnt(0)
    v_max3_u32 v7, v60, v61, v62
    v_max_u32 v7, v7, v63
    v_smfmac_f32_16x16x64_bf16 v[68:71], v[56:59], a[80:87], v6
    v_cmp_eq_u32 vcc, s34, v7
    v_smfmac_f32_16x16x64_bf16 v[72:75], v[56:59], a[48:55], v6
    v_smfmac_f32_16x16x64_bf16 v[76:79], v[56:59], a[112:119], v6
    s_cbranch_vccnz L_q_a_22
    v_smfmac_f32_16x16x64_bf16 v[64:67], v[60:63], a[24:31], v6
    v_smfmac_f32_16x16x64_bf16 v[68:71], v[60:63], a[88:95], v6
    v_smfmac_f32_16x16x64_bf16 v[72:75], v[60:63], a[56:63], v6
    v_smfmac_f32_16x16x64_bf16 v[76:79], v[60:63], a[120:127], v6
L_gd_a_18:
    v_cvt_pk_bf16_f32 v96, v64, v65
    v_cvt_pk_bf16_f32 v97, v66, v67
    v_cvt_pk_bf16_f32 v98, v68, v69
    v_cvt_pk_bf16_f32 v99, v70, v71
    s_cmp_lg_u32 s18, 0
    v_cvt_pk_bf16_f32 v100, v72, v73
    v_mfma_f32_16x16x32_bf16 v[104:107], v[96:99], v[40:43], 0
    v_cvt_pk_bf16_f32 v101, v74, v75
    v_cvt_pk_bf16_f32 v102, v76, v77
    v_cvt_pk_bf16_f32 v103, v78, v79
    s_nop 1
    v_mfma_f32_16x16x32_bf16 v[108:111], v[100:103], v[40:43], 0
    s_cbranch_scc0 L_help1_13_w0
    s_nop 0
    ds_write_b128 v20, v[104:107]
    s_nop 4
    ds_write_b128 v20, v[108:111] offset:1024
    s_waitcnt lgkmcnt(0)
    s_barrier
    s_cmp_lg_u32 s18, 2
    s_cbranch_scc1 L_poe_101
    s_sub_u32 s20, s19, 1
    s_and_b32 s20, s20, 3
    s_lshl_b32 s21, s20, 16
    s_add_u32 s21, s21, s36
    s_add_u32 s22, s21, 0x140000
    s_lshl_b32 s23, s20, 18
    s_add_u32 s23, s23, s37
    buffer_store_dwordx2 v[36:37], v8, s[8:11], s21 offen
    buffer_store_dwordx2 v[36:37], v28, s[8:11], s22 offen
    buffer_store_dwordx4 v[36:39], v9, s[8:11], s23 offen
    s_mov_b64 exec, s[28:29]
    buffer_store_dwordx4 v[36:39], v10, s[8:11], s23 offen
    s_mov_b64 exec, -1
L_poe_101:
    v_smfmac_f32_16x16x64_bf16 v[80:83], v[48:51], a[128:135], v6
    v_smfmac_f32_16x16x64_bf16 v[84:87], v[48:51], a[160:167], v6
    v_smfmac_f32_16x16x64_bf16 v[80:83], v[52:55], a[136:143], v6
    v_smfmac_f32_16x16x64_bf16 v[84:87], v[52:55], a[168:175], v6
    v_smfmac_f32_16x16x64_bf16 v[80:83], v[56:59], a[144:151], v6
    v_smfmac_f32_16x16x64_bf16 v[84:87], v[56:59], a[176:183], v6
    v_smfmac_f32_16x16x64_bf16 v[80:83], v[60:63], a[152:159], v6
    v_smfmac_f32_16x16x64_bf16 v[84:87], v[60:63], a[184:191], v6
    s_nop 4
    ds_write_b128 v21, v[80:83]
    s_nop 1
    ds_write_b128 v21, v[84:87] offset:512
    s_waitcnt lgkmcnt(0)
    s_barrier
    s_cmp_eq_u32 s18, 1
    s_cbranch_scc1 L_vred_102
L_bar2b_103:
    s_waitcnt lgkmcnt(0)
    s_barrier
    s_cmp_lg_u32 s18, 3
    s_cbranch_scc1 L_bar3_14
    s_cmp_ge_u32 s19, 2
    s_cbranch_scc1 L_gated_104
    s_add_u32 s23, s19, 1
    s_lshl_b32 s21, s23, 7
    s_add_u32 s21, s21, 0x5900000
    v_mov_b32 v34, 0
L_dw_105:
    buffer_load_dword v35, v34, s[8:11], s21 offen sc1
    s_add_u32 s33, s33, 1
    s_cmp_gt_u32 s33, 0x100000
    s_waitcnt vmcnt(0)
    s_cbranch_scc1 chain_kernel_abort
    v_readfirstlane_b32 s20, v35
    s_cmp_ge_u32 s20, 64
    s_cbranch_scc1 L_dwok_106
    s_sleep 2
    s_branch L_dw_105
L_dwok_106:
L_gated_104:
    s_add_u32 m0, s43, 0
    s_nop 0
    buffer_load_dwordx4 v27, s[8:11], s31 offen offset:0 lds
    s_add_u32 m0, s43, 896
    s_nop 0
    buffer_load_dwordx4 v27, s[8:11], s31 offen offset:128 lds
    s_add_u32 m0, s43, 0
    s_nop 0
    buffer_load_dwordx4 v29, s[8:11], s31 offen offset:2048 lds
    s_add_u32 m0, s43, 960
    s_nop 0
    buffer_load_dwordx4 v29, s[8:11], s31 offen offset:2112 lds
    s_xor_b32 s43, s43, 4096
    s_branch L_bar3_14
L_vred_102:
    ds_read_b64 v[168:169], v22 offset:0
    ds_read_b64 v[170:171], v22 offset:512
    ds_read_b64 v[172:173], v22 offset:1024
    ds_read_b64 v[174:175], v22 offset:1536
    ds_read_b64 v[176:177], v22 offset:2048
    ds_read_b64 v[178:179], v22 offset:2560
    ds_read_b64 v[180:181], v22 offset:3072
    ds_read_b64 v[182:183], v22 offset:3584
    ds_read_b64 v[184:185], v22 offset:4096
    ds_read_b64 v[186:187], v22 offset:4608
    ds_read_b64 v[188:189], v22 offset:5120
    ds_read_b64 v[190:191], v22 offset:5632
    ds_read_b64 v[192:193], v22 offset:6144
    ds_read_b64 v[194:195], v22 offset:6656
    ds_read_b64 v[196:197], v22 offset:7168
    s_waitcnt lgkmcnt(11)
    ds_read_b64 v[198:199], v22 offset:7680
    s_waitcnt lgkmcnt(8)
    v_pk_add_f32 v[168:169], v[168:169], v[172:173]
    v_pk_add_f32 v[170:171], v[170:171], v[174:175]
    v_pk_add_f32 v[176:177], v[176:177], v[180:181]
    v_pk_add_f32 v[178:179], v[178:179], v[182:183]
    v_pk_add_f32 v[168:169], v[168:169], v[176:177]
    v_pk_add_f32 v[170:171], v[170:171], v[178:179]
    s_waitcnt lgkmcnt(0)
    v_pk_add_f32 v[184:185], v[184:185], v[188:189]
    v_pk_add_f32 v[186:187], v[186:187], v[190:191]
    v_pk_add_f32 v[192:193], v[192:193], v[196:197]
    v_pk_add_f32 v[194:195], v[194:195], v[198:199]
    v_pk_add_f32 v[168:169], v[168:169], v[184:185]
    v_pk_add_f32 v[170:171], v[170:171], v[186:187]
    v_pk_add_f32 v[168:169], v[168:169], v[192:193]
    v_pk_add_f32 v[170:171], v[170:171], v[194:195]
    v_cvt_pk_bf16_f32 v144, v168, v169
    v_cvt_pk_bf16_f32 v146, v170, v171
    ds_write2_b32 v32, v144, v146 offset0:0 offset1:16
    s_branch L_bar2b_103
L_help1_13_w0:
    v_smfmac_f32_16x16x64_bf16 v[80:83], v[48:51], a[128:135], v6
    v_smfmac_f32_16x16x64_bf16 v[84:87], v[48:51], a[160:167], v6
    v_smfmac_f32_16x16x64_bf16 v[80:83], v[52:55], a[136:143], v6
    v_smfmac_f32_16x16x64_bf16 v[84:87], v[52:55], a[168:175], v6
    v_smfmac_f32_16x16x64_bf16 v[80:83], v[56:59], a[144:151], v6
    v_smfmac_f32_16x16x64_bf16 v[84:87], v[56:59], a[176:183], v6
    v_smfmac_f32_16x16x64_bf16 v[80:83], v[60:63], a[152:159], v6
    v_smfmac_f32_16x16x64_bf16 v[84:87], v[60:63], a[184:191], v6
    s_nop 4
    ds_write_b128 v21, v[80:83]
    s_nop 1
    ds_write_b128 v21, v[84:87] offset:512
    s_barrier
    ds_read_b128 v[168:171], v1 offset:2048
    ds_read_b128 v[172:175], v1 offset:3072
    ds_read_b128 v[176:179], v1 offset:4096
    ds_read_b128 v[180:183], v1 offset:5120
    ds_read_b128 v[184:187], v1 offset:6144
    ds_read_b128 v[188:191], v1 offset:7168
    s_waitcnt lgkmcnt(4)
    v_pk_add_f32 v[104:105], v[104:105], v[168:169]
    v_pk_add_f32 v[106:107], v[106:107], v[170:171]
    v_pk_add_f32 v[108:109], v[108:109], v[172:173]
    v_pk_add_f32 v[110:111], v[110:111], v[174:175]
    s_waitcnt lgkmcnt(2)
    v_pk_add_f32 v[104:105], v[104:105], v[176:177]
    v_pk_add_f32 v[106:107], v[106:107], v[178:179]
    v_pk_add_f32 v[108:109], v[108:109], v[180:181]
    v_pk_add_f32 v[110:111], v[110:111], v[182:183]
    s_waitcnt lgkmcnt(0)
    v_pk_add_f32 v[104:105], v[104:105], v[184:185]
    v_pk_add_f32 v[106:107], v[106:107], v[186:187]
    v_pk_add_f32 v[108:109], v[108:109], v[188:189]
    v_pk_add_f32 v[110:111], v[110:111], v[190:191]
    v_cvt_pk_bf16_f32 v112, v104, v105
    v_cvt_pk_bf16_f32 v113, v106, v107
    v_cvt_pk_bf16_f32 v114, v108, v109
    v_cvt_pk_bf16_f32 v115, v110, v111
    s_mov_b64 exec, s[24:25]
    s_nop 0
    v_mfma_f32_16x16x32_bf16 v[124:127], v[116:119], v[112:115], 0
    v_mfma_f32_16x16x32_bf16 v[128:131], v[120:123], v[112:115], 0
    v_mfma_f32_16x16x32_bf16 v[132:135], v[112:115], v[112:115], 0
    s_nop 3
    buffer_store_dwordx4 v[124:127], v9, s[8:11], s40 offen
    s_nop 0
    buffer_store_dwordx4 v[128:131], v9, s[8:11], s40 offen offset:128
    s_mov_b64 exec, s[28:29]
    buffer_store_dwordx4 v[132:135], v10, s[8:11], s40 offen
    s_mov_b64 exec, -1
    s_barrier
    ds_write_b128 v1, v[112:115] offset:32768
    ds_read_b128 v[136:139], v26 offset:0
    ds_read_b128 v[140:143], v26 offset:1024
    v_mov_b32_dpp v124, v128 row_shr:8 row_mask:0xf bank_mask:0xc
    v_mov_b32_dpp v125, v129 row_shr:8 row_mask:0xf bank_mask:0xc
    v_mov_b32_dpp v126, v130 row_shr:8 row_mask:0xf bank_mask:0xc
    v_mov_b32_dpp v127, v131 row_shr:8 row_mask:0xf bank_mask:0xc
    v_xor_b32 v26, 0x1000, v26
    s_cmp_eq_u32 s19, 63
    s_cbranch_scc1 L_bar2b_103
    s_nop 3
    buffer_load_dwordx4 v[200:203], v16, s[8:11], s40 offen sc1
    buffer_load_dwordx4 v[204:207], v13, s[8:11], s40 offen sc1
    buffer_load_dwordx4 v[208:211], v14, s[8:11], s40 offen sc1
    buffer_load_dwordx4 v[212:215], v15, s[8:11], s40 offen sc1
    s_nop 15
    s_nop 7
    buffer_load_dwordx4 v[216:219], v16, s[8:11], s40 offen sc1
    buffer_load_dwordx4 v[220:223], v13, s[8:11], s40 offen sc1
    buffer_load_dwordx4 v[224:227], v14, s[8:11], s40 offen sc1
    buffer_load_dwordx4 v[228:231], v15, s[8:11], s40 offen sc1
    s_waitcnt vmcnt(7)
    v_permlane32_swap_b32 v200, v202
    v_permlane32_swap_b32 v201, v203
    s_waitcnt vmcnt(6)
    v_pk_add_f32 v[154:155], v[200:201], v[202:203]
    v_pk_add_f32 v[148:149], v[124:125], v[204:205]
    v_pk_add_f32 v[150:151], v[126:127], v[206:207]
    v_permlane16_swap_b32 v154, v155
    s_waitcnt vmcnt(5)
    v_pk_add_f32 v[148:149], v[148:149], v[208:209]
    v_pk_add_f32 v[150:151], v[150:151], v[210:211]
    v_add_f32 v152, v154, v155
    s_waitcnt vmcnt(4)
    v_pk_add_f32 v[148:149], v[148:149], v[212:213]
    v_pk_add_f32 v[150:151], v[150:151], v[214:215]
    v_pk_add_f32 v[154:155], v[148:149], v[150:151]
    v_add_f32 v154, v154, v152
    v_cmp_u_f32 vcc, v154, v155
    v_cvt_pk_bf16_f32 v160, 0, v148
    v_cvt_pk_bf16_f32 v161, 0, v149
    v_cvt_pk_bf16_f32 v162, 0, v150
    v_cvt_pk_bf16_f32 v163, 0, v151
    v_cvt_pk_bf16_f32 v176, 0, v152
    s_cbranch_vccnz L_cf_108
L_chead_110:
    s_waitcnt lgkmcnt(0)
    s_barrier
    ds_read_b32 v144, v32
    ds_read_b32 v146, v32 offset:64
    v_pk_mul_f32 v[148:149], v[160:161], s[46:47]
    v_pk_mul_f32 v[150:151], v[162:163], s[46:47]
    v_mul_f32 v152, s46, v176
    v_cvt_pk_bf16_f32 v148, 0, v148
    v_cvt_pk_bf16_f32 v149, 0, v149
    v_cvt_pk_bf16_f32 v150, 0, v150
    v_cvt_pk_bf16_f32 v151, 0, v151
    v_cvt_pk_bf16_f32 v152, 0, v152
    v_max3_f32 v154, v148, v149, v150
    v_max3_f32 v154, v154, v151, v152
    s_nop 1
    v_max_f32_dpp v154, v154, v154 row_ror:8 row_mask:0xf bank_mask:0xf
    v_mov_b32 v156, v154
    s_nop 1
    v_permlane16_swap_b32 v154, v156
    v_max_f32 v154, v154, v156
    v_mov_b32 v156, v154
    s_nop 1
    v_permlane32_swap_b32 v154, v156
    v_max_f32 v154, v154, v156
    v_mul_f32 v154, s44, v154
    v_fma_f32 v152, v152, s44, -v154
    v_exp_f32 v152, v152
    v_pk_fma_f32 v[148:149], v[148:149], s[44:45], v[154:155] op_sel_hi:[1,1,0] neg_lo:[0,0,1] neg_hi:[0,0,1]
    v_pk_fma_f32 v[150:151], v[150:151], s[44:45], v[154:155] op_sel_hi:[1,1,0] neg_lo:[0,0,1] neg_hi:[0,0,1]
    v_mov_b32_dpp v156, v152 row_ror:8 row_mask:0xf bank_mask:0xf
    v_exp_f32 v148, v148
    v_cvt_pk_bf16_f32 v164, v152, v156
    v_exp_f32 v149, v149
    v_exp_f32 v150, v150
    v_mfma_f32_16x16x16_bf16 v[176:179], v[44:45], v[164:165], 0
    v_exp_f32 v151, v151
    s_waitcnt lgkmcnt(0)
    v_cvt_pk_bf16_f32 v160, v148, v149
    v_mfma_f32_16x16x16_bf16 v[168:171], v[144:145], v[164:165], 0
    v_cvt_pk_bf16_f32 v161, v150, v151
    v_mov_b32_dpp v162, v160 row_ror:8 row_mask:0xf bank_mask:0xf
    v_mfma_f32_16x16x16_bf16 v[172:175], v[146:147], v[164:165], 0
    v_mov_b32_dpp v163, v161 row_ror:8 row_mask:0xf bank_mask:0xf
    s_nop 0
    s_mov_b64 exec, s[24:25]
    v_mfma_f32_16x16x32_bf16 v[176:179], v[44:47], v[160:163], v[176:179]
    v_mfma_f32_16x16x32_bf16 v[168:171], v[136:139], v[160:163], v[168:171]
    v_mfma_f32_16x16x32_bf16 v[172:175], v[140:143], v[160:163], v[172:175]
    s_nop 3
    v_rcp_f32 v176, v176
    s_nop 0
    v_pk_mul_f32 v[168:169], v[168:169], v[176:177] op_sel_hi:[1,0]
    v_pk_mul_f32 v[170:171], v[170:171], v[176:177] op_sel_hi:[1,0]
    v_pk_mul_f32 v[172:173], v[172:173], v[176:177] op_sel_hi:[1,0]
    v_pk_mul_f32 v[174:175], v[174:175], v[176:177] op_sel_hi:[1,0]
    v_cvt_pk_bf16_f32 v180, v168, v169
    v_cvt_pk_bf16_f32 v181, v170, v171
    v_cvt_pk_bf16_f32 v182, v172, v173
    v_cvt_pk_bf16_f32 v183, v174, v175
    buffer_store_dwordx4 v[180:183], v11, s[8:11], s41 offen
    s_mov_b64 exec, -1
    s_barrier
    s_nop 7
    s_branch L_bar3_14_e
L_bar3_14:
    s_waitcnt lgkmcnt(0)
    s_barrier
    s_cmp_eq_u32 s19, 63
    s_cbranch_scc1 L_fin_17
L_bar3_14_e:
    s_nop 15
    s_nop 3
    buffer_load_dwordx4 v[48:51], v2, s[8:11], s41 offen sc1
    v_mov_b32 v64, 0
    v_mov_b32 v65, 0
    v_mov_b32 v66, 0
    v_mov_b32 v67, 0
    v_mov_b32 v68, 0
    v_mov_b32 v69, 0
    v_mov_b32 v70, 0
    v_mov_b32 v71, 0
    v_mov_b32 v72, 0
    v_mov_b32 v73, 0
    v_mov_b32 v74, 0
    v_mov_b32 v75, 0
    buffer_load_dwordx4 v[52:55], v3, s[8:11], s41 offen sc1
    v_mov_b32 v76, 0
    v_mov_b32 v77, 0
    v_mov_b32 v78, 0
    v_mov_b32 v79, 0
    v_mov_b32 v80, 0
    v_mov_b32 v81, 0
    v_mov_b32 v82, 0
    v_mov_b32 v83, 0
    v_mov_b32 v84, 0
    v_mov_b32 v85, 0
    v_mov_b32 v86, 0
    v_mov_b32 v87, 0
    buffer_load_dwordx4 v[56:59], v4, s[8:11], s41 offen sc1
    s_nop 11
    buffer_load_dwordx4 v[60:63], v5, s[8:11], s41 offen sc1
    s_waitcnt vmcnt(3)
    v_max3_u32 v7, v48, v49, v50
    v_max_u32 v7, v7, v51
    v_cmp_eq_u32 vcc, s34, v7
    s_cbranch_vccnz L_q_e_112
    v_smfmac_f32_16x16x64_bf16 v[88:91], v[48:51], a[192:199], v6
    s_waitcnt vmcnt(2)
    v_max3_u32 v7, v52, v53, v54
    v_max_u32 v7, v7, v55
    v_cmp_eq_u32 vcc, s34, v7
    v_smfmac_f32_16x16x64_bf16 v[92:95], v[48:51], a[224:231], v6
    s_cbranch_vccnz L_q_e_113
    v_smfmac_f32_16x16x64_bf16 v[88:91], v[52:55], a[200:207], v6
    s_waitcnt vmcnt(1)
    v_max3_u32 v7, v56, v57, v58
    v_max_u32 v7, v7, v59
    v_cmp_eq_u32 vcc, s34, v7
    v_smfmac_f32_16x16x64_bf16 v[92:95], v[52:55], a[232:239], v6
    s_cbranch_vccnz L_q_e_114
    v_smfmac_f32_16x16x64_bf16 v[88:91], v[56:59], a[208:215], v6
    s_waitcnt vmcnt(0)
    v_max3_u32 v7, v60, v61, v62
    v_max_u32 v7, v7, v63
    v_cmp_eq_u32 vcc, s34, v7
    v_smfmac_f32_16x16x64_bf16 v[92:95], v[56:59], a[240:247], v6
    s_cbranch_vccnz L_q_e_115
    v_smfmac_f32_16x16x64_bf16 v[88:91], v[60:63], a[216:223], v6
    v_smfmac_f32_16x16x64_bf16 v[92:95], v[60:63], a[248:255], v6
L_gd_e_111:
    s_add_u32 s19, s19, 1
    s_cmp_lg_u32 s18, 0
    s_nop 2
    v_cvt_pk_bf16_f32 v96, v88, v89
    v_cvt_pk_bf16_f32 v97, v90, v91
    s_nop 0
    v_cvt_pk_bf16_f32 v98, v92, v93
    v_cvt_pk_bf16_f32 v99, v94, v95
    s_nop 1
    v_mfma_f32_16x16x32_bf16 v[104:107], v[96:99], v[252:255], 0
    s_cbranch_scc1 L_help2_15
    s_barrier
    ds_read_b128 v[172:175], v1 offset:18432
    ds_read_b128 v[176:179], v1 offset:20480
    ds_read_b128 v[180:183], v1 offset:22528
    s_waitcnt lgkmcnt(2)
    v_pk_add_f32 v[168:169], v[104:105], v[172:173]
    v_pk_add_f32 v[170:171], v[106:107], v[174:175]
    s_waitcnt lgkmcnt(1)
    v_pk_add_f32 v[168:169], v[168:169], v[176:177]
    v_pk_add_f32 v[170:171], v[170:171], v[178:179]
    s_waitcnt lgkmcnt(0)
    v_pk_add_f32 v[168:169], v[168:169], v[180:181]
    v_pk_add_f32 v[170:171], v[170:171], v[182:183]
    buffer_store_dwordx4 v[168:171], v12, s[8:11], s42 offen offset:0 sc1
    buffer_store_dwordx4 v[168:171], v12, s[8:11], s42 offen offset:1024 sc1
    s_mov_b32 s22, s42
    s_mov_b32 s23, s39
    s_and_b32 s20, s19, 3
    s_lshl_b32 s21, s20, 16
    s_add_u32 s38, s36, s21
    s_add_u32 s41, s38, 0x140000
    s_lshl_b32 s21, s20, 18
    s_add_u32 s40, s37, s21
    s_add_u32 s42, s31, 0x8000000
    s_add_u32 s21, s19, 1
    s_bitcmp1_b32 s21, 1
    s_cselect_b32 s31, s52, s35
    s_lshl_b32 s21, s21, 20
    s_add_u32 s31, s31, s21
    s_add_u32 s20, s20, 1
    s_and_b32 s20, s20, 3
    s_lshl_b32 s20, s20, 16
    s_add_u32 s39, s36, s20
    s_nop 15
    s_nop 15
    s_nop 15
    s_nop 13
    buffer_load_dwordx4 v[200:203], v17, s[8:11], s22 offen offset:0 sc1
    buffer_load_dwordx4 v[204:207], v18, s[8:11], s22 offen offset:0 sc1
    buffer_load_dwordx4 v[208:211], v19, s[8:11], s22 offen offset:0 sc1
    s_nop 15
    s_nop 15
    s_nop 7
    buffer_load_dwordx4 v[212:215], v17, s[8:11], s22 offen offset:1024 sc1
    buffer_load_dwordx4 v[216:219], v18, s[8:11], s22 offen offset:1024 sc1
    buffer_load_dwordx4 v[220:223], v19, s[8:11], s22 offen offset:1024 sc1
    ds_read_b128 v[172:175], v1 offset:33792
    s_mov_b64 exec, s[26:27]
    s_waitcnt lgkmcnt(1)
    buffer_store_dwordx4 v[112:115], v30, s[8:11], s22 offen offset:3072 sc1
    s_mov_b64 exec, s[48:49]
    s_waitcnt lgkmcnt(0)
    buffer_store_dwordx4 v[172:175], v31, s[8:11], s22 offen offset:3584 sc1
    s_mov_b64 exec, -1
    s_waitcnt vmcnt(7)
    v_pk_add_f32 v[148:149], v[168:169], v[200:201]
    v_pk_add_f32 v[150:151], v[170:171], v[202:203]
    s_waitcnt vmcnt(6)
    v_pk_add_f32 v[148:149], v[148:149], v[204:205]
    v_pk_add_f32 v[150:151], v[150:151], v[206:207]
    s_waitcnt vmcnt(5)
    v_pk_add_f32 v[148:149], v[148:149], v[208:209]
    v_pk_add_f32 v[150:151], v[150:151], v[210:211]
    v_pk_add_f32 v[154:155], v[148:149], v[150:151]
    v_cmp_u_f32 vcc, v154, v155
    v_cvt_pk_bf16_f32 v180, v148, v149
    v_cvt_pk_bf16_f32 v181, v150, v151
    s_cbranch_vccnz L_gf_194
L_gok_195:
    buffer_store_dwordx2 v[180:181], v8, s[8:11], s23 offen
    s_barrier
    s_nop 7
    s_branch L_step_12
L_help2_15:
    s_nop 2
    ds_write_b128 v20, v[104:107] offset:16384
    s_waitcnt lgkmcnt(0)
    s_barrier
    s_and_b32 s20, s19, 3
    s_lshl_b32 s21, s20, 16
    s_add_u32 s38, s36, s21
    s_add_u32 s41, s38, 0x140000
    s_lshl_b32 s21, s20, 18
    s_add_u32 s40, s37, s21
    s_add_u32 s42, s31, 0x8000000
    s_add_u32 s21, s19, 1
    s_bitcmp1_b32 s21, 1
    s_cselect_b32 s31, s52, s35
    s_lshl_b32 s21, s21, 20
    s_add_u32 s31, s31, s21
    s_add_u32 s20, s20, 1
    s_and_b32 s20, s20, 3
    s_lshl_b32 s20, s20, 16
    s_add_u32 s39, s36, s20
    s_cmp_eq_u32 s18, 3
    s_cbranch_scc1 L_w3_198
    s_xor_b32 s20, s18, 2
    s_or_b32 s20, s20, s16
    s_or_b32 s20, s20, s17
    s_cbranch_scc1 L_bar4_16
    s_cmp_lt_u32 s19, 3
    s_cbranch_scc1 L_bar4_16
    s_atomic_add s53, s[98:99], 0x4
    s_branch L_bar4_16
L_w3_198:
    s_or_b32 s20, s16, s17
    s_cbranch_scc1 L_bar4_16
    s_add_u32 s23, s19, 2
    s_min_u32 s23, s23, 63
    s_lshl_b32 s21, s23, 7
    v_mov_b32 v34, 0
L_dw_199:
    s_load_dword s20, s[54:55], s21 glc
    s_add_u32 s33, s33, 1
    s_cmp_gt_u32 s33, 0x100000
    s_waitcnt lgkmcnt(0)
    s_cbranch_scc1 chain_kernel_abort
    s_cmp_ge_u32 s20, 64
    s_cbranch_scc1 L_dwok_200
    s_sleep 2
    s_branch L_dw_199
L_dwok_200:
L_bar4_16:
    s_barrier
    s_branch L_step_12
L_fin_17:
    s_cmp_lg_u32 s18, 2
    s_cbranch_scc1 chain_kernel_done
    ds_read_b128 v[168:171], v1 offset:32768
    ds_read_b128 v[172:175], v1 offset:33792
    s_mov_b64 exec, s[26:27]
    s_waitcnt lgkmcnt(1)
    buffer_store_dwordx4 v[168:171], v30, s[8:11], s42 offen offset:3072 sc1
    s_mov_b64 exec, s[48:49]
    s_waitcnt lgkmcnt(0)
    buffer_store_dwordx4 v[172:175], v31, s[8:11], s42 offen offset:3584 sc1
    s_mov_b64 exec, -1
    s_branch chain_kernel_done
L_q_a_22:
    buffer_load_dwordx4 v[60:63], v5, s[8:11], s38 offen sc1
    s_waitcnt vmcnt(2)
    v_max3_u32 v7, v60, v61, v62
    v_max_u32 v7, v7, v63
    v_cmp_eq_u32 vcc, s34, v7
    s_cbranch_vccz L_ok_a_23
    s_add_u32 s33, s33, 1
    s_cmp_gt_u32 s33, 0x100000
    s_cbranch_scc0 L_q_a_22
    s_branch chain_kernel_abort
L_ok_a_23:
    v_smfmac_f32_16x16x64_bf16 v[64:67], v[60:63], a[24:31], v6
    v_smfmac_f32_16x16x64_bf16 v[68:71], v[60:63], a[88:95], v6
    v_smfmac_f32_16x16x64_bf16 v[72:75], v[60:63], a[56:63], v6
    v_smfmac_f32_16x16x64_bf16 v[76:79], v[60:63], a[120:127], v6
    s_branch L_gd_a_18
L_q_a_21:
    buffer_load_dwordx4 v[56:59], v4, s[8:11], s38 offen sc1
    s_waitcnt vmcnt(1)
    v_max3_u32 v7, v60, v61, v62
    v_max_u32 v7, v7, v63
    v_cmp_eq_u32 vcc, s34, v7
    s_cbranch_vccnz L_q_a_24
    v_smfmac_f32_16x16x64_bf16 v[64:67], v[60:63], a[24:31], v6
    v_smfmac_f32_16x16x64_bf16 v[68:71], v[60:63], a[88:95], v6
    v_smfmac_f32_16x16x64_bf16 v[72:75], v[60:63], a[56:63], v6
    v_smfmac_f32_16x16x64_bf16 v[76:79], v[60:63], a[120:127], v6
    s_branch L_q_a_25
L_q_a_25:
    buffer_load_dwordx4 v[56:59], v4, s[8:11], s38 offen sc1
    s_waitcnt vmcnt(2)
    v_max3_u32 v7, v56, v57, v58
    v_max_u32 v7, v7, v59
    v_cmp_eq_u32 vcc, s34, v7
    s_cbranch_vccz L_ok_a_26
    s_add_u32 s33, s33, 1
    s_cmp_gt_u32 s33, 0x100000
    s_cbranch_scc0 L_q_a_25
    s_branch chain_kernel_abort
L_ok_a_26:
    v_smfmac_f32_16x16x64_bf16 v[64:67], v[56:59], a[16:23], v6
    v_smfmac_f32_16x16x64_bf16 v[68:71], v[56:59], a[80:87], v6
    v_smfmac_f32_16x16x64_bf16 v[72:75], v[56:59], a[48:55], v6
    v_smfmac_f32_16x16x64_bf16 v[76:79], v[56:59], a[112:119], v6
    s_branch L_gd_a_18
L_q_a_24:
    buffer_load_dwordx4 v[60:63], v5, s[8:11], s38 offen sc1
    s_waitcnt vmcnt(2)
    v_max3_u32 v7, v56, v57, v58
    v_max_u32 v7, v7, v59
    v_cmp_eq_u32 vcc, s34, v7
    s_cbranch_vccz L_ok_a_27
    buffer_load_dwordx4 v[56:59], v4, s[8:11], s38 offen sc1
    s_waitcnt vmcnt(2)
    v_max3_u32 v7, v60, v61, v62
    v_max_u32 v7, v7, v63
    v_cmp_eq_u32 vcc, s34, v7
    s_cbranch_vccz L_ok_a_28
    s_add_u32 s33, s33, 1
    s_cmp_gt_u32 s33, 0x100000
    s_cbranch_scc0 L_q_a_24
    s_branch chain_kernel_abort
L_ok_a_27:
    v_smfmac_f32_16x16x64_bf16 v[64:67], v[56:59], a[16:23], v6
    v_smfmac_f32_16x16x64_bf16 v[68:71], v[56:59], a[80:87], v6
    v_smfmac_f32_16x16x64_bf16 v[72:75], v[56:59], a[48:55], v6
    v_smfmac_f32_16x16x64_bf16 v[76:79], v[56:59], a[112:119], v6
    s_branch L_q_a_22
L_ok_a_28:
    v_smfmac_f32_16x16x64_bf16 v[64:67], v[60:63], a[24:31], v6
    v_smfmac_f32_16x16x64_bf16 v[68:71], v[60:63], a[88:95], v6
    v_smfmac_f32_16x16x64_bf16 v[72:75], v[60:63], a[56:63], v6
    v_smfmac_f32_16x16x64_bf16 v[76:79], v[60:63], a[120:127], v6
    s_branch L_q_a_25
L_q_a_20:
    buffer_load_dwordx4 v[52:55], v3, s[8:11], s38 offen sc1
    s_waitcnt vmcnt(2)
    v_max3_u32 v7, v56, v57, v58
    v_max_u32 v7, v7, v59
    v_cmp_eq_u32 vcc, s34, v7
    s_cbranch_vccnz L_q_a_29
    v_smfmac_f32_16x16x64_bf16 v[64:67], v[56:59], a[16:23], v6
    v_smfmac_f32_16x16x64_bf16 v[68:71], v[56:59], a[80:87], v6
    v_smfmac_f32_16x16x64_bf16 v[72:75], v[56:59], a[48:55], v6
    v_smfmac_f32_16x16x64_bf16 v[76:79], v[56:59], a[112:119], v6
    s_branch L_q_a_30
L_q_a_30:
    buffer_load_dwordx4 v[52:55], v3, s[8:11], s38 offen sc1
    s_waitcnt vmcnt(2)
    v_max3_u32 v7, v60, v61, v62
    v_max_u32 v7, v7, v63
    v_cmp_eq_u32 vcc, s34, v7
    s_cbranch_vccnz L_q_a_31
    v_smfmac_f32_16x16x64_bf16 v[64:67], v[60:63], a[24:31], v6
    v_smfmac_f32_16x16x64_bf16 v[68:71], v[60:63], a[88:95], v6
    v_smfmac_f32_16x16x64_bf16 v[72:75], v[60:63], a[56:63], v6
    v_smfmac_f32_16x16x64_bf16 v[76:79], v[60:63], a[120:127], v6
    s_branch L_q_a_32
L_q_a_32:
    buffer_load_dwordx4 v[52:55], v3, s[8:11], s38 offen sc1
    s_waitcnt vmcnt(2)
    v_max3_u32 v7, v52, v53, v54
    v_max_u32 v7, v7, v55
    v_cmp_eq_u32 vcc, s34, v7
    s_cbranch_vccz L_ok_a_33
    s_add_u32 s33, s33, 1
    s_cmp_gt_u32 s33, 0x100000
    s_cbranch_scc0 L_q_a_32
    s_branch chain_kernel_abort
L_ok_a_33:
    v_smfmac_f32_16x16x64_bf16 v[64:67], v[52:55], a[8:15], v6
    v_smfmac_f32_16x16x64_bf16 v[68:71], v[52:55], a[72:79], v6
    v_smfmac_f32_16x16x64_bf16 v[72:75], v[52:55], a[40:47], v6
    v_smfmac_f32_16x16x64_bf16 v[76:79], v[52:55], a[104:111], v6
    s_branch L_gd_a_18
L_q_a_31:
    buffer_load_dwordx4 v[60:63], v5, s[8:11], s38 offen sc1
    s_waitcnt vmcnt(2)
    v_max3_u32 v7, v52, v53, v54
    v_max_u32 v7, v7, v55
    v_cmp_eq_u32 vcc, s34, v7
    s_cbranch_vccz L_ok_a_34
    buffer_load_dwordx4 v[52:55], v3, s[8:11], s38 offen sc1
    s_waitcnt vmcnt(2)
    v_max3_u32 v7, v60, v61, v62
    v_max_u32 v7, v7, v63
    v_cmp_eq_u32 vcc, s34, v7
    s_cbranch_vccz L_ok_a_35
    s_add_u32 s33, s33, 1
    s_cmp_gt_u32 s33, 0x100000
    s_cbranch_scc0 L_q_a_31
    s_branch chain_kernel_abort
L_ok_a_34:
    v_smfmac_f32_16x16x64_bf16 v[64:67], v[52:55], a[8:15], v6
    v_smfmac_f32_16x16x64_bf16 v[68:71], v[52:55], a[72:79], v6
    v_smfmac_f32_16x16x64_bf16 v[72:75], v[52:55], a[40:47], v6
    v_smfmac_f32_16x16x64_bf16 v[76:79], v[52:55], a[104:111], v6
    s_branch L_q_a_22
L_ok_a_35:
    v_smfmac_f32_16x16x64_bf16 v[64:67], v[60:63], a[24:31], v6
    v_smfmac_f32_16x16x64_bf16 v[68:71], v[60:63], a[88:95], v6
    v_smfmac_f32_16x16x64_bf16 v[72:75], v[60:63], a[56:63], v6
    v_smfmac_f32_16x16x64_bf16 v[76:79], v[60:63], a[120:127], v6
    s_branch L_q_a_32
L_q_a_29:
    buffer_load_dwordx4 v[56:59], v4, s[8:11], s38 offen sc1
    s_waitcnt vmcnt(2)
    v_max3_u32 v7, v60, v61, v62
    v_max_u32 v7, v7, v63
    v_cmp_eq_u32 vcc, s34, v7
    s_cbranch_vccnz L_q_a_36
    v_smfmac_f32_16x16x64_bf16 v[64:67], v[60:63], a[24:31], v6
    v_smfmac_f32_16x16x64_bf16 v[68:71], v[60:63], a[88:95], v6
    v_smfmac_f32_16x16x64_bf16 v[72:75], v[60:63], a[56:63], v6
    v_smfmac_f32_16x16x64_bf16 v[76:79], v[60:63], a[120:127], v6
    s_branch L_q_a_37
L_q_a_37:
    buffer_load_dwordx4 v[52:55], v3, s[8:11], s38 offen sc1
    s_waitcnt vmcnt(2)
    v_max3_u32 v7, v56, v57, v58
    v_max_u32 v7, v7, v59
    v_cmp_eq_u32 vcc, s34, v7
    s_cbranch_vccz L_ok_a_38
    buffer_load_dwordx4 v[56:59], v4, s[8:11], s38 offen sc1
    s_waitcnt vmcnt(2)
    v_max3_u32 v7, v52, v53, v54
    v_max_u32 v7, v7, v55
    v_cmp_eq_u32 vcc, s34, v7
    s_cbranch_vccz L_ok_a_39
    s_add_u32 s33, s33, 1
    s_cmp_gt_u32 s33, 0x100000
    s_cbranch_scc0 L_q_a_37
    s_branch chain_kernel_abort
L_ok_a_38:
    v_smfmac_f32_16x16x64_bf16 v[64:67], v[56:59], a[16:23], v6
    v_smfmac_f32_16x16x64_bf16 v[68:71], v[56:59], a[80:87], v6
    v_smfmac_f32_16x16x64_bf16 v[72:75], v[56:59], a[48:55], v6
    v_smfmac_f32_16x16x64_bf16 v[76:79], v[56:59], a[112:119], v6
    s_branch L_q_a_32
L_ok_a_39:
    v_smfmac_f32_16x16x64_bf16 v[64:67], v[52:55], a[8:15], v6
    v_smfmac_f32_16x16x64_bf16 v[68:71], v[52:55], a[72:79], v6
    v_smfmac_f32_16x16x64_bf16 v[72:75], v[52:55], a[40:47], v6
    v_smfmac_f32_16x16x64_bf16 v[76:79], v[52:55], a[104:111], v6
    s_branch L_q_a_25
L_q_a_36:
    buffer_load_dwordx4 v[60:63], v5, s[8:11], s38 offen sc1
    s_waitcnt vmcnt(2)
    v_max3_u32 v7, v52, v53, v54
    v_max_u32 v7, v7, v55
    v_cmp_eq_u32 vcc, s34, v7
    s_cbranch_vccz L_ok_a_40
    buffer_load_dwordx4 v[52:55], v3, s[8:11], s38 offen sc1
    s_waitcnt vmcnt(2)
    v_max3_u32 v7, v56, v57, v58
    v_max_u32 v7, v7, v59
    v_cmp_eq_u32 vcc, s34, v7
    s_cbranch_vccz L_ok_a_41
    buffer_load_dwordx4 v[56:59], v4, s[8:11], s38 offen sc1
    s_waitcnt vmcnt(2)
    v_max3_u32 v7, v60, v61, v62
    v_max_u32 v7, v7, v63
    v_cmp_eq_u32 vcc, s34, v7
    s_cbranch_vccz L_ok_a_42
    s_add_u32 s33, s33, 1
    s_cmp_gt_u32 s33, 0x100000
    s_cbranch_scc0 L_q_a_36
    s_branch chain_kernel_abort
L_ok_a_40:
    v_smfmac_f32_16x16x64_bf16 v[64:67], v[52:55], a[8:15], v6
    v_smfmac_f32_16x16x64_bf16 v[68:71], v[52:55], a[72:79], v6
    v_smfmac_f32_16x16x64_bf16 v[72:75], v[52:55], a[40:47], v6
    v_smfmac_f32_16x16x64_bf16 v[76:79], v[52:55], a[104:111], v6
    s_branch L_q_a_43
L_ok_a_41:
    v_smfmac_f32_16x16x64_bf16 v[64:67], v[56:59], a[16:23], v6
    v_smfmac_f32_16x16x64_bf16 v[68:71], v[56:59], a[80:87], v6
    v_smfmac_f32_16x16x64_bf16 v[72:75], v[56:59], a[48:55], v6
    v_smfmac_f32_16x16x64_bf16 v[76:79], v[56:59], a[112:119], v6
    s_branch L_q_a_44
L_ok_a_42:
    v_smfmac_f32_16x16x64_bf16 v[64:67], v[60:63], a[24:31], v6
    v_smfmac_f32_16x16x64_bf16 v[68:71], v[60:63], a[88:95], v6
    v_smfmac_f32_16x16x64_bf16 v[72:75], v[60:63], a[56:63], v6
    v_smfmac_f32_16x16x64_bf16 v[76:79], v[60:63], a[120:127], v6
    s_branch L_q_a_37
L_q_a_44:
    buffer_load_dwordx4 v[52:55], v3, s[8:11], s38 offen sc1
    s_waitcnt vmcnt(2)
    v_max3_u32 v7, v60, v61, v62
    v_max_u32 v7, v7, v63
    v_cmp_eq_u32 vcc, s34, v7
    s_cbranch_vccz L_ok_a_45
    buffer_load_dwordx4 v[60:63], v5, s[8:11], s38 offen sc1
    s_waitcnt vmcnt(2)
    v_max3_u32 v7, v52, v53, v54
    v_max_u32 v7, v7, v55
    v_cmp_eq_u32 vcc, s34, v7
    s_cbranch_vccz L_ok_a_46
    s_add_u32 s33, s33, 1
    s_cmp_gt_u32 s33, 0x100000
    s_cbranch_scc0 L_q_a_44
    s_branch chain_kernel_abort
L_ok_a_45:
    v_smfmac_f32_16x16x64_bf16 v[64:67], v[60:63], a[24:31], v6
    v_smfmac_f32_16x16x64_bf16 v[68:71], v[60:63], a[88:95], v6
    v_smfmac_f32_16x16x64_bf16 v[72:75], v[60:63], a[56:63], v6
    v_smfmac_f32_16x16x64_bf16 v[76:79], v[60:63], a[120:127], v6
    s_branch L_q_a_32
L_ok_a_46:
    v_smfmac_f32_16x16x64_bf16 v[64:67], v[52:55], a[8:15], v6
    v_smfmac_f32_16x16x64_bf16 v[68:71], v[52:55], a[72:79], v6
    v_smfmac_f32_16x16x64_bf16 v[72:75], v[52:55], a[40:47], v6
    v_smfmac_f32_16x16x64_bf16 v[76:79], v[52:55], a[104:111], v6
    s_branch L_q_a_22
L_q_a_43:
    buffer_load_dwordx4 v[56:59], v4, s[8:11], s38 offen sc1
    s_waitcnt vmcnt(2)
    v_max3_u32 v7, v60, v61, v62
    v_max_u32 v7, v7, v63
    v_cmp_eq_u32 vcc, s34, v7
    s_cbranch_vccz L_ok_a_47
    buffer_load_dwordx4 v[60:63], v5, s[8:11], s38 offen sc1
    s_waitcnt vmcnt(2)
    v_max3_u32 v7, v56, v57, v58
    v_max_u32 v7, v7, v59
    v_cmp_eq_u32 vcc, s34, v7
    s_cbranch_vccz L_ok_a_48
    s_add_u32 s33, s33, 1
    s_cmp_gt_u32 s33, 0x100000
    s_cbranch_scc0 L_q_a_43
    s_branch chain_kernel_abort
L_ok_a_47:
    v_smfmac_f32_16x16x64_bf16 v[64:67], v[60:63], a[24:31], v6
    v_smfmac_f32_16x16x64_bf16 v[68:71], v[60:63], a[88:95], v6
    v_smfmac_f32_16x16x64_bf16 v[72:75], v[60:63], a[56:63], v6
    v_smfmac_f32_16x16x64_bf16 v[76:79], v[60:63], a[120:127], v6
    s_branch L_q_a_25
L_ok_a_48:
    v_smfmac_f32_16x16x64_bf16 v[64:67], v[56:59], a[16:23], v6
    v_smfmac_f32_16x16x64_bf16 v[68:71], v[56:59], a[80:87], v6
    v_smfmac_f32_16x16x64_bf16 v[72:75], v[56:59], a[48:55], v6
    v_smfmac_f32_16x16x64_bf16 v[76:79], v[56:59], a[112:119], v6
    s_branch L_q_a_22
L_q_a_19:
    buffer_load_dwordx4 v[48:51], v2, s[8:11], s38 offen sc1
    s_waitcnt vmcnt(3)
    v_max3_u32 v7, v52, v53, v54
    v_max_u32 v7, v7, v55
    v_cmp_eq_u32 vcc, s34, v7
    s_cbranch_vccnz L_q_a_49
    v_smfmac_f32_16x16x64_bf16 v[64:67], v[52:55], a[8:15], v6
    v_smfmac_f32_16x16x64_bf16 v[68:71], v[52:55], a[72:79], v6
    v_smfmac_f32_16x16x64_bf16 v[72:75], v[52:55], a[40:47], v6
    v_smfmac_f32_16x16x64_bf16 v[76:79], v[52:55], a[104:111], v6
    s_branch L_q_a_50
L_q_a_50:
    buffer_load_dwordx4 v[48:51], v2, s[8:11], s38 offen sc1
    s_waitcnt vmcnt(3)
    v_max3_u32 v7, v56, v57, v58
    v_max_u32 v7, v7, v59
    v_cmp_eq_u32 vcc, s34, v7
    s_cbranch_vccnz L_q_a_51
    v_smfmac_f32_16x16x64_bf16 v[64:67], v[56:59], a[16:23], v6
    v_smfmac_f32_16x16x64_bf16 v[68:71], v[56:59], a[80:87], v6
    v_smfmac_f32_16x16x64_bf16 v[72:75], v[56:59], a[48:55], v6
    v_smfmac_f32_16x16x64_bf16 v[76:79], v[56:59], a[112:119], v6
    s_branch L_q_a_52
L_q_a_52:
    buffer_load_dwordx4 v[48:51], v2, s[8:11], s38 offen sc1
    s_waitcnt vmcnt(3)
    v_max3_u32 v7, v60, v61, v62
    v_max_u32 v7, v7, v63
    v_cmp_eq_u32 vcc, s34, v7
    s_cbranch_vccnz L_q_a_53
    v_smfmac_f32_16x16x64_bf16 v[64:67], v[60:63], a[24:31], v6
    v_smfmac_f32_16x16x64_bf16 v[68:71], v[60:63], a[88:95], v6
    v_smfmac_f32_16x16x64_bf16 v[72:75], v[60:63], a[56:63], v6
    v_smfmac_f32_16x16x64_bf16 v[76:79], v[60:63], a[120:127], v6
    s_branch L_q_a_54
L_q_a_54:
    buffer_load_dwordx4 v[48:51], v2, s[8:11], s38 offen sc1
    s_waitcnt vmcnt(2)
    v_max3_u32 v7, v48, v49, v50
    v_max_u32 v7, v7, v51
    v_cmp_eq_u32 vcc, s34, v7
    s_cbranch_vccz L_ok_a_55
    s_add_u32 s33, s33, 1
    s_cmp_gt_u32 s33, 0x100000
    s_cbranch_scc0 L_q_a_54
    s_branch chain_kernel_abort
L_ok_a_55:
    v_smfmac_f32_16x16x64_bf16 v[64:67], v[48:51], a[0:7], v6
    v_smfmac_f32_16x16x64_bf16 v[68:71], v[48:51], a[64:71], v6
    v_smfmac_f32_16x16x64_bf16 v[72:75], v[48:51], a[32:39], v6
    v_smfmac_f32_16x16x64_bf16 v[76:79], v[48:51], a[96:103], v6
    s_branch L_gd_a_18
L_q_a_53:
    buffer_load_dwordx4 v[60:63], v5, s[8:11], s38 offen sc1
    s_waitcnt vmcnt(2)
    v_max3_u32 v7, v48, v49, v50
    v_max_u32 v7, v7, v51
    v_cmp_eq_u32 vcc, s34, v7
    s_cbranch_vccz L_ok_a_56
    buffer_load_dwordx4 v[48:51], v2, s[8:11], s38 offen sc1
    s_waitcnt vmcnt(2)
    v_max3_u32 v7, v60, v61, v62
    v_max_u32 v7, v7, v63
    v_cmp_eq_u32 vcc, s34, v7
    s_cbranch_vccz L_ok_a_57
    s_add_u32 s33, s33, 1
    s_cmp_gt_u32 s33, 0x100000
    s_cbranch_scc0 L_q_a_53
    s_branch chain_kernel_abort
L_ok_a_56:
    v_smfmac_f32_16x16x64_bf16 v[64:67], v[48:51], a[0:7], v6
    v_smfmac_f32_16x16x64_bf16 v[68:71], v[48:51], a[64:71], v6
    v_smfmac_f32_16x16x64_bf16 v[72:75], v[48:51], a[32:39], v6
    v_smfmac_f32_16x16x64_bf16 v[76:79], v[48:51], a[96:103], v6
    s_branch L_q_a_22
L_ok_a_57:
    v_smfmac_f32_16x16x64_bf16 v[64:67], v[60:63], a[24:31], v6
    v_smfmac_f32_16x16x64_bf16 v[68:71], v[60:63], a[88:95], v6
    v_smfmac_f32_16x16x64_bf16 v[72:75], v[60:63], a[56:63], v6
    v_smfmac_f32_16x16x64_bf16 v[76:79], v[60:63], a[120:127], v6
    s_branch L_q_a_54
L_q_a_51:
    buffer_load_dwordx4 v[56:59], v4, s[8:11], s38 offen sc1
    s_waitcnt vmcnt(3)
    v_max3_u32 v7, v60, v61, v62
    v_max_u32 v7, v7, v63
    v_cmp_eq_u32 vcc, s34, v7
    s_cbranch_vccnz L_q_a_58
    v_smfmac_f32_16x16x64_bf16 v[64:67], v[60:63], a[24:31], v6
    v_smfmac_f32_16x16x64_bf16 v[68:71], v[60:63], a[88:95], v6
    v_smfmac_f32_16x16x64_bf16 v[72:75], v[60:63], a[56:63], v6
    v_smfmac_f32_16x16x64_bf16 v[76:79], v[60:63], a[120:127], v6
    s_branch L_q_a_59
L_q_a_59:
    buffer_load_dwordx4 v[48:51], v2, s[8:11], s38 offen sc1
    s_waitcnt vmcnt(2)
    v_max3_u32 v7, v56, v57, v58
    v_max_u32 v7, v7, v59
    v_cmp_eq_u32 vcc, s34, v7
    s_cbranch_vccz L_ok_a_60
    buffer_load_dwordx4 v[56:59], v4, s[8:11], s38 offen sc1
    s_waitcnt vmcnt(2)
    v_max3_u32 v7, v48, v49, v50
    v_max_u32 v7, v7, v51
    v_cmp_eq_u32 vcc, s34, v7
    s_cbranch_vccz L_ok_a_61
    s_add_u32 s33, s33, 1
    s_cmp_gt_u32 s33, 0x100000
    s_cbranch_scc0 L_q_a_59
    s_branch chain_kernel_abort
L_ok_a_60:
    v_smfmac_f32_16x16x64_bf16 v[64:67], v[56:59], a[16:23], v6
    v_smfmac_f32_16x16x64_bf16 v[68:71], v[56:59], a[80:87], v6
    v_smfmac_f32_16x16x64_bf16 v[72:75], v[56:59], a[48:55], v6
    v_smfmac_f32_16x16x64_bf16 v[76:79], v[56:59], a[112:119], v6
    s_branch L_q_a_54
L_ok_a_61:
    v_smfmac_f32_16x16x64_bf16 v[64:67], v[48:51], a[0:7], v6
    v_smfmac_f32_16x16x64_bf16 v[68:71], v[48:51], a[64:71], v6
    v_smfmac_f32_16x16x64_bf16 v[72:75], v[48:51], a[32:39], v6
    v_smfmac_f32_16x16x64_bf16 v[76:79], v[48:51], a[96:103], v6
    s_branch L_q_a_25
L_q_a_58:
    buffer_load_dwordx4 v[60:63], v5, s[8:11], s38 offen sc1
    s_waitcnt vmcnt(2)
    v_max3_u32 v7, v48, v49, v50
    v_max_u32 v7, v7, v51
    v_cmp_eq_u32 vcc, s34, v7
    s_cbranch_vccz L_ok_a_62
    buffer_load_dwordx4 v[48:51], v2, s[8:11], s38 offen sc1
    s_waitcnt vmcnt(2)
    v_max3_u32 v7, v56, v57, v58
    v_max_u32 v7, v7, v59
    v_cmp_eq_u32 vcc, s34, v7
    s_cbranch_vccz L_ok_a_63
    buffer_load_dwordx4 v[56:59], v4, s[8:11], s38 offen sc1
    s_waitcnt vmcnt(2)
    v_max3_u32 v7, v60, v61, v62
    v_max_u32 v7, v7, v63
    v_cmp_eq_u32 vcc, s34, v7
    s_cbranch_vccz L_ok_a_64
    s_add_u32 s33, s33, 1
    s_cmp_gt_u32 s33, 0x100000
    s_cbranch_scc0 L_q_a_58
    s_branch chain_kernel_abort
L_ok_a_62:
    v_smfmac_f32_16x16x64_bf16 v[64:67], v[48:51], a[0:7], v6
    v_smfmac_f32_16x16x64_bf16 v[68:71], v[48:51], a[64:71], v6
    v_smfmac_f32_16x16x64_bf16 v[72:75], v[48:51], a[32:39], v6
    v_smfmac_f32_16x16x64_bf16 v[76:79], v[48:51], a[96:103], v6
    s_branch L_q_a_43
L_ok_a_63:
    v_smfmac_f32_16x16x64_bf16 v[64:67], v[56:59], a[16:23], v6
    v_smfmac_f32_16x16x64_bf16 v[68:71], v[56:59], a[80:87], v6
    v_smfmac_f32_16x16x64_bf16 v[72:75], v[56:59], a[48:55], v6
    v_smfmac_f32_16x16x64_bf16 v[76:79], v[56:59], a[112:119], v6
    s_branch L_q_a_65
L_ok_a_64:
    v_smfmac_f32_16x16x64_bf16 v[64:67], v[60:63], a[24:31], v6
    v_smfmac_f32_16x16x64_bf16 v[68:71], v[60:63], a[88:95], v6
    v_smfmac_f32_16x16x64_bf16 v[72:75], v[60:63], a[56:63], v6
    v_smfmac_f32_16x16x64_bf16 v[76:79], v[60:63], a[120:127], v6
    s_branch L_q_a_59
L_q_a_65:
    buffer_load_dwordx4 v[48:51], v2, s[8:11], s38 offen sc1
    s_waitcnt vmcnt(2)
    v_max3_u32 v7, v60, v61, v62
    v_max_u32 v7, v7, v63
    v_cmp_eq_u32 vcc, s34, v7
    s_cbranch_vccz L_ok_a_66
    buffer_load_dwordx4 v[60:63], v5, s[8:11], s38 offen sc1
    s_waitcnt vmcnt(2)
    v_max3_u32 v7, v48, v49, v50
    v_max_u32 v7, v7, v51
    v_cmp_eq_u32 vcc, s34, v7
    s_cbranch_vccz L_ok_a_67
    s_add_u32 s33, s33, 1
    s_cmp_gt_u32 s33, 0x100000
    s_cbranch_scc0 L_q_a_65
    s_branch chain_kernel_abort
L_ok_a_66:
    v_smfmac_f32_16x16x64_bf16 v[64:67], v[60:63], a[24:31], v6
    v_smfmac_f32_16x16x64_bf16 v[68:71], v[60:63], a[88:95], v6
    v_smfmac_f32_16x16x64_bf16 v[72:75], v[60:63], a[56:63], v6
    v_smfmac_f32_16x16x64_bf16 v[76:79], v[60:63], a[120:127], v6
    s_branch L_q_a_54
L_ok_a_67:
    v_smfmac_f32_16x16x64_bf16 v[64:67], v[48:51], a[0:7], v6
    v_smfmac_f32_16x16x64_bf16 v[68:71], v[48:51], a[64:71], v6
    v_smfmac_f32_16x16x64_bf16 v[72:75], v[48:51], a[32:39], v6
    v_smfmac_f32_16x16x64_bf16 v[76:79], v[48:51], a[96:103], v6
    s_branch L_q_a_22
L_q_a_49:
    buffer_load_dwordx4 v[52:55], v3, s[8:11], s38 offen sc1
    s_waitcnt vmcnt(3)
    v_max3_u32 v7, v56, v57, v58
    v_max_u32 v7, v7, v59
    v_cmp_eq_u32 vcc, s34, v7
    s_cbranch_vccnz L_q_a_68
    v_smfmac_f32_16x16x64_bf16 v[64:67], v[56:59], a[16:23], v6
    v_smfmac_f32_16x16x64_bf16 v[68:71], v[56:59], a[80:87], v6
    v_smfmac_f32_16x16x64_bf16 v[72:75], v[56:59], a[48:55], v6
    v_smfmac_f32_16x16x64_bf16 v[76:79], v[56:59], a[112:119], v6
    s_branch L_q_a_69
L_q_a_69:
    buffer_load_dwordx4 v[48:51], v2, s[8:11], s38 offen sc1
    s_waitcnt vmcnt(3)
    v_max3_u32 v7, v60, v61, v62
    v_max_u32 v7, v7, v63
    v_cmp_eq_u32 vcc, s34, v7
    s_cbranch_vccnz L_q_a_70
    v_smfmac_f32_16x16x64_bf16 v[64:67], v[60:63], a[24:31], v6
    v_smfmac_f32_16x16x64_bf16 v[68:71], v[60:63], a[88:95], v6
    v_smfmac_f32_16x16x64_bf16 v[72:75], v[60:63], a[56:63], v6
    v_smfmac_f32_16x16x64_bf16 v[76:79], v[60:63], a[120:127], v6
    s_branch L_q_a_71
L_q_a_71:
    buffer_load_dwordx4 v[52:55], v3, s[8:11], s38 offen sc1
    s_waitcnt vmcnt(2)
    v_max3_u32 v7, v48, v49, v50
    v_max_u32 v7, v7, v51
    v_cmp_eq_u32 vcc, s34, v7
    s_cbranch_vccz L_ok_a_72
    buffer_load_dwordx4 v[48:51], v2, s[8:11], s38 offen sc1
    s_waitcnt vmcnt(2)
    v_max3_u32 v7, v52, v53, v54
    v_max_u32 v7, v7, v55
    v_cmp_eq_u32 vcc, s34, v7
    s_cbranch_vccz L_ok_a_73
    s_add_u32 s33, s33, 1
    s_cmp_gt_u32 s33, 0x100000
    s_cbranch_scc0 L_q_a_71
    s_branch chain_kernel_abort
L_ok_a_72:
    v_smfmac_f32_16x16x64_bf16 v[64:67], v[48:51], a[0:7], v6
    v_smfmac_f32_16x16x64_bf16 v[68:71], v[48:51], a[64:71], v6
    v_smfmac_f32_16x16x64_bf16 v[72:75], v[48:51], a[32:39], v6
    v_smfmac_f32_16x16x64_bf16 v[76:79], v[48:51], a[96:103], v6
    s_branch L_q_a_32
L_ok_a_73:
    v_smfmac_f32_16x16x64_bf16 v[64:67], v[52:55], a[8:15], v6
    v_smfmac_f32_16x16x64_bf16 v[68:71], v[52:55], a[72:79], v6
    v_smfmac_f32_16x16x64_bf16 v[72:75], v[52:55], a[40:47], v6
    v_smfmac_f32_16x16x64_bf16 v[76:79], v[52:55], a[104:111], v6
    s_branch L_q_a_54
L_q_a_70:
    buffer_load_dwordx4 v[60:63], v5, s[8:11], s38 offen sc1
    s_waitcnt vmcnt(2)
    v_max3_u32 v7, v52, v53, v54
    v_max_u32 v7, v7, v55
    v_cmp_eq_u32 vcc, s34, v7
    s_cbranch_vccz L_ok_a_74
    buffer_load_dwordx4 v[52:55], v3, s[8:11], s38 offen sc1
    s_waitcnt vmcnt(2)
    v_max3_u32 v7, v48, v49, v50
    v_max_u32 v7, v7, v51
    v_cmp_eq_u32 vcc, s34, v7
    s_cbranch_vccz L_ok_a_75
    buffer_load_dwordx4 v[48:51], v2, s[8:11], s38 offen sc1
    s_waitcnt vmcnt(2)
    v_max3_u32 v7, v60, v61, v62
    v_max_u32 v7, v7, v63
    v_cmp_eq_u32 vcc, s34, v7
    s_cbranch_vccz L_ok_a_76
    s_add_u32 s33, s33, 1
    s_cmp_gt_u32 s33, 0x100000
    s_cbranch_scc0 L_q_a_70
    s_branch chain_kernel_abort
L_ok_a_74:
    v_smfmac_f32_16x16x64_bf16 v[64:67], v[52:55], a[8:15], v6
    v_smfmac_f32_16x16x64_bf16 v[68:71], v[52:55], a[72:79], v6
    v_smfmac_f32_16x16x64_bf16 v[72:75], v[52:55], a[40:47], v6
    v_smfmac_f32_16x16x64_bf16 v[76:79], v[52:55], a[104:111], v6
    s_branch L_q_a_65
L_ok_a_75:
    v_smfmac_f32_16x16x64_bf16 v[64:67], v[48:51], a[0:7], v6
    v_smfmac_f32_16x16x64_bf16 v[68:71], v[48:51], a[64:71], v6
    v_smfmac_f32_16x16x64_bf16 v[72:75], v[48:51], a[32:39], v6
    v_smfmac_f32_16x16x64_bf16 v[76:79], v[48:51], a[96:103], v6
    s_branch L_q_a_44
L_ok_a_76:
    v_smfmac_f32_16x16x64_bf16 v[64:67], v[60:63], a[24:31], v6
    v_smfmac_f32_16x16x64_bf16 v[68:71], v[60:63], a[88:95], v6
    v_smfmac_f32_16x16x64_bf16 v[72:75], v[60:63], a[56:63], v6
    v_smfmac_f32_16x16x64_bf16 v[76:79], v[60:63], a[120:127], v6
    s_branch L_q_a_77
L_q_a_77:
    buffer_load_dwordx4 v[48:51], v2, s[8:11], s38 offen sc1
    s_waitcnt vmcnt(2)
    v_max3_u32 v7, v52, v53, v54
    v_max_u32 v7, v7, v55
    v_cmp_eq_u32 vcc, s34, v7
    s_cbranch_vccz L_ok_a_78
    buffer_load_dwordx4 v[52:55], v3, s[8:11], s38 offen sc1
    s_waitcnt vmcnt(2)
    v_max3_u32 v7, v48, v49, v50
    v_max_u32 v7, v7, v51
    v_cmp_eq_u32 vcc, s34, v7
    s_cbranch_vccz L_ok_a_79
    s_add_u32 s33, s33, 1
    s_cmp_gt_u32 s33, 0x100000
    s_cbranch_scc0 L_q_a_77
    s_branch chain_kernel_abort
L_ok_a_78:
    v_smfmac_f32_16x16x64_bf16 v[64:67], v[52:55], a[8:15], v6
    v_smfmac_f32_16x16x64_bf16 v[68:71], v[52:55], a[72:79], v6
    v_smfmac_f32_16x16x64_bf16 v[72:75], v[52:55], a[40:47], v6
    v_smfmac_f32_16x16x64_bf16 v[76:79], v[52:55], a[104:111], v6
    s_branch L_q_a_54
L_ok_a_79:
    v_smfmac_f32_16x16x64_bf16 v[64:67], v[48:51], a[0:7], v6
    v_smfmac_f32_16x16x64_bf16 v[68:71], v[48:51], a[64:71], v6
    v_smfmac_f32_16x16x64_bf16 v[72:75], v[48:51], a[32:39], v6
    v_smfmac_f32_16x16x64_bf16 v[76:79], v[48:51], a[96:103], v6
    s_branch L_q_a_32
L_q_a_68:
    buffer_load_dwordx4 v[56:59], v4, s[8:11], s38 offen sc1
    s_waitcnt vmcnt(3)
    v_max3_u32 v7, v60, v61, v62
    v_max_u32 v7, v7, v63
    v_cmp_eq_u32 vcc, s34, v7
    s_cbranch_vccnz L_q_a_80
    v_smfmac_f32_16x16x64_bf16 v[64:67], v[60:63], a[24:31], v6
    v_smfmac_f32_16x16x64_bf16 v[68:71], v[60:63], a[88:95], v6
    v_smfmac_f32_16x16x64_bf16 v[72:75], v[60:63], a[56:63], v6
    v_smfmac_f32_16x16x64_bf16 v[76:79], v[60:63], a[120:127], v6
    s_branch L_q_a_81
L_q_a_81:
    buffer_load_dwordx4 v[48:51], v2, s[8:11], s38 offen sc1
    s_waitcnt vmcnt(2)
    v_max3_u32 v7, v52, v53, v54
    v_max_u32 v7, v7, v55
    v_cmp_eq_u32 vcc, s34, v7
    s_cbranch_vccz L_ok_a_82
    buffer_load_dwordx4 v[52:55], v3, s[8:11], s38 offen sc1
    s_waitcnt vmcnt(2)
    v_max3_u32 v7, v56, v57, v58
    v_max_u32 v7, v7, v59
    v_cmp_eq_u32 vcc, s34, v7
    s_cbranch_vccz L_ok_a_83
    buffer_load_dwordx4 v[56:59], v4, s[8:11], s38 offen sc1
    s_waitcnt vmcnt(2)
    v_max3_u32 v7, v48, v49, v50
    v_max_u32 v7, v7, v51
    v_cmp_eq_u32 vcc, s34, v7
    s_cbranch_vccz L_ok_a_84
    s_add_u32 s33, s33, 1
    s_cmp_gt_u32 s33, 0x100000
    s_cbranch_scc0 L_q_a_81
    s_branch chain_kernel_abort
L_ok_a_82:
    v_smfmac_f32_16x16x64_bf16 v[64:67], v[52:55], a[8:15], v6
    v_smfmac_f32_16x16x64_bf16 v[68:71], v[52:55], a[72:79], v6
    v_smfmac_f32_16x16x64_bf16 v[72:75], v[52:55], a[40:47], v6
    v_smfmac_f32_16x16x64_bf16 v[76:79], v[52:55], a[104:111], v6
    s_branch L_q_a_59
L_ok_a_83:
    v_smfmac_f32_16x16x64_bf16 v[64:67], v[56:59], a[16:23], v6
    v_smfmac_f32_16x16x64_bf16 v[68:71], v[56:59], a[80:87], v6
    v_smfmac_f32_16x16x64_bf16 v[72:75], v[56:59], a[48:55], v6
    v_smfmac_f32_16x16x64_bf16 v[76:79], v[56:59], a[112:119], v6
    s_branch L_q_a_77
L_ok_a_84:
    v_smfmac_f32_16x16x64_bf16 v[64:67], v[48:51], a[0:7], v6
    v_smfmac_f32_16x16x64_bf16 v[68:71], v[48:51], a[64:71], v6
    v_smfmac_f32_16x16x64_bf16 v[72:75], v[48:51], a[32:39], v6
    v_smfmac_f32_16x16x64_bf16 v[76:79], v[48:51], a[96:103], v6
    s_branch L_q_a_37
L_q_a_80:
    buffer_load_dwordx4 v[60:63], v5, s[8:11], s38 offen sc1
    s_waitcnt vmcnt(2)
    v_max3_u32 v7, v48, v49, v50
    v_max_u32 v7, v7, v51
    v_cmp_eq_u32 vcc, s34, v7
    s_cbranch_vccz L_ok_a_85
    buffer_load_dwordx4 v[48:51], v2, s[8:11], s38 offen sc1
    s_waitcnt vmcnt(2)
    v_max3_u32 v7, v52, v53, v54
    v_max_u32 v7, v7, v55
    v_cmp_eq_u32 vcc, s34, v7
    s_cbranch_vccz L_ok_a_86
    buffer_load_dwordx4 v[52:55], v3, s[8:11], s38 offen sc1
    s_waitcnt vmcnt(2)
    v_max3_u32 v7, v56, v57, v58
    v_max_u32 v7, v7, v59
    v_cmp_eq_u32 vcc, s34, v7
    s_cbranch_vccz L_ok_a_87
    buffer_load_dwordx4 v[56:59], v4, s[8:11], s38 offen sc1
    s_waitcnt vmcnt(2)
    v_max3_u32 v7, v60, v61, v62
    v_max_u32 v7, v7, v63
    v_cmp_eq_u32 vcc, s34, v7
    s_cbranch_vccz L_ok_a_88
    s_add_u32 s33, s33, 1
    s_cmp_gt_u32 s33, 0x100000
    s_cbranch_scc0 L_q_a_80
    s_branch chain_kernel_abort
L_ok_a_85:
    v_smfmac_f32_16x16x64_bf16 v[64:67], v[48:51], a[0:7], v6
    v_smfmac_f32_16x16x64_bf16 v[68:71], v[48:51], a[64:71], v6
    v_smfmac_f32_16x16x64_bf16 v[72:75], v[48:51], a[32:39], v6
    v_smfmac_f32_16x16x64_bf16 v[76:79], v[48:51], a[96:103], v6
    s_branch L_q_a_89
L_ok_a_86:
    v_smfmac_f32_16x16x64_bf16 v[64:67], v[52:55], a[8:15], v6
    v_smfmac_f32_16x16x64_bf16 v[68:71], v[52:55], a[72:79], v6
    v_smfmac_f32_16x16x64_bf16 v[72:75], v[52:55], a[40:47], v6
    v_smfmac_f32_16x16x64_bf16 v[76:79], v[52:55], a[104:111], v6
    s_branch L_q_a_90
L_ok_a_87:
    v_smfmac_f32_16x16x64_bf16 v[64:67], v[56:59], a[16:23], v6
    v_smfmac_f32_16x16x64_bf16 v[68:71], v[56:59], a[80:87], v6
    v_smfmac_f32_16x16x64_bf16 v[72:75], v[56:59], a[48:55], v6
    v_smfmac_f32_16x16x64_bf16 v[76:79], v[56:59], a[112:119], v6
    s_branch L_q_a_91
L_ok_a_88:
    v_smfmac_f32_16x16x64_bf16 v[64:67], v[60:63], a[24:31], v6
    v_smfmac_f32_16x16x64_bf16 v[68:71], v[60:63], a[88:95], v6
    v_smfmac_f32_16x16x64_bf16 v[72:75], v[60:63], a[56:63], v6
    v_smfmac_f32_16x16x64_bf16 v[76:79], v[60:63], a[120:127], v6
    s_branch L_q_a_81
L_q_a_91:
    buffer_load_dwordx4 v[48:51], v2, s[8:11], s38 offen sc1
    s_waitcnt vmcnt(2)
    v_max3_u32 v7, v52, v53, v54
    v_max_u32 v7, v7, v55
    v_cmp_eq_u32 vcc, s34, v7
    s_cbranch_vccz L_ok_a_92
    buffer_load_dwordx4 v[52:55], v3, s[8:11], s38 offen sc1
    s_waitcnt vmcnt(2)
    v_max3_u32 v7, v60, v61, v62
    v_max_u32 v7, v7, v63
    v_cmp_eq_u32 vcc, s34, v7
    s_cbranch_vccz L_ok_a_93
    buffer_load_dwordx4 v[60:63], v5, s[8:11], s38 offen sc1
    s_waitcnt vmcnt(2)
    v_max3_u32 v7, v48, v49, v50
    v_max_u32 v7, v7, v51
    v_cmp_eq_u32 vcc, s34, v7
    s_cbranch_vccz L_ok_a_94
    s_add_u32 s33, s33, 1
    s_cmp_gt_u32 s33, 0x100000
    s_cbranch_scc0 L_q_a_91
    s_branch chain_kernel_abort
L_ok_a_92:
    v_smfmac_f32_16x16x64_bf16 v[64:67], v[52:55], a[8:15], v6
    v_smfmac_f32_16x16x64_bf16 v[68:71], v[52:55], a[72:79], v6
    v_smfmac_f32_16x16x64_bf16 v[72:75], v[52:55], a[40:47], v6
    v_smfmac_f32_16x16x64_bf16 v[76:79], v[52:55], a[104:111], v6
    s_branch L_q_a_65
L_ok_a_93:
    v_smfmac_f32_16x16x64_bf16 v[64:67], v[60:63], a[24:31], v6
    v_smfmac_f32_16x16x64_bf16 v[68:71], v[60:63], a[88:95], v6
    v_smfmac_f32_16x16x64_bf16 v[72:75], v[60:63], a[56:63], v6
    v_smfmac_f32_16x16x64_bf16 v[76:79], v[60:63], a[120:127], v6
    s_branch L_q_a_77
L_ok_a_94:
    v_smfmac_f32_16x16x64_bf16 v[64:67], v[48:51], a[0:7], v6
    v_smfmac_f32_16x16x64_bf16 v[68:71], v[48:51], a[64:71], v6
    v_smfmac_f32_16x16x64_bf16 v[72:75], v[48:51], a[32:39], v6
    v_smfmac_f32_16x16x64_bf16 v[76:79], v[48:51], a[96:103], v6
    s_branch L_q_a_44
L_q_a_90:
    buffer_load_dwordx4 v[48:51], v2, s[8:11], s38 offen sc1
    s_waitcnt vmcnt(2)
    v_max3_u32 v7, v56, v57, v58
    v_max_u32 v7, v7, v59
    v_cmp_eq_u32 vcc, s34, v7
    s_cbranch_vccz L_ok_a_95
    buffer_load_dwordx4 v[56:59], v4, s[8:11], s38 offen sc1
    s_waitcnt vmcnt(2)
    v_max3_u32 v7, v60, v61, v62
    v_max_u32 v7, v7, v63
    v_cmp_eq_u32 vcc, s34, v7
    s_cbranch_vccz L_ok_a_96
    buffer_load_dwordx4 v[60:63], v5, s[8:11], s38 offen sc1
    s_waitcnt vmcnt(2)
    v_max3_u32 v7, v48, v49, v50
    v_max_u32 v7, v7, v51
    v_cmp_eq_u32 vcc, s34, v7
    s_cbranch_vccz L_ok_a_97
    s_add_u32 s33, s33, 1
    s_cmp_gt_u32 s33, 0x100000
    s_cbranch_scc0 L_q_a_90
    s_branch chain_kernel_abort
L_ok_a_95:
    v_smfmac_f32_16x16x64_bf16 v[64:67], v[56:59], a[16:23], v6
    v_smfmac_f32_16x16x64_bf16 v[68:71], v[56:59], a[80:87], v6
    v_smfmac_f32_16x16x64_bf16 v[72:75], v[56:59], a[48:55], v6
    v_smfmac_f32_16x16x64_bf16 v[76:79], v[56:59], a[112:119], v6
    s_branch L_q_a_65
L_ok_a_96:
    v_smfmac_f32_16x16x64_bf16 v[64:67], v[60:63], a[24:31], v6
    v_smfmac_f32_16x16x64_bf16 v[68:71], v[60:63], a[88:95], v6
    v_smfmac_f32_16x16x64_bf16 v[72:75], v[60:63], a[56:63], v6
    v_smfmac_f32_16x16x64_bf16 v[76:79], v[60:63], a[120:127], v6
    s_branch L_q_a_59
L_ok_a_97:
    v_smfmac_f32_16x16x64_bf16 v[64:67], v[48:51], a[0:7], v6
    v_smfmac_f32_16x16x64_bf16 v[68:71], v[48:51], a[64:71], v6
    v_smfmac_f32_16x16x64_bf16 v[72:75], v[48:51], a[32:39], v6
    v_smfmac_f32_16x16x64_bf16 v[76:79], v[48:51], a[96:103], v6
    s_branch L_q_a_43
L_q_a_89:
    buffer_load_dwordx4 v[52:55], v3, s[8:11], s38 offen sc1
    s_waitcnt vmcnt(2)
    v_max3_u32 v7, v56, v57, v58
    v_max_u32 v7, v7, v59
    v_cmp_eq_u32 vcc, s34, v7
    s_cbranch_vccz L_ok_a_98
    buffer_load_dwordx4 v[56:59], v4, s[8:11], s38 offen sc1
    s_waitcnt vmcnt(2)
    v_max3_u32 v7, v60, v61, v62
    v_max_u32 v7, v7, v63
    v_cmp_eq_u32 vcc, s34, v7
    s_cbranch_vccz L_ok_a_99
    buffer_load_dwordx4 v[60:63], v5, s[8:11], s38 offen sc1
    s_waitcnt vmcnt(2)
    v_max3_u32 v7, v52, v53, v54
    v_max_u32 v7, v7, v55
    v_cmp_eq_u32 vcc, s34, v7
    s_cbranch_vccz L_ok_a_100
    s_add_u32 s33, s33, 1
    s_cmp_gt_u32 s33, 0x100000
    s_cbranch_scc0 L_q_a_89
    s_branch chain_kernel_abort
L_ok_a_98:
    v_smfmac_f32_16x16x64_bf16 v[64:67], v[56:59], a[16:23], v6
    v_smfmac_f32_16x16x64_bf16 v[68:71], v[56:59], a[80:87], v6
    v_smfmac_f32_16x16x64_bf16 v[72:75], v[56:59], a[48:55], v6
    v_smfmac_f32_16x16x64_bf16 v[76:79], v[56:59], a[112:119], v6
    s_branch L_q_a_44
L_ok_a_99:
    v_smfmac_f32_16x16x64_bf16 v[64:67], v[60:63], a[24:31], v6
    v_smfmac_f32_16x16x64_bf16 v[68:71], v[60:63], a[88:95], v6
    v_smfmac_f32_16x16x64_bf16 v[72:75], v[60:63], a[56:63], v6
    v_smfmac_f32_16x16x64_bf16 v[76:79], v[60:63], a[120:127], v6
    s_branch L_q_a_37
L_ok_a_100:
    v_smfmac_f32_16x16x64_bf16 v[64:67], v[52:55], a[8:15], v6
    v_smfmac_f32_16x16x64_bf16 v[68:71], v[52:55], a[72:79], v6
    v_smfmac_f32_16x16x64_bf16 v[72:75], v[52:55], a[40:47], v6
    v_smfmac_f32_16x16x64_bf16 v[76:79], v[52:55], a[104:111], v6
    s_branch L_q_a_43
L_cf_108:
L_rt_109:
    buffer_load_dwordx4 v[200:203], v16, s[8:11], s40 offen sc1
    buffer_load_dwordx4 v[204:207], v13, s[8:11], s40 offen sc1
    buffer_load_dwordx4 v[208:211], v14, s[8:11], s40 offen sc1
    buffer_load_dwordx4 v[212:215], v15, s[8:11], s40 offen sc1
    s_waitcnt vmcnt(7)
    v_permlane32_swap_b32 v216, v218
    v_permlane32_swap_b32 v217, v219
    s_waitcnt vmcnt(6)
    v_pk_add_f32 v[154:155], v[216:217], v[218:219]
    v_pk_add_f32 v[148:149], v[124:125], v[220:221]
    v_pk_add_f32 v[150:151], v[126:127], v[222:223]
    v_permlane16_swap_b32 v154, v155
    s_waitcnt vmcnt(5)
    v_pk_add_f32 v[148:149], v[148:149], v[224:225]
    v_pk_add_f32 v[150:151], v[150:151], v[226:227]
    v_add_f32 v152, v154, v155
    s_waitcnt vmcnt(4)
    v_pk_add_f32 v[148:149], v[148:149], v[228:229]
    v_pk_add_f32 v[150:151], v[150:151], v[230:231]
    v_pk_add_f32 v[154:155], v[148:149], v[150:151]
    v_add_f32 v154, v154, v152
    v_cmp_u_f32 vcc, v154, v155
    s_cbranch_vccz L_cok_107
    buffer_load_dwordx4 v[216:219], v16, s[8:11], s40 offen sc1
    buffer_load_dwordx4 v[220:223], v13, s[8:11], s40 offen sc1
    buffer_load_dwordx4 v[224:227], v14, s[8:11], s40 offen sc1
    buffer_load_dwordx4 v[228:231], v15, s[8:11], s40 offen sc1
    s_waitcnt vmcnt(7)
    v_permlane32_swap_b32 v200, v202
    v_permlane32_swap_b32 v201, v203
    s_waitcnt vmcnt(6)
    v_pk_add_f32 v[154:155], v[200:201], v[202:203]
    v_pk_add_f32 v[148:149], v[124:125], v[204:205]
    v_pk_add_f32 v[150:151], v[126:127], v[206:207]
    v_permlane16_swap_b32 v154, v155
    s_waitcnt vmcnt(5)
    v_pk_add_f32 v[148:149], v[148:149], v[208:209]
    v_pk_add_f32 v[150:151], v[150:151], v[210:211]
    v_add_f32 v152, v154, v155
    s_waitcnt vmcnt(4)
    v_pk_add_f32 v[148:149], v[148:149], v[212:213]
    v_pk_add_f32 v[150:151], v[150:151], v[214:215]
    v_pk_add_f32 v[154:155], v[148:149], v[150:151]
    v_add_f32 v154, v154, v152
    v_cmp_u_f32 vcc, v154, v155
    s_cbranch_vccz L_cok_107
    s_add_u32 s33, s33, 1
    s_cmp_gt_u32 s33, 0x100000
    s_cbranch_scc1 chain_kernel_abort
    s_and_b32 s20, s33, 63
    s_cbranch_scc1 L_rt_109
    v_cmp_eq_u32 vcc, s34, v200
    v_cmp_eq_u32 s[20:21], s34, v201
    s_or_b64 vcc, vcc, s[20:21]
    v_cmp_eq_u32 s[20:21], s34, v202
    s_or_b64 vcc, vcc, s[20:21]
    v_cmp_eq_u32 s[20:21], s34, v203
    s_or_b64 vcc, vcc, s[20:21]
    v_cmp_eq_u32 s[20:21], s34, v204
    s_or_b64 vcc, vcc, s[20:21]
    v_cmp_eq_u32 s[20:21], s34, v205
    s_or_b64 vcc, vcc, s[20:21]
    v_cmp_eq_u32 s[20:21], s34, v206
    s_or_b64 vcc, vcc, s[20:21]
    v_cmp_eq_u32 s[20:21], s34, v207
    s_or_b64 vcc, vcc, s[20:21]
    v_cmp_eq_u32 s[20:21], s34, v208
    s_or_b64 vcc, vcc, s[20:21]
    v_cmp_eq_u32 s[20:21], s34, v209
    s_or_b64 vcc, vcc, s[20:21]
    v_cmp_eq_u32 s[20:21], s34, v210
    s_or_b64 vcc, vcc, s[20:21]
    v_cmp_eq_u32 s[20:21], s34, v211
    s_or_b64 vcc, vcc, s[20:21]
    v_cmp_eq_u32 s[20:21], s34, v212
    s_or_b64 vcc, vcc, s[20:21]
    v_cmp_eq_u32 s[20:21], s34, v213
    s_or_b64 vcc, vcc, s[20:21]
    v_cmp_eq_u32 s[20:21], s34, v214
    s_or_b64 vcc, vcc, s[20:21]
    v_cmp_eq_u32 s[20:21], s34, v215
    s_or_b64 vcc, vcc, s[20:21]
    s_cbranch_vccnz L_rt_109
    s_branch L_cok_107
L_cok_107:
    v_cvt_pk_bf16_f32 v160, 0, v148
    v_cvt_pk_bf16_f32 v161, 0, v149
    v_cvt_pk_bf16_f32 v162, 0, v150
    v_cvt_pk_bf16_f32 v163, 0, v151
    v_cvt_pk_bf16_f32 v176, 0, v152
    s_branch L_chead_110
L_q_e_115:
    buffer_load_dwordx4 v[60:63], v5, s[8:11], s41 offen sc1
    s_waitcnt vmcnt(2)
    v_max3_u32 v7, v60, v61, v62
    v_max_u32 v7, v7, v63
    v_cmp_eq_u32 vcc, s34, v7
    s_cbranch_vccz L_ok_e_116
    s_add_u32 s33, s33, 1
    s_cmp_gt_u32 s33, 0x100000
    s_cbranch_scc0 L_q_e_115
    s_branch chain_kernel_abort
L_ok_e_116:
    v_smfmac_f32_16x16x64_bf16 v[88:91], v[60:63], a[216:223], v6
    v_smfmac_f32_16x16x64_bf16 v[92:95], v[60:63], a[248:255], v6
    s_branch L_gd_e_111
L_q_e_114:
    buffer_load_dwordx4 v[56:59], v4, s[8:11], s41 offen sc1
    s_waitcnt vmcnt(1)
    v_max3_u32 v7, v60, v61, v62
    v_max_u32 v7, v7, v63
    v_cmp_eq_u32 vcc, s34, v7
    s_cbranch_vccnz L_q_e_117
    v_smfmac_f32_16x16x64_bf16 v[88:91], v[60:63], a[216:223], v6
    v_smfmac_f32_16x16x64_bf16 v[92:95], v[60:63], a[248:255], v6
    s_branch L_q_e_118
L_q_e_118:
    buffer_load_dwordx4 v[56:59], v4, s[8:11], s41 offen sc1
    s_waitcnt vmcnt(2)
    v_max3_u32 v7, v56, v57, v58
    v_max_u32 v7, v7, v59
    v_cmp_eq_u32 vcc, s34, v7
    s_cbranch_vccz L_ok_e_119
    s_add_u32 s33, s33, 1
    s_cmp_gt_u32 s33, 0x100000
    s_cbranch_scc0 L_q_e_118
    s_branch chain_kernel_abort
L_ok_e_119:
    v_smfmac_f32_16x16x64_bf16 v[88:91], v[56:59], a[208:215], v6
    v_smfmac_f32_16x16x64_bf16 v[92:95], v[56:59], a[240:247], v6
    s_branch L_gd_e_111
L_q_e_117:
    buffer_load_dwordx4 v[60:63], v5, s[8:11], s41 offen sc1
    s_waitcnt vmcnt(2)
    v_max3_u32 v7, v56, v57, v58
    v_max_u32 v7, v7, v59
    v_cmp_eq_u32 vcc, s34, v7
    s_cbranch_vccz L_ok_e_120
    buffer_load_dwordx4 v[56:59], v4, s[8:11], s41 offen sc1
    s_waitcnt vmcnt(2)
    v_max3_u32 v7, v60, v61, v62
    v_max_u32 v7, v7, v63
    v_cmp_eq_u32 vcc, s34, v7
    s_cbranch_vccz L_ok_e_121
    s_add_u32 s33, s33, 1
    s_cmp_gt_u32 s33, 0x100000
    s_cbranch_scc0 L_q_e_117
    s_branch chain_kernel_abort
L_ok_e_120:
    v_smfmac_f32_16x16x64_bf16 v[88:91], v[56:59], a[208:215], v6
    v_smfmac_f32_16x16x64_bf16 v[92:95], v[56:59], a[240:247], v6
    s_branch L_q_e_115
L_ok_e_121:
    v_smfmac_f32_16x16x64_bf16 v[88:91], v[60:63], a[216:223], v6
    v_smfmac_f32_16x16x64_bf16 v[92:95], v[60:63], a[248:255], v6
    s_branch L_q_e_118
L_q_e_113:
    buffer_load_dwordx4 v[52:55], v3, s[8:11], s41 offen sc1
    s_waitcnt vmcnt(2)
    v_max3_u32 v7, v56, v57, v58
    v_max_u32 v7, v7, v59
    v_cmp_eq_u32 vcc, s34, v7
    s_cbranch_vccnz L_q_e_122
    v_smfmac_f32_16x16x64_bf16 v[88:91], v[56:59], a[208:215], v6
    v_smfmac_f32_16x16x64_bf16 v[92:95], v[56:59], a[240:247], v6
    s_branch L_q_e_123
L_q_e_123:
    buffer_load_dwordx4 v[52:55], v3, s[8:11], s41 offen sc1
    s_waitcnt vmcnt(2)
    v_max3_u32 v7, v60, v61, v62
    v_max_u32 v7, v7, v63
    v_cmp_eq_u32 vcc, s34, v7
    s_cbranch_vccnz L_q_e_124
    v_smfmac_f32_16x16x64_bf16 v[88:91], v[60:63], a[216:223], v6
    v_smfmac_f32_16x16x64_bf16 v[92:95], v[60:63], a[248:255], v6
    s_branch L_q_e_125
L_q_e_125:
    buffer_load_dwordx4 v[52:55], v3, s[8:11], s41 offen sc1
    s_waitcnt vmcnt(2)
    v_max3_u32 v7, v52, v53, v54
    v_max_u32 v7, v7, v55
    v_cmp_eq_u32 vcc, s34, v7
    s_cbranch_vccz L_ok_e_126
    s_add_u32 s33, s33, 1
    s_cmp_gt_u32 s33, 0x100000
    s_cbranch_scc0 L_q_e_125
    s_branch chain_kernel_abort
L_ok_e_126:
    v_smfmac_f32_16x16x64_bf16 v[88:91], v[52:55], a[200:207], v6
    v_smfmac_f32_16x16x64_bf16 v[92:95], v[52:55], a[232:239], v6
    s_branch L_gd_e_111
L_q_e_124:
    buffer_load_dwordx4 v[60:63], v5, s[8:11], s41 offen sc1
    s_waitcnt vmcnt(2)
    v_max3_u32 v7, v52, v53, v54
    v_max_u32 v7, v7, v55
    v_cmp_eq_u32 vcc, s34, v7
    s_cbranch_vccz L_ok_e_127
    buffer_load_dwordx4 v[52:55], v3, s[8:11], s41 offen sc1
    s_waitcnt vmcnt(2)
    v_max3_u32 v7, v60, v61, v62
    v_max_u32 v7, v7, v63
    v_cmp_eq_u32 vcc, s34, v7
    s_cbranch_vccz L_ok_e_128
    s_add_u32 s33, s33, 1
    s_cmp_gt_u32 s33, 0x100000
    s_cbranch_scc0 L_q_e_124
    s_branch chain_kernel_abort
L_ok_e_127:
    v_smfmac_f32_16x16x64_bf16 v[88:91], v[52:55], a[200:207], v6
    v_smfmac_f32_16x16x64_bf16 v[92:95], v[52:55], a[232:239], v6
    s_branch L_q_e_115
L_ok_e_128:
    v_smfmac_f32_16x16x64_bf16 v[88:91], v[60:63], a[216:223], v6
    v_smfmac_f32_16x16x64_bf16 v[92:95], v[60:63], a[248:255], v6
    s_branch L_q_e_125
L_q_e_122:
    buffer_load_dwordx4 v[56:59], v4, s[8:11], s41 offen sc1
    s_waitcnt vmcnt(2)
    v_max3_u32 v7, v60, v61, v62
    v_max_u32 v7, v7, v63
    v_cmp_eq_u32 vcc, s34, v7
    s_cbranch_vccnz L_q_e_129
    v_smfmac_f32_16x16x64_bf16 v[88:91], v[60:63], a[216:223], v6
    v_smfmac_f32_16x16x64_bf16 v[92:95], v[60:63], a[248:255], v6
    s_branch L_q_e_130
L_q_e_130:
    buffer_load_dwordx4 v[52:55], v3, s[8:11], s41 offen sc1
    s_waitcnt vmcnt(2)
    v_max3_u32 v7, v56, v57, v58
    v_max_u32 v7, v7, v59
    v_cmp_eq_u32 vcc, s34, v7
    s_cbranch_vccz L_ok_e_131
    buffer_load_dwordx4 v[56:59], v4, s[8:11], s41 offen sc1
    s_waitcnt vmcnt(2)
    v_max3_u32 v7, v52, v53, v54
    v_max_u32 v7, v7, v55
    v_cmp_eq_u32 vcc, s34, v7
    s_cbranch_vccz L_ok_e_132
    s_add_u32 s33, s33, 1
    s_cmp_gt_u32 s33, 0x100000
    s_cbranch_scc0 L_q_e_130
    s_branch chain_kernel_abort
L_ok_e_131:
    v_smfmac_f32_16x16x64_bf16 v[88:91], v[56:59], a[208:215], v6
    v_smfmac_f32_16x16x64_bf16 v[92:95], v[56:59], a[240:247], v6
    s_branch L_q_e_125
L_ok_e_132:
    v_smfmac_f32_16x16x64_bf16 v[88:91], v[52:55], a[200:207], v6
    v_smfmac_f32_16x16x64_bf16 v[92:95], v[52:55], a[232:239], v6
    s_branch L_q_e_118
L_q_e_129:
    buffer_load_dwordx4 v[60:63], v5, s[8:11], s41 offen sc1
    s_waitcnt vmcnt(2)
    v_max3_u32 v7, v52, v53, v54
    v_max_u32 v7, v7, v55
    v_cmp_eq_u32 vcc, s34, v7
    s_cbranch_vccz L_ok_e_133
    buffer_load_dwordx4 v[52:55], v3, s[8:11], s41 offen sc1
    s_waitcnt vmcnt(2)
    v_max3_u32 v7, v56, v57, v58
    v_max_u32 v7, v7, v59
    v_cmp_eq_u32 vcc, s34, v7
    s_cbranch_vccz L_ok_e_134
    buffer_load_dwordx4 v[56:59], v4, s[8:11], s41 offen sc1
    s_waitcnt vmcnt(2)
    v_max3_u32 v7, v60, v61, v62
    v_max_u32 v7, v7, v63
    v_cmp_eq_u32 vcc, s34, v7
    s_cbranch_vccz L_ok_e_135
    s_add_u32 s33, s33, 1
    s_cmp_gt_u32 s33, 0x100000
    s_cbranch_scc0 L_q_e_129
    s_branch chain_kernel_abort
L_ok_e_133:
    v_smfmac_f32_16x16x64_bf16 v[88:91], v[52:55], a[200:207], v6
    v_smfmac_f32_16x16x64_bf16 v[92:95], v[52:55], a[232:239], v6
    s_branch L_q_e_136
L_ok_e_134:
    v_smfmac_f32_16x16x64_bf16 v[88:91], v[56:59], a[208:215], v6
    v_smfmac_f32_16x16x64_bf16 v[92:95], v[56:59], a[240:247], v6
    s_branch L_q_e_137
L_ok_e_135:
    v_smfmac_f32_16x16x64_bf16 v[88:91], v[60:63], a[216:223], v6
    v_smfmac_f32_16x16x64_bf16 v[92:95], v[60:63], a[248:255], v6
    s_branch L_q_e_130
L_q_e_137:
    buffer_load_dwordx4 v[52:55], v3, s[8:11], s41 offen sc1
    s_waitcnt vmcnt(2)
    v_max3_u32 v7, v60, v61, v62
    v_max_u32 v7, v7, v63
    v_cmp_eq_u32 vcc, s34, v7
    s_cbranch_vccz L_ok_e_138
    buffer_load_dwordx4 v[60:63], v5, s[8:11], s41 offen sc1
    s_waitcnt vmcnt(2)
    v_max3_u32 v7, v52, v53, v54
    v_max_u32 v7, v7, v55
    v_cmp_eq_u32 vcc, s34, v7
    s_cbranch_vccz L_ok_e_139
    s_add_u32 s33, s33, 1
    s_cmp_gt_u32 s33, 0x100000
    s_cbranch_scc0 L_q_e_137
    s_branch chain_kernel_abort
L_ok_e_138:
    v_smfmac_f32_16x16x64_bf16 v[88:91], v[60:63], a[216:223], v6
    v_smfmac_f32_16x16x64_bf16 v[92:95], v[60:63], a[248:255], v6
    s_branch L_q_e_125
L_ok_e_139:
    v_smfmac_f32_16x16x64_bf16 v[88:91], v[52:55], a[200:207], v6
    v_smfmac_f32_16x16x64_bf16 v[92:95], v[52:55], a[232:239], v6
    s_branch L_q_e_115
L_q_e_136:
    buffer_load_dwordx4 v[56:59], v4, s[8:11], s41 offen sc1
    s_waitcnt vmcnt(2)
    v_max3_u32 v7, v60, v61, v62
    v_max_u32 v7, v7, v63
    v_cmp_eq_u32 vcc, s34, v7
    s_cbranch_vccz L_ok_e_140
    buffer_load_dwordx4 v[60:63], v5, s[8:11], s41 offen sc1
    s_waitcnt vmcnt(2)
    v_max3_u32 v7, v56, v57, v58
    v_max_u32 v7, v7, v59
    v_cmp_eq_u32 vcc, s34, v7
    s_cbranch_vccz L_ok_e_141
    s_add_u32 s33, s33, 1
    s_cmp_gt_u32 s33, 0x100000
    s_cbranch_scc0 L_q_e_136
    s_branch chain_kernel_abort
L_ok_e_140:
    v_smfmac_f32_16x16x64_bf16 v[88:91], v[60:63], a[216:223], v6
    v_smfmac_f32_16x16x64_bf16 v[92:95], v[60:63], a[248:255], v6
    s_branch L_q_e_118
L_ok_e_141:
    v_smfmac_f32_16x16x64_bf16 v[88:91], v[56:59], a[208:215], v6
    v_smfmac_f32_16x16x64_bf16 v[92:95], v[56:59], a[240:247], v6
    s_branch L_q_e_115
L_q_e_112:
    buffer_load_dwordx4 v[48:51], v2, s[8:11], s41 offen sc1
    s_waitcnt vmcnt(3)
    v_max3_u32 v7, v52, v53, v54
    v_max_u32 v7, v7, v55
    v_cmp_eq_u32 vcc, s34, v7
    s_cbranch_vccnz L_q_e_142
    v_smfmac_f32_16x16x64_bf16 v[88:91], v[52:55], a[200:207], v6
    v_smfmac_f32_16x16x64_bf16 v[92:95], v[52:55], a[232:239], v6
    s_branch L_q_e_143
L_q_e_143:
    buffer_load_dwordx4 v[48:51], v2, s[8:11], s41 offen sc1
    s_waitcnt vmcnt(3)
    v_max3_u32 v7, v56, v57, v58
    v_max_u32 v7, v7, v59
    v_cmp_eq_u32 vcc, s34, v7
    s_cbranch_vccnz L_q_e_144
    v_smfmac_f32_16x16x64_bf16 v[88:91], v[56:59], a[208:215], v6
    v_smfmac_f32_16x16x64_bf16 v[92:95], v[56:59], a[240:247], v6
    s_branch L_q_e_145
L_q_e_145:
    buffer_load_dwordx4 v[48:51], v2, s[8:11], s41 offen sc1
    s_waitcnt vmcnt(3)
    v_max3_u32 v7, v60, v61, v62
    v_max_u32 v7, v7, v63
    v_cmp_eq_u32 vcc, s34, v7
    s_cbranch_vccnz L_q_e_146
    v_smfmac_f32_16x16x64_bf16 v[88:91], v[60:63], a[216:223], v6
    v_smfmac_f32_16x16x64_bf16 v[92:95], v[60:63], a[248:255], v6
    s_branch L_q_e_147
L_q_e_147:
    buffer_load_dwordx4 v[48:51], v2, s[8:11], s41 offen sc1
    s_waitcnt vmcnt(2)
    v_max3_u32 v7, v48, v49, v50
    v_max_u32 v7, v7, v51
    v_cmp_eq_u32 vcc, s34, v7
    s_cbranch_vccz L_ok_e_148
    s_add_u32 s33, s33, 1
    s_cmp_gt_u32 s33, 0x100000
    s_cbranch_scc0 L_q_e_147
    s_branch chain_kernel_abort
L_ok_e_148:
    v_smfmac_f32_16x16x64_bf16 v[88:91], v[48:51], a[192:199], v6
    v_smfmac_f32_16x16x64_bf16 v[92:95], v[48:51], a[224:231], v6
    s_branch L_gd_e_111
L_q_e_146:
    buffer_load_dwordx4 v[60:63], v5, s[8:11], s41 offen sc1
    s_waitcnt vmcnt(2)
    v_max3_u32 v7, v48, v49, v50
    v_max_u32 v7, v7, v51
    v_cmp_eq_u32 vcc, s34, v7
    s_cbranch_vccz L_ok_e_149
    buffer_load_dwordx4 v[48:51], v2, s[8:11], s41 offen sc1
    s_waitcnt vmcnt(2)
    v_max3_u32 v7, v60, v61, v62
    v_max_u32 v7, v7, v63
    v_cmp_eq_u32 vcc, s34, v7
    s_cbranch_vccz L_ok_e_150
    s_add_u32 s33, s33, 1
    s_cmp_gt_u32 s33, 0x100000
    s_cbranch_scc0 L_q_e_146
    s_branch chain_kernel_abort
L_ok_e_149:
    v_smfmac_f32_16x16x64_bf16 v[88:91], v[48:51], a[192:199], v6
    v_smfmac_f32_16x16x64_bf16 v[92:95], v[48:51], a[224:231], v6
    s_branch L_q_e_115
L_ok_e_150:
    v_smfmac_f32_16x16x64_bf16 v[88:91], v[60:63], a[216:223], v6
    v_smfmac_f32_16x16x64_bf16 v[92:95], v[60:63], a[248:255], v6
    s_branch L_q_e_147
L_q_e_144:
    buffer_load_dwordx4 v[56:59], v4, s[8:11], s41 offen sc1
    s_waitcnt vmcnt(3)
    v_max3_u32 v7, v60, v61, v62
    v_max_u32 v7, v7, v63
    v_cmp_eq_u32 vcc, s34, v7
    s_cbranch_vccnz L_q_e_151
    v_smfmac_f32_16x16x64_bf16 v[88:91], v[60:63], a[216:223], v6
    v_smfmac_f32_16x16x64_bf16 v[92:95], v[60:63], a[248:255], v6
    s_branch L_q_e_152
L_q_e_152:
    buffer_load_dwordx4 v[48:51], v2, s[8:11], s41 offen sc1
    s_waitcnt vmcnt(2)
    v_max3_u32 v7, v56, v57, v58
    v_max_u32 v7, v7, v59
    v_cmp_eq_u32 vcc, s34, v7
    s_cbranch_vccz L_ok_e_153
    buffer_load_dwordx4 v[56:59], v4, s[8:11], s41 offen sc1
    s_waitcnt vmcnt(2)
    v_max3_u32 v7, v48, v49, v50
    v_max_u32 v7, v7, v51
    v_cmp_eq_u32 vcc, s34, v7
    s_cbranch_vccz L_ok_e_154
    s_add_u32 s33, s33, 1
    s_cmp_gt_u32 s33, 0x100000
    s_cbranch_scc0 L_q_e_152
    s_branch chain_kernel_abort
L_ok_e_153:
    v_smfmac_f32_16x16x64_bf16 v[88:91], v[56:59], a[208:215], v6
    v_smfmac_f32_16x16x64_bf16 v[92:95], v[56:59], a[240:247], v6
    s_branch L_q_e_147
L_ok_e_154:
    v_smfmac_f32_16x16x64_bf16 v[88:91], v[48:51], a[192:199], v6
    v_smfmac_f32_16x16x64_bf16 v[92:95], v[48:51], a[224:231], v6
    s_branch L_q_e_118
L_q_e_151:
    buffer_load_dwordx4 v[60:63], v5, s[8:11], s41 offen sc1
    s_waitcnt vmcnt(2)
    v_max3_u32 v7, v48, v49, v50
    v_max_u32 v7, v7, v51
    v_cmp_eq_u32 vcc, s34, v7
    s_cbranch_vccz L_ok_e_155
    buffer_load_dwordx4 v[48:51], v2, s[8:11], s41 offen sc1
    s_waitcnt vmcnt(2)
    v_max3_u32 v7, v56, v57, v58
    v_max_u32 v7, v7, v59
    v_cmp_eq_u32 vcc, s34, v7
    s_cbranch_vccz L_ok_e_156
    buffer_load_dwordx4 v[56:59], v4, s[8:11], s41 offen sc1
    s_waitcnt vmcnt(2)
    v_max3_u32 v7, v60, v61, v62
    v_max_u32 v7, v7, v63
    v_cmp_eq_u32 vcc, s34, v7
    s_cbranch_vccz L_ok_e_157
    s_add_u32 s33, s33, 1
    s_cmp_gt_u32 s33, 0x100000
    s_cbranch_scc0 L_q_e_151
    s_branch chain_kernel_abort
L_ok_e_155:
    v_smfmac_f32_16x16x64_bf16 v[88:91], v[48:51], a[192:199], v6
    v_smfmac_f32_16x16x64_bf16 v[92:95], v[48:51], a[224:231], v6
    s_branch L_q_e_136
L_ok_e_156:
    v_smfmac_f32_16x16x64_bf16 v[88:91], v[56:59], a[208:215], v6
    v_smfmac_f32_16x16x64_bf16 v[92:95], v[56:59], a[240:247], v6
    s_branch L_q_e_158
L_ok_e_157:
    v_smfmac_f32_16x16x64_bf16 v[88:91], v[60:63], a[216:223], v6
    v_smfmac_f32_16x16x64_bf16 v[92:95], v[60:63], a[248:255], v6
    s_branch L_q_e_152
L_q_e_158:
    buffer_load_dwordx4 v[48:51], v2, s[8:11], s41 offen sc1
    s_waitcnt vmcnt(2)
    v_max3_u32 v7, v60, v61, v62
    v_max_u32 v7, v7, v63
    v_cmp_eq_u32 vcc, s34, v7
    s_cbranch_vccz L_ok_e_159
    buffer_load_dwordx4 v[60:63], v5, s[8:11], s41 offen sc1
    s_waitcnt vmcnt(2)
    v_max3_u32 v7, v48, v49, v50
    v_max_u32 v7, v7, v51
    v_cmp_eq_u32 vcc, s34, v7
    s_cbranch_vccz L_ok_e_160
    s_add_u32 s33, s33, 1
    s_cmp_gt_u32 s33, 0x100000
    s_cbranch_scc0 L_q_e_158
    s_branch chain_kernel_abort
L_ok_e_159:
    v_smfmac_f32_16x16x64_bf16 v[88:91], v[60:63], a[216:223], v6
    v_smfmac_f32_16x16x64_bf16 v[92:95], v[60:63], a[248:255], v6
    s_branch L_q_e_147
L_ok_e_160:
    v_smfmac_f32_16x16x64_bf16 v[88:91], v[48:51], a[192:199], v6
    v_smfmac_f32_16x16x64_bf16 v[92:95], v[48:51], a[224:231], v6
    s_branch L_q_e_115
L_q_e_142:
    buffer_load_dwordx4 v[52:55], v3, s[8:11], s41 offen sc1
    s_waitcnt vmcnt(3)
    v_max3_u32 v7, v56, v57, v58
    v_max_u32 v7, v7, v59
    v_cmp_eq_u32 vcc, s34, v7
    s_cbranch_vccnz L_q_e_161
    v_smfmac_f32_16x16x64_bf16 v[88:91], v[56:59], a[208:215], v6
    v_smfmac_f32_16x16x64_bf16 v[92:95], v[56:59], a[240:247], v6
    s_branch L_q_e_162
L_q_e_162:
    buffer_load_dwordx4 v[48:51], v2, s[8:11], s41 offen sc1
    s_waitcnt vmcnt(3)
    v_max3_u32 v7, v60, v61, v62
    v_max_u32 v7, v7, v63
    v_cmp_eq_u32 vcc, s34, v7
    s_cbranch_vccnz L_q_e_163
    v_smfmac_f32_16x16x64_bf16 v[88:91], v[60:63], a[216:223], v6
    v_smfmac_f32_16x16x64_bf16 v[92:95], v[60:63], a[248:255], v6
    s_branch L_q_e_164
L_q_e_164:
    buffer_load_dwordx4 v[52:55], v3, s[8:11], s41 offen sc1
    s_waitcnt vmcnt(2)
    v_max3_u32 v7, v48, v49, v50
    v_max_u32 v7, v7, v51
    v_cmp_eq_u32 vcc, s34, v7
    s_cbranch_vccz L_ok_e_165
    buffer_load_dwordx4 v[48:51], v2, s[8:11], s41 offen sc1
    s_waitcnt vmcnt(2)
    v_max3_u32 v7, v52, v53, v54
    v_max_u32 v7, v7, v55
    v_cmp_eq_u32 vcc, s34, v7
    s_cbranch_vccz L_ok_e_166
    s_add_u32 s33, s33, 1
    s_cmp_gt_u32 s33, 0x100000
    s_cbranch_scc0 L_q_e_164
    s_branch chain_kernel_abort
L_ok_e_165:
    v_smfmac_f32_16x16x64_bf16 v[88:91], v[48:51], a[192:199], v6
    v_smfmac_f32_16x16x64_bf16 v[92:95], v[48:51], a[224:231], v6
    s_branch L_q_e_125
L_ok_e_166:
    v_smfmac_f32_16x16x64_bf16 v[88:91], v[52:55], a[200:207], v6
    v_smfmac_f32_16x16x64_bf16 v[92:95], v[52:55], a[232:239], v6
    s_branch L_q_e_147
L_q_e_163:
    buffer_load_dwordx4 v[60:63], v5, s[8:11], s41 offen sc1
    s_waitcnt vmcnt(2)
    v_max3_u32 v7, v52, v53, v54
    v_max_u32 v7, v7, v55
    v_cmp_eq_u32 vcc, s34, v7
    s_cbranch_vccz L_ok_e_167
    buffer_load_dwordx4 v[52:55], v3, s[8:11], s41 offen sc1
    s_waitcnt vmcnt(2)
    v_max3_u32 v7, v48, v49, v50
    v_max_u32 v7, v7, v51
    v_cmp_eq_u32 vcc, s34, v7
    s_cbranch_vccz L_ok_e_168
    buffer_load_dwordx4 v[48:51], v2, s[8:11], s41 offen sc1
    s_waitcnt vmcnt(2)
    v_max3_u32 v7, v60, v61, v62
    v_max_u32 v7, v7, v63
    v_cmp_eq_u32 vcc, s34, v7
    s_cbranch_vccz L_ok_e_169
    s_add_u32 s33, s33, 1
    s_cmp_gt_u32 s33, 0x100000
    s_cbranch_scc0 L_q_e_163
    s_branch chain_kernel_abort
L_ok_e_167:
    v_smfmac_f32_16x16x64_bf16 v[88:91], v[52:55], a[200:207], v6
    v_smfmac_f32_16x16x64_bf16 v[92:95], v[52:55], a[232:239], v6
    s_branch L_q_e_158
L_ok_e_168:
    v_smfmac_f32_16x16x64_bf16 v[88:91], v[48:51], a[192:199], v6
    v_smfmac_f32_16x16x64_bf16 v[92:95], v[48:51], a[224:231], v6
    s_branch L_q_e_137
L_ok_e_169:
    v_smfmac_f32_16x16x64_bf16 v[88:91], v[60:63], a[216:223], v6
    v_smfmac_f32_16x16x64_bf16 v[92:95], v[60:63], a[248:255], v6
    s_branch L_q_e_170
L_q_e_170:
    buffer_load_dwordx4 v[48:51], v2, s[8:11], s41 offen sc1
    s_waitcnt vmcnt(2)
    v_max3_u32 v7, v52, v53, v54
    v_max_u32 v7, v7, v55
    v_cmp_eq_u32 vcc, s34, v7
    s_cbranch_vccz L_ok_e_171
    buffer_load_dwordx4 v[52:55], v3, s[8:11], s41 offen sc1
    s_waitcnt vmcnt(2)
    v_max3_u32 v7, v48, v49, v50
    v_max_u32 v7, v7, v51
    v_cmp_eq_u32 vcc, s34, v7
    s_cbranch_vccz L_ok_e_172
    s_add_u32 s33, s33, 1
    s_cmp_gt_u32 s33, 0x100000
    s_cbranch_scc0 L_q_e_170
    s_branch chain_kernel_abort
L_ok_e_171:
    v_smfmac_f32_16x16x64_bf16 v[88:91], v[52:55], a[200:207], v6
    v_smfmac_f32_16x16x64_bf16 v[92:95], v[52:55], a[232:239], v6
    s_branch L_q_e_147
L_ok_e_172:
    v_smfmac_f32_16x16x64_bf16 v[88:91], v[48:51], a[192:199], v6
    v_smfmac_f32_16x16x64_bf16 v[92:95], v[48:51], a[224:231], v6
    s_branch L_q_e_125
L_q_e_161:
    buffer_load_dwordx4 v[56:59], v4, s[8:11], s41 offen sc1
    s_waitcnt vmcnt(3)
    v_max3_u32 v7, v60, v61, v62
    v_max_u32 v7, v7, v63
    v_cmp_eq_u32 vcc, s34, v7
    s_cbranch_vccnz L_q_e_173
    v_smfmac_f32_16x16x64_bf16 v[88:91], v[60:63], a[216:223], v6
    v_smfmac_f32_16x16x64_bf16 v[92:95], v[60:63], a[248:255], v6
    s_branch L_q_e_174
L_q_e_174:
    buffer_load_dwordx4 v[48:51], v2, s[8:11], s41 offen sc1
    s_waitcnt vmcnt(2)
    v_max3_u32 v7, v52, v53, v54
    v_max_u32 v7, v7, v55
    v_cmp_eq_u32 vcc, s34, v7
    s_cbranch_vccz L_ok_e_175
    buffer_load_dwordx4 v[52:55], v3, s[8:11], s41 offen sc1
    s_waitcnt vmcnt(2)
    v_max3_u32 v7, v56, v57, v58
    v_max_u32 v7, v7, v59
    v_cmp_eq_u32 vcc, s34, v7
    s_cbranch_vccz L_ok_e_176
    buffer_load_dwordx4 v[56:59], v4, s[8:11], s41 offen sc1
    s_waitcnt vmcnt(2)
    v_max3_u32 v7, v48, v49, v50
    v_max_u32 v7, v7, v51
    v_cmp_eq_u32 vcc, s34, v7
    s_cbranch_vccz L_ok_e_177
    s_add_u32 s33, s33, 1
    s_cmp_gt_u32 s33, 0x100000
    s_cbranch_scc0 L_q_e_174
    s_branch chain_kernel_abort
L_ok_e_175:
    v_smfmac_f32_16x16x64_bf16 v[88:91], v[52:55], a[200:207], v6
    v_smfmac_f32_16x16x64_bf16 v[92:95], v[52:55], a[232:239], v6
    s_branch L_q_e_152
L_ok_e_176:
    v_smfmac_f32_16x16x64_bf16 v[88:91], v[56:59], a[208:215], v6
    v_smfmac_f32_16x16x64_bf16 v[92:95], v[56:59], a[240:247], v6
    s_branch L_q_e_170
L_ok_e_177:
    v_smfmac_f32_16x16x64_bf16 v[88:91], v[48:51], a[192:199], v6
    v_smfmac_f32_16x16x64_bf16 v[92:95], v[48:51], a[224:231], v6
    s_branch L_q_e_130
L_q_e_173:
    buffer_load_dwordx4 v[60:63], v5, s[8:11], s41 offen sc1
    s_waitcnt vmcnt(2)
    v_max3_u32 v7, v48, v49, v50
    v_max_u32 v7, v7, v51
    v_cmp_eq_u32 vcc, s34, v7
    s_cbranch_vccz L_ok_e_178
    buffer_load_dwordx4 v[48:51], v2, s[8:11], s41 offen sc1
    s_waitcnt vmcnt(2)
    v_max3_u32 v7, v52, v53, v54
    v_max_u32 v7, v7, v55
    v_cmp_eq_u32 vcc, s34, v7
    s_cbranch_vccz L_ok_e_179
    buffer_load_dwordx4 v[52:55], v3, s[8:11], s41 offen sc1
    s_waitcnt vmcnt(2)
    v_max3_u32 v7, v56, v57, v58
    v_max_u32 v7, v7, v59
    v_cmp_eq_u32 vcc, s34, v7
    s_cbranch_vccz L_ok_e_180
    buffer_load_dwordx4 v[56:59], v4, s[8:11], s41 offen sc1
    s_waitcnt vmcnt(2)
    v_max3_u32 v7, v60, v61, v62
    v_max_u32 v7, v7, v63
    v_cmp_eq_u32 vcc, s34, v7
    s_cbranch_vccz L_ok_e_181
    s_add_u32 s33, s33, 1
    s_cmp_gt_u32 s33, 0x100000
    s_cbranch_scc0 L_q_e_173
    s_branch chain_kernel_abort
L_ok_e_178:
    v_smfmac_f32_16x16x64_bf16 v[88:91], v[48:51], a[192:199], v6
    v_smfmac_f32_16x16x64_bf16 v[92:95], v[48:51], a[224:231], v6
    s_branch L_q_e_182
L_ok_e_179:
    v_smfmac_f32_16x16x64_bf16 v[88:91], v[52:55], a[200:207], v6
    v_smfmac_f32_16x16x64_bf16 v[92:95], v[52:55], a[232:239], v6
    s_branch L_q_e_183
L_ok_e_180:
    v_smfmac_f32_16x16x64_bf16 v[88:91], v[56:59], a[208:215], v6
    v_smfmac_f32_16x16x64_bf16 v[92:95], v[56:59], a[240:247], v6
    s_branch L_q_e_184
L_ok_e_181:
    v_smfmac_f32_16x16x64_bf16 v[88:91], v[60:63], a[216:223], v6
    v_smfmac_f32_16x16x64_bf16 v[92:95], v[60:63], a[248:255], v6
    s_branch L_q_e_174
L_q_e_184:
    buffer_load_dwordx4 v[48:51], v2, s[8:11], s41 offen sc1
    s_waitcnt vmcnt(2)
    v_max3_u32 v7, v52, v53, v54
    v_max_u32 v7, v7, v55
    v_cmp_eq_u32 vcc, s34, v7
    s_cbranch_vccz L_ok_e_185
    buffer_load_dwordx4 v[52:55], v3, s[8:11], s41 offen sc1
    s_waitcnt vmcnt(2)
    v_max3_u32 v7, v60, v61, v62
    v_max_u32 v7, v7, v63
    v_cmp_eq_u32 vcc, s34, v7
    s_cbranch_vccz L_ok_e_186
    buffer_load_dwordx4 v[60:63], v5, s[8:11], s41 offen sc1
    s_waitcnt vmcnt(2)
    v_max3_u32 v7, v48, v49, v50
    v_max_u32 v7, v7, v51
    v_cmp_eq_u32 vcc, s34, v7
    s_cbranch_vccz L_ok_e_187
    s_add_u32 s33, s33, 1
    s_cmp_gt_u32 s33, 0x100000
    s_cbranch_scc0 L_q_e_184
    s_branch chain_kernel_abort
L_ok_e_185:
    v_smfmac_f32_16x16x64_bf16 v[88:91], v[52:55], a[200:207], v6
    v_smfmac_f32_16x16x64_bf16 v[92:95], v[52:55], a[232:239], v6
    s_branch L_q_e_158
L_ok_e_186:
    v_smfmac_f32_16x16x64_bf16 v[88:91], v[60:63], a[216:223], v6
    v_smfmac_f32_16x16x64_bf16 v[92:95], v[60:63], a[248:255], v6
    s_branch L_q_e_170
L_ok_e_187:
    v_smfmac_f32_16x16x64_bf16 v[88:91], v[48:51], a[192:199], v6
    v_smfmac_f32_16x16x64_bf16 v[92:95], v[48:51], a[224:231], v6
    s_branch L_q_e_137
L_q_e_183:
    buffer_load_dwordx4 v[48:51], v2, s[8:11], s41 offen sc1
    s_waitcnt vmcnt(2)
    v_max3_u32 v7, v56, v57, v58
    v_max_u32 v7, v7, v59
    v_cmp_eq_u32 vcc, s34, v7
    s_cbranch_vccz L_ok_e_188
    buffer_load_dwordx4 v[56:59], v4, s[8:11], s41 offen sc1
    s_waitcnt vmcnt(2)
    v_max3_u32 v7, v60, v61, v62
    v_max_u32 v7, v7, v63
    v_cmp_eq_u32 vcc, s34, v7
    s_cbranch_vccz L_ok_e_189
    buffer_load_dwordx4 v[60:63], v5, s[8:11], s41 offen sc1
    s_waitcnt vmcnt(2)
    v_max3_u32 v7, v48, v49, v50
    v_max_u32 v7, v7, v51
    v_cmp_eq_u32 vcc, s34, v7
    s_cbranch_vccz L_ok_e_190
    s_add_u32 s33, s33, 1
    s_cmp_gt_u32 s33, 0x100000
    s_cbranch_scc0 L_q_e_183
    s_branch chain_kernel_abort
L_ok_e_188:
    v_smfmac_f32_16x16x64_bf16 v[88:91], v[56:59], a[208:215], v6
    v_smfmac_f32_16x16x64_bf16 v[92:95], v[56:59], a[240:247], v6
    s_branch L_q_e_158
L_ok_e_189:
    v_smfmac_f32_16x16x64_bf16 v[88:91], v[60:63], a[216:223], v6
    v_smfmac_f32_16x16x64_bf16 v[92:95], v[60:63], a[248:255], v6
    s_branch L_q_e_152
L_ok_e_190:
    v_smfmac_f32_16x16x64_bf16 v[88:91], v[48:51], a[192:199], v6
    v_smfmac_f32_16x16x64_bf16 v[92:95], v[48:51], a[224:231], v6
    s_branch L_q_e_136
L_q_e_182:
    buffer_load_dwordx4 v[52:55], v3, s[8:11], s41 offen sc1
    s_waitcnt vmcnt(2)
    v_max3_u32 v7, v56, v57, v58
    v_max_u32 v7, v7, v59
    v_cmp_eq_u32 vcc, s34, v7
    s_cbranch_vccz L_ok_e_191
    buffer_load_dwordx4 v[56:59], v4, s[8:11], s41 offen sc1
    s_waitcnt vmcnt(2)
    v_max3_u32 v7, v60, v61, v62
    v_max_u32 v7, v7, v63
    v_cmp_eq_u32 vcc, s34, v7
    s_cbranch_vccz L_ok_e_192
    buffer_load_dwordx4 v[60:63], v5, s[8:11], s41 offen sc1
    s_waitcnt vmcnt(2)
    v_max3_u32 v7, v52, v53, v54
    v_max_u32 v7, v7, v55
    v_cmp_eq_u32 vcc, s34, v7
    s_cbranch_vccz L_ok_e_193
    s_add_u32 s33, s33, 1
    s_cmp_gt_u32 s33, 0x100000
    s_cbranch_scc0 L_q_e_182
    s_branch chain_kernel_abort
L_ok_e_191:
    v_smfmac_f32_16x16x64_bf16 v[88:91], v[56:59], a[208:215], v6
    v_smfmac_f32_16x16x64_bf16 v[92:95], v[56:59], a[240:247], v6
    s_branch L_q_e_137
L_ok_e_192:
    v_smfmac_f32_16x16x64_bf16 v[88:91], v[60:63], a[216:223], v6
    v_smfmac_f32_16x16x64_bf16 v[92:95], v[60:63], a[248:255], v6
    s_branch L_q_e_130
L_ok_e_193:
    v_smfmac_f32_16x16x64_bf16 v[88:91], v[52:55], a[200:207], v6
    v_smfmac_f32_16x16x64_bf16 v[92:95], v[52:55], a[232:239], v6
    s_branch L_q_e_136
L_gf_194:
    s_waitcnt vmcnt(4)
    v_pk_add_f32 v[148:149], v[168:169], v[212:213]
    v_pk_add_f32 v[150:151], v[170:171], v[214:215]
    s_waitcnt vmcnt(3)
    v_pk_add_f32 v[148:149], v[148:149], v[216:217]
    v_pk_add_f32 v[150:151], v[150:151], v[218:219]
    s_waitcnt vmcnt(2)
    v_pk_add_f32 v[148:149], v[148:149], v[220:221]
    v_pk_add_f32 v[150:151], v[150:151], v[222:223]
    v_pk_add_f32 v[154:155], v[148:149], v[150:151]
    v_cmp_u_f32 vcc, v154, v155
    v_cvt_pk_bf16_f32 v180, v148, v149
    v_cvt_pk_bf16_f32 v181, v150, v151
    s_cbranch_vccz L_gok_195
    buffer_load_dwordx4 v[212:215], v17, s[8:11], s22 offen offset:1024 sc1
    buffer_load_dwordx4 v[216:219], v18, s[8:11], s22 offen offset:1024 sc1
    buffer_load_dwordx4 v[220:223], v19, s[8:11], s22 offen offset:1024 sc1
    s_nop 11
L_rt_197:
    buffer_load_dwordx4 v[200:203], v17, s[8:11], s22 offen offset:0 sc1
    buffer_load_dwordx4 v[204:207], v18, s[8:11], s22 offen offset:0 sc1
    buffer_load_dwordx4 v[208:211], v19, s[8:11], s22 offen offset:0 sc1
    s_waitcnt vmcnt(5)
    v_pk_add_f32 v[148:149], v[168:169], v[212:213]
    v_pk_add_f32 v[150:151], v[170:171], v[214:215]
    s_waitcnt vmcnt(4)
    v_pk_add_f32 v[148:149], v[148:149], v[216:217]
    v_pk_add_f32 v[150:151], v[150:151], v[218:219]
    s_waitcnt vmcnt(3)
    v_pk_add_f32 v[148:149], v[148:149], v[220:221]
    v_pk_add_f32 v[150:151], v[150:151], v[222:223]
    v_pk_add_f32 v[154:155], v[148:149], v[150:151]
    v_cmp_u_f32 vcc, v154, v155
    v_cvt_pk_bf16_f32 v180, v148, v149
    v_cvt_pk_bf16_f32 v181, v150, v151
    s_cbranch_vccz L_gok_195
    buffer_load_dwordx4 v[212:215], v17, s[8:11], s22 offen offset:1024 sc1
    buffer_load_dwordx4 v[216:219], v18, s[8:11], s22 offen offset:1024 sc1
    buffer_load_dwordx4 v[220:223], v19, s[8:11], s22 offen offset:1024 sc1
    s_waitcnt vmcnt(5)
    v_pk_add_f32 v[148:149], v[168:169], v[200:201]
    v_pk_add_f32 v[150:151], v[170:171], v[202:203]
    s_waitcnt vmcnt(4)
    v_pk_add_f32 v[148:149], v[148:149], v[204:205]
    v_pk_add_f32 v[150:151], v[150:151], v[206:207]
    s_waitcnt vmcnt(3)
    v_pk_add_f32 v[148:149], v[148:149], v[208:209]
    v_pk_add_f32 v[150:151], v[150:151], v[210:211]
    v_pk_add_f32 v[154:155], v[148:149], v[150:151]
    v_cmp_u_f32 vcc, v154, v155
    v_cvt_pk_bf16_f32 v180, v148, v149
    v_cvt_pk_bf16_f32 v181, v150, v151
    s_cbranch_vccz L_gok_195
    s_add_u32 s33, s33, 1
    s_cmp_gt_u32 s33, 0x100000
    s_cbranch_scc1 chain_kernel_abort
    s_and_b32 s20, s33, 63
    s_cbranch_scc1 L_rt_197
    v_cmp_eq_u32 vcc, s34, v200
    v_cmp_eq_u32 s[20:21], s34, v201
    s_or_b64 vcc, vcc, s[20:21]
    v_cmp_eq_u32 s[20:21], s34, v202
    s_or_b64 vcc, vcc, s[20:21]
    v_cmp_eq_u32 s[20:21], s34, v203
    s_or_b64 vcc, vcc, s[20:21]
    v_cmp_eq_u32 s[20:21], s34, v204
    s_or_b64 vcc, vcc, s[20:21]
    v_cmp_eq_u32 s[20:21], s34, v205
    s_or_b64 vcc, vcc, s[20:21]
    v_cmp_eq_u32 s[20:21], s34, v206
    s_or_b64 vcc, vcc, s[20:21]
    v_cmp_eq_u32 s[20:21], s34, v207
    s_or_b64 vcc, vcc, s[20:21]
    v_cmp_eq_u32 s[20:21], s34, v208
    s_or_b64 vcc, vcc, s[20:21]
    v_cmp_eq_u32 s[20:21], s34, v209
    s_or_b64 vcc, vcc, s[20:21]
    v_cmp_eq_u32 s[20:21], s34, v210
    s_or_b64 vcc, vcc, s[20:21]
    v_cmp_eq_u32 s[20:21], s34, v211
    s_or_b64 vcc, vcc, s[20:21]
    s_cbranch_vccnz L_rt_197
    s_branch L_gok_195
chain_kernel_abort:
    s_mov_b64 exec, 1
    v_mov_b32 v1, s19
    v_or_b32 v1, 0xdead0000, v1
    v_mov_b32 v2, 124
    buffer_store_dword v1, v2, s[12:15], 0 offen
chain_kernel_done:
    s_endpgm
chain_kernel_worker:
    s_sub_u32 s40, s16, 4
    s_mov_b32 s41, s17
    s_mov_b32 s49, s18
    s_mov_b32 s12, s100
    s_and_b32 s13, s101, 0xffff
    s_mov_b32 s14, 0x10000000
    s_mov_b32 s15, 0x00020000
    s_mov_b32 s36, 0
    v_mov_b32 v84, 1
    v_min_u32 v85, 1, v0
    v_lshlrev_b32 v85, 30, v85
    s_cmp_eq_u32 s40, 3
    s_cbranch_scc1 L_g1_203
    s_mov_b32 s25, s40
    s_cmp_eq_u32 s25, 1
    s_cselect_b32 s16, s90, s88
    s_cselect_b32 s17, s91, s89
    s_cmp_eq_u32 s25, 2
    s_cselect_b32 s16, s86, s16
    s_cselect_b32 s17, s87, s17
    s_and_b32 s17, s17, 0xffff
    s_mov_b32 s18, 0x800000
    s_mov_b32 s19, 0x00020000
    s_mov_b32 s46, s41
    s_lshl_b32 s44, s46, 8
    s_mov_b32 s8, s82
    s_and_b32 s9, s83, 0xffff
    s_mov_b32 s10, 0x400000
    s_mov_b32 s11, 0x00020000
    v_lshlrev_b32 v1, 4, v0
    s_lshl_b32 s25, s41, 12
    buffer_load_dwordx4 v[52:55], v1, s[8:11], s25 offen
    s_add_u32 s25, s25, 131072
    buffer_load_dwordx4 v[52:55], v1, s[8:11], s25 offen
    s_add_u32 s25, s25, 131072
    v_and_b32 v1, 15, v0
    v_bfe_u32 v2, v0, 4, 2
    v_lshrrev_b32 v3, 6, v0
    v_lshlrev_b32 v4, 2, v2
    v_xor_b32 v4, v4, v1
    v_lshlrev_b32 v4, 4, v4
    v_lshl_add_u32 v5, v3, 5, v2
    s_mov_b32 s25, 8192
    v_mul_lo_u32 v5, v5, s25
    v_add_u32 v20, v5, v4
    v_bfe_u32 v4, v0, 2, 2
    v_lshl_add_u32 v5, v2, 3, v4
    v_lshlrev_b32 v5, 8, v5
    v_xor_b32 v4, v4, v3
    v_lshl_add_u32 v5, v4, 6, v5
    v_and_b32 v4, 3, v0
    v_lshl_add_u32 v5, v4, 3, v5
    v_and_b32 v4, 2, v4
    v_lshl_add_u32 v21, v4, 3, v5
    v_add_u32 v22, 16, v21
    v_add_u32 v23, 0x10000, v21
    v_add_u32 v24, 0x10000, v22
    s_lshl_b32 s26, s49, 13
    s_mov_b32 s25, s44
    s_barrier
    s_add_u32 m0, s26, 0
    s_add_u32 s27, s25, 0
    buffer_load_dwordx4 v20, s[16:19], s27 offen lds
    s_add_u32 m0, s26, 1024
    s_add_u32 s27, s25, 32768
    buffer_load_dwordx4 v20, s[16:19], s27 offen lds
    s_add_u32 m0, s26, 2048
    s_add_u32 s27, s25, 65536
    buffer_load_dwordx4 v20, s[16:19], s27 offen lds
    s_add_u32 m0, s26, 3072
    s_add_u32 s27, s25, 98304
    buffer_load_dwordx4 v20, s[16:19], s27 offen lds
    s_add_u32 m0, s26, 4096
    s_add_u32 s27, s25, 131072
    buffer_load_dwordx4 v20, s[16:19], s27 offen lds
    s_add_u32 m0, s26, 5120
    s_add_u32 s27, s25, 163840
    buffer_load_dwordx4 v20, s[16:19], s27 offen lds
    s_add_u32 m0, s26, 6144
    s_add_u32 s27, s25, 196608
    buffer_load_dwordx4 v20, s[16:19], s27 offen lds
    s_add_u32 m0, s26, 7168
    s_add_u32 s27, s25, 229376
    buffer_load_dwordx4 v20, s[16:19], s27 offen lds
    s_add_u32 m0, s26, 32768
    s_add_u32 s27, s25, 1048576
    buffer_load_dwordx4 v20, s[16:19], s27 offen lds
    s_add_u32 m0, s26, 33792
    s_add_u32 s27, s25, 1081344
    buffer_load_dwordx4 v20, s[16:19], s27 offen lds
    s_add_u32 m0, s26, 34816
    s_add_u32 s27, s25, 1114112
    buffer_load_dwordx4 v20, s[16:19], s27 offen lds
    s_add_u32 m0, s26, 35840
    s_add_u32 s27, s25, 1146880
    buffer_load_dwordx4 v20, s[16:19], s27 offen lds
    s_add_u32 m0, s26, 36864
    s_add_u32 s27, s25, 1179648
    buffer_load_dwordx4 v20, s[16:19], s27 offen lds
    s_add_u32 m0, s26, 37888
    s_add_u32 s27, s25, 1212416
    buffer_load_dwordx4 v20, s[16:19], s27 offen lds
    s_add_u32 m0, s26, 38912
    s_add_u32 s27, s25, 1245184
    buffer_load_dwordx4 v20, s[16:19], s27 offen lds
    s_add_u32 m0, s26, 39936
    s_add_u32 s27, s25, 1277952
    buffer_load_dwordx4 v20, s[16:19], s27 offen lds
    s_add_u32 m0, s26, 65536
    s_add_u32 s27, s25, 2097152
    buffer_load_dwordx4 v20, s[16:19], s27 offen lds
    s_add_u32 m0, s26, 66560
    s_add_u32 s27, s25, 2129920
    buffer_load_dwordx4 v20, s[16:19], s27 offen lds
    s_add_u32 m0, s26, 67584
    s_add_u32 s27, s25, 2162688
    buffer_load_dwordx4 v20, s[16:19], s27 offen lds
    s_add_u32 m0, s26, 68608
    s_add_u32 s27, s25, 2195456
    buffer_load_dwordx4 v20, s[16:19], s27 offen lds
    s_add_u32 m0, s26, 69632
    s_add_u32 s27, s25, 2228224
    buffer_load_dwordx4 v20, s[16:19], s27 offen lds
    s_add_u32 m0, s26, 70656
    s_add_u32 s27, s25, 2260992
    buffer_load_dwordx4 v20, s[16:19], s27 offen lds
    s_add_u32 m0, s26, 71680
    s_add_u32 s27, s25, 2293760
    buffer_load_dwordx4 v20, s[16:19], s27 offen lds
    s_add_u32 m0, s26, 72704
    s_add_u32 s27, s25, 2326528
    buffer_load_dwordx4 v20, s[16:19], s27 offen lds
    s_add_u32 m0, s26, 98304
    s_add_u32 s27, s25, 3145728
    buffer_load_dwordx4 v20, s[16:19], s27 offen lds
    s_add_u32 m0, s26, 99328
    s_add_u32 s27, s25, 3178496
    buffer_load_dwordx4 v20, s[16:19], s27 offen lds
    s_add_u32 m0, s26, 100352
    s_add_u32 s27, s25, 3211264
    buffer_load_dwordx4 v20, s[16:19], s27 offen lds
    s_add_u32 m0, s26, 101376
    s_add_u32 s27, s25, 3244032
    buffer_load_dwordx4 v20, s[16:19], s27 offen lds
    s_add_u32 m0, s26, 102400
    s_add_u32 s27, s25, 3276800
    buffer_load_dwordx4 v20, s[16:19], s27 offen lds
    s_add_u32 m0, s26, 103424
    s_add_u32 s27, s25, 3309568
    buffer_load_dwordx4 v20, s[16:19], s27 offen lds
    s_add_u32 m0, s26, 104448
    s_add_u32 s27, s25, 3342336
    buffer_load_dwordx4 v20, s[16:19], s27 offen lds
    s_add_u32 m0, s26, 105472
    s_add_u32 s27, s25, 3375104
    buffer_load_dwordx4 v20, s[16:19], s27 offen lds
    s_waitcnt vmcnt(24)
    s_barrier
    ds_read_b64_tr_b16 a[0:1], v21 offset:0
    ds_read_b64_tr_b16 a[2:3], v21 offset:1024
    ds_read_b64_tr_b16 a[4:5], v22 offset:0
    ds_read_b64_tr_b16 a[6:7], v22 offset:1024
    ds_read_b64_tr_b16 a[8:9], v21 offset:8192
    ds_read_b64_tr_b16 a[10:11], v21 offset:9216
    ds_read_b64_tr_b16 a[12:13], v22 offset:8192
    ds_read_b64_tr_b16 a[14:15], v22 offset:9216
    s_waitcnt lgkmcnt(0)
    ds_read_b64_tr_b16 a[16:17], v21 offset:16384
    ds_read_b64_tr_b16 a[18:19], v21 offset:17408
    ds_read_b64_tr_b16 a[20:21], v22 offset:16384
    ds_read_b64_tr_b16 a[22:23], v22 offset:17408
    ds_read_b64_tr_b16 a[24:25], v21 offset:24576
    ds_read_b64_tr_b16 a[26:27], v21 offset:25600
    ds_read_b64_tr_b16 a[28:29], v22 offset:24576
    ds_read_b64_tr_b16 a[30:31], v22 offset:25600
    s_waitcnt lgkmcnt(0)
    s_barrier
    s_add_u32 m0, s26, 0
    s_add_u32 s27, s25, 4194304
    buffer_load_dwordx4 v20, s[16:19], s27 offen lds
    s_add_u32 m0, s26, 1024
    s_add_u32 s27, s25, 4227072
    buffer_load_dwordx4 v20, s[16:19], s27 offen lds
    s_add_u32 m0, s26, 2048
    s_add_u32 s27, s25, 4259840
    buffer_load_dwordx4 v20, s[16:19], s27 offen lds
    s_add_u32 m0, s26, 3072
    s_add_u32 s27, s25, 4292608
    buffer_load_dwordx4 v20, s[16:19], s27 offen lds
    s_add_u32 m0, s26, 4096
    s_add_u32 s27, s25, 4325376
    buffer_load_dwordx4 v20, s[16:19], s27 offen lds
    s_add_u32 m0, s26, 5120
    s_add_u32 s27, s25, 4358144
    buffer_load_dwordx4 v20, s[16:19], s27 offen lds
    s_add_u32 m0, s26, 6144
    s_add_u32 s27, s25, 4390912
    buffer_load_dwordx4 v20, s[16:19], s27 offen lds
    s_add_u32 m0, s26, 7168
    s_add_u32 s27, s25, 4423680
    buffer_load_dwordx4 v20, s[16:19], s27 offen lds
    s_waitcnt vmcnt(24)
    s_barrier
    ds_read_b64_tr_b16 a[32:33], v21 offset:32768
    ds_read_b64_tr_b16 a[34:35], v21 offset:33792
    ds_read_b64_tr_b16 a[36:37], v22 offset:32768
    ds_read_b64_tr_b16 a[38:39], v22 offset:33792
    ds_read_b64_tr_b16 a[40:41], v21 offset:40960
    ds_read_b64_tr_b16 a[42:43], v21 offset:41984
    ds_read_b64_tr_b16 a[44:45], v22 offset:40960
    ds_read_b64_tr_b16 a[46:47], v22 offset:41984
    s_waitcnt lgkmcnt(0)
    ds_read_b64_tr_b16 a[48:49], v21 offset:49152
    ds_read_b64_tr_b16 a[50:51], v21 offset:50176
    ds_read_b64_tr_b16 a[52:53], v22 offset:49152
    ds_read_b64_tr_b16 a[54:55], v22 offset:50176
    ds_read_b64_tr_b16 a[56:57], v21 offset:57344
    ds_read_b64_tr_b16 a[58:59], v21 offset:58368
    ds_read_b64_tr_b16 a[60:61], v22 offset:57344
    ds_read_b64_tr_b16 a[62:63], v22 offset:58368
    s_waitcnt lgkmcnt(0)
    s_barrier
    s_add_u32 m0, s26, 32768
    s_add_u32 s27, s25, 5242880
    buffer_load_dwordx4 v20, s[16:19], s27 offen lds
    s_add_u32 m0, s26, 33792
    s_add_u32 s27, s25, 5275648
    buffer_load_dwordx4 v20, s[16:19], s27 offen lds
    s_add_u32 m0, s26, 34816
    s_add_u32 s27, s25, 5308416
    buffer_load_dwordx4 v20, s[16:19], s27 offen lds
    s_add_u32 m0, s26, 35840
    s_add_u32 s27, s25, 5341184
    buffer_load_dwordx4 v20, s[16:19], s27 offen lds
    s_add_u32 m0, s26, 36864
    s_add_u32 s27, s25, 5373952
    buffer_load_dwordx4 v20, s[16:19], s27 offen lds
    s_add_u32 m0, s26, 37888
    s_add_u32 s27, s25, 5406720
    buffer_load_dwordx4 v20, s[16:19], s27 offen lds
    s_add_u32 m0, s26, 38912
    s_add_u32 s27, s25, 5439488
    buffer_load_dwordx4 v20, s[16:19], s27 offen lds
    s_add_u32 m0, s26, 39936
    s_add_u32 s27, s25, 5472256
    buffer_load_dwordx4 v20, s[16:19], s27 offen lds
    s_waitcnt vmcnt(24)
    s_barrier
    ds_read_b64_tr_b16 a[64:65], v23 offset:0
    ds_read_b64_tr_b16 a[66:67], v23 offset:1024
    ds_read_b64_tr_b16 a[68:69], v24 offset:0
    ds_read_b64_tr_b16 a[70:71], v24 offset:1024
    ds_read_b64_tr_b16 a[72:73], v23 offset:8192
    ds_read_b64_tr_b16 a[74:75], v23 offset:9216
    ds_read_b64_tr_b16 a[76:77], v24 offset:8192
    ds_read_b64_tr_b16 a[78:79], v24 offset:9216
    s_waitcnt lgkmcnt(0)
    ds_read_b64_tr_b16 a[80:81], v23 offset:16384
    ds_read_b64_tr_b16 a[82:83], v23 offset:17408
    ds_read_b64_tr_b16 a[84:85], v24 offset:16384
    ds_read_b64_tr_b16 a[86:87], v24 offset:17408
    ds_read_b64_tr_b16 a[88:89], v23 offset:24576
    ds_read_b64_tr_b16 a[90:91], v23 offset:25600
    ds_read_b64_tr_b16 a[92:93], v24 offset:24576
    ds_read_b64_tr_b16 a[94:95], v24 offset:25600
    s_waitcnt lgkmcnt(0)
    s_barrier
    s_add_u32 m0, s26, 65536
    s_add_u32 s27, s25, 6291456
    buffer_load_dwordx4 v20, s[16:19], s27 offen lds
    s_add_u32 m0, s26, 66560
    s_add_u32 s27, s25, 6324224
    buffer_load_dwordx4 v20, s[16:19], s27 offen lds
    s_add_u32 m0, s26, 67584
    s_add_u32 s27, s25, 6356992
    buffer_load_dwordx4 v20, s[16:19], s27 offen lds
    s_add_u32 m0, s26, 68608
    s_add_u32 s27, s25, 6389760
    buffer_load_dwordx4 v20, s[16:19], s27 offen lds
    s_add_u32 m0, s26, 69632
    s_add_u32 s27, s25, 6422528
    buffer_load_dwordx4 v20, s[16:19], s27 offen lds
    s_add_u32 m0, s26, 70656
    s_add_u32 s27, s25, 6455296
    buffer_load_dwordx4 v20, s[16:19], s27 offen lds
    s_add_u32 m0, s26, 71680
    s_add_u32 s27, s25, 6488064
    buffer_load_dwordx4 v20, s[16:19], s27 offen lds
    s_add_u32 m0, s26, 72704
    s_add_u32 s27, s25, 6520832
    buffer_load_dwordx4 v20, s[16:19], s27 offen lds
    s_waitcnt vmcnt(24)
    s_barrier
    ds_read_b64_tr_b16 a[96:97], v23 offset:32768
    ds_read_b64_tr_b16 a[98:99], v23 offset:33792
    ds_read_b64_tr_b16 a[100:101], v24 offset:32768
    ds_read_b64_tr_b16 a[102:103], v24 offset:33792
    ds_read_b64_tr_b16 a[104:105], v23 offset:40960
    ds_read_b64_tr_b16 a[106:107], v23 offset:41984
    ds_read_b64_tr_b16 a[108:109], v24 offset:40960
    ds_read_b64_tr_b16 a[110:111], v24 offset:41984
    s_waitcnt lgkmcnt(0)
    ds_read_b64_tr_b16 a[112:113], v23 offset:49152
    ds_read_b64_tr_b16 a[114:115], v23 offset:50176
    ds_read_b64_tr_b16 a[116:117], v24 offset:49152
    ds_read_b64_tr_b16 a[118:119], v24 offset:50176
    ds_read_b64_tr_b16 a[120:121], v23 offset:57344
    ds_read_b64_tr_b16 a[122:123], v23 offset:58368
    ds_read_b64_tr_b16 a[124:125], v24 offset:57344
    ds_read_b64_tr_b16 a[126:127], v24 offset:58368
    s_waitcnt lgkmcnt(0)
    s_barrier
    s_add_u32 m0, s26, 98304
    s_add_u32 s27, s25, 7340032
    buffer_load_dwordx4 v20, s[16:19], s27 offen lds
    s_add_u32 m0, s26, 99328
    s_add_u32 s27, s25, 7372800
    buffer_load_dwordx4 v20, s[16:19], s27 offen lds
    s_add_u32 m0, s26, 100352
    s_add_u32 s27, s25, 7405568
    buffer_load_dwordx4 v20, s[16:19], s27 offen lds
    s_add_u32 m0, s26, 101376
    s_add_u32 s27, s25, 7438336
    buffer_load_dwordx4 v20, s[16:19], s27 offen lds
    s_add_u32 m0, s26, 102400
    s_add_u32 s27, s25, 7471104
    buffer_load_dwordx4 v20, s[16:19], s27 offen lds
    s_add_u32 m0, s26, 103424
    s_add_u32 s27, s25, 7503872
    buffer_load_dwordx4 v20, s[16:19], s27 offen lds
    s_add_u32 m0, s26, 104448
    s_add_u32 s27, s25, 7536640
    buffer_load_dwordx4 v20, s[16:19], s27 offen lds
    s_add_u32 m0, s26, 105472
    s_add_u32 s27, s25, 7569408
    buffer_load_dwordx4 v20, s[16:19], s27 offen lds
    s_waitcnt vmcnt(24)
    s_barrier
    ds_read_b64_tr_b16 a[128:129], v21 offset:0
    ds_read_b64_tr_b16 a[130:131], v21 offset:1024
    ds_read_b64_tr_b16 a[132:133], v22 offset:0
    ds_read_b64_tr_b16 a[134:135], v22 offset:1024
    ds_read_b64_tr_b16 a[136:137], v21 offset:8192
    ds_read_b64_tr_b16 a[138:139], v21 offset:9216
    ds_read_b64_tr_b16 a[140:141], v22 offset:8192
    ds_read_b64_tr_b16 a[142:143], v22 offset:9216
    s_waitcnt lgkmcnt(0)
    ds_read_b64_tr_b16 a[144:145], v21 offset:16384
    ds_read_b64_tr_b16 a[146:147], v21 offset:17408
    ds_read_b64_tr_b16 a[148:149], v22 offset:16384
    ds_read_b64_tr_b16 a[150:151], v22 offset:17408
    ds_read_b64_tr_b16 a[152:153], v21 offset:24576
    ds_read_b64_tr_b16 a[154:155], v21 offset:25600
    ds_read_b64_tr_b16 a[156:157], v22 offset:24576
    ds_read_b64_tr_b16 a[158:159], v22 offset:25600
    s_waitcnt lgkmcnt(0)
    s_waitcnt vmcnt(16)
    s_barrier
    ds_read_b64_tr_b16 a[160:161], v21 offset:32768
    ds_read_b64_tr_b16 a[162:163], v21 offset:33792
    ds_read_b64_tr_b16 a[164:165], v22 offset:32768
    ds_read_b64_tr_b16 a[166:167], v22 offset:33792
    ds_read_b64_tr_b16 a[168:169], v21 offset:40960
    ds_read_b64_tr_b16 a[170:171], v21 offset:41984
    ds_read_b64_tr_b16 a[172:173], v22 offset:40960
    ds_read_b64_tr_b16 a[174:175], v22 offset:41984
    s_waitcnt lgkmcnt(0)
    ds_read_b64_tr_b16 a[176:177], v21 offset:49152
    ds_read_b64_tr_b16 a[178:179], v21 offset:50176
    ds_read_b64_tr_b16 a[180:181], v22 offset:49152
    ds_read_b64_tr_b16 a[182:183], v22 offset:50176
    ds_read_b64_tr_b16 a[184:185], v21 offset:57344
    ds_read_b64_tr_b16 a[186:187], v21 offset:58368
    ds_read_b64_tr_b16 a[188:189], v22 offset:57344
    ds_read_b64_tr_b16 a[190:191], v22 offset:58368
    s_waitcnt lgkmcnt(0)
    s_waitcnt vmcnt(8)
    s_barrier
    ds_read_b64_tr_b16 a[192:193], v23 offset:0
    ds_read_b64_tr_b16 a[194:195], v23 offset:1024
    ds_read_b64_tr_b16 a[196:197], v24 offset:0
    ds_read_b64_tr_b16 a[198:199], v24 offset:1024
    ds_read_b64_tr_b16 a[200:201], v23 offset:8192
    ds_read_b64_tr_b16 a[202:203], v23 offset:9216
    ds_read_b64_tr_b16 a[204:205], v24 offset:8192
    ds_read_b64_tr_b16 a[206:207], v24 offset:9216
    s_waitcnt lgkmcnt(0)
    ds_read_b64_tr_b16 a[208:209], v23 offset:16384
    ds_read_b64_tr_b16 a[210:211], v23 offset:17408
    ds_read_b64_tr_b16 a[212:213], v24 offset:16384
    ds_read_b64_tr_b16 a[214:215], v24 offset:17408
    ds_read_b64_tr_b16 a[216:217], v23 offset:24576
    ds_read_b64_tr_b16 a[218:219], v23 offset:25600
    ds_read_b64_tr_b16 a[220:221], v24 offset:24576
    ds_read_b64_tr_b16 a[222:223], v24 offset:25600
    s_waitcnt lgkmcnt(0)
    s_waitcnt vmcnt(0)
    s_barrier
    ds_read_b64_tr_b16 a[224:225], v23 offset:32768
    ds_read_b64_tr_b16 a[226:227], v23 offset:33792
    ds_read_b64_tr_b16 a[228:229], v24 offset:32768
    ds_read_b64_tr_b16 a[230:231], v24 offset:33792
    ds_read_b64_tr_b16 a[232:233], v23 offset:40960
    ds_read_b64_tr_b16 a[234:235], v23 offset:41984
    ds_read_b64_tr_b16 a[236:237], v24 offset:40960
    ds_read_b64_tr_b16 a[238:239], v24 offset:41984
    s_waitcnt lgkmcnt(0)
    ds_read_b64_tr_b16 a[240:241], v23 offset:49152
    ds_read_b64_tr_b16 a[242:243], v23 offset:50176
    ds_read_b64_tr_b16 a[244:245], v24 offset:49152
    ds_read_b64_tr_b16 a[246:247], v24 offset:50176
    ds_read_b64_tr_b16 a[248:249], v23 offset:57344
    ds_read_b64_tr_b16 a[250:251], v23 offset:58368
    ds_read_b64_tr_b16 a[252:253], v24 offset:57344
    ds_read_b64_tr_b16 a[254:255], v24 offset:58368
    s_waitcnt lgkmcnt(0)
    s_lshl_b32 s21, s49, 12
    v_and_b32 v1, 63, v0
    v_and_b32 v2, 15, v0
    v_bfe_u32 v3, v0, 4, 2
    v_lshrrev_b32 v4, 6, v0
    v_lshrrev_b32 v5, 5, v1
    v_lshl_add_u32 v5, v4, 3, v5
    v_add_u32 v5, 0, v5
    v_and_b32 v6, 7, v5
    v_lshrrev_b32 v7, 4, v5
    v_lshl_add_u32 v6, v7, 3, v6
    v_and_b32 v7, 31, v1
    v_xor_b32 v6, v6, v7
    v_lshlrev_b32 v6, 4, v6
    v_lshl_add_u32 v8, v5, 11, v6
    v_lshrrev_b32 v5, 5, v1
    v_lshl_add_u32 v5, v4, 3, v5
    v_add_u32 v5, 2, v5
    v_and_b32 v6, 7, v5
    v_lshrrev_b32 v7, 4, v5
    v_lshl_add_u32 v6, v7, 3, v6
    v_and_b32 v7, 31, v1
    v_xor_b32 v6, v6, v7
    v_lshlrev_b32 v6, 4, v6
    v_lshl_add_u32 v9, v5, 11, v6
    v_lshrrev_b32 v5, 5, v1
    v_lshl_add_u32 v5, v4, 3, v5
    v_add_u32 v5, 4, v5
    v_and_b32 v6, 7, v5
    v_lshrrev_b32 v7, 4, v5
    v_lshl_add_u32 v6, v7, 3, v6
    v_and_b32 v7, 31, v1
    v_xor_b32 v6, v6, v7
    v_lshlrev_b32 v6, 4, v6
    v_lshl_add_u32 v10, v5, 11, v6
    v_lshrrev_b32 v5, 5, v1
    v_lshl_add_u32 v5, v4, 3, v5
    v_add_u32 v5, 6, v5
    v_and_b32 v6, 7, v5
    v_lshrrev_b32 v7, 4, v5
    v_lshl_add_u32 v6, v7, 3, v6
    v_and_b32 v7, 31, v1
    v_xor_b32 v6, v6, v7
    v_lshlrev_b32 v6, 4, v6
    v_lshl_add_u32 v11, v5, 11, v6
    v_and_b32 v5, 8, v2
    v_add_u32 v5, v5, v2
    v_add_u32 v6, 0, v3
    v_xor_b32 v6, v6, v2
    v_lshlrev_b32 v6, 4, v6
    v_lshl_add_u32 v12, v5, 9, v6
    v_add_u32 v6, 4, v3
    v_xor_b32 v6, v6, v2
    v_lshlrev_b32 v6, 4, v6
    v_lshl_add_u32 v13, v5, 9, v6
    v_add_u32 v6, 8, v3
    v_xor_b32 v6, v6, v2
    v_lshlrev_b32 v6, 4, v6
    v_lshl_add_u32 v14, v5, 9, v6
    v_add_u32 v6, 12, v3
    v_xor_b32 v6, v6, v2
    v_lshlrev_b32 v6, 4, v6
    v_lshl_add_u32 v15, v5, 9, v6
    v_add_u32 v16, 0x10000, v12
    v_add_u32 v17, 0x10000, v13
    v_add_u32 v18, 0x10000, v14
    v_add_u32 v19, 0x10000, v15
    v_lshlrev_b32 v86, 4, v5
    v_lshl_add_u32 v86, v3, 9, v86
    s_lshl_b32 s44, s46, 15
    s_lshr_b32 s25, s49, 1
    s_lshl_b32 s25, s25, 14
    s_add_u32 s44, s44, s25
    s_and_b32 s25, s49, 1
    s_lshl_b32 s25, s25, 12
    s_add_u32 s44, s44, s25
    s_mov_b32 s22, 0
    s_mov_b32 s24, 0
    s_mov_b32 s20, 0
    s_mov_b32 s37, 0
    s_mov_b32 s23, 64
    s_mov_b32 s32, s98
    s_and_b32 s33, s99, 0xffff
    s_mov_b32 s34, 0x100
    s_mov_b32 s35, 0x00020000
    s_mov_b32 s25, 0
    v_mov_b32 v2, 0
L_pl_206:
    buffer_load_dword v1, v2, s[32:35], s25 offen sc1
    s_add_u32 s36, s36, 1
    s_cmp_gt_u32 s36, 0x100000
    s_cbranch_scc1 chain_kernel_wend
    s_waitcnt vmcnt(0)
    v_readfirstlane_b32 s26, v1
    s_and_b32 s27, s26, 0xffff
    s_cmp_ge_u32 s27, 256
    s_cbranch_scc1 L_plok_207
    s_sleep 4
    s_branch L_pl_206
L_plok_207:
    s_lshr_b32 s25, s26, 16
    s_cmp_gt_u32 s25, 64
    s_cselect_b32 s25, 0x2000, 0x0
    s_add_u32 s54, s100, 0x1fffff
    s_and_b32 s54, s54, 0xffe00000
    s_sub_u32 s55, s54, s100
    s_add_u32 s54, s55, s25
    s_xor_b32 s25, s25, 0x2000
    s_add_u32 s55, s55, s25
    s_cmp_eq_u32 s40, 2
    s_cbranch_scc1 L_q_202
    s_cmp_eq_u32 s40, 1
    s_cbranch_scc1 L_v_201
    v_mov_b32 v96, 0xff81ff81
    v_mov_b32 v97, 0xff81ff81
    v_mov_b32 v98, 0xff81ff81
    v_mov_b32 v99, 0xff81ff81
    v_and_b32 v100, 63, v0
    v_lshlrev_b32 v100, 4, v100
    s_barrier
    s_add_u32 m0, s21, 0
    s_nop 0
    buffer_load_dwordx4 v8, s[8:11], s20 offen lds
    s_add_u32 m0, s21, 1024
    s_nop 0
    buffer_load_dwordx4 v9, s[8:11], s20 offen lds
    s_add_u32 m0, s21, 2048
    s_nop 0
    buffer_load_dwordx4 v10, s[8:11], s20 offen lds
    s_add_u32 m0, s21, 3072
    s_nop 0
    buffer_load_dwordx4 v11, s[8:11], s20 offen lds
    s_add_u32 s20, s20, 512
    s_add_u32 m0, s21, 16384
    s_nop 0
    buffer_load_dwordx4 v8, s[8:11], s20 offen lds
    s_add_u32 m0, s21, 17408
    s_nop 0
    buffer_load_dwordx4 v9, s[8:11], s20 offen lds
    s_add_u32 m0, s21, 18432
    s_nop 0
    buffer_load_dwordx4 v10, s[8:11], s20 offen lds
    s_add_u32 m0, s21, 19456
    s_nop 0
    buffer_load_dwordx4 v11, s[8:11], s20 offen lds
    s_add_u32 s20, s20, 512
    s_add_u32 m0, s21, 32768
    s_nop 0
    buffer_load_dwordx4 v8, s[8:11], s20 offen lds
    s_add_u32 m0, s21, 33792
    s_nop 0
    buffer_load_dwordx4 v9, s[8:11], s20 offen lds
    s_add_u32 m0, s21, 34816
    s_nop 0
    buffer_load_dwordx4 v10, s[8:11], s20 offen lds
    s_add_u32 m0, s21, 35840
    s_nop 0
    buffer_load_dwordx4 v11, s[8:11], s20 offen lds
    s_add_u32 s20, s20, 512
    s_add_u32 m0, s21, 49152
    s_nop 0
    buffer_load_dwordx4 v8, s[8:11], s20 offen lds
    s_add_u32 m0, s21, 50176
    s_nop 0
    buffer_load_dwordx4 v9, s[8:11], s20 offen lds
    s_add_u32 m0, s21, 51200
    s_nop 0
    buffer_load_dwordx4 v10, s[8:11], s20 offen lds
    s_add_u32 m0, s21, 52224
    s_nop 0
    buffer_load_dwordx4 v11, s[8:11], s20 offen lds
    s_add_u32 s24, s24, 1
    s_min_u32 s24, s24, 63
    s_lshl_b32 s53, s24, 16
    s_mov_b32 s20, s53
    s_add_u32 m0, s21, 65536
    s_nop 0
    buffer_load_dwordx4 v8, s[8:11], s20 offen lds
    s_add_u32 m0, s21, 66560
    s_nop 0
    buffer_load_dwordx4 v9, s[8:11], s20 offen lds
    s_add_u32 m0, s21, 67584
    s_nop 0
    buffer_load_dwordx4 v10, s[8:11], s20 offen lds
    s_add_u32 m0, s21, 68608
    s_nop 0
    buffer_load_dwordx4 v11, s[8:11], s20 offen lds
    s_add_u32 s20, s20, 512
    s_add_u32 m0, s21, 81920
    s_nop 0
    buffer_load_dwordx4 v8, s[8:11], s20 offen lds
    s_add_u32 m0, s21, 82944
    s_nop 0
    buffer_load_dwordx4 v9, s[8:11], s20 offen lds
    s_add_u32 m0, s21, 83968
    s_nop 0
    buffer_load_dwordx4 v10, s[8:11], s20 offen lds
    s_add_u32 m0, s21, 84992
    s_nop 0
    buffer_load_dwordx4 v11, s[8:11], s20 offen lds
    s_add_u32 s20, s20, 512
    s_add_u32 m0, s21, 98304
    s_nop 0
    buffer_load_dwordx4 v8, s[8:11], s20 offen lds
    s_waitcnt vmcnt(21)
    s_barrier
    ds_read_b128 v[20:23], v12 offset:0
    ds_read_b128 v[24:27], v12 offset:4096
    ds_read_b128 v[28:31], v13 offset:0
    ds_read_b128 v[32:35], v13 offset:4096
    ds_read_b128 v[36:39], v14 offset:0
    ds_read_b128 v[40:43], v14 offset:4096
    s_waitcnt lgkmcnt(4)
L_st_211:
    v_mfma_f32_16x16x32_bf16 v[52:55], a[0:3], v[20:23], 0
    ds_read_b128 v[44:47], v15 offset:0
    s_add_u32 m0, s21, 99328
    v_mfma_f32_16x16x32_bf16 v[56:59], a[4:7], v[20:23], 0
    buffer_load_dwordx4 v9, s[8:11], s20 offen lds
    v_mfma_f32_16x16x32_bf16 v[60:63], a[0:3], v[24:27], 0
    ds_read_b128 v[48:51], v15 offset:4096
    s_sub_u32 s39, s22, 1
    v_mfma_f32_16x16x32_bf16 v[64:67], a[4:7], v[24:27], 0
    s_waitcnt lgkmcnt(4)
    s_bitcmp1_b32 s39, 1
    s_cselect_b32 s38, s55, s54
    v_mfma_f32_16x16x32_bf16 v[52:55], a[8:11], v[28:31], v[52:55]
    ds_read_b128 v[20:23], v12 offset:256
    v_mfma_f32_16x16x32_bf16 v[56:59], a[12:15], v[28:31], v[56:59]
    s_add_u32 s38, s38, s44
    s_lshl_b32 s42, s39, 20
    v_mfma_f32_16x16x32_bf16 v[60:63], a[8:11], v[32:35], v[60:63]
    ds_read_b128 v[24:27], v12 offset:4352
    s_add_u32 s38, s38, s42
    v_mfma_f32_16x16x32_bf16 v[64:67], a[12:15], v[32:35], v[64:67]
    s_waitcnt lgkmcnt(4)
    s_lshl_b32 s39, s39, 7
    v_mfma_f32_16x16x32_bf16 v[52:55], a[16:19], v[36:39], v[52:55]
    ds_read_b128 v[28:31], v13 offset:256
    s_add_u32 m0, s21, 100352
    v_mfma_f32_16x16x32_bf16 v[56:59], a[20:23], v[36:39], v[56:59]
    buffer_load_dwordx4 v10, s[8:11], s20 offen lds
    v_mfma_f32_16x16x32_bf16 v[60:63], a[16:19], v[40:43], v[60:63]
    ds_read_b128 v[32:35], v13 offset:4352
    s_add_u32 s39, s39, 0x5900000
    v_mfma_f32_16x16x32_bf16 v[64:67], a[20:23], v[40:43], v[64:67]
    s_waitcnt lgkmcnt(4)
    s_cmp_eq_u32 s37, 0
    s_cselect_b32 s38, 0x7ff00000, s38
    s_cselect_b32 s39, 0x7ff00000, s39
    v_mfma_f32_16x16x32_bf16 v[52:55], a[24:27], v[44:47], v[52:55]
    ds_read_b128 v[36:39], v14 offset:256
    v_mfma_f32_16x16x32_bf16 v[56:59], a[28:31], v[44:47], v[56:59]
    v_cvt_pk_bf16_f32 v88, v68, v69
    v_mfma_f32_16x16x32_bf16 v[60:63], a[24:27], v[48:51], v[60:63]
    ds_read_b128 v[40:43], v14 offset:4352
    v_cvt_pk_bf16_f32 v89, v70, v71
    v_mfma_f32_16x16x32_bf16 v[64:67], a[28:31], v[48:51], v[64:67]
    s_waitcnt lgkmcnt(4)
    v_cvt_pk_bf16_f32 v90, v72, v73
    v_mfma_f32_16x16x32_bf16 v[52:55], a[32:35], v[20:23], v[52:55]
    ds_read_b128 v[44:47], v15 offset:256
    s_add_u32 m0, s21, 101376
    v_mfma_f32_16x16x32_bf16 v[56:59], a[36:39], v[20:23], v[56:59]
    buffer_load_dwordx4 v11, s[8:11], s20 offen lds
    v_mfma_f32_16x16x32_bf16 v[60:63], a[32:35], v[24:27], v[60:63]
    ds_read_b128 v[48:51], v15 offset:4352
    v_cvt_pk_bf16_f32 v91, v74, v75
    v_mfma_f32_16x16x32_bf16 v[64:67], a[36:39], v[24:27], v[64:67]
    s_waitcnt lgkmcnt(4)
    v_mfma_f32_16x16x32_bf16 v[52:55], a[40:43], v[28:31], v[52:55]
    s_waitcnt vmcnt(20)
    s_barrier
    ds_read_b128 v[20:23], v12 offset:16384
    v_mfma_f32_16x16x32_bf16 v[56:59], a[44:47], v[28:31], v[56:59]
    s_add_u32 s20, s20, 512
    buffer_store_dwordx4 v[88:91], v86, s[12:15], s38 offen offset:0 sc1
    v_mfma_f32_16x16x32_bf16 v[60:63], a[40:43], v[32:35], v[60:63]
    ds_read_b128 v[24:27], v12 offset:20480
    v_cvt_pk_bf16_f32 v92, v76, v77
    v_mfma_f32_16x16x32_bf16 v[64:67], a[44:47], v[32:35], v[64:67]
    s_waitcnt lgkmcnt(4)
    v_cvt_pk_bf16_f32 v93, v78, v79
    v_mfma_f32_16x16x32_bf16 v[52:55], a[48:51], v[36:39], v[52:55]
    ds_read_b128 v[28:31], v13 offset:16384
    s_add_u32 m0, s21, 114688
    v_mfma_f32_16x16x32_bf16 v[56:59], a[52:55], v[36:39], v[56:59]
    buffer_load_dwordx4 v8, s[8:11], s20 offen lds
    v_mfma_f32_16x16x32_bf16 v[60:63], a[48:51], v[40:43], v[60:63]
    ds_read_b128 v[32:35], v13 offset:20480
    v_cvt_pk_bf16_f32 v94, v80, v81
    v_mfma_f32_16x16x32_bf16 v[64:67], a[52:55], v[40:43], v[64:67]
    s_waitcnt lgkmcnt(4)
    v_cvt_pk_bf16_f32 v95, v82, v83
    v_mfma_f32_16x16x32_bf16 v[52:55], a[56:59], v[44:47], v[52:55]
    ds_read_b128 v[36:39], v14 offset:16384
    v_mfma_f32_16x16x32_bf16 v[56:59], a[60:63], v[44:47], v[56:59]
    buffer_store_dwordx4 v[92:95], v86, s[12:15], s38 offen offset:128 sc1
    v_mfma_f32_16x16x32_bf16 v[60:63], a[56:59], v[48:51], v[60:63]
    ds_read_b128 v[40:43], v14 offset:20480
    s_add_u32 s42, s38, 0x8000000
    v_mfma_f32_16x16x32_bf16 v[64:67], a[60:63], v[48:51], v[64:67]
    s_waitcnt lgkmcnt(4)
    s_cmp_le_u32 s22, 60
    s_cbranch_scc1 L_nokm_212
    buffer_store_dwordx4 v[96:99], v100, s[12:15], s42 offen offset:3072 sc1
L_nokm_212:
    v_mfma_f32_16x16x32_bf16 v[52:55], a[64:67], v[20:23], v[52:55]
    ds_read_b128 v[44:47], v15 offset:16384
    s_add_u32 m0, s21, 115712
    v_mfma_f32_16x16x32_bf16 v[56:59], a[68:71], v[20:23], v[56:59]
    buffer_load_dwordx4 v9, s[8:11], s20 offen lds
    v_mfma_f32_16x16x32_bf16 v[60:63], a[64:67], v[24:27], v[60:63]
    ds_read_b128 v[48:51], v15 offset:20480
    v_mfma_f32_16x16x32_bf16 v[64:67], a[68:71], v[24:27], v[64:67]
    s_waitcnt lgkmcnt(4)
    v_mfma_f32_16x16x32_bf16 v[52:55], a[72:75], v[28:31], v[52:55]
    ds_read_b128 v[20:23], v12 offset:16640
    v_mfma_f32_16x16x32_bf16 v[56:59], a[76:79], v[28:31], v[56:59]
    buffer_store_dwordx4 v[96:99], v100, s[12:15], s42 offen offset:0 sc1
    v_mfma_f32_16x16x32_bf16 v[60:63], a[72:75], v[32:35], v[60:63]
    ds_read_b128 v[24:27], v12 offset:20736
    s_add_u32 s24, s24, 1
    v_mfma_f32_16x16x32_bf16 v[64:67], a[76:79], v[32:35], v[64:67]
    s_waitcnt lgkmcnt(4)
    v_mfma_f32_16x16x32_bf16 v[52:55], a[80:83], v[36:39], v[52:55]
    ds_read_b128 v[28:31], v13 offset:16640
    s_add_u32 m0, s21, 116736
    v_mfma_f32_16x16x32_bf16 v[56:59], a[84:87], v[36:39], v[56:59]
    buffer_load_dwordx4 v10, s[8:11], s20 offen lds
    v_mfma_f32_16x16x32_bf16 v[60:63], a[80:83], v[40:43], v[60:63]
    ds_read_b128 v[32:35], v13 offset:20736
    v_mfma_f32_16x16x32_bf16 v[64:67], a[84:87], v[40:43], v[64:67]
    s_waitcnt lgkmcnt(4)
    s_min_u32 s24, s24, 63
    v_mfma_f32_16x16x32_bf16 v[52:55], a[88:91], v[44:47], v[52:55]
    ds_read_b128 v[36:39], v14 offset:16640
    v_mfma_f32_16x16x32_bf16 v[56:59], a[92:95], v[44:47], v[56:59]
    v_mfma_f32_16x16x32_bf16 v[60:63], a[88:91], v[48:51], v[60:63]
    ds_read_b128 v[40:43], v14 offset:20736
    s_lshl_b32 s53, s24, 16
    v_mfma_f32_16x16x32_bf16 v[64:67], a[92:95], v[48:51], v[64:67]
    s_waitcnt lgkmcnt(4)
    v_mfma_f32_16x16x32_bf16 v[52:55], a[96:99], v[20:23], v[52:55]
    ds_read_b128 v[44:47], v15 offset:16640
    s_add_u32 m0, s21, 117760
    v_mfma_f32_16x16x32_bf16 v[56:59], a[100:103], v[20:23], v[56:59]
    buffer_load_dwordx4 v11, s[8:11], s20 offen lds
    v_mfma_f32_16x16x32_bf16 v[60:63], a[96:99], v[24:27], v[60:63]
    ds_read_b128 v[48:51], v15 offset:20736
    v_mfma_f32_16x16x32_bf16 v[64:67], a[100:103], v[24:27], v[64:67]
    s_waitcnt lgkmcnt(4)
    v_mfma_f32_16x16x32_bf16 v[52:55], a[104:107], v[28:31], v[52:55]
    s_waitcnt vmcnt(20)
    s_barrier
    ds_read_b128 v[20:23], v12 offset:32768
    v_mfma_f32_16x16x32_bf16 v[56:59], a[108:111], v[28:31], v[56:59]
    s_mov_b32 s20, s53
    v_mfma_f32_16x16x32_bf16 v[60:63], a[104:107], v[32:35], v[60:63]
    ds_read_b128 v[24:27], v12 offset:36864
    v_mfma_f32_16x16x32_bf16 v[64:67], a[108:111], v[32:35], v[64:67]
    s_waitcnt lgkmcnt(4)
    v_mfma_f32_16x16x32_bf16 v[52:55], a[112:115], v[36:39], v[52:55]
    ds_read_b128 v[28:31], v13 offset:32768
    s_add_u32 m0, s21, 0
    v_mfma_f32_16x16x32_bf16 v[56:59], a[116:119], v[36:39], v[56:59]
    buffer_load_dwordx4 v8, s[8:11], s20 offen lds
    v_mfma_f32_16x16x32_bf16 v[60:63], a[112:115], v[40:43], v[60:63]
    ds_read_b128 v[32:35], v13 offset:36864
    v_mfma_f32_16x16x32_bf16 v[64:67], a[116:119], v[40:43], v[64:67]
    s_waitcnt lgkmcnt(4)
    v_mfma_f32_16x16x32_bf16 v[52:55], a[120:123], v[44:47], v[52:55]
    ds_read_b128 v[36:39], v14 offset:32768
    v_mfma_f32_16x16x32_bf16 v[56:59], a[124:127], v[44:47], v[56:59]
    v_mfma_f32_16x16x32_bf16 v[60:63], a[120:123], v[48:51], v[60:63]
    ds_read_b128 v[40:43], v14 offset:36864
    v_mfma_f32_16x16x32_bf16 v[64:67], a[124:127], v[48:51], v[64:67]
    s_waitcnt lgkmcnt(4)
    v_mfma_f32_16x16x32_bf16 v[52:55], a[128:131], v[20:23], v[52:55]
    ds_read_b128 v[44:47], v15 offset:32768
    s_add_u32 m0, s21, 1024
    v_mfma_f32_16x16x32_bf16 v[56:59], a[132:135], v[20:23], v[56:59]
    buffer_load_dwordx4 v9, s[8:11], s20 offen lds
    v_mfma_f32_16x16x32_bf16 v[60:63], a[128:131], v[24:27], v[60:63]
    ds_read_b128 v[48:51], v15 offset:36864
    v_mfma_f32_16x16x32_bf16 v[64:67], a[132:135], v[24:27], v[64:67]
    s_waitcnt lgkmcnt(4)
    v_mfma_f32_16x16x32_bf16 v[52:55], a[136:139], v[28:31], v[52:55]
    ds_read_b128 v[20:23], v12 offset:33024
    v_mfma_f32_16x16x32_bf16 v[56:59], a[140:143], v[28:31], v[56:59]
    v_mfma_f32_16x16x32_bf16 v[60:63], a[136:139], v[32:35], v[60:63]
    ds_read_b128 v[24:27], v12 offset:37120
    v_mfma_f32_16x16x32_bf16 v[64:67], a[140:143], v[32:35], v[64:67]
    s_waitcnt lgkmcnt(4)
    v_mfma_f32_16x16x32_bf16 v[52:55], a[144:147], v[36:39], v[52:55]
    ds_read_b128 v[28:31], v13 offset:33024
    s_add_u32 m0, s21, 2048
    v_mfma_f32_16x16x32_bf16 v[56:59], a[148:151], v[36:39], v[56:59]
    buffer_load_dwordx4 v10, s[8:11], s20 offen lds
    v_mfma_f32_16x16x32_bf16 v[60:63], a[144:147], v[40:43], v[60:63]
    ds_read_b128 v[32:35], v13 offset:37120
    v_mfma_f32_16x16x32_bf16 v[64:67], a[148:151], v[40:43], v[64:67]
    s_waitcnt lgkmcnt(4)
    v_mfma_f32_16x16x32_bf16 v[52:55], a[152:155], v[44:47], v[52:55]
    ds_read_b128 v[36:39], v14 offset:33024
    v_mfma_f32_16x16x32_bf16 v[56:59], a[156:159], v[44:47], v[56:59]
    v_mfma_f32_16x16x32_bf16 v[60:63], a[152:155], v[48:51], v[60:63]
    ds_read_b128 v[40:43], v14 offset:37120
    v_mfma_f32_16x16x32_bf16 v[64:67], a[156:159], v[48:51], v[64:67]
    s_waitcnt lgkmcnt(4)
    v_mfma_f32_16x16x32_bf16 v[52:55], a[160:163], v[20:23], v[52:55]
    ds_read_b128 v[44:47], v15 offset:33024
    s_add_u32 m0, s21, 3072
    v_mfma_f32_16x16x32_bf16 v[56:59], a[164:167], v[20:23], v[56:59]
    buffer_load_dwordx4 v11, s[8:11], s20 offen lds
    v_mfma_f32_16x16x32_bf16 v[60:63], a[160:163], v[24:27], v[60:63]
    ds_read_b128 v[48:51], v15 offset:37120
    v_mfma_f32_16x16x32_bf16 v[64:67], a[164:167], v[24:27], v[64:67]
    s_waitcnt lgkmcnt(4)
    v_mfma_f32_16x16x32_bf16 v[52:55], a[168:171], v[28:31], v[52:55]
    s_waitcnt vmcnt(20)
    s_barrier
    ds_read_b128 v[20:23], v12 offset:49152
    v_mfma_f32_16x16x32_bf16 v[56:59], a[172:175], v[28:31], v[56:59]
    s_add_u32 s20, s20, 512
    v_mfma_f32_16x16x32_bf16 v[60:63], a[168:171], v[32:35], v[60:63]
    ds_read_b128 v[24:27], v12 offset:53248
    v_mfma_f32_16x16x32_bf16 v[64:67], a[172:175], v[32:35], v[64:67]
    s_waitcnt lgkmcnt(4)
    v_mfma_f32_16x16x32_bf16 v[52:55], a[176:179], v[36:39], v[52:55]
    ds_read_b128 v[28:31], v13 offset:49152
    s_add_u32 m0, s21, 16384
    v_mfma_f32_16x16x32_bf16 v[56:59], a[180:183], v[36:39], v[56:59]
    buffer_load_dwordx4 v8, s[8:11], s20 offen lds
    v_mfma_f32_16x16x32_bf16 v[60:63], a[176:179], v[40:43], v[60:63]
    ds_read_b128 v[32:35], v13 offset:53248
    v_mfma_f32_16x16x32_bf16 v[64:67], a[180:183], v[40:43], v[64:67]
    s_waitcnt lgkmcnt(4)
    v_mfma_f32_16x16x32_bf16 v[52:55], a[184:187], v[44:47], v[52:55]
    ds_read_b128 v[36:39], v14 offset:49152
    v_mfma_f32_16x16x32_bf16 v[56:59], a[188:191], v[44:47], v[56:59]
    v_mfma_f32_16x16x32_bf16 v[60:63], a[184:187], v[48:51], v[60:63]
    ds_read_b128 v[40:43], v14 offset:53248
    v_mfma_f32_16x16x32_bf16 v[64:67], a[188:191], v[48:51], v[64:67]
    s_waitcnt lgkmcnt(4)
    v_mfma_f32_16x16x32_bf16 v[52:55], a[192:195], v[20:23], v[52:55]
    ds_read_b128 v[44:47], v15 offset:49152
    s_add_u32 m0, s21, 17408
    v_mfma_f32_16x16x32_bf16 v[56:59], a[196:199], v[20:23], v[56:59]
    buffer_load_dwordx4 v9, s[8:11], s20 offen lds
    v_mfma_f32_16x16x32_bf16 v[60:63], a[192:195], v[24:27], v[60:63]
    ds_read_b128 v[48:51], v15 offset:53248
    v_mfma_f32_16x16x32_bf16 v[64:67], a[196:199], v[24:27], v[64:67]
    s_waitcnt lgkmcnt(4)
    v_mfma_f32_16x16x32_bf16 v[52:55], a[200:203], v[28:31], v[52:55]
    ds_read_b128 v[20:23], v12 offset:49408
    v_mfma_f32_16x16x32_bf16 v[56:59], a[204:207], v[28:31], v[56:59]
    v_mfma_f32_16x16x32_bf16 v[60:63], a[200:203], v[32:35], v[60:63]
    ds_read_b128 v[24:27], v12 offset:53504
    v_mfma_f32_16x16x32_bf16 v[64:67], a[204:207], v[32:35], v[64:67]
    s_waitcnt lgkmcnt(4)
    v_mfma_f32_16x16x32_bf16 v[52:55], a[208:211], v[36:39], v[52:55]
    ds_read_b128 v[28:31], v13 offset:49408
    s_add_u32 m0, s21, 18432
    v_mfma_f32_16x16x32_bf16 v[56:59], a[212:215], v[36:39], v[56:59]
    buffer_load_dwordx4 v10, s[8:11], s20 offen lds
    v_mfma_f32_16x16x32_bf16 v[60:63], a[208:211], v[40:43], v[60:63]
    ds_read_b128 v[32:35], v13 offset:53504
    v_mfma_f32_16x16x32_bf16 v[64:67], a[212:215], v[40:43], v[64:67]
    s_waitcnt lgkmcnt(4)
    v_mfma_f32_16x16x32_bf16 v[52:55], a[216:219], v[44:47], v[52:55]
    ds_read_b128 v[36:39], v14 offset:49408
    v_mfma_f32_16x16x32_bf16 v[56:59], a[220:223], v[44:47], v[56:59]
    v_mfma_f32_16x16x32_bf16 v[60:63], a[216:219], v[48:51], v[60:63]
    ds_read_b128 v[40:43], v14 offset:53504
    v_mfma_f32_16x16x32_bf16 v[64:67], a[220:223], v[48:51], v[64:67]
    s_waitcnt lgkmcnt(4)
    v_mfma_f32_16x16x32_bf16 v[52:55], a[224:227], v[20:23], v[52:55]
    ds_read_b128 v[44:47], v15 offset:49408
    s_add_u32 m0, s21, 19456
    v_mfma_f32_16x16x32_bf16 v[56:59], a[228:231], v[20:23], v[56:59]
    buffer_load_dwordx4 v11, s[8:11], s20 offen lds
    v_mfma_f32_16x16x32_bf16 v[60:63], a[224:227], v[24:27], v[60:63]
    ds_read_b128 v[48:51], v15 offset:53504
    v_mfma_f32_16x16x32_bf16 v[64:67], a[228:231], v[24:27], v[64:67]
    s_waitcnt lgkmcnt(4)
    v_mfma_f32_16x16x32_bf16 v[52:55], a[232:235], v[28:31], v[52:55]
    s_waitcnt vmcnt(10)
    s_barrier
    ds_read_b128 v[20:23], v16 offset:0
    v_mfma_f32_16x16x32_bf16 v[56:59], a[236:239], v[28:31], v[56:59]
    s_add_u32 s20, s20, 512
    buffer_atomic_add v84, v85, s[12:15], s39 offen sc1
    v_mfma_f32_16x16x32_bf16 v[60:63], a[232:235], v[32:35], v[60:63]
    ds_read_b128 v[24:27], v16 offset:4096
    s_mov_b32 s37, 1
    v_mfma_f32_16x16x32_bf16 v[64:67], a[236:239], v[32:35], v[64:67]
    s_waitcnt lgkmcnt(4)
    v_mfma_f32_16x16x32_bf16 v[52:55], a[240:243], v[36:39], v[52:55]
    ds_read_b128 v[28:31], v17 offset:0
    s_add_u32 m0, s21, 32768
    v_mfma_f32_16x16x32_bf16 v[56:59], a[244:247], v[36:39], v[56:59]
    buffer_load_dwordx4 v8, s[8:11], s20 offen lds
    v_mfma_f32_16x16x32_bf16 v[60:63], a[240:243], v[40:43], v[60:63]
    ds_read_b128 v[32:35], v17 offset:4096
    v_mfma_f32_16x16x32_bf16 v[64:67], a[244:247], v[40:43], v[64:67]
    s_waitcnt lgkmcnt(4)
    v_mfma_f32_16x16x32_bf16 v[52:55], a[248:251], v[44:47], v[52:55]
    ds_read_b128 v[36:39], v18 offset:0
    v_mfma_f32_16x16x32_bf16 v[56:59], a[252:255], v[44:47], v[56:59]
    v_mfma_f32_16x16x32_bf16 v[60:63], a[248:251], v[48:51], v[60:63]
    ds_read_b128 v[40:43], v18 offset:4096
    v_mfma_f32_16x16x32_bf16 v[64:67], a[252:255], v[48:51], v[64:67]
    s_waitcnt lgkmcnt(4)
    s_add_u32 s22, s22, 1
    s_cmp_ge_u32 s22, s23
    s_cbranch_scc1 L_fl0_208
    v_mfma_f32_16x16x32_bf16 v[68:71], a[0:3], v[20:23], 0
    ds_read_b128 v[44:47], v19 offset:0
    s_add_u32 m0, s21, 33792
    v_mfma_f32_16x16x32_bf16 v[72:75], a[4:7], v[20:23], 0
    buffer_load_dwordx4 v9, s[8:11], s20 offen lds
    v_mfma_f32_16x16x32_bf16 v[76:79], a[0:3], v[24:27], 0
    ds_read_b128 v[48:51], v19 offset:4096
    s_sub_u32 s39, s22, 1
    v_mfma_f32_16x16x32_bf16 v[80:83], a[4:7], v[24:27], 0
    s_waitcnt lgkmcnt(4)
    s_bitcmp1_b32 s39, 1
    s_cselect_b32 s38, s55, s54
    v_mfma_f32_16x16x32_bf16 v[68:71], a[8:11], v[28:31], v[68:71]
    ds_read_b128 v[20:23], v16 offset:256
    v_mfma_f32_16x16x32_bf16 v[72:75], a[12:15], v[28:31], v[72:75]
    s_add_u32 s38, s38, s44
    s_lshl_b32 s42, s39, 20
    v_mfma_f32_16x16x32_bf16 v[76:79], a[8:11], v[32:35], v[76:79]
    ds_read_b128 v[24:27], v16 offset:4352
    s_add_u32 s38, s38, s42
    v_mfma_f32_16x16x32_bf16 v[80:83], a[12:15], v[32:35], v[80:83]
    s_waitcnt lgkmcnt(4)
    s_lshl_b32 s39, s39, 7
    v_mfma_f32_16x16x32_bf16 v[68:71], a[16:19], v[36:39], v[68:71]
    ds_read_b128 v[28:31], v17 offset:256
    s_add_u32 m0, s21, 34816
    v_mfma_f32_16x16x32_bf16 v[72:75], a[20:23], v[36:39], v[72:75]
    buffer_load_dwordx4 v10, s[8:11], s20 offen lds
    v_mfma_f32_16x16x32_bf16 v[76:79], a[16:19], v[40:43], v[76:79]
    ds_read_b128 v[32:35], v17 offset:4352
    s_add_u32 s39, s39, 0x5900000
    v_mfma_f32_16x16x32_bf16 v[80:83], a[20:23], v[40:43], v[80:83]
    s_waitcnt lgkmcnt(4)
    s_cmp_eq_u32 s37, 0
    s_cselect_b32 s38, 0x7ff00000, s38
    s_cselect_b32 s39, 0x7ff00000, s39
    v_mfma_f32_16x16x32_bf16 v[68:71], a[24:27], v[44:47], v[68:71]
    ds_read_b128 v[36:39], v18 offset:256
    v_mfma_f32_16x16x32_bf16 v[72:75], a[28:31], v[44:47], v[72:75]
    v_cvt_pk_bf16_f32 v88, v52, v53
    v_mfma_f32_16x16x32_bf16 v[76:79], a[24:27], v[48:51], v[76:79]
    ds_read_b128 v[40:43], v18 offset:4352
    v_cvt_pk_bf16_f32 v89, v54, v55
    v_mfma_f32_16x16x32_bf16 v[80:83], a[28:31], v[48:51], v[80:83]
    s_waitcnt lgkmcnt(4)
    v_cvt_pk_bf16_f32 v90, v56, v57
    v_mfma_f32_16x16x32_bf16 v[68:71], a[32:35], v[20:23], v[68:71]
    ds_read_b128 v[44:47], v19 offset:256
    s_add_u32 m0, s21, 35840
    v_mfma_f32_16x16x32_bf16 v[72:75], a[36:39], v[20:23], v[72:75]
    buffer_load_dwordx4 v11, s[8:11], s20 offen lds
    v_mfma_f32_16x16x32_bf16 v[76:79], a[32:35], v[24:27], v[76:79]
    ds_read_b128 v[48:51], v19 offset:4352
    v_cvt_pk_bf16_f32 v91, v58, v59
    v_mfma_f32_16x16x32_bf16 v[80:83], a[36:39], v[24:27], v[80:83]
    s_waitcnt lgkmcnt(4)
    v_mfma_f32_16x16x32_bf16 v[68:71], a[40:43], v[28:31], v[68:71]
    s_waitcnt vmcnt(20)
    s_barrier
    ds_read_b128 v[20:23], v16 offset:16384
    v_mfma_f32_16x16x32_bf16 v[72:75], a[44:47], v[28:31], v[72:75]
    s_add_u32 s20, s20, 512
    buffer_store_dwordx4 v[88:91], v86, s[12:15], s38 offen offset:0 sc1
    v_mfma_f32_16x16x32_bf16 v[76:79], a[40:43], v[32:35], v[76:79]
    ds_read_b128 v[24:27], v16 offset:20480
    v_cvt_pk_bf16_f32 v92, v60, v61
    v_mfma_f32_16x16x32_bf16 v[80:83], a[44:47], v[32:35], v[80:83]
    s_waitcnt lgkmcnt(4)
    v_cvt_pk_bf16_f32 v93, v62, v63
    v_mfma_f32_16x16x32_bf16 v[68:71], a[48:51], v[36:39], v[68:71]
    ds_read_b128 v[28:31], v17 offset:16384
    s_add_u32 m0, s21, 49152
    v_mfma_f32_16x16x32_bf16 v[72:75], a[52:55], v[36:39], v[72:75]
    buffer_load_dwordx4 v8, s[8:11], s20 offen lds
    v_mfma_f32_16x16x32_bf16 v[76:79], a[48:51], v[40:43], v[76:79]
    ds_read_b128 v[32:35], v17 offset:20480
    v_cvt_pk_bf16_f32 v94, v64, v65
    v_mfma_f32_16x16x32_bf16 v[80:83], a[52:55], v[40:43], v[80:83]
    s_waitcnt lgkmcnt(4)
    v_cvt_pk_bf16_f32 v95, v66, v67
    v_mfma_f32_16x16x32_bf16 v[68:71], a[56:59], v[44:47], v[68:71]
    ds_read_b128 v[36:39], v18 offset:16384
    v_mfma_f32_16x16x32_bf16 v[72:75], a[60:63], v[44:47], v[72:75]
    buffer_store_dwordx4 v[92:95], v86, s[12:15], s38 offen offset:128 sc1
    v_mfma_f32_16x16x32_bf16 v[76:79], a[56:59], v[48:51], v[76:79]
    ds_read_b128 v[40:43], v18 offset:20480
    s_add_u32 s42, s38, 0x8000000
    v_mfma_f32_16x16x32_bf16 v[80:83], a[60:63], v[48:51], v[80:83]
    s_waitcnt lgkmcnt(4)
    s_cmp_le_u32 s22, 60
    s_cbranch_scc1 L_nokm_213
    buffer_store_dwordx4 v[96:99], v100, s[12:15], s42 offen offset:3072 sc1
L_nokm_213:
    v_mfma_f32_16x16x32_bf16 v[68:71], a[64:67], v[20:23], v[68:71]
    ds_read_b128 v[44:47], v19 offset:16384
    s_add_u32 m0, s21, 50176
    v_mfma_f32_16x16x32_bf16 v[72:75], a[68:71], v[20:23], v[72:75]
    buffer_load_dwordx4 v9, s[8:11], s20 offen lds
    v_mfma_f32_16x16x32_bf16 v[76:79], a[64:67], v[24:27], v[76:79]
    ds_read_b128 v[48:51], v19 offset:20480
    v_mfma_f32_16x16x32_bf16 v[80:83], a[68:71], v[24:27], v[80:83]
    s_waitcnt lgkmcnt(4)
    v_mfma_f32_16x16x32_bf16 v[68:71], a[72:75], v[28:31], v[68:71]
    ds_read_b128 v[20:23], v16 offset:16640
    v_mfma_f32_16x16x32_bf16 v[72:75], a[76:79], v[28:31], v[72:75]
    buffer_store_dwordx4 v[96:99], v100, s[12:15], s42 offen offset:0 sc1
    v_mfma_f32_16x16x32_bf16 v[76:79], a[72:75], v[32:35], v[76:79]
    ds_read_b128 v[24:27], v16 offset:20736
    s_add_u32 s24, s24, 1
    v_mfma_f32_16x16x32_bf16 v[80:83], a[76:79], v[32:35], v[80:83]
    s_waitcnt lgkmcnt(4)
    v_mfma_f32_16x16x32_bf16 v[68:71], a[80:83], v[36:39], v[68:71]
    ds_read_b128 v[28:31], v17 offset:16640
    s_add_u32 m0, s21, 51200
    v_mfma_f32_16x16x32_bf16 v[72:75], a[84:87], v[36:39], v[72:75]
    buffer_load_dwordx4 v10, s[8:11], s20 offen lds
    v_mfma_f32_16x16x32_bf16 v[76:79], a[80:83], v[40:43], v[76:79]
    ds_read_b128 v[32:35], v17 offset:20736
    v_mfma_f32_16x16x32_bf16 v[80:83], a[84:87], v[40:43], v[80:83]
    s_waitcnt lgkmcnt(4)
    s_min_u32 s24, s24, 63
    v_mfma_f32_16x16x32_bf16 v[68:71], a[88:91], v[44:47], v[68:71]
    ds_read_b128 v[36:39], v18 offset:16640
    v_mfma_f32_16x16x32_bf16 v[72:75], a[92:95], v[44:47], v[72:75]
    v_mfma_f32_16x16x32_bf16 v[76:79], a[88:91], v[48:51], v[76:79]
    ds_read_b128 v[40:43], v18 offset:20736
    s_lshl_b32 s53, s24, 16
    v_mfma_f32_16x16x32_bf16 v[80:83], a[92:95], v[48:51], v[80:83]
    s_waitcnt lgkmcnt(4)
    v_mfma_f32_16x16x32_bf16 v[68:71], a[96:99], v[20:23], v[68:71]
    ds_read_b128 v[44:47], v19 offset:16640
    s_add_u32 m0, s21, 52224
    v_mfma_f32_16x16x32_bf16 v[72:75], a[100:103], v[20:23], v[72:75]
    buffer_load_dwordx4 v11, s[8:11], s20 offen lds
    v_mfma_f32_16x16x32_bf16 v[76:79], a[96:99], v[24:27], v[76:79]
    ds_read_b128 v[48:51], v19 offset:20736
    v_mfma_f32_16x16x32_bf16 v[80:83], a[100:103], v[24:27], v[80:83]
    s_waitcnt lgkmcnt(4)
    v_mfma_f32_16x16x32_bf16 v[68:71], a[104:107], v[28:31], v[68:71]
    s_waitcnt vmcnt(20)
    s_barrier
    ds_read_b128 v[20:23], v16 offset:32768
    v_mfma_f32_16x16x32_bf16 v[72:75], a[108:111], v[28:31], v[72:75]
    s_mov_b32 s20, s53
    v_mfma_f32_16x16x32_bf16 v[76:79], a[104:107], v[32:35], v[76:79]
    ds_read_b128 v[24:27], v16 offset:36864
    v_mfma_f32_16x16x32_bf16 v[80:83], a[108:111], v[32:35], v[80:83]
    s_waitcnt lgkmcnt(4)
    v_mfma_f32_16x16x32_bf16 v[68:71], a[112:115], v[36:39], v[68:71]
    ds_read_b128 v[28:31], v17 offset:32768
    s_add_u32 m0, s21, 65536
    v_mfma_f32_16x16x32_bf16 v[72:75], a[116:119], v[36:39], v[72:75]
    buffer_load_dwordx4 v8, s[8:11], s20 offen lds
    v_mfma_f32_16x16x32_bf16 v[76:79], a[112:115], v[40:43], v[76:79]
    ds_read_b128 v[32:35], v17 offset:36864
    v_mfma_f32_16x16x32_bf16 v[80:83], a[116:119], v[40:43], v[80:83]
    s_waitcnt lgkmcnt(4)
    v_mfma_f32_16x16x32_bf16 v[68:71], a[120:123], v[44:47], v[68:71]
    ds_read_b128 v[36:39], v18 offset:32768
    v_mfma_f32_16x16x32_bf16 v[72:75], a[124:127], v[44:47], v[72:75]
    v_mfma_f32_16x16x32_bf16 v[76:79], a[120:123], v[48:51], v[76:79]
    ds_read_b128 v[40:43], v18 offset:36864
    v_mfma_f32_16x16x32_bf16 v[80:83], a[124:127], v[48:51], v[80:83]
    s_waitcnt lgkmcnt(4)
    v_mfma_f32_16x16x32_bf16 v[68:71], a[128:131], v[20:23], v[68:71]
    ds_read_b128 v[44:47], v19 offset:32768
    s_add_u32 m0, s21, 66560
    v_mfma_f32_16x16x32_bf16 v[72:75], a[132:135], v[20:23], v[72:75]
    buffer_load_dwordx4 v9, s[8:11], s20 offen lds
    v_mfma_f32_16x16x32_bf16 v[76:79], a[128:131], v[24:27], v[76:79]
    ds_read_b128 v[48:51], v19 offset:36864
    v_mfma_f32_16x16x32_bf16 v[80:83], a[132:135], v[24:27], v[80:83]
    s_waitcnt lgkmcnt(4)
    v_mfma_f32_16x16x32_bf16 v[68:71], a[136:139], v[28:31], v[68:71]
    ds_read_b128 v[20:23], v16 offset:33024
    v_mfma_f32_16x16x32_bf16 v[72:75], a[140:143], v[28:31], v[72:75]
    v_mfma_f32_16x16x32_bf16 v[76:79], a[136:139], v[32:35], v[76:79]
    ds_read_b128 v[24:27], v16 offset:37120
    v_mfma_f32_16x16x32_bf16 v[80:83], a[140:143], v[32:35], v[80:83]
    s_waitcnt lgkmcnt(4)
    v_mfma_f32_16x16x32_bf16 v[68:71], a[144:147], v[36:39], v[68:71]
    ds_read_b128 v[28:31], v17 offset:33024
    s_add_u32 m0, s21, 67584
    v_mfma_f32_16x16x32_bf16 v[72:75], a[148:151], v[36:39], v[72:75]
    buffer_load_dwordx4 v10, s[8:11], s20 offen lds
    v_mfma_f32_16x16x32_bf16 v[76:79], a[144:147], v[40:43], v[76:79]
    ds_read_b128 v[32:35], v17 offset:37120
    v_mfma_f32_16x16x32_bf16 v[80:83], a[148:151], v[40:43], v[80:83]
    s_waitcnt lgkmcnt(4)
    v_mfma_f32_16x16x32_bf16 v[68:71], a[152:155], v[44:47], v[68:71]
    ds_read_b128 v[36:39], v18 offset:33024
    v_mfma_f32_16x16x32_bf16 v[72:75], a[156:159], v[44:47], v[72:75]
    v_mfma_f32_16x16x32_bf16 v[76:79], a[152:155], v[48:51], v[76:79]
    ds_read_b128 v[40:43], v18 offset:37120
    v_mfma_f32_16x16x32_bf16 v[80:83], a[156:159], v[48:51], v[80:83]
    s_waitcnt lgkmcnt(4)
    v_mfma_f32_16x16x32_bf16 v[68:71], a[160:163], v[20:23], v[68:71]
    ds_read_b128 v[44:47], v19 offset:33024
    s_add_u32 m0, s21, 68608
    v_mfma_f32_16x16x32_bf16 v[72:75], a[164:167], v[20:23], v[72:75]
    buffer_load_dwordx4 v11, s[8:11], s20 offen lds
    v_mfma_f32_16x16x32_bf16 v[76:79], a[160:163], v[24:27], v[76:79]
    ds_read_b128 v[48:51], v19 offset:37120
    v_mfma_f32_16x16x32_bf16 v[80:83], a[164:167], v[24:27], v[80:83]
    s_waitcnt lgkmcnt(4)
    v_mfma_f32_16x16x32_bf16 v[68:71], a[168:171], v[28:31], v[68:71]
    s_waitcnt vmcnt(20)
    s_barrier
    ds_read_b128 v[20:23], v16 offset:49152
    v_mfma_f32_16x16x32_bf16 v[72:75], a[172:175], v[28:31], v[72:75]
    s_add_u32 s20, s20, 512
    v_mfma_f32_16x16x32_bf16 v[76:79], a[168:171], v[32:35], v[76:79]
    ds_read_b128 v[24:27], v16 offset:53248
    v_mfma_f32_16x16x32_bf16 v[80:83], a[172:175], v[32:35], v[80:83]
    s_waitcnt lgkmcnt(4)
    v_mfma_f32_16x16x32_bf16 v[68:71], a[176:179], v[36:39], v[68:71]
    ds_read_b128 v[28:31], v17 offset:49152
    s_add_u32 m0, s21, 81920
    v_mfma_f32_16x16x32_bf16 v[72:75], a[180:183], v[36:39], v[72:75]
    buffer_load_dwordx4 v8, s[8:11], s20 offen lds
    v_mfma_f32_16x16x32_bf16 v[76:79], a[176:179], v[40:43], v[76:79]
    ds_read_b128 v[32:35], v17 offset:53248
    v_mfma_f32_16x16x32_bf16 v[80:83], a[180:183], v[40:43], v[80:83]
    s_waitcnt lgkmcnt(4)
    v_mfma_f32_16x16x32_bf16 v[68:71], a[184:187], v[44:47], v[68:71]
    ds_read_b128 v[36:39], v18 offset:49152
    v_mfma_f32_16x16x32_bf16 v[72:75], a[188:191], v[44:47], v[72:75]
    v_mfma_f32_16x16x32_bf16 v[76:79], a[184:187], v[48:51], v[76:79]
    ds_read_b128 v[40:43], v18 offset:53248
    v_mfma_f32_16x16x32_bf16 v[80:83], a[188:191], v[48:51], v[80:83]
    s_waitcnt lgkmcnt(4)
    v_mfma_f32_16x16x32_bf16 v[68:71], a[192:195], v[20:23], v[68:71]
    ds_read_b128 v[44:47], v19 offset:49152
    s_add_u32 m0, s21, 82944
    v_mfma_f32_16x16x32_bf16 v[72:75], a[196:199], v[20:23], v[72:75]
    buffer_load_dwordx4 v9, s[8:11], s20 offen lds
    v_mfma_f32_16x16x32_bf16 v[76:79], a[192:195], v[24:27], v[76:79]
    ds_read_b128 v[48:51], v19 offset:53248
    v_mfma_f32_16x16x32_bf16 v[80:83], a[196:199], v[24:27], v[80:83]
    s_waitcnt lgkmcnt(4)
    v_mfma_f32_16x16x32_bf16 v[68:71], a[200:203], v[28:31], v[68:71]
    ds_read_b128 v[20:23], v16 offset:49408
    v_mfma_f32_16x16x32_bf16 v[72:75], a[204:207], v[28:31], v[72:75]
    v_mfma_f32_16x16x32_bf16 v[76:79], a[200:203], v[32:35], v[76:79]
    ds_read_b128 v[24:27], v16 offset:53504
    v_mfma_f32_16x16x32_bf16 v[80:83], a[204:207], v[32:35], v[80:83]
    s_waitcnt lgkmcnt(4)
    v_mfma_f32_16x16x32_bf16 v[68:71], a[208:211], v[36:39], v[68:71]
    ds_read_b128 v[28:31], v17 offset:49408
    s_add_u32 m0, s21, 83968
    v_mfma_f32_16x16x32_bf16 v[72:75], a[212:215], v[36:39], v[72:75]
    buffer_load_dwordx4 v10, s[8:11], s20 offen lds
    v_mfma_f32_16x16x32_bf16 v[76:79], a[208:211], v[40:43], v[76:79]
    ds_read_b128 v[32:35], v17 offset:53504
    v_mfma_f32_16x16x32_bf16 v[80:83], a[212:215], v[40:43], v[80:83]
    s_waitcnt lgkmcnt(4)
    v_mfma_f32_16x16x32_bf16 v[68:71], a[216:219], v[44:47], v[68:71]
    ds_read_b128 v[36:39], v18 offset:49408
    v_mfma_f32_16x16x32_bf16 v[72:75], a[220:223], v[44:47], v[72:75]
    v_mfma_f32_16x16x32_bf16 v[76:79], a[216:219], v[48:51], v[76:79]
    ds_read_b128 v[40:43], v18 offset:53504
    v_mfma_f32_16x16x32_bf16 v[80:83], a[220:223], v[48:51], v[80:83]
    s_waitcnt lgkmcnt(4)
    v_mfma_f32_16x16x32_bf16 v[68:71], a[224:227], v[20:23], v[68:71]
    ds_read_b128 v[44:47], v19 offset:49408
    s_add_u32 m0, s21, 84992
    v_mfma_f32_16x16x32_bf16 v[72:75], a[228:231], v[20:23], v[72:75]
    buffer_load_dwordx4 v11, s[8:11], s20 offen lds
    v_mfma_f32_16x16x32_bf16 v[76:79], a[224:227], v[24:27], v[76:79]
    ds_read_b128 v[48:51], v19 offset:53504
    v_mfma_f32_16x16x32_bf16 v[80:83], a[228:231], v[24:27], v[80:83]
    s_waitcnt lgkmcnt(4)
    v_mfma_f32_16x16x32_bf16 v[68:71], a[232:235], v[28:31], v[68:71]
    s_waitcnt vmcnt(10)
    s_barrier
    ds_read_b128 v[20:23], v12 offset:0
    v_mfma_f32_16x16x32_bf16 v[72:75], a[236:239], v[28:31], v[72:75]
    s_add_u32 s20, s20, 512
    buffer_atomic_add v84, v85, s[12:15], s39 offen sc1
    v_mfma_f32_16x16x32_bf16 v[76:79], a[232:235], v[32:35], v[76:79]
    ds_read_b128 v[24:27], v12 offset:4096
    s_mov_b32 s37, 1
    v_mfma_f32_16x16x32_bf16 v[80:83], a[236:239], v[32:35], v[80:83]
    s_waitcnt lgkmcnt(4)
    v_mfma_f32_16x16x32_bf16 v[68:71], a[240:243], v[36:39], v[68:71]
    ds_read_b128 v[28:31], v13 offset:0
    s_add_u32 m0, s21, 98304
    v_mfma_f32_16x16x32_bf16 v[72:75], a[244:247], v[36:39], v[72:75]
    buffer_load_dwordx4 v8, s[8:11], s20 offen lds
    v_mfma_f32_16x16x32_bf16 v[76:79], a[240:243], v[40:43], v[76:79]
    ds_read_b128 v[32:35], v13 offset:4096
    v_mfma_f32_16x16x32_bf16 v[80:83], a[244:247], v[40:43], v[80:83]
    s_waitcnt lgkmcnt(4)
    v_mfma_f32_16x16x32_bf16 v[68:71], a[248:251], v[44:47], v[68:71]
    ds_read_b128 v[36:39], v14 offset:0
    v_mfma_f32_16x16x32_bf16 v[72:75], a[252:255], v[44:47], v[72:75]
    v_mfma_f32_16x16x32_bf16 v[76:79], a[248:251], v[48:51], v[76:79]
    ds_read_b128 v[40:43], v14 offset:4096
    v_mfma_f32_16x16x32_bf16 v[80:83], a[252:255], v[48:51], v[80:83]
    s_waitcnt lgkmcnt(4)
    s_add_u32 s22, s22, 1
    s_cmp_ge_u32 s22, s23
    s_cbranch_scc0 L_st_211
L_fl1_209:
    s_waitcnt lgkmcnt(0)
    s_nop 7
    s_sub_u32 s39, s22, 1
    s_bitcmp1_b32 s39, 1
    s_cselect_b32 s38, s55, s54
    s_add_u32 s38, s38, s44
    s_lshl_b32 s42, s39, 20
    s_add_u32 s38, s38, s42
    s_lshl_b32 s39, s39, 7
    s_add_u32 s39, s39, 0x5900000
    s_cmp_eq_u32 s37, 0
    s_cselect_b32 s38, 0x7ff00000, s38
    s_cselect_b32 s39, 0x7ff00000, s39
    v_cvt_pk_bf16_f32 v88, v68, v69
    v_cvt_pk_bf16_f32 v89, v70, v71
    v_cvt_pk_bf16_f32 v90, v72, v73
    v_cvt_pk_bf16_f32 v91, v74, v75
    buffer_store_dwordx4 v[88:91], v86, s[12:15], s38 offen offset:0 sc1
    v_cvt_pk_bf16_f32 v92, v76, v77
    v_cvt_pk_bf16_f32 v93, v78, v79
    v_cvt_pk_bf16_f32 v94, v80, v81
    v_cvt_pk_bf16_f32 v95, v82, v83
    buffer_store_dwordx4 v[92:95], v86, s[12:15], s38 offen offset:128 sc1
    s_add_u32 s42, s38, 0x8000000
    s_cmp_le_u32 s22, 60
    s_cbranch_scc1 L_nokm_214
    buffer_store_dwordx4 v[96:99], v100, s[12:15], s42 offen offset:3072 sc1
L_nokm_214:
    buffer_store_dwordx4 v[96:99], v100, s[12:15], s42 offen offset:0 sc1
    s_waitcnt vmcnt(0)
    s_barrier
    buffer_atomic_add v84, v85, s[12:15], s39 offen sc1
    s_mov_b32 s37, 1
    s_branch L_ste_210
L_fl0_208:
    s_waitcnt lgkmcnt(0)
    s_nop 7
    s_sub_u32 s39, s22, 1
    s_bitcmp1_b32 s39, 1
    s_cselect_b32 s38, s55, s54
    s_add_u32 s38, s38, s44
    s_lshl_b32 s42, s39, 20
    s_add_u32 s38, s38, s42
    s_lshl_b32 s39, s39, 7
    s_add_u32 s39, s39, 0x5900000
    s_cmp_eq_u32 s37, 0
    s_cselect_b32 s38, 0x7ff00000, s38
    s_cselect_b32 s39, 0x7ff00000, s39
    v_cvt_pk_bf16_f32 v88, v52, v53
    v_cvt_pk_bf16_f32 v89, v54, v55
    v_cvt_pk_bf16_f32 v90, v56, v57
    v_cvt_pk_bf16_f32 v91, v58, v59
    buffer_store_dwordx4 v[88:91], v86, s[12:15], s38 offen offset:0 sc1
    v_cvt_pk_bf16_f32 v92, v60, v61
    v_cvt_pk_bf16_f32 v93, v62, v63
    v_cvt_pk_bf16_f32 v94, v64, v65
    v_cvt_pk_bf16_f32 v95, v66, v67
    buffer_store_dwordx4 v[92:95], v86, s[12:15], s38 offen offset:128 sc1
    s_add_u32 s42, s38, 0x8000000
    s_cmp_le_u32 s22, 60
    s_cbranch_scc1 L_nokm_215
    buffer_store_dwordx4 v[96:99], v100, s[12:15], s42 offen offset:3072 sc1
L_nokm_215:
    buffer_store_dwordx4 v[96:99], v100, s[12:15], s42 offen offset:0 sc1
    s_waitcnt vmcnt(0)
    s_barrier
    buffer_atomic_add v84, v85, s[12:15], s39 offen sc1
    s_mov_b32 s37, 1
L_ste_210:
    s_branch L_op_205
L_v_201:
    v_mov_b32 v96, 0xff81ff81
    v_mov_b32 v97, 0xff81ff81
    v_mov_b32 v98, 0xff81ff81
    v_mov_b32 v99, 0xff81ff81
    v_and_b32 v100, 63, v0
    v_lshlrev_b32 v100, 4, v100
    s_barrier
    s_add_u32 m0, s21, 0
    s_nop 0
    buffer_load_dwordx4 v8, s[8:11], s20 offen lds
    s_add_u32 m0, s21, 1024
    s_nop 0
    buffer_load_dwordx4 v9, s[8:11], s20 offen lds
    s_add_u32 m0, s21, 2048
    s_nop 0
    buffer_load_dwordx4 v10, s[8:11], s20 offen lds
    s_add_u32 m0, s21, 3072
    s_nop 0
    buffer_load_dwordx4 v11, s[8:11], s20 offen lds
    s_add_u32 s20, s20, 512
    s_add_u32 m0, s21, 16384
    s_nop 0
    buffer_load_dwordx4 v8, s[8:11], s20 offen lds
    s_add_u32 m0, s21, 17408
    s_nop 0
    buffer_load_dwordx4 v9, s[8:11], s20 offen lds
    s_add_u32 m0, s21, 18432
    s_nop 0
    buffer_load_dwordx4 v10, s[8:11], s20 offen lds
    s_add_u32 m0, s21, 19456
    s_nop 0
    buffer_load_dwordx4 v11, s[8:11], s20 offen lds
    s_add_u32 s20, s20, 512
    s_add_u32 m0, s21, 32768
    s_nop 0
    buffer_load_dwordx4 v8, s[8:11], s20 offen lds
    s_add_u32 m0, s21, 33792
    s_nop 0
    buffer_load_dwordx4 v9, s[8:11], s20 offen lds
    s_add_u32 m0, s21, 34816
    s_nop 0
    buffer_load_dwordx4 v10, s[8:11], s20 offen lds
    s_add_u32 m0, s21, 35840
    s_nop 0
    buffer_load_dwordx4 v11, s[8:11], s20 offen lds
    s_add_u32 s20, s20, 512
    s_add_u32 m0, s21, 49152
    s_nop 0
    buffer_load_dwordx4 v8, s[8:11], s20 offen lds
    s_add_u32 m0, s21, 50176
    s_nop 0
    buffer_load_dwordx4 v9, s[8:11], s20 offen lds
    s_add_u32 m0, s21, 51200
    s_nop 0
    buffer_load_dwordx4 v10, s[8:11], s20 offen lds
    s_add_u32 m0, s21, 52224
    s_nop 0
    buffer_load_dwordx4 v11, s[8:11], s20 offen lds
    s_add_u32 s24, s24, 1
    s_min_u32 s24, s24, 63
    s_lshl_b32 s53, s24, 16
    s_mov_b32 s20, s53
    s_add_u32 m0, s21, 65536
    s_nop 0
    buffer_load_dwordx4 v8, s[8:11], s20 offen lds
    s_add_u32 m0, s21, 66560
    s_nop 0
    buffer_load_dwordx4 v9, s[8:11], s20 offen lds
    s_add_u32 m0, s21, 67584
    s_nop 0
    buffer_load_dwordx4 v10, s[8:11], s20 offen lds
    s_add_u32 m0, s21, 68608
    s_nop 0
    buffer_load_dwordx4 v11, s[8:11], s20 offen lds
    s_add_u32 s20, s20, 512
    s_add_u32 m0, s21, 81920
    s_nop 0
    buffer_load_dwordx4 v8, s[8:11], s20 offen lds
    s_add_u32 m0, s21, 82944
    s_nop 0
    buffer_load_dwordx4 v9, s[8:11], s20 offen lds
    s_add_u32 m0, s21, 83968
    s_nop 0
    buffer_load_dwordx4 v10, s[8:11], s20 offen lds
    s_add_u32 m0, s21, 84992
    s_nop 0
    buffer_load_dwordx4 v11, s[8:11], s20 offen lds
    s_add_u32 s20, s20, 512
    s_add_u32 m0, s21, 98304
    s_nop 0
    buffer_load_dwordx4 v8, s[8:11], s20 offen lds
    s_waitcnt vmcnt(21)
    s_barrier
    ds_read_b128 v[20:23], v12 offset:0
    ds_read_b128 v[24:27], v12 offset:4096
    ds_read_b128 v[28:31], v13 offset:0
    ds_read_b128 v[32:35], v13 offset:4096
    ds_read_b128 v[36:39], v14 offset:0
    ds_read_b128 v[40:43], v14 offset:4096
    s_waitcnt lgkmcnt(4)
L_st_219:
    v_mfma_f32_16x16x32_bf16 v[52:55], v[20:23], a[0:3], 0
    ds_read_b128 v[44:47], v15 offset:0
    s_add_u32 m0, s21, 99328
    v_mfma_f32_16x16x32_bf16 v[56:59], v[20:23], a[4:7], 0
    buffer_load_dwordx4 v9, s[8:11], s20 offen lds
    v_mfma_f32_16x16x32_bf16 v[60:63], v[24:27], a[0:3], 0
    ds_read_b128 v[48:51], v15 offset:4096
    s_sub_u32 s39, s22, 1
    v_mfma_f32_16x16x32_bf16 v[64:67], v[24:27], a[4:7], 0
    s_waitcnt lgkmcnt(4)
    s_bitcmp1_b32 s39, 1
    s_cselect_b32 s38, s55, s54
    v_mfma_f32_16x16x32_bf16 v[52:55], v[28:31], a[8:11], v[52:55]
    ds_read_b128 v[20:23], v12 offset:256
    v_mfma_f32_16x16x32_bf16 v[56:59], v[28:31], a[12:15], v[56:59]
    s_add_u32 s38, s38, s44
    s_lshl_b32 s42, s39, 20
    v_mfma_f32_16x16x32_bf16 v[60:63], v[32:35], a[8:11], v[60:63]
    ds_read_b128 v[24:27], v12 offset:4352
    s_add_u32 s38, s38, s42
    v_mfma_f32_16x16x32_bf16 v[64:67], v[32:35], a[12:15], v[64:67]
    s_waitcnt lgkmcnt(4)
    s_lshl_b32 s39, s39, 7
    v_mfma_f32_16x16x32_bf16 v[52:55], v[36:39], a[16:19], v[52:55]
    ds_read_b128 v[28:31], v13 offset:256
    s_add_u32 m0, s21, 100352
    v_mfma_f32_16x16x32_bf16 v[56:59], v[36:39], a[20:23], v[56:59]
    buffer_load_dwordx4 v10, s[8:11], s20 offen lds
    v_mfma_f32_16x16x32_bf16 v[60:63], v[40:43], a[16:19], v[60:63]
    ds_read_b128 v[32:35], v13 offset:4352
    s_add_u32 s39, s39, 0x5900000
    v_mfma_f32_16x16x32_bf16 v[64:67], v[40:43], a[20:23], v[64:67]
    s_waitcnt lgkmcnt(4)
    s_cmp_eq_u32 s37, 0
    s_cselect_b32 s38, 0x7ff00000, s38
    s_cselect_b32 s39, 0x7ff00000, s39
    v_mfma_f32_16x16x32_bf16 v[52:55], v[44:47], a[24:27], v[52:55]
    ds_read_b128 v[36:39], v14 offset:256
    v_mfma_f32_16x16x32_bf16 v[56:59], v[44:47], a[28:31], v[56:59]
    v_cvt_pk_bf16_f32 v88, v68, v69
    v_mfma_f32_16x16x32_bf16 v[60:63], v[48:51], a[24:27], v[60:63]
    ds_read_b128 v[40:43], v14 offset:4352
    v_cvt_pk_bf16_f32 v89, v70, v71
    v_mfma_f32_16x16x32_bf16 v[64:67], v[48:51], a[28:31], v[64:67]
    s_waitcnt lgkmcnt(4)
    v_cvt_pk_bf16_f32 v90, v76, v77
    v_mfma_f32_16x16x32_bf16 v[52:55], v[20:23], a[32:35], v[52:55]
    ds_read_b128 v[44:47], v15 offset:256
    s_add_u32 m0, s21, 101376
    v_mfma_f32_16x16x32_bf16 v[56:59], v[20:23], a[36:39], v[56:59]
    buffer_load_dwordx4 v11, s[8:11], s20 offen lds
    v_mfma_f32_16x16x32_bf16 v[60:63], v[24:27], a[32:35], v[60:63]
    ds_read_b128 v[48:51], v15 offset:4352
    v_cvt_pk_bf16_f32 v91, v78, v79
    v_mfma_f32_16x16x32_bf16 v[64:67], v[24:27], a[36:39], v[64:67]
    s_waitcnt lgkmcnt(4)
    v_mfma_f32_16x16x32_bf16 v[52:55], v[28:31], a[40:43], v[52:55]
    s_waitcnt vmcnt(20)
    s_barrier
    ds_read_b128 v[20:23], v12 offset:16384
    v_mfma_f32_16x16x32_bf16 v[56:59], v[28:31], a[44:47], v[56:59]
    s_add_u32 s20, s20, 512
    buffer_store_dwordx4 v[88:91], v86, s[12:15], s38 offen offset:2048 sc1
    v_mfma_f32_16x16x32_bf16 v[60:63], v[32:35], a[40:43], v[60:63]
    ds_read_b128 v[24:27], v12 offset:20480
    v_cvt_pk_bf16_f32 v92, v72, v73
    v_mfma_f32_16x16x32_bf16 v[64:67], v[32:35], a[44:47], v[64:67]
    s_waitcnt lgkmcnt(4)
    v_cvt_pk_bf16_f32 v93, v74, v75
    v_mfma_f32_16x16x32_bf16 v[52:55], v[36:39], a[48:51], v[52:55]
    ds_read_b128 v[28:31], v13 offset:16384
    s_add_u32 m0, s21, 114688
    v_mfma_f32_16x16x32_bf16 v[56:59], v[36:39], a[52:55], v[56:59]
    buffer_load_dwordx4 v8, s[8:11], s20 offen lds
    v_mfma_f32_16x16x32_bf16 v[60:63], v[40:43], a[48:51], v[60:63]
    ds_read_b128 v[32:35], v13 offset:20480
    v_cvt_pk_bf16_f32 v94, v80, v81
    v_mfma_f32_16x16x32_bf16 v[64:67], v[40:43], a[52:55], v[64:67]
    s_waitcnt lgkmcnt(4)
    v_cvt_pk_bf16_f32 v95, v82, v83
    v_mfma_f32_16x16x32_bf16 v[52:55], v[44:47], a[56:59], v[52:55]
    ds_read_b128 v[36:39], v14 offset:16384
    v_mfma_f32_16x16x32_bf16 v[56:59], v[44:47], a[60:63], v[56:59]
    buffer_store_dwordx4 v[92:95], v86, s[12:15], s38 offen offset:2176 sc1
    v_mfma_f32_16x16x32_bf16 v[60:63], v[48:51], a[56:59], v[60:63]
    ds_read_b128 v[40:43], v14 offset:20480
    s_add_u32 s42, s38, 0x8000000
    v_mfma_f32_16x16x32_bf16 v[64:67], v[48:51], a[60:63], v[64:67]
    s_waitcnt lgkmcnt(4)
    v_mfma_f32_16x16x32_bf16 v[52:55], v[20:23], a[64:67], v[52:55]
    ds_read_b128 v[44:47], v15 offset:16384
    s_add_u32 m0, s21, 115712
    v_mfma_f32_16x16x32_bf16 v[56:59], v[20:23], a[68:71], v[56:59]
    buffer_load_dwordx4 v9, s[8:11], s20 offen lds
    v_mfma_f32_16x16x32_bf16 v[60:63], v[24:27], a[64:67], v[60:63]
    ds_read_b128 v[48:51], v15 offset:20480
    v_mfma_f32_16x16x32_bf16 v[64:67], v[24:27], a[68:71], v[64:67]
    s_waitcnt lgkmcnt(4)
    v_mfma_f32_16x16x32_bf16 v[52:55], v[28:31], a[72:75], v[52:55]
    ds_read_b128 v[20:23], v12 offset:16640
    v_mfma_f32_16x16x32_bf16 v[56:59], v[28:31], a[76:79], v[56:59]
    buffer_store_dwordx4 v[96:99], v100, s[12:15], s42 offen offset:1024 sc1
    v_mfma_f32_16x16x32_bf16 v[60:63], v[32:35], a[72:75], v[60:63]
    ds_read_b128 v[24:27], v12 offset:20736
    s_add_u32 s24, s24, 1
    v_mfma_f32_16x16x32_bf16 v[64:67], v[32:35], a[76:79], v[64:67]
    s_waitcnt lgkmcnt(4)
    v_mfma_f32_16x16x32_bf16 v[52:55], v[36:39], a[80:83], v[52:55]
    ds_read_b128 v[28:31], v13 offset:16640
    s_add_u32 m0, s21, 116736
    v_mfma_f32_16x16x32_bf16 v[56:59], v[36:39], a[84:87], v[56:59]
    buffer_load_dwordx4 v10, s[8:11], s20 offen lds
    v_mfma_f32_16x16x32_bf16 v[60:63], v[40:43], a[80:83], v[60:63]
    ds_read_b128 v[32:35], v13 offset:20736
    v_mfma_f32_16x16x32_bf16 v[64:67], v[40:43], a[84:87], v[64:67]
    s_waitcnt lgkmcnt(4)
    s_min_u32 s24, s24, 63
    v_mfma_f32_16x16x32_bf16 v[52:55], v[44:47], a[88:91], v[52:55]
    ds_read_b128 v[36:39], v14 offset:16640
    v_mfma_f32_16x16x32_bf16 v[56:59], v[44:47], a[92:95], v[56:59]
    v_mfma_f32_16x16x32_bf16 v[60:63], v[48:51], a[88:91], v[60:63]
    ds_read_b128 v[40:43], v14 offset:20736
    s_lshl_b32 s53, s24, 16
    v_mfma_f32_16x16x32_bf16 v[64:67], v[48:51], a[92:95], v[64:67]
    s_waitcnt lgkmcnt(4)
    v_mfma_f32_16x16x32_bf16 v[52:55], v[20:23], a[96:99], v[52:55]
    ds_read_b128 v[44:47], v15 offset:16640
    s_add_u32 m0, s21, 117760
    v_mfma_f32_16x16x32_bf16 v[56:59], v[20:23], a[100:103], v[56:59]
    buffer_load_dwordx4 v11, s[8:11], s20 offen lds
    v_mfma_f32_16x16x32_bf16 v[60:63], v[24:27], a[96:99], v[60:63]
    ds_read_b128 v[48:51], v15 offset:20736
    v_mfma_f32_16x16x32_bf16 v[64:67], v[24:27], a[100:103], v[64:67]
    s_waitcnt lgkmcnt(4)
    v_mfma_f32_16x16x32_bf16 v[52:55], v[28:31], a[104:107], v[52:55]
    s_waitcnt vmcnt(20)
    s_barrier
    ds_read_b128 v[20:23], v12 offset:32768
    v_mfma_f32_16x16x32_bf16 v[56:59], v[28:31], a[108:111], v[56:59]
    s_mov_b32 s20, s53
    v_mfma_f32_16x16x32_bf16 v[60:63], v[32:35], a[104:107], v[60:63]
    ds_read_b128 v[24:27], v12 offset:36864
    v_mfma_f32_16x16x32_bf16 v[64:67], v[32:35], a[108:111], v[64:67]
    s_waitcnt lgkmcnt(4)
    v_mfma_f32_16x16x32_bf16 v[52:55], v[36:39], a[112:115], v[52:55]
    ds_read_b128 v[28:31], v13 offset:32768
    s_add_u32 m0, s21, 0
    v_mfma_f32_16x16x32_bf16 v[56:59], v[36:39], a[116:119], v[56:59]
    buffer_load_dwordx4 v8, s[8:11], s20 offen lds
    v_mfma_f32_16x16x32_bf16 v[60:63], v[40:43], a[112:115], v[60:63]
    ds_read_b128 v[32:35], v13 offset:36864
    v_mfma_f32_16x16x32_bf16 v[64:67], v[40:43], a[116:119], v[64:67]
    s_waitcnt lgkmcnt(4)
    v_mfma_f32_16x16x32_bf16 v[52:55], v[44:47], a[120:123], v[52:55]
    ds_read_b128 v[36:39], v14 offset:32768
    v_mfma_f32_16x16x32_bf16 v[56:59], v[44:47], a[124:127], v[56:59]
    v_mfma_f32_16x16x32_bf16 v[60:63], v[48:51], a[120:123], v[60:63]
    ds_read_b128 v[40:43], v14 offset:36864
    v_mfma_f32_16x16x32_bf16 v[64:67], v[48:51], a[124:127], v[64:67]
    s_waitcnt lgkmcnt(4)
    v_mfma_f32_16x16x32_bf16 v[52:55], v[20:23], a[128:131], v[52:55]
    ds_read_b128 v[44:47], v15 offset:32768
    s_add_u32 m0, s21, 1024
    v_mfma_f32_16x16x32_bf16 v[56:59], v[20:23], a[132:135], v[56:59]
    buffer_load_dwordx4 v9, s[8:11], s20 offen lds
    v_mfma_f32_16x16x32_bf16 v[60:63], v[24:27], a[128:131], v[60:63]
    ds_read_b128 v[48:51], v15 offset:36864
    v_mfma_f32_16x16x32_bf16 v[64:67], v[24:27], a[132:135], v[64:67]
    s_waitcnt lgkmcnt(4)
    v_mfma_f32_16x16x32_bf16 v[52:55], v[28:31], a[136:139], v[52:55]
    ds_read_b128 v[20:23], v12 offset:33024
    v_mfma_f32_16x16x32_bf16 v[56:59], v[28:31], a[140:143], v[56:59]
    v_mfma_f32_16x16x32_bf16 v[60:63], v[32:35], a[136:139], v[60:63]
    ds_read_b128 v[24:27], v12 offset:37120
    v_mfma_f32_16x16x32_bf16 v[64:67], v[32:35], a[140:143], v[64:67]
    s_waitcnt lgkmcnt(4)
    v_mfma_f32_16x16x32_bf16 v[52:55], v[36:39], a[144:147], v[52:55]
    ds_read_b128 v[28:31], v13 offset:33024
    s_add_u32 m0, s21, 2048
    v_mfma_f32_16x16x32_bf16 v[56:59], v[36:39], a[148:151], v[56:59]
    buffer_load_dwordx4 v10, s[8:11], s20 offen lds
    v_mfma_f32_16x16x32_bf16 v[60:63], v[40:43], a[144:147], v[60:63]
    ds_read_b128 v[32:35], v13 offset:37120
    v_mfma_f32_16x16x32_bf16 v[64:67], v[40:43], a[148:151], v[64:67]
    s_waitcnt lgkmcnt(4)
    v_mfma_f32_16x16x32_bf16 v[52:55], v[44:47], a[152:155], v[52:55]
    ds_read_b128 v[36:39], v14 offset:33024
    v_mfma_f32_16x16x32_bf16 v[56:59], v[44:47], a[156:159], v[56:59]
    v_mfma_f32_16x16x32_bf16 v[60:63], v[48:51], a[152:155], v[60:63]
    ds_read_b128 v[40:43], v14 offset:37120
    v_mfma_f32_16x16x32_bf16 v[64:67], v[48:51], a[156:159], v[64:67]
    s_waitcnt lgkmcnt(4)
    v_mfma_f32_16x16x32_bf16 v[52:55], v[20:23], a[160:163], v[52:55]
    ds_read_b128 v[44:47], v15 offset:33024
    s_add_u32 m0, s21, 3072
    v_mfma_f32_16x16x32_bf16 v[56:59], v[20:23], a[164:167], v[56:59]
    buffer_load_dwordx4 v11, s[8:11], s20 offen lds
    v_mfma_f32_16x16x32_bf16 v[60:63], v[24:27], a[160:163], v[60:63]
    ds_read_b128 v[48:51], v15 offset:37120
    v_mfma_f32_16x16x32_bf16 v[64:67], v[24:27], a[164:167], v[64:67]
    s_waitcnt lgkmcnt(4)
    v_mfma_f32_16x16x32_bf16 v[52:55], v[28:31], a[168:171], v[52:55]
    s_waitcnt vmcnt(20)
    s_barrier
    ds_read_b128 v[20:23], v12 offset:49152
    v_mfma_f32_16x16x32_bf16 v[56:59], v[28:31], a[172:175], v[56:59]
    s_add_u32 s20, s20, 512
    v_mfma_f32_16x16x32_bf16 v[60:63], v[32:35], a[168:171], v[60:63]
    ds_read_b128 v[24:27], v12 offset:53248
    v_mfma_f32_16x16x32_bf16 v[64:67], v[32:35], a[172:175], v[64:67]
    s_waitcnt lgkmcnt(4)
    v_mfma_f32_16x16x32_bf16 v[52:55], v[36:39], a[176:179], v[52:55]
    ds_read_b128 v[28:31], v13 offset:49152
    s_add_u32 m0, s21, 16384
    v_mfma_f32_16x16x32_bf16 v[56:59], v[36:39], a[180:183], v[56:59]
    buffer_load_dwordx4 v8, s[8:11], s20 offen lds
    v_mfma_f32_16x16x32_bf16 v[60:63], v[40:43], a[176:179], v[60:63]
    ds_read_b128 v[32:35], v13 offset:53248
    v_mfma_f32_16x16x32_bf16 v[64:67], v[40:43], a[180:183], v[64:67]
    s_waitcnt lgkmcnt(4)
    v_mfma_f32_16x16x32_bf16 v[52:55], v[44:47], a[184:187], v[52:55]
    ds_read_b128 v[36:39], v14 offset:49152
    v_mfma_f32_16x16x32_bf16 v[56:59], v[44:47], a[188:191], v[56:59]
    v_mfma_f32_16x16x32_bf16 v[60:63], v[48:51], a[184:187], v[60:63]
    ds_read_b128 v[40:43], v14 offset:53248
    v_mfma_f32_16x16x32_bf16 v[64:67], v[48:51], a[188:191], v[64:67]
    s_waitcnt lgkmcnt(4)
    v_mfma_f32_16x16x32_bf16 v[52:55], v[20:23], a[192:195], v[52:55]
    ds_read_b128 v[44:47], v15 offset:49152
    s_add_u32 m0, s21, 17408
    v_mfma_f32_16x16x32_bf16 v[56:59], v[20:23], a[196:199], v[56:59]
    buffer_load_dwordx4 v9, s[8:11], s20 offen lds
    v_mfma_f32_16x16x32_bf16 v[60:63], v[24:27], a[192:195], v[60:63]
    ds_read_b128 v[48:51], v15 offset:53248
    v_mfma_f32_16x16x32_bf16 v[64:67], v[24:27], a[196:199], v[64:67]
    s_waitcnt lgkmcnt(4)
    v_mfma_f32_16x16x32_bf16 v[52:55], v[28:31], a[200:203], v[52:55]
    ds_read_b128 v[20:23], v12 offset:49408
    v_mfma_f32_16x16x32_bf16 v[56:59], v[28:31], a[204:207], v[56:59]
    v_mfma_f32_16x16x32_bf16 v[60:63], v[32:35], a[200:203], v[60:63]
    ds_read_b128 v[24:27], v12 offset:53504
    v_mfma_f32_16x16x32_bf16 v[64:67], v[32:35], a[204:207], v[64:67]
    s_waitcnt lgkmcnt(4)
    v_mfma_f32_16x16x32_bf16 v[52:55], v[36:39], a[208:211], v[52:55]
    ds_read_b128 v[28:31], v13 offset:49408
    s_add_u32 m0, s21, 18432
    v_mfma_f32_16x16x32_bf16 v[56:59], v[36:39], a[212:215], v[56:59]
    buffer_load_dwordx4 v10, s[8:11], s20 offen lds
    v_mfma_f32_16x16x32_bf16 v[60:63], v[40:43], a[208:211], v[60:63]
    ds_read_b128 v[32:35], v13 offset:53504
    v_mfma_f32_16x16x32_bf16 v[64:67], v[40:43], a[212:215], v[64:67]
    s_waitcnt lgkmcnt(4)
    v_mfma_f32_16x16x32_bf16 v[52:55], v[44:47], a[216:219], v[52:55]
    ds_read_b128 v[36:39], v14 offset:49408
    v_mfma_f32_16x16x32_bf16 v[56:59], v[44:47], a[220:223], v[56:59]
    v_mfma_f32_16x16x32_bf16 v[60:63], v[48:51], a[216:219], v[60:63]
    ds_read_b128 v[40:43], v14 offset:53504
    v_mfma_f32_16x16x32_bf16 v[64:67], v[48:51], a[220:223], v[64:67]
    s_waitcnt lgkmcnt(4)
    v_mfma_f32_16x16x32_bf16 v[52:55], v[20:23], a[224:227], v[52:55]
    ds_read_b128 v[44:47], v15 offset:49408
    s_add_u32 m0, s21, 19456
    v_mfma_f32_16x16x32_bf16 v[56:59], v[20:23], a[228:231], v[56:59]
    buffer_load_dwordx4 v11, s[8:11], s20 offen lds
    v_mfma_f32_16x16x32_bf16 v[60:63], v[24:27], a[224:227], v[60:63]
    ds_read_b128 v[48:51], v15 offset:53504
    v_mfma_f32_16x16x32_bf16 v[64:67], v[24:27], a[228:231], v[64:67]
    s_waitcnt lgkmcnt(4)
    v_mfma_f32_16x16x32_bf16 v[52:55], v[28:31], a[232:235], v[52:55]
    s_waitcnt vmcnt(10)
    s_barrier
    ds_read_b128 v[20:23], v16 offset:0
    v_mfma_f32_16x16x32_bf16 v[56:59], v[28:31], a[236:239], v[56:59]
    s_add_u32 s20, s20, 512
    buffer_atomic_add v84, v85, s[12:15], s39 offen sc1
    v_mfma_f32_16x16x32_bf16 v[60:63], v[32:35], a[232:235], v[60:63]
    ds_read_b128 v[24:27], v16 offset:4096
    s_mov_b32 s37, 1
    v_mfma_f32_16x16x32_bf16 v[64:67], v[32:35], a[236:239], v[64:67]
    s_waitcnt lgkmcnt(4)
    v_mfma_f32_16x16x32_bf16 v[52:55], v[36:39], a[240:243], v[52:55]
    ds_read_b128 v[28:31], v17 offset:0
    s_add_u32 m0, s21, 32768
    v_mfma_f32_16x16x32_bf16 v[56:59], v[36:39], a[244:247], v[56:59]
    buffer_load_dwordx4 v8, s[8:11], s20 offen lds
    v_mfma_f32_16x16x32_bf16 v[60:63], v[40:43], a[240:243], v[60:63]
    ds_read_b128 v[32:35], v17 offset:4096
    v_mfma_f32_16x16x32_bf16 v[64:67], v[40:43], a[244:247], v[64:67]
    s_waitcnt lgkmcnt(4)
    v_mfma_f32_16x16x32_bf16 v[52:55], v[44:47], a[248:251], v[52:55]
    ds_read_b128 v[36:39], v18 offset:0
    v_mfma_f32_16x16x32_bf16 v[56:59], v[44:47], a[252:255], v[56:59]
    v_mfma_f32_16x16x32_bf16 v[60:63], v[48:51], a[248:251], v[60:63]
    ds_read_b128 v[40:43], v18 offset:4096
    v_mfma_f32_16x16x32_bf16 v[64:67], v[48:51], a[252:255], v[64:67]
    s_waitcnt lgkmcnt(4)
    s_add_u32 s22, s22, 1
    s_cmp_ge_u32 s22, s23
    s_cbranch_scc1 L_fl0_216
    v_mfma_f32_16x16x32_bf16 v[68:71], v[20:23], a[0:3], 0
    ds_read_b128 v[44:47], v19 offset:0
    s_add_u32 m0, s21, 33792
    v_mfma_f32_16x16x32_bf16 v[72:75], v[20:23], a[4:7], 0
    buffer_load_dwordx4 v9, s[8:11], s20 offen lds
    v_mfma_f32_16x16x32_bf16 v[76:79], v[24:27], a[0:3], 0
    ds_read_b128 v[48:51], v19 offset:4096
    s_sub_u32 s39, s22, 1
    v_mfma_f32_16x16x32_bf16 v[80:83], v[24:27], a[4:7], 0
    s_waitcnt lgkmcnt(4)
    s_bitcmp1_b32 s39, 1
    s_cselect_b32 s38, s55, s54
    v_mfma_f32_16x16x32_bf16 v[68:71], v[28:31], a[8:11], v[68:71]
    ds_read_b128 v[20:23], v16 offset:256
    v_mfma_f32_16x16x32_bf16 v[72:75], v[28:31], a[12:15], v[72:75]
    s_add_u32 s38, s38, s44
    s_lshl_b32 s42, s39, 20
    v_mfma_f32_16x16x32_bf16 v[76:79], v[32:35], a[8:11], v[76:79]
    ds_read_b128 v[24:27], v16 offset:4352
    s_add_u32 s38, s38, s42
    v_mfma_f32_16x16x32_bf16 v[80:83], v[32:35], a[12:15], v[80:83]
    s_waitcnt lgkmcnt(4)
    s_lshl_b32 s39, s39, 7
    v_mfma_f32_16x16x32_bf16 v[68:71], v[36:39], a[16:19], v[68:71]
    ds_read_b128 v[28:31], v17 offset:256
    s_add_u32 m0, s21, 34816
    v_mfma_f32_16x16x32_bf16 v[72:75], v[36:39], a[20:23], v[72:75]
    buffer_load_dwordx4 v10, s[8:11], s20 offen lds
    v_mfma_f32_16x16x32_bf16 v[76:79], v[40:43], a[16:19], v[76:79]
    ds_read_b128 v[32:35], v17 offset:4352
    s_add_u32 s39, s39, 0x5900000
    v_mfma_f32_16x16x32_bf16 v[80:83], v[40:43], a[20:23], v[80:83]
    s_waitcnt lgkmcnt(4)
    s_cmp_eq_u32 s37, 0
    s_cselect_b32 s38, 0x7ff00000, s38
    s_cselect_b32 s39, 0x7ff00000, s39
    v_mfma_f32_16x16x32_bf16 v[68:71], v[44:47], a[24:27], v[68:71]
    ds_read_b128 v[36:39], v18 offset:256
    v_mfma_f32_16x16x32_bf16 v[72:75], v[44:47], a[28:31], v[72:75]
    v_cvt_pk_bf16_f32 v88, v52, v53
    v_mfma_f32_16x16x32_bf16 v[76:79], v[48:51], a[24:27], v[76:79]
    ds_read_b128 v[40:43], v18 offset:4352
    v_cvt_pk_bf16_f32 v89, v54, v55
    v_mfma_f32_16x16x32_bf16 v[80:83], v[48:51], a[28:31], v[80:83]
    s_waitcnt lgkmcnt(4)
    v_cvt_pk_bf16_f32 v90, v60, v61
    v_mfma_f32_16x16x32_bf16 v[68:71], v[20:23], a[32:35], v[68:71]
    ds_read_b128 v[44:47], v19 offset:256
    s_add_u32 m0, s21, 35840
    v_mfma_f32_16x16x32_bf16 v[72:75], v[20:23], a[36:39], v[72:75]
    buffer_load_dwordx4 v11, s[8:11], s20 offen lds
    v_mfma_f32_16x16x32_bf16 v[76:79], v[24:27], a[32:35], v[76:79]
    ds_read_b128 v[48:51], v19 offset:4352
    v_cvt_pk_bf16_f32 v91, v62, v63
    v_mfma_f32_16x16x32_bf16 v[80:83], v[24:27], a[36:39], v[80:83]
    s_waitcnt lgkmcnt(4)
    v_mfma_f32_16x16x32_bf16 v[68:71], v[28:31], a[40:43], v[68:71]
    s_waitcnt vmcnt(20)
    s_barrier
    ds_read_b128 v[20:23], v16 offset:16384
    v_mfma_f32_16x16x32_bf16 v[72:75], v[28:31], a[44:47], v[72:75]
    s_add_u32 s20, s20, 512
    buffer_store_dwordx4 v[88:91], v86, s[12:15], s38 offen offset:2048 sc1
    v_mfma_f32_16x16x32_bf16 v[76:79], v[32:35], a[40:43], v[76:79]
    ds_read_b128 v[24:27], v16 offset:20480
    v_cvt_pk_bf16_f32 v92, v56, v57
    v_mfma_f32_16x16x32_bf16 v[80:83], v[32:35], a[44:47], v[80:83]
    s_waitcnt lgkmcnt(4)
    v_cvt_pk_bf16_f32 v93, v58, v59
    v_mfma_f32_16x16x32_bf16 v[68:71], v[36:39], a[48:51], v[68:71]
    ds_read_b128 v[28:31], v17 offset:16384
    s_add_u32 m0, s21, 49152
    v_mfma_f32_16x16x32_bf16 v[72:75], v[36:39], a[52:55], v[72:75]
    buffer_load_dwordx4 v8, s[8:11], s20 offen lds
    v_mfma_f32_16x16x32_bf16 v[76:79], v[40:43], a[48:51], v[76:79]
    ds_read_b128 v[32:35], v17 offset:20480
    v_cvt_pk_bf16_f32 v94, v64, v65
    v_mfma_f32_16x16x32_bf16 v[80:83], v[40:43], a[52:55], v[80:83]
    s_waitcnt lgkmcnt(4)
    v_cvt_pk_bf16_f32 v95, v66, v67
    v_mfma_f32_16x16x32_bf16 v[68:71], v[44:47], a[56:59], v[68:71]
    ds_read_b128 v[36:39], v18 offset:16384
    v_mfma_f32_16x16x32_bf16 v[72:75], v[44:47], a[60:63], v[72:75]
    buffer_store_dwordx4 v[92:95], v86, s[12:15], s38 offen offset:2176 sc1
    v_mfma_f32_16x16x32_bf16 v[76:79], v[48:51], a[56:59], v[76:79]
    ds_read_b128 v[40:43], v18 offset:20480
    s_add_u32 s42, s38, 0x8000000
    v_mfma_f32_16x16x32_bf16 v[80:83], v[48:51], a[60:63], v[80:83]
    s_waitcnt lgkmcnt(4)
    v_mfma_f32_16x16x32_bf16 v[68:71], v[20:23], a[64:67], v[68:71]
    ds_read_b128 v[44:47], v19 offset:16384
    s_add_u32 m0, s21, 50176
    v_mfma_f32_16x16x32_bf16 v[72:75], v[20:23], a[68:71], v[72:75]
    buffer_load_dwordx4 v9, s[8:11], s20 offen lds
    v_mfma_f32_16x16x32_bf16 v[76:79], v[24:27], a[64:67], v[76:79]
    ds_read_b128 v[48:51], v19 offset:20480
    v_mfma_f32_16x16x32_bf16 v[80:83], v[24:27], a[68:71], v[80:83]
    s_waitcnt lgkmcnt(4)
    v_mfma_f32_16x16x32_bf16 v[68:71], v[28:31], a[72:75], v[68:71]
    ds_read_b128 v[20:23], v16 offset:16640
    v_mfma_f32_16x16x32_bf16 v[72:75], v[28:31], a[76:79], v[72:75]
    buffer_store_dwordx4 v[96:99], v100, s[12:15], s42 offen offset:1024 sc1
    v_mfma_f32_16x16x32_bf16 v[76:79], v[32:35], a[72:75], v[76:79]
    ds_read_b128 v[24:27], v16 offset:20736
    s_add_u32 s24, s24, 1
    v_mfma_f32_16x16x32_bf16 v[80:83], v[32:35], a[76:79], v[80:83]
    s_waitcnt lgkmcnt(4)
    v_mfma_f32_16x16x32_bf16 v[68:71], v[36:39], a[80:83], v[68:71]
    ds_read_b128 v[28:31], v17 offset:16640
    s_add_u32 m0, s21, 51200
    v_mfma_f32_16x16x32_bf16 v[72:75], v[36:39], a[84:87], v[72:75]
    buffer_load_dwordx4 v10, s[8:11], s20 offen lds
    v_mfma_f32_16x16x32_bf16 v[76:79], v[40:43], a[80:83], v[76:79]
    ds_read_b128 v[32:35], v17 offset:20736
    v_mfma_f32_16x16x32_bf16 v[80:83], v[40:43], a[84:87], v[80:83]
    s_waitcnt lgkmcnt(4)
    s_min_u32 s24, s24, 63
    v_mfma_f32_16x16x32_bf16 v[68:71], v[44:47], a[88:91], v[68:71]
    ds_read_b128 v[36:39], v18 offset:16640
    v_mfma_f32_16x16x32_bf16 v[72:75], v[44:47], a[92:95], v[72:75]
    v_mfma_f32_16x16x32_bf16 v[76:79], v[48:51], a[88:91], v[76:79]
    ds_read_b128 v[40:43], v18 offset:20736
    s_lshl_b32 s53, s24, 16
    v_mfma_f32_16x16x32_bf16 v[80:83], v[48:51], a[92:95], v[80:83]
    s_waitcnt lgkmcnt(4)
    v_mfma_f32_16x16x32_bf16 v[68:71], v[20:23], a[96:99], v[68:71]
    ds_read_b128 v[44:47], v19 offset:16640
    s_add_u32 m0, s21, 52224
    v_mfma_f32_16x16x32_bf16 v[72:75], v[20:23], a[100:103], v[72:75]
    buffer_load_dwordx4 v11, s[8:11], s20 offen lds
    v_mfma_f32_16x16x32_bf16 v[76:79], v[24:27], a[96:99], v[76:79]
    ds_read_b128 v[48:51], v19 offset:20736
    v_mfma_f32_16x16x32_bf16 v[80:83], v[24:27], a[100:103], v[80:83]
    s_waitcnt lgkmcnt(4)
    v_mfma_f32_16x16x32_bf16 v[68:71], v[28:31], a[104:107], v[68:71]
    s_waitcnt vmcnt(20)
    s_barrier
    ds_read_b128 v[20:23], v16 offset:32768
    v_mfma_f32_16x16x32_bf16 v[72:75], v[28:31], a[108:111], v[72:75]
    s_mov_b32 s20, s53
    v_mfma_f32_16x16x32_bf16 v[76:79], v[32:35], a[104:107], v[76:79]
    ds_read_b128 v[24:27], v16 offset:36864
    v_mfma_f32_16x16x32_bf16 v[80:83], v[32:35], a[108:111], v[80:83]
    s_waitcnt lgkmcnt(4)
    v_mfma_f32_16x16x32_bf16 v[68:71], v[36:39], a[112:115], v[68:71]
    ds_read_b128 v[28:31], v17 offset:32768
    s_add_u32 m0, s21, 65536
    v_mfma_f32_16x16x32_bf16 v[72:75], v[36:39], a[116:119], v[72:75]
    buffer_load_dwordx4 v8, s[8:11], s20 offen lds
    v_mfma_f32_16x16x32_bf16 v[76:79], v[40:43], a[112:115], v[76:79]
    ds_read_b128 v[32:35], v17 offset:36864
    v_mfma_f32_16x16x32_bf16 v[80:83], v[40:43], a[116:119], v[80:83]
    s_waitcnt lgkmcnt(4)
    v_mfma_f32_16x16x32_bf16 v[68:71], v[44:47], a[120:123], v[68:71]
    ds_read_b128 v[36:39], v18 offset:32768
    v_mfma_f32_16x16x32_bf16 v[72:75], v[44:47], a[124:127], v[72:75]
    v_mfma_f32_16x16x32_bf16 v[76:79], v[48:51], a[120:123], v[76:79]
    ds_read_b128 v[40:43], v18 offset:36864
    v_mfma_f32_16x16x32_bf16 v[80:83], v[48:51], a[124:127], v[80:83]
    s_waitcnt lgkmcnt(4)
    v_mfma_f32_16x16x32_bf16 v[68:71], v[20:23], a[128:131], v[68:71]
    ds_read_b128 v[44:47], v19 offset:32768
    s_add_u32 m0, s21, 66560
    v_mfma_f32_16x16x32_bf16 v[72:75], v[20:23], a[132:135], v[72:75]
    buffer_load_dwordx4 v9, s[8:11], s20 offen lds
    v_mfma_f32_16x16x32_bf16 v[76:79], v[24:27], a[128:131], v[76:79]
    ds_read_b128 v[48:51], v19 offset:36864
    v_mfma_f32_16x16x32_bf16 v[80:83], v[24:27], a[132:135], v[80:83]
    s_waitcnt lgkmcnt(4)
    v_mfma_f32_16x16x32_bf16 v[68:71], v[28:31], a[136:139], v[68:71]
    ds_read_b128 v[20:23], v16 offset:33024
    v_mfma_f32_16x16x32_bf16 v[72:75], v[28:31], a[140:143], v[72:75]
    v_mfma_f32_16x16x32_bf16 v[76:79], v[32:35], a[136:139], v[76:79]
    ds_read_b128 v[24:27], v16 offset:37120
    v_mfma_f32_16x16x32_bf16 v[80:83], v[32:35], a[140:143], v[80:83]
    s_waitcnt lgkmcnt(4)
    v_mfma_f32_16x16x32_bf16 v[68:71], v[36:39], a[144:147], v[68:71]
    ds_read_b128 v[28:31], v17 offset:33024
    s_add_u32 m0, s21, 67584
    v_mfma_f32_16x16x32_bf16 v[72:75], v[36:39], a[148:151], v[72:75]
    buffer_load_dwordx4 v10, s[8:11], s20 offen lds
    v_mfma_f32_16x16x32_bf16 v[76:79], v[40:43], a[144:147], v[76:79]
    ds_read_b128 v[32:35], v17 offset:37120
    v_mfma_f32_16x16x32_bf16 v[80:83], v[40:43], a[148:151], v[80:83]
    s_waitcnt lgkmcnt(4)
    v_mfma_f32_16x16x32_bf16 v[68:71], v[44:47], a[152:155], v[68:71]
    ds_read_b128 v[36:39], v18 offset:33024
    v_mfma_f32_16x16x32_bf16 v[72:75], v[44:47], a[156:159], v[72:75]
    v_mfma_f32_16x16x32_bf16 v[76:79], v[48:51], a[152:155], v[76:79]
    ds_read_b128 v[40:43], v18 offset:37120
    v_mfma_f32_16x16x32_bf16 v[80:83], v[48:51], a[156:159], v[80:83]
    s_waitcnt lgkmcnt(4)
    v_mfma_f32_16x16x32_bf16 v[68:71], v[20:23], a[160:163], v[68:71]
    ds_read_b128 v[44:47], v19 offset:33024
    s_add_u32 m0, s21, 68608
    v_mfma_f32_16x16x32_bf16 v[72:75], v[20:23], a[164:167], v[72:75]
    buffer_load_dwordx4 v11, s[8:11], s20 offen lds
    v_mfma_f32_16x16x32_bf16 v[76:79], v[24:27], a[160:163], v[76:79]
    ds_read_b128 v[48:51], v19 offset:37120
    v_mfma_f32_16x16x32_bf16 v[80:83], v[24:27], a[164:167], v[80:83]
    s_waitcnt lgkmcnt(4)
    v_mfma_f32_16x16x32_bf16 v[68:71], v[28:31], a[168:171], v[68:71]
    s_waitcnt vmcnt(20)
    s_barrier
    ds_read_b128 v[20:23], v16 offset:49152
    v_mfma_f32_16x16x32_bf16 v[72:75], v[28:31], a[172:175], v[72:75]
    s_add_u32 s20, s20, 512
    v_mfma_f32_16x16x32_bf16 v[76:79], v[32:35], a[168:171], v[76:79]
    ds_read_b128 v[24:27], v16 offset:53248
    v_mfma_f32_16x16x32_bf16 v[80:83], v[32:35], a[172:175], v[80:83]
    s_waitcnt lgkmcnt(4)
    v_mfma_f32_16x16x32_bf16 v[68:71], v[36:39], a[176:179], v[68:71]
    ds_read_b128 v[28:31], v17 offset:49152
    s_add_u32 m0, s21, 81920
    v_mfma_f32_16x16x32_bf16 v[72:75], v[36:39], a[180:183], v[72:75]
    buffer_load_dwordx4 v8, s[8:11], s20 offen lds
    v_mfma_f32_16x16x32_bf16 v[76:79], v[40:43], a[176:179], v[76:79]
    ds_read_b128 v[32:35], v17 offset:53248
    v_mfma_f32_16x16x32_bf16 v[80:83], v[40:43], a[180:183], v[80:83]
    s_waitcnt lgkmcnt(4)
    v_mfma_f32_16x16x32_bf16 v[68:71], v[44:47], a[184:187], v[68:71]
    ds_read_b128 v[36:39], v18 offset:49152
    v_mfma_f32_16x16x32_bf16 v[72:75], v[44:47], a[188:191], v[72:75]
    v_mfma_f32_16x16x32_bf16 v[76:79], v[48:51], a[184:187], v[76:79]
    ds_read_b128 v[40:43], v18 offset:53248
    v_mfma_f32_16x16x32_bf16 v[80:83], v[48:51], a[188:191], v[80:83]
    s_waitcnt lgkmcnt(4)
    v_mfma_f32_16x16x32_bf16 v[68:71], v[20:23], a[192:195], v[68:71]
    ds_read_b128 v[44:47], v19 offset:49152
    s_add_u32 m0, s21, 82944
    v_mfma_f32_16x16x32_bf16 v[72:75], v[20:23], a[196:199], v[72:75]
    buffer_load_dwordx4 v9, s[8:11], s20 offen lds
    v_mfma_f32_16x16x32_bf16 v[76:79], v[24:27], a[192:195], v[76:79]
    ds_read_b128 v[48:51], v19 offset:53248
    v_mfma_f32_16x16x32_bf16 v[80:83], v[24:27], a[196:199], v[80:83]
    s_waitcnt lgkmcnt(4)
    v_mfma_f32_16x16x32_bf16 v[68:71], v[28:31], a[200:203], v[68:71]
    ds_read_b128 v[20:23], v16 offset:49408
    v_mfma_f32_16x16x32_bf16 v[72:75], v[28:31], a[204:207], v[72:75]
    v_mfma_f32_16x16x32_bf16 v[76:79], v[32:35], a[200:203], v[76:79]
    ds_read_b128 v[24:27], v16 offset:53504
    v_mfma_f32_16x16x32_bf16 v[80:83], v[32:35], a[204:207], v[80:83]
    s_waitcnt lgkmcnt(4)
    v_mfma_f32_16x16x32_bf16 v[68:71], v[36:39], a[208:211], v[68:71]
    ds_read_b128 v[28:31], v17 offset:49408
    s_add_u32 m0, s21, 83968
    v_mfma_f32_16x16x32_bf16 v[72:75], v[36:39], a[212:215], v[72:75]
    buffer_load_dwordx4 v10, s[8:11], s20 offen lds
    v_mfma_f32_16x16x32_bf16 v[76:79], v[40:43], a[208:211], v[76:79]
    ds_read_b128 v[32:35], v17 offset:53504
    v_mfma_f32_16x16x32_bf16 v[80:83], v[40:43], a[212:215], v[80:83]
    s_waitcnt lgkmcnt(4)
    v_mfma_f32_16x16x32_bf16 v[68:71], v[44:47], a[216:219], v[68:71]
    ds_read_b128 v[36:39], v18 offset:49408
    v_mfma_f32_16x16x32_bf16 v[72:75], v[44:47], a[220:223], v[72:75]
    v_mfma_f32_16x16x32_bf16 v[76:79], v[48:51], a[216:219], v[76:79]
    ds_read_b128 v[40:43], v18 offset:53504
    v_mfma_f32_16x16x32_bf16 v[80:83], v[48:51], a[220:223], v[80:83]
    s_waitcnt lgkmcnt(4)
    v_mfma_f32_16x16x32_bf16 v[68:71], v[20:23], a[224:227], v[68:71]
    ds_read_b128 v[44:47], v19 offset:49408
    s_add_u32 m0, s21, 84992
    v_mfma_f32_16x16x32_bf16 v[72:75], v[20:23], a[228:231], v[72:75]
    buffer_load_dwordx4 v11, s[8:11], s20 offen lds
    v_mfma_f32_16x16x32_bf16 v[76:79], v[24:27], a[224:227], v[76:79]
    ds_read_b128 v[48:51], v19 offset:53504
    v_mfma_f32_16x16x32_bf16 v[80:83], v[24:27], a[228:231], v[80:83]
    s_waitcnt lgkmcnt(4)
    v_mfma_f32_16x16x32_bf16 v[68:71], v[28:31], a[232:235], v[68:71]
    s_waitcnt vmcnt(10)
    s_barrier
    ds_read_b128 v[20:23], v12 offset:0
    v_mfma_f32_16x16x32_bf16 v[72:75], v[28:31], a[236:239], v[72:75]
    s_add_u32 s20, s20, 512
    buffer_atomic_add v84, v85, s[12:15], s39 offen sc1
    v_mfma_f32_16x16x32_bf16 v[76:79], v[32:35], a[232:235], v[76:79]
    ds_read_b128 v[24:27], v12 offset:4096
    s_mov_b32 s37, 1
    v_mfma_f32_16x16x32_bf16 v[80:83], v[32:35], a[236:239], v[80:83]
    s_waitcnt lgkmcnt(4)
    v_mfma_f32_16x16x32_bf16 v[68:71], v[36:39], a[240:243], v[68:71]
    ds_read_b128 v[28:31], v13 offset:0
    s_add_u32 m0, s21, 98304
    v_mfma_f32_16x16x32_bf16 v[72:75], v[36:39], a[244:247], v[72:75]
    buffer_load_dwordx4 v8, s[8:11], s20 offen lds
    v_mfma_f32_16x16x32_bf16 v[76:79], v[40:43], a[240:243], v[76:79]
    ds_read_b128 v[32:35], v13 offset:4096
    v_mfma_f32_16x16x32_bf16 v[80:83], v[40:43], a[244:247], v[80:83]
    s_waitcnt lgkmcnt(4)
    v_mfma_f32_16x16x32_bf16 v[68:71], v[44:47], a[248:251], v[68:71]
    ds_read_b128 v[36:39], v14 offset:0
    v_mfma_f32_16x16x32_bf16 v[72:75], v[44:47], a[252:255], v[72:75]
    v_mfma_f32_16x16x32_bf16 v[76:79], v[48:51], a[248:251], v[76:79]
    ds_read_b128 v[40:43], v14 offset:4096
    v_mfma_f32_16x16x32_bf16 v[80:83], v[48:51], a[252:255], v[80:83]
    s_waitcnt lgkmcnt(4)
    s_add_u32 s22, s22, 1
    s_cmp_ge_u32 s22, s23
    s_cbranch_scc0 L_st_219
L_fl1_217:
    s_waitcnt lgkmcnt(0)
    s_nop 7
    s_sub_u32 s39, s22, 1
    s_bitcmp1_b32 s39, 1
    s_cselect_b32 s38, s55, s54
    s_add_u32 s38, s38, s44
    s_lshl_b32 s42, s39, 20
    s_add_u32 s38, s38, s42
    s_lshl_b32 s39, s39, 7
    s_add_u32 s39, s39, 0x5900000
    s_cmp_eq_u32 s37, 0
    s_cselect_b32 s38, 0x7ff00000, s38
    s_cselect_b32 s39, 0x7ff00000, s39
    v_cvt_pk_bf16_f32 v88, v68, v69
    v_cvt_pk_bf16_f32 v89, v70, v71
    v_cvt_pk_bf16_f32 v90, v76, v77
    v_cvt_pk_bf16_f32 v91, v78, v79
    buffer_store_dwordx4 v[88:91], v86, s[12:15], s38 offen offset:2048 sc1
    v_cvt_pk_bf16_f32 v92, v72, v73
    v_cvt_pk_bf16_f32 v93, v74, v75
    v_cvt_pk_bf16_f32 v94, v80, v81
    v_cvt_pk_bf16_f32 v95, v82, v83
    buffer_store_dwordx4 v[92:95], v86, s[12:15], s38 offen offset:2176 sc1
    s_add_u32 s42, s38, 0x8000000
    buffer_store_dwordx4 v[96:99], v100, s[12:15], s42 offen offset:1024 sc1
    s_waitcnt vmcnt(0)
    s_barrier
    buffer_atomic_add v84, v85, s[12:15], s39 offen sc1
    s_mov_b32 s37, 1
    s_branch L_ste_218
L_fl0_216:
    s_waitcnt lgkmcnt(0)
    s_nop 7
    s_sub_u32 s39, s22, 1
    s_bitcmp1_b32 s39, 1
    s_cselect_b32 s38, s55, s54
    s_add_u32 s38, s38, s44
    s_lshl_b32 s42, s39, 20
    s_add_u32 s38, s38, s42
    s_lshl_b32 s39, s39, 7
    s_add_u32 s39, s39, 0x5900000
    s_cmp_eq_u32 s37, 0
    s_cselect_b32 s38, 0x7ff00000, s38
    s_cselect_b32 s39, 0x7ff00000, s39
    v_cvt_pk_bf16_f32 v88, v52, v53
    v_cvt_pk_bf16_f32 v89, v54, v55
    v_cvt_pk_bf16_f32 v90, v60, v61
    v_cvt_pk_bf16_f32 v91, v62, v63
    buffer_store_dwordx4 v[88:91], v86, s[12:15], s38 offen offset:2048 sc1
    v_cvt_pk_bf16_f32 v92, v56, v57
    v_cvt_pk_bf16_f32 v93, v58, v59
    v_cvt_pk_bf16_f32 v94, v64, v65
    v_cvt_pk_bf16_f32 v95, v66, v67
    buffer_store_dwordx4 v[92:95], v86, s[12:15], s38 offen offset:2176 sc1
    s_add_u32 s42, s38, 0x8000000
    buffer_store_dwordx4 v[96:99], v100, s[12:15], s42 offen offset:1024 sc1
    s_waitcnt vmcnt(0)
    s_barrier
    buffer_atomic_add v84, v85, s[12:15], s39 offen sc1
    s_mov_b32 s37, 1
L_ste_218:
    s_branch L_op_205
L_q_202:
    v_and_b32 v1, 31, v0
    v_bfe_u32 v2, v0, 5, 1
    v_and_b32 v96, 63, v0
    v_lshlrev_b32 v96, 4, v96
    v_and_b32 v4, 7, v1
    v_lshlrev_b32 v4, 4, v4
    s_lshl_b32 s7, s49, 12
    s_add_u32 s7, s7, 0x21000
    v_lshl_add_u32 v97, v2, 7, v4
    v_add_u32 v97, s7, v97
    v_bfe_u32 v5, v1, 2, 1
    v_lshlrev_b32 v5, 4, v5
    v_lshrrev_b32 v6, 3, v1
    v_lshl_add_u32 v5, v6, 2, v5
    v_and_b32 v6, 3, v1
    v_add_u32 v5, v5, v6
    v_lshlrev_b32 v5, 4, v5
    v_lshl_add_u32 v98, v2, 9, v5
    v_lshl_add_u32 v99, v2, 3, v5
    v_add_u32 v99, s7, v99
    v_lshlrev_b32 v4, 4, v1
    v_lshl_add_u32 v100, v2, 10, v4
    v_and_b32 v85, 63, v0
    v_min_u32 v85, 1, v85
    v_lshlrev_b32 v85, 30, v85
    v_lshlrev_b32 v4, 2, v2
    v_sub_u32 v4, v1, v4
    v_mov_b32 v5, 0xff800000
    v_cmp_gt_i32 vcc, 0, v4
    s_nop 1
    v_cndmask_b32 v240, 0, v5, vcc
    v_cmp_gt_i32 vcc, 1, v4
    s_nop 1
    v_cndmask_b32 v241, 0, v5, vcc
    v_cmp_gt_i32 vcc, 2, v4
    s_nop 1
    v_cndmask_b32 v242, 0, v5, vcc
    v_cmp_gt_i32 vcc, 3, v4
    s_nop 1
    v_cndmask_b32 v243, 0, v5, vcc
    v_cmp_gt_i32 vcc, 8, v4
    s_nop 1
    v_cndmask_b32 v244, 0, v5, vcc
    v_cmp_gt_i32 vcc, 9, v4
    s_nop 1
    v_cndmask_b32 v245, 0, v5, vcc
    v_cmp_gt_i32 vcc, 10, v4
    s_nop 1
    v_cndmask_b32 v246, 0, v5, vcc
    v_cmp_gt_i32 vcc, 11, v4
    s_nop 1
    v_cndmask_b32 v247, 0, v5, vcc
    v_cmp_gt_i32 vcc, 16, v4
    s_nop 1
    v_cndmask_b32 v248, 0, v5, vcc
    v_cmp_gt_i32 vcc, 17, v4
    s_nop 1
    v_cndmask_b32 v249, 0, v5, vcc
    v_cmp_gt_i32 vcc, 18, v4
    s_nop 1
    v_cndmask_b32 v250, 0, v5, vcc
    v_cmp_gt_i32 vcc, 19, v4
    s_nop 1
    v_cndmask_b32 v251, 0, v5, vcc
    v_cmp_gt_i32 vcc, 24, v4
    s_nop 1
    v_cndmask_b32 v252, 0, v5, vcc
    v_cmp_gt_i32 vcc, 25, v4
    s_nop 1
    v_cndmask_b32 v253, 0, v5, vcc
    v_cmp_gt_i32 vcc, 26, v4
    s_nop 1
    v_cndmask_b32 v254, 0, v5, vcc
    v_cmp_gt_i32 vcc, 27, v4
    s_nop 1
    v_cndmask_b32 v255, 0, v5, vcc
    s_mov_b32 s47, 0
    v_mov_b32 v102, 0x20000
    v_lshl_add_u32 v101, v0, 2, v102
    v_mov_b32 v103, 4
    v_mov_b32 v87, 0
    s_mov_b32 s48, 0x40000000
    s_mov_b32 s50, 0x40000000
    s_mov_b32 s51, 0x40000000
    s_mov_b32 s45, 0
    s_barrier
    s_add_u32 m0, s21, 0
    s_nop 0
    buffer_load_dwordx4 v8, s[8:11], s20 offen lds
    s_add_u32 m0, s21, 1024
    s_nop 0
    buffer_load_dwordx4 v9, s[8:11], s20 offen lds
    s_add_u32 m0, s21, 2048
    s_nop 0
    buffer_load_dwordx4 v10, s[8:11], s20 offen lds
    s_add_u32 m0, s21, 3072
    s_nop 0
    buffer_load_dwordx4 v11, s[8:11], s20 offen lds
    s_add_u32 s20, s20, 512
    s_add_u32 m0, s21, 16384
    s_nop 0
    buffer_load_dwordx4 v8, s[8:11], s20 offen lds
    s_add_u32 m0, s21, 17408
    s_nop 0
    buffer_load_dwordx4 v9, s[8:11], s20 offen lds
    s_add_u32 m0, s21, 18432
    s_nop 0
    buffer_load_dwordx4 v10, s[8:11], s20 offen lds
    s_add_u32 m0, s21, 19456
    s_nop 0
    buffer_load_dwordx4 v11, s[8:11], s20 offen lds
    s_add_u32 s20, s20, 512
    s_add_u32 m0, s21, 32768
    s_nop 0
    buffer_load_dwordx4 v8, s[8:11], s20 offen lds
    s_add_u32 m0, s21, 33792
    s_nop 0
    buffer_load_dwordx4 v9, s[8:11], s20 offen lds
    s_add_u32 m0, s21, 34816
    s_nop 0
    buffer_load_dwordx4 v10, s[8:11], s20 offen lds
    s_add_u32 m0, s21, 35840
    s_nop 0
    buffer_load_dwordx4 v11, s[8:11], s20 offen lds
    s_add_u32 s20, s20, 512
    s_add_u32 m0, s21, 49152
    s_nop 0
    buffer_load_dwordx4 v8, s[8:11], s20 offen lds
    s_add_u32 m0, s21, 50176
    s_nop 0
    buffer_load_dwordx4 v9, s[8:11], s20 offen lds
    s_add_u32 m0, s21, 51200
    s_nop 0
    buffer_load_dwordx4 v10, s[8:11], s20 offen lds
    s_add_u32 m0, s21, 52224
    s_nop 0
    buffer_load_dwordx4 v11, s[8:11], s20 offen lds
    s_add_u32 s24, s24, 1
    s_min_u32 s24, s24, 63
    s_lshl_b32 s53, s24, 16
    s_mov_b32 s20, s53
    s_add_u32 m0, s21, 65536
    s_nop 0
    buffer_load_dwordx4 v8, s[8:11], s20 offen lds
    s_add_u32 m0, s21, 66560
    s_nop 0
    buffer_load_dwordx4 v9, s[8:11], s20 offen lds
    s_add_u32 m0, s21, 67584
    s_nop 0
    buffer_load_dwordx4 v10, s[8:11], s20 offen lds
    s_add_u32 m0, s21, 68608
    s_nop 0
    buffer_load_dwordx4 v11, s[8:11], s20 offen lds
    s_add_u32 s20, s20, 512
    s_add_u32 m0, s21, 81920
    s_nop 0
    buffer_load_dwordx4 v8, s[8:11], s20 offen lds
    s_add_u32 m0, s21, 82944
    s_nop 0
    buffer_load_dwordx4 v9, s[8:11], s20 offen lds
    s_add_u32 m0, s21, 83968
    s_nop 0
    buffer_load_dwordx4 v10, s[8:11], s20 offen lds
    s_add_u32 m0, s21, 84992
    s_nop 0
    buffer_load_dwordx4 v11, s[8:11], s20 offen lds
    s_add_u32 s20, s20, 512
    s_add_u32 m0, s21, 98304
    s_nop 0
    buffer_load_dwordx4 v8, s[8:11], s20 offen lds
    s_waitcnt vmcnt(21)
    s_barrier
    ds_read_b128 v[20:23], v12 offset:0
    ds_read_b128 v[24:27], v12 offset:4096
    ds_read_b128 v[28:31], v13 offset:0
    ds_read_b128 v[32:35], v13 offset:4096
    ds_read_b128 v[36:39], v14 offset:0
    ds_read_b128 v[40:43], v14 offset:4096
    s_waitcnt lgkmcnt(4)
L_st_225:
    v_mfma_f32_16x16x32_bf16 v[52:55], a[0:3], v[20:23], 0
    ds_read_b128 v[44:47], v15 offset:0
    s_add_u32 m0, s21, 99328
    s_sub_u32 s39, s22, 1
    v_mfma_f32_16x16x32_bf16 v[56:59], a[4:7], v[20:23], 0
    buffer_load_dwordx4 v9, s[8:11], s20 offen lds
    v_mfma_f32_16x16x32_bf16 v[60:63], a[0:3], v[24:27], 0
    ds_read_b128 v[48:51], v15 offset:4096
    s_bitcmp1_b32 s39, 1
    s_cselect_b32 s38, s54, s55
    v_mfma_f32_16x16x32_bf16 v[64:67], a[4:7], v[24:27], 0
    s_waitcnt lgkmcnt(4)
    v_mfma_f32_16x16x32_bf16 v[52:55], a[8:11], v[28:31], v[52:55]
    ds_read_b128 v[20:23], v12 offset:256
    s_add_u32 s38, s38, s44
    s_waitcnt vmcnt(10)
    v_mfma_f32_16x16x32_bf16 v[56:59], a[12:15], v[28:31], v[56:59]
    s_lshl_b32 s42, s39, 20
    s_add_u32 s38, s38, s42
    ds_write_b32 v101, v87
    v_mfma_f32_16x16x32_bf16 v[60:63], a[8:11], v[32:35], v[60:63]
    ds_read_b128 v[24:27], v12 offset:4352
    s_cmp_eq_u32 s37, 0
    s_cselect_b32 s38, 0x7ff00000, s38
    v_mfma_f32_16x16x32_bf16 v[64:67], a[12:15], v[32:35], v[64:67]
    s_waitcnt lgkmcnt(4)
    v_mfma_f32_16x16x32_bf16 v[52:55], a[16:19], v[36:39], v[52:55]
    ds_read_b128 v[28:31], v13 offset:256
    s_add_u32 m0, s21, 100352
    v_mfma_f32_16x16x32_bf16 v[56:59], a[20:23], v[36:39], v[56:59]
    buffer_load_dwordx4 v10, s[8:11], s20 offen lds
    s_mov_b32 s37, 1
    v_mfma_f32_16x16x32_bf16 v[60:63], a[16:19], v[40:43], v[60:63]
    ds_read_b128 v[32:35], v13 offset:4352
    v_cvt_pk_bf16_f32 v88, v68, v69
    v_mfma_f32_16x16x32_bf16 v[64:67], a[20:23], v[40:43], v[64:67]
    s_waitcnt lgkmcnt(4)
    v_cvt_pk_bf16_f32 v89, v70, v71
    v_mfma_f32_16x16x32_bf16 v[52:55], a[24:27], v[44:47], v[52:55]
    ds_read_b128 v[36:39], v14 offset:256
    v_cvt_pk_bf16_f32 v90, v72, v73
    v_mfma_f32_16x16x32_bf16 v[56:59], a[28:31], v[44:47], v[56:59]
    v_cvt_pk_bf16_f32 v91, v74, v75
    v_mfma_f32_16x16x32_bf16 v[60:63], a[24:27], v[48:51], v[60:63]
    ds_read_b128 v[40:43], v14 offset:4352
    buffer_store_dwordx4 v[88:91], v86, s[12:15], s38 offen offset:0
    v_mfma_f32_16x16x32_bf16 v[64:67], a[28:31], v[48:51], v[64:67]
    s_waitcnt lgkmcnt(4)
    v_cvt_pk_bf16_f32 v92, v76, v77
    v_cvt_pk_bf16_f32 v93, v78, v79
    v_mfma_f32_16x16x32_bf16 v[52:55], a[32:35], v[20:23], v[52:55]
    ds_read_b128 v[44:47], v15 offset:256
    s_add_u32 m0, s21, 101376
    v_mfma_f32_16x16x32_bf16 v[56:59], a[36:39], v[20:23], v[56:59]
    buffer_load_dwordx4 v11, s[8:11], s20 offen lds
    v_cvt_pk_bf16_f32 v94, v80, v81
    v_mfma_f32_16x16x32_bf16 v[60:63], a[32:35], v[24:27], v[60:63]
    ds_read_b128 v[48:51], v15 offset:4352
    v_cvt_pk_bf16_f32 v95, v82, v83
    v_mfma_f32_16x16x32_bf16 v[64:67], a[36:39], v[24:27], v[64:67]
    s_waitcnt lgkmcnt(4)
    buffer_store_dwordx4 v[92:95], v86, s[12:15], s38 offen offset:128
    v_mfma_f32_16x16x32_bf16 v[52:55], a[40:43], v[28:31], v[52:55]
    s_waitcnt vmcnt(20)
    s_barrier
    ds_read_b128 v[20:23], v12 offset:16384
    v_mfma_f32_16x16x32_bf16 v[56:59], a[44:47], v[28:31], v[56:59]
    s_add_u32 s20, s20, 512
    v_mfma_f32_16x16x32_bf16 v[60:63], a[40:43], v[32:35], v[60:63]
    ds_read_b128 v[24:27], v12 offset:20480
    ds_read_b32 v87, v102
    v_mfma_f32_16x16x32_bf16 v[64:67], a[44:47], v[32:35], v[64:67]
    s_waitcnt lgkmcnt(4)
    v_mfma_f32_16x16x32_bf16 v[52:55], a[48:51], v[36:39], v[52:55]
    ds_read_b128 v[28:31], v13 offset:16384
    s_add_u32 m0, s21, 114688
    v_mfma_f32_16x16x32_bf16 v[56:59], a[52:55], v[36:39], v[56:59]
    buffer_load_dwordx4 v8, s[8:11], s20 offen lds
    v_mfma_f32_16x16x32_bf16 v[60:63], a[48:51], v[40:43], v[60:63]
    ds_read_b128 v[32:35], v13 offset:20480
    v_mfma_f32_16x16x32_bf16 v[64:67], a[52:55], v[40:43], v[64:67]
    s_waitcnt lgkmcnt(4)
    v_mfma_f32_16x16x32_bf16 v[52:55], a[56:59], v[44:47], v[52:55]
    ds_read_b128 v[36:39], v14 offset:16384
    v_mfma_f32_16x16x32_bf16 v[56:59], a[60:63], v[44:47], v[56:59]
    v_mfma_f32_16x16x32_bf16 v[60:63], a[56:59], v[48:51], v[60:63]
    ds_read_b128 v[40:43], v14 offset:20480
    v_mfma_f32_16x16x32_bf16 v[64:67], a[60:63], v[48:51], v[64:67]
    s_waitcnt lgkmcnt(4)
    v_mfma_f32_16x16x32_bf16 v[52:55], a[64:67], v[20:23], v[52:55]
    ds_read_b128 v[44:47], v15 offset:16384
    s_add_u32 m0, s21, 115712
    v_mfma_f32_16x16x32_bf16 v[56:59], a[68:71], v[20:23], v[56:59]
    buffer_load_dwordx4 v9, s[8:11], s20 offen lds
    v_mfma_f32_16x16x32_bf16 v[60:63], a[64:67], v[24:27], v[60:63]
    ds_read_b128 v[48:51], v15 offset:20480
    s_waitcnt vmcnt(12)
    s_branch L_att_220
L_attr_221:
    v_mfma_f32_16x16x32_bf16 v[64:67], a[68:71], v[24:27], v[64:67]
    s_waitcnt lgkmcnt(4)
    s_add_u32 s43, s50, 0
    buffer_load_dwordx4 v[136:139], v96, s[12:15], s43 offen offset:0
    v_mfma_f32_16x16x32_bf16 v[52:55], a[72:75], v[28:31], v[52:55]
    ds_read_b128 v[20:23], v12 offset:16640
    v_mfma_f32_16x16x32_bf16 v[56:59], a[76:79], v[28:31], v[56:59]
    v_mfma_f32_16x16x32_bf16 v[60:63], a[72:75], v[32:35], v[60:63]
    ds_read_b128 v[24:27], v12 offset:20736
    s_add_u32 s24, s24, 1
    v_mfma_f32_16x16x32_bf16 v[64:67], a[76:79], v[32:35], v[64:67]
    s_waitcnt lgkmcnt(4)
    v_mfma_f32_16x16x32_bf16 v[52:55], a[80:83], v[36:39], v[52:55]
    ds_read_b128 v[28:31], v13 offset:16640
    s_add_u32 m0, s21, 116736
    v_mfma_f32_16x16x32_bf16 v[56:59], a[84:87], v[36:39], v[56:59]
    buffer_load_dwordx4 v10, s[8:11], s20 offen lds
    v_mfma_f32_16x16x32_bf16 v[60:63], a[80:83], v[40:43], v[60:63]
    ds_read_b128 v[32:35], v13 offset:20736
    v_mfma_f32_16x16x32_bf16 v[64:67], a[84:87], v[40:43], v[64:67]
    s_waitcnt lgkmcnt(4)
    s_add_u32 s43, s50, 0
    buffer_load_dwordx4 v[140:143], v96, s[12:15], s43 offen offset:1024
    v_mfma_f32_16x16x32_bf16 v[52:55], a[88:91], v[44:47], v[52:55]
    ds_read_b128 v[36:39], v14 offset:16640
    s_min_u32 s24, s24, 63
    v_mfma_f32_16x16x32_bf16 v[56:59], a[92:95], v[44:47], v[56:59]
    v_mfma_f32_16x16x32_bf16 v[60:63], a[88:91], v[48:51], v[60:63]
    ds_read_b128 v[40:43], v14 offset:20736
    s_add_u32 s43, s48, 0
    buffer_load_dwordx4 v[104:107], v96, s[12:15], s43 offen offset:0
    v_mfma_f32_16x16x32_bf16 v[64:67], a[92:95], v[48:51], v[64:67]
    s_waitcnt lgkmcnt(4)
    s_lshl_b32 s53, s24, 16
    v_mfma_f32_16x16x32_bf16 v[52:55], a[96:99], v[20:23], v[52:55]
    ds_read_b128 v[44:47], v15 offset:16640
    s_add_u32 m0, s21, 117760
    v_mfma_f32_16x16x32_bf16 v[56:59], a[100:103], v[20:23], v[56:59]
    buffer_load_dwordx4 v11, s[8:11], s20 offen lds
    v_mfma_f32_16x16x32_bf16 v[60:63], a[96:99], v[24:27], v[60:63]
    ds_read_b128 v[48:51], v15 offset:20736
    v_mfma_f32_16x16x32_bf16 v[64:67], a[100:103], v[24:27], v[64:67]
    s_waitcnt lgkmcnt(4)
    v_mfma_f32_16x16x32_bf16 v[52:55], a[104:107], v[28:31], v[52:55]
    s_waitcnt vmcnt(20)
    s_barrier
    ds_read_b128 v[20:23], v12 offset:32768
    v_mfma_f32_16x16x32_bf16 v[56:59], a[108:111], v[28:31], v[56:59]
    s_mov_b32 s20, s53
    v_mfma_f32_16x16x32_bf16 v[60:63], a[104:107], v[32:35], v[60:63]
    ds_read_b128 v[24:27], v12 offset:36864
    s_add_u32 s43, s48, 0
    buffer_load_dwordx4 v[108:111], v96, s[12:15], s43 offen offset:1024
    v_mfma_f32_16x16x32_bf16 v[64:67], a[108:111], v[32:35], v[64:67]
    s_waitcnt lgkmcnt(4)
    v_mfma_f32_16x16x32_bf16 v[52:55], a[112:115], v[36:39], v[52:55]
    ds_read_b128 v[28:31], v13 offset:32768
    s_add_u32 m0, s21, 0
    v_mfma_f32_16x16x32_bf16 v[56:59], a[116:119], v[36:39], v[56:59]
    buffer_load_dwordx4 v8, s[8:11], s20 offen lds
    v_mfma_f32_16x16x32_bf16 v[60:63], a[112:115], v[40:43], v[60:63]
    ds_read_b128 v[32:35], v13 offset:36864
    v_mfma_f32_16x16x32_bf16 v[64:67], a[116:119], v[40:43], v[64:67]
    s_waitcnt lgkmcnt(4)
    s_add_u32 s43, s48, 0
    buffer_load_dwordx4 v[168:171], v98, s[12:15], s43 offen offset:2048
    v_mfma_f32_16x16x32_bf16 v[52:55], a[120:123], v[44:47], v[52:55]
    ds_read_b128 v[36:39], v14 offset:32768
    v_mfma_f32_16x16x32_bf16 v[56:59], a[124:127], v[44:47], v[56:59]
    v_mfma_f32_16x16x32_bf16 v[60:63], a[120:123], v[48:51], v[60:63]
    ds_read_b128 v[40:43], v14 offset:36864
    v_mfma_f32_16x16x32_bf16 v[64:67], a[124:127], v[48:51], v[64:67]
    s_waitcnt lgkmcnt(4)
    v_mfma_f32_16x16x32_bf16 v[52:55], a[128:131], v[20:23], v[52:55]
    ds_read_b128 v[44:47], v15 offset:32768
    s_add_u32 m0, s21, 1024
    v_mfma_f32_16x16x32_bf16 v[56:59], a[132:135], v[20:23], v[56:59]
    buffer_load_dwordx4 v9, s[8:11], s20 offen lds
    v_mfma_f32_16x16x32_bf16 v[60:63], a[128:131], v[24:27], v[60:63]
    ds_read_b128 v[48:51], v15 offset:36864
    v_mfma_f32_16x16x32_bf16 v[64:67], a[132:135], v[24:27], v[64:67]
    s_waitcnt lgkmcnt(4)
    s_add_u32 s43, s48, 0
    buffer_load_dwordx4 v[172:175], v98, s[12:15], s43 offen offset:3072
    v_mfma_f32_16x16x32_bf16 v[52:55], a[136:139], v[28:31], v[52:55]
    ds_read_b128 v[20:23], v12 offset:33024
    v_mfma_f32_16x16x32_bf16 v[56:59], a[140:143], v[28:31], v[56:59]
    v_mfma_f32_16x16x32_bf16 v[60:63], a[136:139], v[32:35], v[60:63]
    ds_read_b128 v[24:27], v12 offset:37120
    s_add_u32 s43, s50, 4096
    buffer_load_dwordx4 v[144:147], v96, s[12:15], s43 offen offset:0
    v_mfma_f32_16x16x32_bf16 v[64:67], a[140:143], v[32:35], v[64:67]
    s_waitcnt lgkmcnt(4)
    v_mfma_f32_16x16x32_bf16 v[52:55], a[144:147], v[36:39], v[52:55]
    ds_read_b128 v[28:31], v13 offset:33024
    s_add_u32 m0, s21, 2048
    v_mfma_f32_16x16x32_bf16 v[56:59], a[148:151], v[36:39], v[56:59]
    buffer_load_dwordx4 v10, s[8:11], s20 offen lds
    v_mfma_f32_16x16x32_bf16 v[60:63], a[144:147], v[40:43], v[60:63]
    ds_read_b128 v[32:35], v13 offset:37120
    v_mfma_f32_16x16x32_bf16 v[64:67], a[148:151], v[40:43], v[64:67]
    s_waitcnt lgkmcnt(4)
    v_mfma_f32_16x16x32_bf16 v[52:55], a[152:155], v[44:47], v[52:55]
    ds_read_b128 v[36:39], v14 offset:33024
    v_mfma_f32_16x16x32_bf16 v[56:59], a[156:159], v[44:47], v[56:59]
    v_mfma_f32_16x16x32_bf16 v[60:63], a[152:155], v[48:51], v[60:63]
    ds_read_b128 v[40:43], v14 offset:37120
    s_add_u32 s43, s50, 4096
    buffer_load_dwordx4 v[148:151], v96, s[12:15], s43 offen offset:1024
    v_mfma_f32_16x16x32_bf16 v[64:67], a[156:159], v[48:51], v[64:67]
    s_waitcnt lgkmcnt(4)
    v_mfma_f32_16x16x32_bf16 v[52:55], a[160:163], v[20:23], v[52:55]
    ds_read_b128 v[44:47], v15 offset:33024
    s_add_u32 m0, s21, 3072
    v_mfma_f32_16x16x32_bf16 v[56:59], a[164:167], v[20:23], v[56:59]
    buffer_load_dwordx4 v11, s[8:11], s20 offen lds
    v_mfma_f32_16x16x32_bf16 v[60:63], a[160:163], v[24:27], v[60:63]
    ds_read_b128 v[48:51], v15 offset:37120
    v_mfma_f32_16x16x32_bf16 v[64:67], a[164:167], v[24:27], v[64:67]
    s_waitcnt lgkmcnt(4)
    s_add_u32 s43, s48, 4096
    buffer_load_dwordx4 v[112:115], v96, s[12:15], s43 offen offset:0
    v_mfma_f32_16x16x32_bf16 v[52:55], a[168:171], v[28:31], v[52:55]
    s_waitcnt vmcnt(20)
    s_barrier
    ds_read_b128 v[20:23], v12 offset:49152
    v_mfma_f32_16x16x32_bf16 v[56:59], a[172:175], v[28:31], v[56:59]
    s_add_u32 s20, s20, 512
    v_mfma_f32_16x16x32_bf16 v[60:63], a[168:171], v[32:35], v[60:63]
    ds_read_b128 v[24:27], v12 offset:53248
    v_mfma_f32_16x16x32_bf16 v[64:67], a[172:175], v[32:35], v[64:67]
    s_waitcnt lgkmcnt(4)
    v_mfma_f32_16x16x32_bf16 v[52:55], a[176:179], v[36:39], v[52:55]
    ds_read_b128 v[28:31], v13 offset:49152
    s_add_u32 m0, s21, 16384
    v_mfma_f32_16x16x32_bf16 v[56:59], a[180:183], v[36:39], v[56:59]
    buffer_load_dwordx4 v8, s[8:11], s20 offen lds
    v_mfma_f32_16x16x32_bf16 v[60:63], a[176:179], v[40:43], v[60:63]
    ds_read_b128 v[32:35], v13 offset:53248
    v_mfma_f32_16x16x32_bf16 v[64:67], a[180:183], v[40:43], v[64:67]
    s_waitcnt lgkmcnt(4)
    s_add_u32 s43, s48, 4096
    buffer_load_dwordx4 v[116:119], v96, s[12:15], s43 offen offset:1024
    v_mfma_f32_16x16x32_bf16 v[52:55], a[184:187], v[44:47], v[52:55]
    ds_read_b128 v[36:39], v14 offset:49152
    v_mfma_f32_16x16x32_bf16 v[56:59], a[188:191], v[44:47], v[56:59]
    v_mfma_f32_16x16x32_bf16 v[60:63], a[184:187], v[48:51], v[60:63]
    ds_read_b128 v[40:43], v14 offset:53248
    s_add_u32 s43, s48, 4096
    buffer_load_dwordx4 v[176:179], v98, s[12:15], s43 offen offset:2048
    v_mfma_f32_16x16x32_bf16 v[64:67], a[188:191], v[48:51], v[64:67]
    s_waitcnt lgkmcnt(4)
    v_mfma_f32_16x16x32_bf16 v[52:55], a[192:195], v[20:23], v[52:55]
    ds_read_b128 v[44:47], v15 offset:49152
    s_add_u32 m0, s21, 17408
    v_mfma_f32_16x16x32_bf16 v[56:59], a[196:199], v[20:23], v[56:59]
    buffer_load_dwordx4 v9, s[8:11], s20 offen lds
    v_mfma_f32_16x16x32_bf16 v[60:63], a[192:195], v[24:27], v[60:63]
    ds_read_b128 v[48:51], v15 offset:53248
    v_mfma_f32_16x16x32_bf16 v[64:67], a[196:199], v[24:27], v[64:67]
    s_waitcnt lgkmcnt(4)
    v_mfma_f32_16x16x32_bf16 v[52:55], a[200:203], v[28:31], v[52:55]
    ds_read_b128 v[20:23], v12 offset:49408
    v_mfma_f32_16x16x32_bf16 v[56:59], a[204:207], v[28:31], v[56:59]
    v_mfma_f32_16x16x32_bf16 v[60:63], a[200:203], v[32:35], v[60:63]
    ds_read_b128 v[24:27], v12 offset:53504
    s_add_u32 s43, s48, 4096
    buffer_load_dwordx4 v[180:183], v98, s[12:15], s43 offen offset:3072
    v_mfma_f32_16x16x32_bf16 v[64:67], a[204:207], v[32:35], v[64:67]
    s_waitcnt lgkmcnt(4)
    v_mfma_f32_16x16x32_bf16 v[52:55], a[208:211], v[36:39], v[52:55]
    ds_read_b128 v[28:31], v13 offset:49408
    s_add_u32 m0, s21, 18432
    v_mfma_f32_16x16x32_bf16 v[56:59], a[212:215], v[36:39], v[56:59]
    buffer_load_dwordx4 v10, s[8:11], s20 offen lds
    v_mfma_f32_16x16x32_bf16 v[60:63], a[208:211], v[40:43], v[60:63]
    ds_read_b128 v[32:35], v13 offset:53504
    v_mfma_f32_16x16x32_bf16 v[64:67], a[212:215], v[40:43], v[64:67]
    s_waitcnt lgkmcnt(4)
    s_add_u32 s43, s50, 16384
    buffer_load_dwordx4 v[152:155], v96, s[12:15], s43 offen offset:0
    v_mfma_f32_16x16x32_bf16 v[52:55], a[216:219], v[44:47], v[52:55]
    ds_read_b128 v[36:39], v14 offset:49408
    v_mfma_f32_16x16x32_bf16 v[56:59], a[220:223], v[44:47], v[56:59]
    v_mfma_f32_16x16x32_bf16 v[60:63], a[216:219], v[48:51], v[60:63]
    ds_read_b128 v[40:43], v14 offset:53504
    v_mfma_f32_16x16x32_bf16 v[64:67], a[220:223], v[48:51], v[64:67]
    s_waitcnt lgkmcnt(4)
    v_mfma_f32_16x16x32_bf16 v[52:55], a[224:227], v[20:23], v[52:55]
    ds_read_b128 v[44:47], v15 offset:49408
    s_add_u32 m0, s21, 19456
    v_mfma_f32_16x16x32_bf16 v[56:59], a[228:231], v[20:23], v[56:59]
    buffer_load_dwordx4 v11, s[8:11], s20 offen lds
    v_mfma_f32_16x16x32_bf16 v[60:63], a[224:227], v[24:27], v[60:63]
    ds_read_b128 v[48:51], v15 offset:53504
    v_mfma_f32_16x16x32_bf16 v[64:67], a[228:231], v[24:27], v[64:67]
    s_waitcnt lgkmcnt(4)
    s_add_u32 s43, s50, 16384
    buffer_load_dwordx4 v[156:159], v96, s[12:15], s43 offen offset:1024
    v_mfma_f32_16x16x32_bf16 v[52:55], a[232:235], v[28:31], v[52:55]
    s_waitcnt vmcnt(20)
    s_barrier
    ds_read_b128 v[20:23], v16 offset:0
    v_mfma_f32_16x16x32_bf16 v[56:59], a[236:239], v[28:31], v[56:59]
    s_add_u32 s20, s20, 512
    v_mfma_f32_16x16x32_bf16 v[60:63], a[232:235], v[32:35], v[60:63]
    ds_read_b128 v[24:27], v16 offset:4096
    s_add_u32 s43, s48, 16384
    buffer_load_dwordx4 v[120:123], v96, s[12:15], s43 offen offset:0
    v_mfma_f32_16x16x32_bf16 v[64:67], a[236:239], v[32:35], v[64:67]
    s_waitcnt lgkmcnt(4)
    v_mfma_f32_16x16x32_bf16 v[52:55], a[240:243], v[36:39], v[52:55]
    ds_read_b128 v[28:31], v17 offset:0
    s_add_u32 m0, s21, 32768
    v_mfma_f32_16x16x32_bf16 v[56:59], a[244:247], v[36:39], v[56:59]
    buffer_load_dwordx4 v8, s[8:11], s20 offen lds
    v_mfma_f32_16x16x32_bf16 v[60:63], a[240:243], v[40:43], v[60:63]
    ds_read_b128 v[32:35], v17 offset:4096
    v_mfma_f32_16x16x32_bf16 v[64:67], a[244:247], v[40:43], v[64:67]
    s_waitcnt lgkmcnt(4)
    v_mfma_f32_16x16x32_bf16 v[52:55], a[248:251], v[44:47], v[52:55]
    ds_read_b128 v[36:39], v18 offset:0
    v_mfma_f32_16x16x32_bf16 v[56:59], a[252:255], v[44:47], v[56:59]
    v_mfma_f32_16x16x32_bf16 v[60:63], a[248:251], v[48:51], v[60:63]
    ds_read_b128 v[40:43], v18 offset:4096
    v_mfma_f32_16x16x32_bf16 v[64:67], a[252:255], v[48:51], v[64:67]
    s_waitcnt lgkmcnt(4)
    s_add_u32 s22, s22, 1
    s_cmp_ge_u32 s22, s23
    s_cbranch_scc1 L_fl0_222
    v_mfma_f32_16x16x32_bf16 v[68:71], a[0:3], v[20:23], 0
    ds_read_b128 v[44:47], v19 offset:0
    s_add_u32 m0, s21, 33792
    s_sub_u32 s39, s22, 1
    v_mfma_f32_16x16x32_bf16 v[72:75], a[4:7], v[20:23], 0
    buffer_load_dwordx4 v9, s[8:11], s20 offen lds
    s_bitcmp1_b32 s39, 1
    s_cselect_b32 s38, s54, s55
    v_mfma_f32_16x16x32_bf16 v[76:79], a[0:3], v[24:27], 0
    ds_read_b128 v[48:51], v19 offset:4096
    v_mfma_f32_16x16x32_bf16 v[80:83], a[4:7], v[24:27], 0
    s_waitcnt lgkmcnt(4)
    s_add_u32 s43, s48, 16384
    buffer_load_dwordx4 v[124:127], v96, s[12:15], s43 offen offset:1024
    v_mfma_f32_16x16x32_bf16 v[68:71], a[8:11], v[28:31], v[68:71]
    ds_read_b128 v[20:23], v16 offset:256
    s_add_u32 s38, s38, s44
    v_mfma_f32_16x16x32_bf16 v[72:75], a[12:15], v[28:31], v[72:75]
    s_lshl_b32 s42, s39, 20
    s_add_u32 s38, s38, s42
    v_mfma_f32_16x16x32_bf16 v[76:79], a[8:11], v[32:35], v[76:79]
    ds_read_b128 v[24:27], v16 offset:4352
    s_add_u32 s43, s48, 16384
    buffer_load_dwordx4 v[184:187], v98, s[12:15], s43 offen offset:2048
    v_mfma_f32_16x16x32_bf16 v[80:83], a[12:15], v[32:35], v[80:83]
    s_waitcnt lgkmcnt(4)
    s_cmp_eq_u32 s37, 0
    s_cselect_b32 s38, 0x7ff00000, s38
    v_mfma_f32_16x16x32_bf16 v[68:71], a[16:19], v[36:39], v[68:71]
    ds_read_b128 v[28:31], v17 offset:256
    s_add_u32 m0, s21, 34816
    v_mfma_f32_16x16x32_bf16 v[72:75], a[20:23], v[36:39], v[72:75]
    buffer_load_dwordx4 v10, s[8:11], s20 offen lds
    s_mov_b32 s37, 1
    v_mfma_f32_16x16x32_bf16 v[76:79], a[16:19], v[40:43], v[76:79]
    ds_read_b128 v[32:35], v17 offset:4352
    v_cvt_pk_bf16_f32 v88, v52, v53
    v_mfma_f32_16x16x32_bf16 v[80:83], a[20:23], v[40:43], v[80:83]
    s_waitcnt lgkmcnt(4)
    s_add_u32 s43, s48, 16384
    buffer_load_dwordx4 v[188:191], v98, s[12:15], s43 offen offset:3072
    v_mfma_f32_16x16x32_bf16 v[68:71], a[24:27], v[44:47], v[68:71]
    ds_read_b128 v[36:39], v18 offset:256
    v_cvt_pk_bf16_f32 v89, v54, v55
    v_cvt_pk_bf16_f32 v90, v56, v57
    v_mfma_f32_16x16x32_bf16 v[72:75], a[28:31], v[44:47], v[72:75]
    v_cvt_pk_bf16_f32 v91, v58, v59
    v_mfma_f32_16x16x32_bf16 v[76:79], a[24:27], v[48:51], v[76:79]
    ds_read_b128 v[40:43], v18 offset:4352
    buffer_store_dwordx4 v[88:91], v86, s[12:15], s38 offen offset:0
    v_mfma_f32_16x16x32_bf16 v[80:83], a[28:31], v[48:51], v[80:83]
    s_waitcnt lgkmcnt(4)
    v_cvt_pk_bf16_f32 v92, v60, v61
    v_cvt_pk_bf16_f32 v93, v62, v63
    v_mfma_f32_16x16x32_bf16 v[68:71], a[32:35], v[20:23], v[68:71]
    ds_read_b128 v[44:47], v19 offset:256
    s_add_u32 m0, s21, 35840
    v_mfma_f32_16x16x32_bf16 v[72:75], a[36:39], v[20:23], v[72:75]
    buffer_load_dwordx4 v11, s[8:11], s20 offen lds
    v_cvt_pk_bf16_f32 v94, v64, v65
    v_mfma_f32_16x16x32_bf16 v[76:79], a[32:35], v[24:27], v[76:79]
    ds_read_b128 v[48:51], v19 offset:4352
    v_cvt_pk_bf16_f32 v95, v66, v67
    v_mfma_f32_16x16x32_bf16 v[80:83], a[36:39], v[24:27], v[80:83]
    s_waitcnt lgkmcnt(4)
    buffer_store_dwordx4 v[92:95], v86, s[12:15], s38 offen offset:128
    v_mfma_f32_16x16x32_bf16 v[68:71], a[40:43], v[28:31], v[68:71]
    s_waitcnt vmcnt(20)
    s_barrier
    ds_read_b128 v[20:23], v16 offset:16384
    v_mfma_f32_16x16x32_bf16 v[72:75], a[44:47], v[28:31], v[72:75]
    s_add_u32 s20, s20, 512
    v_mfma_f32_16x16x32_bf16 v[76:79], a[40:43], v[32:35], v[76:79]
    ds_read_b128 v[24:27], v16 offset:20480
    s_add_u32 s43, s50, 20480
    buffer_load_dwordx4 v[160:163], v96, s[12:15], s43 offen offset:0
    v_mfma_f32_16x16x32_bf16 v[80:83], a[44:47], v[32:35], v[80:83]
    s_waitcnt lgkmcnt(4)
    v_mfma_f32_16x16x32_bf16 v[68:71], a[48:51], v[36:39], v[68:71]
    ds_read_b128 v[28:31], v17 offset:16384
    s_add_u32 m0, s21, 49152
    v_mfma_f32_16x16x32_bf16 v[72:75], a[52:55], v[36:39], v[72:75]
    buffer_load_dwordx4 v8, s[8:11], s20 offen lds
    v_mfma_f32_16x16x32_bf16 v[76:79], a[48:51], v[40:43], v[76:79]
    ds_read_b128 v[32:35], v17 offset:20480
    v_mfma_f32_16x16x32_bf16 v[80:83], a[52:55], v[40:43], v[80:83]
    s_waitcnt lgkmcnt(4)
    s_add_u32 s43, s50, 20480
    buffer_load_dwordx4 v[164:167], v96, s[12:15], s43 offen offset:1024
    v_mfma_f32_16x16x32_bf16 v[68:71], a[56:59], v[44:47], v[68:71]
    ds_read_b128 v[36:39], v18 offset:16384
    v_mfma_f32_16x16x32_bf16 v[72:75], a[60:63], v[44:47], v[72:75]
    v_mfma_f32_16x16x32_bf16 v[76:79], a[56:59], v[48:51], v[76:79]
    ds_read_b128 v[40:43], v18 offset:20480
    s_add_u32 s43, s48, 20480
    buffer_load_dwordx4 v[128:131], v96, s[12:15], s43 offen offset:0
    v_mfma_f32_16x16x32_bf16 v[80:83], a[60:63], v[48:51], v[80:83]
    s_waitcnt lgkmcnt(4)
    v_mfma_f32_16x16x32_bf16 v[68:71], a[64:67], v[20:23], v[68:71]
    ds_read_b128 v[44:47], v19 offset:16384
    s_add_u32 m0, s21, 50176
    v_mfma_f32_16x16x32_bf16 v[72:75], a[68:71], v[20:23], v[72:75]
    buffer_load_dwordx4 v9, s[8:11], s20 offen lds
    v_mfma_f32_16x16x32_bf16 v[76:79], a[64:67], v[24:27], v[76:79]
    ds_read_b128 v[48:51], v19 offset:20480
    v_mfma_f32_16x16x32_bf16 v[80:83], a[68:71], v[24:27], v[80:83]
    s_waitcnt lgkmcnt(4)
    s_add_u32 s43, s48, 20480
    buffer_load_dwordx4 v[132:135], v96, s[12:15], s43 offen offset:1024
    v_mfma_f32_16x16x32_bf16 v[68:71], a[72:75], v[28:31], v[68:71]
    ds_read_b128 v[20:23], v16 offset:16640
    v_mfma_f32_16x16x32_bf16 v[72:75], a[76:79], v[28:31], v[72:75]
    v_mfma_f32_16x16x32_bf16 v[76:79], a[72:75], v[32:35], v[76:79]
    ds_read_b128 v[24:27], v16 offset:20736
    s_add_u32 s24, s24, 1
    v_mfma_f32_16x16x32_bf16 v[80:83], a[76:79], v[32:35], v[80:83]
    s_waitcnt lgkmcnt(4)
    v_mfma_f32_16x16x32_bf16 v[68:71], a[80:83], v[36:39], v[68:71]
    ds_read_b128 v[28:31], v17 offset:16640
    s_add_u32 m0, s21, 51200
    v_mfma_f32_16x16x32_bf16 v[72:75], a[84:87], v[36:39], v[72:75]
    buffer_load_dwordx4 v10, s[8:11], s20 offen lds
    v_mfma_f32_16x16x32_bf16 v[76:79], a[80:83], v[40:43], v[76:79]
    ds_read_b128 v[32:35], v17 offset:20736
    v_mfma_f32_16x16x32_bf16 v[80:83], a[84:87], v[40:43], v[80:83]
    s_waitcnt lgkmcnt(4)
    s_add_u32 s43, s48, 20480
    buffer_load_dwordx4 v[192:195], v98, s[12:15], s43 offen offset:2048
    v_mfma_f32_16x16x32_bf16 v[68:71], a[88:91], v[44:47], v[68:71]
    ds_read_b128 v[36:39], v18 offset:16640
    s_min_u32 s24, s24, 63
    v_mfma_f32_16x16x32_bf16 v[72:75], a[92:95], v[44:47], v[72:75]
    v_mfma_f32_16x16x32_bf16 v[76:79], a[88:91], v[48:51], v[76:79]
    ds_read_b128 v[40:43], v18 offset:20736
    s_add_u32 s43, s48, 20480
    buffer_load_dwordx4 v[196:199], v98, s[12:15], s43 offen offset:3072
    v_mfma_f32_16x16x32_bf16 v[80:83], a[92:95], v[48:51], v[80:83]
    s_waitcnt lgkmcnt(4)
    s_lshl_b32 s53, s24, 16
    v_mfma_f32_16x16x32_bf16 v[68:71], a[96:99], v[20:23], v[68:71]
    ds_read_b128 v[44:47], v19 offset:16640
    s_add_u32 m0, s21, 52224
    v_mfma_f32_16x16x32_bf16 v[72:75], a[100:103], v[20:23], v[72:75]
    buffer_load_dwordx4 v11, s[8:11], s20 offen lds
    v_mfma_f32_16x16x32_bf16 v[76:79], a[96:99], v[24:27], v[76:79]
    ds_read_b128 v[48:51], v19 offset:20736
    v_mfma_f32_16x16x32_bf16 v[80:83], a[100:103], v[24:27], v[80:83]
    s_waitcnt lgkmcnt(4)
    v_mfma_f32_16x16x32_bf16 v[68:71], a[104:107], v[28:31], v[68:71]
    s_waitcnt vmcnt(20)
    s_barrier
    ds_read_b128 v[20:23], v16 offset:32768
    v_mfma_f32_16x16x32_bf16 v[72:75], a[108:111], v[28:31], v[72:75]
    s_mov_b32 s20, s53
    v_mfma_f32_16x16x32_bf16 v[76:79], a[104:107], v[32:35], v[76:79]
    ds_read_b128 v[24:27], v16 offset:36864
    s_add_u32 m0, s7, 0
    s_add_u32 s43, s48, 0x8000c00
    buffer_load_dwordx4 v96, s[12:15], s43 offen sc1 lds
    v_mfma_f32_16x16x32_bf16 v[80:83], a[108:111], v[32:35], v[80:83]
    s_waitcnt lgkmcnt(4)
    v_mfma_f32_16x16x32_bf16 v[68:71], a[112:115], v[36:39], v[68:71]
    ds_read_b128 v[28:31], v17 offset:32768
    s_add_u32 m0, s21, 65536
    v_mfma_f32_16x16x32_bf16 v[72:75], a[116:119], v[36:39], v[72:75]
    buffer_load_dwordx4 v8, s[8:11], s20 offen lds
    v_mfma_f32_16x16x32_bf16 v[76:79], a[112:115], v[40:43], v[76:79]
    ds_read_b128 v[32:35], v17 offset:36864
    v_mfma_f32_16x16x32_bf16 v[80:83], a[116:119], v[40:43], v[80:83]
    s_waitcnt lgkmcnt(4)
    v_mfma_f32_16x16x32_bf16 v[68:71], a[120:123], v[44:47], v[68:71]
    ds_read_b128 v[36:39], v18 offset:32768
    v_mfma_f32_16x16x32_bf16 v[72:75], a[124:127], v[44:47], v[72:75]
    v_mfma_f32_16x16x32_bf16 v[76:79], a[120:123], v[48:51], v[76:79]
    ds_read_b128 v[40:43], v18 offset:36864
    s_add_u32 m0, s7, 1024
    s_add_u32 s43, s48, 0x8001c00
    buffer_load_dwordx4 v96, s[12:15], s43 offen sc1 lds
    v_mfma_f32_16x16x32_bf16 v[80:83], a[124:127], v[48:51], v[80:83]
    s_waitcnt lgkmcnt(4)
    v_mfma_f32_16x16x32_bf16 v[68:71], a[128:131], v[20:23], v[68:71]
    ds_read_b128 v[44:47], v19 offset:32768
    s_add_u32 m0, s21, 66560
    v_mfma_f32_16x16x32_bf16 v[72:75], a[132:135], v[20:23], v[72:75]
    buffer_load_dwordx4 v9, s[8:11], s20 offen lds
    v_mfma_f32_16x16x32_bf16 v[76:79], a[128:131], v[24:27], v[76:79]
    ds_read_b128 v[48:51], v19 offset:36864
    v_mfma_f32_16x16x32_bf16 v[80:83], a[132:135], v[24:27], v[80:83]
    s_waitcnt lgkmcnt(4)
    buffer_load_dword v87, v103, s[32:35], 0 offen sc1
    v_mfma_f32_16x16x32_bf16 v[68:71], a[136:139], v[28:31], v[68:71]
    ds_read_b128 v[20:23], v16 offset:33024
    v_mfma_f32_16x16x32_bf16 v[72:75], a[140:143], v[28:31], v[72:75]
    v_mfma_f32_16x16x32_bf16 v[76:79], a[136:139], v[32:35], v[76:79]
    ds_read_b128 v[24:27], v16 offset:37120
    s_add_u32 m0, s7, 2048
    s_add_u32 s43, s48, 0x8004c00
    buffer_load_dwordx4 v96, s[12:15], s43 offen sc1 lds
    v_mfma_f32_16x16x32_bf16 v[80:83], a[140:143], v[32:35], v[80:83]
    s_waitcnt lgkmcnt(4)
    v_mfma_f32_16x16x32_bf16 v[68:71], a[144:147], v[36:39], v[68:71]
    ds_read_b128 v[28:31], v17 offset:33024
    s_add_u32 m0, s21, 67584
    v_mfma_f32_16x16x32_bf16 v[72:75], a[148:151], v[36:39], v[72:75]
    buffer_load_dwordx4 v10, s[8:11], s20 offen lds
    v_mfma_f32_16x16x32_bf16 v[76:79], a[144:147], v[40:43], v[76:79]
    ds_read_b128 v[32:35], v17 offset:37120
    v_mfma_f32_16x16x32_bf16 v[80:83], a[148:151], v[40:43], v[80:83]
    s_waitcnt lgkmcnt(4)
    v_mfma_f32_16x16x32_bf16 v[68:71], a[152:155], v[44:47], v[68:71]
    ds_read_b128 v[36:39], v18 offset:33024
    v_mfma_f32_16x16x32_bf16 v[72:75], a[156:159], v[44:47], v[72:75]
    v_mfma_f32_16x16x32_bf16 v[76:79], a[152:155], v[48:51], v[76:79]
    ds_read_b128 v[40:43], v18 offset:37120
    v_mfma_f32_16x16x32_bf16 v[80:83], a[156:159], v[48:51], v[80:83]
    s_waitcnt lgkmcnt(4)
    v_mfma_f32_16x16x32_bf16 v[68:71], a[160:163], v[20:23], v[68:71]
    ds_read_b128 v[44:47], v19 offset:33024
    s_add_u32 m0, s21, 68608
    v_mfma_f32_16x16x32_bf16 v[72:75], a[164:167], v[20:23], v[72:75]
    buffer_load_dwordx4 v11, s[8:11], s20 offen lds
    v_mfma_f32_16x16x32_bf16 v[76:79], a[160:163], v[24:27], v[76:79]
    ds_read_b128 v[48:51], v19 offset:37120
    v_mfma_f32_16x16x32_bf16 v[80:83], a[164:167], v[24:27], v[80:83]
    s_waitcnt lgkmcnt(4)
    s_add_u32 m0, s7, 3072
    s_add_u32 s43, s48, 0x8005c00
    buffer_load_dwordx4 v96, s[12:15], s43 offen sc1 lds
    v_mfma_f32_16x16x32_bf16 v[68:71], a[168:171], v[28:31], v[68:71]
    s_waitcnt vmcnt(20)
    s_barrier
    ds_read_b128 v[20:23], v16 offset:49152
    v_mfma_f32_16x16x32_bf16 v[72:75], a[172:175], v[28:31], v[72:75]
    s_add_u32 s20, s20, 512
    v_mfma_f32_16x16x32_bf16 v[76:79], a[168:171], v[32:35], v[76:79]
    ds_read_b128 v[24:27], v16 offset:53248
    v_mfma_f32_16x16x32_bf16 v[80:83], a[172:175], v[32:35], v[80:83]
    s_waitcnt lgkmcnt(4)
    v_mfma_f32_16x16x32_bf16 v[68:71], a[176:179], v[36:39], v[68:71]
    ds_read_b128 v[28:31], v17 offset:49152
    s_add_u32 m0, s21, 81920
    v_mfma_f32_16x16x32_bf16 v[72:75], a[180:183], v[36:39], v[72:75]
    buffer_load_dwordx4 v8, s[8:11], s20 offen lds
    v_mfma_f32_16x16x32_bf16 v[76:79], a[176:179], v[40:43], v[76:79]
    ds_read_b128 v[32:35], v17 offset:53248
    v_mfma_f32_16x16x32_bf16 v[80:83], a[180:183], v[40:43], v[80:83]
    s_waitcnt lgkmcnt(4)
    v_mfma_f32_16x16x32_bf16 v[68:71], a[184:187], v[44:47], v[68:71]
    ds_read_b128 v[36:39], v18 offset:49152
    v_mfma_f32_16x16x32_bf16 v[72:75], a[188:191], v[44:47], v[72:75]
    v_mfma_f32_16x16x32_bf16 v[76:79], a[184:187], v[48:51], v[76:79]
    ds_read_b128 v[40:43], v18 offset:53248
    v_mfma_f32_16x16x32_bf16 v[80:83], a[188:191], v[48:51], v[80:83]
    s_waitcnt lgkmcnt(4)
    v_mfma_f32_16x16x32_bf16 v[68:71], a[192:195], v[20:23], v[68:71]
    ds_read_b128 v[44:47], v19 offset:49152
    s_add_u32 m0, s21, 82944
    v_mfma_f32_16x16x32_bf16 v[72:75], a[196:199], v[20:23], v[72:75]
    buffer_load_dwordx4 v9, s[8:11], s20 offen lds
    v_mfma_f32_16x16x32_bf16 v[76:79], a[192:195], v[24:27], v[76:79]
    ds_read_b128 v[48:51], v19 offset:53248
    v_mfma_f32_16x16x32_bf16 v[80:83], a[196:199], v[24:27], v[80:83]
    s_waitcnt lgkmcnt(4)
    v_mfma_f32_16x16x32_bf16 v[68:71], a[200:203], v[28:31], v[68:71]
    ds_read_b128 v[20:23], v16 offset:49408
    v_mfma_f32_16x16x32_bf16 v[72:75], a[204:207], v[28:31], v[72:75]
    v_mfma_f32_16x16x32_bf16 v[76:79], a[200:203], v[32:35], v[76:79]
    ds_read_b128 v[24:27], v16 offset:53504
    v_mfma_f32_16x16x32_bf16 v[80:83], a[204:207], v[32:35], v[80:83]
    s_waitcnt lgkmcnt(4)
    v_mfma_f32_16x16x32_bf16 v[68:71], a[208:211], v[36:39], v[68:71]
    ds_read_b128 v[28:31], v17 offset:49408
    s_add_u32 m0, s21, 83968
    v_mfma_f32_16x16x32_bf16 v[72:75], a[212:215], v[36:39], v[72:75]
    buffer_load_dwordx4 v10, s[8:11], s20 offen lds
    v_mfma_f32_16x16x32_bf16 v[76:79], a[208:211], v[40:43], v[76:79]
    ds_read_b128 v[32:35], v17 offset:53504
    v_mfma_f32_16x16x32_bf16 v[80:83], a[212:215], v[40:43], v[80:83]
    s_waitcnt lgkmcnt(4)
    v_mfma_f32_16x16x32_bf16 v[68:71], a[216:219], v[44:47], v[68:71]
    ds_read_b128 v[36:39], v18 offset:49408
    v_mfma_f32_16x16x32_bf16 v[72:75], a[220:223], v[44:47], v[72:75]
    v_mfma_f32_16x16x32_bf16 v[76:79], a[216:219], v[48:51], v[76:79]
    ds_read_b128 v[40:43], v18 offset:53504
    v_mfma_f32_16x16x32_bf16 v[80:83], a[220:223], v[48:51], v[80:83]
    s_waitcnt lgkmcnt(4)
    v_mfma_f32_16x16x32_bf16 v[68:71], a[224:227], v[20:23], v[68:71]
    ds_read_b128 v[44:47], v19 offset:49408
    s_add_u32 m0, s21, 84992
    v_mfma_f32_16x16x32_bf16 v[72:75], a[228:231], v[20:23], v[72:75]
    buffer_load_dwordx4 v11, s[8:11], s20 offen lds
    v_mfma_f32_16x16x32_bf16 v[76:79], a[224:227], v[24:27], v[76:79]
    ds_read_b128 v[48:51], v19 offset:53504
    v_mfma_f32_16x16x32_bf16 v[80:83], a[228:231], v[24:27], v[80:83]
    s_waitcnt lgkmcnt(4)
    v_mfma_f32_16x16x32_bf16 v[68:71], a[232:235], v[28:31], v[68:71]
    s_waitcnt vmcnt(20)
    s_barrier
    ds_read_b128 v[20:23], v12 offset:0
    v_mfma_f32_16x16x32_bf16 v[72:75], a[236:239], v[28:31], v[72:75]
    s_add_u32 s20, s20, 512
    v_mfma_f32_16x16x32_bf16 v[76:79], a[232:235], v[32:35], v[76:79]
    ds_read_b128 v[24:27], v12 offset:4096
    v_mfma_f32_16x16x32_bf16 v[80:83], a[236:239], v[32:35], v[80:83]
    s_waitcnt lgkmcnt(4)
    v_mfma_f32_16x16x32_bf16 v[68:71], a[240:243], v[36:39], v[68:71]
    ds_read_b128 v[28:31], v13 offset:0
    s_add_u32 m0, s21, 98304
    v_mfma_f32_16x16x32_bf16 v[72:75], a[244:247], v[36:39], v[72:75]
    buffer_load_dwordx4 v8, s[8:11], s20 offen lds
    v_mfma_f32_16x16x32_bf16 v[76:79], a[240:243], v[40:43], v[76:79]
    ds_read_b128 v[32:35], v13 offset:4096
    v_mfma_f32_16x16x32_bf16 v[80:83], a[244:247], v[40:43], v[80:83]
    s_waitcnt lgkmcnt(4)
    v_mfma_f32_16x16x32_bf16 v[68:71], a[248:251], v[44:47], v[68:71]
    ds_read_b128 v[36:39], v14 offset:0
    v_mfma_f32_16x16x32_bf16 v[72:75], a[252:255], v[44:47], v[72:75]
    v_mfma_f32_16x16x32_bf16 v[76:79], a[248:251], v[48:51], v[76:79]
    ds_read_b128 v[40:43], v14 offset:4096
    v_mfma_f32_16x16x32_bf16 v[80:83], a[252:255], v[48:51], v[80:83]
    s_waitcnt lgkmcnt(4)
    s_add_u32 s22, s22, 1
    s_cmp_ge_u32 s22, s23
    s_cbranch_scc0 L_st_225
L_fl1_223:
    s_waitcnt lgkmcnt(0)
    s_nop 7
    s_sub_u32 s39, s22, 1
    s_bitcmp1_b32 s39, 1
    s_cselect_b32 s38, s54, s55
    s_add_u32 s38, s38, s44
    s_lshl_b32 s42, s39, 20
    s_add_u32 s38, s38, s42
    s_cmp_eq_u32 s37, 0
    s_cselect_b32 s38, 0x7ff00000, s38
    s_mov_b32 s37, 1
    v_cvt_pk_bf16_f32 v88, v68, v69
    v_cvt_pk_bf16_f32 v89, v70, v71
    v_cvt_pk_bf16_f32 v90, v72, v73
    v_cvt_pk_bf16_f32 v91, v74, v75
    buffer_store_dwordx4 v[88:91], v86, s[12:15], s38 offen offset:0
    v_cvt_pk_bf16_f32 v92, v76, v77
    v_cvt_pk_bf16_f32 v93, v78, v79
    v_cvt_pk_bf16_f32 v94, v80, v81
    v_cvt_pk_bf16_f32 v95, v82, v83
    buffer_store_dwordx4 v[92:95], v86, s[12:15], s38 offen offset:128
    s_waitcnt vmcnt(0)
    s_barrier
    s_mov_b32 s25, 0x5901f80
    v_mov_b32 v2, 0
L_pl_229:
    buffer_load_dword v1, v2, s[12:15], s25 offen sc1
    s_add_u32 s36, s36, 1
    s_cmp_gt_u32 s36, 0x100000
    s_cbranch_scc1 chain_kernel_wend
    s_waitcnt vmcnt(0)
    v_readfirstlane_b32 s26, v1
    s_cmp_ge_u32 s26, 64
    s_cbranch_scc1 L_plok_230
    s_sleep 4
    s_branch L_pl_229
L_plok_230:
L_att_220:
    buffer_atomic_add v84, v85, s[12:15], s51 offen sc1
    s_mov_b32 s51, 0x40000000
    s_waitcnt lgkmcnt(0)
    s_cmp_eq_u32 s45, 0
    s_cbranch_scc1 L_anext_226
    s_add_u32 s38, s47, s49
    v_mfma_f32_32x32x16_bf16 v[200:215], v[104:107], v[136:139], 0
    v_mfma_f32_32x32x16_bf16 v[200:215], v[108:111], v[140:143], v[200:215]
    v_mfma_f32_32x32x16_bf16 v[200:215], v[112:115], v[144:147], v[200:215]
    v_mfma_f32_32x32x16_bf16 v[200:215], v[116:119], v[148:151], v[200:215]
    v_mfma_f32_32x32x16_bf16 v[200:215], v[120:123], v[152:155], v[200:215]
    v_mfma_f32_32x32x16_bf16 v[200:215], v[124:127], v[156:159], v[200:215]
    v_mfma_f32_32x32x16_bf16 v[200:215], v[128:131], v[160:163], v[200:215]
    v_mfma_f32_32x32x16_bf16 v[200:215], v[132:135], v[164:167], v[200:215]
    s_mov_b32 s28, 0x3fb8aa3b
    s_mov_b32 s29, 0x3db504f3
    s_nop 9
    v_cvt_pk_bf16_f32 v200, 0, v200
    v_cvt_pk_bf16_f32 v201, 0, v201
    v_cvt_pk_bf16_f32 v202, 0, v202
    v_cvt_pk_bf16_f32 v203, 0, v203
    v_cvt_pk_bf16_f32 v204, 0, v204
    v_cvt_pk_bf16_f32 v205, 0, v205
    v_cvt_pk_bf16_f32 v206, 0, v206
    v_cvt_pk_bf16_f32 v207, 0, v207
    v_cvt_pk_bf16_f32 v208, 0, v208
    v_cvt_pk_bf16_f32 v209, 0, v209
    v_cvt_pk_bf16_f32 v210, 0, v210
    v_cvt_pk_bf16_f32 v211, 0, v211
    v_cvt_pk_bf16_f32 v212, 0, v212
    v_cvt_pk_bf16_f32 v213, 0, v213
    v_cvt_pk_bf16_f32 v214, 0, v214
    v_cvt_pk_bf16_f32 v215, 0, v215
    v_mul_f32 v200, s29, v200
    v_mul_f32 v201, s29, v201
    v_mul_f32 v202, s29, v202
    v_mul_f32 v203, s29, v203
    v_mul_f32 v204, s29, v204
    v_mul_f32 v205, s29, v205
    v_mul_f32 v206, s29, v206
    v_mul_f32 v207, s29, v207
    v_mul_f32 v208, s29, v208
    v_mul_f32 v209, s29, v209
    v_mul_f32 v210, s29, v210
    v_mul_f32 v211, s29, v211
    v_mul_f32 v212, s29, v212
    v_mul_f32 v213, s29, v213
    v_mul_f32 v214, s29, v214
    v_mul_f32 v215, s29, v215
    v_cvt_pk_bf16_f32 v200, 0, v200
    v_cvt_pk_bf16_f32 v201, 0, v201
    v_cvt_pk_bf16_f32 v202, 0, v202
    v_cvt_pk_bf16_f32 v203, 0, v203
    v_cvt_pk_bf16_f32 v204, 0, v204
    v_cvt_pk_bf16_f32 v205, 0, v205
    v_cvt_pk_bf16_f32 v206, 0, v206
    v_cvt_pk_bf16_f32 v207, 0, v207
    v_cvt_pk_bf16_f32 v208, 0, v208
    v_cvt_pk_bf16_f32 v209, 0, v209
    v_cvt_pk_bf16_f32 v210, 0, v210
    v_cvt_pk_bf16_f32 v211, 0, v211
    v_cvt_pk_bf16_f32 v212, 0, v212
    v_cvt_pk_bf16_f32 v213, 0, v213
    v_cvt_pk_bf16_f32 v214, 0, v214
    v_cvt_pk_bf16_f32 v215, 0, v215
    v_add_f32 v200, v200, v240
    v_add_f32 v201, v201, v241
    v_add_f32 v202, v202, v242
    v_add_f32 v203, v203, v243
    v_add_f32 v204, v204, v244
    v_add_f32 v205, v205, v245
    v_add_f32 v206, v206, v246
    v_add_f32 v207, v207, v247
    v_add_f32 v208, v208, v248
    v_add_f32 v209, v209, v249
    v_add_f32 v210, v210, v250
    v_add_f32 v211, v211, v251
    v_add_f32 v212, v212, v252
    v_add_f32 v213, v213, v253
    v_add_f32 v214, v214, v254
    v_add_f32 v215, v215, v255
    v_max3_f32 v234, v200, v201, v202
    v_max3_f32 v235, v203, v204, v205
    v_max3_f32 v234, v234, v206, v207
    v_max3_f32 v235, v235, v208, v209
    v_max3_f32 v234, v234, v210, v211
    v_max3_f32 v235, v235, v212, v213
    v_max3_f32 v234, v234, v214, v215
    s_add_u32 s27, s38, 1
    s_sub_u32 s26, s38, 1
    s_min_u32 s26, s26, 61
    s_cmp_ge_u32 s38, 60
    s_cselect_b32 s27, s26, s27
    v_mov_b32 v2, 4
    s_cmp_lt_u32 s22, 64
    s_cbranch_scc1 L_have_233
L_cw_231:
    buffer_load_dword v1, v2, s[32:35], 0 offen sc1
    s_add_u32 s36, s36, 1
    s_cmp_gt_u32 s36, 0x100000
    s_cbranch_scc1 chain_kernel_wend
    s_waitcnt vmcnt(0)
    v_readfirstlane_b32 s25, v1
    s_cmp_ge_u32 s25, s27
    s_cbranch_scc1 L_cwok_232
    s_sleep 4
    s_branch L_cw_231
L_cwok_232:
    s_add_u32 m0, s7, 0
    s_add_u32 s43, s48, 0x8000c00
    buffer_load_dwordx4 v96, s[12:15], s43 offen sc1 lds
    s_add_u32 m0, s7, 1024
    s_add_u32 s43, s48, 0x8001c00
    buffer_load_dwordx4 v96, s[12:15], s43 offen sc1 lds
    s_add_u32 m0, s7, 2048
    s_add_u32 s43, s48, 0x8004c00
    buffer_load_dwordx4 v96, s[12:15], s43 offen sc1 lds
    s_add_u32 m0, s7, 3072
    s_add_u32 s43, s48, 0x8005c00
    buffer_load_dwordx4 v96, s[12:15], s43 offen sc1 lds
    s_add_u32 s36, s36, 1
    s_cmp_gt_u32 s36, 0x100000
    s_cbranch_scc1 chain_kernel_wend
    s_waitcnt vmcnt(0)
L_have_233:
    ds_read_b128 v[104:107], v97 offset:0
    ds_read_b128 v[108:111], v97 offset:256
    ds_read_b64 v[216:217], v99 offset:512
    ds_read_b128 v[112:115], v97 offset:1024
    ds_read_b128 v[116:119], v97 offset:1280
    ds_read_b64 v[218:219], v99 offset:1536
    ds_read_b128 v[120:123], v97 offset:2048
    ds_read_b128 v[124:127], v97 offset:2304
    ds_read_b64 v[220:221], v99 offset:2560
    ds_read_b128 v[128:131], v97 offset:3072
    ds_read_b128 v[132:135], v97 offset:3328
    ds_read_b64 v[222:223], v99 offset:3584
    v_mov_b32 v1, 0
    s_waitcnt lgkmcnt(11)
    v_mfma_f32_32x32x16_bf16 v[68:83], v[104:107], v[136:139], 0
    v_max3_u32 v1, v1, v104, v105
    v_max3_u32 v1, v1, v106, v107
    s_waitcnt lgkmcnt(9)
    v_mfma_f32_32x32x16_bf16 v[68:83], v[108:111], v[140:143], v[68:83]
    v_max3_u32 v1, v1, v108, v109
    v_max3_u32 v1, v1, v110, v111
    v_max3_u32 v1, v1, v216, v217
    s_waitcnt lgkmcnt(8)
    v_mfma_f32_32x32x16_bf16 v[68:83], v[112:115], v[144:147], v[68:83]
    v_max3_u32 v1, v1, v112, v113
    v_max3_u32 v1, v1, v114, v115
    s_waitcnt lgkmcnt(6)
    v_mfma_f32_32x32x16_bf16 v[68:83], v[116:119], v[148:151], v[68:83]
    v_max3_u32 v1, v1, v116, v117
    v_max3_u32 v1, v1, v118, v119
    v_max3_u32 v1, v1, v218, v219
    s_waitcnt lgkmcnt(5)
    v_mfma_f32_32x32x16_bf16 v[68:83], v[120:123], v[152:155], v[68:83]
    v_max3_u32 v1, v1, v120, v121
    v_max3_u32 v1, v1, v122, v123
    s_waitcnt lgkmcnt(3)
    v_mfma_f32_32x32x16_bf16 v[68:83], v[124:127], v[156:159], v[68:83]
    v_max3_u32 v1, v1, v124, v125
    v_max3_u32 v1, v1, v126, v127
    v_max3_u32 v1, v1, v220, v221
    s_waitcnt lgkmcnt(2)
    v_mfma_f32_32x32x16_bf16 v[68:83], v[128:131], v[160:163], v[68:83]
    v_max3_u32 v1, v1, v128, v129
    v_max3_u32 v1, v1, v130, v131
    s_waitcnt lgkmcnt(0)
    v_mfma_f32_32x32x16_bf16 v[68:83], v[132:135], v[164:167], v[68:83]
    v_max3_u32 v1, v1, v132, v133
    v_max3_u32 v1, v1, v134, v135
    v_max3_u32 v1, v1, v222, v223
    v_cmp_eq_u32 vcc, 0xff81ff81, v1
    s_cbranch_vccnz L_cwok_232
    s_nop 6
    v_cvt_pk_bf16_f32 v68, 0, v68
    v_cvt_pk_bf16_f32 v69, 0, v69
    v_cvt_pk_bf16_f32 v70, 0, v70
    v_cvt_pk_bf16_f32 v71, 0, v71
    v_mul_f32 v68, s29, v68
    v_mul_f32 v69, s29, v69
    v_mul_f32 v70, s29, v70
    v_mul_f32 v71, s29, v71
    v_cvt_pk_bf16_f32 v68, 0, v68
    v_cvt_pk_bf16_f32 v69, 0, v69
    v_cvt_pk_bf16_f32 v70, 0, v70
    v_cvt_pk_bf16_f32 v71, 0, v71
    v_max3_f32 v235, v235, v68, v69
    v_max3_f32 v234, v234, v70, v71
    v_max_f32 v234, v234, v235
    v_mov_b32 v235, v234
    s_nop 1
    v_permlane32_swap_b32 v234, v235
    s_nop 0
    v_max_f32 v234, v234, v235
    v_mul_f32 v234, s28, v234
    v_fma_f32 v200, v200, s28, -v234
    v_fma_f32 v201, v201, s28, -v234
    v_fma_f32 v202, v202, s28, -v234
    v_fma_f32 v203, v203, s28, -v234
    v_fma_f32 v204, v204, s28, -v234
    v_fma_f32 v205, v205, s28, -v234
    v_fma_f32 v206, v206, s28, -v234
    v_fma_f32 v207, v207, s28, -v234
    v_fma_f32 v208, v208, s28, -v234
    v_fma_f32 v209, v209, s28, -v234
    v_fma_f32 v210, v210, s28, -v234
    v_fma_f32 v211, v211, s28, -v234
    v_fma_f32 v212, v212, s28, -v234
    v_fma_f32 v213, v213, s28, -v234
    v_fma_f32 v214, v214, s28, -v234
    v_fma_f32 v215, v215, s28, -v234
    v_fma_f32 v68, v68, s28, -v234
    v_fma_f32 v69, v69, s28, -v234
    v_fma_f32 v70, v70, s28, -v234
    v_fma_f32 v71, v71, s28, -v234
    v_exp_f32 v200, v200
    v_exp_f32 v201, v201
    v_exp_f32 v202, v202
    v_exp_f32 v203, v203
    v_exp_f32 v204, v204
    v_exp_f32 v205, v205
    v_exp_f32 v206, v206
    v_exp_f32 v207, v207
    v_exp_f32 v208, v208
    v_exp_f32 v209, v209
    v_exp_f32 v210, v210
    v_exp_f32 v211, v211
    v_exp_f32 v212, v212
    v_exp_f32 v213, v213
    v_exp_f32 v214, v214
    v_exp_f32 v215, v215
    v_exp_f32 v68, v68
    v_exp_f32 v69, v69
    v_exp_f32 v70, v70
    v_exp_f32 v71, v71
    v_pk_add_f32 v[236:237], v[200:201], v[202:203]
    v_pk_add_f32 v[236:237], v[236:237], v[204:205]
    v_pk_add_f32 v[236:237], v[236:237], v[206:207]
    v_pk_add_f32 v[236:237], v[236:237], v[208:209]
    v_pk_add_f32 v[236:237], v[236:237], v[210:211]
    v_pk_add_f32 v[236:237], v[236:237], v[212:213]
    v_pk_add_f32 v[236:237], v[236:237], v[214:215]
    v_pk_add_f32 v[236:237], v[236:237], v[68:69]
    v_pk_add_f32 v[236:237], v[236:237], v[70:71]
    v_add_f32 v236, v236, v237
    v_mov_b32 v235, v236
    s_nop 1
    v_permlane32_swap_b32 v236, v235
    s_nop 0
    v_add_f32 v236, v236, v235
    v_rcp_f32 v236, v236
    s_nop 0
    v_pk_mul_f32 v[200:201], v[200:201], v[236:237] op_sel_hi:[1,0]
    v_pk_mul_f32 v[202:203], v[202:203], v[236:237] op_sel_hi:[1,0]
    v_pk_mul_f32 v[204:205], v[204:205], v[236:237] op_sel_hi:[1,0]
    v_pk_mul_f32 v[206:207], v[206:207], v[236:237] op_sel_hi:[1,0]
    v_pk_mul_f32 v[208:209], v[208:209], v[236:237] op_sel_hi:[1,0]
    v_pk_mul_f32 v[210:211], v[210:211], v[236:237] op_sel_hi:[1,0]
    v_pk_mul_f32 v[212:213], v[212:213], v[236:237] op_sel_hi:[1,0]
    v_pk_mul_f32 v[214:215], v[214:215], v[236:237] op_sel_hi:[1,0]
    v_pk_mul_f32 v[68:69], v[68:69], v[236:237] op_sel_hi:[1,0]
    v_pk_mul_f32 v[70:71], v[70:71], v[236:237] op_sel_hi:[1,0]
    v_cvt_pk_bf16_f32 v224, v200, v201
    v_cvt_pk_bf16_f32 v225, v202, v203
    v_cvt_pk_bf16_f32 v226, v204, v205
    v_cvt_pk_bf16_f32 v227, v206, v207
    v_cvt_pk_bf16_f32 v228, v208, v209
    v_cvt_pk_bf16_f32 v229, v210, v211
    v_cvt_pk_bf16_f32 v230, v212, v213
    v_cvt_pk_bf16_f32 v231, v214, v215
    v_cvt_pk_bf16_f32 v232, v68, v69
    v_cvt_pk_bf16_f32 v233, v70, v71
    s_nop 1
    v_mfma_f32_32x32x8_bf16 v[104:119], v[216:217], v[232:233], 0
    v_mfma_f32_32x32x8_bf16 v[120:135], v[218:219], v[232:233], 0
    v_mfma_f32_32x32x8_bf16 v[136:151], v[220:221], v[232:233], 0
    v_mfma_f32_32x32x8_bf16 v[152:167], v[222:223], v[232:233], 0
    v_mfma_f32_32x32x16_bf16 v[104:119], v[168:171], v[224:227], v[104:119]
    v_mfma_f32_32x32x16_bf16 v[120:135], v[176:179], v[224:227], v[120:135]
    v_mfma_f32_32x32x16_bf16 v[136:151], v[184:187], v[224:227], v[136:151]
    v_mfma_f32_32x32x16_bf16 v[152:167], v[192:195], v[224:227], v[152:167]
    v_mfma_f32_32x32x16_bf16 v[104:119], v[172:175], v[228:231], v[104:119]
    v_mfma_f32_32x32x16_bf16 v[120:135], v[180:183], v[228:231], v[120:135]
    v_mfma_f32_32x32x16_bf16 v[136:151], v[188:191], v[228:231], v[136:151]
    v_mfma_f32_32x32x16_bf16 v[152:167], v[196:199], v[228:231], v[152:167]
    s_lshl_b32 s25, s38, 9
    s_lshr_b32 s26, s46, 3
    s_lshl_b32 s26, s26, 7
    s_add_u32 s25, s25, s26
    s_add_u32 s51, s25, 0x5904000
    s_nop 4
    v_cvt_pk_bf16_f32 v168, v104, v105
    v_cvt_pk_bf16_f32 v169, v106, v107
    v_cvt_pk_bf16_f32 v170, v108, v109
    v_cvt_pk_bf16_f32 v171, v110, v111
    v_cvt_pk_bf16_f32 v172, v112, v113
    v_cvt_pk_bf16_f32 v173, v114, v115
    v_cvt_pk_bf16_f32 v174, v116, v117
    v_cvt_pk_bf16_f32 v175, v118, v119
    s_add_u32 s43, s50, 0
    buffer_store_dwordx4 v[168:171], v100, s[12:15], s43 offen offset:2048 sc1
    buffer_store_dwordx4 v[172:175], v100, s[12:15], s43 offen offset:2560 sc1
    v_cvt_pk_bf16_f32 v176, v120, v121
    v_cvt_pk_bf16_f32 v177, v122, v123
    v_cvt_pk_bf16_f32 v178, v124, v125
    v_cvt_pk_bf16_f32 v179, v126, v127
    v_cvt_pk_bf16_f32 v180, v128, v129
    v_cvt_pk_bf16_f32 v181, v130, v131
    v_cvt_pk_bf16_f32 v182, v132, v133
    v_cvt_pk_bf16_f32 v183, v134, v135
    s_add_u32 s43, s50, 4096
    buffer_store_dwordx4 v[176:179], v100, s[12:15], s43 offen offset:2048 sc1
    buffer_store_dwordx4 v[180:183], v100, s[12:15], s43 offen offset:2560 sc1
    v_cvt_pk_bf16_f32 v184, v136, v137
    v_cvt_pk_bf16_f32 v185, v138, v139
    v_cvt_pk_bf16_f32 v186, v140, v141
    v_cvt_pk_bf16_f32 v187, v142, v143
    v_cvt_pk_bf16_f32 v188, v144, v145
    v_cvt_pk_bf16_f32 v189, v146, v147
    v_cvt_pk_bf16_f32 v190, v148, v149
    v_cvt_pk_bf16_f32 v191, v150, v151
    s_add_u32 s43, s50, 16384
    buffer_store_dwordx4 v[184:187], v100, s[12:15], s43 offen offset:2048 sc1
    buffer_store_dwordx4 v[188:191], v100, s[12:15], s43 offen offset:2560 sc1
    v_cvt_pk_bf16_f32 v192, v152, v153
    v_cvt_pk_bf16_f32 v193, v154, v155
    v_cvt_pk_bf16_f32 v194, v156, v157
    v_cvt_pk_bf16_f32 v195, v158, v159
    v_cvt_pk_bf16_f32 v196, v160, v161
    v_cvt_pk_bf16_f32 v197, v162, v163
    v_cvt_pk_bf16_f32 v198, v164, v165
    v_cvt_pk_bf16_f32 v199, v166, v167
    s_add_u32 s43, s50, 20480
    buffer_store_dwordx4 v[192:195], v100, s[12:15], s43 offen offset:2048 sc1
    buffer_store_dwordx4 v[196:199], v100, s[12:15], s43 offen offset:2560 sc1
    s_add_u32 s47, s47, 4
L_anext_226:
    s_add_u32 s27, s47, s49
    s_lshl_b32 s25, s27, 20
    s_lshl_b32 s26, s46, 15
    s_add_u32 s25, s25, s26
    s_bitcmp1_b32 s27, 1
    s_cselect_b32 s48, s55, s54
    s_cselect_b32 s50, s54, s55
    s_add_u32 s48, s48, s25
    s_add_u32 s50, s50, s25
    s_cmp_ge_u32 s22, 64
    s_cbranch_scc1 L_aserve_227
    v_readfirstlane_b32 s25, v87
    s_sub_u32 s26, s22, 3
    s_min_i32 s25, s25, s26
    s_add_u32 s26, s47, 4
    s_cmp_ge_i32 s25, s26
    s_cselect_b32 s45, 1, 0
    s_cselect_b32 s48, s48, 0x40000000
    s_cselect_b32 s50, s50, 0x40000000
    s_branch L_attr_221
L_aserve_227:
    s_waitcnt vmcnt(0)
    buffer_atomic_add v84, v85, s[12:15], s51 offen sc1
    s_mov_b32 s51, 0x40000000
    s_cmp_ge_u32 s47, 64
    s_cbranch_scc1 L_afin_228
    s_add_u32 s43, s50, 0
    buffer_load_dwordx4 v[136:139], v96, s[12:15], s43 offen offset:0
    s_add_u32 s43, s50, 0
    buffer_load_dwordx4 v[140:143], v96, s[12:15], s43 offen offset:1024
    s_add_u32 s43, s48, 0
    buffer_load_dwordx4 v[104:107], v96, s[12:15], s43 offen offset:0
    s_add_u32 s43, s48, 0
    buffer_load_dwordx4 v[108:111], v96, s[12:15], s43 offen offset:1024
    s_add_u32 s43, s48, 0
    buffer_load_dwordx4 v[168:171], v98, s[12:15], s43 offen offset:2048
    s_add_u32 s43, s48, 0
    buffer_load_dwordx4 v[172:175], v98, s[12:15], s43 offen offset:3072
    s_add_u32 s43, s50, 4096
    buffer_load_dwordx4 v[144:147], v96, s[12:15], s43 offen offset:0
    s_add_u32 s43, s50, 4096
    buffer_load_dwordx4 v[148:151], v96, s[12:15], s43 offen offset:1024
    s_add_u32 s43, s48, 4096
    buffer_load_dwordx4 v[112:115], v96, s[12:15], s43 offen offset:0
    s_add_u32 s43, s48, 4096
    buffer_load_dwordx4 v[116:119], v96, s[12:15], s43 offen offset:1024
    s_add_u32 s43, s48, 4096
    buffer_load_dwordx4 v[176:179], v98, s[12:15], s43 offen offset:2048
    s_add_u32 s43, s48, 4096
    buffer_load_dwordx4 v[180:183], v98, s[12:15], s43 offen offset:3072
    s_add_u32 s43, s50, 16384
    buffer_load_dwordx4 v[152:155], v96, s[12:15], s43 offen offset:0
    s_add_u32 s43, s50, 16384
    buffer_load_dwordx4 v[156:159], v96, s[12:15], s43 offen offset:1024
    s_add_u32 s43, s48, 16384
    buffer_load_dwordx4 v[120:123], v96, s[12:15], s43 offen offset:0
    s_add_u32 s43, s48, 16384
    buffer_load_dwordx4 v[124:127], v96, s[12:15], s43 offen offset:1024
    s_add_u32 s43, s48, 16384
    buffer_load_dwordx4 v[184:187], v98, s[12:15], s43 offen offset:2048
    s_add_u32 s43, s48, 16384
    buffer_load_dwordx4 v[188:191], v98, s[12:15], s43 offen offset:3072
    s_add_u32 s43, s50, 20480
    buffer_load_dwordx4 v[160:163], v96, s[12:15], s43 offen offset:0
    s_add_u32 s43, s50, 20480
    buffer_load_dwordx4 v[164:167], v96, s[12:15], s43 offen offset:1024
    s_add_u32 s43, s48, 20480
    buffer_load_dwordx4 v[128:131], v96, s[12:15], s43 offen offset:0
    s_add_u32 s43, s48, 20480
    buffer_load_dwordx4 v[132:135], v96, s[12:15], s43 offen offset:1024
    s_add_u32 s43, s48, 20480
    buffer_load_dwordx4 v[192:195], v98, s[12:15], s43 offen offset:2048
    s_add_u32 s43, s48, 20480
    buffer_load_dwordx4 v[196:199], v98, s[12:15], s43 offen offset:3072
    s_mov_b32 s45, 1
    s_waitcnt vmcnt(0)
    s_branch L_att_220
L_afin_228:
    s_branch L_ste_224
L_fl0_222:
    s_waitcnt lgkmcnt(0)
    s_nop 7
L_ste_224:
    s_branch chain_kernel_wend
L_g1_203:
    s_cmp_ge_u32 s41, 16
    s_cbranch_scc1 L_g2_204
    s_mov_b32 s8, s64
    s_and_b32 s9, s65, 0xffff
    s_mov_b32 s10, 0x400000
    s_mov_b32 s11, 0x00020000
    v_lshlrev_b32 v1, 4, v0
    s_lshl_b32 s25, s41, 12
    buffer_load_dwordx4 v[52:55], v1, s[8:11], s25 offen
    s_add_u32 s25, s25, 65536
    buffer_load_dwordx4 v[52:55], v1, s[8:11], s25 offen
    s_add_u32 s25, s25, 65536
    buffer_load_dwordx4 v[52:55], v1, s[8:11], s25 offen
    s_add_u32 s25, s25, 65536
    buffer_load_dwordx4 v[52:55], v1, s[8:11], s25 offen
    s_add_u32 s25, s25, 65536
    s_lshl_b32 s46, s41, 6
    s_lshl_b32 s25, s49, 4
    s_add_u32 s46, s46, s25
    v_and_b32 v1, 15, v0
    v_add_u32 v1, s46, v1
    v_bfe_u32 v2, v0, 4, 2
    v_lshlrev_b32 v3, 1, v1
    s_mov_b32 s16, s66
    s_and_b32 s17, s67, 0xffff
    s_mov_b32 s18, 0x800
    s_mov_b32 s19, 0x00020000
    buffer_load_ushort v128, v3, s[16:19], 0 offen
    s_mov_b32 s16, s68
    s_and_b32 s17, s69, 0xffff
    s_mov_b32 s18, 0x800
    s_mov_b32 s19, 0x00020000
    buffer_load_ushort v129, v3, s[16:19], 0 offen
    s_mov_b32 s16, s78
    s_and_b32 s17, s79, 0xffff
    s_mov_b32 s18, 0x800
    s_mov_b32 s19, 0x00020000
    buffer_load_ushort v130, v3, s[16:19], 0 offen
    s_mov_b32 s16, s70
    s_and_b32 s17, s71, 0xffff
    s_mov_b32 s18, 0x200000
    s_mov_b32 s19, 0x00020000
    s_mov_b32 s32, s72
    s_and_b32 s33, s73, 0xffff
    s_mov_b32 s34, 0x200000
    s_mov_b32 s35, 0x00020000
    s_lshl_b32 s25, s49, 11
    s_add_u32 s25, s25, 0x20000
    v_bfe_u32 v5, v0, 1, 2
    v_xor_b32 v5, v5, v2
    v_lshlrev_b32 v5, 4, v5
    v_and_b32 v6, 15, v0
    v_lshl_add_u32 v5, v6, 6, v5
    v_add_u32 v116, s25, v5
    v_bfe_u32 v5, v0, 5, 1
    v_bfe_u32 v6, v0, 2, 2
    v_lshl_add_u32 v5, v5, 3, v6
    v_lshlrev_b32 v5, 6, v5
    v_bfe_u32 v7, v0, 4, 1
    v_lshlrev_b32 v7, 1, v7
    v_bfe_u32 v117, v0, 1, 1
    v_add_u32 v7, v7, v117
    v_lshrrev_b32 v6, 1, v6
    v_xor_b32 v7, v7, v6
    v_lshl_add_u32 v5, v7, 4, v5
    v_and_b32 v6, 1, v0
    v_lshl_add_u32 v5, v6, 3, v5
    v_add_u32 v117, s25, v5
    v_xor_b32 v118, 32, v117
    s_lshl_b32 s25, s46, 6
    v_and_b32 v5, 63, v0
    v_lshlrev_b32 v5, 4, v5
    v_add_u32 v86, s25, v5
    v_and_b32 v1, 31, v0
    v_bfe_u32 v2, v0, 5, 1
    v_add_u32 v3, 0, v2
    v_xor_b32 v4, v3, v1
    v_lshlrev_b32 v4, 4, v4
    v_add_u32 v3, s46, v3
    v_lshl_add_u32 v20, v3, 11, v4
    v_add_u32 v3, 2, v2
    v_xor_b32 v4, v3, v1
    v_lshlrev_b32 v4, 4, v4
    v_add_u32 v3, s46, v3
    v_lshl_add_u32 v21, v3, 11, v4
    v_add_u32 v3, 4, v2
    v_xor_b32 v4, v3, v1
    v_lshlrev_b32 v4, 4, v4
    v_add_u32 v3, s46, v3
    v_lshl_add_u32 v22, v3, 11, v4
    v_add_u32 v3, 6, v2
    v_xor_b32 v4, v3, v1
    v_lshlrev_b32 v4, 4, v4
    v_add_u32 v3, s46, v3
    v_lshl_add_u32 v23, v3, 11, v4
    v_add_u32 v3, 8, v2
    v_xor_b32 v4, v3, v1
    v_lshlrev_b32 v4, 4, v4
    v_add_u32 v3, s46, v3
    v_lshl_add_u32 v24, v3, 11, v4
    v_add_u32 v3, 10, v2
    v_xor_b32 v4, v3, v1
    v_lshlrev_b32 v4, 4, v4
    v_add_u32 v3, s46, v3
    v_lshl_add_u32 v25, v3, 11, v4
    v_add_u32 v3, 12, v2
    v_xor_b32 v4, v3, v1
    v_lshlrev_b32 v4, 4, v4
    v_add_u32 v3, s46, v3
    v_lshl_add_u32 v26, v3, 11, v4
    v_add_u32 v3, 14, v2
    v_xor_b32 v4, v3, v1
    v_lshlrev_b32 v4, 4, v4
    v_add_u32 v3, s46, v3
    v_lshl_add_u32 v27, v3, 11, v4
    v_and_b32 v1, 15, v0
    v_bfe_u32 v2, v0, 4, 2
    v_lshrrev_b32 v3, 6, v0
    v_lshlrev_b32 v3, 15, v3
    v_lshl_add_u32 v3, v1, 9, v3
    v_add_u32 v4, 0, v2
    v_xor_b32 v4, v4, v1
    v_lshl_add_u32 v28, v4, 4, v3
    v_add_u32 v4, 4, v2
    v_xor_b32 v4, v4, v1
    v_lshl_add_u32 v29, v4, 4, v3
    v_add_u32 v4, 8, v2
    v_xor_b32 v4, v4, v1
    v_lshl_add_u32 v30, v4, 4, v3
    v_add_u32 v4, 12, v2
    v_xor_b32 v4, v4, v1
    v_lshl_add_u32 v31, v4, 4, v3
    s_lshl_b32 s26, s49, 15
    s_barrier
    s_mov_b32 s27, 0
    s_add_u32 m0, s26, 0
    s_nop 0
    buffer_load_dwordx4 v20, s[16:19], s27 offen nt lds
    s_add_u32 m0, s26, 1024
    s_nop 0
    buffer_load_dwordx4 v21, s[16:19], s27 offen nt lds
    s_add_u32 m0, s26, 2048
    s_nop 0
    buffer_load_dwordx4 v22, s[16:19], s27 offen nt lds
    s_add_u32 m0, s26, 3072
    s_nop 0
    buffer_load_dwordx4 v23, s[16:19], s27 offen nt lds
    s_add_u32 m0, s26, 4096
    s_nop 0
    buffer_load_dwordx4 v24, s[16:19], s27 offen nt lds
    s_add_u32 m0, s26, 5120
    s_nop 0
    buffer_load_dwordx4 v25, s[16:19], s27 offen nt lds
    s_add_u32 m0, s26, 6144
    s_nop 0
    buffer_load_dwordx4 v26, s[16:19], s27 offen nt lds
    s_add_u32 m0, s26, 7168
    s_nop 0
    buffer_load_dwordx4 v27, s[16:19], s27 offen nt lds
    s_mov_b32 s27, 0
    s_add_u32 m0, s26, 8192
    s_nop 0
    buffer_load_dwordx4 v20, s[32:35], s27 offen nt lds
    s_add_u32 m0, s26, 9216
    s_nop 0
    buffer_load_dwordx4 v21, s[32:35], s27 offen nt lds
    s_add_u32 m0, s26, 10240
    s_nop 0
    buffer_load_dwordx4 v22, s[32:35], s27 offen nt lds
    s_add_u32 m0, s26, 11264
    s_nop 0
    buffer_load_dwordx4 v23, s[32:35], s27 offen nt lds
    s_add_u32 m0, s26, 12288
    s_nop 0
    buffer_load_dwordx4 v24, s[32:35], s27 offen nt lds
    s_add_u32 m0, s26, 13312
    s_nop 0
    buffer_load_dwordx4 v25, s[32:35], s27 offen nt lds
    s_add_u32 m0, s26, 14336
    s_nop 0
    buffer_load_dwordx4 v26, s[32:35], s27 offen nt lds
    s_add_u32 m0, s26, 15360
    s_nop 0
    buffer_load_dwordx4 v27, s[32:35], s27 offen nt lds
    s_mov_b32 s27, 512
    s_add_u32 m0, s26, 16384
    s_nop 0
    buffer_load_dwordx4 v20, s[16:19], s27 offen nt lds
    s_add_u32 m0, s26, 17408
    s_nop 0
    buffer_load_dwordx4 v21, s[16:19], s27 offen nt lds
    s_add_u32 m0, s26, 18432
    s_nop 0
    buffer_load_dwordx4 v22, s[16:19], s27 offen nt lds
    s_add_u32 m0, s26, 19456
    s_nop 0
    buffer_load_dwordx4 v23, s[16:19], s27 offen nt lds
    s_add_u32 m0, s26, 20480
    s_nop 0
    buffer_load_dwordx4 v24, s[16:19], s27 offen nt lds
    s_add_u32 m0, s26, 21504
    s_nop 0
    buffer_load_dwordx4 v25, s[16:19], s27 offen nt lds
    s_add_u32 m0, s26, 22528
    s_nop 0
    buffer_load_dwordx4 v26, s[16:19], s27 offen nt lds
    s_add_u32 m0, s26, 23552
    s_nop 0
    buffer_load_dwordx4 v27, s[16:19], s27 offen nt lds
    s_mov_b32 s27, 512
    s_add_u32 m0, s26, 24576
    s_nop 0
    buffer_load_dwordx4 v20, s[32:35], s27 offen nt lds
    s_add_u32 m0, s26, 25600
    s_nop 0
    buffer_load_dwordx4 v21, s[32:35], s27 offen nt lds
    s_add_u32 m0, s26, 26624
    s_nop 0
    buffer_load_dwordx4 v22, s[32:35], s27 offen nt lds
    s_add_u32 m0, s26, 27648
    s_nop 0
    buffer_load_dwordx4 v23, s[32:35], s27 offen nt lds
    s_add_u32 m0, s26, 28672
    s_nop 0
    buffer_load_dwordx4 v24, s[32:35], s27 offen nt lds
    s_add_u32 m0, s26, 29696
    s_nop 0
    buffer_load_dwordx4 v25, s[32:35], s27 offen nt lds
    s_add_u32 m0, s26, 30720
    s_nop 0
    buffer_load_dwordx4 v26, s[32:35], s27 offen nt lds
    s_add_u32 m0, s26, 31744
    s_nop 0
    buffer_load_dwordx4 v27, s[32:35], s27 offen nt lds
    s_waitcnt vmcnt(16)
    ds_read_b128 a[0:3], v28 offset:0
    ds_read_b128 a[4:7], v28 offset:8192
    ds_read_b128 a[8:11], v29 offset:0
    ds_read_b128 a[12:15], v29 offset:8192
    ds_read_b128 a[16:19], v30 offset:0
    ds_read_b128 a[20:23], v30 offset:8192
    ds_read_b128 a[24:27], v31 offset:0
    ds_read_b128 a[28:31], v31 offset:8192
    s_waitcnt lgkmcnt(0)
    ds_read_b128 a[32:35], v28 offset:256
    ds_read_b128 a[36:39], v28 offset:8448
    ds_read_b128 a[40:43], v29 offset:256
    ds_read_b128 a[44:47], v29 offset:8448
    ds_read_b128 a[48:51], v30 offset:256
    ds_read_b128 a[52:55], v30 offset:8448
    ds_read_b128 a[56:59], v31 offset:256
    ds_read_b128 a[60:63], v31 offset:8448
    s_waitcnt lgkmcnt(0)
    s_mov_b32 s27, 1024
    s_add_u32 m0, s26, 0
    s_nop 0
    buffer_load_dwordx4 v20, s[16:19], s27 offen nt lds
    s_add_u32 m0, s26, 1024
    s_nop 0
    buffer_load_dwordx4 v21, s[16:19], s27 offen nt lds
    s_add_u32 m0, s26, 2048
    s_nop 0
    buffer_load_dwordx4 v22, s[16:19], s27 offen nt lds
    s_add_u32 m0, s26, 3072
    s_nop 0
    buffer_load_dwordx4 v23, s[16:19], s27 offen nt lds
    s_add_u32 m0, s26, 4096
    s_nop 0
    buffer_load_dwordx4 v24, s[16:19], s27 offen nt lds
    s_add_u32 m0, s26, 5120
    s_nop 0
    buffer_load_dwordx4 v25, s[16:19], s27 offen nt lds
    s_add_u32 m0, s26, 6144
    s_nop 0
    buffer_load_dwordx4 v26, s[16:19], s27 offen nt lds
    s_add_u32 m0, s26, 7168
    s_nop 0
    buffer_load_dwordx4 v27, s[16:19], s27 offen nt lds
    s_mov_b32 s27, 1024
    s_add_u32 m0, s26, 8192
    s_nop 0
    buffer_load_dwordx4 v20, s[32:35], s27 offen nt lds
    s_add_u32 m0, s26, 9216
    s_nop 0
    buffer_load_dwordx4 v21, s[32:35], s27 offen nt lds
    s_add_u32 m0, s26, 10240
    s_nop 0
    buffer_load_dwordx4 v22, s[32:35], s27 offen nt lds
    s_add_u32 m0, s26, 11264
    s_nop 0
    buffer_load_dwordx4 v23, s[32:35], s27 offen nt lds
    s_add_u32 m0, s26, 12288
    s_nop 0
    buffer_load_dwordx4 v24, s[32:35], s27 offen nt lds
    s_add_u32 m0, s26, 13312
    s_nop 0
    buffer_load_dwordx4 v25, s[32:35], s27 offen nt lds
    s_add_u32 m0, s26, 14336
    s_nop 0
    buffer_load_dwordx4 v26, s[32:35], s27 offen nt lds
    s_add_u32 m0, s26, 15360
    s_nop 0
    buffer_load_dwordx4 v27, s[32:35], s27 offen nt lds
    s_waitcnt vmcnt(16)
    ds_read_b128 a[64:67], v28 offset:16384
    ds_read_b128 a[68:71], v28 offset:24576
    ds_read_b128 a[72:75], v29 offset:16384
    ds_read_b128 a[76:79], v29 offset:24576
    ds_read_b128 a[80:83], v30 offset:16384
    ds_read_b128 a[84:87], v30 offset:24576
    ds_read_b128 a[88:91], v31 offset:16384
    ds_read_b128 a[92:95], v31 offset:24576
    s_waitcnt lgkmcnt(0)
    ds_read_b128 a[96:99], v28 offset:16640
    ds_read_b128 a[100:103], v28 offset:24832
    ds_read_b128 a[104:107], v29 offset:16640
    ds_read_b128 a[108:111], v29 offset:24832
    ds_read_b128 a[112:115], v30 offset:16640
    ds_read_b128 a[116:119], v30 offset:24832
    ds_read_b128 a[120:123], v31 offset:16640
    ds_read_b128 a[124:127], v31 offset:24832
    s_waitcnt lgkmcnt(0)
    s_mov_b32 s27, 1536
    s_add_u32 m0, s26, 16384
    s_nop 0
    buffer_load_dwordx4 v20, s[16:19], s27 offen nt lds
    s_add_u32 m0, s26, 17408
    s_nop 0
    buffer_load_dwordx4 v21, s[16:19], s27 offen nt lds
    s_add_u32 m0, s26, 18432
    s_nop 0
    buffer_load_dwordx4 v22, s[16:19], s27 offen nt lds
    s_add_u32 m0, s26, 19456
    s_nop 0
    buffer_load_dwordx4 v23, s[16:19], s27 offen nt lds
    s_add_u32 m0, s26, 20480
    s_nop 0
    buffer_load_dwordx4 v24, s[16:19], s27 offen nt lds
    s_add_u32 m0, s26, 21504
    s_nop 0
    buffer_load_dwordx4 v25, s[16:19], s27 offen nt lds
    s_add_u32 m0, s26, 22528
    s_nop 0
    buffer_load_dwordx4 v26, s[16:19], s27 offen nt lds
    s_add_u32 m0, s26, 23552
    s_nop 0
    buffer_load_dwordx4 v27, s[16:19], s27 offen nt lds
    s_mov_b32 s27, 1536
    s_add_u32 m0, s26, 24576
    s_nop 0
    buffer_load_dwordx4 v20, s[32:35], s27 offen nt lds
    s_add_u32 m0, s26, 25600
    s_nop 0
    buffer_load_dwordx4 v21, s[32:35], s27 offen nt lds
    s_add_u32 m0, s26, 26624
    s_nop 0
    buffer_load_dwordx4 v22, s[32:35], s27 offen nt lds
    s_add_u32 m0, s26, 27648
    s_nop 0
    buffer_load_dwordx4 v23, s[32:35], s27 offen nt lds
    s_add_u32 m0, s26, 28672
    s_nop 0
    buffer_load_dwordx4 v24, s[32:35], s27 offen nt lds
    s_add_u32 m0, s26, 29696
    s_nop 0
    buffer_load_dwordx4 v25, s[32:35], s27 offen nt lds
    s_add_u32 m0, s26, 30720
    s_nop 0
    buffer_load_dwordx4 v26, s[32:35], s27 offen nt lds
    s_add_u32 m0, s26, 31744
    s_nop 0
    buffer_load_dwordx4 v27, s[32:35], s27 offen nt lds
    s_waitcnt vmcnt(16)
    ds_read_b128 a[128:131], v28 offset:0
    ds_read_b128 a[132:135], v28 offset:8192
    ds_read_b128 a[136:139], v29 offset:0
    ds_read_b128 a[140:143], v29 offset:8192
    ds_read_b128 a[144:147], v30 offset:0
    ds_read_b128 a[148:151], v30 offset:8192
    ds_read_b128 a[152:155], v31 offset:0
    ds_read_b128 a[156:159], v31 offset:8192
    s_waitcnt lgkmcnt(0)
    ds_read_b128 a[160:163], v28 offset:256
    ds_read_b128 a[164:167], v28 offset:8448
    ds_read_b128 a[168:171], v29 offset:256
    ds_read_b128 a[172:175], v29 offset:8448
    ds_read_b128 a[176:179], v30 offset:256
    ds_read_b128 a[180:183], v30 offset:8448
    ds_read_b128 a[184:187], v31 offset:256
    ds_read_b128 a[188:191], v31 offset:8448
    s_waitcnt lgkmcnt(0)
    s_waitcnt vmcnt(0)
    ds_read_b128 a[192:195], v28 offset:16384
    ds_read_b128 a[196:199], v28 offset:24576
    ds_read_b128 a[200:203], v29 offset:16384
    ds_read_b128 a[204:207], v29 offset:24576
    ds_read_b128 a[208:211], v30 offset:16384
    ds_read_b128 a[212:215], v30 offset:24576
    ds_read_b128 a[216:219], v31 offset:16384
    ds_read_b128 a[220:223], v31 offset:24576
    s_waitcnt lgkmcnt(0)
    ds_read_b128 a[224:227], v28 offset:16640
    ds_read_b128 a[228:231], v28 offset:24832
    ds_read_b128 a[232:235], v29 offset:16640
    ds_read_b128 a[236:239], v29 offset:24832
    ds_read_b128 a[240:243], v30 offset:16640
    ds_read_b128 a[244:247], v30 offset:24832
    ds_read_b128 a[248:251], v31 offset:16640
    ds_read_b128 a[252:255], v31 offset:24832
    s_waitcnt lgkmcnt(0)
    v_lshlrev_b32 v128, 16, v128
    v_lshlrev_b32 v129, 16, v129
    v_lshlrev_b32 v130, 16, v130
    v_mul_f32 v131, 0x3fb8aa3b, v130
    v_exp_f32 v131, v131
    s_nop 0
    v_cvt_pk_bf16_f32 v131, 0, v131
    v_mul_f32 v132, v131, v128
    v_mul_f32 v133, v131, v129
    v_mul_f32 v132, 0x3fb8aa3b, v132
    v_exp_f32 v132, v132
    v_mul_f32 v133, 0x3e22f983, v133
    v_fract_f32 v133, v133
    v_cos_f32 v134, v133
    v_sin_f32 v133, v133
    s_nop 0
    v_mul_f32 v88, v132, v134
    v_mul_f32 v89, v132, v133
    v_add_f32 v131, -1.0, v88
    v_mul_f32 v132, v131, v128
    v_fma_f32 v132, v89, v129, v132
    v_mul_f32 v133, v89, v128
    v_fma_f32 v133, -v131, v129, v133
    v_mul_f32 v134, v128, v128
    v_fma_f32 v134, v129, v129, v134
    v_rcp_f32 v134, v134
    s_nop 0
    v_add_f32 v134, v134, v134
    v_mul_f32 v90, v132, v134
    v_mul_f32 v91, v133, v134
    v_mov_b32 v92, v88
    v_mov_b32 v93, v89
    v_mul_f32 v131, v93, v93
    v_mul_f32 v93, v92, v93
    v_fma_f32 v92, v92, v92, -v131
    v_add_f32 v93, v93, v93
    v_mul_f32 v131, v93, v93
    v_mul_f32 v93, v92, v93
    v_fma_f32 v92, v92, v92, -v131
    v_add_f32 v93, v93, v93
    v_mul_f32 v131, v93, v93
    v_mul_f32 v93, v92, v93
    v_fma_f32 v92, v92, v92, -v131
    v_add_f32 v93, v93, v93
    v_xor_b32 v152, 0x80000000, v89
    v_xor_b32 v153, 0x80000000, v93
    v_xor_b32 v154, 0x80000000, v90
    v_xor_b32 v155, 0x80000000, v91
    v_mul_f32 v156, v88, v90
    v_mul_f32 v157, v88, v91
    v_fmac_f32 v156, v152, v91
    v_fmac_f32 v157, v89, v90
    v_mul_f32 v158, v88, v156
    v_mul_f32 v159, v88, v157
    v_fmac_f32 v158, v152, v157
    v_fmac_f32 v159, v89, v156
    v_mul_f32 v160, v88, v158
    v_mul_f32 v161, v88, v159
    v_fmac_f32 v160, v152, v159
    v_fmac_f32 v161, v89, v158
    v_mul_f32 v162, v88, v160
    v_mul_f32 v163, v88, v161
    v_fmac_f32 v162, v152, v161
    v_fmac_f32 v163, v89, v160
    v_mul_f32 v164, v88, v162
    v_mul_f32 v165, v88, v163
    v_fmac_f32 v164, v152, v163
    v_fmac_f32 v165, v89, v162
    v_mul_f32 v166, v88, v164
    v_mul_f32 v167, v88, v165
    v_fmac_f32 v166, v152, v165
    v_fmac_f32 v167, v89, v164
    v_mul_f32 v168, v88, v166
    v_mul_f32 v169, v88, v167
    v_fmac_f32 v168, v152, v167
    v_fmac_f32 v169, v89, v166
    v_mul_f32 v170, v88, v168
    v_mul_f32 v171, v88, v169
    v_fmac_f32 v170, v152, v169
    v_fmac_f32 v171, v89, v168
    v_mov_b32 v94, 0
    v_mov_b32 v95, 0
    v_mov_b32 v68, 0
    v_mov_b32 v69, 0
    v_mov_b32 v70, 0
    v_mov_b32 v71, 0
    v_mov_b32 v72, 0
    v_mov_b32 v73, 0
    v_mov_b32 v74, 0
    v_mov_b32 v75, 0
    v_mov_b32 v76, 0
    v_mov_b32 v77, 0
    v_mov_b32 v78, 0
    v_mov_b32 v79, 0
    v_mov_b32 v80, 0
    v_mov_b32 v81, 0
    v_mov_b32 v82, 0
    v_mov_b32 v83, 0
    s_lshl_b32 s21, s49, 12
    v_and_b32 v1, 63, v0
    v_and_b32 v2, 15, v0
    v_bfe_u32 v3, v0, 4, 2
    v_lshrrev_b32 v4, 6, v0
    v_lshrrev_b32 v5, 5, v1
    v_lshl_add_u32 v5, v4, 3, v5
    v_add_u32 v5, 0, v5
    v_and_b32 v6, 3, v5
    v_lshrrev_b32 v7, 3, v5
    v_lshl_add_u32 v6, v7, 2, v6
    v_and_b32 v7, 31, v1
    v_xor_b32 v6, v6, v7
    v_lshlrev_b32 v6, 4, v6
    v_lshl_add_u32 v8, v5, 11, v6
    v_lshrrev_b32 v5, 5, v1
    v_lshl_add_u32 v5, v4, 3, v5
    v_add_u32 v5, 2, v5
    v_and_b32 v6, 3, v5
    v_lshrrev_b32 v7, 3, v5
    v_lshl_add_u32 v6, v7, 2, v6
    v_and_b32 v7, 31, v1
    v_xor_b32 v6, v6, v7
    v_lshlrev_b32 v6, 4, v6
    v_lshl_add_u32 v9, v5, 11, v6
    v_lshrrev_b32 v5, 5, v1
    v_lshl_add_u32 v5, v4, 3, v5
    v_add_u32 v5, 4, v5
    v_and_b32 v6, 3, v5
    v_lshrrev_b32 v7, 3, v5
    v_lshl_add_u32 v6, v7, 2, v6
    v_and_b32 v7, 31, v1
    v_xor_b32 v6, v6, v7
    v_lshlrev_b32 v6, 4, v6
    v_lshl_add_u32 v10, v5, 11, v6
    v_lshrrev_b32 v5, 5, v1
    v_lshl_add_u32 v5, v4, 3, v5
    v_add_u32 v5, 6, v5
    v_and_b32 v6, 3, v5
    v_lshrrev_b32 v7, 3, v5
    v_lshl_add_u32 v6, v7, 2, v6
    v_and_b32 v7, 31, v1
    v_xor_b32 v6, v6, v7
    v_lshlrev_b32 v6, 4, v6
    v_lshl_add_u32 v11, v5, 11, v6
    v_and_b32 v5, 12, v2
    v_add_u32 v5, v5, v2
    v_add_u32 v6, 0, v3
    v_xor_b32 v6, v6, v2
    v_lshlrev_b32 v6, 4, v6
    v_lshl_add_u32 v12, v5, 9, v6
    v_add_u32 v6, 4, v3
    v_xor_b32 v6, v6, v2
    v_lshlrev_b32 v6, 4, v6
    v_lshl_add_u32 v13, v5, 9, v6
    v_add_u32 v6, 8, v3
    v_xor_b32 v6, v6, v2
    v_lshlrev_b32 v6, 4, v6
    v_lshl_add_u32 v14, v5, 9, v6
    v_add_u32 v6, 12, v3
    v_xor_b32 v6, v6, v2
    v_lshlrev_b32 v6, 4, v6
    v_lshl_add_u32 v15, v5, 9, v6
    v_add_u32 v16, 0x10000, v12
    v_add_u32 v17, 0x10000, v13
    v_add_u32 v18, 0x10000, v14
    v_add_u32 v19, 0x10000, v15
    s_mov_b32 s32, s98
    s_and_b32 s33, s99, 0xffff
    s_mov_b32 s34, 0x100
    s_mov_b32 s35, 0x00020000
    s_mov_b32 s25, 0
    v_mov_b32 v2, 0
L_pl_234:
    buffer_load_dword v1, v2, s[32:35], s25 offen sc1
    s_add_u32 s36, s36, 1
    s_cmp_gt_u32 s36, 0x100000
    s_cbranch_scc1 chain_kernel_wend
    s_waitcnt vmcnt(0)
    v_readfirstlane_b32 s26, v1
    s_and_b32 s27, s26, 0xffff
    s_cmp_ge_u32 s27, 256
    s_cbranch_scc1 L_plok_235
    s_sleep 4
    s_branch L_pl_234
L_plok_235:
    s_lshr_b32 s25, s26, 16
    s_cmp_gt_u32 s25, 64
    s_cselect_b32 s25, 0x2000, 0x0
    s_add_u32 s54, s100, 0x1fffff
    s_and_b32 s54, s54, 0xffe00000
    s_sub_u32 s55, s54, s100
    s_add_u32 s54, s55, s25
    s_xor_b32 s25, s25, 0x2000
    s_add_u32 s55, s55, s25
    s_mov_b32 s56, 0xffff0000
    s_mov_b32 s57, 0xffffffff
    s_mov_b32 s58, 0x0
    s_mov_b32 s59, 0xffffffff
    s_mov_b32 s60, 0x0
    s_mov_b32 s61, 0xffff0000
    s_mov_b32 s22, 0
    s_mov_b32 s24, 0
    s_mov_b32 s20, 0
    s_mov_b32 s37, 0
    s_mov_b32 s23, 64
    s_mov_b32 s38, 0x7ff00000
    s_mov_b32 s39, 0x7ff00000
    s_mov_b32 s43, 0x7ff00000
    s_barrier
    s_add_u32 m0, s21, 0
    s_nop 0
    buffer_load_dwordx4 v8, s[8:11], s20 offen lds
    s_add_u32 m0, s21, 1024
    s_nop 0
    buffer_load_dwordx4 v9, s[8:11], s20 offen lds
    s_add_u32 m0, s21, 2048
    s_nop 0
    buffer_load_dwordx4 v10, s[8:11], s20 offen lds
    s_add_u32 m0, s21, 3072
    s_nop 0
    buffer_load_dwordx4 v11, s[8:11], s20 offen lds
    s_add_u32 s20, s20, 512
    s_add_u32 m0, s21, 16384
    s_nop 0
    buffer_load_dwordx4 v8, s[8:11], s20 offen lds
    s_add_u32 m0, s21, 17408
    s_nop 0
    buffer_load_dwordx4 v9, s[8:11], s20 offen lds
    s_add_u32 m0, s21, 18432
    s_nop 0
    buffer_load_dwordx4 v10, s[8:11], s20 offen lds
    s_add_u32 m0, s21, 19456
    s_nop 0
    buffer_load_dwordx4 v11, s[8:11], s20 offen lds
    s_add_u32 s20, s20, 512
    s_add_u32 m0, s21, 32768
    s_nop 0
    buffer_load_dwordx4 v8, s[8:11], s20 offen lds
    s_add_u32 m0, s21, 33792
    s_nop 0
    buffer_load_dwordx4 v9, s[8:11], s20 offen lds
    s_add_u32 m0, s21, 34816
    s_nop 0
    buffer_load_dwordx4 v10, s[8:11], s20 offen lds
    s_add_u32 m0, s21, 35840
    s_nop 0
    buffer_load_dwordx4 v11, s[8:11], s20 offen lds
    s_add_u32 s20, s20, 512
    s_add_u32 m0, s21, 49152
    s_nop 0
    buffer_load_dwordx4 v8, s[8:11], s20 offen lds
    s_add_u32 m0, s21, 50176
    s_nop 0
    buffer_load_dwordx4 v9, s[8:11], s20 offen lds
    s_add_u32 m0, s21, 51200
    s_nop 0
    buffer_load_dwordx4 v10, s[8:11], s20 offen lds
    s_add_u32 m0, s21, 52224
    s_nop 0
    buffer_load_dwordx4 v11, s[8:11], s20 offen lds
    s_add_u32 s24, s24, 1
    s_min_u32 s24, s24, 63
    s_lshl_b32 s53, s24, 16
    s_mov_b32 s20, s53
    s_add_u32 m0, s21, 65536
    s_nop 0
    buffer_load_dwordx4 v8, s[8:11], s20 offen lds
    s_add_u32 m0, s21, 66560
    s_nop 0
    buffer_load_dwordx4 v9, s[8:11], s20 offen lds
    s_add_u32 m0, s21, 67584
    s_nop 0
    buffer_load_dwordx4 v10, s[8:11], s20 offen lds
    s_add_u32 m0, s21, 68608
    s_nop 0
    buffer_load_dwordx4 v11, s[8:11], s20 offen lds
    s_add_u32 s20, s20, 512
    s_add_u32 m0, s21, 81920
    s_nop 0
    buffer_load_dwordx4 v8, s[8:11], s20 offen lds
    s_add_u32 m0, s21, 82944
    s_nop 0
    buffer_load_dwordx4 v9, s[8:11], s20 offen lds
    s_add_u32 m0, s21, 83968
    s_nop 0
    buffer_load_dwordx4 v10, s[8:11], s20 offen lds
    s_add_u32 m0, s21, 84992
    s_nop 0
    buffer_load_dwordx4 v11, s[8:11], s20 offen lds
    s_add_u32 s20, s20, 512
    s_add_u32 m0, s21, 98304
    s_nop 0
    buffer_load_dwordx4 v8, s[8:11], s20 offen lds
    s_waitcnt vmcnt(21)
    s_barrier
    ds_read_b128 v[20:23], v12 offset:0
    ds_read_b128 v[24:27], v12 offset:2048
    ds_read_b128 v[28:31], v13 offset:0
    ds_read_b128 v[32:35], v13 offset:2048
    ds_read_b128 v[36:39], v14 offset:0
    ds_read_b128 v[40:43], v14 offset:2048
    s_waitcnt lgkmcnt(4)
L_st_239:
    v_mfma_f32_16x16x32_bf16 v[52:55], v[20:23], a[0:3], 0
    ds_read_b128 v[44:47], v15 offset:0
    s_add_u32 m0, s21, 99328
    v_mfma_f32_16x16x32_bf16 v[56:59], v[20:23], a[4:7], 0
    buffer_load_dwordx4 v9, s[8:11], s20 offen lds
    v_mfma_f32_16x16x32_bf16 v[60:63], v[24:27], a[0:3], 0
    ds_read_b128 v[48:51], v15 offset:2048
    v_mfma_f32_16x16x32_bf16 v[64:67], v[24:27], a[4:7], 0
    s_waitcnt lgkmcnt(4)
    v_fmac_f32 v69, v88, v68
    v_fmac_f32 v73, v88, v72
    v_mfma_f32_16x16x32_bf16 v[52:55], v[28:31], a[8:11], v[52:55]
    ds_read_b128 v[20:23], v12 offset:256
    s_waitcnt lgkmcnt(7)
    v_mul_f32 v128, v90, v68
    v_mfma_f32_16x16x32_bf16 v[56:59], v[28:31], a[12:15], v[56:59]
    buffer_store_dwordx4 v[144:147], v86, s[12:15], s38 offen sc1
    v_mfma_f32_16x16x32_bf16 v[60:63], v[32:35], a[8:11], v[60:63]
    ds_read_b128 v[24:27], v12 offset:2304
    v_mul_f32 v136, v154, v72
    v_fmac_f32 v69, v152, v72
    v_mfma_f32_16x16x32_bf16 v[64:67], v[32:35], a[12:15], v[64:67]
    s_waitcnt lgkmcnt(4)
    v_fmac_f32 v73, v89, v68
    v_mfma_f32_16x16x32_bf16 v[52:55], v[36:39], a[16:19], v[52:55]
    ds_read_b128 v[28:31], v13 offset:256
    s_add_u32 m0, s21, 100352
    v_fmac_f32 v128, v155, v72
    v_mfma_f32_16x16x32_bf16 v[56:59], v[36:39], a[20:23], v[56:59]
    buffer_load_dwordx4 v10, s[8:11], s20 offen lds
    v_fmac_f32 v136, v155, v68
    v_mfma_f32_16x16x32_bf16 v[60:63], v[40:43], a[16:19], v[60:63]
    ds_read_b128 v[32:35], v13 offset:2304
    v_fmac_f32 v70, v88, v69
    v_mfma_f32_16x16x32_bf16 v[64:67], v[40:43], a[20:23], v[64:67]
    s_waitcnt lgkmcnt(4)
    v_fmac_f32 v74, v88, v73
    v_mul_f32 v129, v90, v69
    v_mfma_f32_16x16x32_bf16 v[52:55], v[44:47], a[24:27], v[52:55]
    ds_read_b128 v[36:39], v14 offset:256
    v_mul_f32 v137, v154, v73
    v_mfma_f32_16x16x32_bf16 v[56:59], v[44:47], a[28:31], v[56:59]
    buffer_store_dwordx4 v[148:151], v86, s[12:15], s43 offen sc1
    v_fmac_f32 v70, v152, v73
    v_mfma_f32_16x16x32_bf16 v[60:63], v[48:51], a[24:27], v[60:63]
    ds_read_b128 v[40:43], v14 offset:2304
    v_fmac_f32 v74, v89, v69
    v_mfma_f32_16x16x32_bf16 v[64:67], v[48:51], a[28:31], v[64:67]
    s_waitcnt lgkmcnt(4)
    v_fmac_f32 v129, v155, v73
    v_fmac_f32 v137, v155, v69
    v_mfma_f32_16x16x32_bf16 v[52:55], v[20:23], a[32:35], v[52:55]
    ds_read_b128 v[44:47], v15 offset:256
    s_add_u32 m0, s21, 101376
    v_fmac_f32 v71, v88, v70
    v_mfma_f32_16x16x32_bf16 v[56:59], v[20:23], a[36:39], v[56:59]
    buffer_load_dwordx4 v11, s[8:11], s20 offen lds
    v_mfma_f32_16x16x32_bf16 v[60:63], v[24:27], a[32:35], v[60:63]
    ds_read_b128 v[48:51], v15 offset:2304
    v_fmac_f32 v75, v88, v74
    v_mul_f32 v130, v90, v70
    v_mfma_f32_16x16x32_bf16 v[64:67], v[24:27], a[36:39], v[64:67]
    s_waitcnt lgkmcnt(4)
    v_mul_f32 v138, v154, v74
    v_mfma_f32_16x16x32_bf16 v[52:55], v[28:31], a[40:43], v[52:55]
    s_waitcnt vmcnt(20)
    s_barrier
    ds_read_b128 v[20:23], v12 offset:16384
    v_mfma_f32_16x16x32_bf16 v[56:59], v[28:31], a[44:47], v[56:59]
    s_add_u32 s20, s20, 512
    v_fmac_f32 v71, v152, v74
    v_fmac_f32 v75, v89, v70
    v_mfma_f32_16x16x32_bf16 v[60:63], v[32:35], a[40:43], v[60:63]
    ds_read_b128 v[24:27], v12 offset:18432
    v_fmac_f32 v130, v155, v74
    v_mfma_f32_16x16x32_bf16 v[64:67], v[32:35], a[44:47], v[64:67]
    s_waitcnt lgkmcnt(4)
    v_fmac_f32 v138, v155, v70
    v_fmac_f32 v76, v88, v71
    v_mfma_f32_16x16x32_bf16 v[52:55], v[36:39], a[48:51], v[52:55]
    ds_read_b128 v[28:31], v13 offset:16384
    s_add_u32 m0, s21, 114688
    v_mfma_f32_16x16x32_bf16 v[56:59], v[36:39], a[52:55], v[56:59]
    buffer_load_dwordx4 v8, s[8:11], s20 offen lds
    v_fmac_f32 v80, v88, v75
    v_mfma_f32_16x16x32_bf16 v[60:63], v[40:43], a[48:51], v[60:63]
    ds_read_b128 v[32:35], v13 offset:18432
    v_mul_f32 v131, v90, v71
    v_mul_f32 v139, v154, v75
    v_mfma_f32_16x16x32_bf16 v[64:67], v[40:43], a[52:55], v[64:67]
    s_waitcnt lgkmcnt(4)
    v_fmac_f32 v76, v152, v75
    v_mfma_f32_16x16x32_bf16 v[52:55], v[44:47], a[56:59], v[52:55]
    ds_read_b128 v[36:39], v14 offset:16384
    v_fmac_f32 v80, v89, v71
    v_fmac_f32 v131, v155, v75
    v_mfma_f32_16x16x32_bf16 v[56:59], v[44:47], a[60:63], v[56:59]
    v_fmac_f32 v139, v155, v71
    v_fmac_f32 v77, v88, v76
    v_mfma_f32_16x16x32_bf16 v[60:63], v[48:51], a[56:59], v[60:63]
    ds_read_b128 v[40:43], v14 offset:18432
    v_fmac_f32 v81, v88, v80
    v_mfma_f32_16x16x32_bf16 v[64:67], v[48:51], a[60:63], v[64:67]
    s_waitcnt lgkmcnt(4)
    v_mul_f32 v132, v90, v76
    v_mul_f32 v140, v154, v80
    v_mfma_f32_16x16x32_bf16 v[52:55], v[20:23], a[64:67], v[52:55]
    ds_read_b128 v[44:47], v15 offset:16384
    s_add_u32 m0, s21, 115712
    v_mfma_f32_16x16x32_bf16 v[56:59], v[20:23], a[68:71], v[56:59]
    buffer_load_dwordx4 v9, s[8:11], s20 offen lds
    v_fmac_f32 v77, v152, v80
    v_mfma_f32_16x16x32_bf16 v[60:63], v[24:27], a[64:67], v[60:63]
    ds_read_b128 v[48:51], v15 offset:18432
    v_fmac_f32 v81, v89, v76
    v_fmac_f32 v132, v155, v80
    v_mfma_f32_16x16x32_bf16 v[64:67], v[24:27], a[68:71], v[64:67]
    s_waitcnt lgkmcnt(4)
    v_fmac_f32 v140, v155, v76
    v_mfma_f32_16x16x32_bf16 v[52:55], v[28:31], a[72:75], v[52:55]
    ds_read_b128 v[20:23], v12 offset:16640
    v_fmac_f32 v78, v88, v77
    v_fmac_f32 v82, v88, v81
    v_mfma_f32_16x16x32_bf16 v[56:59], v[28:31], a[76:79], v[56:59]
    v_mul_f32 v133, v90, v77
    v_mul_f32 v141, v154, v81
    v_mfma_f32_16x16x32_bf16 v[60:63], v[32:35], a[72:75], v[60:63]
    ds_read_b128 v[24:27], v12 offset:18688
    s_add_u32 s24, s24, 1
    v_fmac_f32 v78, v152, v81
    v_mfma_f32_16x16x32_bf16 v[64:67], v[32:35], a[76:79], v[64:67]
    s_waitcnt lgkmcnt(4)
    v_fmac_f32 v82, v89, v77
    v_mfma_f32_16x16x32_bf16 v[52:55], v[36:39], a[80:83], v[52:55]
    ds_read_b128 v[28:31], v13 offset:16640
    s_add_u32 m0, s21, 116736
    v_fmac_f32 v133, v155, v81
    v_mfma_f32_16x16x32_bf16 v[56:59], v[36:39], a[84:87], v[56:59]
    buffer_load_dwordx4 v10, s[8:11], s20 offen lds
    v_mfma_f32_16x16x32_bf16 v[60:63], v[40:43], a[80:83], v[60:63]
    ds_read_b128 v[32:35], v13 offset:18688
    v_fmac_f32 v141, v155, v77
    v_fmac_f32 v79, v88, v78
    v_mfma_f32_16x16x32_bf16 v[64:67], v[40:43], a[84:87], v[64:67]
    s_waitcnt lgkmcnt(4)
    s_min_u32 s24, s24, 63
    v_fmac_f32 v83, v88, v82
    v_mfma_f32_16x16x32_bf16 v[52:55], v[44:47], a[88:91], v[52:55]
    ds_read_b128 v[36:39], v14 offset:16640
    v_mul_f32 v134, v90, v78
    v_mfma_f32_16x16x32_bf16 v[56:59], v[44:47], a[92:95], v[56:59]
    v_mul_f32 v142, v154, v82
    v_fmac_f32 v79, v152, v82
    v_mfma_f32_16x16x32_bf16 v[60:63], v[48:51], a[88:91], v[60:63]
    ds_read_b128 v[40:43], v14 offset:18688
    s_lshl_b32 s53, s24, 16
    v_fmac_f32 v83, v89, v78
    v_mfma_f32_16x16x32_bf16 v[64:67], v[48:51], a[92:95], v[64:67]
    s_waitcnt lgkmcnt(4)
    v_fmac_f32 v134, v155, v82
    v_fmac_f32 v142, v155, v78
    v_mfma_f32_16x16x32_bf16 v[52:55], v[20:23], a[96:99], v[52:55]
    ds_read_b128 v[44:47], v15 offset:16640
    s_add_u32 m0, s21, 117760
    v_mfma_f32_16x16x32_bf16 v[56:59], v[20:23], a[100:103], v[56:59]
    buffer_load_dwordx4 v11, s[8:11], s20 offen lds
    v_mov_b32 v102, v79
    v_mfma_f32_16x16x32_bf16 v[60:63], v[24:27], a[96:99], v[60:63]
    ds_read_b128 v[48:51], v15 offset:18688
    v_mov_b32 v103, v79
    v_mfma_f32_16x16x32_bf16 v[64:67], v[24:27], a[100:103], v[64:67]
    s_waitcnt lgkmcnt(4)
    v_mov_b32 v106, v83
    v_mov_b32 v107, v83
    v_mfma_f32_16x16x32_bf16 v[52:55], v[28:31], a[104:107], v[52:55]
    s_waitcnt vmcnt(20)
    s_barrier
    ds_read_b128 v[20:23], v12 offset:32768
    v_mfma_f32_16x16x32_bf16 v[56:59], v[28:31], a[108:111], v[56:59]
    s_mov_b32 s20, s53
    v_mul_f32 v135, v90, v79
    v_mfma_f32_16x16x32_bf16 v[60:63], v[32:35], a[104:107], v[60:63]
    ds_read_b128 v[24:27], v12 offset:34816
    v_mul_f32 v143, v154, v83
    v_permlane16_swap_b32 v102, v103
    v_mfma_f32_16x16x32_bf16 v[64:67], v[32:35], a[108:111], v[64:67]
    s_waitcnt lgkmcnt(4)
    v_permlane16_swap_b32 v106, v107
    v_mfma_f32_16x16x32_bf16 v[52:55], v[36:39], a[112:115], v[52:55]
    ds_read_b128 v[28:31], v13 offset:32768
    s_add_u32 m0, s21, 0
    v_mov_b32 v104, v102
    v_mfma_f32_16x16x32_bf16 v[56:59], v[36:39], a[116:119], v[56:59]
    buffer_load_dwordx4 v8, s[8:11], s20 offen lds
    v_mov_b32 v105, v103
    v_mfma_f32_16x16x32_bf16 v[60:63], v[40:43], a[112:115], v[60:63]
    ds_read_b128 v[32:35], v13 offset:34816
    v_mov_b32 v108, v106
    v_mfma_f32_16x16x32_bf16 v[64:67], v[40:43], a[116:119], v[64:67]
    s_waitcnt lgkmcnt(4)
    v_mov_b32 v109, v107
    v_fmac_f32 v135, v155, v83
    v_mfma_f32_16x16x32_bf16 v[52:55], v[44:47], a[120:123], v[52:55]
    ds_read_b128 v[36:39], v14 offset:32768
    v_fmac_f32 v143, v155, v79
    v_mfma_f32_16x16x32_bf16 v[56:59], v[44:47], a[124:127], v[56:59]
    v_permlane32_swap_b32 v102, v104
    v_permlane32_swap_b32 v103, v105
    v_mfma_f32_16x16x32_bf16 v[60:63], v[48:51], a[120:123], v[60:63]
    ds_read_b128 v[40:43], v14 offset:34816
    v_permlane32_swap_b32 v106, v108
    v_permlane32_swap_b32 v107, v109
    v_mfma_f32_16x16x32_bf16 v[64:67], v[48:51], a[124:127], v[64:67]
    s_waitcnt lgkmcnt(4)
    v_fmac_f32 v102, v92, v94
    v_mfma_f32_16x16x32_bf16 v[52:55], v[20:23], a[128:131], v[52:55]
    ds_read_b128 v[44:47], v15 offset:32768
    s_add_u32 m0, s21, 1024
    v_fmac_f32 v106, v92, v95
    v_mfma_f32_16x16x32_bf16 v[56:59], v[20:23], a[132:135], v[56:59]
    buffer_load_dwordx4 v9, s[8:11], s20 offen lds
    v_fmac_f32 v102, v153, v95
    v_mfma_f32_16x16x32_bf16 v[60:63], v[24:27], a[128:131], v[60:63]
    ds_read_b128 v[48:51], v15 offset:34816
    v_fmac_f32 v106, v93, v94
    v_mfma_f32_16x16x32_bf16 v[64:67], v[24:27], a[132:135], v[64:67]
    s_waitcnt lgkmcnt(4)
    v_cndmask_b32 v96, v94, v102, s[56:57]
    v_cndmask_b32 v97, v95, v106, s[56:57]
    v_mfma_f32_16x16x32_bf16 v[52:55], v[28:31], a[136:139], v[52:55]
    ds_read_b128 v[20:23], v12 offset:33024
    v_fmac_f32 v103, v92, v102
    v_mfma_f32_16x16x32_bf16 v[56:59], v[28:31], a[140:143], v[56:59]
    v_fmac_f32 v107, v92, v106
    v_fmac_f32 v103, v153, v106
    v_mfma_f32_16x16x32_bf16 v[60:63], v[32:35], a[136:139], v[60:63]
    ds_read_b128 v[24:27], v12 offset:35072
    v_fmac_f32 v107, v93, v102
    v_cndmask_b32 v96, v96, v103, s[58:59]
    v_mfma_f32_16x16x32_bf16 v[64:67], v[32:35], a[140:143], v[64:67]
    s_waitcnt lgkmcnt(4)
    v_cndmask_b32 v97, v97, v107, s[58:59]
    v_mfma_f32_16x16x32_bf16 v[52:55], v[36:39], a[144:147], v[52:55]
    ds_read_b128 v[28:31], v13 offset:33024
    s_add_u32 m0, s21, 2048
    v_fmac_f32 v104, v92, v103
    v_mfma_f32_16x16x32_bf16 v[56:59], v[36:39], a[148:151], v[56:59]
    buffer_load_dwordx4 v10, s[8:11], s20 offen lds
    v_fmac_f32 v108, v92, v107
    v_mfma_f32_16x16x32_bf16 v[60:63], v[40:43], a[144:147], v[60:63]
    ds_read_b128 v[32:35], v13 offset:35072
    v_fmac_f32 v104, v153, v107
    v_mfma_f32_16x16x32_bf16 v[64:67], v[40:43], a[148:151], v[64:67]
    s_waitcnt lgkmcnt(4)
    v_fmac_f32 v108, v93, v103
    v_cndmask_b32 v96, v96, v104, s[60:61]
    v_mfma_f32_16x16x32_bf16 v[52:55], v[44:47], a[152:155], v[52:55]
    ds_read_b128 v[36:39], v14 offset:33024
    v_cndmask_b32 v97, v97, v108, s[60:61]
    v_mfma_f32_16x16x32_bf16 v[56:59], v[44:47], a[156:159], v[56:59]
    v_fmac_f32 v105, v92, v104
    v_fmac_f32 v109, v92, v108
    v_mfma_f32_16x16x32_bf16 v[60:63], v[48:51], a[152:155], v[60:63]
    ds_read_b128 v[40:43], v14 offset:35072
    v_fmac_f32 v105, v153, v108
    v_fmac_f32 v109, v93, v104
    v_mfma_f32_16x16x32_bf16 v[64:67], v[48:51], a[156:159], v[64:67]
    s_waitcnt lgkmcnt(4)
    v_xor_b32 v98, 0x80000000, v96
    v_mfma_f32_16x16x32_bf16 v[52:55], v[20:23], a[160:163], v[52:55]
    ds_read_b128 v[44:47], v15 offset:33024
    s_add_u32 m0, s21, 3072
    v_xor_b32 v99, 0x80000000, v97
    v_mfma_f32_16x16x32_bf16 v[56:59], v[20:23], a[164:167], v[56:59]
    buffer_load_dwordx4 v11, s[8:11], s20 offen lds
    v_mov_b32 v94, v105
    v_mfma_f32_16x16x32_bf16 v[60:63], v[24:27], a[160:163], v[60:63]
    ds_read_b128 v[48:51], v15 offset:35072
    v_mov_b32 v95, v109
    v_mfma_f32_16x16x32_bf16 v[64:67], v[24:27], a[164:167], v[64:67]
    s_waitcnt lgkmcnt(4)
    v_fmac_f32 v128, v156, v96
    v_fmac_f32 v136, v156, v99
    v_mfma_f32_16x16x32_bf16 v[52:55], v[28:31], a[168:171], v[52:55]
    s_waitcnt vmcnt(9)
    s_barrier
    ds_read_b128 v[20:23], v12 offset:49152
    v_mfma_f32_16x16x32_bf16 v[56:59], v[28:31], a[172:175], v[56:59]
    s_add_u32 s20, s20, 512
    buffer_atomic_add v84, v85, s[12:15], s39 offen sc1
    v_mfma_f32_16x16x32_bf16 v[60:63], v[32:35], a[168:171], v[60:63]
    ds_read_b128 v[24:27], v12 offset:51200
    v_fmac_f32 v128, v157, v99
    v_mfma_f32_16x16x32_bf16 v[64:67], v[32:35], a[172:175], v[64:67]
    s_waitcnt lgkmcnt(4)
    v_fmac_f32 v136, v157, v98
    v_fmac_f32 v129, v158, v96
    v_mfma_f32_16x16x32_bf16 v[52:55], v[36:39], a[176:179], v[52:55]
    ds_read_b128 v[28:31], v13 offset:49152
    s_add_u32 m0, s21, 16384
    v_mfma_f32_16x16x32_bf16 v[56:59], v[36:39], a[180:183], v[56:59]
    buffer_load_dwordx4 v8, s[8:11], s20 offen lds
    v_fmac_f32 v137, v158, v99
    v_mfma_f32_16x16x32_bf16 v[60:63], v[40:43], a[176:179], v[60:63]
    ds_read_b128 v[32:35], v13 offset:51200
    v_fmac_f32 v129, v159, v99
    v_fmac_f32 v137, v159, v98
    v_mfma_f32_16x16x32_bf16 v[64:67], v[40:43], a[180:183], v[64:67]
    s_waitcnt lgkmcnt(4)
    v_cvt_pk_bf16_f32 v120, v128, v129
    v_mfma_f32_16x16x32_bf16 v[52:55], v[44:47], a[184:187], v[52:55]
    ds_read_b128 v[36:39], v14 offset:49152
    v_cvt_pk_bf16_f32 v124, v136, v137
    v_fmac_f32 v130, v160, v96
    v_mfma_f32_16x16x32_bf16 v[56:59], v[44:47], a[188:191], v[56:59]
    v_fmac_f32 v138, v160, v99
    v_fmac_f32 v130, v161, v99
    v_mfma_f32_16x16x32_bf16 v[60:63], v[48:51], a[184:187], v[60:63]
    ds_read_b128 v[40:43], v14 offset:51200
    v_fmac_f32 v138, v161, v98
    v_mfma_f32_16x16x32_bf16 v[64:67], v[48:51], a[188:191], v[64:67]
    s_waitcnt lgkmcnt(4)
    v_fmac_f32 v131, v162, v96
    v_fmac_f32 v139, v162, v99
    v_mfma_f32_16x16x32_bf16 v[52:55], v[20:23], a[192:195], v[52:55]
    ds_read_b128 v[44:47], v15 offset:49152
    s_add_u32 m0, s21, 17408
    v_mfma_f32_16x16x32_bf16 v[56:59], v[20:23], a[196:199], v[56:59]
    buffer_load_dwordx4 v9, s[8:11], s20 offen lds
    v_fmac_f32 v131, v163, v99
    v_mfma_f32_16x16x32_bf16 v[60:63], v[24:27], a[192:195], v[60:63]
    ds_read_b128 v[48:51], v15 offset:51200
    v_fmac_f32 v139, v163, v98
    v_cvt_pk_bf16_f32 v121, v130, v131
    v_mfma_f32_16x16x32_bf16 v[64:67], v[24:27], a[196:199], v[64:67]
    s_waitcnt lgkmcnt(4)
    v_cvt_pk_bf16_f32 v125, v138, v139
    v_mfma_f32_16x16x32_bf16 v[52:55], v[28:31], a[200:203], v[52:55]
    ds_read_b128 v[20:23], v12 offset:49408
    v_fmac_f32 v132, v164, v96
    v_fmac_f32 v140, v164, v99
    v_mfma_f32_16x16x32_bf16 v[56:59], v[28:31], a[204:207], v[56:59]
    v_fmac_f32 v132, v165, v99
    v_fmac_f32 v140, v165, v98
    v_mfma_f32_16x16x32_bf16 v[60:63], v[32:35], a[200:203], v[60:63]
    ds_read_b128 v[24:27], v12 offset:51456
    v_fmac_f32 v133, v166, v96
    v_mfma_f32_16x16x32_bf16 v[64:67], v[32:35], a[204:207], v[64:67]
    s_waitcnt lgkmcnt(4)
    v_fmac_f32 v141, v166, v99
    v_fmac_f32 v133, v167, v99
    v_mfma_f32_16x16x32_bf16 v[52:55], v[36:39], a[208:211], v[52:55]
    ds_read_b128 v[28:31], v13 offset:49408
    s_add_u32 m0, s21, 18432
    v_mfma_f32_16x16x32_bf16 v[56:59], v[36:39], a[212:215], v[56:59]
    buffer_load_dwordx4 v10, s[8:11], s20 offen lds
    v_fmac_f32 v141, v167, v98
    v_mfma_f32_16x16x32_bf16 v[60:63], v[40:43], a[208:211], v[60:63]
    ds_read_b128 v[32:35], v13 offset:51456
    v_cvt_pk_bf16_f32 v122, v132, v133
    v_cvt_pk_bf16_f32 v126, v140, v141
    v_mfma_f32_16x16x32_bf16 v[64:67], v[40:43], a[212:215], v[64:67]
    s_waitcnt lgkmcnt(4)
    v_fmac_f32 v134, v168, v96
    v_mfma_f32_16x16x32_bf16 v[52:55], v[44:47], a[216:219], v[52:55]
    ds_read_b128 v[36:39], v14 offset:49408
    v_fmac_f32 v142, v168, v99
    v_fmac_f32 v134, v169, v99
    v_mfma_f32_16x16x32_bf16 v[56:59], v[44:47], a[220:223], v[56:59]
    v_fmac_f32 v142, v169, v98
    v_fmac_f32 v135, v170, v96
    v_mfma_f32_16x16x32_bf16 v[60:63], v[48:51], a[216:219], v[60:63]
    ds_read_b128 v[40:43], v14 offset:51456
    v_fmac_f32 v143, v170, v99
    v_mfma_f32_16x16x32_bf16 v[64:67], v[48:51], a[220:223], v[64:67]
    s_waitcnt lgkmcnt(4)
    v_fmac_f32 v135, v171, v99
    v_fmac_f32 v143, v171, v98
    v_mfma_f32_16x16x32_bf16 v[52:55], v[20:23], a[224:227], v[52:55]
    ds_read_b128 v[44:47], v15 offset:49408
    s_add_u32 m0, s21, 19456
    v_mfma_f32_16x16x32_bf16 v[56:59], v[20:23], a[228:231], v[56:59]
    buffer_load_dwordx4 v11, s[8:11], s20 offen lds
    v_cvt_pk_bf16_f32 v123, v134, v135
    v_mfma_f32_16x16x32_bf16 v[60:63], v[24:27], a[224:227], v[60:63]
    ds_read_b128 v[48:51], v15 offset:51456
    v_cvt_pk_bf16_f32 v127, v142, v143
    ds_write_b128 v116, v[120:123] offset:0
    v_mfma_f32_16x16x32_bf16 v[64:67], v[24:27], a[228:231], v[64:67]
    s_waitcnt lgkmcnt(4)
    ds_write_b128 v116, v[124:127] offset:1024
    v_mfma_f32_16x16x32_bf16 v[52:55], v[28:31], a[232:235], v[52:55]
    s_waitcnt vmcnt(20)
    s_barrier
    ds_read_b128 v[20:23], v16 offset:0
    v_mfma_f32_16x16x32_bf16 v[56:59], v[28:31], a[236:239], v[56:59]
    s_add_u32 s20, s20, 512
    ds_read_b64_tr_b16 v[144:145], v117 offset:0
    ds_read_b64_tr_b16 v[146:147], v118 offset:256
    v_mfma_f32_16x16x32_bf16 v[60:63], v[32:35], a[232:235], v[60:63]
    ds_read_b128 v[24:27], v16 offset:2048
    ds_read_b64_tr_b16 v[148:149], v117 offset:1024
    v_mfma_f32_16x16x32_bf16 v[64:67], v[32:35], a[236:239], v[64:67]
    s_waitcnt lgkmcnt(4)
    ds_read_b64_tr_b16 v[150:151], v118 offset:1280
    v_mfma_f32_16x16x32_bf16 v[52:55], v[36:39], a[240:243], v[52:55]
    ds_read_b128 v[28:31], v17 offset:0
    s_add_u32 m0, s21, 32768
    s_sub_u32 s39, s22, 1
    v_mfma_f32_16x16x32_bf16 v[56:59], v[36:39], a[244:247], v[56:59]
    buffer_load_dwordx4 v8, s[8:11], s20 offen lds
    s_lshl_b32 s38, s39, 17
    v_mfma_f32_16x16x32_bf16 v[60:63], v[40:43], a[240:243], v[60:63]
    ds_read_b128 v[32:35], v17 offset:2048
    s_add_u32 s38, s38, 0x4400000
    v_mfma_f32_16x16x32_bf16 v[64:67], v[40:43], a[244:247], v[64:67]
    s_waitcnt lgkmcnt(4)
    s_add_u32 s43, s38, 0x10000
    s_lshl_b32 s39, s39, 7
    v_mfma_f32_16x16x32_bf16 v[52:55], v[44:47], a[248:251], v[52:55]
    ds_read_b128 v[36:39], v18 offset:0
    s_add_u32 s39, s39, 0x5902000
    v_mfma_f32_16x16x32_bf16 v[56:59], v[44:47], a[252:255], v[56:59]
    s_cmp_eq_u32 s37, 0
    s_cselect_b32 s38, 0x7ff00000, s38
    s_cselect_b32 s39, 0x7ff00000, s39
    s_cselect_b32 s43, 0x7ff00000, s43
    v_mfma_f32_16x16x32_bf16 v[60:63], v[48:51], a[248:251], v[60:63]
    ds_read_b128 v[40:43], v18 offset:2048
    v_mfma_f32_16x16x32_bf16 v[64:67], v[48:51], a[252:255], v[64:67]
    s_waitcnt lgkmcnt(4)
    s_mov_b32 s37, 1
    s_add_u32 s22, s22, 1
    s_cmp_ge_u32 s22, s23
    s_cbranch_scc1 L_fl0_236
    v_mfma_f32_16x16x32_bf16 v[68:71], v[20:23], a[0:3], 0
    ds_read_b128 v[44:47], v19 offset:0
    s_add_u32 m0, s21, 33792
    v_mfma_f32_16x16x32_bf16 v[72:75], v[20:23], a[4:7], 0
    buffer_load_dwordx4 v9, s[8:11], s20 offen lds
    v_mfma_f32_16x16x32_bf16 v[76:79], v[24:27], a[0:3], 0
    ds_read_b128 v[48:51], v19 offset:2048
    v_mfma_f32_16x16x32_bf16 v[80:83], v[24:27], a[4:7], 0
    s_waitcnt lgkmcnt(4)
    v_fmac_f32 v53, v88, v52
    v_fmac_f32 v57, v88, v56
    v_mfma_f32_16x16x32_bf16 v[68:71], v[28:31], a[8:11], v[68:71]
    ds_read_b128 v[20:23], v16 offset:256
    s_waitcnt lgkmcnt(7)
    v_mul_f32 v128, v90, v52
    v_mfma_f32_16x16x32_bf16 v[72:75], v[28:31], a[12:15], v[72:75]
    buffer_store_dwordx4 v[144:147], v86, s[12:15], s38 offen sc1
    v_mfma_f32_16x16x32_bf16 v[76:79], v[32:35], a[8:11], v[76:79]
    ds_read_b128 v[24:27], v16 offset:2304
    v_mul_f32 v136, v154, v56
    v_fmac_f32 v53, v152, v56
    v_mfma_f32_16x16x32_bf16 v[80:83], v[32:35], a[12:15], v[80:83]
    s_waitcnt lgkmcnt(4)
    v_fmac_f32 v57, v89, v52
    v_mfma_f32_16x16x32_bf16 v[68:71], v[36:39], a[16:19], v[68:71]
    ds_read_b128 v[28:31], v17 offset:256
    s_add_u32 m0, s21, 34816
    v_fmac_f32 v128, v155, v56
    v_mfma_f32_16x16x32_bf16 v[72:75], v[36:39], a[20:23], v[72:75]
    buffer_load_dwordx4 v10, s[8:11], s20 offen lds
    v_fmac_f32 v136, v155, v52
    v_mfma_f32_16x16x32_bf16 v[76:79], v[40:43], a[16:19], v[76:79]
    ds_read_b128 v[32:35], v17 offset:2304
    v_fmac_f32 v54, v88, v53
    v_mfma_f32_16x16x32_bf16 v[80:83], v[40:43], a[20:23], v[80:83]
    s_waitcnt lgkmcnt(4)
    v_fmac_f32 v58, v88, v57
    v_mul_f32 v129, v90, v53
    v_mfma_f32_16x16x32_bf16 v[68:71], v[44:47], a[24:27], v[68:71]
    ds_read_b128 v[36:39], v18 offset:256
    v_mul_f32 v137, v154, v57
    v_mfma_f32_16x16x32_bf16 v[72:75], v[44:47], a[28:31], v[72:75]
    buffer_store_dwordx4 v[148:151], v86, s[12:15], s43 offen sc1
    v_fmac_f32 v54, v152, v57
    v_mfma_f32_16x16x32_bf16 v[76:79], v[48:51], a[24:27], v[76:79]
    ds_read_b128 v[40:43], v18 offset:2304
    v_fmac_f32 v58, v89, v53
    v_mfma_f32_16x16x32_bf16 v[80:83], v[48:51], a[28:31], v[80:83]
    s_waitcnt lgkmcnt(4)
    v_fmac_f32 v129, v155, v57
    v_fmac_f32 v137, v155, v53
    v_mfma_f32_16x16x32_bf16 v[68:71], v[20:23], a[32:35], v[68:71]
    ds_read_b128 v[44:47], v19 offset:256
    s_add_u32 m0, s21, 35840
    v_fmac_f32 v55, v88, v54
    v_mfma_f32_16x16x32_bf16 v[72:75], v[20:23], a[36:39], v[72:75]
    buffer_load_dwordx4 v11, s[8:11], s20 offen lds
    v_mfma_f32_16x16x32_bf16 v[76:79], v[24:27], a[32:35], v[76:79]
    ds_read_b128 v[48:51], v19 offset:2304
    v_fmac_f32 v59, v88, v58
    v_mul_f32 v130, v90, v54
    v_mfma_f32_16x16x32_bf16 v[80:83], v[24:27], a[36:39], v[80:83]
    s_waitcnt lgkmcnt(4)
    v_mul_f32 v138, v154, v58
    v_mfma_f32_16x16x32_bf16 v[68:71], v[28:31], a[40:43], v[68:71]
    s_waitcnt vmcnt(20)
    s_barrier
    ds_read_b128 v[20:23], v16 offset:16384
    v_mfma_f32_16x16x32_bf16 v[72:75], v[28:31], a[44:47], v[72:75]
    s_add_u32 s20, s20, 512
    v_fmac_f32 v55, v152, v58
    v_fmac_f32 v59, v89, v54
    v_mfma_f32_16x16x32_bf16 v[76:79], v[32:35], a[40:43], v[76:79]
    ds_read_b128 v[24:27], v16 offset:18432
    v_fmac_f32 v130, v155, v58
    v_mfma_f32_16x16x32_bf16 v[80:83], v[32:35], a[44:47], v[80:83]
    s_waitcnt lgkmcnt(4)
    v_fmac_f32 v138, v155, v54
    v_fmac_f32 v60, v88, v55
    v_mfma_f32_16x16x32_bf16 v[68:71], v[36:39], a[48:51], v[68:71]
    ds_read_b128 v[28:31], v17 offset:16384
    s_add_u32 m0, s21, 49152
    v_mfma_f32_16x16x32_bf16 v[72:75], v[36:39], a[52:55], v[72:75]
    buffer_load_dwordx4 v8, s[8:11], s20 offen lds
    v_fmac_f32 v64, v88, v59
    v_mfma_f32_16x16x32_bf16 v[76:79], v[40:43], a[48:51], v[76:79]
    ds_read_b128 v[32:35], v17 offset:18432
    v_mul_f32 v131, v90, v55
    v_mul_f32 v139, v154, v59
    v_mfma_f32_16x16x32_bf16 v[80:83], v[40:43], a[52:55], v[80:83]
    s_waitcnt lgkmcnt(4)
    v_fmac_f32 v60, v152, v59
    v_mfma_f32_16x16x32_bf16 v[68:71], v[44:47], a[56:59], v[68:71]
    ds_read_b128 v[36:39], v18 offset:16384
    v_fmac_f32 v64, v89, v55
    v_fmac_f32 v131, v155, v59
    v_mfma_f32_16x16x32_bf16 v[72:75], v[44:47], a[60:63], v[72:75]
    v_fmac_f32 v139, v155, v55
    v_fmac_f32 v61, v88, v60
    v_mfma_f32_16x16x32_bf16 v[76:79], v[48:51], a[56:59], v[76:79]
    ds_read_b128 v[40:43], v18 offset:18432
    v_fmac_f32 v65, v88, v64
    v_mfma_f32_16x16x32_bf16 v[80:83], v[48:51], a[60:63], v[80:83]
    s_waitcnt lgkmcnt(4)
    v_mul_f32 v132, v90, v60
    v_mul_f32 v140, v154, v64
    v_mfma_f32_16x16x32_bf16 v[68:71], v[20:23], a[64:67], v[68:71]
    ds_read_b128 v[44:47], v19 offset:16384
    s_add_u32 m0, s21, 50176
    v_mfma_f32_16x16x32_bf16 v[72:75], v[20:23], a[68:71], v[72:75]
    buffer_load_dwordx4 v9, s[8:11], s20 offen lds
    v_fmac_f32 v61, v152, v64
    v_mfma_f32_16x16x32_bf16 v[76:79], v[24:27], a[64:67], v[76:79]
    ds_read_b128 v[48:51], v19 offset:18432
    v_fmac_f32 v65, v89, v60
    v_fmac_f32 v132, v155, v64
    v_mfma_f32_16x16x32_bf16 v[80:83], v[24:27], a[68:71], v[80:83]
    s_waitcnt lgkmcnt(4)
    v_fmac_f32 v140, v155, v60
    v_mfma_f32_16x16x32_bf16 v[68:71], v[28:31], a[72:75], v[68:71]
    ds_read_b128 v[20:23], v16 offset:16640
    v_fmac_f32 v62, v88, v61
    v_fmac_f32 v66, v88, v65
    v_mfma_f32_16x16x32_bf16 v[72:75], v[28:31], a[76:79], v[72:75]
    v_mul_f32 v133, v90, v61
    v_mul_f32 v141, v154, v65
    v_mfma_f32_16x16x32_bf16 v[76:79], v[32:35], a[72:75], v[76:79]
    ds_read_b128 v[24:27], v16 offset:18688
    s_add_u32 s24, s24, 1
    v_fmac_f32 v62, v152, v65
    v_mfma_f32_16x16x32_bf16 v[80:83], v[32:35], a[76:79], v[80:83]
    s_waitcnt lgkmcnt(4)
    v_fmac_f32 v66, v89, v61
    v_mfma_f32_16x16x32_bf16 v[68:71], v[36:39], a[80:83], v[68:71]
    ds_read_b128 v[28:31], v17 offset:16640
    s_add_u32 m0, s21, 51200
    v_fmac_f32 v133, v155, v65
    v_mfma_f32_16x16x32_bf16 v[72:75], v[36:39], a[84:87], v[72:75]
    buffer_load_dwordx4 v10, s[8:11], s20 offen lds
    v_mfma_f32_16x16x32_bf16 v[76:79], v[40:43], a[80:83], v[76:79]
    ds_read_b128 v[32:35], v17 offset:18688
    v_fmac_f32 v141, v155, v61
    v_fmac_f32 v63, v88, v62
    v_mfma_f32_16x16x32_bf16 v[80:83], v[40:43], a[84:87], v[80:83]
    s_waitcnt lgkmcnt(4)
    s_min_u32 s24, s24, 63
    v_fmac_f32 v67, v88, v66
    v_mfma_f32_16x16x32_bf16 v[68:71], v[44:47], a[88:91], v[68:71]
    ds_read_b128 v[36:39], v18 offset:16640
    v_mul_f32 v134, v90, v62
    v_mfma_f32_16x16x32_bf16 v[72:75], v[44:47], a[92:95], v[72:75]
    v_mul_f32 v142, v154, v66
    v_fmac_f32 v63, v152, v66
    v_mfma_f32_16x16x32_bf16 v[76:79], v[48:51], a[88:91], v[76:79]
    ds_read_b128 v[40:43], v18 offset:18688
    s_lshl_b32 s53, s24, 16
    v_fmac_f32 v67, v89, v62
    v_mfma_f32_16x16x32_bf16 v[80:83], v[48:51], a[92:95], v[80:83]
    s_waitcnt lgkmcnt(4)
    v_fmac_f32 v134, v155, v66
    v_fmac_f32 v142, v155, v62
    v_mfma_f32_16x16x32_bf16 v[68:71], v[20:23], a[96:99], v[68:71]
    ds_read_b128 v[44:47], v19 offset:16640
    s_add_u32 m0, s21, 52224
    v_mfma_f32_16x16x32_bf16 v[72:75], v[20:23], a[100:103], v[72:75]
    buffer_load_dwordx4 v11, s[8:11], s20 offen lds
    v_mov_b32 v102, v63
    v_mfma_f32_16x16x32_bf16 v[76:79], v[24:27], a[96:99], v[76:79]
    ds_read_b128 v[48:51], v19 offset:18688
    v_mov_b32 v103, v63
    v_mfma_f32_16x16x32_bf16 v[80:83], v[24:27], a[100:103], v[80:83]
    s_waitcnt lgkmcnt(4)
    v_mov_b32 v106, v67
    v_mov_b32 v107, v67
    v_mfma_f32_16x16x32_bf16 v[68:71], v[28:31], a[104:107], v[68:71]
    s_waitcnt vmcnt(20)
    s_barrier
    ds_read_b128 v[20:23], v16 offset:32768
    v_mfma_f32_16x16x32_bf16 v[72:75], v[28:31], a[108:111], v[72:75]
    s_mov_b32 s20, s53
    v_mul_f32 v135, v90, v63
    v_mfma_f32_16x16x32_bf16 v[76:79], v[32:35], a[104:107], v[76:79]
    ds_read_b128 v[24:27], v16 offset:34816
    v_mul_f32 v143, v154, v67
    v_permlane16_swap_b32 v102, v103
    v_mfma_f32_16x16x32_bf16 v[80:83], v[32:35], a[108:111], v[80:83]
    s_waitcnt lgkmcnt(4)
    v_permlane16_swap_b32 v106, v107
    v_mfma_f32_16x16x32_bf16 v[68:71], v[36:39], a[112:115], v[68:71]
    ds_read_b128 v[28:31], v17 offset:32768
    s_add_u32 m0, s21, 65536
    v_mov_b32 v104, v102
    v_mfma_f32_16x16x32_bf16 v[72:75], v[36:39], a[116:119], v[72:75]
    buffer_load_dwordx4 v8, s[8:11], s20 offen lds
    v_mov_b32 v105, v103
    v_mfma_f32_16x16x32_bf16 v[76:79], v[40:43], a[112:115], v[76:79]
    ds_read_b128 v[32:35], v17 offset:34816
    v_mov_b32 v108, v106
    v_mfma_f32_16x16x32_bf16 v[80:83], v[40:43], a[116:119], v[80:83]
    s_waitcnt lgkmcnt(4)
    v_mov_b32 v109, v107
    v_fmac_f32 v135, v155, v67
    v_mfma_f32_16x16x32_bf16 v[68:71], v[44:47], a[120:123], v[68:71]
    ds_read_b128 v[36:39], v18 offset:32768
    v_fmac_f32 v143, v155, v63
    v_mfma_f32_16x16x32_bf16 v[72:75], v[44:47], a[124:127], v[72:75]
    v_permlane32_swap_b32 v102, v104
    v_permlane32_swap_b32 v103, v105
    v_mfma_f32_16x16x32_bf16 v[76:79], v[48:51], a[120:123], v[76:79]
    ds_read_b128 v[40:43], v18 offset:34816
    v_permlane32_swap_b32 v106, v108
    v_permlane32_swap_b32 v107, v109
    v_mfma_f32_16x16x32_bf16 v[80:83], v[48:51], a[124:127], v[80:83]
    s_waitcnt lgkmcnt(4)
    v_fmac_f32 v102, v92, v94
    v_mfma_f32_16x16x32_bf16 v[68:71], v[20:23], a[128:131], v[68:71]
    ds_read_b128 v[44:47], v19 offset:32768
    s_add_u32 m0, s21, 66560
    v_fmac_f32 v106, v92, v95
    v_mfma_f32_16x16x32_bf16 v[72:75], v[20:23], a[132:135], v[72:75]
    buffer_load_dwordx4 v9, s[8:11], s20 offen lds
    v_fmac_f32 v102, v153, v95
    v_mfma_f32_16x16x32_bf16 v[76:79], v[24:27], a[128:131], v[76:79]
    ds_read_b128 v[48:51], v19 offset:34816
    v_fmac_f32 v106, v93, v94
    v_mfma_f32_16x16x32_bf16 v[80:83], v[24:27], a[132:135], v[80:83]
    s_waitcnt lgkmcnt(4)
    v_cndmask_b32 v96, v94, v102, s[56:57]
    v_cndmask_b32 v97, v95, v106, s[56:57]
    v_mfma_f32_16x16x32_bf16 v[68:71], v[28:31], a[136:139], v[68:71]
    ds_read_b128 v[20:23], v16 offset:33024
    v_fmac_f32 v103, v92, v102
    v_mfma_f32_16x16x32_bf16 v[72:75], v[28:31], a[140:143], v[72:75]
    v_fmac_f32 v107, v92, v106
    v_fmac_f32 v103, v153, v106
    v_mfma_f32_16x16x32_bf16 v[76:79], v[32:35], a[136:139], v[76:79]
    ds_read_b128 v[24:27], v16 offset:35072
    v_fmac_f32 v107, v93, v102
    v_cndmask_b32 v96, v96, v103, s[58:59]
    v_mfma_f32_16x16x32_bf16 v[80:83], v[32:35], a[140:143], v[80:83]
    s_waitcnt lgkmcnt(4)
    v_cndmask_b32 v97, v97, v107, s[58:59]
    v_mfma_f32_16x16x32_bf16 v[68:71], v[36:39], a[144:147], v[68:71]
    ds_read_b128 v[28:31], v17 offset:33024
    s_add_u32 m0, s21, 67584
    v_fmac_f32 v104, v92, v103
    v_mfma_f32_16x16x32_bf16 v[72:75], v[36:39], a[148:151], v[72:75]
    buffer_load_dwordx4 v10, s[8:11], s20 offen lds
    v_fmac_f32 v108, v92, v107
    v_mfma_f32_16x16x32_bf16 v[76:79], v[40:43], a[144:147], v[76:79]
    ds_read_b128 v[32:35], v17 offset:35072
    v_fmac_f32 v104, v153, v107
    v_mfma_f32_16x16x32_bf16 v[80:83], v[40:43], a[148:151], v[80:83]
    s_waitcnt lgkmcnt(4)
    v_fmac_f32 v108, v93, v103
    v_cndmask_b32 v96, v96, v104, s[60:61]
    v_mfma_f32_16x16x32_bf16 v[68:71], v[44:47], a[152:155], v[68:71]
    ds_read_b128 v[36:39], v18 offset:33024
    v_cndmask_b32 v97, v97, v108, s[60:61]
    v_mfma_f32_16x16x32_bf16 v[72:75], v[44:47], a[156:159], v[72:75]
    v_fmac_f32 v105, v92, v104
    v_fmac_f32 v109, v92, v108
    v_mfma_f32_16x16x32_bf16 v[76:79], v[48:51], a[152:155], v[76:79]
    ds_read_b128 v[40:43], v18 offset:35072
    v_fmac_f32 v105, v153, v108
    v_fmac_f32 v109, v93, v104
    v_mfma_f32_16x16x32_bf16 v[80:83], v[48:51], a[156:159], v[80:83]
    s_waitcnt lgkmcnt(4)
    v_xor_b32 v98, 0x80000000, v96
    v_mfma_f32_16x16x32_bf16 v[68:71], v[20:23], a[160:163], v[68:71]
    ds_read_b128 v[44:47], v19 offset:33024
    s_add_u32 m0, s21, 68608
    v_xor_b32 v99, 0x80000000, v97
    v_mfma_f32_16x16x32_bf16 v[72:75], v[20:23], a[164:167], v[72:75]
    buffer_load_dwordx4 v11, s[8:11], s20 offen lds
    v_mov_b32 v94, v105
    v_mfma_f32_16x16x32_bf16 v[76:79], v[24:27], a[160:163], v[76:79]
    ds_read_b128 v[48:51], v19 offset:35072
    v_mov_b32 v95, v109
    v_mfma_f32_16x16x32_bf16 v[80:83], v[24:27], a[164:167], v[80:83]
    s_waitcnt lgkmcnt(4)
    v_fmac_f32 v128, v156, v96
    v_fmac_f32 v136, v156, v99
    v_mfma_f32_16x16x32_bf16 v[68:71], v[28:31], a[168:171], v[68:71]
    s_waitcnt vmcnt(9)
    s_barrier
    ds_read_b128 v[20:23], v16 offset:49152
    v_mfma_f32_16x16x32_bf16 v[72:75], v[28:31], a[172:175], v[72:75]
    s_add_u32 s20, s20, 512
    buffer_atomic_add v84, v85, s[12:15], s39 offen sc1
    v_mfma_f32_16x16x32_bf16 v[76:79], v[32:35], a[168:171], v[76:79]
    ds_read_b128 v[24:27], v16 offset:51200
    v_fmac_f32 v128, v157, v99
    v_mfma_f32_16x16x32_bf16 v[80:83], v[32:35], a[172:175], v[80:83]
    s_waitcnt lgkmcnt(4)
    v_fmac_f32 v136, v157, v98
    v_fmac_f32 v129, v158, v96
    v_mfma_f32_16x16x32_bf16 v[68:71], v[36:39], a[176:179], v[68:71]
    ds_read_b128 v[28:31], v17 offset:49152
    s_add_u32 m0, s21, 81920
    v_mfma_f32_16x16x32_bf16 v[72:75], v[36:39], a[180:183], v[72:75]
    buffer_load_dwordx4 v8, s[8:11], s20 offen lds
    v_fmac_f32 v137, v158, v99
    v_mfma_f32_16x16x32_bf16 v[76:79], v[40:43], a[176:179], v[76:79]
    ds_read_b128 v[32:35], v17 offset:51200
    v_fmac_f32 v129, v159, v99
    v_fmac_f32 v137, v159, v98
    v_mfma_f32_16x16x32_bf16 v[80:83], v[40:43], a[180:183], v[80:83]
    s_waitcnt lgkmcnt(4)
    v_cvt_pk_bf16_f32 v120, v128, v129
    v_mfma_f32_16x16x32_bf16 v[68:71], v[44:47], a[184:187], v[68:71]
    ds_read_b128 v[36:39], v18 offset:49152
    v_cvt_pk_bf16_f32 v124, v136, v137
    v_fmac_f32 v130, v160, v96
    v_mfma_f32_16x16x32_bf16 v[72:75], v[44:47], a[188:191], v[72:75]
    v_fmac_f32 v138, v160, v99
    v_fmac_f32 v130, v161, v99
    v_mfma_f32_16x16x32_bf16 v[76:79], v[48:51], a[184:187], v[76:79]
    ds_read_b128 v[40:43], v18 offset:51200
    v_fmac_f32 v138, v161, v98
    v_mfma_f32_16x16x32_bf16 v[80:83], v[48:51], a[188:191], v[80:83]
    s_waitcnt lgkmcnt(4)
    v_fmac_f32 v131, v162, v96
    v_fmac_f32 v139, v162, v99
    v_mfma_f32_16x16x32_bf16 v[68:71], v[20:23], a[192:195], v[68:71]
    ds_read_b128 v[44:47], v19 offset:49152
    s_add_u32 m0, s21, 82944
    v_mfma_f32_16x16x32_bf16 v[72:75], v[20:23], a[196:199], v[72:75]
    buffer_load_dwordx4 v9, s[8:11], s20 offen lds
    v_fmac_f32 v131, v163, v99
    v_mfma_f32_16x16x32_bf16 v[76:79], v[24:27], a[192:195], v[76:79]
    ds_read_b128 v[48:51], v19 offset:51200
    v_fmac_f32 v139, v163, v98
    v_cvt_pk_bf16_f32 v121, v130, v131
    v_mfma_f32_16x16x32_bf16 v[80:83], v[24:27], a[196:199], v[80:83]
    s_waitcnt lgkmcnt(4)
    v_cvt_pk_bf16_f32 v125, v138, v139
    v_mfma_f32_16x16x32_bf16 v[68:71], v[28:31], a[200:203], v[68:71]
    ds_read_b128 v[20:23], v16 offset:49408
    v_fmac_f32 v132, v164, v96
    v_fmac_f32 v140, v164, v99
    v_mfma_f32_16x16x32_bf16 v[72:75], v[28:31], a[204:207], v[72:75]
    v_fmac_f32 v132, v165, v99
    v_fmac_f32 v140, v165, v98
    v_mfma_f32_16x16x32_bf16 v[76:79], v[32:35], a[200:203], v[76:79]
    ds_read_b128 v[24:27], v16 offset:51456
    v_fmac_f32 v133, v166, v96
    v_mfma_f32_16x16x32_bf16 v[80:83], v[32:35], a[204:207], v[80:83]
    s_waitcnt lgkmcnt(4)
    v_fmac_f32 v141, v166, v99
    v_fmac_f32 v133, v167, v99
    v_mfma_f32_16x16x32_bf16 v[68:71], v[36:39], a[208:211], v[68:71]
    ds_read_b128 v[28:31], v17 offset:49408
    s_add_u32 m0, s21, 83968
    v_mfma_f32_16x16x32_bf16 v[72:75], v[36:39], a[212:215], v[72:75]
    buffer_load_dwordx4 v10, s[8:11], s20 offen lds
    v_fmac_f32 v141, v167, v98
    v_mfma_f32_16x16x32_bf16 v[76:79], v[40:43], a[208:211], v[76:79]
    ds_read_b128 v[32:35], v17 offset:51456
    v_cvt_pk_bf16_f32 v122, v132, v133
    v_cvt_pk_bf16_f32 v126, v140, v141
    v_mfma_f32_16x16x32_bf16 v[80:83], v[40:43], a[212:215], v[80:83]
    s_waitcnt lgkmcnt(4)
    v_fmac_f32 v134, v168, v96
    v_mfma_f32_16x16x32_bf16 v[68:71], v[44:47], a[216:219], v[68:71]
    ds_read_b128 v[36:39], v18 offset:49408
    v_fmac_f32 v142, v168, v99
    v_fmac_f32 v134, v169, v99
    v_mfma_f32_16x16x32_bf16 v[72:75], v[44:47], a[220:223], v[72:75]
    v_fmac_f32 v142, v169, v98
    v_fmac_f32 v135, v170, v96
    v_mfma_f32_16x16x32_bf16 v[76:79], v[48:51], a[216:219], v[76:79]
    ds_read_b128 v[40:43], v18 offset:51456
    v_fmac_f32 v143, v170, v99
    v_mfma_f32_16x16x32_bf16 v[80:83], v[48:51], a[220:223], v[80:83]
    s_waitcnt lgkmcnt(4)
    v_fmac_f32 v135, v171, v99
    v_fmac_f32 v143, v171, v98
    v_mfma_f32_16x16x32_bf16 v[68:71], v[20:23], a[224:227], v[68:71]
    ds_read_b128 v[44:47], v19 offset:49408
    s_add_u32 m0, s21, 84992
    v_mfma_f32_16x16x32_bf16 v[72:75], v[20:23], a[228:231], v[72:75]
    buffer_load_dwordx4 v11, s[8:11], s20 offen lds
    v_cvt_pk_bf16_f32 v123, v134, v135
    v_mfma_f32_16x16x32_bf16 v[76:79], v[24:27], a[224:227], v[76:79]
    ds_read_b128 v[48:51], v19 offset:51456
    v_cvt_pk_bf16_f32 v127, v142, v143
    ds_write_b128 v116, v[120:123] offset:0
    v_mfma_f32_16x16x32_bf16 v[80:83], v[24:27], a[228:231], v[80:83]
    s_waitcnt lgkmcnt(4)
    ds_write_b128 v116, v[124:127] offset:1024
    v_mfma_f32_16x16x32_bf16 v[68:71], v[28:31], a[232:235], v[68:71]
    s_waitcnt vmcnt(20)
    s_barrier
    ds_read_b128 v[20:23], v12 offset:0
    v_mfma_f32_16x16x32_bf16 v[72:75], v[28:31], a[236:239], v[72:75]
    s_add_u32 s20, s20, 512
    ds_read_b64_tr_b16 v[144:145], v117 offset:0
    ds_read_b64_tr_b16 v[146:147], v118 offset:256
    v_mfma_f32_16x16x32_bf16 v[76:79], v[32:35], a[232:235], v[76:79]
    ds_read_b128 v[24:27], v12 offset:2048
    ds_read_b64_tr_b16 v[148:149], v117 offset:1024
    v_mfma_f32_16x16x32_bf16 v[80:83], v[32:35], a[236:239], v[80:83]
    s_waitcnt lgkmcnt(4)
    ds_read_b64_tr_b16 v[150:151], v118 offset:1280
    v_mfma_f32_16x16x32_bf16 v[68:71], v[36:39], a[240:243], v[68:71]
    ds_read_b128 v[28:31], v13 offset:0
    s_add_u32 m0, s21, 98304
    s_sub_u32 s39, s22, 1
    v_mfma_f32_16x16x32_bf16 v[72:75], v[36:39], a[244:247], v[72:75]
    buffer_load_dwordx4 v8, s[8:11], s20 offen lds
    s_lshl_b32 s38, s39, 17
    v_mfma_f32_16x16x32_bf16 v[76:79], v[40:43], a[240:243], v[76:79]
    ds_read_b128 v[32:35], v13 offset:2048
    s_add_u32 s38, s38, 0x4400000
    v_mfma_f32_16x16x32_bf16 v[80:83], v[40:43], a[244:247], v[80:83]
    s_waitcnt lgkmcnt(4)
    s_add_u32 s43, s38, 0x10000
    s_lshl_b32 s39, s39, 7
    v_mfma_f32_16x16x32_bf16 v[68:71], v[44:47], a[248:251], v[68:71]
    ds_read_b128 v[36:39], v14 offset:0
    s_add_u32 s39, s39, 0x5902000
    v_mfma_f32_16x16x32_bf16 v[72:75], v[44:47], a[252:255], v[72:75]
    s_cmp_eq_u32 s37, 0
    s_cselect_b32 s38, 0x7ff00000, s38
    s_cselect_b32 s39, 0x7ff00000, s39
    s_cselect_b32 s43, 0x7ff00000, s43
    v_mfma_f32_16x16x32_bf16 v[76:79], v[48:51], a[248:251], v[76:79]
    ds_read_b128 v[40:43], v14 offset:2048
    v_mfma_f32_16x16x32_bf16 v[80:83], v[48:51], a[252:255], v[80:83]
    s_waitcnt lgkmcnt(4)
    s_mov_b32 s37, 1
    s_add_u32 s22, s22, 1
    s_cmp_ge_u32 s22, s23
    s_cbranch_scc0 L_st_239
L_fl1_237:
    s_waitcnt lgkmcnt(0)
    s_nop 7
    s_waitcnt lgkmcnt(0)
    buffer_store_dwordx4 v[144:147], v86, s[12:15], s38 offen sc1
    buffer_store_dwordx4 v[148:151], v86, s[12:15], s43 offen sc1
    s_waitcnt vmcnt(0)
    s_barrier
    buffer_atomic_add v84, v85, s[12:15], s39 offen sc1
    v_fmac_f32 v69, v88, v68
    v_fmac_f32 v73, v88, v72
    v_mul_f32 v128, v90, v68
    v_mul_f32 v136, v154, v72
    v_fmac_f32 v69, v152, v72
    v_fmac_f32 v73, v89, v68
    v_fmac_f32 v128, v155, v72
    v_fmac_f32 v136, v155, v68
    v_fmac_f32 v70, v88, v69
    v_fmac_f32 v74, v88, v73
    v_mul_f32 v129, v90, v69
    v_mul_f32 v137, v154, v73
    v_fmac_f32 v70, v152, v73
    v_fmac_f32 v74, v89, v69
    v_fmac_f32 v129, v155, v73
    v_fmac_f32 v137, v155, v69
    v_fmac_f32 v71, v88, v70
    v_fmac_f32 v75, v88, v74
    v_mul_f32 v130, v90, v70
    v_mul_f32 v138, v154, v74
    v_fmac_f32 v71, v152, v74
    v_fmac_f32 v75, v89, v70
    v_fmac_f32 v130, v155, v74
    v_fmac_f32 v138, v155, v70
    v_fmac_f32 v76, v88, v71
    v_fmac_f32 v80, v88, v75
    v_mul_f32 v131, v90, v71
    v_mul_f32 v139, v154, v75
    v_fmac_f32 v76, v152, v75
    v_fmac_f32 v80, v89, v71
    v_fmac_f32 v131, v155, v75
    v_fmac_f32 v139, v155, v71
    v_fmac_f32 v77, v88, v76
    v_fmac_f32 v81, v88, v80
    v_mul_f32 v132, v90, v76
    v_mul_f32 v140, v154, v80
    v_fmac_f32 v77, v152, v80
    v_fmac_f32 v81, v89, v76
    v_fmac_f32 v132, v155, v80
    v_fmac_f32 v140, v155, v76
    v_fmac_f32 v78, v88, v77
    v_fmac_f32 v82, v88, v81
    v_mul_f32 v133, v90, v77
    v_mul_f32 v141, v154, v81
    v_fmac_f32 v78, v152, v81
    v_fmac_f32 v82, v89, v77
    v_fmac_f32 v133, v155, v81
    v_fmac_f32 v141, v155, v77
    v_fmac_f32 v79, v88, v78
    v_fmac_f32 v83, v88, v82
    v_mul_f32 v134, v90, v78
    v_mul_f32 v142, v154, v82
    v_fmac_f32 v79, v152, v82
    v_fmac_f32 v83, v89, v78
    v_fmac_f32 v134, v155, v82
    v_fmac_f32 v142, v155, v78
    v_mov_b32 v102, v79
    v_mov_b32 v103, v79
    v_mov_b32 v106, v83
    v_mov_b32 v107, v83
    v_mul_f32 v135, v90, v79
    v_mul_f32 v143, v154, v83
    v_permlane16_swap_b32 v102, v103
    v_permlane16_swap_b32 v106, v107
    v_mov_b32 v104, v102
    v_mov_b32 v105, v103
    v_mov_b32 v108, v106
    v_mov_b32 v109, v107
    v_fmac_f32 v135, v155, v83
    v_fmac_f32 v143, v155, v79
    v_permlane32_swap_b32 v102, v104
    v_permlane32_swap_b32 v103, v105
    v_permlane32_swap_b32 v106, v108
    v_permlane32_swap_b32 v107, v109
    v_fmac_f32 v102, v92, v94
    v_fmac_f32 v106, v92, v95
    v_fmac_f32 v102, v153, v95
    v_fmac_f32 v106, v93, v94
    v_cndmask_b32 v96, v94, v102, s[56:57]
    v_cndmask_b32 v97, v95, v106, s[56:57]
    v_fmac_f32 v103, v92, v102
    v_fmac_f32 v107, v92, v106
    v_fmac_f32 v103, v153, v106
    v_fmac_f32 v107, v93, v102
    v_cndmask_b32 v96, v96, v103, s[58:59]
    v_cndmask_b32 v97, v97, v107, s[58:59]
    v_fmac_f32 v104, v92, v103
    v_fmac_f32 v108, v92, v107
    v_fmac_f32 v104, v153, v107
    v_fmac_f32 v108, v93, v103
    v_cndmask_b32 v96, v96, v104, s[60:61]
    v_cndmask_b32 v97, v97, v108, s[60:61]
    v_fmac_f32 v105, v92, v104
    v_fmac_f32 v109, v92, v108
    v_fmac_f32 v105, v153, v108
    v_fmac_f32 v109, v93, v104
    v_xor_b32 v98, 0x80000000, v96
    v_xor_b32 v99, 0x80000000, v97
    v_mov_b32 v94, v105
    v_mov_b32 v95, v109
    v_fmac_f32 v128, v156, v96
    v_fmac_f32 v136, v156, v99
    v_fmac_f32 v128, v157, v99
    v_fmac_f32 v136, v157, v98
    v_fmac_f32 v129, v158, v96
    v_fmac_f32 v137, v158, v99
    v_fmac_f32 v129, v159, v99
    v_fmac_f32 v137, v159, v98
    v_cvt_pk_bf16_f32 v120, v128, v129
    v_cvt_pk_bf16_f32 v124, v136, v137
    v_fmac_f32 v130, v160, v96
    v_fmac_f32 v138, v160, v99
    v_fmac_f32 v130, v161, v99
    v_fmac_f32 v138, v161, v98
    v_fmac_f32 v131, v162, v96
    v_fmac_f32 v139, v162, v99
    v_fmac_f32 v131, v163, v99
    v_fmac_f32 v139, v163, v98
    v_cvt_pk_bf16_f32 v121, v130, v131
    v_cvt_pk_bf16_f32 v125, v138, v139
    v_fmac_f32 v132, v164, v96
    v_fmac_f32 v140, v164, v99
    v_fmac_f32 v132, v165, v99
    v_fmac_f32 v140, v165, v98
    v_fmac_f32 v133, v166, v96
    v_fmac_f32 v141, v166, v99
    v_fmac_f32 v133, v167, v99
    v_fmac_f32 v141, v167, v98
    v_cvt_pk_bf16_f32 v122, v132, v133
    v_cvt_pk_bf16_f32 v126, v140, v141
    v_fmac_f32 v134, v168, v96
    v_fmac_f32 v142, v168, v99
    v_fmac_f32 v134, v169, v99
    v_fmac_f32 v142, v169, v98
    v_fmac_f32 v135, v170, v96
    v_fmac_f32 v143, v170, v99
    v_fmac_f32 v135, v171, v99
    v_fmac_f32 v143, v171, v98
    v_cvt_pk_bf16_f32 v123, v134, v135
    v_cvt_pk_bf16_f32 v127, v142, v143
    ds_write_b128 v116, v[120:123] offset:0
    ds_write_b128 v116, v[124:127] offset:1024
    ds_read_b64_tr_b16 v[144:145], v117 offset:0
    ds_read_b64_tr_b16 v[146:147], v118 offset:256
    ds_read_b64_tr_b16 v[148:149], v117 offset:1024
    ds_read_b64_tr_b16 v[150:151], v118 offset:1280
    s_sub_u32 s39, s22, 1
    s_lshl_b32 s38, s39, 17
    s_add_u32 s38, s38, 0x4400000
    s_add_u32 s43, s38, 0x10000
    s_lshl_b32 s39, s39, 7
    s_add_u32 s39, s39, 0x5902000
    s_cmp_eq_u32 s37, 0
    s_cselect_b32 s38, 0x7ff00000, s38
    s_cselect_b32 s39, 0x7ff00000, s39
    s_cselect_b32 s43, 0x7ff00000, s43
    s_mov_b32 s37, 1
    s_waitcnt lgkmcnt(0)
    buffer_store_dwordx4 v[144:147], v86, s[12:15], s38 offen sc1
    buffer_store_dwordx4 v[148:151], v86, s[12:15], s43 offen sc1
    s_waitcnt vmcnt(0)
    s_barrier
    buffer_atomic_add v84, v85, s[12:15], s39 offen sc1
    s_branch L_ste_238
L_fl0_236:
    s_waitcnt lgkmcnt(0)
    s_nop 7
    s_waitcnt lgkmcnt(0)
    buffer_store_dwordx4 v[144:147], v86, s[12:15], s38 offen sc1
    buffer_store_dwordx4 v[148:151], v86, s[12:15], s43 offen sc1
    s_waitcnt vmcnt(0)
    s_barrier
    buffer_atomic_add v84, v85, s[12:15], s39 offen sc1
    v_fmac_f32 v53, v88, v52
    v_fmac_f32 v57, v88, v56
    v_mul_f32 v128, v90, v52
    v_mul_f32 v136, v154, v56
    v_fmac_f32 v53, v152, v56
    v_fmac_f32 v57, v89, v52
    v_fmac_f32 v128, v155, v56
    v_fmac_f32 v136, v155, v52
    v_fmac_f32 v54, v88, v53
    v_fmac_f32 v58, v88, v57
    v_mul_f32 v129, v90, v53
    v_mul_f32 v137, v154, v57
    v_fmac_f32 v54, v152, v57
    v_fmac_f32 v58, v89, v53
    v_fmac_f32 v129, v155, v57
    v_fmac_f32 v137, v155, v53
    v_fmac_f32 v55, v88, v54
    v_fmac_f32 v59, v88, v58
    v_mul_f32 v130, v90, v54
    v_mul_f32 v138, v154, v58
    v_fmac_f32 v55, v152, v58
    v_fmac_f32 v59, v89, v54
    v_fmac_f32 v130, v155, v58
    v_fmac_f32 v138, v155, v54
    v_fmac_f32 v60, v88, v55
    v_fmac_f32 v64, v88, v59
    v_mul_f32 v131, v90, v55
    v_mul_f32 v139, v154, v59
    v_fmac_f32 v60, v152, v59
    v_fmac_f32 v64, v89, v55
    v_fmac_f32 v131, v155, v59
    v_fmac_f32 v139, v155, v55
    v_fmac_f32 v61, v88, v60
    v_fmac_f32 v65, v88, v64
    v_mul_f32 v132, v90, v60
    v_mul_f32 v140, v154, v64
    v_fmac_f32 v61, v152, v64
    v_fmac_f32 v65, v89, v60
    v_fmac_f32 v132, v155, v64
    v_fmac_f32 v140, v155, v60
    v_fmac_f32 v62, v88, v61
    v_fmac_f32 v66, v88, v65
    v_mul_f32 v133, v90, v61
    v_mul_f32 v141, v154, v65
    v_fmac_f32 v62, v152, v65
    v_fmac_f32 v66, v89, v61
    v_fmac_f32 v133, v155, v65
    v_fmac_f32 v141, v155, v61
    v_fmac_f32 v63, v88, v62
    v_fmac_f32 v67, v88, v66
    v_mul_f32 v134, v90, v62
    v_mul_f32 v142, v154, v66
    v_fmac_f32 v63, v152, v66
    v_fmac_f32 v67, v89, v62
    v_fmac_f32 v134, v155, v66
    v_fmac_f32 v142, v155, v62
    v_mov_b32 v102, v63
    v_mov_b32 v103, v63
    v_mov_b32 v106, v67
    v_mov_b32 v107, v67
    v_mul_f32 v135, v90, v63
    v_mul_f32 v143, v154, v67
    v_permlane16_swap_b32 v102, v103
    v_permlane16_swap_b32 v106, v107
    v_mov_b32 v104, v102
    v_mov_b32 v105, v103
    v_mov_b32 v108, v106
    v_mov_b32 v109, v107
    v_fmac_f32 v135, v155, v67
    v_fmac_f32 v143, v155, v63
    v_permlane32_swap_b32 v102, v104
    v_permlane32_swap_b32 v103, v105
    v_permlane32_swap_b32 v106, v108
    v_permlane32_swap_b32 v107, v109
    v_fmac_f32 v102, v92, v94
    v_fmac_f32 v106, v92, v95
    v_fmac_f32 v102, v153, v95
    v_fmac_f32 v106, v93, v94
    v_cndmask_b32 v96, v94, v102, s[56:57]
    v_cndmask_b32 v97, v95, v106, s[56:57]
    v_fmac_f32 v103, v92, v102
    v_fmac_f32 v107, v92, v106
    v_fmac_f32 v103, v153, v106
    v_fmac_f32 v107, v93, v102
    v_cndmask_b32 v96, v96, v103, s[58:59]
    v_cndmask_b32 v97, v97, v107, s[58:59]
    v_fmac_f32 v104, v92, v103
    v_fmac_f32 v108, v92, v107
    v_fmac_f32 v104, v153, v107
    v_fmac_f32 v108, v93, v103
    v_cndmask_b32 v96, v96, v104, s[60:61]
    v_cndmask_b32 v97, v97, v108, s[60:61]
    v_fmac_f32 v105, v92, v104
    v_fmac_f32 v109, v92, v108
    v_fmac_f32 v105, v153, v108
    v_fmac_f32 v109, v93, v104
    v_xor_b32 v98, 0x80000000, v96
    v_xor_b32 v99, 0x80000000, v97
    v_mov_b32 v94, v105
    v_mov_b32 v95, v109
    v_fmac_f32 v128, v156, v96
    v_fmac_f32 v136, v156, v99
    v_fmac_f32 v128, v157, v99
    v_fmac_f32 v136, v157, v98
    v_fmac_f32 v129, v158, v96
    v_fmac_f32 v137, v158, v99
    v_fmac_f32 v129, v159, v99
    v_fmac_f32 v137, v159, v98
    v_cvt_pk_bf16_f32 v120, v128, v129
    v_cvt_pk_bf16_f32 v124, v136, v137
    v_fmac_f32 v130, v160, v96
    v_fmac_f32 v138, v160, v99
    v_fmac_f32 v130, v161, v99
    v_fmac_f32 v138, v161, v98
    v_fmac_f32 v131, v162, v96
    v_fmac_f32 v139, v162, v99
    v_fmac_f32 v131, v163, v99
    v_fmac_f32 v139, v163, v98
    v_cvt_pk_bf16_f32 v121, v130, v131
    v_cvt_pk_bf16_f32 v125, v138, v139
    v_fmac_f32 v132, v164, v96
    v_fmac_f32 v140, v164, v99
    v_fmac_f32 v132, v165, v99
    v_fmac_f32 v140, v165, v98
    v_fmac_f32 v133, v166, v96
    v_fmac_f32 v141, v166, v99
    v_fmac_f32 v133, v167, v99
    v_fmac_f32 v141, v167, v98
    v_cvt_pk_bf16_f32 v122, v132, v133
    v_cvt_pk_bf16_f32 v126, v140, v141
    v_fmac_f32 v134, v168, v96
    v_fmac_f32 v142, v168, v99
    v_fmac_f32 v134, v169, v99
    v_fmac_f32 v142, v169, v98
    v_fmac_f32 v135, v170, v96
    v_fmac_f32 v143, v170, v99
    v_fmac_f32 v135, v171, v99
    v_fmac_f32 v143, v171, v98
    v_cvt_pk_bf16_f32 v123, v134, v135
    v_cvt_pk_bf16_f32 v127, v142, v143
    ds_write_b128 v116, v[120:123] offset:0
    ds_write_b128 v116, v[124:127] offset:1024
    ds_read_b64_tr_b16 v[144:145], v117 offset:0
    ds_read_b64_tr_b16 v[146:147], v118 offset:256
    ds_read_b64_tr_b16 v[148:149], v117 offset:1024
    ds_read_b64_tr_b16 v[150:151], v118 offset:1280
    s_sub_u32 s39, s22, 1
    s_lshl_b32 s38, s39, 17
    s_add_u32 s38, s38, 0x4400000
    s_add_u32 s43, s38, 0x10000
    s_lshl_b32 s39, s39, 7
    s_add_u32 s39, s39, 0x5902000
    s_cmp_eq_u32 s37, 0
    s_cselect_b32 s38, 0x7ff00000, s38
    s_cselect_b32 s39, 0x7ff00000, s39
    s_cselect_b32 s43, 0x7ff00000, s43
    s_mov_b32 s37, 1
    s_waitcnt lgkmcnt(0)
    buffer_store_dwordx4 v[144:147], v86, s[12:15], s38 offen sc1
    buffer_store_dwordx4 v[148:151], v86, s[12:15], s43 offen sc1
    s_waitcnt vmcnt(0)
    s_barrier
    buffer_atomic_add v84, v85, s[12:15], s39 offen sc1
L_ste_238:
    s_branch L_op_205
L_g2_204:
    s_and_b32 s46, s41, 15
    s_mov_b32 s32, s98
    s_and_b32 s33, s99, 0xffff
    s_mov_b32 s34, 0x100
    s_mov_b32 s35, 0x00020000
    s_mov_b32 s25, 0
    v_mov_b32 v2, 0
L_pl_240:
    buffer_load_dword v1, v2, s[32:35], s25 offen sc1
    s_add_u32 s36, s36, 1
    s_cmp_gt_u32 s36, 0x100000
    s_cbranch_scc1 chain_kernel_wend
    s_waitcnt vmcnt(0)
    v_readfirstlane_b32 s26, v1
    s_and_b32 s27, s26, 0xffff
    s_cmp_ge_u32 s27, 256
    s_cbranch_scc1 L_plok_241
    s_sleep 4
    s_branch L_pl_240
L_plok_241:
    s_lshr_b32 s25, s26, 16
    s_cmp_gt_u32 s25, 64
    s_cselect_b32 s25, 0x2000, 0x0
    s_add_u32 s54, s100, 0x1fffff
    s_and_b32 s54, s54, 0xffe00000
    s_sub_u32 s55, s54, s100
    s_add_u32 s54, s55, s25
    s_xor_b32 s25, s25, 0x2000
    s_add_u32 s55, s55, s25
    s_lshl_b32 s44, s46, 15
    s_lshl_b32 s25, s49, 13
    s_add_u32 s44, s44, s25
    s_xor_b32 s45, s44, 0x8000
    s_add_u32 s44, s44, 0x6800000
    s_add_u32 s45, s45, 0x6800000
    s_lshr_b32 s48, s46, 1
    s_lshl_b32 s48, s48, 7
    s_add_u32 s48, s48, 0x590d000
    v_mov_b32 v104, 0
    v_mov_b32 v105, 0
    v_mov_b32 v106, 0
    v_mov_b32 v107, 0
    v_and_b32 v2, 63, v0
    v_lshlrev_b32 v3, 4, v2
    v_lshlrev_b32 v112, 4, v2
    s_add_u32 s28, s44, 0
    buffer_store_dwordx4 v[104:107], v3, s[12:15], s28 offen sc1
    s_add_u32 s28, s44, 1024
    buffer_store_dwordx4 v[104:107], v3, s[12:15], s28 offen sc1
    s_add_u32 s28, s44, 2048
    buffer_store_dwordx4 v[104:107], v3, s[12:15], s28 offen sc1
    s_add_u32 s28, s44, 3072
    buffer_store_dwordx4 v[104:107], v3, s[12:15], s28 offen sc1
    s_add_u32 s28, s44, 4096
    buffer_store_dwordx4 v[104:107], v3, s[12:15], s28 offen sc1
    s_add_u32 s28, s44, 5120
    buffer_store_dwordx4 v[104:107], v3, s[12:15], s28 offen sc1
    s_add_u32 s28, s44, 6144
    buffer_store_dwordx4 v[104:107], v3, s[12:15], s28 offen sc1
    s_add_u32 s28, s44, 7168
    buffer_store_dwordx4 v[104:107], v3, s[12:15], s28 offen sc1
    v_lshrrev_b32 v1, 6, v0
    v_lshlrev_b32 v1, 11, v1
    v_add_u32 v1, 0x21000, v1
    v_bfe_u32 v2, v0, 3, 3
    v_lshlrev_b32 v2, 4, v2
    v_xor_b32 v2, v2, v3
    v_add_u32 v113, v1, v2
    v_and_b32 v2, 15, v0
    v_lshl_add_u32 v1, v2, 7, v1
    v_bfe_u32 v2, v0, 4, 2
    v_lshlrev_b32 v2, 1, v2
    v_and_b32 v3, 7, v0
    v_xor_b32 v2, v2, v3
    v_lshl_add_u32 v114, v2, 4, v1
    v_xor_b32 v115, 16, v114
    s_waitcnt vmcnt(0)
    s_barrier
    buffer_atomic_add v84, v85, s[12:15], s48 offen sc1
    v_mov_b32 v2, 0
L_pl_242:
    buffer_load_dword v1, v2, s[12:15], s48 offen sc1
    s_add_u32 s36, s36, 1
    s_cmp_gt_u32 s36, 0x100000
    s_cbranch_scc1 chain_kernel_wend
    s_waitcnt vmcnt(0)
    v_readfirstlane_b32 s26, v1
    s_cmp_ge_u32 s26, 2
    s_cbranch_scc1 L_plok_243
    s_sleep 4
    s_branch L_pl_242
L_plok_243:
    s_and_b32 s47, s46, 1
    s_cmp_eq_u32 s47, 1
    s_cselect_b32 s16, s76, s74
    s_cselect_b32 s17, s77, s75
    s_and_b32 s17, s17, 0xffff
    s_mov_b32 s18, 0x200000
    s_mov_b32 s19, 0x00020000
    s_lshr_b32 s25, s46, 1
    s_lshl_b32 s25, s25, 7
    s_lshl_b32 s26, s49, 5
    s_add_u32 s25, s25, s26
    v_and_b32 v5, 7, v0
    v_lshl_add_u32 v5, v5, 2, s25
    s_lshl_b32 s26, s47, 4
    v_bfe_u32 v6, v0, 3, 3
    v_add_u32 v6, s26, v6
    v_lshlrev_b32 v7, 1, v5
    v_lshl_add_u32 v136, v6, 11, v7
    v_add_u32 v137, 0x4000, v136
    v_lshlrev_b32 v5, 2, v5
    v_lshl_add_u32 v138, v6, 13, v5
    v_add_u32 v139, 0x10000, v138
    s_mov_b32 s32, s80
    s_and_b32 s33, s81, 0xffff
    s_mov_b32 s34, 0x800
    s_mov_b32 s35, 0x00020000
    buffer_load_dwordx2 v[132:133], v7, s[32:35], 0 offen
    v_and_b32 v1, 31, v0
    v_bfe_u32 v2, v0, 5, 1
    v_add_u32 v3, 0, v2
    v_xor_b32 v4, v3, v1
    v_lshlrev_b32 v4, 4, v4
    v_and_b32 v5, 12, v3
    v_add_u32 v3, v3, v5
    v_add_u32 v3, s25, v3
    v_lshl_add_u32 v20, v3, 11, v4
    v_add_u32 v3, 2, v2
    v_xor_b32 v4, v3, v1
    v_lshlrev_b32 v4, 4, v4
    v_and_b32 v5, 12, v3
    v_add_u32 v3, v3, v5
    v_add_u32 v3, s25, v3
    v_lshl_add_u32 v21, v3, 11, v4
    v_add_u32 v3, 4, v2
    v_xor_b32 v4, v3, v1
    v_lshlrev_b32 v4, 4, v4
    v_and_b32 v5, 12, v3
    v_add_u32 v3, v3, v5
    v_add_u32 v3, s25, v3
    v_lshl_add_u32 v22, v3, 11, v4
    v_add_u32 v3, 6, v2
    v_xor_b32 v4, v3, v1
    v_lshlrev_b32 v4, 4, v4
    v_and_b32 v5, 12, v3
    v_add_u32 v3, v3, v5
    v_add_u32 v3, s25, v3
    v_lshl_add_u32 v23, v3, 11, v4
    v_add_u32 v3, 8, v2
    v_xor_b32 v4, v3, v1
    v_lshlrev_b32 v4, 4, v4
    v_and_b32 v5, 12, v3
    v_add_u32 v3, v3, v5
    v_add_u32 v3, s25, v3
    v_lshl_add_u32 v24, v3, 11, v4
    v_add_u32 v3, 10, v2
    v_xor_b32 v4, v3, v1
    v_lshlrev_b32 v4, 4, v4
    v_and_b32 v5, 12, v3
    v_add_u32 v3, v3, v5
    v_add_u32 v3, s25, v3
    v_lshl_add_u32 v25, v3, 11, v4
    v_add_u32 v3, 12, v2
    v_xor_b32 v4, v3, v1
    v_lshlrev_b32 v4, 4, v4
    v_and_b32 v5, 12, v3
    v_add_u32 v3, v3, v5
    v_add_u32 v3, s25, v3
    v_lshl_add_u32 v26, v3, 11, v4
    v_add_u32 v3, 14, v2
    v_xor_b32 v4, v3, v1
    v_lshlrev_b32 v4, 4, v4
    v_and_b32 v5, 12, v3
    v_add_u32 v3, v3, v5
    v_add_u32 v3, s25, v3
    v_lshl_add_u32 v27, v3, 11, v4
    v_and_b32 v1, 15, v0
    v_bfe_u32 v2, v0, 4, 2
    v_lshrrev_b32 v3, 6, v0
    v_lshlrev_b32 v3, 15, v3
    v_lshl_add_u32 v3, v1, 9, v3
    v_add_u32 v4, 0, v2
    v_xor_b32 v4, v4, v1
    v_lshl_add_u32 v28, v4, 4, v3
    v_add_u32 v4, 4, v2
    v_xor_b32 v4, v4, v1
    v_lshl_add_u32 v29, v4, 4, v3
    v_add_u32 v4, 8, v2
    v_xor_b32 v4, v4, v1
    v_lshl_add_u32 v30, v4, 4, v3
    v_add_u32 v4, 12, v2
    v_xor_b32 v4, v4, v1
    v_lshl_add_u32 v31, v4, 4, v3
    s_lshl_b32 s26, s49, 15
    s_barrier
    s_mov_b32 s27, 0
    s_add_u32 m0, s26, 0
    s_nop 0
    buffer_load_dwordx4 v20, s[16:19], s27 offen nt lds
    s_add_u32 m0, s26, 1024
    s_nop 0
    buffer_load_dwordx4 v21, s[16:19], s27 offen nt lds
    s_add_u32 m0, s26, 2048
    s_nop 0
    buffer_load_dwordx4 v22, s[16:19], s27 offen nt lds
    s_add_u32 m0, s26, 3072
    s_nop 0
    buffer_load_dwordx4 v23, s[16:19], s27 offen nt lds
    s_add_u32 m0, s26, 4096
    s_nop 0
    buffer_load_dwordx4 v24, s[16:19], s27 offen nt lds
    s_add_u32 m0, s26, 5120
    s_nop 0
    buffer_load_dwordx4 v25, s[16:19], s27 offen nt lds
    s_add_u32 m0, s26, 6144
    s_nop 0
    buffer_load_dwordx4 v26, s[16:19], s27 offen nt lds
    s_add_u32 m0, s26, 7168
    s_nop 0
    buffer_load_dwordx4 v27, s[16:19], s27 offen nt lds
    s_mov_b32 s27, 8192
    s_add_u32 m0, s26, 8192
    s_nop 0
    buffer_load_dwordx4 v20, s[16:19], s27 offen nt lds
    s_add_u32 m0, s26, 9216
    s_nop 0
    buffer_load_dwordx4 v21, s[16:19], s27 offen nt lds
    s_add_u32 m0, s26, 10240
    s_nop 0
    buffer_load_dwordx4 v22, s[16:19], s27 offen nt lds
    s_add_u32 m0, s26, 11264
    s_nop 0
    buffer_load_dwordx4 v23, s[16:19], s27 offen nt lds
    s_add_u32 m0, s26, 12288
    s_nop 0
    buffer_load_dwordx4 v24, s[16:19], s27 offen nt lds
    s_add_u32 m0, s26, 13312
    s_nop 0
    buffer_load_dwordx4 v25, s[16:19], s27 offen nt lds
    s_add_u32 m0, s26, 14336
    s_nop 0
    buffer_load_dwordx4 v26, s[16:19], s27 offen nt lds
    s_add_u32 m0, s26, 15360
    s_nop 0
    buffer_load_dwordx4 v27, s[16:19], s27 offen nt lds
    s_mov_b32 s27, 512
    s_add_u32 m0, s26, 16384
    s_nop 0
    buffer_load_dwordx4 v20, s[16:19], s27 offen nt lds
    s_add_u32 m0, s26, 17408
    s_nop 0
    buffer_load_dwordx4 v21, s[16:19], s27 offen nt lds
    s_add_u32 m0, s26, 18432
    s_nop 0
    buffer_load_dwordx4 v22, s[16:19], s27 offen nt lds
    s_add_u32 m0, s26, 19456
    s_nop 0
    buffer_load_dwordx4 v23, s[16:19], s27 offen nt lds
    s_add_u32 m0, s26, 20480
    s_nop 0
    buffer_load_dwordx4 v24, s[16:19], s27 offen nt lds
    s_add_u32 m0, s26, 21504
    s_nop 0
    buffer_load_dwordx4 v25, s[16:19], s27 offen nt lds
    s_add_u32 m0, s26, 22528
    s_nop 0
    buffer_load_dwordx4 v26, s[16:19], s27 offen nt lds
    s_add_u32 m0, s26, 23552
    s_nop 0
    buffer_load_dwordx4 v27, s[16:19], s27 offen nt lds
    s_mov_b32 s27, 8704
    s_add_u32 m0, s26, 24576
    s_nop 0
    buffer_load_dwordx4 v20, s[16:19], s27 offen nt lds
    s_add_u32 m0, s26, 25600
    s_nop 0
    buffer_load_dwordx4 v21, s[16:19], s27 offen nt lds
    s_add_u32 m0, s26, 26624
    s_nop 0
    buffer_load_dwordx4 v22, s[16:19], s27 offen nt lds
    s_add_u32 m0, s26, 27648
    s_nop 0
    buffer_load_dwordx4 v23, s[16:19], s27 offen nt lds
    s_add_u32 m0, s26, 28672
    s_nop 0
    buffer_load_dwordx4 v24, s[16:19], s27 offen nt lds
    s_add_u32 m0, s26, 29696
    s_nop 0
    buffer_load_dwordx4 v25, s[16:19], s27 offen nt lds
    s_add_u32 m0, s26, 30720
    s_nop 0
    buffer_load_dwordx4 v26, s[16:19], s27 offen nt lds
    s_add_u32 m0, s26, 31744
    s_nop 0
    buffer_load_dwordx4 v27, s[16:19], s27 offen nt lds
    s_waitcnt vmcnt(16)
    ds_read_b128 a[0:3], v28 offset:0
    ds_read_b128 a[4:7], v28 offset:8192
    ds_read_b128 a[8:11], v29 offset:0
    ds_read_b128 a[12:15], v29 offset:8192
    ds_read_b128 a[16:19], v30 offset:0
    ds_read_b128 a[20:23], v30 offset:8192
    ds_read_b128 a[24:27], v31 offset:0
    ds_read_b128 a[28:31], v31 offset:8192
    s_waitcnt lgkmcnt(0)
    ds_read_b128 a[32:35], v28 offset:256
    ds_read_b128 a[36:39], v28 offset:8448
    ds_read_b128 a[40:43], v29 offset:256
    ds_read_b128 a[44:47], v29 offset:8448
    ds_read_b128 a[48:51], v30 offset:256
    ds_read_b128 a[52:55], v30 offset:8448
    ds_read_b128 a[56:59], v31 offset:256
    ds_read_b128 a[60:63], v31 offset:8448
    s_waitcnt lgkmcnt(0)
    s_mov_b32 s27, 1024
    s_add_u32 m0, s26, 0
    s_nop 0
    buffer_load_dwordx4 v20, s[16:19], s27 offen nt lds
    s_add_u32 m0, s26, 1024
    s_nop 0
    buffer_load_dwordx4 v21, s[16:19], s27 offen nt lds
    s_add_u32 m0, s26, 2048
    s_nop 0
    buffer_load_dwordx4 v22, s[16:19], s27 offen nt lds
    s_add_u32 m0, s26, 3072
    s_nop 0
    buffer_load_dwordx4 v23, s[16:19], s27 offen nt lds
    s_add_u32 m0, s26, 4096
    s_nop 0
    buffer_load_dwordx4 v24, s[16:19], s27 offen nt lds
    s_add_u32 m0, s26, 5120
    s_nop 0
    buffer_load_dwordx4 v25, s[16:19], s27 offen nt lds
    s_add_u32 m0, s26, 6144
    s_nop 0
    buffer_load_dwordx4 v26, s[16:19], s27 offen nt lds
    s_add_u32 m0, s26, 7168
    s_nop 0
    buffer_load_dwordx4 v27, s[16:19], s27 offen nt lds
    s_mov_b32 s27, 9216
    s_add_u32 m0, s26, 8192
    s_nop 0
    buffer_load_dwordx4 v20, s[16:19], s27 offen nt lds
    s_add_u32 m0, s26, 9216
    s_nop 0
    buffer_load_dwordx4 v21, s[16:19], s27 offen nt lds
    s_add_u32 m0, s26, 10240
    s_nop 0
    buffer_load_dwordx4 v22, s[16:19], s27 offen nt lds
    s_add_u32 m0, s26, 11264
    s_nop 0
    buffer_load_dwordx4 v23, s[16:19], s27 offen nt lds
    s_add_u32 m0, s26, 12288
    s_nop 0
    buffer_load_dwordx4 v24, s[16:19], s27 offen nt lds
    s_add_u32 m0, s26, 13312
    s_nop 0
    buffer_load_dwordx4 v25, s[16:19], s27 offen nt lds
    s_add_u32 m0, s26, 14336
    s_nop 0
    buffer_load_dwordx4 v26, s[16:19], s27 offen nt lds
    s_add_u32 m0, s26, 15360
    s_nop 0
    buffer_load_dwordx4 v27, s[16:19], s27 offen nt lds
    s_waitcnt vmcnt(16)
    ds_read_b128 a[64:67], v28 offset:16384
    ds_read_b128 a[68:71], v28 offset:24576
    ds_read_b128 a[72:75], v29 offset:16384
    ds_read_b128 a[76:79], v29 offset:24576
    ds_read_b128 a[80:83], v30 offset:16384
    ds_read_b128 a[84:87], v30 offset:24576
    ds_read_b128 a[88:91], v31 offset:16384
    ds_read_b128 a[92:95], v31 offset:24576
    s_waitcnt lgkmcnt(0)
    ds_read_b128 a[96:99], v28 offset:16640
    ds_read_b128 a[100:103], v28 offset:24832
    ds_read_b128 a[104:107], v29 offset:16640
    ds_read_b128 a[108:111], v29 offset:24832
    ds_read_b128 a[112:115], v30 offset:16640
    ds_read_b128 a[116:119], v30 offset:24832
    ds_read_b128 a[120:123], v31 offset:16640
    ds_read_b128 a[124:127], v31 offset:24832
    s_waitcnt lgkmcnt(0)
    s_mov_b32 s27, 1536
    s_add_u32 m0, s26, 16384
    s_nop 0
    buffer_load_dwordx4 v20, s[16:19], s27 offen nt lds
    s_add_u32 m0, s26, 17408
    s_nop 0
    buffer_load_dwordx4 v21, s[16:19], s27 offen nt lds
    s_add_u32 m0, s26, 18432
    s_nop 0
    buffer_load_dwordx4 v22, s[16:19], s27 offen nt lds
    s_add_u32 m0, s26, 19456
    s_nop 0
    buffer_load_dwordx4 v23, s[16:19], s27 offen nt lds
    s_add_u32 m0, s26, 20480
    s_nop 0
    buffer_load_dwordx4 v24, s[16:19], s27 offen nt lds
    s_add_u32 m0, s26, 21504
    s_nop 0
    buffer_load_dwordx4 v25, s[16:19], s27 offen nt lds
    s_add_u32 m0, s26, 22528
    s_nop 0
    buffer_load_dwordx4 v26, s[16:19], s27 offen nt lds
    s_add_u32 m0, s26, 23552
    s_nop 0
    buffer_load_dwordx4 v27, s[16:19], s27 offen nt lds
    s_mov_b32 s27, 9728
    s_add_u32 m0, s26, 24576
    s_nop 0
    buffer_load_dwordx4 v20, s[16:19], s27 offen nt lds
    s_add_u32 m0, s26, 25600
    s_nop 0
    buffer_load_dwordx4 v21, s[16:19], s27 offen nt lds
    s_add_u32 m0, s26, 26624
    s_nop 0
    buffer_load_dwordx4 v22, s[16:19], s27 offen nt lds
    s_add_u32 m0, s26, 27648
    s_nop 0
    buffer_load_dwordx4 v23, s[16:19], s27 offen nt lds
    s_add_u32 m0, s26, 28672
    s_nop 0
    buffer_load_dwordx4 v24, s[16:19], s27 offen nt lds
    s_add_u32 m0, s26, 29696
    s_nop 0
    buffer_load_dwordx4 v25, s[16:19], s27 offen nt lds
    s_add_u32 m0, s26, 30720
    s_nop 0
    buffer_load_dwordx4 v26, s[16:19], s27 offen nt lds
    s_add_u32 m0, s26, 31744
    s_nop 0
    buffer_load_dwordx4 v27, s[16:19], s27 offen nt lds
    s_waitcnt vmcnt(16)
    ds_read_b128 a[128:131], v28 offset:0
    ds_read_b128 a[132:135], v28 offset:8192
    ds_read_b128 a[136:139], v29 offset:0
    ds_read_b128 a[140:143], v29 offset:8192
    ds_read_b128 a[144:147], v30 offset:0
    ds_read_b128 a[148:151], v30 offset:8192
    ds_read_b128 a[152:155], v31 offset:0
    ds_read_b128 a[156:159], v31 offset:8192
    s_waitcnt lgkmcnt(0)
    ds_read_b128 a[160:163], v28 offset:256
    ds_read_b128 a[164:167], v28 offset:8448
    ds_read_b128 a[168:171], v29 offset:256
    ds_read_b128 a[172:175], v29 offset:8448
    ds_read_b128 a[176:179], v30 offset:256
    ds_read_b128 a[180:183], v30 offset:8448
    ds_read_b128 a[184:187], v31 offset:256
    ds_read_b128 a[188:191], v31 offset:8448
    s_waitcnt lgkmcnt(0)
    s_waitcnt vmcnt(0)
    ds_read_b128 a[192:195], v28 offset:16384
    ds_read_b128 a[196:199], v28 offset:24576
    ds_read_b128 a[200:203], v29 offset:16384
    ds_read_b128 a[204:207], v29 offset:24576
    ds_read_b128 a[208:211], v30 offset:16384
    ds_read_b128 a[212:215], v30 offset:24576
    ds_read_b128 a[216:219], v31 offset:16384
    ds_read_b128 a[220:223], v31 offset:24576
    s_waitcnt lgkmcnt(0)
    ds_read_b128 a[224:227], v28 offset:16640
    ds_read_b128 a[228:231], v28 offset:24832
    ds_read_b128 a[232:235], v29 offset:16640
    ds_read_b128 a[236:239], v29 offset:24832
    ds_read_b128 a[240:243], v30 offset:16640
    ds_read_b128 a[244:247], v30 offset:24832
    ds_read_b128 a[248:251], v31 offset:16640
    ds_read_b128 a[252:255], v31 offset:24832
    s_waitcnt lgkmcnt(0)
    v_lshlrev_b32 v128, 16, v132
    v_and_b32 v129, 0xffff0000, v132
    v_lshlrev_b32 v130, 16, v133
    v_and_b32 v131, 0xffff0000, v133
    s_mov_b32 s48, 0x5902000
    s_lshl_b32 s50, s47, 16
    s_add_u32 s50, s50, 0x4400000
    s_mov_b32 s8, s100
    s_and_b32 s9, s101, 0xffff
    s_mov_b32 s10, 0x10000000
    s_mov_b32 s11, 0x00020000
    s_mov_b32 s16, s96
    s_and_b32 s17, s97, 0xffff
    s_mov_b32 s18, 0x1000000
    s_mov_b32 s19, 0x00020000
    s_mov_b32 s32, s64
    s_and_b32 s33, s65, 0xffff
    s_mov_b32 s34, 0x400000
    s_mov_b32 s35, 0x00020000
    s_lshl_b32 s47, s47, 8
    s_lshl_b32 s21, s49, 12
    v_and_b32 v1, 63, v0
    v_and_b32 v2, 15, v0
    v_bfe_u32 v3, v0, 4, 2
    v_lshrrev_b32 v4, 6, v0
    v_lshlrev_b32 v5, 4, v1
    v_lshl_add_u32 v5, v4, 12, v5
    v_add_u32 v8, 0, v5
    v_add_u32 v9, 1024, v5
    v_add_u32 v10, 2048, v5
    v_add_u32 v11, 3072, v5
    v_lshlrev_b32 v5, 4, v2
    v_lshl_add_u32 v5, v3, 9, v5
    v_xor_b32 v12, s47, v5
    v_xor_b32 v13, 0x100, v12
    v_add_u32 v16, 0x10000, v12
    v_add_u32 v17, 0x10000, v13
    s_mov_b32 s22, 0
    s_mov_b32 s52, 0
    v_mov_b32 v2, 0x20000
    v_lshl_add_u32 v3, v0, 2, v2
    v_mov_b32 v4, 0
L_run_244:
    s_mov_b32 s25, s22
    s_cmp_ge_u32 s25, 64
    s_cbranch_scc1 L_rdone_247
    s_add_u32 s28, s22, 3
    s_min_u32 s28, s28, 63
    s_add_u32 s29, s22, 1
    s_add_u32 s25, s28, 0
    s_cmp_lt_u32 s25, 64
    s_cselect_b32 s25, s25, 0x800000
    s_lshl_b32 s25, s25, 7
    s_add_u32 s25, s25, s48
    s_add_u32 s26, s22, 1
    s_cmp_lt_u32 s26, 64
    s_cselect_b32 s26, s26, 0x800000
    s_lshl_b32 s26, s26, 7
    s_add_u32 s26, s26, s48
    s_add_u32 s27, s29, 1
    s_cmp_lt_u32 s27, 64
    s_cselect_b32 s27, s27, 0x800000
    s_lshl_b32 s27, s27, 7
    s_add_u32 s27, s27, s48
L_rw_245:
    buffer_load_dword v88, v4, s[12:15], s25 offen sc1
    buffer_load_dword v89, v4, s[12:15], s26 offen sc1
    buffer_load_dword v90, v4, s[12:15], s27 offen sc1
    s_add_u32 s36, s36, 1
    s_cmp_gt_u32 s36, 0x100000
    s_cbranch_scc1 chain_kernel_wend
    s_waitcnt vmcnt(0)
    s_barrier
    v_lshl_add_u32 v1, v0, 4, v2
    ds_write_b128 v1, v[88:91]
    s_waitcnt lgkmcnt(0)
    s_barrier
    ds_read_b128 v[88:91], v2
    s_waitcnt lgkmcnt(0)
    v_readfirstlane_b32 s28, v88
    s_cmp_ge_u32 s28, 16
    s_cbranch_scc1 L_rgo_246
    s_sleep 2
    s_branch L_rw_245
L_rgo_246:
    v_readfirstlane_b32 s51, v89
    v_mov_b32 v87, v90
    s_mov_b32 s24, s22
    s_add_u32 s23, s22, 1
    s_mov_b32 s37, 0
    s_mov_b32 s7, 0
    v_mov_b32 v88, 0
    v_mov_b32 v89, 0
    v_mov_b32 v90, 0
    v_mov_b32 v91, 0
    v_mov_b32 v92, 0
    v_mov_b32 v93, 0
    v_mov_b32 v94, 0
    v_mov_b32 v95, 0
    s_lshl_b32 s53, s24, 17
    s_add_u32 s53, s53, s50
    s_mov_b32 s20, s53
    s_mov_b32 s39, 0x7ff00000
    s_mov_b32 s42, 0x7ff00000
    s_mov_b32 s43, 0x7ff00000
    s_barrier
    s_add_u32 m0, s21, 0
    s_nop 0
    buffer_load_dwordx4 v8, s[8:11], s20 offen lds
    s_add_u32 m0, s21, 1024
    s_nop 0
    buffer_load_dwordx4 v9, s[8:11], s20 offen lds
    s_add_u32 m0, s21, 2048
    s_nop 0
    buffer_load_dwordx4 v10, s[8:11], s20 offen lds
    s_add_u32 m0, s21, 3072
    s_nop 0
    buffer_load_dwordx4 v11, s[8:11], s20 offen lds
    s_add_u32 s20, s20, 16384
    s_add_u32 m0, s21, 16384
    s_nop 0
    buffer_load_dwordx4 v8, s[8:11], s20 offen lds
    s_add_u32 m0, s21, 17408
    s_nop 0
    buffer_load_dwordx4 v9, s[8:11], s20 offen lds
    s_add_u32 m0, s21, 18432
    s_nop 0
    buffer_load_dwordx4 v10, s[8:11], s20 offen lds
    s_add_u32 m0, s21, 19456
    s_nop 0
    buffer_load_dwordx4 v11, s[8:11], s20 offen lds
    s_add_u32 s20, s20, 16384
    s_add_u32 m0, s21, 32768
    s_nop 0
    buffer_load_dwordx4 v8, s[8:11], s20 offen lds
    s_add_u32 m0, s21, 33792
    s_nop 0
    buffer_load_dwordx4 v9, s[8:11], s20 offen lds
    s_add_u32 m0, s21, 34816
    s_nop 0
    buffer_load_dwordx4 v10, s[8:11], s20 offen lds
    s_add_u32 m0, s21, 35840
    s_nop 0
    buffer_load_dwordx4 v11, s[8:11], s20 offen lds
    s_add_u32 s20, s20, 16384
    s_add_u32 m0, s21, 49152
    s_nop 0
    buffer_load_dwordx4 v8, s[8:11], s20 offen lds
    s_add_u32 m0, s21, 50176
    s_nop 0
    buffer_load_dwordx4 v9, s[8:11], s20 offen lds
    s_add_u32 m0, s21, 51200
    s_nop 0
    buffer_load_dwordx4 v10, s[8:11], s20 offen lds
    s_add_u32 m0, s21, 52224
    s_nop 0
    buffer_load_dwordx4 v11, s[8:11], s20 offen lds
    s_cmp_ge_u32 s51, 16
    s_cselect_b32 s30, 1, 0
    s_add_u32 s24, s24, s30
    s_add_u32 s23, s23, s30
    s_lshl_b32 s53, s24, 17
    s_add_u32 s53, s53, s50
    s_mov_b32 s20, s53
    s_add_u32 m0, s21, 65536
    s_nop 0
    buffer_load_dwordx4 v8, s[8:11], s20 offen lds
    s_add_u32 m0, s21, 66560
    s_nop 0
    buffer_load_dwordx4 v9, s[8:11], s20 offen lds
    s_add_u32 m0, s21, 67584
    s_nop 0
    buffer_load_dwordx4 v10, s[8:11], s20 offen lds
    s_add_u32 m0, s21, 68608
    s_nop 0
    buffer_load_dwordx4 v11, s[8:11], s20 offen lds
    s_add_u32 s20, s20, 16384
    s_add_u32 m0, s21, 81920
    s_nop 0
    buffer_load_dwordx4 v8, s[8:11], s20 offen lds
    s_add_u32 m0, s21, 82944
    s_nop 0
    buffer_load_dwordx4 v9, s[8:11], s20 offen lds
    s_add_u32 m0, s21, 83968
    s_nop 0
    buffer_load_dwordx4 v10, s[8:11], s20 offen lds
    s_add_u32 m0, s21, 84992
    s_nop 0
    buffer_load_dwordx4 v11, s[8:11], s20 offen lds
    s_add_u32 s20, s20, 16384
    s_add_u32 m0, s21, 98304
    s_nop 0
    buffer_load_dwordx4 v8, s[8:11], s20 offen lds
    s_waitcnt vmcnt(21)
    s_barrier
    ds_read_b128 v[20:23], v12 offset:0
    ds_read_b128 v[24:27], v13 offset:0
    ds_read_b128 v[28:31], v12 offset:2048
    ds_read_b128 v[32:35], v13 offset:2048
    ds_read_b128 v[36:39], v12 offset:4096
    ds_read_b128 v[40:43], v13 offset:4096
    s_waitcnt lgkmcnt(4)
L_st_251:
    v_mfma_f32_16x16x32_bf16 v[52:55], a[0:3], v[20:23], 0
    ds_read_b128 v[44:47], v12 offset:6144
    s_add_u32 m0, s21, 99328
    v_mfma_f32_16x16x32_bf16 v[56:59], a[4:7], v[20:23], 0
    buffer_load_dwordx4 v9, s[8:11], s20 offen lds
    v_mfma_f32_16x16x32_bf16 v[60:63], a[0:3], v[24:27], 0
    ds_read_b128 v[48:51], v13 offset:6144
    s_sub_u32 s38, s22, 1
    v_mfma_f32_16x16x32_bf16 v[64:67], a[4:7], v[24:27], 0
    s_waitcnt lgkmcnt(4)
    s_and_b32 s31, s38, 3
    v_mfma_f32_16x16x32_bf16 v[52:55], a[8:11], v[28:31], v[52:55]
    ds_read_b128 v[20:23], v12 offset:8192
    s_waitcnt vmcnt(12)
    ds_write_b32 v3, v87
    v_mfma_f32_16x16x32_bf16 v[56:59], a[12:15], v[28:31], v[56:59]
    buffer_load_dwordx2 v[132:133], v136, s[32:35], s42 offen
    v_mfma_f32_16x16x32_bf16 v[60:63], a[8:11], v[32:35], v[60:63]
    ds_read_b128 v[24:27], v13 offset:8192
    s_lshl_b32 s31, s31, 11
    v_mfma_f32_16x16x32_bf16 v[64:67], a[12:15], v[32:35], v[64:67]
    s_waitcnt lgkmcnt(4)
    v_mfma_f32_16x16x32_bf16 v[52:55], a[16:19], v[36:39], v[52:55]
    ds_read_b128 v[28:31], v12 offset:10240
    s_add_u32 m0, s21, 100352
    v_mfma_f32_16x16x32_bf16 v[56:59], a[20:23], v[36:39], v[56:59]
    buffer_load_dwordx4 v10, s[8:11], s20 offen lds
    v_mfma_f32_16x16x32_bf16 v[60:63], a[16:19], v[40:43], v[60:63]
    ds_read_b128 v[32:35], v13 offset:10240
    s_bfe_u32 s38, s38, 0x10002
    v_mfma_f32_16x16x32_bf16 v[64:67], a[20:23], v[40:43], v[64:67]
    s_waitcnt lgkmcnt(4)
    s_xor_b32 s38, s38, 1
    v_mfma_f32_16x16x32_bf16 v[52:55], a[24:27], v[44:47], v[52:55]
    ds_read_b128 v[36:39], v12 offset:12288
    s_cmp_eq_u32 s37, 0
    s_cselect_b32 s31, 0x40000000, s31
    s_cselect_b32 s38, 0, s38
    v_mfma_f32_16x16x32_bf16 v[56:59], a[28:31], v[44:47], v[56:59]
    buffer_load_dwordx2 v[134:135], v137, s[32:35], s42 offen
    v_mfma_f32_16x16x32_bf16 v[60:63], a[24:27], v[48:51], v[60:63]
    ds_read_b128 v[40:43], v13 offset:12288
    v_mfma_f32_16x16x32_bf16 v[64:67], a[28:31], v[48:51], v[64:67]
    s_waitcnt lgkmcnt(4)
    v_mfma_f32_16x16x32_bf16 v[52:55], a[32:35], v[20:23], v[52:55]
    ds_read_b128 v[44:47], v12 offset:14336
    s_add_u32 m0, s21, 101376
    v_mfma_f32_16x16x32_bf16 v[56:59], a[36:39], v[20:23], v[56:59]
    buffer_load_dwordx4 v11, s[8:11], s20 offen lds
    v_mfma_f32_16x16x32_bf16 v[60:63], a[32:35], v[24:27], v[60:63]
    ds_read_b128 v[48:51], v13 offset:14336
    v_mfma_f32_16x16x32_bf16 v[64:67], a[36:39], v[24:27], v[64:67]
    s_waitcnt lgkmcnt(4)
    v_cvt_pk_bf16_f32 v104, v76, v77
    v_mfma_f32_16x16x32_bf16 v[52:55], a[40:43], v[28:31], v[52:55]
    s_waitcnt vmcnt(20)
    s_barrier
    ds_read_b128 v[20:23], v12 offset:16384
    v_mfma_f32_16x16x32_bf16 v[56:59], a[44:47], v[28:31], v[56:59]
    s_add_u32 s20, s20, 16384
    v_mfma_f32_16x16x32_bf16 v[60:63], a[40:43], v[32:35], v[60:63]
    ds_read_b128 v[24:27], v13 offset:16384
    ds_read_b32 v1, v2
    v_mfma_f32_16x16x32_bf16 v[64:67], a[44:47], v[32:35], v[64:67]
    s_waitcnt lgkmcnt(4)
    v_cvt_pk_bf16_f32 v105, v78, v79
    v_mfma_f32_16x16x32_bf16 v[52:55], a[48:51], v[36:39], v[52:55]
    ds_read_b128 v[28:31], v12 offset:18432
    s_add_u32 m0, s21, 114688
    v_mfma_f32_16x16x32_bf16 v[56:59], a[52:55], v[36:39], v[56:59]
    buffer_load_dwordx4 v8, s[8:11], s20 offen lds
    v_mfma_f32_16x16x32_bf16 v[60:63], a[48:51], v[40:43], v[60:63]
    ds_read_b128 v[32:35], v13 offset:18432
    v_cvt_pk_bf16_f32 v106, v80, v81
    v_mfma_f32_16x16x32_bf16 v[64:67], a[52:55], v[40:43], v[64:67]
    s_waitcnt lgkmcnt(4)
    v_cvt_pk_bf16_f32 v107, v82, v83
    v_mfma_f32_16x16x32_bf16 v[52:55], a[56:59], v[44:47], v[52:55]
    ds_read_b128 v[36:39], v12 offset:20480
    v_mfma_f32_16x16x32_bf16 v[56:59], a[60:63], v[44:47], v[56:59]
    v_and_or_b32 v104, v104, -2, s38
    v_and_or_b32 v105, v105, -2, s38
    v_mfma_f32_16x16x32_bf16 v[60:63], a[56:59], v[48:51], v[60:63]
    ds_read_b128 v[40:43], v13 offset:20480
    v_and_or_b32 v106, v106, -2, s38
    v_mfma_f32_16x16x32_bf16 v[64:67], a[60:63], v[48:51], v[64:67]
    s_waitcnt lgkmcnt(4)
    v_mfma_f32_16x16x32_bf16 v[52:55], a[64:67], v[20:23], v[52:55]
    ds_read_b128 v[44:47], v12 offset:22528
    s_add_u32 m0, s21, 115712
    v_mfma_f32_16x16x32_bf16 v[56:59], a[68:71], v[20:23], v[56:59]
    buffer_load_dwordx4 v9, s[8:11], s20 offen lds
    v_mfma_f32_16x16x32_bf16 v[60:63], a[64:67], v[24:27], v[60:63]
    ds_read_b128 v[48:51], v13 offset:22528
    v_and_or_b32 v107, v107, -2, s38
    v_mfma_f32_16x16x32_bf16 v[64:67], a[68:71], v[24:27], v[64:67]
    s_waitcnt lgkmcnt(4)
    s_add_u32 s29, s45, s31
    v_mfma_f32_16x16x32_bf16 v[52:55], a[72:75], v[28:31], v[52:55]
    ds_read_b128 v[20:23], v12 offset:24576
    v_mfma_f32_16x16x32_bf16 v[56:59], a[76:79], v[28:31], v[56:59]
    buffer_store_dwordx4 v[104:107], v112, s[12:15], s29 offen offset:0 sc1
    v_mfma_f32_16x16x32_bf16 v[60:63], a[72:75], v[32:35], v[60:63]
    ds_read_b128 v[24:27], v13 offset:24576
    v_readfirstlane_b32 s51, v1
    v_mfma_f32_16x16x32_bf16 v[64:67], a[76:79], v[32:35], v[64:67]
    s_waitcnt lgkmcnt(4)
    s_add_u32 s30, s22, 1
    v_mfma_f32_16x16x32_bf16 v[52:55], a[80:83], v[36:39], v[52:55]
    ds_read_b128 v[28:31], v12 offset:26624
    s_add_u32 m0, s21, 116736
    v_mfma_f32_16x16x32_bf16 v[56:59], a[84:87], v[36:39], v[56:59]
    buffer_load_dwordx4 v10, s[8:11], s20 offen lds
    v_mfma_f32_16x16x32_bf16 v[60:63], a[80:83], v[40:43], v[60:63]
    ds_read_b128 v[32:35], v13 offset:26624
    s_cmp_eq_u32 s30, s24
    s_cselect_b32 s51, s51, 0
    v_mfma_f32_16x16x32_bf16 v[64:67], a[84:87], v[40:43], v[64:67]
    s_waitcnt lgkmcnt(4)
    v_mfma_f32_16x16x32_bf16 v[52:55], a[88:91], v[44:47], v[52:55]
    ds_read_b128 v[36:39], v12 offset:28672
    s_cmp_ge_u32 s51, 16
    s_cselect_b32 s30, 1, 0
    v_mfma_f32_16x16x32_bf16 v[56:59], a[92:95], v[44:47], v[56:59]
    s_add_u32 s24, s24, s30
    v_mfma_f32_16x16x32_bf16 v[60:63], a[88:91], v[48:51], v[60:63]
    ds_read_b128 v[40:43], v13 offset:28672
    s_add_u32 s23, s23, s30
    v_mfma_f32_16x16x32_bf16 v[64:67], a[92:95], v[48:51], v[64:67]
    s_waitcnt lgkmcnt(4)
    s_lshl_b32 s53, s24, 17
    v_mfma_f32_16x16x32_bf16 v[52:55], a[96:99], v[20:23], v[52:55]
    ds_read_b128 v[44:47], v12 offset:30720
    s_add_u32 m0, s21, 117760
    v_mfma_f32_16x16x32_bf16 v[56:59], a[100:103], v[20:23], v[56:59]
    buffer_load_dwordx4 v11, s[8:11], s20 offen lds
    v_mfma_f32_16x16x32_bf16 v[60:63], a[96:99], v[24:27], v[60:63]
    ds_read_b128 v[48:51], v13 offset:30720
    s_add_u32 s53, s53, s50
    v_mfma_f32_16x16x32_bf16 v[64:67], a[100:103], v[24:27], v[64:67]
    s_waitcnt lgkmcnt(4)
    v_mfma_f32_16x16x32_bf16 v[52:55], a[104:107], v[28:31], v[52:55]
    s_waitcnt vmcnt(20)
    s_barrier
    ds_read_b128 v[20:23], v12 offset:32768
    v_mfma_f32_16x16x32_bf16 v[56:59], a[108:111], v[28:31], v[56:59]
    s_mov_b32 s20, s53
    s_add_u32 s30, s24, 1
    v_mfma_f32_16x16x32_bf16 v[60:63], a[104:107], v[32:35], v[60:63]
    ds_read_b128 v[24:27], v13 offset:32768
    s_cmp_lt_u32 s30, 64
    s_cselect_b32 s30, s30, 0x800000
    v_mfma_f32_16x16x32_bf16 v[64:67], a[108:111], v[32:35], v[64:67]
    s_waitcnt lgkmcnt(4)
    s_waitcnt vmcnt(10)
    v_xor_b32 v124, s7, v88
    v_mfma_f32_16x16x32_bf16 v[52:55], a[112:115], v[36:39], v[52:55]
    ds_read_b128 v[28:31], v12 offset:34816
    s_add_u32 m0, s21, 0
    v_bitop3_b32 v124, v124, v89, s7 bitop3:0xf6
    v_mfma_f32_16x16x32_bf16 v[56:59], a[116:119], v[36:39], v[56:59]
    buffer_load_dwordx4 v8, s[8:11], s20 offen lds
    v_bitop3_b32 v124, v124, v90, s7 bitop3:0xf6
    v_mfma_f32_16x16x32_bf16 v[60:63], a[112:115], v[40:43], v[60:63]
    ds_read_b128 v[32:35], v13 offset:34816
    s_lshl_b32 s30, s30, 7
    v_mfma_f32_16x16x32_bf16 v[64:67], a[116:119], v[40:43], v[64:67]
    s_waitcnt lgkmcnt(4)
    s_add_u32 s30, s30, s48
    v_bitop3_b32 v124, v124, v91, s7 bitop3:0xf6
    v_mfma_f32_16x16x32_bf16 v[52:55], a[120:123], v[44:47], v[52:55]
    ds_read_b128 v[36:39], v12 offset:36864
    v_and_b32 v124, 1, v124
    v_cmp_ne_u32 vcc, 0, v124
    v_mfma_f32_16x16x32_bf16 v[56:59], a[124:127], v[44:47], v[56:59]
    buffer_load_dword v87, v4, s[12:15], s30 offen sc1
    s_nop 0
    v_mfma_f32_16x16x32_bf16 v[60:63], a[120:123], v[48:51], v[60:63]
    ds_read_b128 v[40:43], v13 offset:36864
    s_nop 0
    v_mfma_f32_16x16x32_bf16 v[64:67], a[124:127], v[48:51], v[64:67]
    s_waitcnt lgkmcnt(4)
    s_nop 0
    s_cbranch_vccnz L_rbad_252
L_rok_253:
    v_mfma_f32_16x16x32_bf16 v[52:55], a[128:131], v[20:23], v[52:55]
    ds_read_b128 v[44:47], v12 offset:38912
    s_add_u32 m0, s21, 1024
    v_mfma_f32_16x16x32_bf16 v[56:59], a[132:135], v[20:23], v[56:59]
    buffer_load_dwordx4 v9, s[8:11], s20 offen lds
    v_mfma_f32_16x16x32_bf16 v[60:63], a[128:131], v[24:27], v[60:63]
    ds_read_b128 v[48:51], v13 offset:38912
    v_lshlrev_b32 v124, 16, v88
    v_and_b32 v125, 0xffff0000, v88
    v_mfma_f32_16x16x32_bf16 v[64:67], a[132:135], v[24:27], v[64:67]
    s_waitcnt lgkmcnt(4)
    v_add_f32 v96, v116, v124
    v_mfma_f32_16x16x32_bf16 v[52:55], a[136:139], v[28:31], v[52:55]
    ds_read_b128 v[20:23], v12 offset:40960
    v_add_f32 v97, v117, v125
    v_lshlrev_b32 v124, 16, v89
    v_mfma_f32_16x16x32_bf16 v[56:59], a[140:143], v[28:31], v[56:59]
    v_and_b32 v125, 0xffff0000, v89
    v_add_f32 v98, v118, v124
    v_mfma_f32_16x16x32_bf16 v[60:63], a[136:139], v[32:35], v[60:63]
    ds_read_b128 v[24:27], v13 offset:40960
    v_add_f32 v99, v119, v125
    v_lshlrev_b32 v124, 16, v90
    v_mfma_f32_16x16x32_bf16 v[64:67], a[140:143], v[32:35], v[64:67]
    s_waitcnt lgkmcnt(4)
    v_and_b32 v125, 0xffff0000, v90
    v_mfma_f32_16x16x32_bf16 v[52:55], a[144:147], v[36:39], v[52:55]
    ds_read_b128 v[28:31], v12 offset:43008
    s_add_u32 m0, s21, 2048
    v_add_f32 v100, v120, v124
    v_mfma_f32_16x16x32_bf16 v[56:59], a[148:151], v[36:39], v[56:59]
    buffer_load_dwordx4 v10, s[8:11], s20 offen lds
    v_add_f32 v101, v121, v125
    v_mfma_f32_16x16x32_bf16 v[60:63], a[144:147], v[40:43], v[60:63]
    ds_read_b128 v[32:35], v13 offset:43008
    v_lshlrev_b32 v124, 16, v91
    v_mfma_f32_16x16x32_bf16 v[64:67], a[148:151], v[40:43], v[64:67]
    s_waitcnt lgkmcnt(4)
    v_and_b32 v125, 0xffff0000, v91
    v_add_f32 v102, v122, v124
    v_mfma_f32_16x16x32_bf16 v[52:55], a[152:155], v[44:47], v[52:55]
    ds_read_b128 v[36:39], v12 offset:45056
    v_add_f32 v103, v123, v125
    ds_write_b128 v114, v[96:99]
    v_mfma_f32_16x16x32_bf16 v[56:59], a[156:159], v[44:47], v[56:59]
    ds_write_b128 v115, v[100:103]
    ds_read_b128 v[88:91], v113 offset:0
    v_mfma_f32_16x16x32_bf16 v[60:63], a[152:155], v[48:51], v[60:63]
    ds_read_b128 v[40:43], v13 offset:45056
    ds_read_b128 v[92:95], v113 offset:1024
    v_mfma_f32_16x16x32_bf16 v[64:67], a[156:159], v[48:51], v[64:67]
    s_waitcnt lgkmcnt(4)
    v_mfma_f32_16x16x32_bf16 v[52:55], a[160:163], v[20:23], v[52:55]
    ds_read_b128 v[44:47], v12 offset:47104
    s_add_u32 m0, s21, 3072
    v_mfma_f32_16x16x32_bf16 v[56:59], a[164:167], v[20:23], v[56:59]
    buffer_load_dwordx4 v11, s[8:11], s20 offen lds
    v_mfma_f32_16x16x32_bf16 v[60:63], a[160:163], v[24:27], v[60:63]
    ds_read_b128 v[48:51], v13 offset:47104
    s_waitcnt lgkmcnt(2)
    s_waitcnt vmcnt(11)
    v_mfma_f32_16x16x32_bf16 v[64:67], a[164:167], v[24:27], v[64:67]
    s_waitcnt lgkmcnt(4)
    v_lshlrev_b32 v140, 16, v132
    v_and_b32 v141, 0xffff0000, v132
    v_mfma_f32_16x16x32_bf16 v[52:55], a[168:171], v[28:31], v[52:55]
    s_waitcnt vmcnt(20)
    s_barrier
    ds_read_b128 v[20:23], v12 offset:49152
    v_mfma_f32_16x16x32_bf16 v[56:59], a[172:175], v[28:31], v[56:59]
    s_add_u32 s20, s20, 16384
    v_mul_f32 v140, v140, v128
    v_mul_f32 v141, v141, v129
    v_mfma_f32_16x16x32_bf16 v[60:63], a[168:171], v[32:35], v[60:63]
    ds_read_b128 v[24:27], v13 offset:49152
    v_cvt_pk_bf16_f32 v140, 0, v140
    v_cvt_pk_bf16_f32 v141, 0, v141
    v_mfma_f32_16x16x32_bf16 v[64:67], a[172:175], v[32:35], v[64:67]
    s_waitcnt lgkmcnt(4)
    v_add_f32 v96, v88, v140
    v_add_f32 v97, v89, v141
    v_mfma_f32_16x16x32_bf16 v[52:55], a[176:179], v[36:39], v[52:55]
    ds_read_b128 v[28:31], v12 offset:51200
    s_add_u32 m0, s21, 16384
    v_lshlrev_b32 v140, 16, v133
    v_mfma_f32_16x16x32_bf16 v[56:59], a[180:183], v[36:39], v[56:59]
    buffer_load_dwordx4 v8, s[8:11], s20 offen lds
    v_and_b32 v141, 0xffff0000, v133
    v_mfma_f32_16x16x32_bf16 v[60:63], a[176:179], v[40:43], v[60:63]
    ds_read_b128 v[32:35], v13 offset:51200
    v_mul_f32 v140, v140, v130
    v_mul_f32 v141, v141, v131
    v_mfma_f32_16x16x32_bf16 v[64:67], a[180:183], v[40:43], v[64:67]
    s_waitcnt lgkmcnt(4)
    v_cvt_pk_bf16_f32 v140, 0, v140
    v_cvt_pk_bf16_f32 v141, 0, v141
    v_mfma_f32_16x16x32_bf16 v[52:55], a[184:187], v[44:47], v[52:55]
    ds_read_b128 v[36:39], v12 offset:53248
    v_add_f32 v98, v90, v140
    v_add_f32 v99, v91, v141
    v_mfma_f32_16x16x32_bf16 v[56:59], a[188:191], v[44:47], v[56:59]
    buffer_store_dwordx4 v[96:99], v138, s[16:19], s43 offen
    v_lshlrev_b32 v140, 16, v134
    v_mfma_f32_16x16x32_bf16 v[60:63], a[184:187], v[48:51], v[60:63]
    ds_read_b128 v[40:43], v13 offset:53248
    v_and_b32 v141, 0xffff0000, v134
    v_mfma_f32_16x16x32_bf16 v[64:67], a[188:191], v[48:51], v[64:67]
    s_waitcnt lgkmcnt(4)
    v_mul_f32 v140, v140, v128
    v_mfma_f32_16x16x32_bf16 v[52:55], a[192:195], v[20:23], v[52:55]
    ds_read_b128 v[44:47], v12 offset:55296
    s_add_u32 m0, s21, 17408
    v_mul_f32 v141, v141, v129
    v_mfma_f32_16x16x32_bf16 v[56:59], a[196:199], v[20:23], v[56:59]
    buffer_load_dwordx4 v9, s[8:11], s20 offen lds
    v_mfma_f32_16x16x32_bf16 v[60:63], a[192:195], v[24:27], v[60:63]
    ds_read_b128 v[48:51], v13 offset:55296
    v_cvt_pk_bf16_f32 v140, 0, v140
    v_mfma_f32_16x16x32_bf16 v[64:67], a[196:199], v[24:27], v[64:67]
    s_waitcnt lgkmcnt(4)
    v_cvt_pk_bf16_f32 v141, 0, v141
    v_add_f32 v100, v92, v140
    v_mfma_f32_16x16x32_bf16 v[52:55], a[200:203], v[28:31], v[52:55]
    ds_read_b128 v[20:23], v12 offset:57344
    v_add_f32 v101, v93, v141
    v_mfma_f32_16x16x32_bf16 v[56:59], a[204:207], v[28:31], v[56:59]
    v_lshlrev_b32 v140, 16, v135
    v_mfma_f32_16x16x32_bf16 v[60:63], a[200:203], v[32:35], v[60:63]
    ds_read_b128 v[24:27], v13 offset:57344
    v_and_b32 v141, 0xffff0000, v135
    v_mfma_f32_16x16x32_bf16 v[64:67], a[204:207], v[32:35], v[64:67]
    s_waitcnt lgkmcnt(4)
    v_mul_f32 v140, v140, v130
    v_mul_f32 v141, v141, v131
    v_mfma_f32_16x16x32_bf16 v[52:55], a[208:211], v[36:39], v[52:55]
    ds_read_b128 v[28:31], v12 offset:59392
    s_add_u32 m0, s21, 18432
    v_mfma_f32_16x16x32_bf16 v[56:59], a[212:215], v[36:39], v[56:59]
    buffer_load_dwordx4 v10, s[8:11], s20 offen lds
    v_cvt_pk_bf16_f32 v140, 0, v140
    v_mfma_f32_16x16x32_bf16 v[60:63], a[208:211], v[40:43], v[60:63]
    ds_read_b128 v[32:35], v13 offset:59392
    v_cvt_pk_bf16_f32 v141, 0, v141
    v_mfma_f32_16x16x32_bf16 v[64:67], a[212:215], v[40:43], v[64:67]
    s_waitcnt lgkmcnt(4)
    v_add_f32 v102, v94, v140
    v_mfma_f32_16x16x32_bf16 v[52:55], a[216:219], v[44:47], v[52:55]
    ds_read_b128 v[36:39], v12 offset:61440
    v_add_f32 v103, v95, v141
    v_mfma_f32_16x16x32_bf16 v[56:59], a[220:223], v[44:47], v[56:59]
    buffer_store_dwordx4 v[100:103], v139, s[16:19], s43 offen
    v_mfma_f32_16x16x32_bf16 v[60:63], a[216:219], v[48:51], v[60:63]
    ds_read_b128 v[40:43], v13 offset:61440
    v_mfma_f32_16x16x32_bf16 v[64:67], a[220:223], v[48:51], v[64:67]
    s_waitcnt lgkmcnt(4)
    v_mfma_f32_16x16x32_bf16 v[52:55], a[224:227], v[20:23], v[52:55]
    ds_read_b128 v[44:47], v12 offset:63488
    s_add_u32 m0, s21, 19456
    v_mov_b32 v116, v68
    v_mfma_f32_16x16x32_bf16 v[56:59], a[228:231], v[20:23], v[56:59]
    buffer_load_dwordx4 v11, s[8:11], s20 offen lds
    v_mov_b32 v117, v69
    v_mfma_f32_16x16x32_bf16 v[60:63], a[224:227], v[24:27], v[60:63]
    ds_read_b128 v[48:51], v13 offset:63488
    v_mov_b32 v118, v70
    v_mov_b32 v119, v71
    v_mfma_f32_16x16x32_bf16 v[64:67], a[228:231], v[24:27], v[64:67]
    s_waitcnt lgkmcnt(4)
    v_mov_b32 v120, v72
    v_mfma_f32_16x16x32_bf16 v[52:55], a[232:235], v[28:31], v[52:55]
    s_waitcnt vmcnt(20)
    s_barrier
    ds_read_b128 v[20:23], v16 offset:0
    v_mfma_f32_16x16x32_bf16 v[56:59], a[236:239], v[28:31], v[56:59]
    s_add_u32 s20, s20, 16384
    v_mov_b32 v121, v73
    v_mov_b32 v122, v74
    v_mfma_f32_16x16x32_bf16 v[60:63], a[232:235], v[32:35], v[60:63]
    ds_read_b128 v[24:27], v17 offset:0
    v_mov_b32 v123, v75
    v_mfma_f32_16x16x32_bf16 v[64:67], a[236:239], v[32:35], v[64:67]
    s_waitcnt lgkmcnt(4)
    s_mov_b32 s7, s38
    s_add_u32 s39, s44, s31
    v_mfma_f32_16x16x32_bf16 v[52:55], a[240:243], v[36:39], v[52:55]
    ds_read_b128 v[28:31], v16 offset:2048
    s_add_u32 m0, s21, 32768
    v_mfma_f32_16x16x32_bf16 v[56:59], a[244:247], v[36:39], v[56:59]
    buffer_load_dwordx4 v8, s[8:11], s20 offen lds
    s_sub_u32 s43, s22, 1
    v_mfma_f32_16x16x32_bf16 v[60:63], a[240:243], v[40:43], v[60:63]
    ds_read_b128 v[32:35], v17 offset:2048
    s_lshl_b32 s42, s43, 16
    s_lshl_b32 s43, s43, 18
    v_mfma_f32_16x16x32_bf16 v[64:67], a[244:247], v[40:43], v[64:67]
    s_waitcnt lgkmcnt(4)
    s_cmp_eq_u32 s37, 0
    s_cselect_b32 s42, 0x7ff00000, s42
    s_cselect_b32 s43, 0x7ff00000, s43
    v_mfma_f32_16x16x32_bf16 v[52:55], a[248:251], v[44:47], v[52:55]
    ds_read_b128 v[36:39], v16 offset:4096
    v_mfma_f32_16x16x32_bf16 v[56:59], a[252:255], v[44:47], v[56:59]
    buffer_load_dwordx4 v[88:91], v112, s[12:15], s39 offen offset:0 sc1
    v_mfma_f32_16x16x32_bf16 v[60:63], a[248:251], v[48:51], v[60:63]
    ds_read_b128 v[40:43], v17 offset:4096
    s_mov_b32 s37, 1
    v_mfma_f32_16x16x32_bf16 v[64:67], a[252:255], v[48:51], v[64:67]
    s_waitcnt lgkmcnt(4)
    s_add_u32 s22, s22, 1
    s_cmp_ge_u32 s22, s23
    s_cbranch_scc1 L_fl0_248
    v_mfma_f32_16x16x32_bf16 v[68:71], a[0:3], v[20:23], 0
    ds_read_b128 v[44:47], v16 offset:6144
    s_add_u32 m0, s21, 33792
    v_mfma_f32_16x16x32_bf16 v[72:75], a[4:7], v[20:23], 0
    buffer_load_dwordx4 v9, s[8:11], s20 offen lds
    v_mfma_f32_16x16x32_bf16 v[76:79], a[0:3], v[24:27], 0
    ds_read_b128 v[48:51], v17 offset:6144
    s_sub_u32 s38, s22, 1
    v_mfma_f32_16x16x32_bf16 v[80:83], a[4:7], v[24:27], 0
    s_waitcnt lgkmcnt(4)
    s_and_b32 s31, s38, 3
    v_mfma_f32_16x16x32_bf16 v[68:71], a[8:11], v[28:31], v[68:71]
    ds_read_b128 v[20:23], v16 offset:8192
    s_waitcnt vmcnt(12)
    ds_write_b32 v3, v87
    v_mfma_f32_16x16x32_bf16 v[72:75], a[12:15], v[28:31], v[72:75]
    buffer_load_dwordx2 v[132:133], v136, s[32:35], s42 offen
    v_mfma_f32_16x16x32_bf16 v[76:79], a[8:11], v[32:35], v[76:79]
    ds_read_b128 v[24:27], v17 offset:8192
    s_lshl_b32 s31, s31, 11
    v_mfma_f32_16x16x32_bf16 v[80:83], a[12:15], v[32:35], v[80:83]
    s_waitcnt lgkmcnt(4)
    v_mfma_f32_16x16x32_bf16 v[68:71], a[16:19], v[36:39], v[68:71]
    ds_read_b128 v[28:31], v16 offset:10240
    s_add_u32 m0, s21, 34816
    v_mfma_f32_16x16x32_bf16 v[72:75], a[20:23], v[36:39], v[72:75]
    buffer_load_dwordx4 v10, s[8:11], s20 offen lds
    v_mfma_f32_16x16x32_bf16 v[76:79], a[16:19], v[40:43], v[76:79]
    ds_read_b128 v[32:35], v17 offset:10240
    s_bfe_u32 s38, s38, 0x10002
    v_mfma_f32_16x16x32_bf16 v[80:83], a[20:23], v[40:43], v[80:83]
    s_waitcnt lgkmcnt(4)
    s_xor_b32 s38, s38, 1
    v_mfma_f32_16x16x32_bf16 v[68:71], a[24:27], v[44:47], v[68:71]
    ds_read_b128 v[36:39], v16 offset:12288
    s_cmp_eq_u32 s37, 0
    s_cselect_b32 s31, 0x40000000, s31
    s_cselect_b32 s38, 0, s38
    v_mfma_f32_16x16x32_bf16 v[72:75], a[28:31], v[44:47], v[72:75]
    buffer_load_dwordx2 v[134:135], v137, s[32:35], s42 offen
    v_mfma_f32_16x16x32_bf16 v[76:79], a[24:27], v[48:51], v[76:79]
    ds_read_b128 v[40:43], v17 offset:12288
    v_mfma_f32_16x16x32_bf16 v[80:83], a[28:31], v[48:51], v[80:83]
    s_waitcnt lgkmcnt(4)
    v_mfma_f32_16x16x32_bf16 v[68:71], a[32:35], v[20:23], v[68:71]
    ds_read_b128 v[44:47], v16 offset:14336
    s_add_u32 m0, s21, 35840
    v_mfma_f32_16x16x32_bf16 v[72:75], a[36:39], v[20:23], v[72:75]
    buffer_load_dwordx4 v11, s[8:11], s20 offen lds
    v_mfma_f32_16x16x32_bf16 v[76:79], a[32:35], v[24:27], v[76:79]
    ds_read_b128 v[48:51], v17 offset:14336
    v_mfma_f32_16x16x32_bf16 v[80:83], a[36:39], v[24:27], v[80:83]
    s_waitcnt lgkmcnt(4)
    v_cvt_pk_bf16_f32 v104, v60, v61
    v_mfma_f32_16x16x32_bf16 v[68:71], a[40:43], v[28:31], v[68:71]
    s_waitcnt vmcnt(20)
    s_barrier
    ds_read_b128 v[20:23], v16 offset:16384
    v_mfma_f32_16x16x32_bf16 v[72:75], a[44:47], v[28:31], v[72:75]
    s_add_u32 s20, s20, 16384
    v_mfma_f32_16x16x32_bf16 v[76:79], a[40:43], v[32:35], v[76:79]
    ds_read_b128 v[24:27], v17 offset:16384
    ds_read_b32 v1, v2
    v_mfma_f32_16x16x32_bf16 v[80:83], a[44:47], v[32:35], v[80:83]
    s_waitcnt lgkmcnt(4)
    v_cvt_pk_bf16_f32 v105, v62, v63
    v_mfma_f32_16x16x32_bf16 v[68:71], a[48:51], v[36:39], v[68:71]
    ds_read_b128 v[28:31], v16 offset:18432
    s_add_u32 m0, s21, 49152
    v_mfma_f32_16x16x32_bf16 v[72:75], a[52:55], v[36:39], v[72:75]
    buffer_load_dwordx4 v8, s[8:11], s20 offen lds
    v_mfma_f32_16x16x32_bf16 v[76:79], a[48:51], v[40:43], v[76:79]
    ds_read_b128 v[32:35], v17 offset:18432
    v_cvt_pk_bf16_f32 v106, v64, v65
    v_mfma_f32_16x16x32_bf16 v[80:83], a[52:55], v[40:43], v[80:83]
    s_waitcnt lgkmcnt(4)
    v_cvt_pk_bf16_f32 v107, v66, v67
    v_mfma_f32_16x16x32_bf16 v[68:71], a[56:59], v[44:47], v[68:71]
    ds_read_b128 v[36:39], v16 offset:20480
    v_mfma_f32_16x16x32_bf16 v[72:75], a[60:63], v[44:47], v[72:75]
    v_and_or_b32 v104, v104, -2, s38
    v_and_or_b32 v105, v105, -2, s38
    v_mfma_f32_16x16x32_bf16 v[76:79], a[56:59], v[48:51], v[76:79]
    ds_read_b128 v[40:43], v17 offset:20480
    v_and_or_b32 v106, v106, -2, s38
    v_mfma_f32_16x16x32_bf16 v[80:83], a[60:63], v[48:51], v[80:83]
    s_waitcnt lgkmcnt(4)
    v_mfma_f32_16x16x32_bf16 v[68:71], a[64:67], v[20:23], v[68:71]
    ds_read_b128 v[44:47], v16 offset:22528
    s_add_u32 m0, s21, 50176
    v_mfma_f32_16x16x32_bf16 v[72:75], a[68:71], v[20:23], v[72:75]
    buffer_load_dwordx4 v9, s[8:11], s20 offen lds
    v_mfma_f32_16x16x32_bf16 v[76:79], a[64:67], v[24:27], v[76:79]
    ds_read_b128 v[48:51], v17 offset:22528
    v_and_or_b32 v107, v107, -2, s38
    v_mfma_f32_16x16x32_bf16 v[80:83], a[68:71], v[24:27], v[80:83]
    s_waitcnt lgkmcnt(4)
    s_add_u32 s29, s45, s31
    v_mfma_f32_16x16x32_bf16 v[68:71], a[72:75], v[28:31], v[68:71]
    ds_read_b128 v[20:23], v16 offset:24576
    v_mfma_f32_16x16x32_bf16 v[72:75], a[76:79], v[28:31], v[72:75]
    buffer_store_dwordx4 v[104:107], v112, s[12:15], s29 offen offset:0 sc1
    v_mfma_f32_16x16x32_bf16 v[76:79], a[72:75], v[32:35], v[76:79]
    ds_read_b128 v[24:27], v17 offset:24576
    v_readfirstlane_b32 s51, v1
    v_mfma_f32_16x16x32_bf16 v[80:83], a[76:79], v[32:35], v[80:83]
    s_waitcnt lgkmcnt(4)
    s_add_u32 s30, s22, 1
    v_mfma_f32_16x16x32_bf16 v[68:71], a[80:83], v[36:39], v[68:71]
    ds_read_b128 v[28:31], v16 offset:26624
    s_add_u32 m0, s21, 51200
    v_mfma_f32_16x16x32_bf16 v[72:75], a[84:87], v[36:39], v[72:75]
    buffer_load_dwordx4 v10, s[8:11], s20 offen lds
    v_mfma_f32_16x16x32_bf16 v[76:79], a[80:83], v[40:43], v[76:79]
    ds_read_b128 v[32:35], v17 offset:26624
    s_cmp_eq_u32 s30, s24
    s_cselect_b32 s51, s51, 0
    v_mfma_f32_16x16x32_bf16 v[80:83], a[84:87], v[40:43], v[80:83]
    s_waitcnt lgkmcnt(4)
    v_mfma_f32_16x16x32_bf16 v[68:71], a[88:91], v[44:47], v[68:71]
    ds_read_b128 v[36:39], v16 offset:28672
    s_cmp_ge_u32 s51, 16
    s_cselect_b32 s30, 1, 0
    v_mfma_f32_16x16x32_bf16 v[72:75], a[92:95], v[44:47], v[72:75]
    s_add_u32 s24, s24, s30
    v_mfma_f32_16x16x32_bf16 v[76:79], a[88:91], v[48:51], v[76:79]
    ds_read_b128 v[40:43], v17 offset:28672
    s_add_u32 s23, s23, s30
    v_mfma_f32_16x16x32_bf16 v[80:83], a[92:95], v[48:51], v[80:83]
    s_waitcnt lgkmcnt(4)
    s_lshl_b32 s53, s24, 17
    v_mfma_f32_16x16x32_bf16 v[68:71], a[96:99], v[20:23], v[68:71]
    ds_read_b128 v[44:47], v16 offset:30720
    s_add_u32 m0, s21, 52224
    v_mfma_f32_16x16x32_bf16 v[72:75], a[100:103], v[20:23], v[72:75]
    buffer_load_dwordx4 v11, s[8:11], s20 offen lds
    v_mfma_f32_16x16x32_bf16 v[76:79], a[96:99], v[24:27], v[76:79]
    ds_read_b128 v[48:51], v17 offset:30720
    s_add_u32 s53, s53, s50
    v_mfma_f32_16x16x32_bf16 v[80:83], a[100:103], v[24:27], v[80:83]
    s_waitcnt lgkmcnt(4)
    v_mfma_f32_16x16x32_bf16 v[68:71], a[104:107], v[28:31], v[68:71]
    s_waitcnt vmcnt(20)
    s_barrier
    ds_read_b128 v[20:23], v16 offset:32768
    v_mfma_f32_16x16x32_bf16 v[72:75], a[108:111], v[28:31], v[72:75]
    s_mov_b32 s20, s53
    s_add_u32 s30, s24, 1
    v_mfma_f32_16x16x32_bf16 v[76:79], a[104:107], v[32:35], v[76:79]
    ds_read_b128 v[24:27], v17 offset:32768
    s_cmp_lt_u32 s30, 64
    s_cselect_b32 s30, s30, 0x800000
    v_mfma_f32_16x16x32_bf16 v[80:83], a[108:111], v[32:35], v[80:83]
    s_waitcnt lgkmcnt(4)
    s_waitcnt vmcnt(10)
    v_xor_b32 v124, s7, v88
    v_mfma_f32_16x16x32_bf16 v[68:71], a[112:115], v[36:39], v[68:71]
    ds_read_b128 v[28:31], v16 offset:34816
    s_add_u32 m0, s21, 65536
    v_bitop3_b32 v124, v124, v89, s7 bitop3:0xf6
    v_mfma_f32_16x16x32_bf16 v[72:75], a[116:119], v[36:39], v[72:75]
    buffer_load_dwordx4 v8, s[8:11], s20 offen lds
    v_bitop3_b32 v124, v124, v90, s7 bitop3:0xf6
    v_mfma_f32_16x16x32_bf16 v[76:79], a[112:115], v[40:43], v[76:79]
    ds_read_b128 v[32:35], v17 offset:34816
    s_lshl_b32 s30, s30, 7
    v_mfma_f32_16x16x32_bf16 v[80:83], a[116:119], v[40:43], v[80:83]
    s_waitcnt lgkmcnt(4)
    s_add_u32 s30, s30, s48
    v_bitop3_b32 v124, v124, v91, s7 bitop3:0xf6
    v_mfma_f32_16x16x32_bf16 v[68:71], a[120:123], v[44:47], v[68:71]
    ds_read_b128 v[36:39], v16 offset:36864
    v_and_b32 v124, 1, v124
    v_cmp_ne_u32 vcc, 0, v124
    v_mfma_f32_16x16x32_bf16 v[72:75], a[124:127], v[44:47], v[72:75]
    buffer_load_dword v87, v4, s[12:15], s30 offen sc1
    s_nop 0
    v_mfma_f32_16x16x32_bf16 v[76:79], a[120:123], v[48:51], v[76:79]
    ds_read_b128 v[40:43], v17 offset:36864
    s_nop 0
    v_mfma_f32_16x16x32_bf16 v[80:83], a[124:127], v[48:51], v[80:83]
    s_waitcnt lgkmcnt(4)
    s_nop 0
    s_cbranch_vccnz L_rbad_254
L_rok_255:
    v_mfma_f32_16x16x32_bf16 v[68:71], a[128:131], v[20:23], v[68:71]
    ds_read_b128 v[44:47], v16 offset:38912
    s_add_u32 m0, s21, 66560
    v_mfma_f32_16x16x32_bf16 v[72:75], a[132:135], v[20:23], v[72:75]
    buffer_load_dwordx4 v9, s[8:11], s20 offen lds
    v_mfma_f32_16x16x32_bf16 v[76:79], a[128:131], v[24:27], v[76:79]
    ds_read_b128 v[48:51], v17 offset:38912
    v_lshlrev_b32 v124, 16, v88
    v_and_b32 v125, 0xffff0000, v88
    v_mfma_f32_16x16x32_bf16 v[80:83], a[132:135], v[24:27], v[80:83]
    s_waitcnt lgkmcnt(4)
    v_add_f32 v96, v116, v124
    v_mfma_f32_16x16x32_bf16 v[68:71], a[136:139], v[28:31], v[68:71]
    ds_read_b128 v[20:23], v16 offset:40960
    v_add_f32 v97, v117, v125
    v_lshlrev_b32 v124, 16, v89
    v_mfma_f32_16x16x32_bf16 v[72:75], a[140:143], v[28:31], v[72:75]
    v_and_b32 v125, 0xffff0000, v89
    v_add_f32 v98, v118, v124
    v_mfma_f32_16x16x32_bf16 v[76:79], a[136:139], v[32:35], v[76:79]
    ds_read_b128 v[24:27], v17 offset:40960
    v_add_f32 v99, v119, v125
    v_lshlrev_b32 v124, 16, v90
    v_mfma_f32_16x16x32_bf16 v[80:83], a[140:143], v[32:35], v[80:83]
    s_waitcnt lgkmcnt(4)
    v_and_b32 v125, 0xffff0000, v90
    v_mfma_f32_16x16x32_bf16 v[68:71], a[144:147], v[36:39], v[68:71]
    ds_read_b128 v[28:31], v16 offset:43008
    s_add_u32 m0, s21, 67584
    v_add_f32 v100, v120, v124
    v_mfma_f32_16x16x32_bf16 v[72:75], a[148:151], v[36:39], v[72:75]
    buffer_load_dwordx4 v10, s[8:11], s20 offen lds
    v_add_f32 v101, v121, v125
    v_mfma_f32_16x16x32_bf16 v[76:79], a[144:147], v[40:43], v[76:79]
    ds_read_b128 v[32:35], v17 offset:43008
    v_lshlrev_b32 v124, 16, v91
    v_mfma_f32_16x16x32_bf16 v[80:83], a[148:151], v[40:43], v[80:83]
    s_waitcnt lgkmcnt(4)
    v_and_b32 v125, 0xffff0000, v91
    v_add_f32 v102, v122, v124
    v_mfma_f32_16x16x32_bf16 v[68:71], a[152:155], v[44:47], v[68:71]
    ds_read_b128 v[36:39], v16 offset:45056
    v_add_f32 v103, v123, v125
    ds_write_b128 v114, v[96:99]
    v_mfma_f32_16x16x32_bf16 v[72:75], a[156:159], v[44:47], v[72:75]
    ds_write_b128 v115, v[100:103]
    ds_read_b128 v[88:91], v113 offset:0
    v_mfma_f32_16x16x32_bf16 v[76:79], a[152:155], v[48:51], v[76:79]
    ds_read_b128 v[40:43], v17 offset:45056
    ds_read_b128 v[92:95], v113 offset:1024
    v_mfma_f32_16x16x32_bf16 v[80:83], a[156:159], v[48:51], v[80:83]
    s_waitcnt lgkmcnt(4)
    v_mfma_f32_16x16x32_bf16 v[68:71], a[160:163], v[20:23], v[68:71]
    ds_read_b128 v[44:47], v16 offset:47104
    s_add_u32 m0, s21, 68608
    v_mfma_f32_16x16x32_bf16 v[72:75], a[164:167], v[20:23], v[72:75]
    buffer_load_dwordx4 v11, s[8:11], s20 offen lds
    v_mfma_f32_16x16x32_bf16 v[76:79], a[160:163], v[24:27], v[76:79]
    ds_read_b128 v[48:51], v17 offset:47104
    s_waitcnt lgkmcnt(2)
    s_waitcnt vmcnt(11)
    v_mfma_f32_16x16x32_bf16 v[80:83], a[164:167], v[24:27], v[80:83]
    s_waitcnt lgkmcnt(4)
    v_lshlrev_b32 v140, 16, v132
    v_and_b32 v141, 0xffff0000, v132
    v_mfma_f32_16x16x32_bf16 v[68:71], a[168:171], v[28:31], v[68:71]
    s_waitcnt vmcnt(20)
    s_barrier
    ds_read_b128 v[20:23], v16 offset:49152
    v_mfma_f32_16x16x32_bf16 v[72:75], a[172:175], v[28:31], v[72:75]
    s_add_u32 s20, s20, 16384
    v_mul_f32 v140, v140, v128
    v_mul_f32 v141, v141, v129
    v_mfma_f32_16x16x32_bf16 v[76:79], a[168:171], v[32:35], v[76:79]
    ds_read_b128 v[24:27], v17 offset:49152
    v_cvt_pk_bf16_f32 v140, 0, v140
    v_cvt_pk_bf16_f32 v141, 0, v141
    v_mfma_f32_16x16x32_bf16 v[80:83], a[172:175], v[32:35], v[80:83]
    s_waitcnt lgkmcnt(4)
    v_add_f32 v96, v88, v140
    v_add_f32 v97, v89, v141
    v_mfma_f32_16x16x32_bf16 v[68:71], a[176:179], v[36:39], v[68:71]
    ds_read_b128 v[28:31], v16 offset:51200
    s_add_u32 m0, s21, 81920
    v_lshlrev_b32 v140, 16, v133
    v_mfma_f32_16x16x32_bf16 v[72:75], a[180:183], v[36:39], v[72:75]
    buffer_load_dwordx4 v8, s[8:11], s20 offen lds
    v_and_b32 v141, 0xffff0000, v133
    v_mfma_f32_16x16x32_bf16 v[76:79], a[176:179], v[40:43], v[76:79]
    ds_read_b128 v[32:35], v17 offset:51200
    v_mul_f32 v140, v140, v130
    v_mul_f32 v141, v141, v131
    v_mfma_f32_16x16x32_bf16 v[80:83], a[180:183], v[40:43], v[80:83]
    s_waitcnt lgkmcnt(4)
    v_cvt_pk_bf16_f32 v140, 0, v140
    v_cvt_pk_bf16_f32 v141, 0, v141
    v_mfma_f32_16x16x32_bf16 v[68:71], a[184:187], v[44:47], v[68:71]
    ds_read_b128 v[36:39], v16 offset:53248
    v_add_f32 v98, v90, v140
    v_add_f32 v99, v91, v141
    v_mfma_f32_16x16x32_bf16 v[72:75], a[188:191], v[44:47], v[72:75]
    buffer_store_dwordx4 v[96:99], v138, s[16:19], s43 offen
    v_lshlrev_b32 v140, 16, v134
    v_mfma_f32_16x16x32_bf16 v[76:79], a[184:187], v[48:51], v[76:79]
    ds_read_b128 v[40:43], v17 offset:53248
    v_and_b32 v141, 0xffff0000, v134
    v_mfma_f32_16x16x32_bf16 v[80:83], a[188:191], v[48:51], v[80:83]
    s_waitcnt lgkmcnt(4)
    v_mul_f32 v140, v140, v128
    v_mfma_f32_16x16x32_bf16 v[68:71], a[192:195], v[20:23], v[68:71]
    ds_read_b128 v[44:47], v16 offset:55296
    s_add_u32 m0, s21, 82944
    v_mul_f32 v141, v141, v129
    v_mfma_f32_16x16x32_bf16 v[72:75], a[196:199], v[20:23], v[72:75]
    buffer_load_dwordx4 v9, s[8:11], s20 offen lds
    v_mfma_f32_16x16x32_bf16 v[76:79], a[192:195], v[24:27], v[76:79]
    ds_read_b128 v[48:51], v17 offset:55296
    v_cvt_pk_bf16_f32 v140, 0, v140
    v_mfma_f32_16x16x32_bf16 v[80:83], a[196:199], v[24:27], v[80:83]
    s_waitcnt lgkmcnt(4)
    v_cvt_pk_bf16_f32 v141, 0, v141
    v_add_f32 v100, v92, v140
    v_mfma_f32_16x16x32_bf16 v[68:71], a[200:203], v[28:31], v[68:71]
    ds_read_b128 v[20:23], v16 offset:57344
    v_add_f32 v101, v93, v141
    v_mfma_f32_16x16x32_bf16 v[72:75], a[204:207], v[28:31], v[72:75]
    v_lshlrev_b32 v140, 16, v135
    v_mfma_f32_16x16x32_bf16 v[76:79], a[200:203], v[32:35], v[76:79]
    ds_read_b128 v[24:27], v17 offset:57344
    v_and_b32 v141, 0xffff0000, v135
    v_mfma_f32_16x16x32_bf16 v[80:83], a[204:207], v[32:35], v[80:83]
    s_waitcnt lgkmcnt(4)
    v_mul_f32 v140, v140, v130
    v_mul_f32 v141, v141, v131
    v_mfma_f32_16x16x32_bf16 v[68:71], a[208:211], v[36:39], v[68:71]
    ds_read_b128 v[28:31], v16 offset:59392
    s_add_u32 m0, s21, 83968
    v_mfma_f32_16x16x32_bf16 v[72:75], a[212:215], v[36:39], v[72:75]
    buffer_load_dwordx4 v10, s[8:11], s20 offen lds
    v_cvt_pk_bf16_f32 v140, 0, v140
    v_mfma_f32_16x16x32_bf16 v[76:79], a[208:211], v[40:43], v[76:79]
    ds_read_b128 v[32:35], v17 offset:59392
    v_cvt_pk_bf16_f32 v141, 0, v141
    v_mfma_f32_16x16x32_bf16 v[80:83], a[212:215], v[40:43], v[80:83]
    s_waitcnt lgkmcnt(4)
    v_add_f32 v102, v94, v140
    v_mfma_f32_16x16x32_bf16 v[68:71], a[216:219], v[44:47], v[68:71]
    ds_read_b128 v[36:39], v16 offset:61440
    v_add_f32 v103, v95, v141
    v_mfma_f32_16x16x32_bf16 v[72:75], a[220:223], v[44:47], v[72:75]
    buffer_store_dwordx4 v[100:103], v139, s[16:19], s43 offen
    v_mfma_f32_16x16x32_bf16 v[76:79], a[216:219], v[48:51], v[76:79]
    ds_read_b128 v[40:43], v17 offset:61440
    v_mfma_f32_16x16x32_bf16 v[80:83], a[220:223], v[48:51], v[80:83]
    s_waitcnt lgkmcnt(4)
    v_mfma_f32_16x16x32_bf16 v[68:71], a[224:227], v[20:23], v[68:71]
    ds_read_b128 v[44:47], v16 offset:63488
    s_add_u32 m0, s21, 84992
    v_mov_b32 v116, v52
    v_mfma_f32_16x16x32_bf16 v[72:75], a[228:231], v[20:23], v[72:75]
    buffer_load_dwordx4 v11, s[8:11], s20 offen lds
    v_mov_b32 v117, v53
    v_mfma_f32_16x16x32_bf16 v[76:79], a[224:227], v[24:27], v[76:79]
    ds_read_b128 v[48:51], v17 offset:63488
    v_mov_b32 v118, v54
    v_mov_b32 v119, v55
    v_mfma_f32_16x16x32_bf16 v[80:83], a[228:231], v[24:27], v[80:83]
    s_waitcnt lgkmcnt(4)
    v_mov_b32 v120, v56
    v_mfma_f32_16x16x32_bf16 v[68:71], a[232:235], v[28:31], v[68:71]
    s_waitcnt vmcnt(20)
    s_barrier
    ds_read_b128 v[20:23], v12 offset:0
    v_mfma_f32_16x16x32_bf16 v[72:75], a[236:239], v[28:31], v[72:75]
    s_add_u32 s20, s20, 16384
    v_mov_b32 v121, v57
    v_mov_b32 v122, v58
    v_mfma_f32_16x16x32_bf16 v[76:79], a[232:235], v[32:35], v[76:79]
    ds_read_b128 v[24:27], v13 offset:0
    v_mov_b32 v123, v59
    v_mfma_f32_16x16x32_bf16 v[80:83], a[236:239], v[32:35], v[80:83]
    s_waitcnt lgkmcnt(4)
    s_mov_b32 s7, s38
    s_add_u32 s39, s44, s31
    v_mfma_f32_16x16x32_bf16 v[68:71], a[240:243], v[36:39], v[68:71]
    ds_read_b128 v[28:31], v12 offset:2048
    s_add_u32 m0, s21, 98304
    v_mfma_f32_16x16x32_bf16 v[72:75], a[244:247], v[36:39], v[72:75]
    buffer_load_dwordx4 v8, s[8:11], s20 offen lds
    s_sub_u32 s43, s22, 1
    v_mfma_f32_16x16x32_bf16 v[76:79], a[240:243], v[40:43], v[76:79]
    ds_read_b128 v[32:35], v13 offset:2048
    s_lshl_b32 s42, s43, 16
    s_lshl_b32 s43, s43, 18
    v_mfma_f32_16x16x32_bf16 v[80:83], a[244:247], v[40:43], v[80:83]
    s_waitcnt lgkmcnt(4)
    s_cmp_eq_u32 s37, 0
    s_cselect_b32 s42, 0x7ff00000, s42
    s_cselect_b32 s43, 0x7ff00000, s43
    v_mfma_f32_16x16x32_bf16 v[68:71], a[248:251], v[44:47], v[68:71]
    ds_read_b128 v[36:39], v12 offset:4096
    v_mfma_f32_16x16x32_bf16 v[72:75], a[252:255], v[44:47], v[72:75]
    buffer_load_dwordx4 v[88:91], v112, s[12:15], s39 offen offset:0 sc1
    v_mfma_f32_16x16x32_bf16 v[76:79], a[248:251], v[48:51], v[76:79]
    ds_read_b128 v[40:43], v13 offset:4096
    s_mov_b32 s37, 1
    v_mfma_f32_16x16x32_bf16 v[80:83], a[252:255], v[48:51], v[80:83]
    s_waitcnt lgkmcnt(4)
    s_add_u32 s22, s22, 1
    s_cmp_ge_u32 s22, s23
    s_cbranch_scc0 L_st_251
L_fl1_249:
    s_waitcnt lgkmcnt(0)
    s_nop 7
    s_sub_u32 s38, s22, 1
    s_and_b32 s31, s38, 3
    s_lshl_b32 s31, s31, 11
    s_bfe_u32 s38, s38, 0x10002
    s_xor_b32 s38, s38, 1
    s_cmp_eq_u32 s37, 0
    s_cselect_b32 s31, 0x40000000, s31
    s_cselect_b32 s38, 0, s38
    v_cvt_pk_bf16_f32 v104, v76, v77
    v_cvt_pk_bf16_f32 v105, v78, v79
    v_cvt_pk_bf16_f32 v106, v80, v81
    v_cvt_pk_bf16_f32 v107, v82, v83
    v_and_or_b32 v104, v104, -2, s38
    v_and_or_b32 v105, v105, -2, s38
    v_and_or_b32 v106, v106, -2, s38
    v_and_or_b32 v107, v107, -2, s38
    s_add_u32 s29, s45, s31
    buffer_store_dwordx4 v[104:107], v112, s[12:15], s29 offen offset:0 sc1
    buffer_load_dwordx2 v[132:133], v136, s[32:35], s42 offen
    buffer_load_dwordx2 v[134:135], v137, s[32:35], s42 offen
    s_waitcnt vmcnt(0)
    v_xor_b32 v124, s7, v88
    v_bitop3_b32 v124, v124, v89, s7 bitop3:0xf6
    v_bitop3_b32 v124, v124, v90, s7 bitop3:0xf6
    v_bitop3_b32 v124, v124, v91, s7 bitop3:0xf6
    v_and_b32 v124, 1, v124
    v_cmp_ne_u32 vcc, 0, v124
    s_nop 0
    s_nop 0
    s_nop 0
    s_cbranch_vccnz L_rbad_256
L_rok_257:
    v_lshlrev_b32 v124, 16, v88
    v_and_b32 v125, 0xffff0000, v88
    v_add_f32 v96, v116, v124
    v_add_f32 v97, v117, v125
    v_lshlrev_b32 v124, 16, v89
    v_and_b32 v125, 0xffff0000, v89
    v_add_f32 v98, v118, v124
    v_add_f32 v99, v119, v125
    v_lshlrev_b32 v124, 16, v90
    v_and_b32 v125, 0xffff0000, v90
    v_add_f32 v100, v120, v124
    v_add_f32 v101, v121, v125
    v_lshlrev_b32 v124, 16, v91
    v_and_b32 v125, 0xffff0000, v91
    v_add_f32 v102, v122, v124
    v_add_f32 v103, v123, v125
    ds_write_b128 v114, v[96:99]
    ds_write_b128 v115, v[100:103]
    ds_read_b128 v[88:91], v113 offset:0
    ds_read_b128 v[92:95], v113 offset:1024
    s_waitcnt lgkmcnt(0)
    s_waitcnt vmcnt(0)
    v_lshlrev_b32 v140, 16, v132
    v_and_b32 v141, 0xffff0000, v132
    v_mul_f32 v140, v140, v128
    v_mul_f32 v141, v141, v129
    v_cvt_pk_bf16_f32 v140, 0, v140
    v_cvt_pk_bf16_f32 v141, 0, v141
    v_add_f32 v96, v88, v140
    v_add_f32 v97, v89, v141
    v_lshlrev_b32 v140, 16, v133
    v_and_b32 v141, 0xffff0000, v133
    v_mul_f32 v140, v140, v130
    v_mul_f32 v141, v141, v131
    v_cvt_pk_bf16_f32 v140, 0, v140
    v_cvt_pk_bf16_f32 v141, 0, v141
    v_add_f32 v98, v90, v140
    v_add_f32 v99, v91, v141
    buffer_store_dwordx4 v[96:99], v138, s[16:19], s43 offen
    v_lshlrev_b32 v140, 16, v134
    v_and_b32 v141, 0xffff0000, v134
    v_mul_f32 v140, v140, v128
    v_mul_f32 v141, v141, v129
    v_cvt_pk_bf16_f32 v140, 0, v140
    v_cvt_pk_bf16_f32 v141, 0, v141
    v_add_f32 v100, v92, v140
    v_add_f32 v101, v93, v141
    v_lshlrev_b32 v140, 16, v135
    v_and_b32 v141, 0xffff0000, v135
    v_mul_f32 v140, v140, v130
    v_mul_f32 v141, v141, v131
    v_cvt_pk_bf16_f32 v140, 0, v140
    v_cvt_pk_bf16_f32 v141, 0, v141
    v_add_f32 v102, v94, v140
    v_add_f32 v103, v95, v141
    buffer_store_dwordx4 v[100:103], v139, s[16:19], s43 offen
    v_mov_b32 v116, v68
    v_mov_b32 v117, v69
    v_mov_b32 v118, v70
    v_mov_b32 v119, v71
    v_mov_b32 v120, v72
    v_mov_b32 v121, v73
    v_mov_b32 v122, v74
    v_mov_b32 v123, v75
    s_mov_b32 s7, s38
    s_add_u32 s39, s44, s31
    s_sub_u32 s43, s22, 1
    s_lshl_b32 s42, s43, 16
    s_lshl_b32 s43, s43, 18
    s_cmp_eq_u32 s37, 0
    s_cselect_b32 s42, 0x7ff00000, s42
    s_cselect_b32 s43, 0x7ff00000, s43
    buffer_load_dwordx4 v[88:91], v112, s[12:15], s39 offen offset:0 sc1
    s_mov_b32 s37, 1
    buffer_load_dwordx2 v[132:133], v136, s[32:35], s42 offen
    buffer_load_dwordx2 v[134:135], v137, s[32:35], s42 offen
    s_waitcnt vmcnt(0)
    v_xor_b32 v124, s7, v88
    v_bitop3_b32 v124, v124, v89, s7 bitop3:0xf6
    v_bitop3_b32 v124, v124, v90, s7 bitop3:0xf6
    v_bitop3_b32 v124, v124, v91, s7 bitop3:0xf6
    v_and_b32 v124, 1, v124
    v_cmp_ne_u32 vcc, 0, v124
    s_nop 0
    s_nop 0
    s_nop 0
    s_cbranch_vccnz L_rbad_258
L_rok_259:
    v_lshlrev_b32 v124, 16, v88
    v_and_b32 v125, 0xffff0000, v88
    v_add_f32 v96, v116, v124
    v_add_f32 v97, v117, v125
    v_lshlrev_b32 v124, 16, v89
    v_and_b32 v125, 0xffff0000, v89
    v_add_f32 v98, v118, v124
    v_add_f32 v99, v119, v125
    v_lshlrev_b32 v124, 16, v90
    v_and_b32 v125, 0xffff0000, v90
    v_add_f32 v100, v120, v124
    v_add_f32 v101, v121, v125
    v_lshlrev_b32 v124, 16, v91
    v_and_b32 v125, 0xffff0000, v91
    v_add_f32 v102, v122, v124
    v_add_f32 v103, v123, v125
    ds_write_b128 v114, v[96:99]
    ds_write_b128 v115, v[100:103]
    ds_read_b128 v[88:91], v113 offset:0
    ds_read_b128 v[92:95], v113 offset:1024
    s_waitcnt lgkmcnt(0)
    s_waitcnt vmcnt(0)
    v_lshlrev_b32 v140, 16, v132
    v_and_b32 v141, 0xffff0000, v132
    v_mul_f32 v140, v140, v128
    v_mul_f32 v141, v141, v129
    v_cvt_pk_bf16_f32 v140, 0, v140
    v_cvt_pk_bf16_f32 v141, 0, v141
    v_add_f32 v96, v88, v140
    v_add_f32 v97, v89, v141
    v_lshlrev_b32 v140, 16, v133
    v_and_b32 v141, 0xffff0000, v133
    v_mul_f32 v140, v140, v130
    v_mul_f32 v141, v141, v131
    v_cvt_pk_bf16_f32 v140, 0, v140
    v_cvt_pk_bf16_f32 v141, 0, v141
    v_add_f32 v98, v90, v140
    v_add_f32 v99, v91, v141
    buffer_store_dwordx4 v[96:99], v138, s[16:19], s43 offen
    v_lshlrev_b32 v140, 16, v134
    v_and_b32 v141, 0xffff0000, v134
    v_mul_f32 v140, v140, v128
    v_mul_f32 v141, v141, v129
    v_cvt_pk_bf16_f32 v140, 0, v140
    v_cvt_pk_bf16_f32 v141, 0, v141
    v_add_f32 v100, v92, v140
    v_add_f32 v101, v93, v141
    v_lshlrev_b32 v140, 16, v135
    v_and_b32 v141, 0xffff0000, v135
    v_mul_f32 v140, v140, v130
    v_mul_f32 v141, v141, v131
    v_cvt_pk_bf16_f32 v140, 0, v140
    v_cvt_pk_bf16_f32 v141, 0, v141
    v_add_f32 v102, v94, v140
    v_add_f32 v103, v95, v141
    buffer_store_dwordx4 v[100:103], v139, s[16:19], s43 offen
    s_branch L_ste_250
L_rbad_252:
    buffer_load_dwordx4 v[88:91], v112, s[12:15], s39 offen offset:0 sc1
    s_add_u32 s36, s36, 1
    s_cmp_gt_u32 s36, 0x100000
    s_cbranch_scc1 chain_kernel_wend
    s_waitcnt vmcnt(0)
    v_xor_b32 v124, s7, v88
    v_bitop3_b32 v124, v124, v89, s7 bitop3:0xf6
    v_bitop3_b32 v124, v124, v90, s7 bitop3:0xf6
    v_bitop3_b32 v124, v124, v91, s7 bitop3:0xf6
    v_and_b32 v124, 1, v124
    v_cmp_ne_u32 vcc, 0, v124
    s_cbranch_vccnz L_rbad_252
    s_branch L_rok_253
L_rbad_254:
    buffer_load_dwordx4 v[88:91], v112, s[12:15], s39 offen offset:0 sc1
    s_add_u32 s36, s36, 1
    s_cmp_gt_u32 s36, 0x100000
    s_cbranch_scc1 chain_kernel_wend
    s_waitcnt vmcnt(0)
    v_xor_b32 v124, s7, v88
    v_bitop3_b32 v124, v124, v89, s7 bitop3:0xf6
    v_bitop3_b32 v124, v124, v90, s7 bitop3:0xf6
    v_bitop3_b32 v124, v124, v91, s7 bitop3:0xf6
    v_and_b32 v124, 1, v124
    v_cmp_ne_u32 vcc, 0, v124
    s_cbranch_vccnz L_rbad_254
    s_branch L_rok_255
L_rbad_256:
    buffer_load_dwordx4 v[88:91], v112, s[12:15], s39 offen offset:0 sc1
    s_add_u32 s36, s36, 1
    s_cmp_gt_u32 s36, 0x100000
    s_cbranch_scc1 chain_kernel_wend
    s_waitcnt vmcnt(0)
    v_xor_b32 v124, s7, v88
    v_bitop3_b32 v124, v124, v89, s7 bitop3:0xf6
    v_bitop3_b32 v124, v124, v90, s7 bitop3:0xf6
    v_bitop3_b32 v124, v124, v91, s7 bitop3:0xf6
    v_and_b32 v124, 1, v124
    v_cmp_ne_u32 vcc, 0, v124
    s_cbranch_vccnz L_rbad_256
    s_branch L_rok_257
L_rbad_258:
    buffer_load_dwordx4 v[88:91], v112, s[12:15], s39 offen offset:0 sc1
    s_add_u32 s36, s36, 1
    s_cmp_gt_u32 s36, 0x100000
    s_cbranch_scc1 chain_kernel_wend
    s_waitcnt vmcnt(0)
    v_xor_b32 v124, s7, v88
    v_bitop3_b32 v124, v124, v89, s7 bitop3:0xf6
    v_bitop3_b32 v124, v124, v90, s7 bitop3:0xf6
    v_bitop3_b32 v124, v124, v91, s7 bitop3:0xf6
    v_and_b32 v124, 1, v124
    v_cmp_ne_u32 vcc, 0, v124
    s_cbranch_vccnz L_rbad_258
    s_branch L_rok_259
L_fl0_248:
    s_waitcnt lgkmcnt(0)
    s_nop 7
    s_sub_u32 s38, s22, 1
    s_and_b32 s31, s38, 3
    s_lshl_b32 s31, s31, 11
    s_bfe_u32 s38, s38, 0x10002
    s_xor_b32 s38, s38, 1
    s_cmp_eq_u32 s37, 0
    s_cselect_b32 s31, 0x40000000, s31
    s_cselect_b32 s38, 0, s38
    v_cvt_pk_bf16_f32 v104, v60, v61
    v_cvt_pk_bf16_f32 v105, v62, v63
    v_cvt_pk_bf16_f32 v106, v64, v65
    v_cvt_pk_bf16_f32 v107, v66, v67
    v_and_or_b32 v104, v104, -2, s38
    v_and_or_b32 v105, v105, -2, s38
    v_and_or_b32 v106, v106, -2, s38
    v_and_or_b32 v107, v107, -2, s38
    s_add_u32 s29, s45, s31
    buffer_store_dwordx4 v[104:107], v112, s[12:15], s29 offen offset:0 sc1
    buffer_load_dwordx2 v[132:133], v136, s[32:35], s42 offen
    buffer_load_dwordx2 v[134:135], v137, s[32:35], s42 offen
    s_waitcnt vmcnt(0)
    v_xor_b32 v124, s7, v88
    v_bitop3_b32 v124, v124, v89, s7 bitop3:0xf6
    v_bitop3_b32 v124, v124, v90, s7 bitop3:0xf6
    v_bitop3_b32 v124, v124, v91, s7 bitop3:0xf6
    v_and_b32 v124, 1, v124
    v_cmp_ne_u32 vcc, 0, v124
    s_nop 0
    s_nop 0
    s_nop 0
    s_cbranch_vccnz L_rbad_260
L_rok_261:
    v_lshlrev_b32 v124, 16, v88
    v_and_b32 v125, 0xffff0000, v88
    v_add_f32 v96, v116, v124
    v_add_f32 v97, v117, v125
    v_lshlrev_b32 v124, 16, v89
    v_and_b32 v125, 0xffff0000, v89
    v_add_f32 v98, v118, v124
    v_add_f32 v99, v119, v125
    v_lshlrev_b32 v124, 16, v90
    v_and_b32 v125, 0xffff0000, v90
    v_add_f32 v100, v120, v124
    v_add_f32 v101, v121, v125
    v_lshlrev_b32 v124, 16, v91
    v_and_b32 v125, 0xffff0000, v91
    v_add_f32 v102, v122, v124
    v_add_f32 v103, v123, v125
    ds_write_b128 v114, v[96:99]
    ds_write_b128 v115, v[100:103]
    ds_read_b128 v[88:91], v113 offset:0
    ds_read_b128 v[92:95], v113 offset:1024
    s_waitcnt lgkmcnt(0)
    s_waitcnt vmcnt(0)
    v_lshlrev_b32 v140, 16, v132
    v_and_b32 v141, 0xffff0000, v132
    v_mul_f32 v140, v140, v128
    v_mul_f32 v141, v141, v129
    v_cvt_pk_bf16_f32 v140, 0, v140
    v_cvt_pk_bf16_f32 v141, 0, v141
    v_add_f32 v96, v88, v140
    v_add_f32 v97, v89, v141
    v_lshlrev_b32 v140, 16, v133
    v_and_b32 v141, 0xffff0000, v133
    v_mul_f32 v140, v140, v130
    v_mul_f32 v141, v141, v131
    v_cvt_pk_bf16_f32 v140, 0, v140
    v_cvt_pk_bf16_f32 v141, 0, v141
    v_add_f32 v98, v90, v140
    v_add_f32 v99, v91, v141
    buffer_store_dwordx4 v[96:99], v138, s[16:19], s43 offen
    v_lshlrev_b32 v140, 16, v134
    v_and_b32 v141, 0xffff0000, v134
    v_mul_f32 v140, v140, v128
    v_mul_f32 v141, v141, v129
    v_cvt_pk_bf16_f32 v140, 0, v140
    v_cvt_pk_bf16_f32 v141, 0, v141
    v_add_f32 v100, v92, v140
    v_add_f32 v101, v93, v141
    v_lshlrev_b32 v140, 16, v135
    v_and_b32 v141, 0xffff0000, v135
    v_mul_f32 v140, v140, v130
    v_mul_f32 v141, v141, v131
    v_cvt_pk_bf16_f32 v140, 0, v140
    v_cvt_pk_bf16_f32 v141, 0, v141
    v_add_f32 v102, v94, v140
    v_add_f32 v103, v95, v141
    buffer_store_dwordx4 v[100:103], v139, s[16:19], s43 offen
    v_mov_b32 v116, v52
    v_mov_b32 v117, v53
    v_mov_b32 v118, v54
    v_mov_b32 v119, v55
    v_mov_b32 v120, v56
    v_mov_b32 v121, v57
    v_mov_b32 v122, v58
    v_mov_b32 v123, v59
    s_mov_b32 s7, s38
    s_add_u32 s39, s44, s31
    s_sub_u32 s43, s22, 1
    s_lshl_b32 s42, s43, 16
    s_lshl_b32 s43, s43, 18
    s_cmp_eq_u32 s37, 0
    s_cselect_b32 s42, 0x7ff00000, s42
    s_cselect_b32 s43, 0x7ff00000, s43
    buffer_load_dwordx4 v[88:91], v112, s[12:15], s39 offen offset:0 sc1
    s_mov_b32 s37, 1
    buffer_load_dwordx2 v[132:133], v136, s[32:35], s42 offen
    buffer_load_dwordx2 v[134:135], v137, s[32:35], s42 offen
    s_waitcnt vmcnt(0)
    v_xor_b32 v124, s7, v88
    v_bitop3_b32 v124, v124, v89, s7 bitop3:0xf6
    v_bitop3_b32 v124, v124, v90, s7 bitop3:0xf6
    v_bitop3_b32 v124, v124, v91, s7 bitop3:0xf6
    v_and_b32 v124, 1, v124
    v_cmp_ne_u32 vcc, 0, v124
    s_nop 0
    s_nop 0
    s_nop 0
    s_cbranch_vccnz L_rbad_262
L_rok_263:
    v_lshlrev_b32 v124, 16, v88
    v_and_b32 v125, 0xffff0000, v88
    v_add_f32 v96, v116, v124
    v_add_f32 v97, v117, v125
    v_lshlrev_b32 v124, 16, v89
    v_and_b32 v125, 0xffff0000, v89
    v_add_f32 v98, v118, v124
    v_add_f32 v99, v119, v125
    v_lshlrev_b32 v124, 16, v90
    v_and_b32 v125, 0xffff0000, v90
    v_add_f32 v100, v120, v124
    v_add_f32 v101, v121, v125
    v_lshlrev_b32 v124, 16, v91
    v_and_b32 v125, 0xffff0000, v91
    v_add_f32 v102, v122, v124
    v_add_f32 v103, v123, v125
    ds_write_b128 v114, v[96:99]
    ds_write_b128 v115, v[100:103]
    ds_read_b128 v[88:91], v113 offset:0
    ds_read_b128 v[92:95], v113 offset:1024
    s_waitcnt lgkmcnt(0)
    s_waitcnt vmcnt(0)
    v_lshlrev_b32 v140, 16, v132
    v_and_b32 v141, 0xffff0000, v132
    v_mul_f32 v140, v140, v128
    v_mul_f32 v141, v141, v129
    v_cvt_pk_bf16_f32 v140, 0, v140
    v_cvt_pk_bf16_f32 v141, 0, v141
    v_add_f32 v96, v88, v140
    v_add_f32 v97, v89, v141
    v_lshlrev_b32 v140, 16, v133
    v_and_b32 v141, 0xffff0000, v133
    v_mul_f32 v140, v140, v130
    v_mul_f32 v141, v141, v131
    v_cvt_pk_bf16_f32 v140, 0, v140
    v_cvt_pk_bf16_f32 v141, 0, v141
    v_add_f32 v98, v90, v140
    v_add_f32 v99, v91, v141
    buffer_store_dwordx4 v[96:99], v138, s[16:19], s43 offen
    v_lshlrev_b32 v140, 16, v134
    v_and_b32 v141, 0xffff0000, v134
    v_mul_f32 v140, v140, v128
    v_mul_f32 v141, v141, v129
    v_cvt_pk_bf16_f32 v140, 0, v140
    v_cvt_pk_bf16_f32 v141, 0, v141
    v_add_f32 v100, v92, v140
    v_add_f32 v101, v93, v141
    v_lshlrev_b32 v140, 16, v135
    v_and_b32 v141, 0xffff0000, v135
    v_mul_f32 v140, v140, v130
    v_mul_f32 v141, v141, v131
    v_cvt_pk_bf16_f32 v140, 0, v140
    v_cvt_pk_bf16_f32 v141, 0, v141
    v_add_f32 v102, v94, v140
    v_add_f32 v103, v95, v141
    buffer_store_dwordx4 v[100:103], v139, s[16:19], s43 offen
    s_branch L_ste_250
L_rbad_260:
    buffer_load_dwordx4 v[88:91], v112, s[12:15], s39 offen offset:0 sc1
    s_add_u32 s36, s36, 1
    s_cmp_gt_u32 s36, 0x100000
    s_cbranch_scc1 chain_kernel_wend
    s_waitcnt vmcnt(0)
    v_xor_b32 v124, s7, v88
    v_bitop3_b32 v124, v124, v89, s7 bitop3:0xf6
    v_bitop3_b32 v124, v124, v90, s7 bitop3:0xf6
    v_bitop3_b32 v124, v124, v91, s7 bitop3:0xf6
    v_and_b32 v124, 1, v124
    v_cmp_ne_u32 vcc, 0, v124
    s_cbranch_vccnz L_rbad_260
    s_branch L_rok_261
L_rbad_262:
    buffer_load_dwordx4 v[88:91], v112, s[12:15], s39 offen offset:0 sc1
    s_add_u32 s36, s36, 1
    s_cmp_gt_u32 s36, 0x100000
    s_cbranch_scc1 chain_kernel_wend
    s_waitcnt vmcnt(0)
    v_xor_b32 v124, s7, v88
    v_bitop3_b32 v124, v124, v89, s7 bitop3:0xf6
    v_bitop3_b32 v124, v124, v90, s7 bitop3:0xf6
    v_bitop3_b32 v124, v124, v91, s7 bitop3:0xf6
    v_and_b32 v124, 1, v124
    v_cmp_ne_u32 vcc, 0, v124
    s_cbranch_vccnz L_rbad_262
    s_branch L_rok_263
L_ste_250:
    s_branch L_run_244
L_rdone_247:
L_op_205:
    s_mov_b32 s38, s41
    s_and_b32 s39, s38, 3
    s_lshr_b32 s42, s38, 2
    s_lshl_b32 s44, s40, 5
    s_add_u32 s44, s44, s38
    s_lshl_b32 s44, s44, 15
    s_lshl_b32 s25, s49, 13
    s_add_u32 s44, s44, s25
    s_xor_b32 s45, s44, 0x8000
    s_add_u32 s45, s45, 0x6900000
    s_xor_b32 s46, s44, 0x10000
    s_add_u32 s46, s46, 0x6900000
    s_xor_b32 s47, s44, 0x18000
    s_add_u32 s47, s47, 0x6900000
    s_add_u32 s44, s44, 0x6900000
    s_lshl_b32 s48, s40, 3
    s_lshr_b32 s25, s38, 2
    s_add_u32 s48, s48, s25
    s_lshl_b32 s48, s48, 7
    s_add_u32 s48, s48, 0x590c000
    s_mov_b32 s16, s92
    s_and_b32 s17, s93, 0xffff
    s_mov_b32 s18, 0x800000
    s_mov_b32 s19, 0x00020000
    s_lshl_b32 s50, s39, 21
    s_lshl_b32 s25, s42, 8
    s_add_u32 s50, s50, s25
    v_mov_b32 v104, 0
    v_mov_b32 v105, 0
    v_mov_b32 v106, 0
    v_mov_b32 v107, 0
    v_and_b32 v2, 63, v0
    v_lshlrev_b32 v3, 4, v2
    v_lshlrev_b32 v112, 3, v2
    s_add_u32 s28, s44, 0
    buffer_store_dwordx4 v[104:107], v3, s[12:15], s28 offen sc1
    s_add_u32 s28, s44, 1024
    buffer_store_dwordx4 v[104:107], v3, s[12:15], s28 offen sc1
    s_add_u32 s28, s44, 2048
    buffer_store_dwordx4 v[104:107], v3, s[12:15], s28 offen sc1
    s_add_u32 s28, s44, 3072
    buffer_store_dwordx4 v[104:107], v3, s[12:15], s28 offen sc1
    s_add_u32 s28, s44, 4096
    buffer_store_dwordx4 v[104:107], v3, s[12:15], s28 offen sc1
    s_add_u32 s28, s44, 5120
    buffer_store_dwordx4 v[104:107], v3, s[12:15], s28 offen sc1
    s_add_u32 s28, s44, 6144
    buffer_store_dwordx4 v[104:107], v3, s[12:15], s28 offen sc1
    s_add_u32 s28, s44, 7168
    buffer_store_dwordx4 v[104:107], v3, s[12:15], s28 offen sc1
    v_lshrrev_b32 v1, 6, v0
    v_lshlrev_b32 v1, 11, v1
    v_add_u32 v1, 0x21000, v1
    v_add_u32 v113, v1, v3
    v_and_b32 v2, 15, v0
    v_lshl_add_u32 v1, v2, 2, v1
    v_bfe_u32 v2, v0, 4, 2
    v_lshl_add_u32 v114, v2, 7, v1
    v_and_b32 v1, 15, v0
    v_bfe_u32 v2, v0, 4, 2
    v_lshrrev_b32 v3, 6, v0
    v_lshlrev_b32 v4, 2, v2
    v_xor_b32 v4, v4, v1
    v_lshlrev_b32 v4, 4, v4
    v_lshl_add_u32 v5, v3, 5, v2
    s_mov_b32 s25, 2048
    v_mul_lo_u32 v5, v5, s25
    v_add_u32 v20, v5, v4
    v_bfe_u32 v4, v0, 2, 2
    v_lshl_add_u32 v5, v2, 3, v4
    v_lshlrev_b32 v5, 8, v5
    v_xor_b32 v4, v4, v3
    v_lshl_add_u32 v5, v4, 6, v5
    v_and_b32 v4, 3, v0
    v_lshl_add_u32 v5, v4, 3, v5
    v_mov_b32 v21, v5
    v_add_u32 v22, 32, v21
    v_add_u32 v23, 0x10000, v21
    v_add_u32 v24, 0x10000, v22
    s_lshl_b32 s26, s49, 13
    s_mov_b32 s25, s50
    s_barrier
    s_add_u32 m0, s26, 0
    s_add_u32 s27, s25, 0
    buffer_load_dwordx4 v20, s[16:19], s27 offen lds
    s_add_u32 m0, s26, 1024
    s_add_u32 s27, s25, 8192
    buffer_load_dwordx4 v20, s[16:19], s27 offen lds
    s_add_u32 m0, s26, 2048
    s_add_u32 s27, s25, 16384
    buffer_load_dwordx4 v20, s[16:19], s27 offen lds
    s_add_u32 m0, s26, 3072
    s_add_u32 s27, s25, 24576
    buffer_load_dwordx4 v20, s[16:19], s27 offen lds
    s_add_u32 m0, s26, 4096
    s_add_u32 s27, s25, 32768
    buffer_load_dwordx4 v20, s[16:19], s27 offen lds
    s_add_u32 m0, s26, 5120
    s_add_u32 s27, s25, 40960
    buffer_load_dwordx4 v20, s[16:19], s27 offen lds
    s_add_u32 m0, s26, 6144
    s_add_u32 s27, s25, 49152
    buffer_load_dwordx4 v20, s[16:19], s27 offen lds
    s_add_u32 m0, s26, 7168
    s_add_u32 s27, s25, 57344
    buffer_load_dwordx4 v20, s[16:19], s27 offen lds
    s_add_u32 m0, s26, 32768
    s_add_u32 s27, s25, 262144
    buffer_load_dwordx4 v20, s[16:19], s27 offen lds
    s_add_u32 m0, s26, 33792
    s_add_u32 s27, s25, 270336
    buffer_load_dwordx4 v20, s[16:19], s27 offen lds
    s_add_u32 m0, s26, 34816
    s_add_u32 s27, s25, 278528
    buffer_load_dwordx4 v20, s[16:19], s27 offen lds
    s_add_u32 m0, s26, 35840
    s_add_u32 s27, s25, 286720
    buffer_load_dwordx4 v20, s[16:19], s27 offen lds
    s_add_u32 m0, s26, 36864
    s_add_u32 s27, s25, 294912
    buffer_load_dwordx4 v20, s[16:19], s27 offen lds
    s_add_u32 m0, s26, 37888
    s_add_u32 s27, s25, 303104
    buffer_load_dwordx4 v20, s[16:19], s27 offen lds
    s_add_u32 m0, s26, 38912
    s_add_u32 s27, s25, 311296
    buffer_load_dwordx4 v20, s[16:19], s27 offen lds
    s_add_u32 m0, s26, 39936
    s_add_u32 s27, s25, 319488
    buffer_load_dwordx4 v20, s[16:19], s27 offen lds
    s_add_u32 m0, s26, 65536
    s_add_u32 s27, s25, 524288
    buffer_load_dwordx4 v20, s[16:19], s27 offen lds
    s_add_u32 m0, s26, 66560
    s_add_u32 s27, s25, 532480
    buffer_load_dwordx4 v20, s[16:19], s27 offen lds
    s_add_u32 m0, s26, 67584
    s_add_u32 s27, s25, 540672
    buffer_load_dwordx4 v20, s[16:19], s27 offen lds
    s_add_u32 m0, s26, 68608
    s_add_u32 s27, s25, 548864
    buffer_load_dwordx4 v20, s[16:19], s27 offen lds
    s_add_u32 m0, s26, 69632
    s_add_u32 s27, s25, 557056
    buffer_load_dwordx4 v20, s[16:19], s27 offen lds
    s_add_u32 m0, s26, 70656
    s_add_u32 s27, s25, 565248
    buffer_load_dwordx4 v20, s[16:19], s27 offen lds
    s_add_u32 m0, s26, 71680
    s_add_u32 s27, s25, 573440
    buffer_load_dwordx4 v20, s[16:19], s27 offen lds
    s_add_u32 m0, s26, 72704
    s_add_u32 s27, s25, 581632
    buffer_load_dwordx4 v20, s[16:19], s27 offen lds
    s_add_u32 m0, s26, 98304
    s_add_u32 s27, s25, 786432
    buffer_load_dwordx4 v20, s[16:19], s27 offen lds
    s_add_u32 m0, s26, 99328
    s_add_u32 s27, s25, 794624
    buffer_load_dwordx4 v20, s[16:19], s27 offen lds
    s_add_u32 m0, s26, 100352
    s_add_u32 s27, s25, 802816
    buffer_load_dwordx4 v20, s[16:19], s27 offen lds
    s_add_u32 m0, s26, 101376
    s_add_u32 s27, s25, 811008
    buffer_load_dwordx4 v20, s[16:19], s27 offen lds
    s_add_u32 m0, s26, 102400
    s_add_u32 s27, s25, 819200
    buffer_load_dwordx4 v20, s[16:19], s27 offen lds
    s_add_u32 m0, s26, 103424
    s_add_u32 s27, s25, 827392
    buffer_load_dwordx4 v20, s[16:19], s27 offen lds
    s_add_u32 m0, s26, 104448
    s_add_u32 s27, s25, 835584
    buffer_load_dwordx4 v20, s[16:19], s27 offen lds
    s_add_u32 m0, s26, 105472
    s_add_u32 s27, s25, 843776
    buffer_load_dwordx4 v20, s[16:19], s27 offen lds
    s_waitcnt vmcnt(24)
    s_barrier
    buffer_atomic_add v84, v85, s[12:15], s48 offen sc1
    ds_read_b64_tr_b16 a[0:1], v21 offset:0
    ds_read_b64_tr_b16 a[2:3], v21 offset:1024
    ds_read_b64_tr_b16 a[4:5], v22 offset:0
    ds_read_b64_tr_b16 a[6:7], v22 offset:1024
    ds_read_b64_tr_b16 a[8:9], v21 offset:8192
    ds_read_b64_tr_b16 a[10:11], v21 offset:9216
    ds_read_b64_tr_b16 a[12:13], v22 offset:8192
    ds_read_b64_tr_b16 a[14:15], v22 offset:9216
    s_waitcnt lgkmcnt(0)
    ds_read_b64_tr_b16 a[16:17], v21 offset:16384
    ds_read_b64_tr_b16 a[18:19], v21 offset:17408
    ds_read_b64_tr_b16 a[20:21], v22 offset:16384
    ds_read_b64_tr_b16 a[22:23], v22 offset:17408
    ds_read_b64_tr_b16 a[24:25], v21 offset:24576
    ds_read_b64_tr_b16 a[26:27], v21 offset:25600
    ds_read_b64_tr_b16 a[28:29], v22 offset:24576
    ds_read_b64_tr_b16 a[30:31], v22 offset:25600
    s_waitcnt lgkmcnt(0)
    s_barrier
    s_add_u32 m0, s26, 0
    s_add_u32 s27, s25, 1048576
    buffer_load_dwordx4 v20, s[16:19], s27 offen lds
    s_add_u32 m0, s26, 1024
    s_add_u32 s27, s25, 1056768
    buffer_load_dwordx4 v20, s[16:19], s27 offen lds
    s_add_u32 m0, s26, 2048
    s_add_u32 s27, s25, 1064960
    buffer_load_dwordx4 v20, s[16:19], s27 offen lds
    s_add_u32 m0, s26, 3072
    s_add_u32 s27, s25, 1073152
    buffer_load_dwordx4 v20, s[16:19], s27 offen lds
    s_add_u32 m0, s26, 4096
    s_add_u32 s27, s25, 1081344
    buffer_load_dwordx4 v20, s[16:19], s27 offen lds
    s_add_u32 m0, s26, 5120
    s_add_u32 s27, s25, 1089536
    buffer_load_dwordx4 v20, s[16:19], s27 offen lds
    s_add_u32 m0, s26, 6144
    s_add_u32 s27, s25, 1097728
    buffer_load_dwordx4 v20, s[16:19], s27 offen lds
    s_add_u32 m0, s26, 7168
    s_add_u32 s27, s25, 1105920
    buffer_load_dwordx4 v20, s[16:19], s27 offen lds
    s_waitcnt vmcnt(24)
    s_barrier
    ds_read_b64_tr_b16 a[32:33], v21 offset:32768
    ds_read_b64_tr_b16 a[34:35], v21 offset:33792
    ds_read_b64_tr_b16 a[36:37], v22 offset:32768
    ds_read_b64_tr_b16 a[38:39], v22 offset:33792
    ds_read_b64_tr_b16 a[40:41], v21 offset:40960
    ds_read_b64_tr_b16 a[42:43], v21 offset:41984
    ds_read_b64_tr_b16 a[44:45], v22 offset:40960
    ds_read_b64_tr_b16 a[46:47], v22 offset:41984
    s_waitcnt lgkmcnt(0)
    ds_read_b64_tr_b16 a[48:49], v21 offset:49152
    ds_read_b64_tr_b16 a[50:51], v21 offset:50176
    ds_read_b64_tr_b16 a[52:53], v22 offset:49152
    ds_read_b64_tr_b16 a[54:55], v22 offset:50176
    ds_read_b64_tr_b16 a[56:57], v21 offset:57344
    ds_read_b64_tr_b16 a[58:59], v21 offset:58368
    ds_read_b64_tr_b16 a[60:61], v22 offset:57344
    ds_read_b64_tr_b16 a[62:63], v22 offset:58368
    s_waitcnt lgkmcnt(0)
    s_barrier
    s_add_u32 m0, s26, 32768
    s_add_u32 s27, s25, 1310720
    buffer_load_dwordx4 v20, s[16:19], s27 offen lds
    s_add_u32 m0, s26, 33792
    s_add_u32 s27, s25, 1318912
    buffer_load_dwordx4 v20, s[16:19], s27 offen lds
    s_add_u32 m0, s26, 34816
    s_add_u32 s27, s25, 1327104
    buffer_load_dwordx4 v20, s[16:19], s27 offen lds
    s_add_u32 m0, s26, 35840
    s_add_u32 s27, s25, 1335296
    buffer_load_dwordx4 v20, s[16:19], s27 offen lds
    s_add_u32 m0, s26, 36864
    s_add_u32 s27, s25, 1343488
    buffer_load_dwordx4 v20, s[16:19], s27 offen lds
    s_add_u32 m0, s26, 37888
    s_add_u32 s27, s25, 1351680
    buffer_load_dwordx4 v20, s[16:19], s27 offen lds
    s_add_u32 m0, s26, 38912
    s_add_u32 s27, s25, 1359872
    buffer_load_dwordx4 v20, s[16:19], s27 offen lds
    s_add_u32 m0, s26, 39936
    s_add_u32 s27, s25, 1368064
    buffer_load_dwordx4 v20, s[16:19], s27 offen lds
    s_waitcnt vmcnt(24)
    s_barrier
    ds_read_b64_tr_b16 a[64:65], v23 offset:0
    ds_read_b64_tr_b16 a[66:67], v23 offset:1024
    ds_read_b64_tr_b16 a[68:69], v24 offset:0
    ds_read_b64_tr_b16 a[70:71], v24 offset:1024
    ds_read_b64_tr_b16 a[72:73], v23 offset:8192
    ds_read_b64_tr_b16 a[74:75], v23 offset:9216
    ds_read_b64_tr_b16 a[76:77], v24 offset:8192
    ds_read_b64_tr_b16 a[78:79], v24 offset:9216
    s_waitcnt lgkmcnt(0)
    ds_read_b64_tr_b16 a[80:81], v23 offset:16384
    ds_read_b64_tr_b16 a[82:83], v23 offset:17408
    ds_read_b64_tr_b16 a[84:85], v24 offset:16384
    ds_read_b64_tr_b16 a[86:87], v24 offset:17408
    ds_read_b64_tr_b16 a[88:89], v23 offset:24576
    ds_read_b64_tr_b16 a[90:91], v23 offset:25600
    ds_read_b64_tr_b16 a[92:93], v24 offset:24576
    ds_read_b64_tr_b16 a[94:95], v24 offset:25600
    s_waitcnt lgkmcnt(0)
    s_barrier
    s_add_u32 m0, s26, 65536
    s_add_u32 s27, s25, 1572864
    buffer_load_dwordx4 v20, s[16:19], s27 offen lds
    s_add_u32 m0, s26, 66560
    s_add_u32 s27, s25, 1581056
    buffer_load_dwordx4 v20, s[16:19], s27 offen lds
    s_add_u32 m0, s26, 67584
    s_add_u32 s27, s25, 1589248
    buffer_load_dwordx4 v20, s[16:19], s27 offen lds
    s_add_u32 m0, s26, 68608
    s_add_u32 s27, s25, 1597440
    buffer_load_dwordx4 v20, s[16:19], s27 offen lds
    s_add_u32 m0, s26, 69632
    s_add_u32 s27, s25, 1605632
    buffer_load_dwordx4 v20, s[16:19], s27 offen lds
    s_add_u32 m0, s26, 70656
    s_add_u32 s27, s25, 1613824
    buffer_load_dwordx4 v20, s[16:19], s27 offen lds
    s_add_u32 m0, s26, 71680
    s_add_u32 s27, s25, 1622016
    buffer_load_dwordx4 v20, s[16:19], s27 offen lds
    s_add_u32 m0, s26, 72704
    s_add_u32 s27, s25, 1630208
    buffer_load_dwordx4 v20, s[16:19], s27 offen lds
    s_waitcnt vmcnt(24)
    s_barrier
    ds_read_b64_tr_b16 a[96:97], v23 offset:32768
    ds_read_b64_tr_b16 a[98:99], v23 offset:33792
    ds_read_b64_tr_b16 a[100:101], v24 offset:32768
    ds_read_b64_tr_b16 a[102:103], v24 offset:33792
    ds_read_b64_tr_b16 a[104:105], v23 offset:40960
    ds_read_b64_tr_b16 a[106:107], v23 offset:41984
    ds_read_b64_tr_b16 a[108:109], v24 offset:40960
    ds_read_b64_tr_b16 a[110:111], v24 offset:41984
    s_waitcnt lgkmcnt(0)
    ds_read_b64_tr_b16 a[112:113], v23 offset:49152
    ds_read_b64_tr_b16 a[114:115], v23 offset:50176
    ds_read_b64_tr_b16 a[116:117], v24 offset:49152
    ds_read_b64_tr_b16 a[118:119], v24 offset:50176
    ds_read_b64_tr_b16 a[120:121], v23 offset:57344
    ds_read_b64_tr_b16 a[122:123], v23 offset:58368
    ds_read_b64_tr_b16 a[124:125], v24 offset:57344
    ds_read_b64_tr_b16 a[126:127], v24 offset:58368
    s_waitcnt lgkmcnt(0)
    s_barrier
    s_add_u32 m0, s26, 98304
    s_add_u32 s27, s25, 1835008
    buffer_load_dwordx4 v20, s[16:19], s27 offen lds
    s_add_u32 m0, s26, 99328
    s_add_u32 s27, s25, 1843200
    buffer_load_dwordx4 v20, s[16:19], s27 offen lds
    s_add_u32 m0, s26, 100352
    s_add_u32 s27, s25, 1851392
    buffer_load_dwordx4 v20, s[16:19], s27 offen lds
    s_add_u32 m0, s26, 101376
    s_add_u32 s27, s25, 1859584
    buffer_load_dwordx4 v20, s[16:19], s27 offen lds
    s_add_u32 m0, s26, 102400
    s_add_u32 s27, s25, 1867776
    buffer_load_dwordx4 v20, s[16:19], s27 offen lds
    s_add_u32 m0, s26, 103424
    s_add_u32 s27, s25, 1875968
    buffer_load_dwordx4 v20, s[16:19], s27 offen lds
    s_add_u32 m0, s26, 104448
    s_add_u32 s27, s25, 1884160
    buffer_load_dwordx4 v20, s[16:19], s27 offen lds
    s_add_u32 m0, s26, 105472
    s_add_u32 s27, s25, 1892352
    buffer_load_dwordx4 v20, s[16:19], s27 offen lds
    s_waitcnt vmcnt(24)
    s_barrier
    ds_read_b64_tr_b16 a[128:129], v21 offset:0
    ds_read_b64_tr_b16 a[130:131], v21 offset:1024
    ds_read_b64_tr_b16 a[132:133], v22 offset:0
    ds_read_b64_tr_b16 a[134:135], v22 offset:1024
    ds_read_b64_tr_b16 a[136:137], v21 offset:8192
    ds_read_b64_tr_b16 a[138:139], v21 offset:9216
    ds_read_b64_tr_b16 a[140:141], v22 offset:8192
    ds_read_b64_tr_b16 a[142:143], v22 offset:9216
    s_waitcnt lgkmcnt(0)
    ds_read_b64_tr_b16 a[144:145], v21 offset:16384
    ds_read_b64_tr_b16 a[146:147], v21 offset:17408
    ds_read_b64_tr_b16 a[148:149], v22 offset:16384
    ds_read_b64_tr_b16 a[150:151], v22 offset:17408
    ds_read_b64_tr_b16 a[152:153], v21 offset:24576
    ds_read_b64_tr_b16 a[154:155], v21 offset:25600
    ds_read_b64_tr_b16 a[156:157], v22 offset:24576
    ds_read_b64_tr_b16 a[158:159], v22 offset:25600
    s_waitcnt lgkmcnt(0)
    s_waitcnt vmcnt(16)
    s_barrier
    ds_read_b64_tr_b16 a[160:161], v21 offset:32768
    ds_read_b64_tr_b16 a[162:163], v21 offset:33792
    ds_read_b64_tr_b16 a[164:165], v22 offset:32768
    ds_read_b64_tr_b16 a[166:167], v22 offset:33792
    ds_read_b64_tr_b16 a[168:169], v21 offset:40960
    ds_read_b64_tr_b16 a[170:171], v21 offset:41984
    ds_read_b64_tr_b16 a[172:173], v22 offset:40960
    ds_read_b64_tr_b16 a[174:175], v22 offset:41984
    s_waitcnt lgkmcnt(0)
    ds_read_b64_tr_b16 a[176:177], v21 offset:49152
    ds_read_b64_tr_b16 a[178:179], v21 offset:50176
    ds_read_b64_tr_b16 a[180:181], v22 offset:49152
    ds_read_b64_tr_b16 a[182:183], v22 offset:50176
    ds_read_b64_tr_b16 a[184:185], v21 offset:57344
    ds_read_b64_tr_b16 a[186:187], v21 offset:58368
    ds_read_b64_tr_b16 a[188:189], v22 offset:57344
    ds_read_b64_tr_b16 a[190:191], v22 offset:58368
    s_waitcnt lgkmcnt(0)
    s_waitcnt vmcnt(8)
    s_barrier
    ds_read_b64_tr_b16 a[192:193], v23 offset:0
    ds_read_b64_tr_b16 a[194:195], v23 offset:1024
    ds_read_b64_tr_b16 a[196:197], v24 offset:0
    ds_read_b64_tr_b16 a[198:199], v24 offset:1024
    ds_read_b64_tr_b16 a[200:201], v23 offset:8192
    ds_read_b64_tr_b16 a[202:203], v23 offset:9216
    ds_read_b64_tr_b16 a[204:205], v24 offset:8192
    ds_read_b64_tr_b16 a[206:207], v24 offset:9216
    s_waitcnt lgkmcnt(0)
    ds_read_b64_tr_b16 a[208:209], v23 offset:16384
    ds_read_b64_tr_b16 a[210:211], v23 offset:17408
    ds_read_b64_tr_b16 a[212:213], v24 offset:16384
    ds_read_b64_tr_b16 a[214:215], v24 offset:17408
    ds_read_b64_tr_b16 a[216:217], v23 offset:24576
    ds_read_b64_tr_b16 a[218:219], v23 offset:25600
    ds_read_b64_tr_b16 a[220:221], v24 offset:24576
    ds_read_b64_tr_b16 a[222:223], v24 offset:25600
    s_waitcnt lgkmcnt(0)
    s_waitcnt vmcnt(0)
    s_barrier
    ds_read_b64_tr_b16 a[224:225], v23 offset:32768
    ds_read_b64_tr_b16 a[226:227], v23 offset:33792
    ds_read_b64_tr_b16 a[228:229], v24 offset:32768
    ds_read_b64_tr_b16 a[230:231], v24 offset:33792
    ds_read_b64_tr_b16 a[232:233], v23 offset:40960
    ds_read_b64_tr_b16 a[234:235], v23 offset:41984
    ds_read_b64_tr_b16 a[236:237], v24 offset:40960
    ds_read_b64_tr_b16 a[238:239], v24 offset:41984
    s_waitcnt lgkmcnt(0)
    ds_read_b64_tr_b16 a[240:241], v23 offset:49152
    ds_read_b64_tr_b16 a[242:243], v23 offset:50176
    ds_read_b64_tr_b16 a[244:245], v24 offset:49152
    ds_read_b64_tr_b16 a[246:247], v24 offset:50176
    ds_read_b64_tr_b16 a[248:249], v23 offset:57344
    ds_read_b64_tr_b16 a[250:251], v23 offset:58368
    ds_read_b64_tr_b16 a[252:253], v24 offset:57344
    ds_read_b64_tr_b16 a[254:255], v24 offset:58368
    s_waitcnt lgkmcnt(0)
    v_mov_b32 v2, 0
L_pl_264:
    buffer_load_dword v1, v2, s[12:15], s48 offen sc1
    s_add_u32 s36, s36, 1
    s_cmp_gt_u32 s36, 0x100000
    s_cbranch_scc1 chain_kernel_wend
    s_waitcnt vmcnt(0)
    v_readfirstlane_b32 s26, v1
    s_cmp_ge_u32 s26, 4
    s_cbranch_scc1 L_plok_265
    s_sleep 4
    s_branch L_pl_264
L_plok_265:
    s_lshl_b32 s25, s42, 9
    s_lshl_b32 s26, s49, 7
    s_add_u32 s25, s25, s26
    s_lshl_b32 s26, s39, 13
    s_add_u32 s25, s25, s26
    s_add_u32 s25, s25, 4096
    v_bfe_u32 v1, v0, 3, 3
    v_and_b32 v2, 7, v0
    v_lshlrev_b32 v1, 15, v1
    v_lshl_add_u32 v1, v2, 4, v1
    v_add_u32 v128, s25, v1
    s_lshl_b32 s48, s39, 7
    s_add_u32 s48, s48, 0x5904000
    s_lshl_b32 s50, s39, 18
    s_add_u32 s50, s50, 2048
    s_mov_b32 s8, s100
    s_and_b32 s9, s101, 0xffff
    s_mov_b32 s10, 0x10000000
    s_mov_b32 s11, 0x00020000
    s_mov_b32 s16, s96
    s_and_b32 s17, s97, 0xffff
    s_mov_b32 s18, 0x1000000
    s_mov_b32 s19, 0x00020000
    s_lshl_b32 s39, s39, 4
    s_lshl_b32 s21, s49, 12
    v_and_b32 v1, 63, v0
    v_and_b32 v2, 15, v0
    v_bfe_u32 v3, v0, 4, 2
    v_lshrrev_b32 v4, 6, v0
    v_lshlrev_b32 v5, 4, v1
    v_lshl_add_u32 v5, v4, 14, v5
    v_add_u32 v8, 0, v5
    v_add_u32 v9, 1024, v5
    v_add_u32 v10, 4096, v5
    v_add_u32 v11, 5120, v5
    v_lshlrev_b32 v5, 4, v2
    v_lshl_add_u32 v5, v3, 9, v5
    v_xor_b32 v12, s39, v5
    v_xor_b32 v13, 0x100, v12
    v_add_u32 v16, 0x10000, v12
    v_add_u32 v17, 0x10000, v13
    s_cmp_lt_u32 s41, 16
    s_cselect_b32 s25, 12, 24
    s_lshr_b32 s26, s25, 1
    s_sub_u32 s95, s40, s26
    s_add_u32 s25, s25, 2
    s_cmp_eq_u32 s40, 3
    s_cselect_b32 s95, s25, s95
    s_cselect_b32 s94, 0, s40
    s_mov_b32 s22, 0
    s_mov_b32 s52, 0
    v_mov_b32 v2, 0x20000
    v_lshl_add_u32 v3, v0, 2, v2
    v_mov_b32 v4, 0
L_run_266:
    s_mov_b32 s25, s22
    s_mul_i32 s3, s25, 3
    s_add_u32 s3, s3, s95
    s_lshl1_add_u32 s25, s25, s94
    s_max_i32 s25, s25, s3
    s_cmp_ge_u32 s25, 64
    s_cbranch_scc1 L_rdone_269
    s_add_u32 s28, s22, 0
    s_min_u32 s28, s28, 63
    s_add_u32 s29, s22, 1
    s_add_u32 s25, s28, 0
    s_mul_i32 s3, s25, 3
    s_add_u32 s3, s3, s95
    s_lshl1_add_u32 s25, s25, s94
    s_max_i32 s25, s25, s3
    s_cmp_lt_u32 s25, 64
    s_cselect_b32 s25, s25, 0x200000
    s_lshl_b32 s25, s25, 9
    s_add_u32 s25, s25, s48
    s_add_u32 s26, s22, 1
    s_mul_i32 s3, s26, 3
    s_add_u32 s3, s3, s95
    s_lshl1_add_u32 s26, s26, s94
    s_max_i32 s26, s26, s3
    s_cmp_lt_u32 s26, 64
    s_cselect_b32 s26, s26, 0x200000
    s_lshl_b32 s26, s26, 9
    s_add_u32 s26, s26, s48
    s_add_u32 s27, s29, 1
    s_mul_i32 s3, s27, 3
    s_add_u32 s3, s3, s95
    s_lshl1_add_u32 s27, s27, s94
    s_max_i32 s27, s27, s3
    s_cmp_lt_u32 s27, 64
    s_cselect_b32 s27, s27, 0x200000
    s_lshl_b32 s27, s27, 9
    s_add_u32 s27, s27, s48
L_rw_267:
    buffer_load_dword v88, v4, s[12:15], s25 offen sc1
    buffer_load_dword v89, v4, s[12:15], s26 offen sc1
    buffer_load_dword v90, v4, s[12:15], s27 offen sc1
    s_add_u32 s36, s36, 1
    s_cmp_gt_u32 s36, 0x100000
    s_cbranch_scc1 chain_kernel_wend
    s_waitcnt vmcnt(0)
    s_barrier
    v_lshl_add_u32 v1, v0, 4, v2
    ds_write_b128 v1, v[88:91]
    s_waitcnt lgkmcnt(0)
    s_barrier
    ds_read_b128 v[88:91], v2
    s_waitcnt lgkmcnt(0)
    v_readfirstlane_b32 s28, v88
    s_cmp_ge_u32 s28, 8
    s_cbranch_scc1 L_rgo_268
    s_sleep 2
    s_branch L_rw_267
L_rgo_268:
    v_readfirstlane_b32 s51, v89
    v_mov_b32 v87, v90
    s_mov_b32 s24, s22
    s_add_u32 s23, s22, 1
    s_mov_b32 s37, 0
    s_mov_b32 s7, 0
    v_mov_b32 v88, 0
    v_mov_b32 v89, 0
    v_mov_b32 v90, 0
    v_mov_b32 v91, 0
    v_mov_b32 v92, 0
    v_mov_b32 v93, 0
    v_mov_b32 v94, 0
    v_mov_b32 v95, 0
    s_mov_b32 s30, s24
    s_mul_i32 s3, s30, 3
    s_add_u32 s3, s3, s95
    s_lshl1_add_u32 s30, s30, s94
    s_max_i32 s30, s30, s3
    s_bitcmp1_b32 s30, 1
    s_cselect_b32 s53, s54, s55
    s_lshl_b32 s30, s30, 20
    s_add_u32 s53, s53, s30
    s_add_u32 s53, s53, s50
    s_mov_b32 s20, s53
    s_mov_b32 s39, 0x7ff00000
    s_mov_b32 s42, 0x7ff00000
    s_mov_b32 s43, 0x7ff00000
    s_barrier
    s_add_u32 m0, s21, 0
    s_nop 0
    buffer_load_dwordx4 v8, s[8:11], s20 offen lds
    s_add_u32 m0, s21, 1024
    s_nop 0
    buffer_load_dwordx4 v9, s[8:11], s20 offen lds
    s_add_u32 m0, s21, 2048
    s_nop 0
    buffer_load_dwordx4 v10, s[8:11], s20 offen lds
    s_add_u32 m0, s21, 3072
    s_nop 0
    buffer_load_dwordx4 v11, s[8:11], s20 offen lds
    s_add_u32 s20, s20, 65536
    s_add_u32 m0, s21, 16384
    s_nop 0
    buffer_load_dwordx4 v8, s[8:11], s20 offen lds
    s_add_u32 m0, s21, 17408
    s_nop 0
    buffer_load_dwordx4 v9, s[8:11], s20 offen lds
    s_add_u32 m0, s21, 18432
    s_nop 0
    buffer_load_dwordx4 v10, s[8:11], s20 offen lds
    s_add_u32 m0, s21, 19456
    s_nop 0
    buffer_load_dwordx4 v11, s[8:11], s20 offen lds
    s_add_u32 s20, s20, 65536
    s_add_u32 m0, s21, 32768
    s_nop 0
    buffer_load_dwordx4 v8, s[8:11], s20 offen lds
    s_add_u32 m0, s21, 33792
    s_nop 0
    buffer_load_dwordx4 v9, s[8:11], s20 offen lds
    s_add_u32 m0, s21, 34816
    s_nop 0
    buffer_load_dwordx4 v10, s[8:11], s20 offen lds
    s_add_u32 m0, s21, 35840
    s_nop 0
    buffer_load_dwordx4 v11, s[8:11], s20 offen lds
    s_add_u32 s20, s20, 65536
    s_add_u32 m0, s21, 49152
    s_nop 0
    buffer_load_dwordx4 v8, s[8:11], s20 offen lds
    s_add_u32 m0, s21, 50176
    s_nop 0
    buffer_load_dwordx4 v9, s[8:11], s20 offen lds
    s_add_u32 m0, s21, 51200
    s_nop 0
    buffer_load_dwordx4 v10, s[8:11], s20 offen lds
    s_add_u32 m0, s21, 52224
    s_nop 0
    buffer_load_dwordx4 v11, s[8:11], s20 offen lds
    s_cmp_ge_u32 s51, 8
    s_cselect_b32 s30, 1, 0
    s_add_u32 s24, s24, s30
    s_add_u32 s23, s23, s30
    s_mov_b32 s30, s24
    s_mul_i32 s3, s30, 3
    s_add_u32 s3, s3, s95
    s_lshl1_add_u32 s30, s30, s94
    s_max_i32 s30, s30, s3
    s_bitcmp1_b32 s30, 1
    s_cselect_b32 s53, s54, s55
    s_lshl_b32 s30, s30, 20
    s_add_u32 s53, s53, s30
    s_add_u32 s53, s53, s50
    s_mov_b32 s20, s53
    s_add_u32 m0, s21, 65536
    s_nop 0
    buffer_load_dwordx4 v8, s[8:11], s20 offen lds
    s_add_u32 m0, s21, 66560
    s_nop 0
    buffer_load_dwordx4 v9, s[8:11], s20 offen lds
    s_add_u32 m0, s21, 67584
    s_nop 0
    buffer_load_dwordx4 v10, s[8:11], s20 offen lds
    s_add_u32 m0, s21, 68608
    s_nop 0
    buffer_load_dwordx4 v11, s[8:11], s20 offen lds
    s_add_u32 s20, s20, 65536
    s_add_u32 m0, s21, 81920
    s_nop 0
    buffer_load_dwordx4 v8, s[8:11], s20 offen lds
    s_add_u32 m0, s21, 82944
    s_nop 0
    buffer_load_dwordx4 v9, s[8:11], s20 offen lds
    s_add_u32 m0, s21, 83968
    s_nop 0
    buffer_load_dwordx4 v10, s[8:11], s20 offen lds
    s_add_u32 m0, s21, 84992
    s_nop 0
    buffer_load_dwordx4 v11, s[8:11], s20 offen lds
    s_add_u32 s20, s20, 65536
    s_add_u32 m0, s21, 98304
    s_nop 0
    buffer_load_dwordx4 v8, s[8:11], s20 offen lds
    s_waitcnt vmcnt(21)
    s_barrier
    ds_read_b128 v[20:23], v12 offset:0
    ds_read_b128 v[24:27], v13 offset:0
    ds_read_b128 v[28:31], v12 offset:2048
    ds_read_b128 v[32:35], v13 offset:2048
    ds_read_b128 v[36:39], v12 offset:4096
    ds_read_b128 v[40:43], v13 offset:4096
    s_waitcnt lgkmcnt(4)
L_st_273:
    v_mfma_f32_16x16x32_bf16 v[52:55], v[20:23], a[0:3], 0
    ds_read_b128 v[44:47], v12 offset:6144
    s_add_u32 m0, s21, 99328
    v_mfma_f32_16x16x32_bf16 v[56:59], v[20:23], a[4:7], 0
    buffer_load_dwordx4 v9, s[8:11], s20 offen lds
    v_mfma_f32_16x16x32_bf16 v[60:63], v[24:27], a[0:3], 0
    ds_read_b128 v[48:51], v13 offset:6144
    s_sub_u32 s38, s22, 1
    v_mfma_f32_16x16x32_bf16 v[64:67], v[24:27], a[4:7], 0
    s_waitcnt lgkmcnt(4)
    s_and_b32 s31, s38, 3
    v_mfma_f32_16x16x32_bf16 v[52:55], v[28:31], a[8:11], v[52:55]
    ds_read_b128 v[20:23], v12 offset:8192
    s_waitcnt vmcnt(13)
    v_mfma_f32_16x16x32_bf16 v[56:59], v[28:31], a[12:15], v[56:59]
    ds_write_b32 v3, v87
    s_lshl_b32 s31, s31, 11
    v_mfma_f32_16x16x32_bf16 v[60:63], v[32:35], a[8:11], v[60:63]
    ds_read_b128 v[24:27], v13 offset:8192
    s_bfe_u32 s38, s38, 0x10002
    v_mfma_f32_16x16x32_bf16 v[64:67], v[32:35], a[12:15], v[64:67]
    s_waitcnt lgkmcnt(4)
    s_xor_b32 s38, s38, 1
    v_mfma_f32_16x16x32_bf16 v[52:55], v[36:39], a[16:19], v[52:55]
    ds_read_b128 v[28:31], v12 offset:10240
    s_add_u32 m0, s21, 100352
    v_mfma_f32_16x16x32_bf16 v[56:59], v[36:39], a[20:23], v[56:59]
    buffer_load_dwordx4 v10, s[8:11], s20 offen lds
    v_mfma_f32_16x16x32_bf16 v[60:63], v[40:43], a[16:19], v[60:63]
    ds_read_b128 v[32:35], v13 offset:10240
    s_cmp_eq_u32 s37, 0
    s_cselect_b32 s31, 0x40000000, s31
    s_cselect_b32 s38, 0, s38
    v_mfma_f32_16x16x32_bf16 v[64:67], v[40:43], a[20:23], v[64:67]
    s_waitcnt lgkmcnt(4)
    v_mfma_f32_16x16x32_bf16 v[52:55], v[44:47], a[24:27], v[52:55]
    ds_read_b128 v[36:39], v12 offset:12288
    v_mfma_f32_16x16x32_bf16 v[56:59], v[44:47], a[28:31], v[56:59]
    v_cvt_pk_bf16_f32 v104, v69, v73
    v_cvt_pk_bf16_f32 v105, v77, v81
    v_mfma_f32_16x16x32_bf16 v[60:63], v[48:51], a[24:27], v[60:63]
    ds_read_b128 v[40:43], v13 offset:12288
    v_and_or_b32 v104, v104, -2, s38
    v_mfma_f32_16x16x32_bf16 v[64:67], v[48:51], a[28:31], v[64:67]
    s_waitcnt lgkmcnt(4)
    v_and_or_b32 v105, v105, -2, s38
    v_mfma_f32_16x16x32_bf16 v[52:55], v[20:23], a[32:35], v[52:55]
    ds_read_b128 v[44:47], v12 offset:14336
    s_add_u32 m0, s21, 101376
    v_mfma_f32_16x16x32_bf16 v[56:59], v[20:23], a[36:39], v[56:59]
    buffer_load_dwordx4 v11, s[8:11], s20 offen lds
    v_mfma_f32_16x16x32_bf16 v[60:63], v[24:27], a[32:35], v[60:63]
    ds_read_b128 v[48:51], v13 offset:14336
    s_add_u32 s29, s45, s31
    v_mfma_f32_16x16x32_bf16 v[64:67], v[24:27], a[36:39], v[64:67]
    s_waitcnt lgkmcnt(4)
    v_mfma_f32_16x16x32_bf16 v[52:55], v[28:31], a[40:43], v[52:55]
    s_waitcnt vmcnt(20)
    s_barrier
    ds_read_b128 v[20:23], v12 offset:16384
    v_mfma_f32_16x16x32_bf16 v[56:59], v[28:31], a[44:47], v[56:59]
    s_add_u32 s20, s20, 65536
    buffer_store_dwordx2 v[104:105], v112, s[12:15], s29 offen offset:0 sc1
    v_mfma_f32_16x16x32_bf16 v[60:63], v[32:35], a[40:43], v[60:63]
    ds_read_b128 v[24:27], v13 offset:16384
    ds_read_b32 v1, v2
    v_cvt_pk_bf16_f32 v106, v70, v74
    v_mfma_f32_16x16x32_bf16 v[64:67], v[32:35], a[44:47], v[64:67]
    s_waitcnt lgkmcnt(4)
    v_cvt_pk_bf16_f32 v107, v78, v82
    v_mfma_f32_16x16x32_bf16 v[52:55], v[36:39], a[48:51], v[52:55]
    ds_read_b128 v[28:31], v12 offset:18432
    s_add_u32 m0, s21, 114688
    v_mfma_f32_16x16x32_bf16 v[56:59], v[36:39], a[52:55], v[56:59]
    buffer_load_dwordx4 v8, s[8:11], s20 offen lds
    v_and_or_b32 v106, v106, -2, s38
    v_mfma_f32_16x16x32_bf16 v[60:63], v[40:43], a[48:51], v[60:63]
    ds_read_b128 v[32:35], v13 offset:18432
    v_mfma_f32_16x16x32_bf16 v[64:67], v[40:43], a[52:55], v[64:67]
    s_waitcnt lgkmcnt(4)
    v_and_or_b32 v107, v107, -2, s38
    v_mfma_f32_16x16x32_bf16 v[52:55], v[44:47], a[56:59], v[52:55]
    ds_read_b128 v[36:39], v12 offset:20480
    s_add_u32 s29, s46, s31
    v_mfma_f32_16x16x32_bf16 v[56:59], v[44:47], a[60:63], v[56:59]
    buffer_store_dwordx2 v[106:107], v112, s[12:15], s29 offen offset:512 sc1
    v_mfma_f32_16x16x32_bf16 v[60:63], v[48:51], a[56:59], v[60:63]
    ds_read_b128 v[40:43], v13 offset:20480
    v_cvt_pk_bf16_f32 v108, v71, v75
    v_mfma_f32_16x16x32_bf16 v[64:67], v[48:51], a[60:63], v[64:67]
    s_waitcnt lgkmcnt(4)
    v_cvt_pk_bf16_f32 v109, v79, v83
    v_mfma_f32_16x16x32_bf16 v[52:55], v[20:23], a[64:67], v[52:55]
    ds_read_b128 v[44:47], v12 offset:22528
    s_add_u32 m0, s21, 115712
    v_mfma_f32_16x16x32_bf16 v[56:59], v[20:23], a[68:71], v[56:59]
    buffer_load_dwordx4 v9, s[8:11], s20 offen lds
    v_mfma_f32_16x16x32_bf16 v[60:63], v[24:27], a[64:67], v[60:63]
    ds_read_b128 v[48:51], v13 offset:22528
    v_and_or_b32 v108, v108, -2, s38
    v_mfma_f32_16x16x32_bf16 v[64:67], v[24:27], a[68:71], v[64:67]
    s_waitcnt lgkmcnt(4)
    v_and_or_b32 v109, v109, -2, s38
    v_mfma_f32_16x16x32_bf16 v[52:55], v[28:31], a[72:75], v[52:55]
    ds_read_b128 v[20:23], v12 offset:24576
    s_add_u32 s29, s47, s31
    v_mfma_f32_16x16x32_bf16 v[56:59], v[28:31], a[76:79], v[56:59]
    buffer_store_dwordx2 v[108:109], v112, s[12:15], s29 offen offset:1024 sc1
    v_mfma_f32_16x16x32_bf16 v[60:63], v[32:35], a[72:75], v[60:63]
    ds_read_b128 v[24:27], v13 offset:24576
    v_readfirstlane_b32 s51, v1
    s_add_u32 s30, s22, 1
    v_mfma_f32_16x16x32_bf16 v[64:67], v[32:35], a[76:79], v[64:67]
    s_waitcnt lgkmcnt(4)
    s_cmp_eq_u32 s30, s24
    s_cselect_b32 s51, s51, 0
    v_mfma_f32_16x16x32_bf16 v[52:55], v[36:39], a[80:83], v[52:55]
    ds_read_b128 v[28:31], v12 offset:26624
    s_add_u32 m0, s21, 116736
    v_mfma_f32_16x16x32_bf16 v[56:59], v[36:39], a[84:87], v[56:59]
    buffer_load_dwordx4 v10, s[8:11], s20 offen lds
    s_cmp_ge_u32 s51, 8
    s_cselect_b32 s30, 1, 0
    v_mfma_f32_16x16x32_bf16 v[60:63], v[40:43], a[80:83], v[60:63]
    ds_read_b128 v[32:35], v13 offset:26624
    v_mfma_f32_16x16x32_bf16 v[64:67], v[40:43], a[84:87], v[64:67]
    s_waitcnt lgkmcnt(4)
    s_add_u32 s24, s24, s30
    s_add_u32 s23, s23, s30
    v_mfma_f32_16x16x32_bf16 v[52:55], v[44:47], a[88:91], v[52:55]
    ds_read_b128 v[36:39], v12 offset:28672
    s_mov_b32 s30, s24
    v_mfma_f32_16x16x32_bf16 v[56:59], v[44:47], a[92:95], v[56:59]
    s_mul_i32 s3, s30, 3
    s_add_u32 s3, s3, s95
    v_mfma_f32_16x16x32_bf16 v[60:63], v[48:51], a[88:91], v[60:63]
    ds_read_b128 v[40:43], v13 offset:28672
    s_lshl1_add_u32 s30, s30, s94
    s_max_i32 s30, s30, s3
    v_mfma_f32_16x16x32_bf16 v[64:67], v[48:51], a[92:95], v[64:67]
    s_waitcnt lgkmcnt(4)
    s_bitcmp1_b32 s30, 1
    s_cselect_b32 s53, s54, s55
    v_mfma_f32_16x16x32_bf16 v[52:55], v[20:23], a[96:99], v[52:55]
    ds_read_b128 v[44:47], v12 offset:30720
    s_add_u32 m0, s21, 117760
    v_mfma_f32_16x16x32_bf16 v[56:59], v[20:23], a[100:103], v[56:59]
    buffer_load_dwordx4 v11, s[8:11], s20 offen lds
    s_lshl_b32 s30, s30, 20
    v_mfma_f32_16x16x32_bf16 v[60:63], v[24:27], a[96:99], v[60:63]
    ds_read_b128 v[48:51], v13 offset:30720
    s_add_u32 s53, s53, s30
    v_mfma_f32_16x16x32_bf16 v[64:67], v[24:27], a[100:103], v[64:67]
    s_waitcnt lgkmcnt(4)
    s_add_u32 s53, s53, s50
    v_mfma_f32_16x16x32_bf16 v[52:55], v[28:31], a[104:107], v[52:55]
    s_waitcnt vmcnt(20)
    s_barrier
    ds_read_b128 v[20:23], v12 offset:32768
    v_mfma_f32_16x16x32_bf16 v[56:59], v[28:31], a[108:111], v[56:59]
    s_mov_b32 s20, s53
    s_add_u32 s30, s24, 1
    s_mul_i32 s3, s30, 3
    v_mfma_f32_16x16x32_bf16 v[60:63], v[32:35], a[104:107], v[60:63]
    ds_read_b128 v[24:27], v13 offset:32768
    s_add_u32 s3, s3, s95
    v_mfma_f32_16x16x32_bf16 v[64:67], v[32:35], a[108:111], v[64:67]
    s_waitcnt lgkmcnt(4)
    s_lshl1_add_u32 s30, s30, s94
    v_mfma_f32_16x16x32_bf16 v[52:55], v[36:39], a[112:115], v[52:55]
    ds_read_b128 v[28:31], v12 offset:34816
    s_add_u32 m0, s21, 0
    s_max_i32 s30, s30, s3
    v_mfma_f32_16x16x32_bf16 v[56:59], v[36:39], a[116:119], v[56:59]
    buffer_load_dwordx4 v8, s[8:11], s20 offen lds
    s_waitcnt vmcnt(11)
    v_mfma_f32_16x16x32_bf16 v[60:63], v[40:43], a[112:115], v[60:63]
    ds_read_b128 v[32:35], v13 offset:34816
    s_cmp_lt_u32 s30, 64
    s_cselect_b32 s30, s30, 0x200000
    v_mfma_f32_16x16x32_bf16 v[64:67], v[40:43], a[116:119], v[64:67]
    s_waitcnt lgkmcnt(4)
    s_lshl_b32 s30, s30, 9
    v_xor_b32 v124, s7, v88
    v_mfma_f32_16x16x32_bf16 v[52:55], v[44:47], a[120:123], v[52:55]
    ds_read_b128 v[36:39], v12 offset:36864
    s_add_u32 s30, s30, s48
    v_bitop3_b32 v124, v124, v89, s7 bitop3:0xf6
    v_mfma_f32_16x16x32_bf16 v[56:59], v[44:47], a[124:127], v[56:59]
    buffer_load_dword v87, v4, s[12:15], s30 offen sc1
    v_bitop3_b32 v124, v124, v90, s7 bitop3:0xf6
    v_mfma_f32_16x16x32_bf16 v[60:63], v[48:51], a[120:123], v[60:63]
    ds_read_b128 v[40:43], v13 offset:36864
    v_bitop3_b32 v124, v124, v91, s7 bitop3:0xf6
    v_mfma_f32_16x16x32_bf16 v[64:67], v[48:51], a[124:127], v[64:67]
    s_waitcnt lgkmcnt(4)
    v_bitop3_b32 v124, v124, v92, s7 bitop3:0xf6
    v_bitop3_b32 v124, v124, v93, s7 bitop3:0xf6
    v_mfma_f32_16x16x32_bf16 v[52:55], v[20:23], a[128:131], v[52:55]
    ds_read_b128 v[44:47], v12 offset:38912
    s_add_u32 m0, s21, 1024
    v_mfma_f32_16x16x32_bf16 v[56:59], v[20:23], a[132:135], v[56:59]
    buffer_load_dwordx4 v9, s[8:11], s20 offen lds
    v_and_b32 v124, 1, v124
    v_mfma_f32_16x16x32_bf16 v[60:63], v[24:27], a[128:131], v[60:63]
    ds_read_b128 v[48:51], v13 offset:38912
    v_cmp_ne_u32 vcc, 0, v124
    s_nop 0
    v_mfma_f32_16x16x32_bf16 v[64:67], v[24:27], a[132:135], v[64:67]
    s_waitcnt lgkmcnt(4)
    s_nop 0
    v_mfma_f32_16x16x32_bf16 v[52:55], v[28:31], a[136:139], v[52:55]
    ds_read_b128 v[20:23], v12 offset:40960
    s_nop 0
    s_cbranch_vccnz L_rbad_274
L_rok_275:
    v_mfma_f32_16x16x32_bf16 v[56:59], v[28:31], a[140:143], v[56:59]
    v_lshlrev_b32 v124, 16, v88
    v_mfma_f32_16x16x32_bf16 v[60:63], v[32:35], a[136:139], v[60:63]
    ds_read_b128 v[24:27], v13 offset:40960
    v_and_b32 v125, 0xffff0000, v88
    v_mfma_f32_16x16x32_bf16 v[64:67], v[32:35], a[140:143], v[64:67]
    s_waitcnt lgkmcnt(4)
    v_add_f32 v96, v116, v124
    v_add_f32 v97, v117, v125
    v_mfma_f32_16x16x32_bf16 v[52:55], v[36:39], a[144:147], v[52:55]
    ds_read_b128 v[28:31], v12 offset:43008
    s_add_u32 m0, s21, 2048
    v_lshlrev_b32 v124, 16, v89
    v_mfma_f32_16x16x32_bf16 v[56:59], v[36:39], a[148:151], v[56:59]
    buffer_load_dwordx4 v10, s[8:11], s20 offen lds
    v_mfma_f32_16x16x32_bf16 v[60:63], v[40:43], a[144:147], v[60:63]
    ds_read_b128 v[32:35], v13 offset:43008
    v_and_b32 v125, 0xffff0000, v89
    v_add_f32 v98, v118, v124
    v_mfma_f32_16x16x32_bf16 v[64:67], v[40:43], a[148:151], v[64:67]
    s_waitcnt lgkmcnt(4)
    v_add_f32 v99, v119, v125
    v_lshlrev_b32 v124, 16, v90
    v_mfma_f32_16x16x32_bf16 v[52:55], v[44:47], a[152:155], v[52:55]
    ds_read_b128 v[36:39], v12 offset:45056
    v_and_b32 v125, 0xffff0000, v90
    v_mfma_f32_16x16x32_bf16 v[56:59], v[44:47], a[156:159], v[56:59]
    v_add_f32 v96, v96, v124
    v_add_f32 v97, v97, v125
    v_mfma_f32_16x16x32_bf16 v[60:63], v[48:51], a[152:155], v[60:63]
    ds_read_b128 v[40:43], v13 offset:45056
    v_lshlrev_b32 v124, 16, v91
    v_and_b32 v125, 0xffff0000, v91
    v_mfma_f32_16x16x32_bf16 v[64:67], v[48:51], a[156:159], v[64:67]
    s_waitcnt lgkmcnt(4)
    v_add_f32 v98, v98, v124
    v_mfma_f32_16x16x32_bf16 v[52:55], v[20:23], a[160:163], v[52:55]
    ds_read_b128 v[44:47], v12 offset:47104
    s_add_u32 m0, s21, 3072
    v_add_f32 v99, v99, v125
    v_mfma_f32_16x16x32_bf16 v[56:59], v[20:23], a[164:167], v[56:59]
    buffer_load_dwordx4 v11, s[8:11], s20 offen lds
    v_lshlrev_b32 v124, 16, v92
    v_mfma_f32_16x16x32_bf16 v[60:63], v[24:27], a[160:163], v[60:63]
    ds_read_b128 v[48:51], v13 offset:47104
    v_and_b32 v125, 0xffff0000, v92
    v_mfma_f32_16x16x32_bf16 v[64:67], v[24:27], a[164:167], v[64:67]
    s_waitcnt lgkmcnt(4)
    v_add_f32 v96, v96, v124
    v_add_f32 v97, v97, v125
    v_mfma_f32_16x16x32_bf16 v[52:55], v[28:31], a[168:171], v[52:55]
    s_waitcnt vmcnt(20)
    s_barrier
    ds_read_b128 v[20:23], v12 offset:49152
    v_mfma_f32_16x16x32_bf16 v[56:59], v[28:31], a[172:175], v[56:59]
    s_add_u32 s20, s20, 65536
    v_lshlrev_b32 v124, 16, v93
    v_mfma_f32_16x16x32_bf16 v[60:63], v[32:35], a[168:171], v[60:63]
    ds_read_b128 v[24:27], v13 offset:49152
    v_and_b32 v125, 0xffff0000, v93
    v_add_f32 v98, v98, v124
    v_mfma_f32_16x16x32_bf16 v[64:67], v[32:35], a[172:175], v[64:67]
    s_waitcnt lgkmcnt(4)
    v_add_f32 v99, v99, v125
    v_mfma_f32_16x16x32_bf16 v[52:55], v[36:39], a[176:179], v[52:55]
    ds_read_b128 v[28:31], v12 offset:51200
    s_add_u32 m0, s21, 16384
    ds_write2_b32 v114, v96, v97 offset0:0 offset1:16
    v_mfma_f32_16x16x32_bf16 v[56:59], v[36:39], a[180:183], v[56:59]
    buffer_load_dwordx4 v8, s[8:11], s20 offen lds
    ds_write2_b32 v114, v98, v99 offset0:128 offset1:144
    v_mfma_f32_16x16x32_bf16 v[60:63], v[40:43], a[176:179], v[60:63]
    ds_read_b128 v[32:35], v13 offset:51200
    ds_read_b128 v[88:91], v113 offset:0
    v_mfma_f32_16x16x32_bf16 v[64:67], v[40:43], a[180:183], v[64:67]
    s_waitcnt lgkmcnt(4)
    v_mfma_f32_16x16x32_bf16 v[52:55], v[44:47], a[184:187], v[52:55]
    ds_read_b128 v[36:39], v12 offset:53248
    v_mfma_f32_16x16x32_bf16 v[56:59], v[44:47], a[188:191], v[56:59]
    v_mfma_f32_16x16x32_bf16 v[60:63], v[48:51], a[184:187], v[60:63]
    ds_read_b128 v[40:43], v13 offset:53248
    s_waitcnt lgkmcnt(2)
    v_mfma_f32_16x16x32_bf16 v[64:67], v[48:51], a[188:191], v[64:67]
    s_waitcnt lgkmcnt(4)
    v_cvt_pk_bf16_f32 v96, 0, v88
    v_mfma_f32_16x16x32_bf16 v[52:55], v[20:23], a[192:195], v[52:55]
    ds_read_b128 v[44:47], v12 offset:55296
    s_add_u32 m0, s21, 17408
    v_mfma_f32_16x16x32_bf16 v[56:59], v[20:23], a[196:199], v[56:59]
    buffer_load_dwordx4 v9, s[8:11], s20 offen lds
    v_mfma_f32_16x16x32_bf16 v[60:63], v[24:27], a[192:195], v[60:63]
    ds_read_b128 v[48:51], v13 offset:55296
    v_cvt_pk_bf16_f32 v97, 0, v89
    v_mfma_f32_16x16x32_bf16 v[64:67], v[24:27], a[196:199], v[64:67]
    s_waitcnt lgkmcnt(4)
    v_cvt_pk_bf16_f32 v98, 0, v90
    v_mfma_f32_16x16x32_bf16 v[52:55], v[28:31], a[200:203], v[52:55]
    ds_read_b128 v[20:23], v12 offset:57344
    v_cvt_pk_bf16_f32 v99, 0, v91
    v_mfma_f32_16x16x32_bf16 v[56:59], v[28:31], a[204:207], v[56:59]
    buffer_store_dwordx4 v[96:99], v128, s[16:19], s43 offen
    v_mfma_f32_16x16x32_bf16 v[60:63], v[32:35], a[200:203], v[60:63]
    ds_read_b128 v[24:27], v13 offset:57344
    v_mfma_f32_16x16x32_bf16 v[64:67], v[32:35], a[204:207], v[64:67]
    s_waitcnt lgkmcnt(4)
    v_mfma_f32_16x16x32_bf16 v[52:55], v[36:39], a[208:211], v[52:55]
    ds_read_b128 v[28:31], v12 offset:59392
    s_add_u32 m0, s21, 18432
    v_mov_b32 v116, v68
    v_mov_b32 v117, v72
    v_mfma_f32_16x16x32_bf16 v[56:59], v[36:39], a[212:215], v[56:59]
    buffer_load_dwordx4 v10, s[8:11], s20 offen lds
    v_mov_b32 v118, v76
    v_mov_b32 v119, v80
    v_mfma_f32_16x16x32_bf16 v[60:63], v[40:43], a[208:211], v[60:63]
    ds_read_b128 v[32:35], v13 offset:59392
    s_mov_b32 s7, s38
    s_add_u32 s39, s44, s31
    s_sub_u32 s43, s22, 1
    v_mfma_f32_16x16x32_bf16 v[64:67], v[40:43], a[212:215], v[64:67]
    s_waitcnt lgkmcnt(4)
    s_mul_i32 s3, s43, 3
    s_add_u32 s3, s3, s95
    s_lshl1_add_u32 s43, s43, s94
    v_mfma_f32_16x16x32_bf16 v[52:55], v[44:47], a[216:219], v[52:55]
    ds_read_b128 v[36:39], v12 offset:61440
    s_max_i32 s43, s43, s3
    s_lshl_b32 s43, s43, 18
    s_cmp_eq_u32 s37, 0
    s_cselect_b32 s43, 0x7ff00000, s43
    v_mfma_f32_16x16x32_bf16 v[56:59], v[44:47], a[220:223], v[56:59]
    buffer_load_dwordx2 v[88:89], v112, s[12:15], s39 offen offset:0 sc1
    v_mfma_f32_16x16x32_bf16 v[60:63], v[48:51], a[216:219], v[60:63]
    ds_read_b128 v[40:43], v13 offset:61440
    v_mfma_f32_16x16x32_bf16 v[64:67], v[48:51], a[220:223], v[64:67]
    s_waitcnt lgkmcnt(4)
    v_mfma_f32_16x16x32_bf16 v[52:55], v[20:23], a[224:227], v[52:55]
    ds_read_b128 v[44:47], v12 offset:63488
    s_add_u32 m0, s21, 19456
    v_mfma_f32_16x16x32_bf16 v[56:59], v[20:23], a[228:231], v[56:59]
    buffer_load_dwordx4 v11, s[8:11], s20 offen lds
    v_mfma_f32_16x16x32_bf16 v[60:63], v[24:27], a[224:227], v[60:63]
    ds_read_b128 v[48:51], v13 offset:63488
    v_mfma_f32_16x16x32_bf16 v[64:67], v[24:27], a[228:231], v[64:67]
    s_waitcnt lgkmcnt(4)
    v_mfma_f32_16x16x32_bf16 v[52:55], v[28:31], a[232:235], v[52:55]
    s_waitcnt vmcnt(20)
    s_barrier
    ds_read_b128 v[20:23], v16 offset:0
    v_mfma_f32_16x16x32_bf16 v[56:59], v[28:31], a[236:239], v[56:59]
    s_add_u32 s20, s20, 65536
    buffer_load_dwordx2 v[90:91], v112, s[12:15], s39 offen offset:512 sc1
    v_mfma_f32_16x16x32_bf16 v[60:63], v[32:35], a[232:235], v[60:63]
    ds_read_b128 v[24:27], v17 offset:0
    v_mfma_f32_16x16x32_bf16 v[64:67], v[32:35], a[236:239], v[64:67]
    s_waitcnt lgkmcnt(4)
    v_mfma_f32_16x16x32_bf16 v[52:55], v[36:39], a[240:243], v[52:55]
    ds_read_b128 v[28:31], v16 offset:2048
    s_add_u32 m0, s21, 32768
    v_mfma_f32_16x16x32_bf16 v[56:59], v[36:39], a[244:247], v[56:59]
    buffer_load_dwordx4 v8, s[8:11], s20 offen lds
    v_mfma_f32_16x16x32_bf16 v[60:63], v[40:43], a[240:243], v[60:63]
    ds_read_b128 v[32:35], v17 offset:2048
    v_mfma_f32_16x16x32_bf16 v[64:67], v[40:43], a[244:247], v[64:67]
    s_waitcnt lgkmcnt(4)
    v_mfma_f32_16x16x32_bf16 v[52:55], v[44:47], a[248:251], v[52:55]
    ds_read_b128 v[36:39], v16 offset:4096
    v_mfma_f32_16x16x32_bf16 v[56:59], v[44:47], a[252:255], v[56:59]
    buffer_load_dwordx2 v[92:93], v112, s[12:15], s39 offen offset:1024 sc1
    v_mfma_f32_16x16x32_bf16 v[60:63], v[48:51], a[248:251], v[60:63]
    ds_read_b128 v[40:43], v17 offset:4096
    s_mov_b32 s37, 1
    v_mfma_f32_16x16x32_bf16 v[64:67], v[48:51], a[252:255], v[64:67]
    s_waitcnt lgkmcnt(4)
    s_add_u32 s22, s22, 1
    s_cmp_ge_u32 s22, s23
    s_cbranch_scc1 L_fl0_270
    v_mfma_f32_16x16x32_bf16 v[68:71], v[20:23], a[0:3], 0
    ds_read_b128 v[44:47], v16 offset:6144
    s_add_u32 m0, s21, 33792
    v_mfma_f32_16x16x32_bf16 v[72:75], v[20:23], a[4:7], 0
    buffer_load_dwordx4 v9, s[8:11], s20 offen lds
    v_mfma_f32_16x16x32_bf16 v[76:79], v[24:27], a[0:3], 0
    ds_read_b128 v[48:51], v17 offset:6144
    s_sub_u32 s38, s22, 1
    v_mfma_f32_16x16x32_bf16 v[80:83], v[24:27], a[4:7], 0
    s_waitcnt lgkmcnt(4)
    s_and_b32 s31, s38, 3
    v_mfma_f32_16x16x32_bf16 v[68:71], v[28:31], a[8:11], v[68:71]
    ds_read_b128 v[20:23], v16 offset:8192
    s_waitcnt vmcnt(13)
    v_mfma_f32_16x16x32_bf16 v[72:75], v[28:31], a[12:15], v[72:75]
    ds_write_b32 v3, v87
    s_lshl_b32 s31, s31, 11
    v_mfma_f32_16x16x32_bf16 v[76:79], v[32:35], a[8:11], v[76:79]
    ds_read_b128 v[24:27], v17 offset:8192
    s_bfe_u32 s38, s38, 0x10002
    v_mfma_f32_16x16x32_bf16 v[80:83], v[32:35], a[12:15], v[80:83]
    s_waitcnt lgkmcnt(4)
    s_xor_b32 s38, s38, 1
    v_mfma_f32_16x16x32_bf16 v[68:71], v[36:39], a[16:19], v[68:71]
    ds_read_b128 v[28:31], v16 offset:10240
    s_add_u32 m0, s21, 34816
    v_mfma_f32_16x16x32_bf16 v[72:75], v[36:39], a[20:23], v[72:75]
    buffer_load_dwordx4 v10, s[8:11], s20 offen lds
    v_mfma_f32_16x16x32_bf16 v[76:79], v[40:43], a[16:19], v[76:79]
    ds_read_b128 v[32:35], v17 offset:10240
    s_cmp_eq_u32 s37, 0
    s_cselect_b32 s31, 0x40000000, s31
    s_cselect_b32 s38, 0, s38
    v_mfma_f32_16x16x32_bf16 v[80:83], v[40:43], a[20:23], v[80:83]
    s_waitcnt lgkmcnt(4)
    v_mfma_f32_16x16x32_bf16 v[68:71], v[44:47], a[24:27], v[68:71]
    ds_read_b128 v[36:39], v16 offset:12288
    v_mfma_f32_16x16x32_bf16 v[72:75], v[44:47], a[28:31], v[72:75]
    v_cvt_pk_bf16_f32 v104, v53, v57
    v_cvt_pk_bf16_f32 v105, v61, v65
    v_mfma_f32_16x16x32_bf16 v[76:79], v[48:51], a[24:27], v[76:79]
    ds_read_b128 v[40:43], v17 offset:12288
    v_and_or_b32 v104, v104, -2, s38
    v_mfma_f32_16x16x32_bf16 v[80:83], v[48:51], a[28:31], v[80:83]
    s_waitcnt lgkmcnt(4)
    v_and_or_b32 v105, v105, -2, s38
    v_mfma_f32_16x16x32_bf16 v[68:71], v[20:23], a[32:35], v[68:71]
    ds_read_b128 v[44:47], v16 offset:14336
    s_add_u32 m0, s21, 35840
    v_mfma_f32_16x16x32_bf16 v[72:75], v[20:23], a[36:39], v[72:75]
    buffer_load_dwordx4 v11, s[8:11], s20 offen lds
    v_mfma_f32_16x16x32_bf16 v[76:79], v[24:27], a[32:35], v[76:79]
    ds_read_b128 v[48:51], v17 offset:14336
    s_add_u32 s29, s45, s31
    v_mfma_f32_16x16x32_bf16 v[80:83], v[24:27], a[36:39], v[80:83]
    s_waitcnt lgkmcnt(4)
    v_mfma_f32_16x16x32_bf16 v[68:71], v[28:31], a[40:43], v[68:71]
    s_waitcnt vmcnt(20)
    s_barrier
    ds_read_b128 v[20:23], v16 offset:16384
    v_mfma_f32_16x16x32_bf16 v[72:75], v[28:31], a[44:47], v[72:75]
    s_add_u32 s20, s20, 65536
    buffer_store_dwordx2 v[104:105], v112, s[12:15], s29 offen offset:0 sc1
    v_mfma_f32_16x16x32_bf16 v[76:79], v[32:35], a[40:43], v[76:79]
    ds_read_b128 v[24:27], v17 offset:16384
    ds_read_b32 v1, v2
    v_cvt_pk_bf16_f32 v106, v54, v58
    v_mfma_f32_16x16x32_bf16 v[80:83], v[32:35], a[44:47], v[80:83]
    s_waitcnt lgkmcnt(4)
    v_cvt_pk_bf16_f32 v107, v62, v66
    v_mfma_f32_16x16x32_bf16 v[68:71], v[36:39], a[48:51], v[68:71]
    ds_read_b128 v[28:31], v16 offset:18432
    s_add_u32 m0, s21, 49152
    v_mfma_f32_16x16x32_bf16 v[72:75], v[36:39], a[52:55], v[72:75]
    buffer_load_dwordx4 v8, s[8:11], s20 offen lds
    v_and_or_b32 v106, v106, -2, s38
    v_mfma_f32_16x16x32_bf16 v[76:79], v[40:43], a[48:51], v[76:79]
    ds_read_b128 v[32:35], v17 offset:18432
    v_mfma_f32_16x16x32_bf16 v[80:83], v[40:43], a[52:55], v[80:83]
    s_waitcnt lgkmcnt(4)
    v_and_or_b32 v107, v107, -2, s38
    v_mfma_f32_16x16x32_bf16 v[68:71], v[44:47], a[56:59], v[68:71]
    ds_read_b128 v[36:39], v16 offset:20480
    s_add_u32 s29, s46, s31
    v_mfma_f32_16x16x32_bf16 v[72:75], v[44:47], a[60:63], v[72:75]
    buffer_store_dwordx2 v[106:107], v112, s[12:15], s29 offen offset:512 sc1
    v_mfma_f32_16x16x32_bf16 v[76:79], v[48:51], a[56:59], v[76:79]
    ds_read_b128 v[40:43], v17 offset:20480
    v_cvt_pk_bf16_f32 v108, v55, v59
    v_mfma_f32_16x16x32_bf16 v[80:83], v[48:51], a[60:63], v[80:83]
    s_waitcnt lgkmcnt(4)
    v_cvt_pk_bf16_f32 v109, v63, v67
    v_mfma_f32_16x16x32_bf16 v[68:71], v[20:23], a[64:67], v[68:71]
    ds_read_b128 v[44:47], v16 offset:22528
    s_add_u32 m0, s21, 50176
    v_mfma_f32_16x16x32_bf16 v[72:75], v[20:23], a[68:71], v[72:75]
    buffer_load_dwordx4 v9, s[8:11], s20 offen lds
    v_mfma_f32_16x16x32_bf16 v[76:79], v[24:27], a[64:67], v[76:79]
    ds_read_b128 v[48:51], v17 offset:22528
    v_and_or_b32 v108, v108, -2, s38
    v_mfma_f32_16x16x32_bf16 v[80:83], v[24:27], a[68:71], v[80:83]
    s_waitcnt lgkmcnt(4)
    v_and_or_b32 v109, v109, -2, s38
    v_mfma_f32_16x16x32_bf16 v[68:71], v[28:31], a[72:75], v[68:71]
    ds_read_b128 v[20:23], v16 offset:24576
    s_add_u32 s29, s47, s31
    v_mfma_f32_16x16x32_bf16 v[72:75], v[28:31], a[76:79], v[72:75]
    buffer_store_dwordx2 v[108:109], v112, s[12:15], s29 offen offset:1024 sc1
    v_mfma_f32_16x16x32_bf16 v[76:79], v[32:35], a[72:75], v[76:79]
    ds_read_b128 v[24:27], v17 offset:24576
    v_readfirstlane_b32 s51, v1
    s_add_u32 s30, s22, 1
    v_mfma_f32_16x16x32_bf16 v[80:83], v[32:35], a[76:79], v[80:83]
    s_waitcnt lgkmcnt(4)
    s_cmp_eq_u32 s30, s24
    s_cselect_b32 s51, s51, 0
    v_mfma_f32_16x16x32_bf16 v[68:71], v[36:39], a[80:83], v[68:71]
    ds_read_b128 v[28:31], v16 offset:26624
    s_add_u32 m0, s21, 51200
    v_mfma_f32_16x16x32_bf16 v[72:75], v[36:39], a[84:87], v[72:75]
    buffer_load_dwordx4 v10, s[8:11], s20 offen lds
    s_cmp_ge_u32 s51, 8
    s_cselect_b32 s30, 1, 0
    v_mfma_f32_16x16x32_bf16 v[76:79], v[40:43], a[80:83], v[76:79]
    ds_read_b128 v[32:35], v17 offset:26624
    v_mfma_f32_16x16x32_bf16 v[80:83], v[40:43], a[84:87], v[80:83]
    s_waitcnt lgkmcnt(4)
    s_add_u32 s24, s24, s30
    s_add_u32 s23, s23, s30
    v_mfma_f32_16x16x32_bf16 v[68:71], v[44:47], a[88:91], v[68:71]
    ds_read_b128 v[36:39], v16 offset:28672
    s_mov_b32 s30, s24
    v_mfma_f32_16x16x32_bf16 v[72:75], v[44:47], a[92:95], v[72:75]
    s_mul_i32 s3, s30, 3
    s_add_u32 s3, s3, s95
    v_mfma_f32_16x16x32_bf16 v[76:79], v[48:51], a[88:91], v[76:79]
    ds_read_b128 v[40:43], v17 offset:28672
    s_lshl1_add_u32 s30, s30, s94
    s_max_i32 s30, s30, s3
    v_mfma_f32_16x16x32_bf16 v[80:83], v[48:51], a[92:95], v[80:83]
    s_waitcnt lgkmcnt(4)
    s_bitcmp1_b32 s30, 1
    s_cselect_b32 s53, s54, s55
    v_mfma_f32_16x16x32_bf16 v[68:71], v[20:23], a[96:99], v[68:71]
    ds_read_b128 v[44:47], v16 offset:30720
    s_add_u32 m0, s21, 52224
    v_mfma_f32_16x16x32_bf16 v[72:75], v[20:23], a[100:103], v[72:75]
    buffer_load_dwordx4 v11, s[8:11], s20 offen lds
    s_lshl_b32 s30, s30, 20
    v_mfma_f32_16x16x32_bf16 v[76:79], v[24:27], a[96:99], v[76:79]
    ds_read_b128 v[48:51], v17 offset:30720
    s_add_u32 s53, s53, s30
    v_mfma_f32_16x16x32_bf16 v[80:83], v[24:27], a[100:103], v[80:83]
    s_waitcnt lgkmcnt(4)
    s_add_u32 s53, s53, s50
    v_mfma_f32_16x16x32_bf16 v[68:71], v[28:31], a[104:107], v[68:71]
    s_waitcnt vmcnt(20)
    s_barrier
    ds_read_b128 v[20:23], v16 offset:32768
    v_mfma_f32_16x16x32_bf16 v[72:75], v[28:31], a[108:111], v[72:75]
    s_mov_b32 s20, s53
    s_add_u32 s30, s24, 1
    s_mul_i32 s3, s30, 3
    v_mfma_f32_16x16x32_bf16 v[76:79], v[32:35], a[104:107], v[76:79]
    ds_read_b128 v[24:27], v17 offset:32768
    s_add_u32 s3, s3, s95
    v_mfma_f32_16x16x32_bf16 v[80:83], v[32:35], a[108:111], v[80:83]
    s_waitcnt lgkmcnt(4)
    s_lshl1_add_u32 s30, s30, s94
    v_mfma_f32_16x16x32_bf16 v[68:71], v[36:39], a[112:115], v[68:71]
    ds_read_b128 v[28:31], v16 offset:34816
    s_add_u32 m0, s21, 65536
    s_max_i32 s30, s30, s3
    v_mfma_f32_16x16x32_bf16 v[72:75], v[36:39], a[116:119], v[72:75]
    buffer_load_dwordx4 v8, s[8:11], s20 offen lds
    s_waitcnt vmcnt(11)
    v_mfma_f32_16x16x32_bf16 v[76:79], v[40:43], a[112:115], v[76:79]
    ds_read_b128 v[32:35], v17 offset:34816
    s_cmp_lt_u32 s30, 64
    s_cselect_b32 s30, s30, 0x200000
    v_mfma_f32_16x16x32_bf16 v[80:83], v[40:43], a[116:119], v[80:83]
    s_waitcnt lgkmcnt(4)
    s_lshl_b32 s30, s30, 9
    v_xor_b32 v124, s7, v88
    v_mfma_f32_16x16x32_bf16 v[68:71], v[44:47], a[120:123], v[68:71]
    ds_read_b128 v[36:39], v16 offset:36864
    s_add_u32 s30, s30, s48
    v_bitop3_b32 v124, v124, v89, s7 bitop3:0xf6
    v_mfma_f32_16x16x32_bf16 v[72:75], v[44:47], a[124:127], v[72:75]
    buffer_load_dword v87, v4, s[12:15], s30 offen sc1
    v_bitop3_b32 v124, v124, v90, s7 bitop3:0xf6
    v_mfma_f32_16x16x32_bf16 v[76:79], v[48:51], a[120:123], v[76:79]
    ds_read_b128 v[40:43], v17 offset:36864
    v_bitop3_b32 v124, v124, v91, s7 bitop3:0xf6
    v_mfma_f32_16x16x32_bf16 v[80:83], v[48:51], a[124:127], v[80:83]
    s_waitcnt lgkmcnt(4)
    v_bitop3_b32 v124, v124, v92, s7 bitop3:0xf6
    v_bitop3_b32 v124, v124, v93, s7 bitop3:0xf6
    v_mfma_f32_16x16x32_bf16 v[68:71], v[20:23], a[128:131], v[68:71]
    ds_read_b128 v[44:47], v16 offset:38912
    s_add_u32 m0, s21, 66560
    v_mfma_f32_16x16x32_bf16 v[72:75], v[20:23], a[132:135], v[72:75]
    buffer_load_dwordx4 v9, s[8:11], s20 offen lds
    v_and_b32 v124, 1, v124
    v_mfma_f32_16x16x32_bf16 v[76:79], v[24:27], a[128:131], v[76:79]
    ds_read_b128 v[48:51], v17 offset:38912
    v_cmp_ne_u32 vcc, 0, v124
    s_nop 0
    v_mfma_f32_16x16x32_bf16 v[80:83], v[24:27], a[132:135], v[80:83]
    s_waitcnt lgkmcnt(4)
    s_nop 0
    v_mfma_f32_16x16x32_bf16 v[68:71], v[28:31], a[136:139], v[68:71]
    ds_read_b128 v[20:23], v16 offset:40960
    s_nop 0
    s_cbranch_vccnz L_rbad_276
L_rok_277:
    v_mfma_f32_16x16x32_bf16 v[72:75], v[28:31], a[140:143], v[72:75]
    v_lshlrev_b32 v124, 16, v88
    v_mfma_f32_16x16x32_bf16 v[76:79], v[32:35], a[136:139], v[76:79]
    ds_read_b128 v[24:27], v17 offset:40960
    v_and_b32 v125, 0xffff0000, v88
    v_mfma_f32_16x16x32_bf16 v[80:83], v[32:35], a[140:143], v[80:83]
    s_waitcnt lgkmcnt(4)
    v_add_f32 v96, v116, v124
    v_add_f32 v97, v117, v125
    v_mfma_f32_16x16x32_bf16 v[68:71], v[36:39], a[144:147], v[68:71]
    ds_read_b128 v[28:31], v16 offset:43008
    s_add_u32 m0, s21, 67584
    v_lshlrev_b32 v124, 16, v89
    v_mfma_f32_16x16x32_bf16 v[72:75], v[36:39], a[148:151], v[72:75]
    buffer_load_dwordx4 v10, s[8:11], s20 offen lds
    v_mfma_f32_16x16x32_bf16 v[76:79], v[40:43], a[144:147], v[76:79]
    ds_read_b128 v[32:35], v17 offset:43008
    v_and_b32 v125, 0xffff0000, v89
    v_add_f32 v98, v118, v124
    v_mfma_f32_16x16x32_bf16 v[80:83], v[40:43], a[148:151], v[80:83]
    s_waitcnt lgkmcnt(4)
    v_add_f32 v99, v119, v125
    v_lshlrev_b32 v124, 16, v90
    v_mfma_f32_16x16x32_bf16 v[68:71], v[44:47], a[152:155], v[68:71]
    ds_read_b128 v[36:39], v16 offset:45056
    v_and_b32 v125, 0xffff0000, v90
    v_mfma_f32_16x16x32_bf16 v[72:75], v[44:47], a[156:159], v[72:75]
    v_add_f32 v96, v96, v124
    v_add_f32 v97, v97, v125
    v_mfma_f32_16x16x32_bf16 v[76:79], v[48:51], a[152:155], v[76:79]
    ds_read_b128 v[40:43], v17 offset:45056
    v_lshlrev_b32 v124, 16, v91
    v_and_b32 v125, 0xffff0000, v91
    v_mfma_f32_16x16x32_bf16 v[80:83], v[48:51], a[156:159], v[80:83]
    s_waitcnt lgkmcnt(4)
    v_add_f32 v98, v98, v124
    v_mfma_f32_16x16x32_bf16 v[68:71], v[20:23], a[160:163], v[68:71]
    ds_read_b128 v[44:47], v16 offset:47104
    s_add_u32 m0, s21, 68608
    v_add_f32 v99, v99, v125
    v_mfma_f32_16x16x32_bf16 v[72:75], v[20:23], a[164:167], v[72:75]
    buffer_load_dwordx4 v11, s[8:11], s20 offen lds
    v_lshlrev_b32 v124, 16, v92
    v_mfma_f32_16x16x32_bf16 v[76:79], v[24:27], a[160:163], v[76:79]
    ds_read_b128 v[48:51], v17 offset:47104
    v_and_b32 v125, 0xffff0000, v92
    v_mfma_f32_16x16x32_bf16 v[80:83], v[24:27], a[164:167], v[80:83]
    s_waitcnt lgkmcnt(4)
    v_add_f32 v96, v96, v124
    v_add_f32 v97, v97, v125
    v_mfma_f32_16x16x32_bf16 v[68:71], v[28:31], a[168:171], v[68:71]
    s_waitcnt vmcnt(20)
    s_barrier
    ds_read_b128 v[20:23], v16 offset:49152
    v_mfma_f32_16x16x32_bf16 v[72:75], v[28:31], a[172:175], v[72:75]
    s_add_u32 s20, s20, 65536
    v_lshlrev_b32 v124, 16, v93
    v_mfma_f32_16x16x32_bf16 v[76:79], v[32:35], a[168:171], v[76:79]
    ds_read_b128 v[24:27], v17 offset:49152
    v_and_b32 v125, 0xffff0000, v93
    v_add_f32 v98, v98, v124
    v_mfma_f32_16x16x32_bf16 v[80:83], v[32:35], a[172:175], v[80:83]
    s_waitcnt lgkmcnt(4)
    v_add_f32 v99, v99, v125
    v_mfma_f32_16x16x32_bf16 v[68:71], v[36:39], a[176:179], v[68:71]
    ds_read_b128 v[28:31], v16 offset:51200
    s_add_u32 m0, s21, 81920
    ds_write2_b32 v114, v96, v97 offset0:0 offset1:16
    v_mfma_f32_16x16x32_bf16 v[72:75], v[36:39], a[180:183], v[72:75]
    buffer_load_dwordx4 v8, s[8:11], s20 offen lds
    ds_write2_b32 v114, v98, v99 offset0:128 offset1:144
    v_mfma_f32_16x16x32_bf16 v[76:79], v[40:43], a[176:179], v[76:79]
    ds_read_b128 v[32:35], v17 offset:51200
    ds_read_b128 v[88:91], v113 offset:0
    v_mfma_f32_16x16x32_bf16 v[80:83], v[40:43], a[180:183], v[80:83]
    s_waitcnt lgkmcnt(4)
    v_mfma_f32_16x16x32_bf16 v[68:71], v[44:47], a[184:187], v[68:71]
    ds_read_b128 v[36:39], v16 offset:53248
    v_mfma_f32_16x16x32_bf16 v[72:75], v[44:47], a[188:191], v[72:75]
    v_mfma_f32_16x16x32_bf16 v[76:79], v[48:51], a[184:187], v[76:79]
    ds_read_b128 v[40:43], v17 offset:53248
    s_waitcnt lgkmcnt(2)
    v_mfma_f32_16x16x32_bf16 v[80:83], v[48:51], a[188:191], v[80:83]
    s_waitcnt lgkmcnt(4)
    v_cvt_pk_bf16_f32 v96, 0, v88
    v_mfma_f32_16x16x32_bf16 v[68:71], v[20:23], a[192:195], v[68:71]
    ds_read_b128 v[44:47], v16 offset:55296
    s_add_u32 m0, s21, 82944
    v_mfma_f32_16x16x32_bf16 v[72:75], v[20:23], a[196:199], v[72:75]
    buffer_load_dwordx4 v9, s[8:11], s20 offen lds
    v_mfma_f32_16x16x32_bf16 v[76:79], v[24:27], a[192:195], v[76:79]
    ds_read_b128 v[48:51], v17 offset:55296
    v_cvt_pk_bf16_f32 v97, 0, v89
    v_mfma_f32_16x16x32_bf16 v[80:83], v[24:27], a[196:199], v[80:83]
    s_waitcnt lgkmcnt(4)
    v_cvt_pk_bf16_f32 v98, 0, v90
    v_mfma_f32_16x16x32_bf16 v[68:71], v[28:31], a[200:203], v[68:71]
    ds_read_b128 v[20:23], v16 offset:57344
    v_cvt_pk_bf16_f32 v99, 0, v91
    v_mfma_f32_16x16x32_bf16 v[72:75], v[28:31], a[204:207], v[72:75]
    buffer_store_dwordx4 v[96:99], v128, s[16:19], s43 offen
    v_mfma_f32_16x16x32_bf16 v[76:79], v[32:35], a[200:203], v[76:79]
    ds_read_b128 v[24:27], v17 offset:57344
    v_mfma_f32_16x16x32_bf16 v[80:83], v[32:35], a[204:207], v[80:83]
    s_waitcnt lgkmcnt(4)
    v_mfma_f32_16x16x32_bf16 v[68:71], v[36:39], a[208:211], v[68:71]
    ds_read_b128 v[28:31], v16 offset:59392
    s_add_u32 m0, s21, 83968
    v_mov_b32 v116, v52
    v_mov_b32 v117, v56
    v_mfma_f32_16x16x32_bf16 v[72:75], v[36:39], a[212:215], v[72:75]
    buffer_load_dwordx4 v10, s[8:11], s20 offen lds
    v_mov_b32 v118, v60
    v_mov_b32 v119, v64
    v_mfma_f32_16x16x32_bf16 v[76:79], v[40:43], a[208:211], v[76:79]
    ds_read_b128 v[32:35], v17 offset:59392
    s_mov_b32 s7, s38
    s_add_u32 s39, s44, s31
    s_sub_u32 s43, s22, 1
    v_mfma_f32_16x16x32_bf16 v[80:83], v[40:43], a[212:215], v[80:83]
    s_waitcnt lgkmcnt(4)
    s_mul_i32 s3, s43, 3
    s_add_u32 s3, s3, s95
    s_lshl1_add_u32 s43, s43, s94
    v_mfma_f32_16x16x32_bf16 v[68:71], v[44:47], a[216:219], v[68:71]
    ds_read_b128 v[36:39], v16 offset:61440
    s_max_i32 s43, s43, s3
    s_lshl_b32 s43, s43, 18
    s_cmp_eq_u32 s37, 0
    s_cselect_b32 s43, 0x7ff00000, s43
    v_mfma_f32_16x16x32_bf16 v[72:75], v[44:47], a[220:223], v[72:75]
    buffer_load_dwordx2 v[88:89], v112, s[12:15], s39 offen offset:0 sc1
    v_mfma_f32_16x16x32_bf16 v[76:79], v[48:51], a[216:219], v[76:79]
    ds_read_b128 v[40:43], v17 offset:61440
    v_mfma_f32_16x16x32_bf16 v[80:83], v[48:51], a[220:223], v[80:83]
    s_waitcnt lgkmcnt(4)
    v_mfma_f32_16x16x32_bf16 v[68:71], v[20:23], a[224:227], v[68:71]
    ds_read_b128 v[44:47], v16 offset:63488
    s_add_u32 m0, s21, 84992
    v_mfma_f32_16x16x32_bf16 v[72:75], v[20:23], a[228:231], v[72:75]
    buffer_load_dwordx4 v11, s[8:11], s20 offen lds
    v_mfma_f32_16x16x32_bf16 v[76:79], v[24:27], a[224:227], v[76:79]
    ds_read_b128 v[48:51], v17 offset:63488
    v_mfma_f32_16x16x32_bf16 v[80:83], v[24:27], a[228:231], v[80:83]
    s_waitcnt lgkmcnt(4)
    v_mfma_f32_16x16x32_bf16 v[68:71], v[28:31], a[232:235], v[68:71]
    s_waitcnt vmcnt(20)
    s_barrier
    ds_read_b128 v[20:23], v12 offset:0
    v_mfma_f32_16x16x32_bf16 v[72:75], v[28:31], a[236:239], v[72:75]
    s_add_u32 s20, s20, 65536
    buffer_load_dwordx2 v[90:91], v112, s[12:15], s39 offen offset:512 sc1
    v_mfma_f32_16x16x32_bf16 v[76:79], v[32:35], a[232:235], v[76:79]
    ds_read_b128 v[24:27], v13 offset:0
    v_mfma_f32_16x16x32_bf16 v[80:83], v[32:35], a[236:239], v[80:83]
    s_waitcnt lgkmcnt(4)
    v_mfma_f32_16x16x32_bf16 v[68:71], v[36:39], a[240:243], v[68:71]
    ds_read_b128 v[28:31], v12 offset:2048
    s_add_u32 m0, s21, 98304
    v_mfma_f32_16x16x32_bf16 v[72:75], v[36:39], a[244:247], v[72:75]
    buffer_load_dwordx4 v8, s[8:11], s20 offen lds
    v_mfma_f32_16x16x32_bf16 v[76:79], v[40:43], a[240:243], v[76:79]
    ds_read_b128 v[32:35], v13 offset:2048
    v_mfma_f32_16x16x32_bf16 v[80:83], v[40:43], a[244:247], v[80:83]
    s_waitcnt lgkmcnt(4)
    v_mfma_f32_16x16x32_bf16 v[68:71], v[44:47], a[248:251], v[68:71]
    ds_read_b128 v[36:39], v12 offset:4096
    v_mfma_f32_16x16x32_bf16 v[72:75], v[44:47], a[252:255], v[72:75]
    buffer_load_dwordx2 v[92:93], v112, s[12:15], s39 offen offset:1024 sc1
    v_mfma_f32_16x16x32_bf16 v[76:79], v[48:51], a[248:251], v[76:79]
    ds_read_b128 v[40:43], v13 offset:4096
    s_mov_b32 s37, 1
    v_mfma_f32_16x16x32_bf16 v[80:83], v[48:51], a[252:255], v[80:83]
    s_waitcnt lgkmcnt(4)
    s_add_u32 s22, s22, 1
    s_cmp_ge_u32 s22, s23
    s_cbranch_scc0 L_st_273
L_fl1_271:
    s_waitcnt lgkmcnt(0)
    s_nop 7
    s_sub_u32 s38, s22, 1
    s_and_b32 s31, s38, 3
    s_lshl_b32 s31, s31, 11
    s_bfe_u32 s38, s38, 0x10002
    s_xor_b32 s38, s38, 1
    s_cmp_eq_u32 s37, 0
    s_cselect_b32 s31, 0x40000000, s31
    s_cselect_b32 s38, 0, s38
    v_cvt_pk_bf16_f32 v104, v69, v73
    v_cvt_pk_bf16_f32 v105, v77, v81
    v_and_or_b32 v104, v104, -2, s38
    v_and_or_b32 v105, v105, -2, s38
    s_add_u32 s29, s45, s31
    buffer_store_dwordx2 v[104:105], v112, s[12:15], s29 offen offset:0 sc1
    v_cvt_pk_bf16_f32 v106, v70, v74
    v_cvt_pk_bf16_f32 v107, v78, v82
    v_and_or_b32 v106, v106, -2, s38
    v_and_or_b32 v107, v107, -2, s38
    s_add_u32 s29, s46, s31
    buffer_store_dwordx2 v[106:107], v112, s[12:15], s29 offen offset:512 sc1
    v_cvt_pk_bf16_f32 v108, v71, v75
    v_cvt_pk_bf16_f32 v109, v79, v83
    v_and_or_b32 v108, v108, -2, s38
    v_and_or_b32 v109, v109, -2, s38
    s_add_u32 s29, s47, s31
    buffer_store_dwordx2 v[108:109], v112, s[12:15], s29 offen offset:1024 sc1
    s_waitcnt vmcnt(0)
    v_xor_b32 v124, s7, v88
    v_bitop3_b32 v124, v124, v89, s7 bitop3:0xf6
    v_bitop3_b32 v124, v124, v90, s7 bitop3:0xf6
    v_bitop3_b32 v124, v124, v91, s7 bitop3:0xf6
    v_bitop3_b32 v124, v124, v92, s7 bitop3:0xf6
    v_bitop3_b32 v124, v124, v93, s7 bitop3:0xf6
    v_and_b32 v124, 1, v124
    v_cmp_ne_u32 vcc, 0, v124
    s_nop 0
    s_nop 0
    s_nop 0
    s_cbranch_vccnz L_rbad_278
L_rok_279:
    v_lshlrev_b32 v124, 16, v88
    v_and_b32 v125, 0xffff0000, v88
    v_add_f32 v96, v116, v124
    v_add_f32 v97, v117, v125
    v_lshlrev_b32 v124, 16, v89
    v_and_b32 v125, 0xffff0000, v89
    v_add_f32 v98, v118, v124
    v_add_f32 v99, v119, v125
    v_lshlrev_b32 v124, 16, v90
    v_and_b32 v125, 0xffff0000, v90
    v_add_f32 v96, v96, v124
    v_add_f32 v97, v97, v125
    v_lshlrev_b32 v124, 16, v91
    v_and_b32 v125, 0xffff0000, v91
    v_add_f32 v98, v98, v124
    v_add_f32 v99, v99, v125
    v_lshlrev_b32 v124, 16, v92
    v_and_b32 v125, 0xffff0000, v92
    v_add_f32 v96, v96, v124
    v_add_f32 v97, v97, v125
    v_lshlrev_b32 v124, 16, v93
    v_and_b32 v125, 0xffff0000, v93
    v_add_f32 v98, v98, v124
    v_add_f32 v99, v99, v125
    ds_write2_b32 v114, v96, v97 offset0:0 offset1:16
    ds_write2_b32 v114, v98, v99 offset0:128 offset1:144
    ds_read_b128 v[88:91], v113 offset:0
    s_waitcnt lgkmcnt(0)
    v_cvt_pk_bf16_f32 v96, 0, v88
    v_cvt_pk_bf16_f32 v97, 0, v89
    v_cvt_pk_bf16_f32 v98, 0, v90
    v_cvt_pk_bf16_f32 v99, 0, v91
    buffer_store_dwordx4 v[96:99], v128, s[16:19], s43 offen
    v_mov_b32 v116, v68
    v_mov_b32 v117, v72
    v_mov_b32 v118, v76
    v_mov_b32 v119, v80
    s_mov_b32 s7, s38
    s_add_u32 s39, s44, s31
    s_sub_u32 s43, s22, 1
    s_mul_i32 s3, s43, 3
    s_add_u32 s3, s3, s95
    s_lshl1_add_u32 s43, s43, s94
    s_max_i32 s43, s43, s3
    s_lshl_b32 s43, s43, 18
    s_cmp_eq_u32 s37, 0
    s_cselect_b32 s43, 0x7ff00000, s43
    buffer_load_dwordx2 v[88:89], v112, s[12:15], s39 offen offset:0 sc1
    buffer_load_dwordx2 v[90:91], v112, s[12:15], s39 offen offset:512 sc1
    buffer_load_dwordx2 v[92:93], v112, s[12:15], s39 offen offset:1024 sc1
    s_mov_b32 s37, 1
    s_waitcnt vmcnt(0)
    v_xor_b32 v124, s7, v88
    v_bitop3_b32 v124, v124, v89, s7 bitop3:0xf6
    v_bitop3_b32 v124, v124, v90, s7 bitop3:0xf6
    v_bitop3_b32 v124, v124, v91, s7 bitop3:0xf6
    v_bitop3_b32 v124, v124, v92, s7 bitop3:0xf6
    v_bitop3_b32 v124, v124, v93, s7 bitop3:0xf6
    v_and_b32 v124, 1, v124
    v_cmp_ne_u32 vcc, 0, v124
    s_nop 0
    s_nop 0
    s_nop 0
    s_cbranch_vccnz L_rbad_280
L_rok_281:
    v_lshlrev_b32 v124, 16, v88
    v_and_b32 v125, 0xffff0000, v88
    v_add_f32 v96, v116, v124
    v_add_f32 v97, v117, v125
    v_lshlrev_b32 v124, 16, v89
    v_and_b32 v125, 0xffff0000, v89
    v_add_f32 v98, v118, v124
    v_add_f32 v99, v119, v125
    v_lshlrev_b32 v124, 16, v90
    v_and_b32 v125, 0xffff0000, v90
    v_add_f32 v96, v96, v124
    v_add_f32 v97, v97, v125
    v_lshlrev_b32 v124, 16, v91
    v_and_b32 v125, 0xffff0000, v91
    v_add_f32 v98, v98, v124
    v_add_f32 v99, v99, v125
    v_lshlrev_b32 v124, 16, v92
    v_and_b32 v125, 0xffff0000, v92
    v_add_f32 v96, v96, v124
    v_add_f32 v97, v97, v125
    v_lshlrev_b32 v124, 16, v93
    v_and_b32 v125, 0xffff0000, v93
    v_add_f32 v98, v98, v124
    v_add_f32 v99, v99, v125
    ds_write2_b32 v114, v96, v97 offset0:0 offset1:16
    ds_write2_b32 v114, v98, v99 offset0:128 offset1:144
    ds_read_b128 v[88:91], v113 offset:0
    s_waitcnt lgkmcnt(0)
    v_cvt_pk_bf16_f32 v96, 0, v88
    v_cvt_pk_bf16_f32 v97, 0, v89
    v_cvt_pk_bf16_f32 v98, 0, v90
    v_cvt_pk_bf16_f32 v99, 0, v91
    buffer_store_dwordx4 v[96:99], v128, s[16:19], s43 offen
    s_branch L_ste_272
L_rbad_274:
    buffer_load_dwordx2 v[88:89], v112, s[12:15], s39 offen offset:0 sc1
    buffer_load_dwordx2 v[90:91], v112, s[12:15], s39 offen offset:512 sc1
    buffer_load_dwordx2 v[92:93], v112, s[12:15], s39 offen offset:1024 sc1
    s_add_u32 s36, s36, 1
    s_cmp_gt_u32 s36, 0x100000
    s_cbranch_scc1 chain_kernel_wend
    s_waitcnt vmcnt(0)
    v_xor_b32 v124, s7, v88
    v_bitop3_b32 v124, v124, v89, s7 bitop3:0xf6
    v_bitop3_b32 v124, v124, v90, s7 bitop3:0xf6
    v_bitop3_b32 v124, v124, v91, s7 bitop3:0xf6
    v_bitop3_b32 v124, v124, v92, s7 bitop3:0xf6
    v_bitop3_b32 v124, v124, v93, s7 bitop3:0xf6
    v_and_b32 v124, 1, v124
    v_cmp_ne_u32 vcc, 0, v124
    s_cbranch_vccnz L_rbad_274
    s_branch L_rok_275
L_rbad_276:
    buffer_load_dwordx2 v[88:89], v112, s[12:15], s39 offen offset:0 sc1
    buffer_load_dwordx2 v[90:91], v112, s[12:15], s39 offen offset:512 sc1
    buffer_load_dwordx2 v[92:93], v112, s[12:15], s39 offen offset:1024 sc1
    s_add_u32 s36, s36, 1
    s_cmp_gt_u32 s36, 0x100000
    s_cbranch_scc1 chain_kernel_wend
    s_waitcnt vmcnt(0)
    v_xor_b32 v124, s7, v88
    v_bitop3_b32 v124, v124, v89, s7 bitop3:0xf6
    v_bitop3_b32 v124, v124, v90, s7 bitop3:0xf6
    v_bitop3_b32 v124, v124, v91, s7 bitop3:0xf6
    v_bitop3_b32 v124, v124, v92, s7 bitop3:0xf6
    v_bitop3_b32 v124, v124, v93, s7 bitop3:0xf6
    v_and_b32 v124, 1, v124
    v_cmp_ne_u32 vcc, 0, v124
    s_cbranch_vccnz L_rbad_276
    s_branch L_rok_277
L_rbad_278:
    buffer_load_dwordx2 v[88:89], v112, s[12:15], s39 offen offset:0 sc1
    buffer_load_dwordx2 v[90:91], v112, s[12:15], s39 offen offset:512 sc1
    buffer_load_dwordx2 v[92:93], v112, s[12:15], s39 offen offset:1024 sc1
    s_add_u32 s36, s36, 1
    s_cmp_gt_u32 s36, 0x100000
    s_cbranch_scc1 chain_kernel_wend
    s_waitcnt vmcnt(0)
    v_xor_b32 v124, s7, v88
    v_bitop3_b32 v124, v124, v89, s7 bitop3:0xf6
    v_bitop3_b32 v124, v124, v90, s7 bitop3:0xf6
    v_bitop3_b32 v124, v124, v91, s7 bitop3:0xf6
    v_bitop3_b32 v124, v124, v92, s7 bitop3:0xf6
    v_bitop3_b32 v124, v124, v93, s7 bitop3:0xf6
    v_and_b32 v124, 1, v124
    v_cmp_ne_u32 vcc, 0, v124
    s_cbranch_vccnz L_rbad_278
    s_branch L_rok_279
L_rbad_280:
    buffer_load_dwordx2 v[88:89], v112, s[12:15], s39 offen offset:0 sc1
    buffer_load_dwordx2 v[90:91], v112, s[12:15], s39 offen offset:512 sc1
    buffer_load_dwordx2 v[92:93], v112, s[12:15], s39 offen offset:1024 sc1
    s_add_u32 s36, s36, 1
    s_cmp_gt_u32 s36, 0x100000
    s_cbranch_scc1 chain_kernel_wend
    s_waitcnt vmcnt(0)
    v_xor_b32 v124, s7, v88
    v_bitop3_b32 v124, v124, v89, s7 bitop3:0xf6
    v_bitop3_b32 v124, v124, v90, s7 bitop3:0xf6
    v_bitop3_b32 v124, v124, v91, s7 bitop3:0xf6
    v_bitop3_b32 v124, v124, v92, s7 bitop3:0xf6
    v_bitop3_b32 v124, v124, v93, s7 bitop3:0xf6
    v_and_b32 v124, 1, v124
    v_cmp_ne_u32 vcc, 0, v124
    s_cbranch_vccnz L_rbad_280
    s_branch L_rok_281
L_fl0_270:
    s_waitcnt lgkmcnt(0)
    s_nop 7
    s_sub_u32 s38, s22, 1
    s_and_b32 s31, s38, 3
    s_lshl_b32 s31, s31, 11
    s_bfe_u32 s38, s38, 0x10002
    s_xor_b32 s38, s38, 1
    s_cmp_eq_u32 s37, 0
    s_cselect_b32 s31, 0x40000000, s31
    s_cselect_b32 s38, 0, s38
    v_cvt_pk_bf16_f32 v104, v53, v57
    v_cvt_pk_bf16_f32 v105, v61, v65
    v_and_or_b32 v104, v104, -2, s38
    v_and_or_b32 v105, v105, -2, s38
    s_add_u32 s29, s45, s31
    buffer_store_dwordx2 v[104:105], v112, s[12:15], s29 offen offset:0 sc1
    v_cvt_pk_bf16_f32 v106, v54, v58
    v_cvt_pk_bf16_f32 v107, v62, v66
    v_and_or_b32 v106, v106, -2, s38
    v_and_or_b32 v107, v107, -2, s38
    s_add_u32 s29, s46, s31
    buffer_store_dwordx2 v[106:107], v112, s[12:15], s29 offen offset:512 sc1
    v_cvt_pk_bf16_f32 v108, v55, v59
    v_cvt_pk_bf16_f32 v109, v63, v67
    v_and_or_b32 v108, v108, -2, s38
    v_and_or_b32 v109, v109, -2, s38
    s_add_u32 s29, s47, s31
    buffer_store_dwordx2 v[108:109], v112, s[12:15], s29 offen offset:1024 sc1
    s_waitcnt vmcnt(0)
    v_xor_b32 v124, s7, v88
    v_bitop3_b32 v124, v124, v89, s7 bitop3:0xf6
    v_bitop3_b32 v124, v124, v90, s7 bitop3:0xf6
    v_bitop3_b32 v124, v124, v91, s7 bitop3:0xf6
    v_bitop3_b32 v124, v124, v92, s7 bitop3:0xf6
    v_bitop3_b32 v124, v124, v93, s7 bitop3:0xf6
    v_and_b32 v124, 1, v124
    v_cmp_ne_u32 vcc, 0, v124
    s_nop 0
    s_nop 0
    s_nop 0
    s_cbranch_vccnz L_rbad_282
L_rok_283:
    v_lshlrev_b32 v124, 16, v88
    v_and_b32 v125, 0xffff0000, v88
    v_add_f32 v96, v116, v124
    v_add_f32 v97, v117, v125
    v_lshlrev_b32 v124, 16, v89
    v_and_b32 v125, 0xffff0000, v89
    v_add_f32 v98, v118, v124
    v_add_f32 v99, v119, v125
    v_lshlrev_b32 v124, 16, v90
    v_and_b32 v125, 0xffff0000, v90
    v_add_f32 v96, v96, v124
    v_add_f32 v97, v97, v125
    v_lshlrev_b32 v124, 16, v91
    v_and_b32 v125, 0xffff0000, v91
    v_add_f32 v98, v98, v124
    v_add_f32 v99, v99, v125
    v_lshlrev_b32 v124, 16, v92
    v_and_b32 v125, 0xffff0000, v92
    v_add_f32 v96, v96, v124
    v_add_f32 v97, v97, v125
    v_lshlrev_b32 v124, 16, v93
    v_and_b32 v125, 0xffff0000, v93
    v_add_f32 v98, v98, v124
    v_add_f32 v99, v99, v125
    ds_write2_b32 v114, v96, v97 offset0:0 offset1:16
    ds_write2_b32 v114, v98, v99 offset0:128 offset1:144
    ds_read_b128 v[88:91], v113 offset:0
    s_waitcnt lgkmcnt(0)
    v_cvt_pk_bf16_f32 v96, 0, v88
    v_cvt_pk_bf16_f32 v97, 0, v89
    v_cvt_pk_bf16_f32 v98, 0, v90
    v_cvt_pk_bf16_f32 v99, 0, v91
    buffer_store_dwordx4 v[96:99], v128, s[16:19], s43 offen
    v_mov_b32 v116, v52
    v_mov_b32 v117, v56
    v_mov_b32 v118, v60
    v_mov_b32 v119, v64
    s_mov_b32 s7, s38
    s_add_u32 s39, s44, s31
    s_sub_u32 s43, s22, 1
    s_mul_i32 s3, s43, 3
    s_add_u32 s3, s3, s95
    s_lshl1_add_u32 s43, s43, s94
    s_max_i32 s43, s43, s3
    s_lshl_b32 s43, s43, 18
    s_cmp_eq_u32 s37, 0
    s_cselect_b32 s43, 0x7ff00000, s43
    buffer_load_dwordx2 v[88:89], v112, s[12:15], s39 offen offset:0 sc1
    buffer_load_dwordx2 v[90:91], v112, s[12:15], s39 offen offset:512 sc1
    buffer_load_dwordx2 v[92:93], v112, s[12:15], s39 offen offset:1024 sc1
    s_mov_b32 s37, 1
    s_waitcnt vmcnt(0)
    v_xor_b32 v124, s7, v88
    v_bitop3_b32 v124, v124, v89, s7 bitop3:0xf6
    v_bitop3_b32 v124, v124, v90, s7 bitop3:0xf6
    v_bitop3_b32 v124, v124, v91, s7 bitop3:0xf6
    v_bitop3_b32 v124, v124, v92, s7 bitop3:0xf6
    v_bitop3_b32 v124, v124, v93, s7 bitop3:0xf6
    v_and_b32 v124, 1, v124
    v_cmp_ne_u32 vcc, 0, v124
    s_nop 0
    s_nop 0
    s_nop 0
    s_cbranch_vccnz L_rbad_284
L_rok_285:
    v_lshlrev_b32 v124, 16, v88
    v_and_b32 v125, 0xffff0000, v88
    v_add_f32 v96, v116, v124
    v_add_f32 v97, v117, v125
    v_lshlrev_b32 v124, 16, v89
    v_and_b32 v125, 0xffff0000, v89
    v_add_f32 v98, v118, v124
    v_add_f32 v99, v119, v125
    v_lshlrev_b32 v124, 16, v90
    v_and_b32 v125, 0xffff0000, v90
    v_add_f32 v96, v96, v124
    v_add_f32 v97, v97, v125
    v_lshlrev_b32 v124, 16, v91
    v_and_b32 v125, 0xffff0000, v91
    v_add_f32 v98, v98, v124
    v_add_f32 v99, v99, v125
    v_lshlrev_b32 v124, 16, v92
    v_and_b32 v125, 0xffff0000, v92
    v_add_f32 v96, v96, v124
    v_add_f32 v97, v97, v125
    v_lshlrev_b32 v124, 16, v93
    v_and_b32 v125, 0xffff0000, v93
    v_add_f32 v98, v98, v124
    v_add_f32 v99, v99, v125
    ds_write2_b32 v114, v96, v97 offset0:0 offset1:16
    ds_write2_b32 v114, v98, v99 offset0:128 offset1:144
    ds_read_b128 v[88:91], v113 offset:0
    s_waitcnt lgkmcnt(0)
    v_cvt_pk_bf16_f32 v96, 0, v88
    v_cvt_pk_bf16_f32 v97, 0, v89
    v_cvt_pk_bf16_f32 v98, 0, v90
    v_cvt_pk_bf16_f32 v99, 0, v91
    buffer_store_dwordx4 v[96:99], v128, s[16:19], s43 offen
    s_branch L_ste_272
L_rbad_282:
    buffer_load_dwordx2 v[88:89], v112, s[12:15], s39 offen offset:0 sc1
    buffer_load_dwordx2 v[90:91], v112, s[12:15], s39 offen offset:512 sc1
    buffer_load_dwordx2 v[92:93], v112, s[12:15], s39 offen offset:1024 sc1
    s_add_u32 s36, s36, 1
    s_cmp_gt_u32 s36, 0x100000
    s_cbranch_scc1 chain_kernel_wend
    s_waitcnt vmcnt(0)
    v_xor_b32 v124, s7, v88
    v_bitop3_b32 v124, v124, v89, s7 bitop3:0xf6
    v_bitop3_b32 v124, v124, v90, s7 bitop3:0xf6
    v_bitop3_b32 v124, v124, v91, s7 bitop3:0xf6
    v_bitop3_b32 v124, v124, v92, s7 bitop3:0xf6
    v_bitop3_b32 v124, v124, v93, s7 bitop3:0xf6
    v_and_b32 v124, 1, v124
    v_cmp_ne_u32 vcc, 0, v124
    s_cbranch_vccnz L_rbad_282
    s_branch L_rok_283
L_rbad_284:
    buffer_load_dwordx2 v[88:89], v112, s[12:15], s39 offen offset:0 sc1
    buffer_load_dwordx2 v[90:91], v112, s[12:15], s39 offen offset:512 sc1
    buffer_load_dwordx2 v[92:93], v112, s[12:15], s39 offen offset:1024 sc1
    s_add_u32 s36, s36, 1
    s_cmp_gt_u32 s36, 0x100000
    s_cbranch_scc1 chain_kernel_wend
    s_waitcnt vmcnt(0)
    v_xor_b32 v124, s7, v88
    v_bitop3_b32 v124, v124, v89, s7 bitop3:0xf6
    v_bitop3_b32 v124, v124, v90, s7 bitop3:0xf6
    v_bitop3_b32 v124, v124, v91, s7 bitop3:0xf6
    v_bitop3_b32 v124, v124, v92, s7 bitop3:0xf6
    v_bitop3_b32 v124, v124, v93, s7 bitop3:0xf6
    v_and_b32 v124, 1, v124
    v_cmp_ne_u32 vcc, 0, v124
    s_cbranch_vccnz L_rbad_284
    s_branch L_rok_285
L_ste_272:
    s_branch L_run_266
L_rdone_269:
chain_kernel_wend:
chain_kernel_end:
    s_endpgm
.section .rodata,"a"
.p2align 6
.amdhsa_kernel chain_kernel
  .amdhsa_next_free_vgpr 512
  .amdhsa_next_free_sgpr 102
  .amdhsa_accum_offset 256
  .amdhsa_group_segment_fixed_size 0
  .amdhsa_kernarg_size 152
  .amdhsa_user_sgpr_count 2
  .amdhsa_user_sgpr_kernarg_segment_ptr 1
  .amdhsa_system_sgpr_workgroup_id_x 1
  .amdhsa_float_denorm_mode_32 3
  .amdhsa_float_denorm_mode_16_64 3
.end_amdhsa_kernel
```

```asm
; @launch kernel=chain_kernel grid=(256,1,1) block=(256,1,1) lds=163840
.amdgcn_target "amdgcn-amd-amdhsa--gfx950"
.text
.globl chain_kernel
.p2align 8
.type chain_kernel,@function
chain_kernel:
    s_cmp_ge_u32 s2, 256
    s_cbranch_scc1 chain_kernel_end
    s_load_dwordx16 s[64:79], s[0:1], 0
    s_load_dwordx16 s[80:95], s[0:1], 64
    s_load_dwordx4 s[96:99], s[0:1], 128
    s_load_dwordx2 s[100:101], s[0:1], 144
    s_waitcnt lgkmcnt(0)
    s_getreg_b32 s16, hwreg(HW_REG_XCC_ID)
    s_and_b32 s16, s16, 7
    v_lshrrev_b32 v3, 6, v0
    s_mov_b32 s12, s98
    s_and_b32 s13, s99, 0xffff
    s_mov_b32 s14, 0x100
    s_mov_b32 s15, 0x00020000
    v_readfirstlane_b32 s18, v3
    s_lshl_b32 s3, s16, 5
    v_mov_b32 v12, 1
    v_lshlrev_b32 v13, 8, v0
    buffer_atomic_add v12, v13, s[12:15], s3 offen offset:24 sc0 sc1
    s_add_u32 s8, s100, 0x5000000
    s_addc_u32 s9, s101, 0
    s_and_b32 s9, s9, 0xffff
    s_mov_b32 s10, 0x180000
    s_mov_b32 s11, 0x00020000
    s_lshl_b32 s3, s2, 13
    v_lshlrev_b32 v1, 4, v0
    v_mov_b32 v4, 0xff81ff81
    v_mov_b32 v5, 0xff81ff81
    v_mov_b32 v6, 0xff81ff81
    v_mov_b32 v7, 0xff81ff81
    buffer_store_dwordx4 v[4:7], v1, s[8:11], s3 offen sc1
    s_add_u32 s3, s3, 4096
    buffer_store_dwordx4 v[4:7], v1, s[8:11], s3 offen sc1
    s_add_u32 s3, s3, 4096
    s_add_u32 s8, s100, 0x8000000
    s_addc_u32 s9, s101, 0
    s_and_b32 s9, s9, 0xffff
    s_mov_b32 s10, 0x4600000
    s_mov_b32 s11, 0x00020000
    s_add_u32 s4, s8, 0x1fffff
    s_and_b32 s4, s4, 0xffe00000
    s_sub_u32 s4, s4, s8
    s_add_u32 s8, s100, 0x5900000
    s_addc_u32 s9, s101, 0
    s_and_b32 s9, s9, 0xffff
    s_mov_b32 s10, 0x10000
    s_mov_b32 s11, 0x00020000
    s_lshl_b32 s3, s2, 12
    v_mov_b32 v8, 0
    v_mov_b32 v9, 0
    v_mov_b32 v10, 0
    v_mov_b32 v11, 0
    buffer_store_dwordx4 v[8:11], v1, s[8:11], s3 offen sc1
    s_cmp_lg_u32 s18, 1
    s_cbranch_scc1 L_role_1
    s_mov_b32 s7, 1
    s_cmp_lg_u32 s16, 7
    s_cbranch_scc1 L_rolew_2
    s_lshr_b32 s6, s2, 7
    s_lshl_b32 s6, s6, 8
    s_add_u32 s4, s4, s6
    s_and_b32 s5, s2, 127
    s_lshl_b32 s5, s5, 14
    s_add_u32 s5, s5, s4
    s_add_u32 s5, s5, 0xc000800
    s_add_u32 s12, s100, s5
    s_addc_u32 s13, s101, 0
    s_mov_b32 s5, 0
    s_mov_b32 s6, 0
    s_atomic_add s5, s[12:13], 0x0 glc
    s_atomic_add s6, s[12:13], 0x2000 glc
    s_mov_b32 s24, -1
    s_mov_b32 s25, -1
    s_waitcnt lgkmcnt(0)
    s_mov_b32 s5, 0
    s_memtime s[20:21]
    s_waitcnt lgkmcnt(0)
    s_atomic_add s5, s[12:13], 0x0 glc
    s_waitcnt lgkmcnt(0)
    s_memtime s[22:23]
    s_waitcnt lgkmcnt(0)
    s_sub_u32 s22, s22, s20
    s_min_u32 s24, s24, s22
    s_mov_b32 s5, 0
    s_memtime s[20:21]
    s_waitcnt lgkmcnt(0)
    s_atomic_add s5, s[12:13], 0x2000 glc
    s_waitcnt lgkmcnt(0)
    s_memtime s[22:23]
    s_waitcnt lgkmcnt(0)
    s_sub_u32 s22, s22, s20
    s_min_u32 s25, s25, s22
    s_cmp_gt_u32 s25, s24
    s_cselect_b32 s7, 0x10001, 1
L_rolew_2:
L_role_1:
    v_lshlrev_b32 v2, 2, v0
    s_waitcnt vmcnt(0)
    ds_write_b32 v2, v12 offset:0
    s_waitcnt lgkmcnt(0)
    s_barrier
    v_mov_b32 v2, 0
    ds_read_b32 v4, v2 offset:0
    s_waitcnt lgkmcnt(0)
    v_readfirstlane_b32 s17, v4
    s_cmp_lg_u32 s18, 1
    s_cbranch_scc1 L_nosig_3
    s_atomic_add s7, s[98:99], 0x0
L_nosig_3:
    s_cmp_ge_u32 s17, 32
    s_cbranch_scc1 chain_kernel_end
    s_cmp_ge_u32 s16, 4
    s_cbranch_scc1 chain_kernel_worker
    s_mov_b32 s8, s100
    s_and_b32 s9, s101, 0xffff
    s_mov_b32 s10, 0x10000000
    s_mov_b32 s11, 0x00020000
    s_mov_b32 s33, 0
    s_mov_b32 s24, 0xff00ff
    s_mov_b32 s25, 0xff00ff
    s_mov_b32 s26, 0xff00ff00
    s_mov_b32 s27, 0xff00ff00
    s_mov_b32 s28, 0x0
    s_mov_b32 s29, 0xff00ff
    s_mov_b32 s48, 0xffffffff
    s_mov_b32 s49, 0x0
    s_mov_b32 s50, 0xffff
    s_mov_b32 s51, 0x0
    s_mov_b32 s44, 0x3fb8aa3b
    s_mov_b32 s45, 0x3fb8aa3b
    s_mov_b32 s46, 0x3db504f3
    s_mov_b32 s47, 0x3db504f3
    s_mov_b32 s34, 0xff81ff81
    s_lshl_b32 s36, s16, 14
    s_add_u32 s36, s36, 0x5000000
    s_lshl_b32 s37, s16, 16
    s_add_u32 s37, s37, 0x5040000
    v_mov_b32 v36, s34
    v_mov_b32 v44, 0x3f803f80
    v_mov_b32 v37, s34
    v_mov_b32 v45, 0x3f803f80
    v_mov_b32 v38, s34
    v_mov_b32 v46, 0x3f803f80
    v_mov_b32 v39, s34
    v_mov_b32 v47, 0x3f803f80
    v_and_b32 v250, 63, v0
    v_and_b32 v248, 15, v0
    v_bfe_u32 v249, v0, 4, 2
    v_lshrrev_b32 v251, 6, v0
    v_lshlrev_b32 v1, 4, v250
    s_lshl_b32 s20, s16, 10
    s_lshl_b32 s21, s17, 5
    s_add_u32 s20, s20, s21
    s_and_b32 s30, s17, 3
    v_lshl_add_u32 v252, v251, 12, v1
    s_add_u32 s21, s30, 0
    s_and_b32 s21, s21, 3
    s_lshl_b32 s21, s21, 10
    v_add_u32 v2, s21, v252
    s_add_u32 s21, s30, 1
    s_and_b32 s21, s21, 3
    s_lshl_b32 s21, s21, 10
    v_add_u32 v3, s21, v252
    s_add_u32 s21, s30, 2
    s_and_b32 s21, s21, 3
    s_lshl_b32 s21, s21, 10
    v_add_u32 v4, s21, v252
    s_add_u32 s21, s30, 3
    s_and_b32 s21, s21, 3
    s_lshl_b32 s21, s21, 10
    v_add_u32 v5, s21, v252
    v_mov_b32 v6, 0x44444444
    v_mov_b32 v252, 0xeeeeeeee
    v_cndmask_b32 v6, v6, v252, s[26:27]
    v_bfe_u32 v252, v250, 1, 3
    v_and_b32 v253, 1, v250
    v_lshlrev_b32 v33, 11, v252
    v_lshl_add_u32 v33, v253, 3, v33
    v_lshl_add_u32 v33, v249, 4, v33
    s_xor_b32 s22, s17, 8
    s_lshl_b32 s21, s22, 6
    v_add_u32 v33, s21, v33
    v_lshlrev_b32 v8, 3, v250
    s_xor_b32 s21, s17, 2
    s_lshl_b32 s21, s21, 9
    v_add_u32 v28, s21, v8
    s_lshl_b32 s22, s22, 9
    v_add_u32 v8, s22, v8
    v_lshlrev_b32 v11, 4, v248
    v_lshl_add_u32 v11, v249, 7, v11
    v_add_u32 v11, s21, v11
    s_lshr_b32 s22, s17, 2
    s_lshl_b32 s22, s22, 13
    s_add_u32 s21, s17, 0
    s_and_b32 s21, s21, 3
    s_lshl_b32 s21, s21, 10
    s_add_u32 s21, s21, s22
    v_add_u32 v9, s21, v1
    s_add_u32 s21, s17, 1
    s_and_b32 s21, s21, 3
    s_lshl_b32 s21, s21, 10
    s_add_u32 s21, s21, s22
    v_add_u32 v13, s21, v1
    s_add_u32 s21, s17, 2
    s_and_b32 s21, s21, 3
    s_lshl_b32 s21, s21, 10
    s_add_u32 s21, s21, s22
    v_add_u32 v14, s21, v1
    s_add_u32 s21, s17, 3
    s_and_b32 s21, s21, 3
    s_lshl_b32 s21, s21, 10
    s_add_u32 s21, s21, s22
    v_add_u32 v15, s21, v1
    s_add_u32 s22, s22, 4096
    v_add_u32 v16, s22, v1
    s_and_b32 s21, s17, 3
    s_lshl_b32 s21, s21, 8
    s_add_u32 s21, s21, s22
    v_and_b32 v253, 1, v249
    v_lshlrev_b32 v10, 4, v248
    v_lshl_add_u32 v10, v253, 7, v10
    v_add_u32 v10, s21, v10
    v_lshl_add_u32 v20, v251, 11, v1
    v_lshrrev_b32 v252, 1, v249
    v_lshl_add_u32 v252, v251, 1, v252
    v_lshlrev_b32 v21, 10, v252
    v_lshl_add_u32 v21, v248, 5, v21
    v_lshl_add_u32 v21, v253, 4, v21
    v_add_u32 v21, 8192, v21
    v_lshlrev_b32 v22, 5, v248
    v_lshl_add_u32 v22, v249, 3, v22
    v_add_u32 v22, 8192, v22
    v_lshrrev_b32 v253, 2, v248
    v_and_b32 v252, 3, v248
    v_lshl_add_u32 v253, v253, 3, v252
    v_add_u32 v25, 24576, v1
    v_add_u32 v26, 26624, v1
    v_lshlrev_b32 v32, 4, v253
    v_lshl_add_u32 v29, v249, 9, v32
    v_lshl_add_u32 v32, v249, 2, v32
    v_add_u32 v32, 33792, v32
    s_add_u32 s21, s16, 0
    s_and_b32 s21, s21, 3
    s_lshl_b32 s21, s21, 18
    s_lshr_b32 s22, s17, 1
    s_lshl_b32 s22, s22, 14
    s_add_u32 s21, s21, s22
    s_and_b32 s22, s17, 1
    s_lshl_b32 s22, s22, 12
    s_add_u32 s23, s21, s22
    v_lshl_add_u32 v12, v250, 3, s23
    s_add_u32 s21, s16, 1
    s_and_b32 s21, s21, 3
    s_lshl_b32 s21, s21, 18
    s_lshr_b32 s22, s17, 1
    s_lshl_b32 s22, s22, 14
    s_add_u32 s21, s21, s22
    s_and_b32 s22, s17, 1
    s_lshl_b32 s22, s22, 12
    s_add_u32 s21, s21, s22
    v_lshl_add_u32 v17, v250, 3, s21
    s_add_u32 s21, s16, 2
    s_and_b32 s21, s21, 3
    s_lshl_b32 s21, s21, 18
    s_lshr_b32 s22, s17, 1
    s_lshl_b32 s22, s22, 14
    s_add_u32 s21, s21, s22
    s_and_b32 s22, s17, 1
    s_lshl_b32 s22, s22, 12
    s_add_u32 s21, s21, s22
    v_lshl_add_u32 v18, v250, 3, s21
    s_add_u32 s21, s16, 3
    s_and_b32 s21, s21, 3
    s_lshl_b32 s21, s21, 18
    s_lshr_b32 s22, s17, 1
    s_lshl_b32 s22, s22, 14
    s_add_u32 s21, s21, s22
    s_and_b32 s22, s17, 1
    s_lshl_b32 s22, s22, 12
    s_add_u32 s21, s21, s22
    v_lshl_add_u32 v19, v250, 3, s21
    s_xor_b32 s21, s23, 0x4000
    v_add_u32 v29, s21, v29
    v_add_u32 v31, s21, v1
    v_and_b32 v253, 8, v248
    v_add_u32 v253, v253, v248
    v_lshlrev_b32 v27, 4, v253
    v_lshl_add_u32 v27, v249, 9, v27
    v_add_u32 v27, s23, v27
    v_bfe_u32 v253, v248, 2, 1
    v_lshl_add_u32 v252, v252, 1, v253
    v_cndmask_b32 v252, v248, v252, s[26:27]
    v_lshlrev_b32 v30, 4, v252
    v_lshl_add_u32 v30, v249, 7, v30
    v_add_u32 v30, s23, v30
    v_and_b32 v253, 1, v252
    v_lshlrev_b32 v253, 4, v253
    v_mov_b32 v254, 0x3f80
    v_lshlrev_b32 v254, v253, v254
    v_lshrrev_b32 v253, 2, v252
    v_xor_b32 v253, v253, v249
    v_and_b32 v253, 1, v253
    v_bfe_u32 v252, v252, 1, 1
    v_lshl_add_u32 v252, v253, 2, v252
    v_lshrrev_b32 v253, 3, v248
    v_lshl_add_u32 v252, v253, 1, v252
    v_cmp_eq_u32 vcc, 0, v252
    s_nop 1
    v_cndmask_b32 v40, 0, v254, vcc
    v_cmp_eq_u32 vcc, 1, v252
    s_nop 1
    v_cndmask_b32 v41, 0, v254, vcc
    v_cmp_eq_u32 vcc, 2, v252
    s_nop 1
    v_cndmask_b32 v42, 0, v254, vcc
    v_cmp_eq_u32 vcc, 3, v252
    s_nop 1
    v_cndmask_b32 v43, 0, v254, vcc
    v_bfe_u32 v248, v0, 4, 2
    v_lshlrev_b32 v250, 1, v248
    v_bfe_u32 v248, v0, 2, 1
    v_add_u32 v250, v250, v248
    v_bfe_u32 v248, v0, 3, 1
    v_lshl_add_u32 v250, v248, 3, v250
    v_lshrrev_b32 v248, 6, v0
    v_lshl_add_u32 v250, v248, 8, v250
    v_and_b32 v249, 3, v0
    v_lshlrev_b32 v251, 13, v250
    v_lshl_add_u32 v251, v249, 4, v251
    s_lshl_b32 s21, s20, 1
    v_add_u32 v251, s21, v251
    s_lshl_b32 s21, s16, 10
    v_add_u32 v252, s21, v250
    v_lshlrev_b32 v252, 11, v252
    v_lshl_add_u32 v252, v249, 4, v252
    s_xor_b32 s21, s17, 8
    s_lshl_b32 s21, s21, 6
    v_add_u32 v252, s21, v252
    v_bfe_u32 v248, v0, 4, 2
    v_lshlrev_b32 v248, 3, v248
    v_bfe_u32 v242, v0, 2, 2
    v_add_u32 v248, v248, v242
    v_lshlrev_b32 v242, 6, v248
    v_lshrrev_b32 v248, 6, v0
    v_lshl_add_u32 v242, v248, 14, v242
    v_lshl_add_u32 v240, v249, 3, v242
    v_and_b32 v241, 2, v249
    v_lshl_add_u32 v240, v241, 3, v240
    v_lshl_add_u32 v242, v249, 4, v242
    v_add_u32 v241, 0x10000, v240
    v_add_u32 v243, 0x10000, v242
    v_lshl_add_u32 v244, v248, 14, v1
    v_add_u32 v245, 0x10000, v244
    s_lshl_b32 s22, s18, 14
    s_add_u32 s22, s22, 32768
    s_and_b32 s23, s17, 14
    s_cmp_eq_u32 s23, 6
    s_cselect_b64 vcc, 0, -1
    v_xor_b32 v253, 128, v251
    s_mov_b32 s12, s88
    s_and_b32 s13, s89, 0xffff
    s_mov_b32 s14, 0x800000
    s_mov_b32 s15, 0x00020000
    s_add_u32 m0, s22, 0
    s_add_u32 s23, s30, 0
    s_and_b32 s23, s23, 3
    s_lshl_b32 s23, s23, 2
    s_add_u32 s23, s23, 0
    s_mul_i32 s23, s23, 131072
    buffer_load_dwordx4 v251, s[12:15], s23 offen lds
    s_add_u32 m0, s22, 1024
    s_add_u32 s23, s30, 0
    s_and_b32 s23, s23, 3
    s_lshl_b32 s23, s23, 2
    s_add_u32 s23, s23, 1
    s_mul_i32 s23, s23, 131072
    buffer_load_dwordx4 v251, s[12:15], s23 offen lds
    s_add_u32 m0, s22, 2048
    s_add_u32 s23, s30, 0
    s_and_b32 s23, s23, 3
    s_lshl_b32 s23, s23, 2
    s_add_u32 s23, s23, 2
    s_mul_i32 s23, s23, 131072
    buffer_load_dwordx4 v251, s[12:15], s23 offen lds
    s_add_u32 m0, s22, 3072
    s_add_u32 s23, s30, 0
    s_and_b32 s23, s23, 3
    s_lshl_b32 s23, s23, 2
    s_add_u32 s23, s23, 3
    s_mul_i32 s23, s23, 131072
    buffer_load_dwordx4 v251, s[12:15], s23 offen lds
    s_add_u32 m0, s22, 4096
    s_add_u32 s23, s30, 1
    s_and_b32 s23, s23, 3
    s_lshl_b32 s23, s23, 2
    s_add_u32 s23, s23, 0
    s_mul_i32 s23, s23, 131072
    buffer_load_dwordx4 v251, s[12:15], s23 offen lds
    s_add_u32 m0, s22, 5120
    s_add_u32 s23, s30, 1
    s_and_b32 s23, s23, 3
    s_lshl_b32 s23, s23, 2
    s_add_u32 s23, s23, 1
    s_mul_i32 s23, s23, 131072
    buffer_load_dwordx4 v251, s[12:15], s23 offen lds
    s_add_u32 m0, s22, 6144
    s_add_u32 s23, s30, 1
    s_and_b32 s23, s23, 3
    s_lshl_b32 s23, s23, 2
    s_add_u32 s23, s23, 2
    s_mul_i32 s23, s23, 131072
    buffer_load_dwordx4 v251, s[12:15], s23 offen lds
    s_add_u32 m0, s22, 7168
    s_add_u32 s23, s30, 1
    s_and_b32 s23, s23, 3
    s_lshl_b32 s23, s23, 2
    s_add_u32 s23, s23, 3
    s_mul_i32 s23, s23, 131072
    buffer_load_dwordx4 v251, s[12:15], s23 offen lds
    s_add_u32 m0, s22, 8192
    s_add_u32 s23, s30, 2
    s_and_b32 s23, s23, 3
    s_lshl_b32 s23, s23, 2
    s_add_u32 s23, s23, 0
    s_mul_i32 s23, s23, 131072
    buffer_load_dwordx4 v251, s[12:15], s23 offen lds
    s_add_u32 m0, s22, 9216
    s_add_u32 s23, s30, 2
    s_and_b32 s23, s23, 3
    s_lshl_b32 s23, s23, 2
    s_add_u32 s23, s23, 1
    s_mul_i32 s23, s23, 131072
    buffer_load_dwordx4 v251, s[12:15], s23 offen lds
    s_add_u32 m0, s22, 10240
    s_add_u32 s23, s30, 2
    s_and_b32 s23, s23, 3
    s_lshl_b32 s23, s23, 2
    s_add_u32 s23, s23, 2
    s_mul_i32 s23, s23, 131072
    buffer_load_dwordx4 v251, s[12:15], s23 offen lds
    s_add_u32 m0, s22, 11264
    s_add_u32 s23, s30, 2
    s_and_b32 s23, s23, 3
    s_lshl_b32 s23, s23, 2
    s_add_u32 s23, s23, 3
    s_mul_i32 s23, s23, 131072
    buffer_load_dwordx4 v251, s[12:15], s23 offen lds
    s_add_u32 m0, s22, 12288
    s_add_u32 s23, s30, 3
    s_and_b32 s23, s23, 3
    s_lshl_b32 s23, s23, 2
    s_add_u32 s23, s23, 0
    s_mul_i32 s23, s23, 131072
    buffer_load_dwordx4 v251, s[12:15], s23 offen lds
    s_add_u32 m0, s22, 13312
    s_add_u32 s23, s30, 3
    s_and_b32 s23, s23, 3
    s_lshl_b32 s23, s23, 2
    s_add_u32 s23, s23, 1
    s_mul_i32 s23, s23, 131072
    buffer_load_dwordx4 v251, s[12:15], s23 offen lds
    s_add_u32 m0, s22, 14336
    s_add_u32 s23, s30, 3
    s_and_b32 s23, s23, 3
    s_lshl_b32 s23, s23, 2
    s_add_u32 s23, s23, 2
    s_mul_i32 s23, s23, 131072
    buffer_load_dwordx4 v251, s[12:15], s23 offen lds
    s_add_u32 m0, s22, 15360
    s_add_u32 s23, s30, 3
    s_and_b32 s23, s23, 3
    s_lshl_b32 s23, s23, 2
    s_add_u32 s23, s23, 3
    s_mul_i32 s23, s23, 131072
    buffer_load_dwordx4 v251, s[12:15], s23 offen lds
    s_mov_b32 s12, s90
    s_and_b32 s13, s91, 0xffff
    s_mov_b32 s14, 0x800000
    s_mov_b32 s15, 0x00020000
    s_add_u32 m0, s22, 65536
    s_add_u32 s23, s30, 0
    s_and_b32 s23, s23, 3
    s_lshl_b32 s23, s23, 2
    s_add_u32 s23, s23, 0
    s_mul_i32 s23, s23, 131072
    buffer_load_dwordx4 v253, s[12:15], s23 offen lds
    s_add_u32 m0, s22, 66560
    s_add_u32 s23, s30, 0
    s_and_b32 s23, s23, 3
    s_lshl_b32 s23, s23, 2
    s_add_u32 s23, s23, 1
    s_mul_i32 s23, s23, 131072
    buffer_load_dwordx4 v253, s[12:15], s23 offen lds
    s_add_u32 m0, s22, 67584
    s_add_u32 s23, s30, 0
    s_and_b32 s23, s23, 3
    s_lshl_b32 s23, s23, 2
    s_add_u32 s23, s23, 2
    s_mul_i32 s23, s23, 131072
    buffer_load_dwordx4 v253, s[12:15], s23 offen lds
    s_add_u32 m0, s22, 68608
    s_add_u32 s23, s30, 0
    s_and_b32 s23, s23, 3
    s_lshl_b32 s23, s23, 2
    s_add_u32 s23, s23, 3
    s_mul_i32 s23, s23, 131072
    buffer_load_dwordx4 v253, s[12:15], s23 offen lds
    s_add_u32 m0, s22, 69632
    s_add_u32 s23, s30, 1
    s_and_b32 s23, s23, 3
    s_lshl_b32 s23, s23, 2
    s_add_u32 s23, s23, 0
    s_mul_i32 s23, s23, 131072
    buffer_load_dwordx4 v253, s[12:15], s23 offen lds
    s_add_u32 m0, s22, 70656
    s_add_u32 s23, s30, 1
    s_and_b32 s23, s23, 3
    s_lshl_b32 s23, s23, 2
    s_add_u32 s23, s23, 1
    s_mul_i32 s23, s23, 131072
    buffer_load_dwordx4 v253, s[12:15], s23 offen lds
    s_add_u32 m0, s22, 71680
    s_add_u32 s23, s30, 1
    s_and_b32 s23, s23, 3
    s_lshl_b32 s23, s23, 2
    s_add_u32 s23, s23, 2
    s_mul_i32 s23, s23, 131072
    buffer_load_dwordx4 v253, s[12:15], s23 offen lds
    s_add_u32 m0, s22, 72704
    s_add_u32 s23, s30, 1
    s_and_b32 s23, s23, 3
    s_lshl_b32 s23, s23, 2
    s_add_u32 s23, s23, 3
    s_mul_i32 s23, s23, 131072
    buffer_load_dwordx4 v253, s[12:15], s23 offen lds
    s_add_u32 m0, s22, 73728
    s_add_u32 s23, s30, 2
    s_and_b32 s23, s23, 3
    s_lshl_b32 s23, s23, 2
    s_add_u32 s23, s23, 0
    s_mul_i32 s23, s23, 131072
    buffer_load_dwordx4 v253, s[12:15], s23 offen lds
    s_add_u32 m0, s22, 74752
    s_add_u32 s23, s30, 2
    s_and_b32 s23, s23, 3
    s_lshl_b32 s23, s23, 2
    s_add_u32 s23, s23, 1
    s_mul_i32 s23, s23, 131072
    buffer_load_dwordx4 v253, s[12:15], s23 offen lds
    s_add_u32 m0, s22, 75776
    s_add_u32 s23, s30, 2
    s_and_b32 s23, s23, 3
    s_lshl_b32 s23, s23, 2
    s_add_u32 s23, s23, 2
    s_mul_i32 s23, s23, 131072
    buffer_load_dwordx4 v253, s[12:15], s23 offen lds
    s_add_u32 m0, s22, 76800
    s_add_u32 s23, s30, 2
    s_and_b32 s23, s23, 3
    s_lshl_b32 s23, s23, 2
    s_add_u32 s23, s23, 3
    s_mul_i32 s23, s23, 131072
    buffer_load_dwordx4 v253, s[12:15], s23 offen lds
    s_add_u32 m0, s22, 77824
    s_add_u32 s23, s30, 3
    s_and_b32 s23, s23, 3
    s_lshl_b32 s23, s23, 2
    s_add_u32 s23, s23, 0
    s_mul_i32 s23, s23, 131072
    buffer_load_dwordx4 v253, s[12:15], s23 offen lds
    s_add_u32 m0, s22, 78848
    s_add_u32 s23, s30, 3
    s_and_b32 s23, s23, 3
    s_lshl_b32 s23, s23, 2
    s_add_u32 s23, s23, 1
    s_mul_i32 s23, s23, 131072
    buffer_load_dwordx4 v253, s[12:15], s23 offen lds
    s_add_u32 m0, s22, 79872
    s_add_u32 s23, s30, 3
    s_and_b32 s23, s23, 3
    s_lshl_b32 s23, s23, 2
    s_add_u32 s23, s23, 2
    s_mul_i32 s23, s23, 131072
    buffer_load_dwordx4 v253, s[12:15], s23 offen lds
    s_add_u32 m0, s22, 80896
    s_add_u32 s23, s30, 3
    s_and_b32 s23, s23, 3
    s_lshl_b32 s23, s23, 2
    s_add_u32 s23, s23, 3
    s_mul_i32 s23, s23, 131072
    buffer_load_dwordx4 v253, s[12:15], s23 offen lds
    s_mov_b32 s12, s86
    s_and_b32 s13, s87, 0xffff
    s_mov_b32 s14, 0x800000
    s_mov_b32 s15, 0x00020000
    s_add_u32 s23, s30, 0
    s_and_b32 s23, s23, 3
    s_lshl_b32 s23, s23, 2
    s_add_u32 s23, s23, 0
    s_mul_i32 s23, s23, 131072
    buffer_load_dwordx4 v[112:115], v251, s[12:15], s23 offen
    s_add_u32 s23, s30, 0
    s_and_b32 s23, s23, 3
    s_lshl_b32 s23, s23, 2
    s_add_u32 s23, s23, 1
    s_mul_i32 s23, s23, 131072
    buffer_load_dwordx4 v[116:119], v251, s[12:15], s23 offen
    s_add_u32 s23, s30, 0
    s_and_b32 s23, s23, 3
    s_lshl_b32 s23, s23, 2
    s_add_u32 s23, s23, 2
    s_mul_i32 s23, s23, 131072
    buffer_load_dwordx4 v[120:123], v251, s[12:15], s23 offen
    s_add_u32 s23, s30, 0
    s_and_b32 s23, s23, 3
    s_lshl_b32 s23, s23, 2
    s_add_u32 s23, s23, 3
    s_mul_i32 s23, s23, 131072
    buffer_load_dwordx4 v[124:127], v251, s[12:15], s23 offen
    s_add_u32 s23, s30, 1
    s_and_b32 s23, s23, 3
    s_lshl_b32 s23, s23, 2
    s_add_u32 s23, s23, 0
    s_mul_i32 s23, s23, 131072
    buffer_load_dwordx4 v[128:131], v251, s[12:15], s23 offen
    s_add_u32 s23, s30, 1
    s_and_b32 s23, s23, 3
    s_lshl_b32 s23, s23, 2
    s_add_u32 s23, s23, 1
    s_mul_i32 s23, s23, 131072
    buffer_load_dwordx4 v[132:135], v251, s[12:15], s23 offen
    s_add_u32 s23, s30, 1
    s_and_b32 s23, s23, 3
    s_lshl_b32 s23, s23, 2
    s_add_u32 s23, s23, 2
    s_mul_i32 s23, s23, 131072
    buffer_load_dwordx4 v[136:139], v251, s[12:15], s23 offen
    s_add_u32 s23, s30, 1
    s_and_b32 s23, s23, 3
    s_lshl_b32 s23, s23, 2
    s_add_u32 s23, s23, 3
    s_mul_i32 s23, s23, 131072
    buffer_load_dwordx4 v[140:143], v251, s[12:15], s23 offen
    s_add_u32 s23, s30, 2
    s_and_b32 s23, s23, 3
    s_lshl_b32 s23, s23, 2
    s_add_u32 s23, s23, 0
    s_mul_i32 s23, s23, 131072
    buffer_load_dwordx4 v[144:147], v251, s[12:15], s23 offen
    s_add_u32 s23, s30, 2
    s_and_b32 s23, s23, 3
    s_lshl_b32 s23, s23, 2
    s_add_u32 s23, s23, 1
    s_mul_i32 s23, s23, 131072
    buffer_load_dwordx4 v[148:151], v251, s[12:15], s23 offen
    s_add_u32 s23, s30, 2
    s_and_b32 s23, s23, 3
    s_lshl_b32 s23, s23, 2
    s_add_u32 s23, s23, 2
    s_mul_i32 s23, s23, 131072
    buffer_load_dwordx4 v[152:155], v251, s[12:15], s23 offen
    s_add_u32 s23, s30, 2
    s_and_b32 s23, s23, 3
    s_lshl_b32 s23, s23, 2
    s_add_u32 s23, s23, 3
    s_mul_i32 s23, s23, 131072
    buffer_load_dwordx4 v[156:159], v251, s[12:15], s23 offen
    s_add_u32 s23, s30, 3
    s_and_b32 s23, s23, 3
    s_lshl_b32 s23, s23, 2
    s_add_u32 s23, s23, 0
    s_mul_i32 s23, s23, 131072
    buffer_load_dwordx4 v[160:163], v251, s[12:15], s23 offen
    s_add_u32 s23, s30, 3
    s_and_b32 s23, s23, 3
    s_lshl_b32 s23, s23, 2
    s_add_u32 s23, s23, 1
    s_mul_i32 s23, s23, 131072
    buffer_load_dwordx4 v[164:167], v251, s[12:15], s23 offen
    s_add_u32 s23, s30, 3
    s_and_b32 s23, s23, 3
    s_lshl_b32 s23, s23, 2
    s_add_u32 s23, s23, 2
    s_mul_i32 s23, s23, 131072
    buffer_load_dwordx4 v[168:171], v251, s[12:15], s23 offen
    s_add_u32 s23, s30, 3
    s_and_b32 s23, s23, 3
    s_lshl_b32 s23, s23, 2
    s_add_u32 s23, s23, 3
    s_mul_i32 s23, s23, 131072
    buffer_load_dwordx4 v[172:175], v251, s[12:15], s23 offen
    s_waitcnt vmcnt(32)
    s_mov_b32 s12, s92
    s_and_b32 s13, s93, 0xffff
    s_mov_b32 s14, 0x800000
    s_mov_b32 s15, 0x00020000
    s_add_u32 s23, s30, 0
    s_and_b32 s23, s23, 3
    s_lshl_b32 s23, s23, 2
    s_add_u32 s23, s23, 0
    s_mul_i32 s23, s23, 32768
    buffer_load_dwordx4 v[48:51], v252, s[12:15], s23 offen
    s_add_u32 s23, s30, 0
    s_and_b32 s23, s23, 3
    s_lshl_b32 s23, s23, 2
    s_add_u32 s23, s23, 1
    s_mul_i32 s23, s23, 32768
    buffer_load_dwordx4 v[52:55], v252, s[12:15], s23 offen
    s_add_u32 s23, s30, 0
    s_and_b32 s23, s23, 3
    s_lshl_b32 s23, s23, 2
    s_add_u32 s23, s23, 2
    s_mul_i32 s23, s23, 32768
    buffer_load_dwordx4 v[56:59], v252, s[12:15], s23 offen
    s_add_u32 s23, s30, 0
    s_and_b32 s23, s23, 3
    s_lshl_b32 s23, s23, 2
    s_add_u32 s23, s23, 3
    s_mul_i32 s23, s23, 32768
    buffer_load_dwordx4 v[60:63], v252, s[12:15], s23 offen
    s_add_u32 s23, s30, 1
    s_and_b32 s23, s23, 3
    s_lshl_b32 s23, s23, 2
    s_add_u32 s23, s23, 0
    s_mul_i32 s23, s23, 32768
    buffer_load_dwordx4 v[64:67], v252, s[12:15], s23 offen
    s_add_u32 s23, s30, 1
    s_and_b32 s23, s23, 3
    s_lshl_b32 s23, s23, 2
    s_add_u32 s23, s23, 1
    s_mul_i32 s23, s23, 32768
    buffer_load_dwordx4 v[68:71], v252, s[12:15], s23 offen
    s_add_u32 s23, s30, 1
    s_and_b32 s23, s23, 3
    s_lshl_b32 s23, s23, 2
    s_add_u32 s23, s23, 2
    s_mul_i32 s23, s23, 32768
    buffer_load_dwordx4 v[72:75], v252, s[12:15], s23 offen
    s_add_u32 s23, s30, 1
    s_and_b32 s23, s23, 3
    s_lshl_b32 s23, s23, 2
    s_add_u32 s23, s23, 3
    s_mul_i32 s23, s23, 32768
    buffer_load_dwordx4 v[76:79], v252, s[12:15], s23 offen
    s_add_u32 s23, s30, 2
    s_and_b32 s23, s23, 3
    s_lshl_b32 s23, s23, 2
    s_add_u32 s23, s23, 0
    s_mul_i32 s23, s23, 32768
    buffer_load_dwordx4 v[80:83], v252, s[12:15], s23 offen
    s_add_u32 s23, s30, 2
    s_and_b32 s23, s23, 3
    s_lshl_b32 s23, s23, 2
    s_add_u32 s23, s23, 1
    s_mul_i32 s23, s23, 32768
    buffer_load_dwordx4 v[84:87], v252, s[12:15], s23 offen
    s_add_u32 s23, s30, 2
    s_and_b32 s23, s23, 3
    s_lshl_b32 s23, s23, 2
    s_add_u32 s23, s23, 2
    s_mul_i32 s23, s23, 32768
    buffer_load_dwordx4 v[88:91], v252, s[12:15], s23 offen
    s_add_u32 s23, s30, 2
    s_and_b32 s23, s23, 3
    s_lshl_b32 s23, s23, 2
    s_add_u32 s23, s23, 3
    s_mul_i32 s23, s23, 32768
    buffer_load_dwordx4 v[92:95], v252, s[12:15], s23 offen
    s_add_u32 s23, s30, 3
    s_and_b32 s23, s23, 3
    s_lshl_b32 s23, s23, 2
    s_add_u32 s23, s23, 0
    s_mul_i32 s23, s23, 32768
    buffer_load_dwordx4 v[96:99], v252, s[12:15], s23 offen
    s_add_u32 s23, s30, 3
    s_and_b32 s23, s23, 3
    s_lshl_b32 s23, s23, 2
    s_add_u32 s23, s23, 1
    s_mul_i32 s23, s23, 32768
    buffer_load_dwordx4 v[100:103], v252, s[12:15], s23 offen
    s_add_u32 s23, s30, 3
    s_and_b32 s23, s23, 3
    s_lshl_b32 s23, s23, 2
    s_add_u32 s23, s23, 2
    s_mul_i32 s23, s23, 32768
    buffer_load_dwordx4 v[104:107], v252, s[12:15], s23 offen
    s_add_u32 s23, s30, 3
    s_and_b32 s23, s23, 3
    s_lshl_b32 s23, s23, 2
    s_add_u32 s23, s23, 3
    s_mul_i32 s23, s23, 32768
    buffer_load_dwordx4 v[108:111], v252, s[12:15], s23 offen
    ds_read_b64_tr_b16 a[64:65], v240 offset:32768
    ds_read_b64_tr_b16 a[66:67], v240 offset:33024
    ds_read_b64_tr_b16 a[68:69], v240 offset:34816
    ds_read_b64_tr_b16 a[70:71], v240 offset:35072
    ds_read_b64_tr_b16 a[96:97], v240 offset:32784
    ds_read_b64_tr_b16 a[98:99], v240 offset:33040
    ds_read_b64_tr_b16 a[100:101], v240 offset:34832
    ds_read_b64_tr_b16 a[102:103], v240 offset:35088
    s_waitcnt lgkmcnt(0)
    ds_read_b64_tr_b16 a[72:73], v240 offset:36864
    ds_read_b64_tr_b16 a[74:75], v240 offset:37120
    ds_read_b64_tr_b16 a[76:77], v240 offset:38912
    ds_read_b64_tr_b16 a[78:79], v240 offset:39168
    ds_read_b64_tr_b16 a[104:105], v240 offset:36880
    ds_read_b64_tr_b16 a[106:107], v240 offset:37136
    ds_read_b64_tr_b16 a[108:109], v240 offset:38928
    ds_read_b64_tr_b16 a[110:111], v240 offset:39184
    s_waitcnt lgkmcnt(0)
    ds_read_b64_tr_b16 a[80:81], v240 offset:40960
    ds_read_b64_tr_b16 a[82:83], v240 offset:41216
    ds_read_b64_tr_b16 a[84:85], v240 offset:43008
    ds_read_b64_tr_b16 a[86:87], v240 offset:43264
    ds_read_b64_tr_b16 a[112:113], v240 offset:40976
    ds_read_b64_tr_b16 a[114:115], v240 offset:41232
    ds_read_b64_tr_b16 a[116:117], v240 offset:43024
    ds_read_b64_tr_b16 a[118:119], v240 offset:43280
    s_waitcnt lgkmcnt(0)
    ds_read_b64_tr_b16 a[88:89], v240 offset:45056
    ds_read_b64_tr_b16 a[90:91], v240 offset:45312
    ds_read_b64_tr_b16 a[92:93], v240 offset:47104
    ds_read_b64_tr_b16 a[94:95], v240 offset:47360
    ds_read_b64_tr_b16 a[120:121], v240 offset:45072
    ds_read_b64_tr_b16 a[122:123], v240 offset:45328
    ds_read_b64_tr_b16 a[124:125], v240 offset:47120
    ds_read_b64_tr_b16 a[126:127], v240 offset:47376
    s_waitcnt lgkmcnt(0)
    s_waitcnt vmcnt(32)
    ds_read_b64_tr_b16 a[128:129], v243 offset:32768
    ds_read_b64_tr_b16 a[130:131], v243 offset:33024
    ds_read_b64_tr_b16 a[132:133], v243 offset:34816
    ds_read_b64_tr_b16 a[134:135], v243 offset:35072
    ds_read_b64_tr_b16 a[160:161], v243 offset:32776
    ds_read_b64_tr_b16 a[162:163], v243 offset:33032
    ds_read_b64_tr_b16 a[164:165], v243 offset:34824
    ds_read_b64_tr_b16 a[166:167], v243 offset:35080
    s_waitcnt lgkmcnt(0)
    ds_read_b64_tr_b16 a[136:137], v243 offset:36864
    ds_read_b64_tr_b16 a[138:139], v243 offset:37120
    ds_read_b64_tr_b16 a[140:141], v243 offset:38912
    ds_read_b64_tr_b16 a[142:143], v243 offset:39168
    ds_read_b64_tr_b16 a[168:169], v243 offset:36872
    ds_read_b64_tr_b16 a[170:171], v243 offset:37128
    ds_read_b64_tr_b16 a[172:173], v243 offset:38920
    ds_read_b64_tr_b16 a[174:175], v243 offset:39176
    s_waitcnt lgkmcnt(0)
    ds_read_b64_tr_b16 a[144:145], v243 offset:40960
    ds_read_b64_tr_b16 a[146:147], v243 offset:41216
    ds_read_b64_tr_b16 a[148:149], v243 offset:43008
    ds_read_b64_tr_b16 a[150:151], v243 offset:43264
    ds_read_b64_tr_b16 a[176:177], v243 offset:40968
    ds_read_b64_tr_b16 a[178:179], v243 offset:41224
    ds_read_b64_tr_b16 a[180:181], v243 offset:43016
    ds_read_b64_tr_b16 a[182:183], v243 offset:43272
    s_waitcnt lgkmcnt(0)
    ds_read_b64_tr_b16 a[152:153], v243 offset:45056
    ds_read_b64_tr_b16 a[154:155], v243 offset:45312
    ds_read_b64_tr_b16 a[156:157], v243 offset:47104
    ds_read_b64_tr_b16 a[158:159], v243 offset:47360
    ds_read_b64_tr_b16 a[184:185], v243 offset:45064
    ds_read_b64_tr_b16 a[186:187], v243 offset:45320
    ds_read_b64_tr_b16 a[188:189], v243 offset:47112
    ds_read_b64_tr_b16 a[190:191], v243 offset:47368
    s_waitcnt lgkmcnt(0)
    s_waitcnt vmcnt(16)
    ds_write_b128 v244, v[112:115] offset:32768
    ds_write_b128 v244, v[116:119] offset:33792
    ds_write_b128 v244, v[120:123] offset:34816
    ds_write_b128 v244, v[124:127] offset:35840
    ds_write_b128 v244, v[128:131] offset:36864
    ds_write_b128 v244, v[132:135] offset:37888
    ds_write_b128 v244, v[136:139] offset:38912
    ds_write_b128 v244, v[140:143] offset:39936
    ds_write_b128 v244, v[144:147] offset:40960
    ds_write_b128 v244, v[148:151] offset:41984
    ds_write_b128 v244, v[152:155] offset:43008
    ds_write_b128 v244, v[156:159] offset:44032
    ds_write_b128 v244, v[160:163] offset:45056
    ds_write_b128 v244, v[164:167] offset:46080
    ds_write_b128 v244, v[168:171] offset:47104
    ds_write_b128 v244, v[172:175] offset:48128
    s_waitcnt lgkmcnt(0)
    ds_read_b64_tr_b16 a[0:1], v240 offset:32768
    ds_read_b64_tr_b16 a[2:3], v240 offset:33024
    ds_read_b64_tr_b16 a[4:5], v240 offset:34816
    ds_read_b64_tr_b16 a[6:7], v240 offset:35072
    ds_read_b64_tr_b16 a[32:33], v240 offset:32784
    ds_read_b64_tr_b16 a[34:35], v240 offset:33040
    ds_read_b64_tr_b16 a[36:37], v240 offset:34832
    ds_read_b64_tr_b16 a[38:39], v240 offset:35088
    s_waitcnt lgkmcnt(0)
    ds_read_b64_tr_b16 a[8:9], v240 offset:36864
    ds_read_b64_tr_b16 a[10:11], v240 offset:37120
    ds_read_b64_tr_b16 a[12:13], v240 offset:38912
    ds_read_b64_tr_b16 a[14:15], v240 offset:39168
    ds_read_b64_tr_b16 a[40:41], v240 offset:36880
    ds_read_b64_tr_b16 a[42:43], v240 offset:37136
    ds_read_b64_tr_b16 a[44:45], v240 offset:38928
    ds_read_b64_tr_b16 a[46:47], v240 offset:39184
    s_waitcnt lgkmcnt(0)
    ds_read_b64_tr_b16 a[16:17], v240 offset:40960
    ds_read_b64_tr_b16 a[18:19], v240 offset:41216
    ds_read_b64_tr_b16 a[20:21], v240 offset:43008
    ds_read_b64_tr_b16 a[22:23], v240 offset:43264
    ds_read_b64_tr_b16 a[48:49], v240 offset:40976
    ds_read_b64_tr_b16 a[50:51], v240 offset:41232
    ds_read_b64_tr_b16 a[52:53], v240 offset:43024
    ds_read_b64_tr_b16 a[54:55], v240 offset:43280
    s_waitcnt lgkmcnt(0)
    ds_read_b64_tr_b16 a[24:25], v240 offset:45056
    ds_read_b64_tr_b16 a[26:27], v240 offset:45312
    ds_read_b64_tr_b16 a[28:29], v240 offset:47104
    ds_read_b64_tr_b16 a[30:31], v240 offset:47360
    ds_read_b64_tr_b16 a[56:57], v240 offset:45072
    ds_read_b64_tr_b16 a[58:59], v240 offset:45328
    ds_read_b64_tr_b16 a[60:61], v240 offset:47120
    ds_read_b64_tr_b16 a[62:63], v240 offset:47376
    s_waitcnt lgkmcnt(0)
    s_waitcnt vmcnt(0)
    ds_write_b128 v245, v[48:51] offset:32768
    ds_write_b128 v245, v[52:55] offset:33792
    ds_write_b128 v245, v[56:59] offset:34816
    ds_write_b128 v245, v[60:63] offset:35840
    ds_write_b128 v245, v[64:67] offset:36864
    ds_write_b128 v245, v[68:71] offset:37888
    ds_write_b128 v245, v[72:75] offset:38912
    ds_write_b128 v245, v[76:79] offset:39936
    ds_write_b128 v245, v[80:83] offset:40960
    ds_write_b128 v245, v[84:87] offset:41984
    ds_write_b128 v245, v[88:91] offset:43008
    ds_write_b128 v245, v[92:95] offset:44032
    ds_write_b128 v245, v[96:99] offset:45056
    ds_write_b128 v245, v[100:103] offset:46080
    ds_write_b128 v245, v[104:107] offset:47104
    ds_write_b128 v245, v[108:111] offset:48128
    s_waitcnt lgkmcnt(0)
    ds_read_b64_tr_b16 a[192:193], v243 offset:32768
    ds_read_b64_tr_b16 a[194:195], v243 offset:33024
    ds_read_b64_tr_b16 a[196:197], v243 offset:34816
    ds_read_b64_tr_b16 a[198:199], v243 offset:35072
    ds_read_b64_tr_b16 a[224:225], v243 offset:32776
    ds_read_b64_tr_b16 a[226:227], v243 offset:33032
    ds_read_b64_tr_b16 a[228:229], v243 offset:34824
    ds_read_b64_tr_b16 a[230:231], v243 offset:35080
    s_waitcnt lgkmcnt(0)
    ds_read_b64_tr_b16 a[200:201], v243 offset:36864
    ds_read_b64_tr_b16 a[202:203], v243 offset:37120
    ds_read_b64_tr_b16 a[204:205], v243 offset:38912
    ds_read_b64_tr_b16 a[206:207], v243 offset:39168
    ds_read_b64_tr_b16 a[232:233], v243 offset:36872
    ds_read_b64_tr_b16 a[234:235], v243 offset:37128
    ds_read_b64_tr_b16 a[236:237], v243 offset:38920
    ds_read_b64_tr_b16 a[238:239], v243 offset:39176
    s_waitcnt lgkmcnt(0)
    ds_read_b64_tr_b16 a[208:209], v243 offset:40960
    ds_read_b64_tr_b16 a[210:211], v243 offset:41216
    ds_read_b64_tr_b16 a[212:213], v243 offset:43008
    ds_read_b64_tr_b16 a[214:215], v243 offset:43264
    ds_read_b64_tr_b16 a[240:241], v243 offset:40968
    ds_read_b64_tr_b16 a[242:243], v243 offset:41224
    ds_read_b64_tr_b16 a[244:245], v243 offset:43016
    ds_read_b64_tr_b16 a[246:247], v243 offset:43272
    s_waitcnt lgkmcnt(0)
    ds_read_b64_tr_b16 a[216:217], v243 offset:45056
    ds_read_b64_tr_b16 a[218:219], v243 offset:45312
    ds_read_b64_tr_b16 a[220:221], v243 offset:47104
    ds_read_b64_tr_b16 a[222:223], v243 offset:47360
    ds_read_b64_tr_b16 a[248:249], v243 offset:45064
    ds_read_b64_tr_b16 a[250:251], v243 offset:45320
    ds_read_b64_tr_b16 a[252:253], v243 offset:47112
    ds_read_b64_tr_b16 a[254:255], v243 offset:47368
    s_waitcnt lgkmcnt(0)
    v_bfe_u32 v249, v0, 1, 1
    v_lshlrev_b32 v249, 4, v249
    v_mov_b32 v250, 0x3f80
    v_lshlrev_b32 v250, v249, v250
    v_bfe_u32 v248, v0, 3, 1
    v_bfe_u32 v249, v0, 4, 1
    v_xor_b32 v249, v249, v248
    v_bfe_u32 v248, v0, 2, 1
    v_lshl_add_u32 v248, v249, 2, v248
    v_and_b32 v249, 1, v0
    v_lshl_add_u32 v248, v249, 1, v248
    v_cmp_eq_u32 vcc, 0, v248
    s_nop 1
    v_cndmask_b32 v252, 0, v250, vcc
    v_cmp_eq_u32 vcc, 1, v248
    s_nop 1
    v_cndmask_b32 v253, 0, v250, vcc
    v_cmp_eq_u32 vcc, 2, v248
    s_nop 1
    v_cndmask_b32 v254, 0, v250, vcc
    v_cmp_eq_u32 vcc, 3, v248
    s_nop 1
    v_cndmask_b32 v255, 0, v250, vcc
    v_mov_b32 v64, 0
    v_mov_b32 v65, 0
    v_mov_b32 v66, 0
    v_mov_b32 v67, 0
    v_mov_b32 v68, 0
    v_mov_b32 v69, 0
    v_mov_b32 v70, 0
    v_mov_b32 v71, 0
    v_mov_b32 v72, 0
    v_mov_b32 v73, 0
    v_mov_b32 v74, 0
    v_mov_b32 v75, 0
    v_mov_b32 v76, 0
    v_mov_b32 v77, 0
    v_mov_b32 v78, 0
    v_mov_b32 v79, 0
    v_mov_b32 v80, 0
    v_mov_b32 v81, 0
    v_mov_b32 v82, 0
    v_mov_b32 v83, 0
    v_mov_b32 v84, 0
    v_mov_b32 v85, 0
    v_mov_b32 v86, 0
    v_mov_b32 v87, 0
    v_mov_b32 v145, 0
    v_mov_b32 v147, 0
    v_mov_b32 v165, 0
    s_bitcmp1_b32 s17, 2
    s_cbranch_scc1 L_cwarme_5
    s_lshr_b32 s20, s17, 3
    s_lshl_b32 s20, s20, 2
    s_and_b32 s21, s17, 3
    s_add_u32 s20, s20, s21
    s_lshl_b32 s21, s16, 4
    s_add_u32 s20, s20, s21
    s_lshl_b32 s20, s20, 12
    v_lshlrev_b32 v34, 4, v0
    s_mov_b32 s12, s82
    s_and_b32 s13, s83, 0xffff
    s_mov_b32 s14, 0x400000
    s_mov_b32 s15, 0x00020000
    s_mov_b32 s56, s64
    s_and_b32 s57, s65, 0xffff
    s_mov_b32 s58, 0x400000
    s_mov_b32 s59, 0x00020000
    buffer_load_dwordx4 v[168:171], v34, s[12:15], s20 offen
    s_add_u32 s20, s20, 0x40000
    buffer_load_dwordx4 v[168:171], v34, s[12:15], s20 offen
    s_add_u32 s20, s20, 0x40000
    buffer_load_dwordx4 v[168:171], v34, s[12:15], s20 offen
    s_add_u32 s20, s20, 0x40000
    buffer_load_dwordx4 v[168:171], v34, s[12:15], s20 offen
    s_add_u32 s20, s20, 0x40000
    buffer_load_dwordx4 v[168:171], v34, s[12:15], s20 offen
    s_add_u32 s20, s20, 0x40000
    buffer_load_dwordx4 v[168:171], v34, s[12:15], s20 offen
    s_add_u32 s20, s20, 0x40000
    buffer_load_dwordx4 v[168:171], v34, s[12:15], s20 offen
    s_add_u32 s20, s20, 0x40000
    buffer_load_dwordx4 v[168:171], v34, s[12:15], s20 offen
    s_add_u32 s20, s20, 0x40000
    buffer_load_dwordx4 v[168:171], v34, s[12:15], s20 offen
    s_add_u32 s20, s20, 0x40000
    buffer_load_dwordx4 v[168:171], v34, s[12:15], s20 offen
    s_add_u32 s20, s20, 0x40000
    buffer_load_dwordx4 v[168:171], v34, s[12:15], s20 offen
    s_add_u32 s20, s20, 0x40000
    buffer_load_dwordx4 v[168:171], v34, s[12:15], s20 offen
    s_add_u32 s20, s20, 0x40000
    buffer_load_dwordx4 v[168:171], v34, s[12:15], s20 offen
    s_add_u32 s20, s20, 0x40000
    buffer_load_dwordx4 v[168:171], v34, s[12:15], s20 offen
    s_add_u32 s20, s20, 0x40000
    buffer_load_dwordx4 v[168:171], v34, s[12:15], s20 offen
    s_add_u32 s20, s20, 0x40000
    buffer_load_dwordx4 v[168:171], v34, s[12:15], s20 offen
    s_add_u32 s20, s20, 0x40000
L_cwarme_5:
    s_mov_b32 s12, s84
    s_and_b32 s13, s85, 0xffff
    s_mov_b32 s14, 0x4000
    s_mov_b32 s15, 0x00020000
    buffer_load_dwordx2 v[168:169], v33, s[12:15], 0 offen
    s_waitcnt vmcnt(0)
    s_mov_b32 s12, s98
    s_and_b32 s13, s99, 0xffff
    s_mov_b32 s14, 0x100
    s_mov_b32 s15, 0x00020000
    s_mov_b32 s19, 0
    s_mov_b32 s53, 1
    s_mov_b32 s43, 24576
    s_add_u32 s54, s100, 0x5900000
    s_addc_u32 s55, s101, 0
    v_mov_b32 v34, 0
L_dw_6:
    buffer_load_dword v35, v34, s[12:15], 0 offen sc1
    s_add_u32 s33, s33, 1
    s_cmp_gt_u32 s33, 0x100000
    s_waitcnt vmcnt(0)
    s_cbranch_scc1 chain_kernel_abort
    v_readfirstlane_b32 s20, v35
    s_and_b32 s22, s20, 0xffff
    s_cmp_ge_u32 s22, 256
    s_cbranch_scc1 L_dwok_7
    s_sleep 2
    s_branch L_dw_6
L_dwok_7:
    s_lshr_b32 s21, s20, 16
    s_cmp_gt_u32 s21, 16
    s_cselect_b32 s21, 0x2000, 0x0
    s_add_u32 s35, s100, 0x1fffff
    s_and_b32 s35, s35, 0xffe00000
    s_sub_u32 s52, s35, s100
    s_add_u32 s35, s52, s21
    s_xor_b32 s21, s21, 0x2000
    s_add_u32 s52, s52, s21
    s_mov_b32 s31, s35
    s_cmp_lg_u32 s18, 3
    s_cbranch_scc1 L_init3_8
    s_lshl_b32 s21, s19, 7
    s_add_u32 s21, s21, 0x5900000
    v_mov_b32 v34, 0
L_dw_9:
    buffer_load_dword v35, v34, s[8:11], s21 offen sc1
    s_add_u32 s33, s33, 1
    s_cmp_gt_u32 s33, 0x100000
    s_waitcnt vmcnt(0)
    s_cbranch_scc1 chain_kernel_abort
    v_readfirstlane_b32 s20, v35
    s_cmp_ge_u32 s20, 64
    s_cbranch_scc1 L_dwok_10
    s_sleep 2
    s_branch L_dw_9
L_dwok_10:
    s_add_u32 m0, s43, 0
    s_nop 0
    buffer_load_dwordx4 v27, s[8:11], s31 offen offset:0 lds
    s_add_u32 m0, s43, 896
    s_nop 0
    buffer_load_dwordx4 v27, s[8:11], s31 offen offset:128 lds
    s_add_u32 m0, s43, 0
    s_nop 0
    buffer_load_dwordx4 v29, s[8:11], s31 offen offset:2048 lds
    s_add_u32 m0, s43, 960
    s_nop 0
    buffer_load_dwordx4 v29, s[8:11], s31 offen offset:2112 lds
    s_xor_b32 s43, s43, 4096
    s_waitcnt vmcnt(0)
L_init3_8:
    s_and_b32 s20, s19, 3
    s_lshl_b32 s21, s20, 16
    s_add_u32 s38, s36, s21
    s_add_u32 s41, s38, 0x140000
    s_lshl_b32 s21, s20, 18
    s_add_u32 s40, s37, s21
    s_add_u32 s42, s31, 0x8000000
    s_add_u32 s21, s19, 1
    s_bitcmp1_b32 s21, 1
    s_cselect_b32 s31, s52, s35
    s_lshl_b32 s21, s21, 20
    s_add_u32 s31, s31, s21
    s_add_u32 s20, s20, 1
    s_and_b32 s20, s20, 3
    s_lshl_b32 s20, s20, 16
    s_add_u32 s39, s36, s20
    s_cmp_lg_u32 s18, 0
    s_cbranch_scc1 L_init_11
    v_cmp_eq_u32 vcc, s34, v168
    s_nop 1
    v_cndmask_b32 v168, v168, -1, vcc
    v_cmp_eq_u32 vcc, s34, v169
    s_nop 1
    v_cndmask_b32 v169, v169, -1, vcc
    buffer_store_dwordx2 v[168:169], v8, s[8:11], s38 offen
    s_xor_b32 s43, s43, 4096
    s_setprio 3
L_init_11:
    s_barrier
L_step_12:
    s_nop 15
    s_nop 7
L_step_12_nd:
    buffer_load_dwordx4 v[48:51], v2, s[8:11], s38 offen sc1
    v_mov_b32 v88, 0
    v_mov_b32 v89, 0
    v_mov_b32 v90, 0
    v_mov_b32 v91, 0
    v_mov_b32 v92, 0
    v_mov_b32 v93, 0
    v_mov_b32 v94, 0
    v_mov_b32 v95, 0
    ds_read_b128 v[116:119], v25
    ds_read_b128 v[120:123], v25 offset:1024
    v_xor_b32 v25, 0x1000, v25
    s_nop 0
    buffer_load_dwordx4 v[52:55], v3, s[8:11], s38 offen sc1
    s_nop 11
    buffer_load_dwordx4 v[56:59], v4, s[8:11], s38 offen sc1
    s_nop 11
    buffer_load_dwordx4 v[60:63], v5, s[8:11], s38 offen sc1
    s_waitcnt vmcnt(3)
    v_max3_u32 v7, v48, v49, v50
    v_max_u32 v7, v7, v51
    v_cmp_eq_u32 vcc, s34, v7
    s_cbranch_vccnz L_q_a_19
L_v_a_20:
    v_smfmac_f32_16x16x64_bf16 v[64:67], v[48:51], a[0:7], v6
    s_waitcnt vmcnt(2)
    v_max3_u32 v7, v52, v53, v54
    v_max_u32 v7, v7, v55
    v_smfmac_f32_16x16x64_bf16 v[68:71], v[48:51], a[64:71], v6
    v_cmp_eq_u32 vcc, s34, v7
    v_smfmac_f32_16x16x64_bf16 v[72:75], v[48:51], a[32:39], v6
    v_smfmac_f32_16x16x64_bf16 v[76:79], v[48:51], a[96:103], v6
    s_cbranch_vccnz L_q_a_21
L_v_a_22:
    v_smfmac_f32_16x16x64_bf16 v[64:67], v[52:55], a[8:15], v6
    s_waitcnt vmcnt(1)
    v_max3_u32 v7, v56, v57, v58
    v_max_u32 v7, v7, v59
    v_smfmac_f32_16x16x64_bf16 v[68:71], v[52:55], a[72:79], v6
    v_cmp_eq_u32 vcc, s34, v7
    v_smfmac_f32_16x16x64_bf16 v[72:75], v[52:55], a[40:47], v6
    v_smfmac_f32_16x16x64_bf16 v[76:79], v[52:55], a[104:111], v6
    s_cbranch_vccnz L_q_a_23
L_v_a_24:
    v_smfmac_f32_16x16x64_bf16 v[64:67], v[56:59], a[16:23], v6
    s_waitcnt vmcnt(0)
    v_max3_u32 v7, v60, v61, v62
    v_max_u32 v7, v7, v63
    v_smfmac_f32_16x16x64_bf16 v[68:71], v[56:59], a[80:87], v6
    v_cmp_eq_u32 vcc, s34, v7
    v_smfmac_f32_16x16x64_bf16 v[72:75], v[56:59], a[48:55], v6
    v_smfmac_f32_16x16x64_bf16 v[76:79], v[56:59], a[112:119], v6
    s_cbranch_vccnz L_q_a_25
L_v_a_26:
    v_smfmac_f32_16x16x64_bf16 v[64:67], v[60:63], a[24:31], v6
    v_smfmac_f32_16x16x64_bf16 v[68:71], v[60:63], a[88:95], v6
    v_smfmac_f32_16x16x64_bf16 v[72:75], v[60:63], a[56:63], v6
    v_smfmac_f32_16x16x64_bf16 v[76:79], v[60:63], a[120:127], v6
L_gd_a_18:
    v_cvt_pk_bf16_f32 v96, v64, v65
    v_cvt_pk_bf16_f32 v97, v66, v67
    v_cvt_pk_bf16_f32 v98, v68, v69
    v_cvt_pk_bf16_f32 v99, v70, v71
    s_cmp_lg_u32 s18, 0
    v_cvt_pk_bf16_f32 v100, v72, v73
    v_mfma_f32_16x16x32_bf16 v[104:107], v[96:99], v[40:43], 0
    v_cvt_pk_bf16_f32 v101, v74, v75
    v_cvt_pk_bf16_f32 v102, v76, v77
    v_cvt_pk_bf16_f32 v103, v78, v79
    s_nop 1
    v_mfma_f32_16x16x32_bf16 v[108:111], v[100:103], v[40:43], 0
    s_cbranch_scc0 L_help1_13_w0
    s_nop 0
    ds_write_b128 v20, v[104:107]
    s_nop 4
    ds_write_b128 v20, v[108:111] offset:1024
    s_waitcnt lgkmcnt(0)
    s_barrier
    v_smfmac_f32_16x16x64_bf16 v[80:83], v[48:51], a[128:135], v6
    v_smfmac_f32_16x16x64_bf16 v[84:87], v[48:51], a[160:167], v6
    v_smfmac_f32_16x16x64_bf16 v[80:83], v[52:55], a[136:143], v6
    v_smfmac_f32_16x16x64_bf16 v[84:87], v[52:55], a[168:175], v6
    v_smfmac_f32_16x16x64_bf16 v[80:83], v[56:59], a[144:151], v6
    v_smfmac_f32_16x16x64_bf16 v[84:87], v[56:59], a[176:183], v6
    v_smfmac_f32_16x16x64_bf16 v[80:83], v[60:63], a[152:159], v6
    v_smfmac_f32_16x16x64_bf16 v[84:87], v[60:63], a[184:191], v6
    s_nop 4
    ds_write_b128 v21, v[80:83]
    s_nop 1
    ds_write_b128 v21, v[84:87] offset:512
    s_waitcnt lgkmcnt(0)
L_bar2b_111_2:
    s_barrier
    s_cmp_eq_u32 s18, 1
    s_cbranch_scc1 L_vred_110
L_bar2b_111:
    s_waitcnt lgkmcnt(0)
    s_barrier
    s_cmp_lg_u32 s18, 2
    s_cbranch_scc1 L_poe_112
    s_sub_u32 s20, s19, 1
    s_and_b32 s20, s20, 3
    s_lshl_b32 s21, s20, 16
    s_add_u32 s21, s21, s36
    s_add_u32 s22, s21, 0x140000
    s_lshl_b32 s23, s20, 18
    s_add_u32 s23, s23, s37
    buffer_store_dwordx2 v[36:37], v8, s[8:11], s21 offen
    buffer_store_dwordx2 v[36:37], v28, s[8:11], s22 offen
    buffer_store_dwordx4 v[36:39], v9, s[8:11], s23 offen
    s_mov_b64 exec, s[28:29]
    buffer_store_dwordx4 v[36:39], v10, s[8:11], s23 offen
    s_mov_b64 exec, -1
L_poe_112:
    s_cmp_lg_u32 s18, 3
    s_cbranch_scc1 L_bar3_14
    s_cmp_ge_u32 s19, 2
    s_cbranch_scc1 L_gated_113
    s_add_u32 s23, s19, 1
    s_lshl_b32 s21, s23, 7
    s_add_u32 s21, s21, 0x5900000
    v_mov_b32 v34, 0
L_dw_114:
    buffer_load_dword v35, v34, s[8:11], s21 offen sc1
    s_add_u32 s33, s33, 1
    s_cmp_gt_u32 s33, 0x100000
    s_waitcnt vmcnt(0)
    s_cbranch_scc1 chain_kernel_abort
    v_readfirstlane_b32 s20, v35
    s_cmp_ge_u32 s20, 64
    s_cbranch_scc1 L_dwok_115
    s_sleep 2
    s_branch L_dw_114
L_dwok_115:
L_gated_113:
    s_add_u32 m0, s43, 0
    s_nop 0
    buffer_load_dwordx4 v27, s[8:11], s31 offen offset:0 lds
    s_add_u32 m0, s43, 896
    s_nop 0
    buffer_load_dwordx4 v27, s[8:11], s31 offen offset:128 lds
    s_add_u32 m0, s43, 0
    s_nop 0
    buffer_load_dwordx4 v29, s[8:11], s31 offen offset:2048 lds
    s_add_u32 m0, s43, 960
    s_nop 0
    buffer_load_dwordx4 v29, s[8:11], s31 offen offset:2112 lds
    s_xor_b32 s43, s43, 4096
    s_branch L_bar3_14
L_vred_110:
    ds_read_b64 v[168:169], v22 offset:0
    ds_read_b64 v[170:171], v22 offset:512
    ds_read_b64 v[172:173], v22 offset:1024
    ds_read_b64 v[174:175], v22 offset:1536
    ds_read_b64 v[176:177], v22 offset:2048
    ds_read_b64 v[178:179], v22 offset:2560
    ds_read_b64 v[180:181], v22 offset:3072
    ds_read_b64 v[182:183], v22 offset:3584
    ds_read_b64 v[184:185], v22 offset:4096
    ds_read_b64 v[186:187], v22 offset:4608
    ds_read_b64 v[188:189], v22 offset:5120
    ds_read_b64 v[190:191], v22 offset:5632
    ds_read_b64 v[192:193], v22 offset:6144
    ds_read_b64 v[194:195], v22 offset:6656
    ds_read_b64 v[196:197], v22 offset:7168
    s_waitcnt lgkmcnt(11)
    ds_read_b64 v[198:199], v22 offset:7680
    s_waitcnt lgkmcnt(8)
    v_pk_add_f32 v[168:169], v[168:169], v[172:173]
    v_pk_add_f32 v[170:171], v[170:171], v[174:175]
    v_pk_add_f32 v[176:177], v[176:177], v[180:181]
    v_pk_add_f32 v[178:179], v[178:179], v[182:183]
    v_pk_add_f32 v[168:169], v[168:169], v[176:177]
    v_pk_add_f32 v[170:171], v[170:171], v[178:179]
    s_waitcnt lgkmcnt(0)
    v_pk_add_f32 v[184:185], v[184:185], v[188:189]
    v_pk_add_f32 v[186:187], v[186:187], v[190:191]
    v_pk_add_f32 v[192:193], v[192:193], v[196:197]
    v_pk_add_f32 v[194:195], v[194:195], v[198:199]
    v_pk_add_f32 v[168:169], v[168:169], v[184:185]
    v_pk_add_f32 v[170:171], v[170:171], v[186:187]
    v_pk_add_f32 v[168:169], v[168:169], v[192:193]
    v_pk_add_f32 v[170:171], v[170:171], v[194:195]
    v_cvt_pk_bf16_f32 v144, v168, v169
    v_cvt_pk_bf16_f32 v146, v170, v171
    ds_write2_b32 v32, v144, v146 offset0:0 offset1:16
    s_branch L_bar2b_111
L_help1_13_w0:
    v_smfmac_f32_16x16x64_bf16 v[80:83], v[48:51], a[128:135], v6
    v_smfmac_f32_16x16x64_bf16 v[84:87], v[48:51], a[160:167], v6
    v_smfmac_f32_16x16x64_bf16 v[80:83], v[52:55], a[136:143], v6
    v_smfmac_f32_16x16x64_bf16 v[84:87], v[52:55], a[168:175], v6
    v_smfmac_f32_16x16x64_bf16 v[80:83], v[56:59], a[144:151], v6
    v_smfmac_f32_16x16x64_bf16 v[84:87], v[56:59], a[176:183], v6
    v_smfmac_f32_16x16x64_bf16 v[80:83], v[60:63], a[152:159], v6
    v_smfmac_f32_16x16x64_bf16 v[84:87], v[60:63], a[184:191], v6
    s_nop 4
    ds_write_b128 v21, v[80:83]
    s_nop 1
    ds_write_b128 v21, v[84:87] offset:512
    s_barrier
    ds_read_b128 v[168:171], v1 offset:2048
    ds_read_b128 v[172:175], v1 offset:3072
    ds_read_b128 v[176:179], v1 offset:4096
    ds_read_b128 v[180:183], v1 offset:5120
    ds_read_b128 v[184:187], v1 offset:6144
    ds_read_b128 v[188:191], v1 offset:7168
    s_waitcnt lgkmcnt(4)
    v_pk_add_f32 v[104:105], v[104:105], v[168:169]
    v_pk_add_f32 v[106:107], v[106:107], v[170:171]
    v_pk_add_f32 v[108:109], v[108:109], v[172:173]
    v_pk_add_f32 v[110:111], v[110:111], v[174:175]
    s_waitcnt lgkmcnt(2)
    v_pk_add_f32 v[104:105], v[104:105], v[176:177]
    v_pk_add_f32 v[106:107], v[106:107], v[178:179]
    v_pk_add_f32 v[108:109], v[108:109], v[180:181]
    v_pk_add_f32 v[110:111], v[110:111], v[182:183]
    s_waitcnt lgkmcnt(0)
    v_pk_add_f32 v[104:105], v[104:105], v[184:185]
    v_pk_add_f32 v[106:107], v[106:107], v[186:187]
    v_pk_add_f32 v[108:109], v[108:109], v[188:189]
    v_pk_add_f32 v[110:111], v[110:111], v[190:191]
    v_cvt_pk_bf16_f32 v112, v104, v105
    v_cvt_pk_bf16_f32 v113, v106, v107
    v_cvt_pk_bf16_f32 v114, v108, v109
    v_cvt_pk_bf16_f32 v115, v110, v111
    s_mov_b64 exec, s[28:29]
    s_nop 0
    v_mfma_f32_16x16x32_bf16 v[132:135], v[112:115], v[112:115], 0
    v_mfma_f32_16x16x32_bf16 v[124:127], v[116:119], v[112:115], 0
    v_mfma_f32_16x16x32_bf16 v[128:131], v[120:123], v[112:115], 0
    s_nop 3
    buffer_store_dwordx4 v[132:135], v10, s[8:11], s40 offen
    s_mov_b64 exec, s[24:25]
    buffer_store_dwordx4 v[124:127], v9, s[8:11], s40 offen
    s_nop 0
    buffer_store_dwordx4 v[128:131], v9, s[8:11], s40 offen offset:128
    s_mov_b64 exec, -1
    ds_write_b128 v1, v[112:115] offset:32768
    ds_read_b128 v[136:139], v26 offset:0
    ds_read_b128 v[140:143], v26 offset:1024
    v_mov_b32_dpp v124, v128 row_shr:8 row_mask:0xf bank_mask:0xc
    v_mov_b32_dpp v125, v129 row_shr:8 row_mask:0xf bank_mask:0xc
    v_mov_b32_dpp v126, v130 row_shr:8 row_mask:0xf bank_mask:0xc
    v_mov_b32_dpp v127, v131 row_shr:8 row_mask:0xf bank_mask:0xc
    v_xor_b32 v26, 0x1000, v26
    s_cmp_eq_u32 s19, 63
    s_cbranch_scc1 L_bar2b_111_2
    s_nop 11
    buffer_load_dwordx4 v[200:203], v16, s[8:11], s40 offen sc1
    buffer_load_dwordx4 v[204:207], v13, s[8:11], s40 offen sc1
    buffer_load_dwordx4 v[208:211], v14, s[8:11], s40 offen sc1
    buffer_load_dwordx4 v[212:215], v15, s[8:11], s40 offen sc1
    s_barrier
    s_nop 15
    s_nop 7
    buffer_load_dwordx4 v[216:219], v16, s[8:11], s40 offen sc1
    buffer_load_dwordx4 v[220:223], v13, s[8:11], s40 offen sc1
    buffer_load_dwordx4 v[224:227], v14, s[8:11], s40 offen sc1
    buffer_load_dwordx4 v[228:231], v15, s[8:11], s40 offen sc1
    s_waitcnt vmcnt(7)
    v_permlane32_swap_b32 v200, v202
    v_permlane32_swap_b32 v201, v203
    s_waitcnt vmcnt(6)
    v_pk_add_f32 v[154:155], v[200:201], v[202:203]
    v_pk_add_f32 v[148:149], v[124:125], v[204:205]
    v_pk_add_f32 v[150:151], v[126:127], v[206:207]
    v_permlane16_swap_b32 v154, v155
    s_waitcnt vmcnt(5)
    v_pk_add_f32 v[148:149], v[148:149], v[208:209]
    v_pk_add_f32 v[150:151], v[150:151], v[210:211]
    v_add_f32 v152, v154, v155
    s_waitcnt vmcnt(4)
    v_pk_add_f32 v[148:149], v[148:149], v[212:213]
    v_pk_add_f32 v[150:151], v[150:151], v[214:215]
    v_pk_add_f32 v[154:155], v[148:149], v[150:151]
    v_add_f32 v154, v154, v152
    v_cmp_u_f32 vcc, v154, v155
    v_cvt_pk_bf16_f32 v160, 0, v148
    v_cvt_pk_bf16_f32 v161, 0, v149
    v_cvt_pk_bf16_f32 v162, 0, v150
    v_cvt_pk_bf16_f32 v163, 0, v151
    v_cvt_pk_bf16_f32 v176, 0, v152
    s_cbranch_vccnz L_cf_117
L_chead_119:
    s_waitcnt lgkmcnt(0)
    s_barrier
    ds_read_b32 v144, v32
    ds_read_b32 v146, v32 offset:64
    v_pk_mul_f32 v[148:149], v[160:161], s[46:47]
    v_pk_mul_f32 v[150:151], v[162:163], s[46:47]
    v_mul_f32 v152, s46, v176
    v_cvt_pk_bf16_f32 v148, 0, v148
    v_cvt_pk_bf16_f32 v149, 0, v149
    v_cvt_pk_bf16_f32 v150, 0, v150
    v_cvt_pk_bf16_f32 v151, 0, v151
    v_cvt_pk_bf16_f32 v152, 0, v152
    v_max3_f32 v154, v148, v149, v150
    v_max3_f32 v154, v154, v151, v152
    s_nop 1
    v_max_f32_dpp v154, v154, v154 row_ror:8 row_mask:0xf bank_mask:0xf
    v_mov_b32 v156, v154
    s_nop 1
    v_permlane16_swap_b32 v154, v156
    v_max_f32 v154, v154, v156
    v_mov_b32 v156, v154
    s_nop 1
    v_permlane32_swap_b32 v154, v156
    v_max_f32 v154, v154, v156
    v_mul_f32 v154, s44, v154
    v_fma_f32 v152, v152, s44, -v154
    v_exp_f32 v152, v152
    v_pk_fma_f32 v[148:149], v[148:149], s[44:45], v[154:155] op_sel_hi:[1,1,0] neg_lo:[0,0,1] neg_hi:[0,0,1]
    v_pk_fma_f32 v[150:151], v[150:151], s[44:45], v[154:155] op_sel_hi:[1,1,0] neg_lo:[0,0,1] neg_hi:[0,0,1]
    v_mov_b32_dpp v156, v152 row_ror:8 row_mask:0xf bank_mask:0xf
    v_exp_f32 v148, v148
    v_cvt_pk_bf16_f32 v164, v152, v156
    v_exp_f32 v149, v149
    v_exp_f32 v150, v150
    v_mfma_f32_16x16x16_bf16 v[176:179], v[44:45], v[164:165], 0
    v_exp_f32 v151, v151
    s_waitcnt lgkmcnt(0)
    v_cvt_pk_bf16_f32 v160, v148, v149
    v_mfma_f32_16x16x16_bf16 v[168:171], v[144:145], v[164:165], 0
    v_cvt_pk_bf16_f32 v161, v150, v151
    v_mov_b32_dpp v162, v160 row_ror:8 row_mask:0xf bank_mask:0xf
    v_mfma_f32_16x16x16_bf16 v[172:175], v[146:147], v[164:165], 0
    v_mov_b32_dpp v163, v161 row_ror:8 row_mask:0xf bank_mask:0xf
    s_nop 0
    s_mov_b64 exec, s[24:25]
    v_mfma_f32_16x16x32_bf16 v[176:179], v[44:47], v[160:163], v[176:179]
    v_mfma_f32_16x16x32_bf16 v[168:171], v[136:139], v[160:163], v[168:171]
    v_mfma_f32_16x16x32_bf16 v[172:175], v[140:143], v[160:163], v[172:175]
    s_nop 3
    v_rcp_f32 v176, v176
    s_nop 0
    v_pk_mul_f32 v[168:169], v[168:169], v[176:177] op_sel_hi:[1,0]
    v_pk_mul_f32 v[170:171], v[170:171], v[176:177] op_sel_hi:[1,0]
    v_pk_mul_f32 v[172:173], v[172:173], v[176:177] op_sel_hi:[1,0]
    v_pk_mul_f32 v[174:175], v[174:175], v[176:177] op_sel_hi:[1,0]
    v_cvt_pk_bf16_f32 v180, v168, v169
    v_cvt_pk_bf16_f32 v181, v170, v171
    v_cvt_pk_bf16_f32 v182, v172, v173
    v_cvt_pk_bf16_f32 v183, v174, v175
    buffer_store_dwordx4 v[180:183], v11, s[8:11], s41 offen
    s_mov_b64 exec, -1
    s_barrier
    s_nop 15
    s_nop 3
    s_branch L_bar3_14_e
L_bar3_14:
    s_waitcnt lgkmcnt(0)
    s_barrier
    s_cmp_eq_u32 s19, 63
    s_cbranch_scc1 L_fin_17
    s_nop 15
    s_nop 3
L_bar3_14_e:
    buffer_load_dwordx4 v[48:51], v2, s[8:11], s41 offen sc1
    v_mov_b32 v64, 0
    v_mov_b32 v65, 0
    v_mov_b32 v66, 0
    v_mov_b32 v67, 0
    v_mov_b32 v68, 0
    v_mov_b32 v69, 0
    v_mov_b32 v70, 0
    v_mov_b32 v71, 0
    v_mov_b32 v72, 0
    v_mov_b32 v73, 0
    v_mov_b32 v74, 0
    v_mov_b32 v75, 0
    buffer_load_dwordx4 v[52:55], v3, s[8:11], s41 offen sc1
    v_mov_b32 v76, 0
    v_mov_b32 v77, 0
    v_mov_b32 v78, 0
    v_mov_b32 v79, 0
    v_mov_b32 v80, 0
    v_mov_b32 v81, 0
    v_mov_b32 v82, 0
    v_mov_b32 v83, 0
    v_mov_b32 v84, 0
    v_mov_b32 v85, 0
    v_mov_b32 v86, 0
    v_mov_b32 v87, 0
    buffer_load_dwordx4 v[56:59], v4, s[8:11], s41 offen sc1
    s_nop 11
    buffer_load_dwordx4 v[60:63], v5, s[8:11], s41 offen sc1
    s_waitcnt vmcnt(3)
    v_max3_u32 v7, v48, v49, v50
    v_max_u32 v7, v7, v51
    v_cmp_eq_u32 vcc, s34, v7
    s_cbranch_vccnz L_q_e_121
L_v_e_122:
    v_smfmac_f32_16x16x64_bf16 v[88:91], v[48:51], a[192:199], v6
    s_waitcnt vmcnt(2)
    v_max3_u32 v7, v52, v53, v54
    v_max_u32 v7, v7, v55
    v_cmp_eq_u32 vcc, s34, v7
    v_smfmac_f32_16x16x64_bf16 v[92:95], v[48:51], a[224:231], v6
    s_cbranch_vccnz L_q_e_123
L_v_e_124:
    v_smfmac_f32_16x16x64_bf16 v[88:91], v[52:55], a[200:207], v6
    s_waitcnt vmcnt(1)
    v_max3_u32 v7, v56, v57, v58
    v_max_u32 v7, v7, v59
    v_cmp_eq_u32 vcc, s34, v7
    v_smfmac_f32_16x16x64_bf16 v[92:95], v[52:55], a[232:239], v6
    s_cbranch_vccnz L_q_e_125
L_v_e_126:
    v_smfmac_f32_16x16x64_bf16 v[88:91], v[56:59], a[208:215], v6
    s_waitcnt vmcnt(0)
    v_max3_u32 v7, v60, v61, v62
    v_max_u32 v7, v7, v63
    v_cmp_eq_u32 vcc, s34, v7
    v_smfmac_f32_16x16x64_bf16 v[92:95], v[56:59], a[240:247], v6
    s_cbranch_vccnz L_q_e_127
L_v_e_128:
    v_smfmac_f32_16x16x64_bf16 v[88:91], v[60:63], a[216:223], v6
    v_smfmac_f32_16x16x64_bf16 v[92:95], v[60:63], a[248:255], v6
L_gd_e_120:
    s_add_u32 s19, s19, 1
    s_cmp_lg_u32 s18, 0
    s_nop 2
    v_cvt_pk_bf16_f32 v96, v88, v89
    v_cvt_pk_bf16_f32 v97, v90, v91
    s_nop 0
    v_cvt_pk_bf16_f32 v98, v92, v93
    v_cvt_pk_bf16_f32 v99, v94, v95
    s_nop 1
    v_mfma_f32_16x16x32_bf16 v[104:107], v[96:99], v[252:255], 0
    s_cbranch_scc1 L_help2_15
    s_barrier
    ds_read_b128 v[172:175], v1 offset:18432
    ds_read_b128 v[176:179], v1 offset:20480
    ds_read_b128 v[180:183], v1 offset:22528
    s_waitcnt lgkmcnt(2)
    v_pk_add_f32 v[168:169], v[104:105], v[172:173]
    v_pk_add_f32 v[170:171], v[106:107], v[174:175]
    s_waitcnt lgkmcnt(1)
    v_pk_add_f32 v[168:169], v[168:169], v[176:177]
    v_pk_add_f32 v[170:171], v[170:171], v[178:179]
    s_waitcnt lgkmcnt(0)
    v_pk_add_f32 v[168:169], v[168:169], v[180:181]
    v_pk_add_f32 v[170:171], v[170:171], v[182:183]
    v_cvt_pk_bf16_f32 v96, v168, v169
    v_cvt_pk_bf16_f32 v97, v170, v171
    buffer_store_dwordx2 v[96:97], v12, s[8:11], s42 offen offset:0 sc1
    buffer_store_dwordx2 v[96:97], v12, s[8:11], s42 offen offset:512 sc1
    s_mov_b32 s22, s42
    s_mov_b32 s23, s39
    s_and_b32 s20, s19, 3
    s_lshl_b32 s21, s20, 16
    s_add_u32 s38, s36, s21
    s_add_u32 s41, s38, 0x140000
    s_lshl_b32 s21, s20, 18
    s_add_u32 s40, s37, s21
    s_add_u32 s42, s31, 0x8000000
    s_add_u32 s21, s19, 1
    s_bitcmp1_b32 s21, 1
    s_cselect_b32 s31, s52, s35
    s_lshl_b32 s21, s21, 20
    s_add_u32 s31, s31, s21
    s_add_u32 s20, s20, 1
    s_and_b32 s20, s20, 3
    s_lshl_b32 s20, s20, 16
    s_add_u32 s39, s36, s20
    s_nop 15
    s_nop 15
    s_nop 15
    buffer_load_dwordx2 v[200:201], v17, s[8:11], s22 offen offset:0 sc1
    buffer_load_dwordx2 v[202:203], v18, s[8:11], s22 offen offset:0 sc1
    buffer_load_dwordx2 v[204:205], v19, s[8:11], s22 offen offset:0 sc1
    s_nop 15
    s_nop 15
    s_nop 15
    s_nop 11
    buffer_load_dwordx2 v[212:213], v17, s[8:11], s22 offen offset:512 sc1
    buffer_load_dwordx2 v[214:215], v18, s[8:11], s22 offen offset:512 sc1
    buffer_load_dwordx2 v[216:217], v19, s[8:11], s22 offen offset:512 sc1
    ds_read_b128 v[172:175], v1 offset:33792
    s_mov_b64 exec, s[26:27]
    s_waitcnt lgkmcnt(1)
    buffer_store_dwordx4 v[112:115], v30, s[8:11], s22 offen offset:3072 sc1
    s_mov_b64 exec, s[48:49]
    s_waitcnt lgkmcnt(0)
    buffer_store_dwordx4 v[172:175], v31, s[8:11], s22 offen offset:3584 sc1
    s_mov_b64 exec, -1
    s_waitcnt vmcnt(7)
    v_lshlrev_b32 v100, 16, v200
    v_and_b32 v101, 0xffff0000, v200
    v_lshlrev_b32 v102, 16, v201
    v_and_b32 v103, 0xffff0000, v201
    v_pk_add_f32 v[148:149], v[168:169], v[100:101]
    v_pk_add_f32 v[150:151], v[170:171], v[102:103]
    s_waitcnt vmcnt(6)
    v_lshlrev_b32 v100, 16, v202
    v_and_b32 v101, 0xffff0000, v202
    v_lshlrev_b32 v102, 16, v203
    v_and_b32 v103, 0xffff0000, v203
    v_pk_add_f32 v[148:149], v[148:149], v[100:101]
    v_pk_add_f32 v[150:151], v[150:151], v[102:103]
    s_waitcnt vmcnt(5)
    v_lshlrev_b32 v100, 16, v204
    v_and_b32 v101, 0xffff0000, v204
    v_lshlrev_b32 v102, 16, v205
    v_and_b32 v103, 0xffff0000, v205
    v_pk_add_f32 v[148:149], v[148:149], v[100:101]
    v_pk_add_f32 v[150:151], v[150:151], v[102:103]
    v_cmp_u_f32 vcc, v148, v150
    v_cvt_pk_bf16_f32 v180, v148, v149
    v_cvt_pk_bf16_f32 v181, v150, v151
    s_cbranch_vccnz L_gf_212
L_gok_213:
    buffer_store_dwordx2 v[180:181], v8, s[8:11], s23 offen
    s_barrier
    s_branch L_step_12
L_help2_15:
    s_nop 2
    ds_write_b128 v20, v[104:107] offset:16384
    s_waitcnt lgkmcnt(0)
    s_barrier
    s_and_b32 s20, s19, 3
    s_lshl_b32 s21, s20, 16
    s_add_u32 s38, s36, s21
    s_add_u32 s41, s38, 0x140000
    s_lshl_b32 s21, s20, 18
    s_add_u32 s40, s37, s21
    s_add_u32 s42, s31, 0x8000000
    s_add_u32 s21, s19, 1
    s_bitcmp1_b32 s21, 1
    s_cselect_b32 s31, s52, s35
    s_lshl_b32 s21, s21, 20
    s_add_u32 s31, s31, s21
    s_add_u32 s20, s20, 1
    s_and_b32 s20, s20, 3
    s_lshl_b32 s20, s20, 16
    s_add_u32 s39, s36, s20
    s_cmp_eq_u32 s18, 3
    s_cbranch_scc1 L_w3_216
    s_xor_b32 s20, s18, 2
    s_or_b32 s20, s20, s16
    s_or_b32 s20, s20, s17
    s_cbranch_scc1 L_bar4_16
    s_cmp_lt_u32 s19, 3
    s_cbranch_scc1 L_bar4_16
    s_atomic_add s53, s[98:99], 0x4
    s_branch L_bar4_16
L_w3_216:
    s_or_b32 s20, s16, s17
    s_cbranch_scc1 L_bar4_16
    s_add_u32 s23, s19, 2
    s_min_u32 s23, s23, 63
    s_lshl_b32 s21, s23, 7
    v_mov_b32 v34, 0
L_dw_217:
    s_load_dword s20, s[54:55], s21 glc
    s_add_u32 s33, s33, 1
    s_cmp_gt_u32 s33, 0x100000
    s_waitcnt lgkmcnt(0)
    s_cbranch_scc1 chain_kernel_abort
    s_cmp_ge_u32 s20, 64
    s_cbranch_scc1 L_dwok_218
    s_sleep 2
    s_branch L_dw_217
L_dwok_218:
L_bar4_16:
    s_barrier
    s_branch L_step_12
L_fin_17:
    s_cmp_lg_u32 s18, 2
    s_cbranch_scc1 chain_kernel_done
    ds_read_b128 v[168:171], v1 offset:32768
    ds_read_b128 v[172:175], v1 offset:33792
    s_mov_b64 exec, s[26:27]
    s_waitcnt lgkmcnt(1)
    buffer_store_dwordx4 v[168:171], v30, s[8:11], s42 offen offset:3072 sc1
    s_mov_b64 exec, s[48:49]
    s_waitcnt lgkmcnt(0)
    buffer_store_dwordx4 v[172:175], v31, s[8:11], s42 offen offset:3584 sc1
    s_mov_b64 exec, -1
    s_branch chain_kernel_done
L_q_a_25:
    buffer_load_dwordx4 v[60:63], v5, s[8:11], s38 offen sc1
    s_waitcnt vmcnt(0)
    v_max3_u32 v7, v60, v61, v62
    v_max_u32 v7, v7, v63
    v_cmp_eq_u32 vcc, s34, v7
    s_cbranch_vccnz L_q_a_27
    s_branch L_v_a_26
L_q_a_27:
    buffer_load_dwordx4 v[60:63], v5, s[8:11], s38 offen sc1
    s_waitcnt vmcnt(2)
    v_max3_u32 v7, v60, v61, v62
    v_max_u32 v7, v7, v63
    v_cmp_eq_u32 vcc, s34, v7
    s_cbranch_vccz L_ok_a_28
    s_add_u32 s33, s33, 1
    s_cmp_gt_u32 s33, 0x100000
    s_cbranch_scc0 L_q_a_27
    s_branch chain_kernel_abort
L_ok_a_28:
    v_smfmac_f32_16x16x64_bf16 v[64:67], v[60:63], a[24:31], v6
    v_smfmac_f32_16x16x64_bf16 v[68:71], v[60:63], a[88:95], v6
    v_smfmac_f32_16x16x64_bf16 v[72:75], v[60:63], a[56:63], v6
    v_smfmac_f32_16x16x64_bf16 v[76:79], v[60:63], a[120:127], v6
    s_branch L_gd_a_18
L_q_a_23:
    buffer_load_dwordx4 v[56:59], v4, s[8:11], s38 offen sc1
    s_waitcnt vmcnt(1)
    v_max3_u32 v7, v60, v61, v62
    v_max_u32 v7, v7, v63
    v_cmp_eq_u32 vcc, s34, v7
    s_cbranch_vccnz L_q_a_29
L_v_a_30:
    v_smfmac_f32_16x16x64_bf16 v[64:67], v[60:63], a[24:31], v6
    s_waitcnt vmcnt(0)
    v_max3_u32 v7, v56, v57, v58
    v_max_u32 v7, v7, v59
    v_smfmac_f32_16x16x64_bf16 v[68:71], v[60:63], a[88:95], v6
    v_cmp_eq_u32 vcc, s34, v7
    v_smfmac_f32_16x16x64_bf16 v[72:75], v[60:63], a[56:63], v6
    v_smfmac_f32_16x16x64_bf16 v[76:79], v[60:63], a[120:127], v6
    s_cbranch_vccnz L_q_a_31
L_v_a_32:
    v_smfmac_f32_16x16x64_bf16 v[64:67], v[56:59], a[16:23], v6
    v_smfmac_f32_16x16x64_bf16 v[68:71], v[56:59], a[80:87], v6
    v_smfmac_f32_16x16x64_bf16 v[72:75], v[56:59], a[48:55], v6
    v_smfmac_f32_16x16x64_bf16 v[76:79], v[56:59], a[112:119], v6
    s_branch L_gd_a_18
L_q_a_31:
    buffer_load_dwordx4 v[56:59], v4, s[8:11], s38 offen sc1
    s_waitcnt vmcnt(2)
    v_max3_u32 v7, v56, v57, v58
    v_max_u32 v7, v7, v59
    v_cmp_eq_u32 vcc, s34, v7
    s_cbranch_vccz L_ok_a_33
    s_add_u32 s33, s33, 1
    s_cmp_gt_u32 s33, 0x100000
    s_cbranch_scc0 L_q_a_31
    s_branch chain_kernel_abort
L_ok_a_33:
    v_smfmac_f32_16x16x64_bf16 v[64:67], v[56:59], a[16:23], v6
    v_smfmac_f32_16x16x64_bf16 v[68:71], v[56:59], a[80:87], v6
    v_smfmac_f32_16x16x64_bf16 v[72:75], v[56:59], a[48:55], v6
    v_smfmac_f32_16x16x64_bf16 v[76:79], v[56:59], a[112:119], v6
    s_branch L_gd_a_18
L_q_a_29:
    buffer_load_dwordx4 v[60:63], v5, s[8:11], s38 offen sc1
    s_waitcnt vmcnt(1)
    v_max3_u32 v7, v56, v57, v58
    v_max_u32 v7, v7, v59
    v_cmp_eq_u32 vcc, s34, v7
    s_cbranch_vccnz L_q_a_34
L_v_a_35:
    v_smfmac_f32_16x16x64_bf16 v[64:67], v[56:59], a[16:23], v6
    s_waitcnt vmcnt(0)
    v_max3_u32 v7, v60, v61, v62
    v_max_u32 v7, v7, v63
    v_smfmac_f32_16x16x64_bf16 v[68:71], v[56:59], a[80:87], v6
    v_cmp_eq_u32 vcc, s34, v7
    v_smfmac_f32_16x16x64_bf16 v[72:75], v[56:59], a[48:55], v6
    v_smfmac_f32_16x16x64_bf16 v[76:79], v[56:59], a[112:119], v6
    s_cbranch_vccnz L_q_a_27
    s_branch L_v_a_26
L_q_a_34:
    buffer_load_dwordx4 v[56:59], v4, s[8:11], s38 offen sc1
    s_waitcnt vmcnt(2)
    v_max3_u32 v7, v60, v61, v62
    v_max_u32 v7, v7, v63
    v_cmp_eq_u32 vcc, s34, v7
    s_cbranch_vccz L_ok_a_36
    buffer_load_dwordx4 v[60:63], v5, s[8:11], s38 offen sc1
    s_waitcnt vmcnt(2)
    v_max3_u32 v7, v56, v57, v58
    v_max_u32 v7, v7, v59
    v_cmp_eq_u32 vcc, s34, v7
    s_cbranch_vccz L_ok_a_37
    s_add_u32 s33, s33, 1
    s_cmp_gt_u32 s33, 0x100000
    s_cbranch_scc0 L_q_a_34
    s_branch chain_kernel_abort
L_ok_a_36:
    v_smfmac_f32_16x16x64_bf16 v[64:67], v[60:63], a[24:31], v6
    v_smfmac_f32_16x16x64_bf16 v[68:71], v[60:63], a[88:95], v6
    v_smfmac_f32_16x16x64_bf16 v[72:75], v[60:63], a[56:63], v6
    v_smfmac_f32_16x16x64_bf16 v[76:79], v[60:63], a[120:127], v6
    s_branch L_q_a_31
L_ok_a_37:
    v_smfmac_f32_16x16x64_bf16 v[64:67], v[56:59], a[16:23], v6
    v_smfmac_f32_16x16x64_bf16 v[68:71], v[56:59], a[80:87], v6
    v_smfmac_f32_16x16x64_bf16 v[72:75], v[56:59], a[48:55], v6
    v_smfmac_f32_16x16x64_bf16 v[76:79], v[56:59], a[112:119], v6
    s_branch L_q_a_27
L_q_a_21:
    buffer_load_dwordx4 v[52:55], v3, s[8:11], s38 offen sc1
    s_waitcnt vmcnt(2)
    v_max3_u32 v7, v56, v57, v58
    v_max_u32 v7, v7, v59
    v_cmp_eq_u32 vcc, s34, v7
    s_cbranch_vccnz L_q_a_38
L_v_a_39:
    v_smfmac_f32_16x16x64_bf16 v[64:67], v[56:59], a[16:23], v6
    s_waitcnt vmcnt(1)
    v_max3_u32 v7, v60, v61, v62
    v_max_u32 v7, v7, v63
    v_smfmac_f32_16x16x64_bf16 v[68:71], v[56:59], a[80:87], v6
    v_cmp_eq_u32 vcc, s34, v7
    v_smfmac_f32_16x16x64_bf16 v[72:75], v[56:59], a[48:55], v6
    v_smfmac_f32_16x16x64_bf16 v[76:79], v[56:59], a[112:119], v6
    s_cbranch_vccnz L_q_a_40
L_v_a_41:
    v_smfmac_f32_16x16x64_bf16 v[64:67], v[60:63], a[24:31], v6
    s_waitcnt vmcnt(0)
    v_max3_u32 v7, v52, v53, v54
    v_max_u32 v7, v7, v55
    v_smfmac_f32_16x16x64_bf16 v[68:71], v[60:63], a[88:95], v6
    v_cmp_eq_u32 vcc, s34, v7
    v_smfmac_f32_16x16x64_bf16 v[72:75], v[60:63], a[56:63], v6
    v_smfmac_f32_16x16x64_bf16 v[76:79], v[60:63], a[120:127], v6
    s_cbranch_vccnz L_q_a_42
L_v_a_43:
    v_smfmac_f32_16x16x64_bf16 v[64:67], v[52:55], a[8:15], v6
    v_smfmac_f32_16x16x64_bf16 v[68:71], v[52:55], a[72:79], v6
    v_smfmac_f32_16x16x64_bf16 v[72:75], v[52:55], a[40:47], v6
    v_smfmac_f32_16x16x64_bf16 v[76:79], v[52:55], a[104:111], v6
    s_branch L_gd_a_18
L_q_a_42:
    buffer_load_dwordx4 v[52:55], v3, s[8:11], s38 offen sc1
    s_waitcnt vmcnt(2)
    v_max3_u32 v7, v52, v53, v54
    v_max_u32 v7, v7, v55
    v_cmp_eq_u32 vcc, s34, v7
    s_cbranch_vccz L_ok_a_44
    s_add_u32 s33, s33, 1
    s_cmp_gt_u32 s33, 0x100000
    s_cbranch_scc0 L_q_a_42
    s_branch chain_kernel_abort
L_ok_a_44:
    v_smfmac_f32_16x16x64_bf16 v[64:67], v[52:55], a[8:15], v6
    v_smfmac_f32_16x16x64_bf16 v[68:71], v[52:55], a[72:79], v6
    v_smfmac_f32_16x16x64_bf16 v[72:75], v[52:55], a[40:47], v6
    v_smfmac_f32_16x16x64_bf16 v[76:79], v[52:55], a[104:111], v6
    s_branch L_gd_a_18
L_q_a_40:
    buffer_load_dwordx4 v[60:63], v5, s[8:11], s38 offen sc1
    s_waitcnt vmcnt(1)
    v_max3_u32 v7, v52, v53, v54
    v_max_u32 v7, v7, v55
    v_cmp_eq_u32 vcc, s34, v7
    s_cbranch_vccnz L_q_a_45
L_v_a_46:
    v_smfmac_f32_16x16x64_bf16 v[64:67], v[52:55], a[8:15], v6
    s_waitcnt vmcnt(0)
    v_max3_u32 v7, v60, v61, v62
    v_max_u32 v7, v7, v63
    v_smfmac_f32_16x16x64_bf16 v[68:71], v[52:55], a[72:79], v6
    v_cmp_eq_u32 vcc, s34, v7
    v_smfmac_f32_16x16x64_bf16 v[72:75], v[52:55], a[40:47], v6
    v_smfmac_f32_16x16x64_bf16 v[76:79], v[52:55], a[104:111], v6
    s_cbranch_vccnz L_q_a_27
    s_branch L_v_a_26
L_q_a_45:
    buffer_load_dwordx4 v[52:55], v3, s[8:11], s38 offen sc1
    s_waitcnt vmcnt(2)
    v_max3_u32 v7, v60, v61, v62
    v_max_u32 v7, v7, v63
    v_cmp_eq_u32 vcc, s34, v7
    s_cbranch_vccz L_ok_a_47
    buffer_load_dwordx4 v[60:63], v5, s[8:11], s38 offen sc1
    s_waitcnt vmcnt(2)
    v_max3_u32 v7, v52, v53, v54
    v_max_u32 v7, v7, v55
    v_cmp_eq_u32 vcc, s34, v7
    s_cbranch_vccz L_ok_a_48
    s_add_u32 s33, s33, 1
    s_cmp_gt_u32 s33, 0x100000
    s_cbranch_scc0 L_q_a_45
    s_branch chain_kernel_abort
L_ok_a_47:
    v_smfmac_f32_16x16x64_bf16 v[64:67], v[60:63], a[24:31], v6
    v_smfmac_f32_16x16x64_bf16 v[68:71], v[60:63], a[88:95], v6
    v_smfmac_f32_16x16x64_bf16 v[72:75], v[60:63], a[56:63], v6
    v_smfmac_f32_16x16x64_bf16 v[76:79], v[60:63], a[120:127], v6
    s_branch L_q_a_42
L_ok_a_48:
    v_smfmac_f32_16x16x64_bf16 v[64:67], v[52:55], a[8:15], v6
    v_smfmac_f32_16x16x64_bf16 v[68:71], v[52:55], a[72:79], v6
    v_smfmac_f32_16x16x64_bf16 v[72:75], v[52:55], a[40:47], v6
    v_smfmac_f32_16x16x64_bf16 v[76:79], v[52:55], a[104:111], v6
    s_branch L_q_a_27
L_q_a_38:
    buffer_load_dwordx4 v[56:59], v4, s[8:11], s38 offen sc1
    s_waitcnt vmcnt(2)
    v_max3_u32 v7, v60, v61, v62
    v_max_u32 v7, v7, v63
    v_cmp_eq_u32 vcc, s34, v7
    s_cbranch_vccnz L_q_a_49
L_v_a_50:
    v_smfmac_f32_16x16x64_bf16 v[64:67], v[60:63], a[24:31], v6
    s_waitcnt vmcnt(1)
    v_max3_u32 v7, v52, v53, v54
    v_max_u32 v7, v7, v55
    v_smfmac_f32_16x16x64_bf16 v[68:71], v[60:63], a[88:95], v6
    v_cmp_eq_u32 vcc, s34, v7
    v_smfmac_f32_16x16x64_bf16 v[72:75], v[60:63], a[56:63], v6
    v_smfmac_f32_16x16x64_bf16 v[76:79], v[60:63], a[120:127], v6
    s_cbranch_vccnz L_q_a_51
L_v_a_52:
    v_smfmac_f32_16x16x64_bf16 v[64:67], v[52:55], a[8:15], v6
    s_waitcnt vmcnt(0)
    v_max3_u32 v7, v56, v57, v58
    v_max_u32 v7, v7, v59
    v_smfmac_f32_16x16x64_bf16 v[68:71], v[52:55], a[72:79], v6
    v_cmp_eq_u32 vcc, s34, v7
    v_smfmac_f32_16x16x64_bf16 v[72:75], v[52:55], a[40:47], v6
    v_smfmac_f32_16x16x64_bf16 v[76:79], v[52:55], a[104:111], v6
    s_cbranch_vccnz L_q_a_31
    s_branch L_v_a_32
L_q_a_51:
    buffer_load_dwordx4 v[52:55], v3, s[8:11], s38 offen sc1
    s_waitcnt vmcnt(2)
    v_max3_u32 v7, v56, v57, v58
    v_max_u32 v7, v7, v59
    v_cmp_eq_u32 vcc, s34, v7
    s_cbranch_vccz L_ok_a_53
    buffer_load_dwordx4 v[56:59], v4, s[8:11], s38 offen sc1
    s_waitcnt vmcnt(2)
    v_max3_u32 v7, v52, v53, v54
    v_max_u32 v7, v7, v55
    v_cmp_eq_u32 vcc, s34, v7
    s_cbranch_vccz L_ok_a_54
    s_add_u32 s33, s33, 1
    s_cmp_gt_u32 s33, 0x100000
    s_cbranch_scc0 L_q_a_51
    s_branch chain_kernel_abort
L_ok_a_53:
    v_smfmac_f32_16x16x64_bf16 v[64:67], v[56:59], a[16:23], v6
    v_smfmac_f32_16x16x64_bf16 v[68:71], v[56:59], a[80:87], v6
    v_smfmac_f32_16x16x64_bf16 v[72:75], v[56:59], a[48:55], v6
    v_smfmac_f32_16x16x64_bf16 v[76:79], v[56:59], a[112:119], v6
    s_branch L_q_a_42
L_ok_a_54:
    v_smfmac_f32_16x16x64_bf16 v[64:67], v[52:55], a[8:15], v6
    v_smfmac_f32_16x16x64_bf16 v[68:71], v[52:55], a[72:79], v6
    v_smfmac_f32_16x16x64_bf16 v[72:75], v[52:55], a[40:47], v6
    v_smfmac_f32_16x16x64_bf16 v[76:79], v[52:55], a[104:111], v6
    s_branch L_q_a_31
L_q_a_49:
    buffer_load_dwordx4 v[60:63], v5, s[8:11], s38 offen sc1
    s_waitcnt vmcnt(2)
    v_max3_u32 v7, v52, v53, v54
    v_max_u32 v7, v7, v55
    v_cmp_eq_u32 vcc, s34, v7
    s_cbranch_vccnz L_q_a_55
L_v_a_56:
    v_smfmac_f32_16x16x64_bf16 v[64:67], v[52:55], a[8:15], v6
    s_waitcnt vmcnt(1)
    v_max3_u32 v7, v56, v57, v58
    v_max_u32 v7, v7, v59
    v_smfmac_f32_16x16x64_bf16 v[68:71], v[52:55], a[72:79], v6
    v_cmp_eq_u32 vcc, s34, v7
    v_smfmac_f32_16x16x64_bf16 v[72:75], v[52:55], a[40:47], v6
    v_smfmac_f32_16x16x64_bf16 v[76:79], v[52:55], a[104:111], v6
    s_cbranch_vccnz L_q_a_34
    s_branch L_v_a_35
L_q_a_55:
    buffer_load_dwordx4 v[52:55], v3, s[8:11], s38 offen sc1
    s_waitcnt vmcnt(2)
    v_max3_u32 v7, v56, v57, v58
    v_max_u32 v7, v7, v59
    v_cmp_eq_u32 vcc, s34, v7
    s_cbranch_vccz L_ok_a_57
    buffer_load_dwordx4 v[56:59], v4, s[8:11], s38 offen sc1
    s_waitcnt vmcnt(2)
    v_max3_u32 v7, v60, v61, v62
    v_max_u32 v7, v7, v63
    v_cmp_eq_u32 vcc, s34, v7
    s_cbranch_vccz L_ok_a_58
    buffer_load_dwordx4 v[60:63], v5, s[8:11], s38 offen sc1
    s_waitcnt vmcnt(2)
    v_max3_u32 v7, v52, v53, v54
    v_max_u32 v7, v7, v55
    v_cmp_eq_u32 vcc, s34, v7
    s_cbranch_vccz L_ok_a_59
    s_add_u32 s33, s33, 1
    s_cmp_gt_u32 s33, 0x100000
    s_cbranch_scc0 L_q_a_55
    s_branch chain_kernel_abort
L_ok_a_57:
    v_smfmac_f32_16x16x64_bf16 v[64:67], v[56:59], a[16:23], v6
    v_smfmac_f32_16x16x64_bf16 v[68:71], v[56:59], a[80:87], v6
    v_smfmac_f32_16x16x64_bf16 v[72:75], v[56:59], a[48:55], v6
    v_smfmac_f32_16x16x64_bf16 v[76:79], v[56:59], a[112:119], v6
    s_branch L_q_a_45
L_ok_a_58:
    v_smfmac_f32_16x16x64_bf16 v[64:67], v[60:63], a[24:31], v6
    v_smfmac_f32_16x16x64_bf16 v[68:71], v[60:63], a[88:95], v6
    v_smfmac_f32_16x16x64_bf16 v[72:75], v[60:63], a[56:63], v6
    v_smfmac_f32_16x16x64_bf16 v[76:79], v[60:63], a[120:127], v6
    s_branch L_q_a_51
L_ok_a_59:
    v_smfmac_f32_16x16x64_bf16 v[64:67], v[52:55], a[8:15], v6
    v_smfmac_f32_16x16x64_bf16 v[68:71], v[52:55], a[72:79], v6
    v_smfmac_f32_16x16x64_bf16 v[72:75], v[52:55], a[40:47], v6
    v_smfmac_f32_16x16x64_bf16 v[76:79], v[52:55], a[104:111], v6
    s_branch L_q_a_34
L_q_a_19:
    buffer_load_dwordx4 v[48:51], v2, s[8:11], s38 offen sc1
    s_waitcnt vmcnt(3)
    v_max3_u32 v7, v52, v53, v54
    v_max_u32 v7, v7, v55
    v_cmp_eq_u32 vcc, s34, v7
    s_cbranch_vccnz L_q_a_60
L_v_a_61:
    v_smfmac_f32_16x16x64_bf16 v[64:67], v[52:55], a[8:15], v6
    s_waitcnt vmcnt(2)
    v_max3_u32 v7, v56, v57, v58
    v_max_u32 v7, v7, v59
    v_smfmac_f32_16x16x64_bf16 v[68:71], v[52:55], a[72:79], v6
    v_cmp_eq_u32 vcc, s34, v7
    v_smfmac_f32_16x16x64_bf16 v[72:75], v[52:55], a[40:47], v6
    v_smfmac_f32_16x16x64_bf16 v[76:79], v[52:55], a[104:111], v6
    s_cbranch_vccnz L_q_a_62
L_v_a_63:
    v_smfmac_f32_16x16x64_bf16 v[64:67], v[56:59], a[16:23], v6
    s_waitcnt vmcnt(1)
    v_max3_u32 v7, v60, v61, v62
    v_max_u32 v7, v7, v63
    v_smfmac_f32_16x16x64_bf16 v[68:71], v[56:59], a[80:87], v6
    v_cmp_eq_u32 vcc, s34, v7
    v_smfmac_f32_16x16x64_bf16 v[72:75], v[56:59], a[48:55], v6
    v_smfmac_f32_16x16x64_bf16 v[76:79], v[56:59], a[112:119], v6
    s_cbranch_vccnz L_q_a_64
L_v_a_65:
    v_smfmac_f32_16x16x64_bf16 v[64:67], v[60:63], a[24:31], v6
    s_waitcnt vmcnt(0)
    v_max3_u32 v7, v48, v49, v50
    v_max_u32 v7, v7, v51
    v_smfmac_f32_16x16x64_bf16 v[68:71], v[60:63], a[88:95], v6
    v_cmp_eq_u32 vcc, s34, v7
    v_smfmac_f32_16x16x64_bf16 v[72:75], v[60:63], a[56:63], v6
    v_smfmac_f32_16x16x64_bf16 v[76:79], v[60:63], a[120:127], v6
    s_cbranch_vccnz L_q_a_66
L_v_a_67:
    v_smfmac_f32_16x16x64_bf16 v[64:67], v[48:51], a[0:7], v6
    v_smfmac_f32_16x16x64_bf16 v[68:71], v[48:51], a[64:71], v6
    v_smfmac_f32_16x16x64_bf16 v[72:75], v[48:51], a[32:39], v6
    v_smfmac_f32_16x16x64_bf16 v[76:79], v[48:51], a[96:103], v6
    s_branch L_gd_a_18
L_q_a_66:
    buffer_load_dwordx4 v[48:51], v2, s[8:11], s38 offen sc1
    s_waitcnt vmcnt(2)
    v_max3_u32 v7, v48, v49, v50
    v_max_u32 v7, v7, v51
    v_cmp_eq_u32 vcc, s34, v7
    s_cbranch_vccz L_ok_a_68
    s_add_u32 s33, s33, 1
    s_cmp_gt_u32 s33, 0x100000
    s_cbranch_scc0 L_q_a_66
    s_branch chain_kernel_abort
L_ok_a_68:
    v_smfmac_f32_16x16x64_bf16 v[64:67], v[48:51], a[0:7], v6
    v_smfmac_f32_16x16x64_bf16 v[68:71], v[48:51], a[64:71], v6
    v_smfmac_f32_16x16x64_bf16 v[72:75], v[48:51], a[32:39], v6
    v_smfmac_f32_16x16x64_bf16 v[76:79], v[48:51], a[96:103], v6
    s_branch L_gd_a_18
L_q_a_64:
    buffer_load_dwordx4 v[60:63], v5, s[8:11], s38 offen sc1
    s_waitcnt vmcnt(1)
    v_max3_u32 v7, v48, v49, v50
    v_max_u32 v7, v7, v51
    v_cmp_eq_u32 vcc, s34, v7
    s_cbranch_vccnz L_q_a_69
L_v_a_70:
    v_smfmac_f32_16x16x64_bf16 v[64:67], v[48:51], a[0:7], v6
    s_waitcnt vmcnt(0)
    v_max3_u32 v7, v60, v61, v62
    v_max_u32 v7, v7, v63
    v_smfmac_f32_16x16x64_bf16 v[68:71], v[48:51], a[64:71], v6
    v_cmp_eq_u32 vcc, s34, v7
    v_smfmac_f32_16x16x64_bf16 v[72:75], v[48:51], a[32:39], v6
    v_smfmac_f32_16x16x64_bf16 v[76:79], v[48:51], a[96:103], v6
    s_cbranch_vccnz L_q_a_27
    s_branch L_v_a_26
L_q_a_69:
    buffer_load_dwordx4 v[48:51], v2, s[8:11], s38 offen sc1
    s_waitcnt vmcnt(2)
    v_max3_u32 v7, v60, v61, v62
    v_max_u32 v7, v7, v63
    v_cmp_eq_u32 vcc, s34, v7
    s_cbranch_vccz L_ok_a_71
    buffer_load_dwordx4 v[60:63], v5, s[8:11], s38 offen sc1
    s_waitcnt vmcnt(2)
    v_max3_u32 v7, v48, v49, v50
    v_max_u32 v7, v7, v51
    v_cmp_eq_u32 vcc, s34, v7
    s_cbranch_vccz L_ok_a_72
    s_add_u32 s33, s33, 1
    s_cmp_gt_u32 s33, 0x100000
    s_cbranch_scc0 L_q_a_69
    s_branch chain_kernel_abort
L_ok_a_71:
    v_smfmac_f32_16x16x64_bf16 v[64:67], v[60:63], a[24:31], v6
    v_smfmac_f32_16x16x64_bf16 v[68:71], v[60:63], a[88:95], v6
    v_smfmac_f32_16x16x64_bf16 v[72:75], v[60:63], a[56:63], v6
    v_smfmac_f32_16x16x64_bf16 v[76:79], v[60:63], a[120:127], v6
    s_branch L_q_a_66
L_ok_a_72:
    v_smfmac_f32_16x16x64_bf16 v[64:67], v[48:51], a[0:7], v6
    v_smfmac_f32_16x16x64_bf16 v[68:71], v[48:51], a[64:71], v6
    v_smfmac_f32_16x16x64_bf16 v[72:75], v[48:51], a[32:39], v6
    v_smfmac_f32_16x16x64_bf16 v[76:79], v[48:51], a[96:103], v6
    s_branch L_q_a_27
L_q_a_62:
    buffer_load_dwordx4 v[56:59], v4, s[8:11], s38 offen sc1
    s_waitcnt vmcnt(2)
    v_max3_u32 v7, v60, v61, v62
    v_max_u32 v7, v7, v63
    v_cmp_eq_u32 vcc, s34, v7
    s_cbranch_vccnz L_q_a_73
L_v_a_74:
    v_smfmac_f32_16x16x64_bf16 v[64:67], v[60:63], a[24:31], v6
    s_waitcnt vmcnt(1)
    v_max3_u32 v7, v48, v49, v50
    v_max_u32 v7, v7, v51
    v_smfmac_f32_16x16x64_bf16 v[68:71], v[60:63], a[88:95], v6
    v_cmp_eq_u32 vcc, s34, v7
    v_smfmac_f32_16x16x64_bf16 v[72:75], v[60:63], a[56:63], v6
    v_smfmac_f32_16x16x64_bf16 v[76:79], v[60:63], a[120:127], v6
    s_cbranch_vccnz L_q_a_75
L_v_a_76:
    v_smfmac_f32_16x16x64_bf16 v[64:67], v[48:51], a[0:7], v6
    s_waitcnt vmcnt(0)
    v_max3_u32 v7, v56, v57, v58
    v_max_u32 v7, v7, v59
    v_smfmac_f32_16x16x64_bf16 v[68:71], v[48:51], a[64:71], v6
    v_cmp_eq_u32 vcc, s34, v7
    v_smfmac_f32_16x16x64_bf16 v[72:75], v[48:51], a[32:39], v6
    v_smfmac_f32_16x16x64_bf16 v[76:79], v[48:51], a[96:103], v6
    s_cbranch_vccnz L_q_a_31
    s_branch L_v_a_32
L_q_a_75:
    buffer_load_dwordx4 v[48:51], v2, s[8:11], s38 offen sc1
    s_waitcnt vmcnt(2)
    v_max3_u32 v7, v56, v57, v58
    v_max_u32 v7, v7, v59
    v_cmp_eq_u32 vcc, s34, v7
    s_cbranch_vccz L_ok_a_77
    buffer_load_dwordx4 v[56:59], v4, s[8:11], s38 offen sc1
    s_waitcnt vmcnt(2)
    v_max3_u32 v7, v48, v49, v50
    v_max_u32 v7, v7, v51
    v_cmp_eq_u32 vcc, s34, v7
    s_cbranch_vccz L_ok_a_78
    s_add_u32 s33, s33, 1
    s_cmp_gt_u32 s33, 0x100000
    s_cbranch_scc0 L_q_a_75
    s_branch chain_kernel_abort
L_ok_a_77:
    v_smfmac_f32_16x16x64_bf16 v[64:67], v[56:59], a[16:23], v6
    v_smfmac_f32_16x16x64_bf16 v[68:71], v[56:59], a[80:87], v6
    v_smfmac_f32_16x16x64_bf16 v[72:75], v[56:59], a[48:55], v6
    v_smfmac_f32_16x16x64_bf16 v[76:79], v[56:59], a[112:119], v6
    s_branch L_q_a_66
L_ok_a_78:
    v_smfmac_f32_16x16x64_bf16 v[64:67], v[48:51], a[0:7], v6
    v_smfmac_f32_16x16x64_bf16 v[68:71], v[48:51], a[64:71], v6
    v_smfmac_f32_16x16x64_bf16 v[72:75], v[48:51], a[32:39], v6
    v_smfmac_f32_16x16x64_bf16 v[76:79], v[48:51], a[96:103], v6
    s_branch L_q_a_31
L_q_a_73:
    buffer_load_dwordx4 v[60:63], v5, s[8:11], s38 offen sc1
    s_waitcnt vmcnt(2)
    v_max3_u32 v7, v48, v49, v50
    v_max_u32 v7, v7, v51
    v_cmp_eq_u32 vcc, s34, v7
    s_cbranch_vccnz L_q_a_79
L_v_a_80:
    v_smfmac_f32_16x16x64_bf16 v[64:67], v[48:51], a[0:7], v6
    s_waitcnt vmcnt(1)
    v_max3_u32 v7, v56, v57, v58
    v_max_u32 v7, v7, v59
    v_smfmac_f32_16x16x64_bf16 v[68:71], v[48:51], a[64:71], v6
    v_cmp_eq_u32 vcc, s34, v7
    v_smfmac_f32_16x16x64_bf16 v[72:75], v[48:51], a[32:39], v6
    v_smfmac_f32_16x16x64_bf16 v[76:79], v[48:51], a[96:103], v6
    s_cbranch_vccnz L_q_a_34
    s_branch L_v_a_35
L_q_a_79:
    buffer_load_dwordx4 v[48:51], v2, s[8:11], s38 offen sc1
    s_waitcnt vmcnt(2)
    v_max3_u32 v7, v56, v57, v58
    v_max_u32 v7, v7, v59
    v_cmp_eq_u32 vcc, s34, v7
    s_cbranch_vccz L_ok_a_81
    buffer_load_dwordx4 v[56:59], v4, s[8:11], s38 offen sc1
    s_waitcnt vmcnt(2)
    v_max3_u32 v7, v60, v61, v62
    v_max_u32 v7, v7, v63
    v_cmp_eq_u32 vcc, s34, v7
    s_cbranch_vccz L_ok_a_82
    buffer_load_dwordx4 v[60:63], v5, s[8:11], s38 offen sc1
    s_waitcnt vmcnt(2)
    v_max3_u32 v7, v48, v49, v50
    v_max_u32 v7, v7, v51
    v_cmp_eq_u32 vcc, s34, v7
    s_cbranch_vccz L_ok_a_83
    s_add_u32 s33, s33, 1
    s_cmp_gt_u32 s33, 0x100000
    s_cbranch_scc0 L_q_a_79
    s_branch chain_kernel_abort
L_ok_a_81:
    v_smfmac_f32_16x16x64_bf16 v[64:67], v[56:59], a[16:23], v6
    v_smfmac_f32_16x16x64_bf16 v[68:71], v[56:59], a[80:87], v6
    v_smfmac_f32_16x16x64_bf16 v[72:75], v[56:59], a[48:55], v6
    v_smfmac_f32_16x16x64_bf16 v[76:79], v[56:59], a[112:119], v6
    s_branch L_q_a_69
L_ok_a_82:
    v_smfmac_f32_16x16x64_bf16 v[64:67], v[60:63], a[24:31], v6
    v_smfmac_f32_16x16x64_bf16 v[68:71], v[60:63], a[88:95], v6
    v_smfmac_f32_16x16x64_bf16 v[72:75], v[60:63], a[56:63], v6
    v_smfmac_f32_16x16x64_bf16 v[76:79], v[60:63], a[120:127], v6
    s_branch L_q_a_75
L_ok_a_83:
    v_smfmac_f32_16x16x64_bf16 v[64:67], v[48:51], a[0:7], v6
    v_smfmac_f32_16x16x64_bf16 v[68:71], v[48:51], a[64:71], v6
    v_smfmac_f32_16x16x64_bf16 v[72:75], v[48:51], a[32:39], v6
    v_smfmac_f32_16x16x64_bf16 v[76:79], v[48:51], a[96:103], v6
    s_branch L_q_a_34
L_q_a_60:
    buffer_load_dwordx4 v[52:55], v3, s[8:11], s38 offen sc1
    s_waitcnt vmcnt(3)
    v_max3_u32 v7, v56, v57, v58
    v_max_u32 v7, v7, v59
    v_cmp_eq_u32 vcc, s34, v7
    s_cbranch_vccnz L_q_a_84
L_v_a_85:
    v_smfmac_f32_16x16x64_bf16 v[64:67], v[56:59], a[16:23], v6
    s_waitcnt vmcnt(2)
    v_max3_u32 v7, v60, v61, v62
    v_max_u32 v7, v7, v63
    v_smfmac_f32_16x16x64_bf16 v[68:71], v[56:59], a[80:87], v6
    v_cmp_eq_u32 vcc, s34, v7
    v_smfmac_f32_16x16x64_bf16 v[72:75], v[56:59], a[48:55], v6
    v_smfmac_f32_16x16x64_bf16 v[76:79], v[56:59], a[112:119], v6
    s_cbranch_vccnz L_q_a_86
L_v_a_87:
    v_smfmac_f32_16x16x64_bf16 v[64:67], v[60:63], a[24:31], v6
    s_waitcnt vmcnt(1)
    v_max3_u32 v7, v48, v49, v50
    v_max_u32 v7, v7, v51
    v_smfmac_f32_16x16x64_bf16 v[68:71], v[60:63], a[88:95], v6
    v_cmp_eq_u32 vcc, s34, v7
    v_smfmac_f32_16x16x64_bf16 v[72:75], v[60:63], a[56:63], v6
    v_smfmac_f32_16x16x64_bf16 v[76:79], v[60:63], a[120:127], v6
    s_cbranch_vccnz L_q_a_88
L_v_a_89:
    v_smfmac_f32_16x16x64_bf16 v[64:67], v[48:51], a[0:7], v6
    s_waitcnt vmcnt(0)
    v_max3_u32 v7, v52, v53, v54
    v_max_u32 v7, v7, v55
    v_smfmac_f32_16x16x64_bf16 v[68:71], v[48:51], a[64:71], v6
    v_cmp_eq_u32 vcc, s34, v7
    v_smfmac_f32_16x16x64_bf16 v[72:75], v[48:51], a[32:39], v6
    v_smfmac_f32_16x16x64_bf16 v[76:79], v[48:51], a[96:103], v6
    s_cbranch_vccnz L_q_a_42
    s_branch L_v_a_43
L_q_a_88:
    buffer_load_dwordx4 v[48:51], v2, s[8:11], s38 offen sc1
    s_waitcnt vmcnt(2)
    v_max3_u32 v7, v52, v53, v54
    v_max_u32 v7, v7, v55
    v_cmp_eq_u32 vcc, s34, v7
    s_cbranch_vccz L_ok_a_90
    buffer_load_dwordx4 v[52:55], v3, s[8:11], s38 offen sc1
    s_waitcnt vmcnt(2)
    v_max3_u32 v7, v48, v49, v50
    v_max_u32 v7, v7, v51
    v_cmp_eq_u32 vcc, s34, v7
    s_cbranch_vccz L_ok_a_91
    s_add_u32 s33, s33, 1
    s_cmp_gt_u32 s33, 0x100000
    s_cbranch_scc0 L_q_a_88
    s_branch chain_kernel_abort
L_ok_a_90:
    v_smfmac_f32_16x16x64_bf16 v[64:67], v[52:55], a[8:15], v6
    v_smfmac_f32_16x16x64_bf16 v[68:71], v[52:55], a[72:79], v6
    v_smfmac_f32_16x16x64_bf16 v[72:75], v[52:55], a[40:47], v6
    v_smfmac_f32_16x16x64_bf16 v[76:79], v[52:55], a[104:111], v6
    s_branch L_q_a_66
L_ok_a_91:
    v_smfmac_f32_16x16x64_bf16 v[64:67], v[48:51], a[0:7], v6
    v_smfmac_f32_16x16x64_bf16 v[68:71], v[48:51], a[64:71], v6
    v_smfmac_f32_16x16x64_bf16 v[72:75], v[48:51], a[32:39], v6
    v_smfmac_f32_16x16x64_bf16 v[76:79], v[48:51], a[96:103], v6
    s_branch L_q_a_42
L_q_a_86:
    buffer_load_dwordx4 v[60:63], v5, s[8:11], s38 offen sc1
    s_waitcnt vmcnt(2)
    v_max3_u32 v7, v48, v49, v50
    v_max_u32 v7, v7, v51
    v_cmp_eq_u32 vcc, s34, v7
    s_cbranch_vccnz L_q_a_92
L_v_a_93:
    v_smfmac_f32_16x16x64_bf16 v[64:67], v[48:51], a[0:7], v6
    s_waitcnt vmcnt(1)
    v_max3_u32 v7, v52, v53, v54
    v_max_u32 v7, v7, v55
    v_smfmac_f32_16x16x64_bf16 v[68:71], v[48:51], a[64:71], v6
    v_cmp_eq_u32 vcc, s34, v7
    v_smfmac_f32_16x16x64_bf16 v[72:75], v[48:51], a[32:39], v6
    v_smfmac_f32_16x16x64_bf16 v[76:79], v[48:51], a[96:103], v6
    s_cbranch_vccnz L_q_a_45
    s_branch L_v_a_46
L_q_a_92:
    buffer_load_dwordx4 v[48:51], v2, s[8:11], s38 offen sc1
    s_waitcnt vmcnt(2)
    v_max3_u32 v7, v52, v53, v54
    v_max_u32 v7, v7, v55
    v_cmp_eq_u32 vcc, s34, v7
    s_cbranch_vccz L_ok_a_94
    buffer_load_dwordx4 v[52:55], v3, s[8:11], s38 offen sc1
    s_waitcnt vmcnt(2)
    v_max3_u32 v7, v60, v61, v62
    v_max_u32 v7, v7, v63
    v_cmp_eq_u32 vcc, s34, v7
    s_cbranch_vccz L_ok_a_95
    buffer_load_dwordx4 v[60:63], v5, s[8:11], s38 offen sc1
    s_waitcnt vmcnt(2)
    v_max3_u32 v7, v48, v49, v50
    v_max_u32 v7, v7, v51
    v_cmp_eq_u32 vcc, s34, v7
    s_cbranch_vccz L_ok_a_96
    s_add_u32 s33, s33, 1
    s_cmp_gt_u32 s33, 0x100000
    s_cbranch_scc0 L_q_a_92
    s_branch chain_kernel_abort
L_ok_a_94:
    v_smfmac_f32_16x16x64_bf16 v[64:67], v[52:55], a[8:15], v6
    v_smfmac_f32_16x16x64_bf16 v[68:71], v[52:55], a[72:79], v6
    v_smfmac_f32_16x16x64_bf16 v[72:75], v[52:55], a[40:47], v6
    v_smfmac_f32_16x16x64_bf16 v[76:79], v[52:55], a[104:111], v6
    s_branch L_q_a_69
L_ok_a_95:
    v_smfmac_f32_16x16x64_bf16 v[64:67], v[60:63], a[24:31], v6
    v_smfmac_f32_16x16x64_bf16 v[68:71], v[60:63], a[88:95], v6
    v_smfmac_f32_16x16x64_bf16 v[72:75], v[60:63], a[56:63], v6
    v_smfmac_f32_16x16x64_bf16 v[76:79], v[60:63], a[120:127], v6
    s_branch L_q_a_88
L_ok_a_96:
    v_smfmac_f32_16x16x64_bf16 v[64:67], v[48:51], a[0:7], v6
    v_smfmac_f32_16x16x64_bf16 v[68:71], v[48:51], a[64:71], v6
    v_smfmac_f32_16x16x64_bf16 v[72:75], v[48:51], a[32:39], v6
    v_smfmac_f32_16x16x64_bf16 v[76:79], v[48:51], a[96:103], v6
    s_branch L_q_a_45
L_q_a_84:
    buffer_load_dwordx4 v[56:59], v4, s[8:11], s38 offen sc1
    s_waitcnt vmcnt(3)
    v_max3_u32 v7, v60, v61, v62
    v_max_u32 v7, v7, v63
    v_cmp_eq_u32 vcc, s34, v7
    s_cbranch_vccnz L_q_a_97
L_v_a_98:
    v_smfmac_f32_16x16x64_bf16 v[64:67], v[60:63], a[24:31], v6
    s_waitcnt vmcnt(2)
    v_max3_u32 v7, v48, v49, v50
    v_max_u32 v7, v7, v51
    v_smfmac_f32_16x16x64_bf16 v[68:71], v[60:63], a[88:95], v6
    v_cmp_eq_u32 vcc, s34, v7
    v_smfmac_f32_16x16x64_bf16 v[72:75], v[60:63], a[56:63], v6
    v_smfmac_f32_16x16x64_bf16 v[76:79], v[60:63], a[120:127], v6
    s_cbranch_vccnz L_q_a_99
L_v_a_100:
    v_smfmac_f32_16x16x64_bf16 v[64:67], v[48:51], a[0:7], v6
    s_waitcnt vmcnt(1)
    v_max3_u32 v7, v52, v53, v54
    v_max_u32 v7, v7, v55
    v_smfmac_f32_16x16x64_bf16 v[68:71], v[48:51], a[64:71], v6
    v_cmp_eq_u32 vcc, s34, v7
    v_smfmac_f32_16x16x64_bf16 v[72:75], v[48:51], a[32:39], v6
    v_smfmac_f32_16x16x64_bf16 v[76:79], v[48:51], a[96:103], v6
    s_cbranch_vccnz L_q_a_51
    s_branch L_v_a_52
L_q_a_99:
    buffer_load_dwordx4 v[48:51], v2, s[8:11], s38 offen sc1
    s_waitcnt vmcnt(2)
    v_max3_u32 v7, v52, v53, v54
    v_max_u32 v7, v7, v55
    v_cmp_eq_u32 vcc, s34, v7
    s_cbranch_vccz L_ok_a_101
    buffer_load_dwordx4 v[52:55], v3, s[8:11], s38 offen sc1
    s_waitcnt vmcnt(2)
    v_max3_u32 v7, v56, v57, v58
    v_max_u32 v7, v7, v59
    v_cmp_eq_u32 vcc, s34, v7
    s_cbranch_vccz L_ok_a_102
    buffer_load_dwordx4 v[56:59], v4, s[8:11], s38 offen sc1
    s_waitcnt vmcnt(2)
    v_max3_u32 v7, v48, v49, v50
    v_max_u32 v7, v7, v51
    v_cmp_eq_u32 vcc, s34, v7
    s_cbranch_vccz L_ok_a_103
    s_add_u32 s33, s33, 1
    s_cmp_gt_u32 s33, 0x100000
    s_cbranch_scc0 L_q_a_99
    s_branch chain_kernel_abort
L_ok_a_101:
    v_smfmac_f32_16x16x64_bf16 v[64:67], v[52:55], a[8:15], v6
    v_smfmac_f32_16x16x64_bf16 v[68:71], v[52:55], a[72:79], v6
    v_smfmac_f32_16x16x64_bf16 v[72:75], v[52:55], a[40:47], v6
    v_smfmac_f32_16x16x64_bf16 v[76:79], v[52:55], a[104:111], v6
    s_branch L_q_a_75
L_ok_a_102:
    v_smfmac_f32_16x16x64_bf16 v[64:67], v[56:59], a[16:23], v6
    v_smfmac_f32_16x16x64_bf16 v[68:71], v[56:59], a[80:87], v6
    v_smfmac_f32_16x16x64_bf16 v[72:75], v[56:59], a[48:55], v6
    v_smfmac_f32_16x16x64_bf16 v[76:79], v[56:59], a[112:119], v6
    s_branch L_q_a_88
L_ok_a_103:
    v_smfmac_f32_16x16x64_bf16 v[64:67], v[48:51], a[0:7], v6
    v_smfmac_f32_16x16x64_bf16 v[68:71], v[48:51], a[64:71], v6
    v_smfmac_f32_16x16x64_bf16 v[72:75], v[48:51], a[32:39], v6
    v_smfmac_f32_16x16x64_bf16 v[76:79], v[48:51], a[96:103], v6
    s_branch L_q_a_51
L_q_a_97:
    buffer_load_dwordx4 v[60:63], v5, s[8:11], s38 offen sc1
    s_waitcnt vmcnt(3)
    v_max3_u32 v7, v48, v49, v50
    v_max_u32 v7, v7, v51
    v_cmp_eq_u32 vcc, s34, v7
    s_cbranch_vccnz L_q_a_104
L_v_a_105:
    v_smfmac_f32_16x16x64_bf16 v[64:67], v[48:51], a[0:7], v6
    s_waitcnt vmcnt(2)
    v_max3_u32 v7, v52, v53, v54
    v_max_u32 v7, v7, v55
    v_smfmac_f32_16x16x64_bf16 v[68:71], v[48:51], a[64:71], v6
    v_cmp_eq_u32 vcc, s34, v7
    v_smfmac_f32_16x16x64_bf16 v[72:75], v[48:51], a[32:39], v6
    v_smfmac_f32_16x16x64_bf16 v[76:79], v[48:51], a[96:103], v6
    s_cbranch_vccnz L_q_a_55
    s_branch L_v_a_56
L_q_a_104:
    buffer_load_dwordx4 v[48:51], v2, s[8:11], s38 offen sc1
    s_waitcnt vmcnt(2)
    v_max3_u32 v7, v52, v53, v54
    v_max_u32 v7, v7, v55
    v_cmp_eq_u32 vcc, s34, v7
    s_cbranch_vccz L_ok_a_106
    buffer_load_dwordx4 v[52:55], v3, s[8:11], s38 offen sc1
    s_waitcnt vmcnt(2)
    v_max3_u32 v7, v56, v57, v58
    v_max_u32 v7, v7, v59
    v_cmp_eq_u32 vcc, s34, v7
    s_cbranch_vccz L_ok_a_107
    buffer_load_dwordx4 v[56:59], v4, s[8:11], s38 offen sc1
    s_waitcnt vmcnt(2)
    v_max3_u32 v7, v60, v61, v62
    v_max_u32 v7, v7, v63
    v_cmp_eq_u32 vcc, s34, v7
    s_cbranch_vccz L_ok_a_108
    buffer_load_dwordx4 v[60:63], v5, s[8:11], s38 offen sc1
    s_waitcnt vmcnt(2)
    v_max3_u32 v7, v48, v49, v50
    v_max_u32 v7, v7, v51
    v_cmp_eq_u32 vcc, s34, v7
    s_cbranch_vccz L_ok_a_109
    s_add_u32 s33, s33, 1
    s_cmp_gt_u32 s33, 0x100000
    s_cbranch_scc0 L_q_a_104
    s_branch chain_kernel_abort
L_ok_a_106:
    v_smfmac_f32_16x16x64_bf16 v[64:67], v[52:55], a[8:15], v6
    v_smfmac_f32_16x16x64_bf16 v[68:71], v[52:55], a[72:79], v6
    v_smfmac_f32_16x16x64_bf16 v[72:75], v[52:55], a[40:47], v6
    v_smfmac_f32_16x16x64_bf16 v[76:79], v[52:55], a[104:111], v6
    s_branch L_q_a_79
L_ok_a_107:
    v_smfmac_f32_16x16x64_bf16 v[64:67], v[56:59], a[16:23], v6
    v_smfmac_f32_16x16x64_bf16 v[68:71], v[56:59], a[80:87], v6
    v_smfmac_f32_16x16x64_bf16 v[72:75], v[56:59], a[48:55], v6
    v_smfmac_f32_16x16x64_bf16 v[76:79], v[56:59], a[112:119], v6
    s_branch L_q_a_92
L_ok_a_108:
    v_smfmac_f32_16x16x64_bf16 v[64:67], v[60:63], a[24:31], v6
    v_smfmac_f32_16x16x64_bf16 v[68:71], v[60:63], a[88:95], v6
    v_smfmac_f32_16x16x64_bf16 v[72:75], v[60:63], a[56:63], v6
    v_smfmac_f32_16x16x64_bf16 v[76:79], v[60:63], a[120:127], v6
    s_branch L_q_a_99
L_ok_a_109:
    v_smfmac_f32_16x16x64_bf16 v[64:67], v[48:51], a[0:7], v6
    v_smfmac_f32_16x16x64_bf16 v[68:71], v[48:51], a[64:71], v6
    v_smfmac_f32_16x16x64_bf16 v[72:75], v[48:51], a[32:39], v6
    v_smfmac_f32_16x16x64_bf16 v[76:79], v[48:51], a[96:103], v6
    s_branch L_q_a_55
L_cf_117:
L_rt_118:
    buffer_load_dwordx4 v[200:203], v16, s[8:11], s40 offen sc1
    buffer_load_dwordx4 v[204:207], v13, s[8:11], s40 offen sc1
    buffer_load_dwordx4 v[208:211], v14, s[8:11], s40 offen sc1
    buffer_load_dwordx4 v[212:215], v15, s[8:11], s40 offen sc1
    s_waitcnt vmcnt(7)
    v_permlane32_swap_b32 v216, v218
    v_permlane32_swap_b32 v217, v219
    s_waitcnt vmcnt(6)
    v_pk_add_f32 v[154:155], v[216:217], v[218:219]
    v_pk_add_f32 v[148:149], v[124:125], v[220:221]
    v_pk_add_f32 v[150:151], v[126:127], v[222:223]
    v_permlane16_swap_b32 v154, v155
    s_waitcnt vmcnt(5)
    v_pk_add_f32 v[148:149], v[148:149], v[224:225]
    v_pk_add_f32 v[150:151], v[150:151], v[226:227]
    v_add_f32 v152, v154, v155
    s_waitcnt vmcnt(4)
    v_pk_add_f32 v[148:149], v[148:149], v[228:229]
    v_pk_add_f32 v[150:151], v[150:151], v[230:231]
    v_pk_add_f32 v[154:155], v[148:149], v[150:151]
    v_add_f32 v154, v154, v152
    v_cmp_u_f32 vcc, v154, v155
    s_cbranch_vccz L_cok_116
    buffer_load_dwordx4 v[216:219], v16, s[8:11], s40 offen sc1
    buffer_load_dwordx4 v[220:223], v13, s[8:11], s40 offen sc1
    buffer_load_dwordx4 v[224:227], v14, s[8:11], s40 offen sc1
    buffer_load_dwordx4 v[228:231], v15, s[8:11], s40 offen sc1
    s_waitcnt vmcnt(7)
    v_permlane32_swap_b32 v200, v202
    v_permlane32_swap_b32 v201, v203
    s_waitcnt vmcnt(6)
    v_pk_add_f32 v[154:155], v[200:201], v[202:203]
    v_pk_add_f32 v[148:149], v[124:125], v[204:205]
    v_pk_add_f32 v[150:151], v[126:127], v[206:207]
    v_permlane16_swap_b32 v154, v155
    s_waitcnt vmcnt(5)
    v_pk_add_f32 v[148:149], v[148:149], v[208:209]
    v_pk_add_f32 v[150:151], v[150:151], v[210:211]
    v_add_f32 v152, v154, v155
    s_waitcnt vmcnt(4)
    v_pk_add_f32 v[148:149], v[148:149], v[212:213]
    v_pk_add_f32 v[150:151], v[150:151], v[214:215]
    v_pk_add_f32 v[154:155], v[148:149], v[150:151]
    v_add_f32 v154, v154, v152
    v_cmp_u_f32 vcc, v154, v155
    s_cbranch_vccz L_cok_116
    s_add_u32 s33, s33, 1
    s_cmp_gt_u32 s33, 0x100000
    s_cbranch_scc1 chain_kernel_abort
    s_and_b32 s20, s33, 63
    s_cbranch_scc1 L_rt_118
    v_cmp_eq_u32 vcc, s34, v200
    v_cmp_eq_u32 s[20:21], s34, v201
    s_or_b64 vcc, vcc, s[20:21]
    v_cmp_eq_u32 s[20:21], s34, v202
    s_or_b64 vcc, vcc, s[20:21]
    v_cmp_eq_u32 s[20:21], s34, v203
    s_or_b64 vcc, vcc, s[20:21]
    v_cmp_eq_u32 s[20:21], s34, v204
    s_or_b64 vcc, vcc, s[20:21]
    v_cmp_eq_u32 s[20:21], s34, v205
    s_or_b64 vcc, vcc, s[20:21]
    v_cmp_eq_u32 s[20:21], s34, v206
    s_or_b64 vcc, vcc, s[20:21]
    v_cmp_eq_u32 s[20:21], s34, v207
    s_or_b64 vcc, vcc, s[20:21]
    v_cmp_eq_u32 s[20:21], s34, v208
    s_or_b64 vcc, vcc, s[20:21]
    v_cmp_eq_u32 s[20:21], s34, v209
    s_or_b64 vcc, vcc, s[20:21]
    v_cmp_eq_u32 s[20:21], s34, v210
    s_or_b64 vcc, vcc, s[20:21]
    v_cmp_eq_u32 s[20:21], s34, v211
    s_or_b64 vcc, vcc, s[20:21]
    v_cmp_eq_u32 s[20:21], s34, v212
    s_or_b64 vcc, vcc, s[20:21]
    v_cmp_eq_u32 s[20:21], s34, v213
    s_or_b64 vcc, vcc, s[20:21]
    v_cmp_eq_u32 s[20:21], s34, v214
    s_or_b64 vcc, vcc, s[20:21]
    v_cmp_eq_u32 s[20:21], s34, v215
    s_or_b64 vcc, vcc, s[20:21]
    s_cbranch_vccnz L_rt_118
    s_branch L_cok_116
L_cok_116:
    v_cvt_pk_bf16_f32 v160, 0, v148
    v_cvt_pk_bf16_f32 v161, 0, v149
    v_cvt_pk_bf16_f32 v162, 0, v150
    v_cvt_pk_bf16_f32 v163, 0, v151
    v_cvt_pk_bf16_f32 v176, 0, v152
    s_branch L_chead_119
L_q_e_127:
    buffer_load_dwordx4 v[60:63], v5, s[8:11], s41 offen sc1
    s_waitcnt vmcnt(0)
    v_max3_u32 v7, v60, v61, v62
    v_max_u32 v7, v7, v63
    v_cmp_eq_u32 vcc, s34, v7
    s_cbranch_vccnz L_q_e_129
    s_branch L_v_e_128
L_q_e_129:
    buffer_load_dwordx4 v[60:63], v5, s[8:11], s41 offen sc1
    s_waitcnt vmcnt(2)
    v_max3_u32 v7, v60, v61, v62
    v_max_u32 v7, v7, v63
    v_cmp_eq_u32 vcc, s34, v7
    s_cbranch_vccz L_ok_e_130
    s_add_u32 s33, s33, 1
    s_cmp_gt_u32 s33, 0x100000
    s_cbranch_scc0 L_q_e_129
    s_branch chain_kernel_abort
L_ok_e_130:
    v_smfmac_f32_16x16x64_bf16 v[88:91], v[60:63], a[216:223], v6
    v_smfmac_f32_16x16x64_bf16 v[92:95], v[60:63], a[248:255], v6
    s_branch L_gd_e_120
L_q_e_125:
    buffer_load_dwordx4 v[56:59], v4, s[8:11], s41 offen sc1
    s_waitcnt vmcnt(1)
    v_max3_u32 v7, v60, v61, v62
    v_max_u32 v7, v7, v63
    v_cmp_eq_u32 vcc, s34, v7
    s_cbranch_vccnz L_q_e_131
L_v_e_132:
    v_smfmac_f32_16x16x64_bf16 v[88:91], v[60:63], a[216:223], v6
    s_waitcnt vmcnt(0)
    v_max3_u32 v7, v56, v57, v58
    v_max_u32 v7, v7, v59
    v_cmp_eq_u32 vcc, s34, v7
    v_smfmac_f32_16x16x64_bf16 v[92:95], v[60:63], a[248:255], v6
    s_cbranch_vccnz L_q_e_133
L_v_e_134:
    v_smfmac_f32_16x16x64_bf16 v[88:91], v[56:59], a[208:215], v6
    v_smfmac_f32_16x16x64_bf16 v[92:95], v[56:59], a[240:247], v6
    s_branch L_gd_e_120
L_q_e_133:
    buffer_load_dwordx4 v[56:59], v4, s[8:11], s41 offen sc1
    s_waitcnt vmcnt(2)
    v_max3_u32 v7, v56, v57, v58
    v_max_u32 v7, v7, v59
    v_cmp_eq_u32 vcc, s34, v7
    s_cbranch_vccz L_ok_e_135
    s_add_u32 s33, s33, 1
    s_cmp_gt_u32 s33, 0x100000
    s_cbranch_scc0 L_q_e_133
    s_branch chain_kernel_abort
L_ok_e_135:
    v_smfmac_f32_16x16x64_bf16 v[88:91], v[56:59], a[208:215], v6
    v_smfmac_f32_16x16x64_bf16 v[92:95], v[56:59], a[240:247], v6
    s_branch L_gd_e_120
L_q_e_131:
    buffer_load_dwordx4 v[60:63], v5, s[8:11], s41 offen sc1
    s_waitcnt vmcnt(1)
    v_max3_u32 v7, v56, v57, v58
    v_max_u32 v7, v7, v59
    v_cmp_eq_u32 vcc, s34, v7
    s_cbranch_vccnz L_q_e_136
L_v_e_137:
    v_smfmac_f32_16x16x64_bf16 v[88:91], v[56:59], a[208:215], v6
    s_waitcnt vmcnt(0)
    v_max3_u32 v7, v60, v61, v62
    v_max_u32 v7, v7, v63
    v_cmp_eq_u32 vcc, s34, v7
    v_smfmac_f32_16x16x64_bf16 v[92:95], v[56:59], a[240:247], v6
    s_cbranch_vccnz L_q_e_129
    s_branch L_v_e_128
L_q_e_136:
    buffer_load_dwordx4 v[56:59], v4, s[8:11], s41 offen sc1
    s_waitcnt vmcnt(2)
    v_max3_u32 v7, v60, v61, v62
    v_max_u32 v7, v7, v63
    v_cmp_eq_u32 vcc, s34, v7
    s_cbranch_vccz L_ok_e_138
    buffer_load_dwordx4 v[60:63], v5, s[8:11], s41 offen sc1
    s_waitcnt vmcnt(2)
    v_max3_u32 v7, v56, v57, v58
    v_max_u32 v7, v7, v59
    v_cmp_eq_u32 vcc, s34, v7
    s_cbranch_vccz L_ok_e_139
    s_add_u32 s33, s33, 1
    s_cmp_gt_u32 s33, 0x100000
    s_cbranch_scc0 L_q_e_136
    s_branch chain_kernel_abort
L_ok_e_138:
    v_smfmac_f32_16x16x64_bf16 v[88:91], v[60:63], a[216:223], v6
    v_smfmac_f32_16x16x64_bf16 v[92:95], v[60:63], a[248:255], v6
    s_branch L_q_e_133
L_ok_e_139:
    v_smfmac_f32_16x16x64_bf16 v[88:91], v[56:59], a[208:215], v6
    v_smfmac_f32_16x16x64_bf16 v[92:95], v[56:59], a[240:247], v6
    s_branch L_q_e_129
L_q_e_123:
    buffer_load_dwordx4 v[52:55], v3, s[8:11], s41 offen sc1
    s_waitcnt vmcnt(2)
    v_max3_u32 v7, v56, v57, v58
    v_max_u32 v7, v7, v59
    v_cmp_eq_u32 vcc, s34, v7
    s_cbranch_vccnz L_q_e_140
L_v_e_141:
    v_smfmac_f32_16x16x64_bf16 v[88:91], v[56:59], a[208:215], v6
    s_waitcnt vmcnt(1)
    v_max3_u32 v7, v60, v61, v62
    v_max_u32 v7, v7, v63
    v_cmp_eq_u32 vcc, s34, v7
    v_smfmac_f32_16x16x64_bf16 v[92:95], v[56:59], a[240:247], v6
    s_cbranch_vccnz L_q_e_142
L_v_e_143:
    v_smfmac_f32_16x16x64_bf16 v[88:91], v[60:63], a[216:223], v6
    s_waitcnt vmcnt(0)
    v_max3_u32 v7, v52, v53, v54
    v_max_u32 v7, v7, v55
    v_cmp_eq_u32 vcc, s34, v7
    v_smfmac_f32_16x16x64_bf16 v[92:95], v[60:63], a[248:255], v6
    s_cbranch_vccnz L_q_e_144
L_v_e_145:
    v_smfmac_f32_16x16x64_bf16 v[88:91], v[52:55], a[200:207], v6
    v_smfmac_f32_16x16x64_bf16 v[92:95], v[52:55], a[232:239], v6
    s_branch L_gd_e_120
L_q_e_144:
    buffer_load_dwordx4 v[52:55], v3, s[8:11], s41 offen sc1
    s_waitcnt vmcnt(2)
    v_max3_u32 v7, v52, v53, v54
    v_max_u32 v7, v7, v55
    v_cmp_eq_u32 vcc, s34, v7
    s_cbranch_vccz L_ok_e_146
    s_add_u32 s33, s33, 1
    s_cmp_gt_u32 s33, 0x100000
    s_cbranch_scc0 L_q_e_144
    s_branch chain_kernel_abort
L_ok_e_146:
    v_smfmac_f32_16x16x64_bf16 v[88:91], v[52:55], a[200:207], v6
    v_smfmac_f32_16x16x64_bf16 v[92:95], v[52:55], a[232:239], v6
    s_branch L_gd_e_120
L_q_e_142:
    buffer_load_dwordx4 v[60:63], v5, s[8:11], s41 offen sc1
    s_waitcnt vmcnt(1)
    v_max3_u32 v7, v52, v53, v54
    v_max_u32 v7, v7, v55
    v_cmp_eq_u32 vcc, s34, v7
    s_cbranch_vccnz L_q_e_147
L_v_e_148:
    v_smfmac_f32_16x16x64_bf16 v[88:91], v[52:55], a[200:207], v6
    s_waitcnt vmcnt(0)
    v_max3_u32 v7, v60, v61, v62
    v_max_u32 v7, v7, v63
    v_cmp_eq_u32 vcc, s34, v7
    v_smfmac_f32_16x16x64_bf16 v[92:95], v[52:55], a[232:239], v6
    s_cbranch_vccnz L_q_e_129
    s_branch L_v_e_128
L_q_e_147:
    buffer_load_dwordx4 v[52:55], v3, s[8:11], s41 offen sc1
    s_waitcnt vmcnt(2)
    v_max3_u32 v7, v60, v61, v62
    v_max_u32 v7, v7, v63
    v_cmp_eq_u32 vcc, s34, v7
    s_cbranch_vccz L_ok_e_149
    buffer_load_dwordx4 v[60:63], v5, s[8:11], s41 offen sc1
    s_waitcnt vmcnt(2)
    v_max3_u32 v7, v52, v53, v54
    v_max_u32 v7, v7, v55
    v_cmp_eq_u32 vcc, s34, v7
    s_cbranch_vccz L_ok_e_150
    s_add_u32 s33, s33, 1
    s_cmp_gt_u32 s33, 0x100000
    s_cbranch_scc0 L_q_e_147
    s_branch chain_kernel_abort
L_ok_e_149:
    v_smfmac_f32_16x16x64_bf16 v[88:91], v[60:63], a[216:223], v6
    v_smfmac_f32_16x16x64_bf16 v[92:95], v[60:63], a[248:255], v6
    s_branch L_q_e_144
L_ok_e_150:
    v_smfmac_f32_16x16x64_bf16 v[88:91], v[52:55], a[200:207], v6
    v_smfmac_f32_16x16x64_bf16 v[92:95], v[52:55], a[232:239], v6
    s_branch L_q_e_129
L_q_e_140:
    buffer_load_dwordx4 v[56:59], v4, s[8:11], s41 offen sc1
    s_waitcnt vmcnt(2)
    v_max3_u32 v7, v60, v61, v62
    v_max_u32 v7, v7, v63
    v_cmp_eq_u32 vcc, s34, v7
    s_cbranch_vccnz L_q_e_151
L_v_e_152:
    v_smfmac_f32_16x16x64_bf16 v[88:91], v[60:63], a[216:223], v6
    s_waitcnt vmcnt(1)
    v_max3_u32 v7, v52, v53, v54
    v_max_u32 v7, v7, v55
    v_cmp_eq_u32 vcc, s34, v7
    v_smfmac_f32_16x16x64_bf16 v[92:95], v[60:63], a[248:255], v6
    s_cbranch_vccnz L_q_e_153
L_v_e_154:
    v_smfmac_f32_16x16x64_bf16 v[88:91], v[52:55], a[200:207], v6
    s_waitcnt vmcnt(0)
    v_max3_u32 v7, v56, v57, v58
    v_max_u32 v7, v7, v59
    v_cmp_eq_u32 vcc, s34, v7
    v_smfmac_f32_16x16x64_bf16 v[92:95], v[52:55], a[232:239], v6
    s_cbranch_vccnz L_q_e_133
    s_branch L_v_e_134
L_q_e_153:
    buffer_load_dwordx4 v[52:55], v3, s[8:11], s41 offen sc1
    s_waitcnt vmcnt(2)
    v_max3_u32 v7, v56, v57, v58
    v_max_u32 v7, v7, v59
    v_cmp_eq_u32 vcc, s34, v7
    s_cbranch_vccz L_ok_e_155
    buffer_load_dwordx4 v[56:59], v4, s[8:11], s41 offen sc1
    s_waitcnt vmcnt(2)
    v_max3_u32 v7, v52, v53, v54
    v_max_u32 v7, v7, v55
    v_cmp_eq_u32 vcc, s34, v7
    s_cbranch_vccz L_ok_e_156
    s_add_u32 s33, s33, 1
    s_cmp_gt_u32 s33, 0x100000
    s_cbranch_scc0 L_q_e_153
    s_branch chain_kernel_abort
L_ok_e_155:
    v_smfmac_f32_16x16x64_bf16 v[88:91], v[56:59], a[208:215], v6
    v_smfmac_f32_16x16x64_bf16 v[92:95], v[56:59], a[240:247], v6
    s_branch L_q_e_144
L_ok_e_156:
    v_smfmac_f32_16x16x64_bf16 v[88:91], v[52:55], a[200:207], v6
    v_smfmac_f32_16x16x64_bf16 v[92:95], v[52:55], a[232:239], v6
    s_branch L_q_e_133
L_q_e_151:
    buffer_load_dwordx4 v[60:63], v5, s[8:11], s41 offen sc1
    s_waitcnt vmcnt(2)
    v_max3_u32 v7, v52, v53, v54
    v_max_u32 v7, v7, v55
    v_cmp_eq_u32 vcc, s34, v7
    s_cbranch_vccnz L_q_e_157
L_v_e_158:
    v_smfmac_f32_16x16x64_bf16 v[88:91], v[52:55], a[200:207], v6
    s_waitcnt vmcnt(1)
    v_max3_u32 v7, v56, v57, v58
    v_max_u32 v7, v7, v59
    v_cmp_eq_u32 vcc, s34, v7
    v_smfmac_f32_16x16x64_bf16 v[92:95], v[52:55], a[232:239], v6
    s_cbranch_vccnz L_q_e_136
    s_branch L_v_e_137
L_q_e_157:
    buffer_load_dwordx4 v[52:55], v3, s[8:11], s41 offen sc1
    s_waitcnt vmcnt(2)
    v_max3_u32 v7, v56, v57, v58
    v_max_u32 v7, v7, v59
    v_cmp_eq_u32 vcc, s34, v7
    s_cbranch_vccz L_ok_e_159
    buffer_load_dwordx4 v[56:59], v4, s[8:11], s41 offen sc1
    s_waitcnt vmcnt(2)
    v_max3_u32 v7, v60, v61, v62
    v_max_u32 v7, v7, v63
    v_cmp_eq_u32 vcc, s34, v7
    s_cbranch_vccz L_ok_e_160
    buffer_load_dwordx4 v[60:63], v5, s[8:11], s41 offen sc1
    s_waitcnt vmcnt(2)
    v_max3_u32 v7, v52, v53, v54
    v_max_u32 v7, v7, v55
    v_cmp_eq_u32 vcc, s34, v7
    s_cbranch_vccz L_ok_e_161
    s_add_u32 s33, s33, 1
    s_cmp_gt_u32 s33, 0x100000
    s_cbranch_scc0 L_q_e_157
    s_branch chain_kernel_abort
L_ok_e_159:
    v_smfmac_f32_16x16x64_bf16 v[88:91], v[56:59], a[208:215], v6
    v_smfmac_f32_16x16x64_bf16 v[92:95], v[56:59], a[240:247], v6
    s_branch L_q_e_147
L_ok_e_160:
    v_smfmac_f32_16x16x64_bf16 v[88:91], v[60:63], a[216:223], v6
    v_smfmac_f32_16x16x64_bf16 v[92:95], v[60:63], a[248:255], v6
    s_branch L_q_e_153
L_ok_e_161:
    v_smfmac_f32_16x16x64_bf16 v[88:91], v[52:55], a[200:207], v6
    v_smfmac_f32_16x16x64_bf16 v[92:95], v[52:55], a[232:239], v6
    s_branch L_q_e_136
L_q_e_121:
    buffer_load_dwordx4 v[48:51], v2, s[8:11], s41 offen sc1
    s_waitcnt vmcnt(3)
    v_max3_u32 v7, v52, v53, v54
    v_max_u32 v7, v7, v55
    v_cmp_eq_u32 vcc, s34, v7
    s_cbranch_vccnz L_q_e_162
L_v_e_163:
    v_smfmac_f32_16x16x64_bf16 v[88:91], v[52:55], a[200:207], v6
    s_waitcnt vmcnt(2)
    v_max3_u32 v7, v56, v57, v58
    v_max_u32 v7, v7, v59
    v_cmp_eq_u32 vcc, s34, v7
    v_smfmac_f32_16x16x64_bf16 v[92:95], v[52:55], a[232:239], v6
    s_cbranch_vccnz L_q_e_164
L_v_e_165:
    v_smfmac_f32_16x16x64_bf16 v[88:91], v[56:59], a[208:215], v6
    s_waitcnt vmcnt(1)
    v_max3_u32 v7, v60, v61, v62
    v_max_u32 v7, v7, v63
    v_cmp_eq_u32 vcc, s34, v7
    v_smfmac_f32_16x16x64_bf16 v[92:95], v[56:59], a[240:247], v6
    s_cbranch_vccnz L_q_e_166
L_v_e_167:
    v_smfmac_f32_16x16x64_bf16 v[88:91], v[60:63], a[216:223], v6
    s_waitcnt vmcnt(0)
    v_max3_u32 v7, v48, v49, v50
    v_max_u32 v7, v7, v51
    v_cmp_eq_u32 vcc, s34, v7
    v_smfmac_f32_16x16x64_bf16 v[92:95], v[60:63], a[248:255], v6
    s_cbranch_vccnz L_q_e_168
L_v_e_169:
    v_smfmac_f32_16x16x64_bf16 v[88:91], v[48:51], a[192:199], v6
    v_smfmac_f32_16x16x64_bf16 v[92:95], v[48:51], a[224:231], v6
    s_branch L_gd_e_120
L_q_e_168:
    buffer_load_dwordx4 v[48:51], v2, s[8:11], s41 offen sc1
    s_waitcnt vmcnt(2)
    v_max3_u32 v7, v48, v49, v50
    v_max_u32 v7, v7, v51
    v_cmp_eq_u32 vcc, s34, v7
    s_cbranch_vccz L_ok_e_170
    s_add_u32 s33, s33, 1
    s_cmp_gt_u32 s33, 0x100000
    s_cbranch_scc0 L_q_e_168
    s_branch chain_kernel_abort
L_ok_e_170:
    v_smfmac_f32_16x16x64_bf16 v[88:91], v[48:51], a[192:199], v6
    v_smfmac_f32_16x16x64_bf16 v[92:95], v[48:51], a[224:231], v6
    s_branch L_gd_e_120
L_q_e_166:
    buffer_load_dwordx4 v[60:63], v5, s[8:11], s41 offen sc1
    s_waitcnt vmcnt(1)
    v_max3_u32 v7, v48, v49, v50
    v_max_u32 v7, v7, v51
    v_cmp_eq_u32 vcc, s34, v7
    s_cbranch_vccnz L_q_e_171
L_v_e_172:
    v_smfmac_f32_16x16x64_bf16 v[88:91], v[48:51], a[192:199], v6
    s_waitcnt vmcnt(0)
    v_max3_u32 v7, v60, v61, v62
    v_max_u32 v7, v7, v63
    v_cmp_eq_u32 vcc, s34, v7
    v_smfmac_f32_16x16x64_bf16 v[92:95], v[48:51], a[224:231], v6
    s_cbranch_vccnz L_q_e_129
    s_branch L_v_e_128
L_q_e_171:
    buffer_load_dwordx4 v[48:51], v2, s[8:11], s41 offen sc1
    s_waitcnt vmcnt(2)
    v_max3_u32 v7, v60, v61, v62
    v_max_u32 v7, v7, v63
    v_cmp_eq_u32 vcc, s34, v7
    s_cbranch_vccz L_ok_e_173
    buffer_load_dwordx4 v[60:63], v5, s[8:11], s41 offen sc1
    s_waitcnt vmcnt(2)
    v_max3_u32 v7, v48, v49, v50
    v_max_u32 v7, v7, v51
    v_cmp_eq_u32 vcc, s34, v7
    s_cbranch_vccz L_ok_e_174
    s_add_u32 s33, s33, 1
    s_cmp_gt_u32 s33, 0x100000
    s_cbranch_scc0 L_q_e_171
    s_branch chain_kernel_abort
L_ok_e_173:
    v_smfmac_f32_16x16x64_bf16 v[88:91], v[60:63], a[216:223], v6
    v_smfmac_f32_16x16x64_bf16 v[92:95], v[60:63], a[248:255], v6
    s_branch L_q_e_168
L_ok_e_174:
    v_smfmac_f32_16x16x64_bf16 v[88:91], v[48:51], a[192:199], v6
    v_smfmac_f32_16x16x64_bf16 v[92:95], v[48:51], a[224:231], v6
    s_branch L_q_e_129
L_q_e_164:
    buffer_load_dwordx4 v[56:59], v4, s[8:11], s41 offen sc1
    s_waitcnt vmcnt(2)
    v_max3_u32 v7, v60, v61, v62
    v_max_u32 v7, v7, v63
    v_cmp_eq_u32 vcc, s34, v7
    s_cbranch_vccnz L_q_e_175
L_v_e_176:
    v_smfmac_f32_16x16x64_bf16 v[88:91], v[60:63], a[216:223], v6
    s_waitcnt vmcnt(1)
    v_max3_u32 v7, v48, v49, v50
    v_max_u32 v7, v7, v51
    v_cmp_eq_u32 vcc, s34, v7
    v_smfmac_f32_16x16x64_bf16 v[92:95], v[60:63], a[248:255], v6
    s_cbranch_vccnz L_q_e_177
L_v_e_178:
    v_smfmac_f32_16x16x64_bf16 v[88:91], v[48:51], a[192:199], v6
    s_waitcnt vmcnt(0)
    v_max3_u32 v7, v56, v57, v58
    v_max_u32 v7, v7, v59
    v_cmp_eq_u32 vcc, s34, v7
    v_smfmac_f32_16x16x64_bf16 v[92:95], v[48:51], a[224:231], v6
    s_cbranch_vccnz L_q_e_133
    s_branch L_v_e_134
L_q_e_177:
    buffer_load_dwordx4 v[48:51], v2, s[8:11], s41 offen sc1
    s_waitcnt vmcnt(2)
    v_max3_u32 v7, v56, v57, v58
    v_max_u32 v7, v7, v59
    v_cmp_eq_u32 vcc, s34, v7
    s_cbranch_vccz L_ok_e_179
    buffer_load_dwordx4 v[56:59], v4, s[8:11], s41 offen sc1
    s_waitcnt vmcnt(2)
    v_max3_u32 v7, v48, v49, v50
    v_max_u32 v7, v7, v51
    v_cmp_eq_u32 vcc, s34, v7
    s_cbranch_vccz L_ok_e_180
    s_add_u32 s33, s33, 1
    s_cmp_gt_u32 s33, 0x100000
    s_cbranch_scc0 L_q_e_177
    s_branch chain_kernel_abort
L_ok_e_179:
    v_smfmac_f32_16x16x64_bf16 v[88:91], v[56:59], a[208:215], v6
    v_smfmac_f32_16x16x64_bf16 v[92:95], v[56:59], a[240:247], v6
    s_branch L_q_e_168
L_ok_e_180:
    v_smfmac_f32_16x16x64_bf16 v[88:91], v[48:51], a[192:199], v6
    v_smfmac_f32_16x16x64_bf16 v[92:95], v[48:51], a[224:231], v6
    s_branch L_q_e_133
L_q_e_175:
    buffer_load_dwordx4 v[60:63], v5, s[8:11], s41 offen sc1
    s_waitcnt vmcnt(2)
    v_max3_u32 v7, v48, v49, v50
    v_max_u32 v7, v7, v51
    v_cmp_eq_u32 vcc, s34, v7
    s_cbranch_vccnz L_q_e_181
L_v_e_182:
    v_smfmac_f32_16x16x64_bf16 v[88:91], v[48:51], a[192:199], v6
    s_waitcnt vmcnt(1)
    v_max3_u32 v7, v56, v57, v58
    v_max_u32 v7, v7, v59
    v_cmp_eq_u32 vcc, s34, v7
    v_smfmac_f32_16x16x64_bf16 v[92:95], v[48:51], a[224:231], v6
    s_cbranch_vccnz L_q_e_136
    s_branch L_v_e_137
L_q_e_181:
    buffer_load_dwordx4 v[48:51], v2, s[8:11], s41 offen sc1
    s_waitcnt vmcnt(2)
    v_max3_u32 v7, v56, v57, v58
    v_max_u32 v7, v7, v59
    v_cmp_eq_u32 vcc, s34, v7
    s_cbranch_vccz L_ok_e_183
    buffer_load_dwordx4 v[56:59], v4, s[8:11], s41 offen sc1
    s_waitcnt vmcnt(2)
    v_max3_u32 v7, v60, v61, v62
    v_max_u32 v7, v7, v63
    v_cmp_eq_u32 vcc, s34, v7
    s_cbranch_vccz L_ok_e_184
    buffer_load_dwordx4 v[60:63], v5, s[8:11], s41 offen sc1
    s_waitcnt vmcnt(2)
    v_max3_u32 v7, v48, v49, v50
    v_max_u32 v7, v7, v51
    v_cmp_eq_u32 vcc, s34, v7
    s_cbranch_vccz L_ok_e_185
    s_add_u32 s33, s33, 1
    s_cmp_gt_u32 s33, 0x100000
    s_cbranch_scc0 L_q_e_181
    s_branch chain_kernel_abort
L_ok_e_183:
    v_smfmac_f32_16x16x64_bf16 v[88:91], v[56:59], a[208:215], v6
    v_smfmac_f32_16x16x64_bf16 v[92:95], v[56:59], a[240:247], v6
    s_branch L_q_e_171
L_ok_e_184:
    v_smfmac_f32_16x16x64_bf16 v[88:91], v[60:63], a[216:223], v6
    v_smfmac_f32_16x16x64_bf16 v[92:95], v[60:63], a[248:255], v6
    s_branch L_q_e_177
L_ok_e_185:
    v_smfmac_f32_16x16x64_bf16 v[88:91], v[48:51], a[192:199], v6
    v_smfmac_f32_16x16x64_bf16 v[92:95], v[48:51], a[224:231], v6
    s_branch L_q_e_136
L_q_e_162:
    buffer_load_dwordx4 v[52:55], v3, s[8:11], s41 offen sc1
    s_waitcnt vmcnt(3)
    v_max3_u32 v7, v56, v57, v58
    v_max_u32 v7, v7, v59
    v_cmp_eq_u32 vcc, s34, v7
    s_cbranch_vccnz L_q_e_186
L_v_e_187:
    v_smfmac_f32_16x16x64_bf16 v[88:91], v[56:59], a[208:215], v6
    s_waitcnt vmcnt(2)
    v_max3_u32 v7, v60, v61, v62
    v_max_u32 v7, v7, v63
    v_cmp_eq_u32 vcc, s34, v7
    v_smfmac_f32_16x16x64_bf16 v[92:95], v[56:59], a[240:247], v6
    s_cbranch_vccnz L_q_e_188
L_v_e_189:
    v_smfmac_f32_16x16x64_bf16 v[88:91], v[60:63], a[216:223], v6
    s_waitcnt vmcnt(1)
    v_max3_u32 v7, v48, v49, v50
    v_max_u32 v7, v7, v51
    v_cmp_eq_u32 vcc, s34, v7
    v_smfmac_f32_16x16x64_bf16 v[92:95], v[60:63], a[248:255], v6
    s_cbranch_vccnz L_q_e_190
L_v_e_191:
    v_smfmac_f32_16x16x64_bf16 v[88:91], v[48:51], a[192:199], v6
    s_waitcnt vmcnt(0)
    v_max3_u32 v7, v52, v53, v54
    v_max_u32 v7, v7, v55
    v_cmp_eq_u32 vcc, s34, v7
    v_smfmac_f32_16x16x64_bf16 v[92:95], v[48:51], a[224:231], v6
    s_cbranch_vccnz L_q_e_144
    s_branch L_v_e_145
L_q_e_190:
    buffer_load_dwordx4 v[48:51], v2, s[8:11], s41 offen sc1
    s_waitcnt vmcnt(2)
    v_max3_u32 v7, v52, v53, v54
    v_max_u32 v7, v7, v55
    v_cmp_eq_u32 vcc, s34, v7
    s_cbranch_vccz L_ok_e_192
    buffer_load_dwordx4 v[52:55], v3, s[8:11], s41 offen sc1
    s_waitcnt vmcnt(2)
    v_max3_u32 v7, v48, v49, v50
    v_max_u32 v7, v7, v51
    v_cmp_eq_u32 vcc, s34, v7
    s_cbranch_vccz L_ok_e_193
    s_add_u32 s33, s33, 1
    s_cmp_gt_u32 s33, 0x100000
    s_cbranch_scc0 L_q_e_190
    s_branch chain_kernel_abort
L_ok_e_192:
    v_smfmac_f32_16x16x64_bf16 v[88:91], v[52:55], a[200:207], v6
    v_smfmac_f32_16x16x64_bf16 v[92:95], v[52:55], a[232:239], v6
    s_branch L_q_e_168
L_ok_e_193:
    v_smfmac_f32_16x16x64_bf16 v[88:91], v[48:51], a[192:199], v6
    v_smfmac_f32_16x16x64_bf16 v[92:95], v[48:51], a[224:231], v6
    s_branch L_q_e_144
L_q_e_188:
    buffer_load_dwordx4 v[60:63], v5, s[8:11], s41 offen sc1
    s_waitcnt vmcnt(2)
    v_max3_u32 v7, v48, v49, v50
    v_max_u32 v7, v7, v51
    v_cmp_eq_u32 vcc, s34, v7
    s_cbranch_vccnz L_q_e_194
L_v_e_195:
    v_smfmac_f32_16x16x64_bf16 v[88:91], v[48:51], a[192:199], v6
    s_waitcnt vmcnt(1)
    v_max3_u32 v7, v52, v53, v54
    v_max_u32 v7, v7, v55
    v_cmp_eq_u32 vcc, s34, v7
    v_smfmac_f32_16x16x64_bf16 v[92:95], v[48:51], a[224:231], v6
    s_cbranch_vccnz L_q_e_147
    s_branch L_v_e_148
L_q_e_194:
    buffer_load_dwordx4 v[48:51], v2, s[8:11], s41 offen sc1
    s_waitcnt vmcnt(2)
    v_max3_u32 v7, v52, v53, v54
    v_max_u32 v7, v7, v55
    v_cmp_eq_u32 vcc, s34, v7
    s_cbranch_vccz L_ok_e_196
    buffer_load_dwordx4 v[52:55], v3, s[8:11], s41 offen sc1
    s_waitcnt vmcnt(2)
    v_max3_u32 v7, v60, v61, v62
    v_max_u32 v7, v7, v63
    v_cmp_eq_u32 vcc, s34, v7
    s_cbranch_vccz L_ok_e_197
    buffer_load_dwordx4 v[60:63], v5, s[8:11], s41 offen sc1
    s_waitcnt vmcnt(2)
    v_max3_u32 v7, v48, v49, v50
    v_max_u32 v7, v7, v51
    v_cmp_eq_u32 vcc, s34, v7
    s_cbranch_vccz L_ok_e_198
    s_add_u32 s33, s33, 1
    s_cmp_gt_u32 s33, 0x100000
    s_cbranch_scc0 L_q_e_194
    s_branch chain_kernel_abort
L_ok_e_196:
    v_smfmac_f32_16x16x64_bf16 v[88:91], v[52:55], a[200:207], v6
    v_smfmac_f32_16x16x64_bf16 v[92:95], v[52:55], a[232:239], v6
    s_branch L_q_e_171
L_ok_e_197:
    v_smfmac_f32_16x16x64_bf16 v[88:91], v[60:63], a[216:223], v6
    v_smfmac_f32_16x16x64_bf16 v[92:95], v[60:63], a[248:255], v6
    s_branch L_q_e_190
L_ok_e_198:
    v_smfmac_f32_16x16x64_bf16 v[88:91], v[48:51], a[192:199], v6
    v_smfmac_f32_16x16x64_bf16 v[92:95], v[48:51], a[224:231], v6
    s_branch L_q_e_147
L_q_e_186:
    buffer_load_dwordx4 v[56:59], v4, s[8:11], s41 offen sc1
    s_waitcnt vmcnt(3)
    v_max3_u32 v7, v60, v61, v62
    v_max_u32 v7, v7, v63
    v_cmp_eq_u32 vcc, s34, v7
    s_cbranch_vccnz L_q_e_199
L_v_e_200:
    v_smfmac_f32_16x16x64_bf16 v[88:91], v[60:63], a[216:223], v6
    s_waitcnt vmcnt(2)
    v_max3_u32 v7, v48, v49, v50
    v_max_u32 v7, v7, v51
    v_cmp_eq_u32 vcc, s34, v7
    v_smfmac_f32_16x16x64_bf16 v[92:95], v[60:63], a[248:255], v6
    s_cbranch_vccnz L_q_e_201
L_v_e_202:
    v_smfmac_f32_16x16x64_bf16 v[88:91], v[48:51], a[192:199], v6
    s_waitcnt vmcnt(1)
    v_max3_u32 v7, v52, v53, v54
    v_max_u32 v7, v7, v55
    v_cmp_eq_u32 vcc, s34, v7
    v_smfmac_f32_16x16x64_bf16 v[92:95], v[48:51], a[224:231], v6
    s_cbranch_vccnz L_q_e_153
    s_branch L_v_e_154
L_q_e_201:
    buffer_load_dwordx4 v[48:51], v2, s[8:11], s41 offen sc1
    s_waitcnt vmcnt(2)
    v_max3_u32 v7, v52, v53, v54
    v_max_u32 v7, v7, v55
    v_cmp_eq_u32 vcc, s34, v7
    s_cbranch_vccz L_ok_e_203
    buffer_load_dwordx4 v[52:55], v3, s[8:11], s41 offen sc1
    s_waitcnt vmcnt(2)
    v_max3_u32 v7, v56, v57, v58
    v_max_u32 v7, v7, v59
    v_cmp_eq_u32 vcc, s34, v7
    s_cbranch_vccz L_ok_e_204
    buffer_load_dwordx4 v[56:59], v4, s[8:11], s41 offen sc1
    s_waitcnt vmcnt(2)
    v_max3_u32 v7, v48, v49, v50
    v_max_u32 v7, v7, v51
    v_cmp_eq_u32 vcc, s34, v7
    s_cbranch_vccz L_ok_e_205
    s_add_u32 s33, s33, 1
    s_cmp_gt_u32 s33, 0x100000
    s_cbranch_scc0 L_q_e_201
    s_branch chain_kernel_abort
L_ok_e_203:
    v_smfmac_f32_16x16x64_bf16 v[88:91], v[52:55], a[200:207], v6
    v_smfmac_f32_16x16x64_bf16 v[92:95], v[52:55], a[232:239], v6
    s_branch L_q_e_177
L_ok_e_204:
    v_smfmac_f32_16x16x64_bf16 v[88:91], v[56:59], a[208:215], v6
    v_smfmac_f32_16x16x64_bf16 v[92:95], v[56:59], a[240:247], v6
    s_branch L_q_e_190
L_ok_e_205:
    v_smfmac_f32_16x16x64_bf16 v[88:91], v[48:51], a[192:199], v6
    v_smfmac_f32_16x16x64_bf16 v[92:95], v[48:51], a[224:231], v6
    s_branch L_q_e_153
L_q_e_199:
    buffer_load_dwordx4 v[60:63], v5, s[8:11], s41 offen sc1
    s_waitcnt vmcnt(3)
    v_max3_u32 v7, v48, v49, v50
    v_max_u32 v7, v7, v51
    v_cmp_eq_u32 vcc, s34, v7
    s_cbranch_vccnz L_q_e_206
L_v_e_207:
    v_smfmac_f32_16x16x64_bf16 v[88:91], v[48:51], a[192:199], v6
    s_waitcnt vmcnt(2)
    v_max3_u32 v7, v52, v53, v54
    v_max_u32 v7, v7, v55
    v_cmp_eq_u32 vcc, s34, v7
    v_smfmac_f32_16x16x64_bf16 v[92:95], v[48:51], a[224:231], v6
    s_cbranch_vccnz L_q_e_157
    s_branch L_v_e_158
L_q_e_206:
    buffer_load_dwordx4 v[48:51], v2, s[8:11], s41 offen sc1
    s_waitcnt vmcnt(2)
    v_max3_u32 v7, v52, v53, v54
    v_max_u32 v7, v7, v55
    v_cmp_eq_u32 vcc, s34, v7
    s_cbranch_vccz L_ok_e_208
    buffer_load_dwordx4 v[52:55], v3, s[8:11], s41 offen sc1
    s_waitcnt vmcnt(2)
    v_max3_u32 v7, v56, v57, v58
    v_max_u32 v7, v7, v59
    v_cmp_eq_u32 vcc, s34, v7
    s_cbranch_vccz L_ok_e_209
    buffer_load_dwordx4 v[56:59], v4, s[8:11], s41 offen sc1
    s_waitcnt vmcnt(2)
    v_max3_u32 v7, v60, v61, v62
    v_max_u32 v7, v7, v63
    v_cmp_eq_u32 vcc, s34, v7
    s_cbranch_vccz L_ok_e_210
    buffer_load_dwordx4 v[60:63], v5, s[8:11], s41 offen sc1
    s_waitcnt vmcnt(2)
    v_max3_u32 v7, v48, v49, v50
    v_max_u32 v7, v7, v51
    v_cmp_eq_u32 vcc, s34, v7
    s_cbranch_vccz L_ok_e_211
    s_add_u32 s33, s33, 1
    s_cmp_gt_u32 s33, 0x100000
    s_cbranch_scc0 L_q_e_206
    s_branch chain_kernel_abort
L_ok_e_208:
    v_smfmac_f32_16x16x64_bf16 v[88:91], v[52:55], a[200:207], v6
    v_smfmac_f32_16x16x64_bf16 v[92:95], v[52:55], a[232:239], v6
    s_branch L_q_e_181
L_ok_e_209:
    v_smfmac_f32_16x16x64_bf16 v[88:91], v[56:59], a[208:215], v6
    v_smfmac_f32_16x16x64_bf16 v[92:95], v[56:59], a[240:247], v6
    s_branch L_q_e_194
L_ok_e_210:
    v_smfmac_f32_16x16x64_bf16 v[88:91], v[60:63], a[216:223], v6
    v_smfmac_f32_16x16x64_bf16 v[92:95], v[60:63], a[248:255], v6
    s_branch L_q_e_201
L_ok_e_211:
    v_smfmac_f32_16x16x64_bf16 v[88:91], v[48:51], a[192:199], v6
    v_smfmac_f32_16x16x64_bf16 v[92:95], v[48:51], a[224:231], v6
    s_branch L_q_e_157
L_gf_212:
    s_waitcnt vmcnt(4)
    v_lshlrev_b32 v100, 16, v212
    v_and_b32 v101, 0xffff0000, v212
    v_lshlrev_b32 v102, 16, v213
    v_and_b32 v103, 0xffff0000, v213
    v_pk_add_f32 v[148:149], v[168:169], v[100:101]
    v_pk_add_f32 v[150:151], v[170:171], v[102:103]
    s_waitcnt vmcnt(3)
    v_lshlrev_b32 v100, 16, v214
    v_and_b32 v101, 0xffff0000, v214
    v_lshlrev_b32 v102, 16, v215
    v_and_b32 v103, 0xffff0000, v215
    v_pk_add_f32 v[148:149], v[148:149], v[100:101]
    v_pk_add_f32 v[150:151], v[150:151], v[102:103]
    s_waitcnt vmcnt(2)
    v_lshlrev_b32 v100, 16, v216
    v_and_b32 v101, 0xffff0000, v216
    v_lshlrev_b32 v102, 16, v217
    v_and_b32 v103, 0xffff0000, v217
    v_pk_add_f32 v[148:149], v[148:149], v[100:101]
    v_pk_add_f32 v[150:151], v[150:151], v[102:103]
    v_cmp_u_f32 vcc, v148, v150
    v_cvt_pk_bf16_f32 v180, v148, v149
    v_cvt_pk_bf16_f32 v181, v150, v151
    s_cbranch_vccz L_gok_213
    buffer_load_dwordx2 v[212:213], v17, s[8:11], s22 offen offset:512 sc1
    buffer_load_dwordx2 v[214:215], v18, s[8:11], s22 offen offset:512 sc1
    buffer_load_dwordx2 v[216:217], v19, s[8:11], s22 offen offset:512 sc1
    s_nop 11
L_rt_215:
    buffer_load_dwordx2 v[200:201], v17, s[8:11], s22 offen offset:0 sc1
    buffer_load_dwordx2 v[202:203], v18, s[8:11], s22 offen offset:0 sc1
    buffer_load_dwordx2 v[204:205], v19, s[8:11], s22 offen offset:0 sc1
    s_waitcnt vmcnt(5)
    v_lshlrev_b32 v100, 16, v212
    v_and_b32 v101, 0xffff0000, v212
    v_lshlrev_b32 v102, 16, v213
    v_and_b32 v103, 0xffff0000, v213
    v_pk_add_f32 v[148:149], v[168:169], v[100:101]
    v_pk_add_f32 v[150:151], v[170:171], v[102:103]
    s_waitcnt vmcnt(4)
    v_lshlrev_b32 v100, 16, v214
    v_and_b32 v101, 0xffff0000, v214
    v_lshlrev_b32 v102, 16, v215
    v_and_b32 v103, 0xffff0000, v215
    v_pk_add_f32 v[148:149], v[148:149], v[100:101]
    v_pk_add_f32 v[150:151], v[150:151], v[102:103]
    s_waitcnt vmcnt(3)
    v_lshlrev_b32 v100, 16, v216
    v_and_b32 v101, 0xffff0000, v216
    v_lshlrev_b32 v102, 16, v217
    v_and_b32 v103, 0xffff0000, v217
    v_pk_add_f32 v[148:149], v[148:149], v[100:101]
    v_pk_add_f32 v[150:151], v[150:151], v[102:103]
    v_cmp_u_f32 vcc, v148, v150
    v_cvt_pk_bf16_f32 v180, v148, v149
    v_cvt_pk_bf16_f32 v181, v150, v151
    s_cbranch_vccz L_gok_213
    buffer_load_dwordx2 v[212:213], v17, s[8:11], s22 offen offset:512 sc1
    buffer_load_dwordx2 v[214:215], v18, s[8:11], s22 offen offset:512 sc1
    buffer_load_dwordx2 v[216:217], v19, s[8:11], s22 offen offset:512 sc1
    s_waitcnt vmcnt(5)
    v_lshlrev_b32 v100, 16, v200
    v_and_b32 v101, 0xffff0000, v200
    v_lshlrev_b32 v102, 16, v201
    v_and_b32 v103, 0xffff0000, v201
    v_pk_add_f32 v[148:149], v[168:169], v[100:101]
    v_pk_add_f32 v[150:151], v[170:171], v[102:103]
    s_waitcnt vmcnt(4)
    v_lshlrev_b32 v100, 16, v202
    v_and_b32 v101, 0xffff0000, v202
    v_lshlrev_b32 v102, 16, v203
    v_and_b32 v103, 0xffff0000, v203
    v_pk_add_f32 v[148:149], v[148:149], v[100:101]
    v_pk_add_f32 v[150:151], v[150:151], v[102:103]
    s_waitcnt vmcnt(3)
    v_lshlrev_b32 v100, 16, v204
    v_and_b32 v101, 0xffff0000, v204
    v_lshlrev_b32 v102, 16, v205
    v_and_b32 v103, 0xffff0000, v205
    v_pk_add_f32 v[148:149], v[148:149], v[100:101]
    v_pk_add_f32 v[150:151], v[150:151], v[102:103]
    v_cmp_u_f32 vcc, v148, v150
    v_cvt_pk_bf16_f32 v180, v148, v149
    v_cvt_pk_bf16_f32 v181, v150, v151
    s_cbranch_vccz L_gok_213
    s_add_u32 s33, s33, 1
    s_cmp_gt_u32 s33, 0x100000
    s_cbranch_scc1 chain_kernel_abort
    s_and_b32 s20, s33, 63
    s_cbranch_scc1 L_rt_215
    v_cmp_eq_u32 vcc, s34, v200
    v_cmp_eq_u32 s[20:21], s34, v201
    s_or_b64 vcc, vcc, s[20:21]
    v_cmp_eq_u32 s[20:21], s34, v202
    s_or_b64 vcc, vcc, s[20:21]
    v_cmp_eq_u32 s[20:21], s34, v203
    s_or_b64 vcc, vcc, s[20:21]
    v_cmp_eq_u32 s[20:21], s34, v204
    s_or_b64 vcc, vcc, s[20:21]
    v_cmp_eq_u32 s[20:21], s34, v205
    s_or_b64 vcc, vcc, s[20:21]
    s_cbranch_vccnz L_rt_215
    s_branch L_gok_213
chain_kernel_abort:
    s_mov_b64 exec, 1
    v_mov_b32 v1, s19
    v_or_b32 v1, 0xdead0000, v1
    v_mov_b32 v2, 124
    buffer_store_dword v1, v2, s[12:15], 0 offen
chain_kernel_done:
    s_endpgm
chain_kernel_worker:
    s_sub_u32 s40, s16, 4
    s_lshl_b32 s40, s40, 2
    s_lshr_b32 s40, 0x3210, s40
    s_and_b32 s40, s40, 3
    s_mov_b32 s41, s17
    s_mov_b32 s49, s18
    s_mov_b32 s12, s100
    s_and_b32 s13, s101, 0xffff
    s_mov_b32 s14, 0x10000000
    s_mov_b32 s15, 0x00020000
    s_mov_b32 s36, 0
    v_mov_b32 v84, 1
    v_min_u32 v85, 1, v0
    v_lshlrev_b32 v85, 30, v85
    s_cmp_eq_u32 s40, 3
    s_cbranch_scc1 L_g1_221
    s_mov_b32 s25, s40
    s_cmp_eq_u32 s25, 1
    s_cselect_b32 s16, s90, s88
    s_cselect_b32 s17, s91, s89
    s_cmp_eq_u32 s25, 2
    s_cselect_b32 s16, s86, s16
    s_cselect_b32 s17, s87, s17
    s_and_b32 s17, s17, 0xffff
    s_mov_b32 s18, 0x800000
    s_mov_b32 s19, 0x00020000
    s_mov_b32 s46, s41
    s_lshl_b32 s44, s46, 8
    s_mov_b32 s8, s82
    s_and_b32 s9, s83, 0xffff
    s_mov_b32 s10, 0x400000
    s_mov_b32 s11, 0x00020000
    v_lshlrev_b32 v1, 4, v0
    s_lshl_b32 s25, s41, 12
    buffer_load_dwordx4 v[52:55], v1, s[8:11], s25 offen
    s_add_u32 s25, s25, 131072
    buffer_load_dwordx4 v[52:55], v1, s[8:11], s25 offen
    s_add_u32 s25, s25, 131072
    v_and_b32 v1, 15, v0
    v_bfe_u32 v2, v0, 4, 2
    v_lshrrev_b32 v3, 6, v0
    v_lshlrev_b32 v4, 2, v2
    v_xor_b32 v4, v4, v1
    v_lshlrev_b32 v4, 4, v4
    v_lshl_add_u32 v5, v3, 5, v2
    s_mov_b32 s25, 8192
    v_mul_lo_u32 v5, v5, s25
    v_add_u32 v20, v5, v4
    v_bfe_u32 v4, v0, 2, 2
    v_lshl_add_u32 v5, v2, 3, v4
    v_lshlrev_b32 v5, 8, v5
    v_xor_b32 v4, v4, v3
    v_lshl_add_u32 v5, v4, 6, v5
    v_and_b32 v4, 3, v0
    v_lshl_add_u32 v5, v4, 3, v5
    v_and_b32 v4, 2, v4
    v_lshl_add_u32 v21, v4, 3, v5
    v_add_u32 v22, 16, v21
    v_add_u32 v23, 0x10000, v21
    v_add_u32 v24, 0x10000, v22
    s_lshl_b32 s26, s49, 13
    s_mov_b32 s25, s44
    s_barrier
    s_add_u32 m0, s26, 0
    s_add_u32 s27, s25, 0
    buffer_load_dwordx4 v20, s[16:19], s27 offen lds
    s_add_u32 m0, s26, 1024
    s_add_u32 s27, s25, 32768
    buffer_load_dwordx4 v20, s[16:19], s27 offen lds
    s_add_u32 m0, s26, 2048
    s_add_u32 s27, s25, 65536
    buffer_load_dwordx4 v20, s[16:19], s27 offen lds
    s_add_u32 m0, s26, 3072
    s_add_u32 s27, s25, 98304
    buffer_load_dwordx4 v20, s[16:19], s27 offen lds
    s_add_u32 m0, s26, 4096
    s_add_u32 s27, s25, 131072
    buffer_load_dwordx4 v20, s[16:19], s27 offen lds
    s_add_u32 m0, s26, 5120
    s_add_u32 s27, s25, 163840
    buffer_load_dwordx4 v20, s[16:19], s27 offen lds
    s_add_u32 m0, s26, 6144
    s_add_u32 s27, s25, 196608
    buffer_load_dwordx4 v20, s[16:19], s27 offen lds
    s_add_u32 m0, s26, 7168
    s_add_u32 s27, s25, 229376
    buffer_load_dwordx4 v20, s[16:19], s27 offen lds
    s_add_u32 m0, s26, 32768
    s_add_u32 s27, s25, 1048576
    buffer_load_dwordx4 v20, s[16:19], s27 offen lds
    s_add_u32 m0, s26, 33792
    s_add_u32 s27, s25, 1081344
    buffer_load_dwordx4 v20, s[16:19], s27 offen lds
    s_add_u32 m0, s26, 34816
    s_add_u32 s27, s25, 1114112
    buffer_load_dwordx4 v20, s[16:19], s27 offen lds
    s_add_u32 m0, s26, 35840
    s_add_u32 s27, s25, 1146880
    buffer_load_dwordx4 v20, s[16:19], s27 offen lds
    s_add_u32 m0, s26, 36864
    s_add_u32 s27, s25, 1179648
    buffer_load_dwordx4 v20, s[16:19], s27 offen lds
    s_add_u32 m0, s26, 37888
    s_add_u32 s27, s25, 1212416
    buffer_load_dwordx4 v20, s[16:19], s27 offen lds
    s_add_u32 m0, s26, 38912
    s_add_u32 s27, s25, 1245184
    buffer_load_dwordx4 v20, s[16:19], s27 offen lds
    s_add_u32 m0, s26, 39936
    s_add_u32 s27, s25, 1277952
    buffer_load_dwordx4 v20, s[16:19], s27 offen lds
    s_add_u32 m0, s26, 65536
    s_add_u32 s27, s25, 2097152
    buffer_load_dwordx4 v20, s[16:19], s27 offen lds
    s_add_u32 m0, s26, 66560
    s_add_u32 s27, s25, 2129920
    buffer_load_dwordx4 v20, s[16:19], s27 offen lds
    s_add_u32 m0, s26, 67584
    s_add_u32 s27, s25, 2162688
    buffer_load_dwordx4 v20, s[16:19], s27 offen lds
    s_add_u32 m0, s26, 68608
    s_add_u32 s27, s25, 2195456
    buffer_load_dwordx4 v20, s[16:19], s27 offen lds
    s_add_u32 m0, s26, 69632
    s_add_u32 s27, s25, 2228224
    buffer_load_dwordx4 v20, s[16:19], s27 offen lds
    s_add_u32 m0, s26, 70656
    s_add_u32 s27, s25, 2260992
    buffer_load_dwordx4 v20, s[16:19], s27 offen lds
    s_add_u32 m0, s26, 71680
    s_add_u32 s27, s25, 2293760
    buffer_load_dwordx4 v20, s[16:19], s27 offen lds
    s_add_u32 m0, s26, 72704
    s_add_u32 s27, s25, 2326528
    buffer_load_dwordx4 v20, s[16:19], s27 offen lds
    s_add_u32 m0, s26, 98304
    s_add_u32 s27, s25, 3145728
    buffer_load_dwordx4 v20, s[16:19], s27 offen lds
    s_add_u32 m0, s26, 99328
    s_add_u32 s27, s25, 3178496
    buffer_load_dwordx4 v20, s[16:19], s27 offen lds
    s_add_u32 m0, s26, 100352
    s_add_u32 s27, s25, 3211264
    buffer_load_dwordx4 v20, s[16:19], s27 offen lds
    s_add_u32 m0, s26, 101376
    s_add_u32 s27, s25, 3244032
    buffer_load_dwordx4 v20, s[16:19], s27 offen lds
    s_add_u32 m0, s26, 102400
    s_add_u32 s27, s25, 3276800
    buffer_load_dwordx4 v20, s[16:19], s27 offen lds
    s_add_u32 m0, s26, 103424
    s_add_u32 s27, s25, 3309568
    buffer_load_dwordx4 v20, s[16:19], s27 offen lds
    s_add_u32 m0, s26, 104448
    s_add_u32 s27, s25, 3342336
    buffer_load_dwordx4 v20, s[16:19], s27 offen lds
    s_add_u32 m0, s26, 105472
    s_add_u32 s27, s25, 3375104
    buffer_load_dwordx4 v20, s[16:19], s27 offen lds
    s_waitcnt vmcnt(24)
    s_barrier
    ds_read_b64_tr_b16 a[0:1], v21 offset:0
    ds_read_b64_tr_b16 a[2:3], v21 offset:1024
    ds_read_b64_tr_b16 a[4:5], v22 offset:0
    ds_read_b64_tr_b16 a[6:7], v22 offset:1024
    ds_read_b64_tr_b16 a[8:9], v21 offset:8192
    ds_read_b64_tr_b16 a[10:11], v21 offset:9216
    ds_read_b64_tr_b16 a[12:13], v22 offset:8192
    ds_read_b64_tr_b16 a[14:15], v22 offset:9216
    s_waitcnt lgkmcnt(0)
    ds_read_b64_tr_b16 a[16:17], v21 offset:16384
    ds_read_b64_tr_b16 a[18:19], v21 offset:17408
    ds_read_b64_tr_b16 a[20:21], v22 offset:16384
    ds_read_b64_tr_b16 a[22:23], v22 offset:17408
    ds_read_b64_tr_b16 a[24:25], v21 offset:24576
    ds_read_b64_tr_b16 a[26:27], v21 offset:25600
    ds_read_b64_tr_b16 a[28:29], v22 offset:24576
    ds_read_b64_tr_b16 a[30:31], v22 offset:25600
    s_waitcnt lgkmcnt(0)
    s_barrier
    s_add_u32 m0, s26, 0
    s_add_u32 s27, s25, 4194304
    buffer_load_dwordx4 v20, s[16:19], s27 offen lds
    s_add_u32 m0, s26, 1024
    s_add_u32 s27, s25, 4227072
    buffer_load_dwordx4 v20, s[16:19], s27 offen lds
    s_add_u32 m0, s26, 2048
    s_add_u32 s27, s25, 4259840
    buffer_load_dwordx4 v20, s[16:19], s27 offen lds
    s_add_u32 m0, s26, 3072
    s_add_u32 s27, s25, 4292608
    buffer_load_dwordx4 v20, s[16:19], s27 offen lds
    s_add_u32 m0, s26, 4096
    s_add_u32 s27, s25, 4325376
    buffer_load_dwordx4 v20, s[16:19], s27 offen lds
    s_add_u32 m0, s26, 5120
    s_add_u32 s27, s25, 4358144
    buffer_load_dwordx4 v20, s[16:19], s27 offen lds
    s_add_u32 m0, s26, 6144
    s_add_u32 s27, s25, 4390912
    buffer_load_dwordx4 v20, s[16:19], s27 offen lds
    s_add_u32 m0, s26, 7168
    s_add_u32 s27, s25, 4423680
    buffer_load_dwordx4 v20, s[16:19], s27 offen lds
    s_waitcnt vmcnt(24)
    s_barrier
    ds_read_b64_tr_b16 a[32:33], v21 offset:32768
    ds_read_b64_tr_b16 a[34:35], v21 offset:33792
    ds_read_b64_tr_b16 a[36:37], v22 offset:32768
    ds_read_b64_tr_b16 a[38:39], v22 offset:33792
    ds_read_b64_tr_b16 a[40:41], v21 offset:40960
    ds_read_b64_tr_b16 a[42:43], v21 offset:41984
    ds_read_b64_tr_b16 a[44:45], v22 offset:40960
    ds_read_b64_tr_b16 a[46:47], v22 offset:41984
    s_waitcnt lgkmcnt(0)
    ds_read_b64_tr_b16 a[48:49], v21 offset:49152
    ds_read_b64_tr_b16 a[50:51], v21 offset:50176
    ds_read_b64_tr_b16 a[52:53], v22 offset:49152
    ds_read_b64_tr_b16 a[54:55], v22 offset:50176
    ds_read_b64_tr_b16 a[56:57], v21 offset:57344
    ds_read_b64_tr_b16 a[58:59], v21 offset:58368
    ds_read_b64_tr_b16 a[60:61], v22 offset:57344
    ds_read_b64_tr_b16 a[62:63], v22 offset:58368
    s_waitcnt lgkmcnt(0)
    s_barrier
    s_add_u32 m0, s26, 32768
    s_add_u32 s27, s25, 5242880
    buffer_load_dwordx4 v20, s[16:19], s27 offen lds
    s_add_u32 m0, s26, 33792
    s_add_u32 s27, s25, 5275648
    buffer_load_dwordx4 v20, s[16:19], s27 offen lds
    s_add_u32 m0, s26, 34816
    s_add_u32 s27, s25, 5308416
    buffer_load_dwordx4 v20, s[16:19], s27 offen lds
    s_add_u32 m0, s26, 35840
    s_add_u32 s27, s25, 5341184
    buffer_load_dwordx4 v20, s[16:19], s27 offen lds
    s_add_u32 m0, s26, 36864
    s_add_u32 s27, s25, 5373952
    buffer_load_dwordx4 v20, s[16:19], s27 offen lds
    s_add_u32 m0, s26, 37888
    s_add_u32 s27, s25, 5406720
    buffer_load_dwordx4 v20, s[16:19], s27 offen lds
    s_add_u32 m0, s26, 38912
    s_add_u32 s27, s25, 5439488
    buffer_load_dwordx4 v20, s[16:19], s27 offen lds
    s_add_u32 m0, s26, 39936
    s_add_u32 s27, s25, 5472256
    buffer_load_dwordx4 v20, s[16:19], s27 offen lds
    s_waitcnt vmcnt(24)
    s_barrier
    ds_read_b64_tr_b16 a[64:65], v23 offset:0
    ds_read_b64_tr_b16 a[66:67], v23 offset:1024
    ds_read_b64_tr_b16 a[68:69], v24 offset:0
    ds_read_b64_tr_b16 a[70:71], v24 offset:1024
    ds_read_b64_tr_b16 a[72:73], v23 offset:8192
    ds_read_b64_tr_b16 a[74:75], v23 offset:9216
    ds_read_b64_tr_b16 a[76:77], v24 offset:8192
    ds_read_b64_tr_b16 a[78:79], v24 offset:9216
    s_waitcnt lgkmcnt(0)
    ds_read_b64_tr_b16 a[80:81], v23 offset:16384
    ds_read_b64_tr_b16 a[82:83], v23 offset:17408
    ds_read_b64_tr_b16 a[84:85], v24 offset:16384
    ds_read_b64_tr_b16 a[86:87], v24 offset:17408
    ds_read_b64_tr_b16 a[88:89], v23 offset:24576
    ds_read_b64_tr_b16 a[90:91], v23 offset:25600
    ds_read_b64_tr_b16 a[92:93], v24 offset:24576
    ds_read_b64_tr_b16 a[94:95], v24 offset:25600
    s_waitcnt lgkmcnt(0)
    s_barrier
    s_add_u32 m0, s26, 65536
    s_add_u32 s27, s25, 6291456
    buffer_load_dwordx4 v20, s[16:19], s27 offen lds
    s_add_u32 m0, s26, 66560
    s_add_u32 s27, s25, 6324224
    buffer_load_dwordx4 v20, s[16:19], s27 offen lds
    s_add_u32 m0, s26, 67584
    s_add_u32 s27, s25, 6356992
    buffer_load_dwordx4 v20, s[16:19], s27 offen lds
    s_add_u32 m0, s26, 68608
    s_add_u32 s27, s25, 6389760
    buffer_load_dwordx4 v20, s[16:19], s27 offen lds
    s_add_u32 m0, s26, 69632
    s_add_u32 s27, s25, 6422528
    buffer_load_dwordx4 v20, s[16:19], s27 offen lds
    s_add_u32 m0, s26, 70656
    s_add_u32 s27, s25, 6455296
    buffer_load_dwordx4 v20, s[16:19], s27 offen lds
    s_add_u32 m0, s26, 71680
    s_add_u32 s27, s25, 6488064
    buffer_load_dwordx4 v20, s[16:19], s27 offen lds
    s_add_u32 m0, s26, 72704
    s_add_u32 s27, s25, 6520832
    buffer_load_dwordx4 v20, s[16:19], s27 offen lds
    s_waitcnt vmcnt(24)
    s_barrier
    ds_read_b64_tr_b16 a[96:97], v23 offset:32768
    ds_read_b64_tr_b16 a[98:99], v23 offset:33792
    ds_read_b64_tr_b16 a[100:101], v24 offset:32768
    ds_read_b64_tr_b16 a[102:103], v24 offset:33792
    ds_read_b64_tr_b16 a[104:105], v23 offset:40960
    ds_read_b64_tr_b16 a[106:107], v23 offset:41984
    ds_read_b64_tr_b16 a[108:109], v24 offset:40960
    ds_read_b64_tr_b16 a[110:111], v24 offset:41984
    s_waitcnt lgkmcnt(0)
    ds_read_b64_tr_b16 a[112:113], v23 offset:49152
    ds_read_b64_tr_b16 a[114:115], v23 offset:50176
    ds_read_b64_tr_b16 a[116:117], v24 offset:49152
    ds_read_b64_tr_b16 a[118:119], v24 offset:50176
    ds_read_b64_tr_b16 a[120:121], v23 offset:57344
    ds_read_b64_tr_b16 a[122:123], v23 offset:58368
    ds_read_b64_tr_b16 a[124:125], v24 offset:57344
    ds_read_b64_tr_b16 a[126:127], v24 offset:58368
    s_waitcnt lgkmcnt(0)
    s_barrier
    s_add_u32 m0, s26, 98304
    s_add_u32 s27, s25, 7340032
    buffer_load_dwordx4 v20, s[16:19], s27 offen lds
    s_add_u32 m0, s26, 99328
    s_add_u32 s27, s25, 7372800
    buffer_load_dwordx4 v20, s[16:19], s27 offen lds
    s_add_u32 m0, s26, 100352
    s_add_u32 s27, s25, 7405568
    buffer_load_dwordx4 v20, s[16:19], s27 offen lds
    s_add_u32 m0, s26, 101376
    s_add_u32 s27, s25, 7438336
    buffer_load_dwordx4 v20, s[16:19], s27 offen lds
    s_add_u32 m0, s26, 102400
    s_add_u32 s27, s25, 7471104
    buffer_load_dwordx4 v20, s[16:19], s27 offen lds
    s_add_u32 m0, s26, 103424
    s_add_u32 s27, s25, 7503872
    buffer_load_dwordx4 v20, s[16:19], s27 offen lds
    s_add_u32 m0, s26, 104448
    s_add_u32 s27, s25, 7536640
    buffer_load_dwordx4 v20, s[16:19], s27 offen lds
    s_add_u32 m0, s26, 105472
    s_add_u32 s27, s25, 7569408
    buffer_load_dwordx4 v20, s[16:19], s27 offen lds
    s_waitcnt vmcnt(24)
    s_barrier
    ds_read_b64_tr_b16 a[128:129], v21 offset:0
    ds_read_b64_tr_b16 a[130:131], v21 offset:1024
    ds_read_b64_tr_b16 a[132:133], v22 offset:0
    ds_read_b64_tr_b16 a[134:135], v22 offset:1024
    ds_read_b64_tr_b16 a[136:137], v21 offset:8192
    ds_read_b64_tr_b16 a[138:139], v21 offset:9216
    ds_read_b64_tr_b16 a[140:141], v22 offset:8192
    ds_read_b64_tr_b16 a[142:143], v22 offset:9216
    s_waitcnt lgkmcnt(0)
    ds_read_b64_tr_b16 a[144:145], v21 offset:16384
    ds_read_b64_tr_b16 a[146:147], v21 offset:17408
    ds_read_b64_tr_b16 a[148:149], v22 offset:16384
    ds_read_b64_tr_b16 a[150:151], v22 offset:17408
    ds_read_b64_tr_b16 a[152:153], v21 offset:24576
    ds_read_b64_tr_b16 a[154:155], v21 offset:25600
    ds_read_b64_tr_b16 a[156:157], v22 offset:24576
    ds_read_b64_tr_b16 a[158:159], v22 offset:25600
    s_waitcnt lgkmcnt(0)
    s_waitcnt vmcnt(16)
    s_barrier
    ds_read_b64_tr_b16 a[160:161], v21 offset:32768
    ds_read_b64_tr_b16 a[162:163], v21 offset:33792
    ds_read_b64_tr_b16 a[164:165], v22 offset:32768
    ds_read_b64_tr_b16 a[166:167], v22 offset:33792
    ds_read_b64_tr_b16 a[168:169], v21 offset:40960
    ds_read_b64_tr_b16 a[170:171], v21 offset:41984
    ds_read_b64_tr_b16 a[172:173], v22 offset:40960
    ds_read_b64_tr_b16 a[174:175], v22 offset:41984
    s_waitcnt lgkmcnt(0)
    ds_read_b64_tr_b16 a[176:177], v21 offset:49152
    ds_read_b64_tr_b16 a[178:179], v21 offset:50176
    ds_read_b64_tr_b16 a[180:181], v22 offset:49152
    ds_read_b64_tr_b16 a[182:183], v22 offset:50176
    ds_read_b64_tr_b16 a[184:185], v21 offset:57344
    ds_read_b64_tr_b16 a[186:187], v21 offset:58368
    ds_read_b64_tr_b16 a[188:189], v22 offset:57344
    ds_read_b64_tr_b16 a[190:191], v22 offset:58368
    s_waitcnt lgkmcnt(0)
    s_waitcnt vmcnt(8)
    s_barrier
    ds_read_b64_tr_b16 a[192:193], v23 offset:0
    ds_read_b64_tr_b16 a[194:195], v23 offset:1024
    ds_read_b64_tr_b16 a[196:197], v24 offset:0
    ds_read_b64_tr_b16 a[198:199], v24 offset:1024
    ds_read_b64_tr_b16 a[200:201], v23 offset:8192
    ds_read_b64_tr_b16 a[202:203], v23 offset:9216
    ds_read_b64_tr_b16 a[204:205], v24 offset:8192
    ds_read_b64_tr_b16 a[206:207], v24 offset:9216
    s_waitcnt lgkmcnt(0)
    ds_read_b64_tr_b16 a[208:209], v23 offset:16384
    ds_read_b64_tr_b16 a[210:211], v23 offset:17408
    ds_read_b64_tr_b16 a[212:213], v24 offset:16384
    ds_read_b64_tr_b16 a[214:215], v24 offset:17408
    ds_read_b64_tr_b16 a[216:217], v23 offset:24576
    ds_read_b64_tr_b16 a[218:219], v23 offset:25600
    ds_read_b64_tr_b16 a[220:221], v24 offset:24576
    ds_read_b64_tr_b16 a[222:223], v24 offset:25600
    s_waitcnt lgkmcnt(0)
    s_waitcnt vmcnt(0)
    s_barrier
    ds_read_b64_tr_b16 a[224:225], v23 offset:32768
    ds_read_b64_tr_b16 a[226:227], v23 offset:33792
    ds_read_b64_tr_b16 a[228:229], v24 offset:32768
    ds_read_b64_tr_b16 a[230:231], v24 offset:33792
    ds_read_b64_tr_b16 a[232:233], v23 offset:40960
    ds_read_b64_tr_b16 a[234:235], v23 offset:41984
    ds_read_b64_tr_b16 a[236:237], v24 offset:40960
    ds_read_b64_tr_b16 a[238:239], v24 offset:41984
    s_waitcnt lgkmcnt(0)
    ds_read_b64_tr_b16 a[240:241], v23 offset:49152
    ds_read_b64_tr_b16 a[242:243], v23 offset:50176
    ds_read_b64_tr_b16 a[244:245], v24 offset:49152
    ds_read_b64_tr_b16 a[246:247], v24 offset:50176
    ds_read_b64_tr_b16 a[248:249], v23 offset:57344
    ds_read_b64_tr_b16 a[250:251], v23 offset:58368
    ds_read_b64_tr_b16 a[252:253], v24 offset:57344
    ds_read_b64_tr_b16 a[254:255], v24 offset:58368
    s_waitcnt lgkmcnt(0)
    s_lshl_b32 s21, s49, 12
    v_and_b32 v1, 63, v0
    v_and_b32 v2, 15, v0
    v_bfe_u32 v3, v0, 4, 2
    v_lshrrev_b32 v4, 6, v0
    v_lshrrev_b32 v5, 5, v1
    v_lshl_add_u32 v5, v4, 3, v5
    v_add_u32 v5, 0, v5
    v_and_b32 v6, 7, v5
    v_lshrrev_b32 v7, 4, v5
    v_lshl_add_u32 v6, v7, 3, v6
    v_and_b32 v7, 31, v1
    v_xor_b32 v6, v6, v7
    v_lshlrev_b32 v6, 4, v6
    v_lshl_add_u32 v8, v5, 11, v6
    v_lshrrev_b32 v5, 5, v1
    v_lshl_add_u32 v5, v4, 3, v5
    v_add_u32 v5, 2, v5
    v_and_b32 v6, 7, v5
    v_lshrrev_b32 v7, 4, v5
    v_lshl_add_u32 v6, v7, 3, v6
    v_and_b32 v7, 31, v1
    v_xor_b32 v6, v6, v7
    v_lshlrev_b32 v6, 4, v6
    v_lshl_add_u32 v9, v5, 11, v6
    v_lshrrev_b32 v5, 5, v1
    v_lshl_add_u32 v5, v4, 3, v5
    v_add_u32 v5, 4, v5
    v_and_b32 v6, 7, v5
    v_lshrrev_b32 v7, 4, v5
    v_lshl_add_u32 v6, v7, 3, v6
    v_and_b32 v7, 31, v1
    v_xor_b32 v6, v6, v7
    v_lshlrev_b32 v6, 4, v6
    v_lshl_add_u32 v10, v5, 11, v6
    v_lshrrev_b32 v5, 5, v1
    v_lshl_add_u32 v5, v4, 3, v5
    v_add_u32 v5, 6, v5
    v_and_b32 v6, 7, v5
    v_lshrrev_b32 v7, 4, v5
    v_lshl_add_u32 v6, v7, 3, v6
    v_and_b32 v7, 31, v1
    v_xor_b32 v6, v6, v7
    v_lshlrev_b32 v6, 4, v6
    v_lshl_add_u32 v11, v5, 11, v6
    v_and_b32 v5, 8, v2
    v_add_u32 v5, v5, v2
    v_add_u32 v6, 0, v3
    v_xor_b32 v6, v6, v2
    v_lshlrev_b32 v6, 4, v6
    v_lshl_add_u32 v12, v5, 9, v6
    v_add_u32 v6, 4, v3
    v_xor_b32 v6, v6, v2
    v_lshlrev_b32 v6, 4, v6
    v_lshl_add_u32 v13, v5, 9, v6
    v_add_u32 v6, 8, v3
    v_xor_b32 v6, v6, v2
    v_lshlrev_b32 v6, 4, v6
    v_lshl_add_u32 v14, v5, 9, v6
    v_add_u32 v6, 12, v3
    v_xor_b32 v6, v6, v2
    v_lshlrev_b32 v6, 4, v6
    v_lshl_add_u32 v15, v5, 9, v6
    v_add_u32 v16, 0x10000, v12
    v_add_u32 v17, 0x10000, v13
    v_add_u32 v18, 0x10000, v14
    v_add_u32 v19, 0x10000, v15
    v_lshlrev_b32 v86, 4, v5
    v_lshl_add_u32 v86, v3, 9, v86
    s_lshl_b32 s44, s46, 15
    s_lshr_b32 s25, s49, 1
    s_lshl_b32 s25, s25, 14
    s_add_u32 s44, s44, s25
    s_and_b32 s25, s49, 1
    s_lshl_b32 s25, s25, 12
    s_add_u32 s44, s44, s25
    s_mov_b32 s22, 0
    s_mov_b32 s24, 0
    s_mov_b32 s20, 0
    s_mov_b32 s37, 0
    s_mov_b32 s23, 64
    s_mov_b32 s32, s98
    s_and_b32 s33, s99, 0xffff
    s_mov_b32 s34, 0x100
    s_mov_b32 s35, 0x00020000
    s_mov_b32 s25, 0
    v_mov_b32 v2, 0
L_pl_224:
    buffer_load_dword v1, v2, s[32:35], s25 offen sc1
    s_add_u32 s36, s36, 1
    s_cmp_gt_u32 s36, 0x100000
    s_cbranch_scc1 chain_kernel_wend
    s_waitcnt vmcnt(0)
    v_readfirstlane_b32 s26, v1
    s_and_b32 s27, s26, 0xffff
    s_cmp_ge_u32 s27, 256
    s_cbranch_scc1 L_plok_225
    s_sleep 4
    s_branch L_pl_224
L_plok_225:
    s_lshr_b32 s25, s26, 16
    s_cmp_gt_u32 s25, 16
    s_cselect_b32 s25, 0x2000, 0x0
    s_add_u32 s54, s100, 0x1fffff
    s_and_b32 s54, s54, 0xffe00000
    s_sub_u32 s55, s54, s100
    s_add_u32 s54, s55, s25
    s_xor_b32 s25, s25, 0x2000
    s_add_u32 s55, s55, s25
    s_cmp_eq_u32 s40, 2
    s_cbranch_scc1 L_q_220
    s_cmp_eq_u32 s40, 1
    s_cbranch_scc1 L_v_219
    v_mov_b32 v96, 0xff81ff81
    v_mov_b32 v97, 0xff81ff81
    v_mov_b32 v98, 0xff81ff81
    v_mov_b32 v99, 0xff81ff81
    v_and_b32 v100, 63, v0
    v_lshlrev_b32 v101, 3, v100
    v_lshlrev_b32 v100, 4, v100
    s_barrier
    s_add_u32 m0, s21, 0
    s_nop 0
    buffer_load_dwordx4 v8, s[8:11], s20 offen lds
    s_add_u32 m0, s21, 1024
    s_nop 0
    buffer_load_dwordx4 v9, s[8:11], s20 offen lds
    s_add_u32 m0, s21, 2048
    s_nop 0
    buffer_load_dwordx4 v10, s[8:11], s20 offen lds
    s_add_u32 m0, s21, 3072
    s_nop 0
    buffer_load_dwordx4 v11, s[8:11], s20 offen lds
    s_add_u32 s20, s20, 512
    s_add_u32 m0, s21, 16384
    s_nop 0
    buffer_load_dwordx4 v8, s[8:11], s20 offen lds
    s_add_u32 m0, s21, 17408
    s_nop 0
    buffer_load_dwordx4 v9, s[8:11], s20 offen lds
    s_add_u32 m0, s21, 18432
    s_nop 0
    buffer_load_dwordx4 v10, s[8:11], s20 offen lds
    s_add_u32 m0, s21, 19456
    s_nop 0
    buffer_load_dwordx4 v11, s[8:11], s20 offen lds
    s_add_u32 s20, s20, 512
    s_add_u32 m0, s21, 32768
    s_nop 0
    buffer_load_dwordx4 v8, s[8:11], s20 offen lds
    s_add_u32 m0, s21, 33792
    s_nop 0
    buffer_load_dwordx4 v9, s[8:11], s20 offen lds
    s_add_u32 m0, s21, 34816
    s_nop 0
    buffer_load_dwordx4 v10, s[8:11], s20 offen lds
    s_add_u32 m0, s21, 35840
    s_nop 0
    buffer_load_dwordx4 v11, s[8:11], s20 offen lds
    s_add_u32 s20, s20, 512
    s_add_u32 m0, s21, 49152
    s_nop 0
    buffer_load_dwordx4 v8, s[8:11], s20 offen lds
    s_add_u32 m0, s21, 50176
    s_nop 0
    buffer_load_dwordx4 v9, s[8:11], s20 offen lds
    s_add_u32 m0, s21, 51200
    s_nop 0
    buffer_load_dwordx4 v10, s[8:11], s20 offen lds
    s_add_u32 m0, s21, 52224
    s_nop 0
    buffer_load_dwordx4 v11, s[8:11], s20 offen lds
    s_add_u32 s24, s24, 1
    s_min_u32 s24, s24, 63
    s_lshl_b32 s53, s24, 16
    s_mov_b32 s20, s53
    s_add_u32 m0, s21, 65536
    s_nop 0
    buffer_load_dwordx4 v8, s[8:11], s20 offen lds
    s_add_u32 m0, s21, 66560
    s_nop 0
    buffer_load_dwordx4 v9, s[8:11], s20 offen lds
    s_add_u32 m0, s21, 67584
    s_nop 0
    buffer_load_dwordx4 v10, s[8:11], s20 offen lds
    s_add_u32 m0, s21, 68608
    s_nop 0
    buffer_load_dwordx4 v11, s[8:11], s20 offen lds
    s_add_u32 s20, s20, 512
    s_add_u32 m0, s21, 81920
    s_nop 0
    buffer_load_dwordx4 v8, s[8:11], s20 offen lds
    s_add_u32 m0, s21, 82944
    s_nop 0
    buffer_load_dwordx4 v9, s[8:11], s20 offen lds
    s_add_u32 m0, s21, 83968
    s_nop 0
    buffer_load_dwordx4 v10, s[8:11], s20 offen lds
    s_add_u32 m0, s21, 84992
    s_nop 0
    buffer_load_dwordx4 v11, s[8:11], s20 offen lds
    s_add_u32 s20, s20, 512
    s_add_u32 m0, s21, 98304
    s_nop 0
    buffer_load_dwordx4 v8, s[8:11], s20 offen lds
    s_waitcnt vmcnt(21)
    s_barrier
    ds_read_b128 v[20:23], v12 offset:0
    ds_read_b128 v[24:27], v12 offset:4096
    ds_read_b128 v[28:31], v13 offset:0
    ds_read_b128 v[32:35], v13 offset:4096
    ds_read_b128 v[36:39], v14 offset:0
    ds_read_b128 v[40:43], v14 offset:4096
    s_waitcnt lgkmcnt(4)
L_st_229:
    v_mfma_f32_16x16x32_bf16 v[52:55], a[0:3], v[20:23], 0
    ds_read_b128 v[44:47], v15 offset:0
    s_add_u32 m0, s21, 99328
    s_sub_u32 s39, s22, 1
    v_mfma_f32_16x16x32_bf16 v[56:59], a[4:7], v[20:23], 0
    buffer_load_dwordx4 v9, s[8:11], s20 offen lds
    s_bitcmp1_b32 s39, 1
    s_cselect_b32 s38, s55, s54
    v_mfma_f32_16x16x32_bf16 v[60:63], a[0:3], v[24:27], 0
    ds_read_b128 v[48:51], v15 offset:4096
    v_mfma_f32_16x16x32_bf16 v[64:67], a[4:7], v[24:27], 0
    s_waitcnt lgkmcnt(4)
    s_add_u32 s38, s38, s44
    v_mfma_f32_16x16x32_bf16 v[52:55], a[8:11], v[28:31], v[52:55]
    ds_read_b128 v[20:23], v12 offset:256
    s_lshl_b32 s42, s39, 20
    v_mfma_f32_16x16x32_bf16 v[56:59], a[12:15], v[28:31], v[56:59]
    s_add_u32 s38, s38, s42
    s_lshl_b32 s39, s39, 7
    v_mfma_f32_16x16x32_bf16 v[60:63], a[8:11], v[32:35], v[60:63]
    ds_read_b128 v[24:27], v12 offset:4352
    s_add_u32 s39, s39, 0x5900000
    s_cmp_eq_u32 s37, 0
    s_cselect_b32 s38, 0x7ff00000, s38
    s_cselect_b32 s39, 0x7ff00000, s39
    v_mfma_f32_16x16x32_bf16 v[64:67], a[12:15], v[32:35], v[64:67]
    s_waitcnt lgkmcnt(4)
    v_mfma_f32_16x16x32_bf16 v[52:55], a[16:19], v[36:39], v[52:55]
    ds_read_b128 v[28:31], v13 offset:256
    s_add_u32 m0, s21, 100352
    v_mfma_f32_16x16x32_bf16 v[56:59], a[20:23], v[36:39], v[56:59]
    buffer_load_dwordx4 v10, s[8:11], s20 offen lds
    v_mfma_f32_16x16x32_bf16 v[60:63], a[16:19], v[40:43], v[60:63]
    ds_read_b128 v[32:35], v13 offset:4352
    v_cvt_pk_bf16_f32 v88, v68, v69
    v_mfma_f32_16x16x32_bf16 v[64:67], a[20:23], v[40:43], v[64:67]
    s_waitcnt lgkmcnt(4)
    v_cvt_pk_bf16_f32 v89, v70, v71
    v_cvt_pk_bf16_f32 v90, v72, v73
    v_mfma_f32_16x16x32_bf16 v[52:55], a[24:27], v[44:47], v[52:55]
    ds_read_b128 v[36:39], v14 offset:256
    v_cvt_pk_bf16_f32 v91, v74, v75
    v_mfma_f32_16x16x32_bf16 v[56:59], a[28:31], v[44:47], v[56:59]
    buffer_store_dwordx4 v[88:91], v86, s[12:15], s38 offen offset:0 sc1
    v_mfma_f32_16x16x32_bf16 v[60:63], a[24:27], v[48:51], v[60:63]
    ds_read_b128 v[40:43], v14 offset:4352
    v_cvt_pk_bf16_f32 v92, v76, v77
    v_mfma_f32_16x16x32_bf16 v[64:67], a[28:31], v[48:51], v[64:67]
    s_waitcnt lgkmcnt(4)
    v_cvt_pk_bf16_f32 v93, v78, v79
    v_mfma_f32_16x16x32_bf16 v[52:55], a[32:35], v[20:23], v[52:55]
    ds_read_b128 v[44:47], v15 offset:256
    s_add_u32 m0, s21, 101376
    v_mfma_f32_16x16x32_bf16 v[56:59], a[36:39], v[20:23], v[56:59]
    buffer_load_dwordx4 v11, s[8:11], s20 offen lds
    v_mfma_f32_16x16x32_bf16 v[60:63], a[32:35], v[24:27], v[60:63]
    ds_read_b128 v[48:51], v15 offset:4352
    v_cvt_pk_bf16_f32 v94, v80, v81
    v_mfma_f32_16x16x32_bf16 v[64:67], a[36:39], v[24:27], v[64:67]
    s_waitcnt lgkmcnt(4)
    v_cvt_pk_bf16_f32 v95, v82, v83
    v_mfma_f32_16x16x32_bf16 v[52:55], a[40:43], v[28:31], v[52:55]
    s_waitcnt vmcnt(20)
    s_barrier
    ds_read_b128 v[20:23], v12 offset:16384
    v_mfma_f32_16x16x32_bf16 v[56:59], a[44:47], v[28:31], v[56:59]
    s_add_u32 s20, s20, 512
    buffer_store_dwordx4 v[92:95], v86, s[12:15], s38 offen offset:128 sc1
    v_mfma_f32_16x16x32_bf16 v[60:63], a[40:43], v[32:35], v[60:63]
    ds_read_b128 v[24:27], v12 offset:20480
    s_add_u32 s42, s38, 0x8000000
    v_mfma_f32_16x16x32_bf16 v[64:67], a[44:47], v[32:35], v[64:67]
    s_waitcnt lgkmcnt(4)
    s_cmp_le_u32 s22, 52
    s_cbranch_scc1 L_nokm_230
    buffer_store_dwordx4 v[96:99], v100, s[12:15], s42 offen offset:3072 sc1
L_nokm_230:
    v_mfma_f32_16x16x32_bf16 v[52:55], a[48:51], v[36:39], v[52:55]
    ds_read_b128 v[28:31], v13 offset:16384
    s_add_u32 m0, s21, 114688
    v_mfma_f32_16x16x32_bf16 v[56:59], a[52:55], v[36:39], v[56:59]
    buffer_load_dwordx4 v8, s[8:11], s20 offen lds
    v_mfma_f32_16x16x32_bf16 v[60:63], a[48:51], v[40:43], v[60:63]
    ds_read_b128 v[32:35], v13 offset:20480
    v_mfma_f32_16x16x32_bf16 v[64:67], a[52:55], v[40:43], v[64:67]
    s_waitcnt lgkmcnt(4)
    v_mfma_f32_16x16x32_bf16 v[52:55], a[56:59], v[44:47], v[52:55]
    ds_read_b128 v[36:39], v14 offset:16384
    v_mfma_f32_16x16x32_bf16 v[56:59], a[60:63], v[44:47], v[56:59]
    buffer_store_dwordx2 v[96:97], v101, s[12:15], s42 offen offset:0 sc1
    v_mfma_f32_16x16x32_bf16 v[60:63], a[56:59], v[48:51], v[60:63]
    ds_read_b128 v[40:43], v14 offset:20480
    v_mfma_f32_16x16x32_bf16 v[64:67], a[60:63], v[48:51], v[64:67]
    s_waitcnt lgkmcnt(4)
    v_mfma_f32_16x16x32_bf16 v[52:55], a[64:67], v[20:23], v[52:55]
    ds_read_b128 v[44:47], v15 offset:16384
    s_add_u32 m0, s21, 115712
    v_mfma_f32_16x16x32_bf16 v[56:59], a[68:71], v[20:23], v[56:59]
    buffer_load_dwordx4 v9, s[8:11], s20 offen lds
    v_mfma_f32_16x16x32_bf16 v[60:63], a[64:67], v[24:27], v[60:63]
    ds_read_b128 v[48:51], v15 offset:20480
    v_mfma_f32_16x16x32_bf16 v[64:67], a[68:71], v[24:27], v[64:67]
    s_waitcnt lgkmcnt(4)
    v_mfma_f32_16x16x32_bf16 v[52:55], a[72:75], v[28:31], v[52:55]
    ds_read_b128 v[20:23], v12 offset:16640
    v_mfma_f32_16x16x32_bf16 v[56:59], a[76:79], v[28:31], v[56:59]
    v_mfma_f32_16x16x32_bf16 v[60:63], a[72:75], v[32:35], v[60:63]
    ds_read_b128 v[24:27], v12 offset:20736
    s_add_u32 s24, s24, 1
    v_mfma_f32_16x16x32_bf16 v[64:67], a[76:79], v[32:35], v[64:67]
    s_waitcnt lgkmcnt(4)
    v_mfma_f32_16x16x32_bf16 v[52:55], a[80:83], v[36:39], v[52:55]
    ds_read_b128 v[28:31], v13 offset:16640
    s_add_u32 m0, s21, 116736
    v_mfma_f32_16x16x32_bf16 v[56:59], a[84:87], v[36:39], v[56:59]
    buffer_load_dwordx4 v10, s[8:11], s20 offen lds
    v_mfma_f32_16x16x32_bf16 v[60:63], a[80:83], v[40:43], v[60:63]
    ds_read_b128 v[32:35], v13 offset:20736
    v_mfma_f32_16x16x32_bf16 v[64:67], a[84:87], v[40:43], v[64:67]
    s_waitcnt lgkmcnt(4)
    s_min_u32 s24, s24, 63
    v_mfma_f32_16x16x32_bf16 v[52:55], a[88:91], v[44:47], v[52:55]
    ds_read_b128 v[36:39], v14 offset:16640
    v_mfma_f32_16x16x32_bf16 v[56:59], a[92:95], v[44:47], v[56:59]
    v_mfma_f32_16x16x32_bf16 v[60:63], a[88:91], v[48:51], v[60:63]
    ds_read_b128 v[40:43], v14 offset:20736
    s_lshl_b32 s53, s24, 16
    v_mfma_f32_16x16x32_bf16 v[64:67], a[92:95], v[48:51], v[64:67]
    s_waitcnt lgkmcnt(4)
    v_mfma_f32_16x16x32_bf16 v[52:55], a[96:99], v[20:23], v[52:55]
    ds_read_b128 v[44:47], v15 offset:16640
    s_add_u32 m0, s21, 117760
    v_mfma_f32_16x16x32_bf16 v[56:59], a[100:103], v[20:23], v[56:59]
    buffer_load_dwordx4 v11, s[8:11], s20 offen lds
    v_mfma_f32_16x16x32_bf16 v[60:63], a[96:99], v[24:27], v[60:63]
    ds_read_b128 v[48:51], v15 offset:20736
    v_mfma_f32_16x16x32_bf16 v[64:67], a[100:103], v[24:27], v[64:67]
    s_waitcnt lgkmcnt(4)
    v_mfma_f32_16x16x32_bf16 v[52:55], a[104:107], v[28:31], v[52:55]
    s_waitcnt vmcnt(20)
    s_barrier
    ds_read_b128 v[20:23], v12 offset:32768
    v_mfma_f32_16x16x32_bf16 v[56:59], a[108:111], v[28:31], v[56:59]
    s_mov_b32 s20, s53
    v_mfma_f32_16x16x32_bf16 v[60:63], a[104:107], v[32:35], v[60:63]
    ds_read_b128 v[24:27], v12 offset:36864
    v_mfma_f32_16x16x32_bf16 v[64:67], a[108:111], v[32:35], v[64:67]
    s_waitcnt lgkmcnt(4)
    v_mfma_f32_16x16x32_bf16 v[52:55], a[112:115], v[36:39], v[52:55]
    ds_read_b128 v[28:31], v13 offset:32768
    s_add_u32 m0, s21, 0
    v_mfma_f32_16x16x32_bf16 v[56:59], a[116:119], v[36:39], v[56:59]
    buffer_load_dwordx4 v8, s[8:11], s20 offen lds
    v_mfma_f32_16x16x32_bf16 v[60:63], a[112:115], v[40:43], v[60:63]
    ds_read_b128 v[32:35], v13 offset:36864
    v_mfma_f32_16x16x32_bf16 v[64:67], a[116:119], v[40:43], v[64:67]
    s_waitcnt lgkmcnt(4)
    v_mfma_f32_16x16x32_bf16 v[52:55], a[120:123], v[44:47], v[52:55]
    ds_read_b128 v[36:39], v14 offset:32768
    v_mfma_f32_16x16x32_bf16 v[56:59], a[124:127], v[44:47], v[56:59]
    v_mfma_f32_16x16x32_bf16 v[60:63], a[120:123], v[48:51], v[60:63]
    ds_read_b128 v[40:43], v14 offset:36864
    v_mfma_f32_16x16x32_bf16 v[64:67], a[124:127], v[48:51], v[64:67]
    s_waitcnt lgkmcnt(4)
    v_mfma_f32_16x16x32_bf16 v[52:55], a[128:131], v[20:23], v[52:55]
    ds_read_b128 v[44:47], v15 offset:32768
    s_add_u32 m0, s21, 1024
    v_mfma_f32_16x16x32_bf16 v[56:59], a[132:135], v[20:23], v[56:59]
    buffer_load_dwordx4 v9, s[8:11], s20 offen lds
    v_mfma_f32_16x16x32_bf16 v[60:63], a[128:131], v[24:27], v[60:63]
    ds_read_b128 v[48:51], v15 offset:36864
    v_mfma_f32_16x16x32_bf16 v[64:67], a[132:135], v[24:27], v[64:67]
    s_waitcnt lgkmcnt(4)
    v_mfma_f32_16x16x32_bf16 v[52:55], a[136:139], v[28:31], v[52:55]
    ds_read_b128 v[20:23], v12 offset:33024
    v_mfma_f32_16x16x32_bf16 v[56:59], a[140:143], v[28:31], v[56:59]
    v_mfma_f32_16x16x32_bf16 v[60:63], a[136:139], v[32:35], v[60:63]
    ds_read_b128 v[24:27], v12 offset:37120
    v_mfma_f32_16x16x32_bf16 v[64:67], a[140:143], v[32:35], v[64:67]
    s_waitcnt lgkmcnt(4)
    v_mfma_f32_16x16x32_bf16 v[52:55], a[144:147], v[36:39], v[52:55]
    ds_read_b128 v[28:31], v13 offset:33024
    s_add_u32 m0, s21, 2048
    v_mfma_f32_16x16x32_bf16 v[56:59], a[148:151], v[36:39], v[56:59]
    buffer_load_dwordx4 v10, s[8:11], s20 offen lds
    v_mfma_f32_16x16x32_bf16 v[60:63], a[144:147], v[40:43], v[60:63]
    ds_read_b128 v[32:35], v13 offset:37120
    v_mfma_f32_16x16x32_bf16 v[64:67], a[148:151], v[40:43], v[64:67]
    s_waitcnt lgkmcnt(4)
    v_mfma_f32_16x16x32_bf16 v[52:55], a[152:155], v[44:47], v[52:55]
    ds_read_b128 v[36:39], v14 offset:33024
    v_mfma_f32_16x16x32_bf16 v[56:59], a[156:159], v[44:47], v[56:59]
    v_mfma_f32_16x16x32_bf16 v[60:63], a[152:155], v[48:51], v[60:63]
    ds_read_b128 v[40:43], v14 offset:37120
    v_mfma_f32_16x16x32_bf16 v[64:67], a[156:159], v[48:51], v[64:67]
    s_waitcnt lgkmcnt(4)
    v_mfma_f32_16x16x32_bf16 v[52:55], a[160:163], v[20:23], v[52:55]
    ds_read_b128 v[44:47], v15 offset:33024
    s_add_u32 m0, s21, 3072
    v_mfma_f32_16x16x32_bf16 v[56:59], a[164:167], v[20:23], v[56:59]
    buffer_load_dwordx4 v11, s[8:11], s20 offen lds
    v_mfma_f32_16x16x32_bf16 v[60:63], a[160:163], v[24:27], v[60:63]
    ds_read_b128 v[48:51], v15 offset:37120
    v_mfma_f32_16x16x32_bf16 v[64:67], a[164:167], v[24:27], v[64:67]
    s_waitcnt lgkmcnt(4)
    v_mfma_f32_16x16x32_bf16 v[52:55], a[168:171], v[28:31], v[52:55]
    s_waitcnt vmcnt(7)
    s_barrier
    ds_read_b128 v[20:23], v12 offset:49152
    v_mfma_f32_16x16x32_bf16 v[56:59], a[172:175], v[28:31], v[56:59]
    s_add_u32 s20, s20, 512
    buffer_atomic_add v84, v85, s[12:15], s39 offen sc1
    v_mfma_f32_16x16x32_bf16 v[60:63], a[168:171], v[32:35], v[60:63]
    ds_read_b128 v[24:27], v12 offset:53248
    s_mov_b32 s37, 1
    v_mfma_f32_16x16x32_bf16 v[64:67], a[172:175], v[32:35], v[64:67]
    s_waitcnt lgkmcnt(4)
    v_mfma_f32_16x16x32_bf16 v[52:55], a[176:179], v[36:39], v[52:55]
    ds_read_b128 v[28:31], v13 offset:49152
    s_add_u32 m0, s21, 16384
    v_mfma_f32_16x16x32_bf16 v[56:59], a[180:183], v[36:39], v[56:59]
    buffer_load_dwordx4 v8, s[8:11], s20 offen lds
    v_mfma_f32_16x16x32_bf16 v[60:63], a[176:179], v[40:43], v[60:63]
    ds_read_b128 v[32:35], v13 offset:53248
    v_mfma_f32_16x16x32_bf16 v[64:67], a[180:183], v[40:43], v[64:67]
    s_waitcnt lgkmcnt(4)
    v_mfma_f32_16x16x32_bf16 v[52:55], a[184:187], v[44:47], v[52:55]
    ds_read_b128 v[36:39], v14 offset:49152
    v_mfma_f32_16x16x32_bf16 v[56:59], a[188:191], v[44:47], v[56:59]
    v_mfma_f32_16x16x32_bf16 v[60:63], a[184:187], v[48:51], v[60:63]
    ds_read_b128 v[40:43], v14 offset:53248
    v_mfma_f32_16x16x32_bf16 v[64:67], a[188:191], v[48:51], v[64:67]
    s_waitcnt lgkmcnt(4)
    v_mfma_f32_16x16x32_bf16 v[52:55], a[192:195], v[20:23], v[52:55]
    ds_read_b128 v[44:47], v15 offset:49152
    s_add_u32 m0, s21, 17408
    v_mfma_f32_16x16x32_bf16 v[56:59], a[196:199], v[20:23], v[56:59]
    buffer_load_dwordx4 v9, s[8:11], s20 offen lds
    v_mfma_f32_16x16x32_bf16 v[60:63], a[192:195], v[24:27], v[60:63]
    ds_read_b128 v[48:51], v15 offset:53248
    v_mfma_f32_16x16x32_bf16 v[64:67], a[196:199], v[24:27], v[64:67]
    s_waitcnt lgkmcnt(4)
    v_mfma_f32_16x16x32_bf16 v[52:55], a[200:203], v[28:31], v[52:55]
    ds_read_b128 v[20:23], v12 offset:49408
    v_mfma_f32_16x16x32_bf16 v[56:59], a[204:207], v[28:31], v[56:59]
    v_mfma_f32_16x16x32_bf16 v[60:63], a[200:203], v[32:35], v[60:63]
    ds_read_b128 v[24:27], v12 offset:53504
    v_mfma_f32_16x16x32_bf16 v[64:67], a[204:207], v[32:35], v[64:67]
    s_waitcnt lgkmcnt(4)
    v_mfma_f32_16x16x32_bf16 v[52:55], a[208:211], v[36:39], v[52:55]
    ds_read_b128 v[28:31], v13 offset:49408
    s_add_u32 m0, s21, 18432
    v_mfma_f32_16x16x32_bf16 v[56:59], a[212:215], v[36:39], v[56:59]
    buffer_load_dwordx4 v10, s[8:11], s20 offen lds
    v_mfma_f32_16x16x32_bf16 v[60:63], a[208:211], v[40:43], v[60:63]
    ds_read_b128 v[32:35], v13 offset:53504
    v_mfma_f32_16x16x32_bf16 v[64:67], a[212:215], v[40:43], v[64:67]
    s_waitcnt lgkmcnt(4)
    v_mfma_f32_16x16x32_bf16 v[52:55], a[216:219], v[44:47], v[52:55]
    ds_read_b128 v[36:39], v14 offset:49408
    v_mfma_f32_16x16x32_bf16 v[56:59], a[220:223], v[44:47], v[56:59]
    v_mfma_f32_16x16x32_bf16 v[60:63], a[216:219], v[48:51], v[60:63]
    ds_read_b128 v[40:43], v14 offset:53504
    v_mfma_f32_16x16x32_bf16 v[64:67], a[220:223], v[48:51], v[64:67]
    s_waitcnt lgkmcnt(4)
    v_mfma_f32_16x16x32_bf16 v[52:55], a[224:227], v[20:23], v[52:55]
    ds_read_b128 v[44:47], v15 offset:49408
    s_add_u32 m0, s21, 19456
    v_mfma_f32_16x16x32_bf16 v[56:59], a[228:231], v[20:23], v[56:59]
    buffer_load_dwordx4 v11, s[8:11], s20 offen lds
    v_mfma_f32_16x16x32_bf16 v[60:63], a[224:227], v[24:27], v[60:63]
    ds_read_b128 v[48:51], v15 offset:53504
    v_mfma_f32_16x16x32_bf16 v[64:67], a[228:231], v[24:27], v[64:67]
    s_waitcnt lgkmcnt(4)
    v_mfma_f32_16x16x32_bf16 v[52:55], a[232:235], v[28:31], v[52:55]
    s_waitcnt vmcnt(20)
    s_barrier
    ds_read_b128 v[20:23], v16 offset:0
    v_mfma_f32_16x16x32_bf16 v[56:59], a[236:239], v[28:31], v[56:59]
    s_add_u32 s20, s20, 512
    v_mfma_f32_16x16x32_bf16 v[60:63], a[232:235], v[32:35], v[60:63]
    ds_read_b128 v[24:27], v16 offset:4096
    v_mfma_f32_16x16x32_bf16 v[64:67], a[236:239], v[32:35], v[64:67]
    s_waitcnt lgkmcnt(4)
    v_mfma_f32_16x16x32_bf16 v[52:55], a[240:243], v[36:39], v[52:55]
    ds_read_b128 v[28:31], v17 offset:0
    s_add_u32 m0, s21, 32768
    v_mfma_f32_16x16x32_bf16 v[56:59], a[244:247], v[36:39], v[56:59]
    buffer_load_dwordx4 v8, s[8:11], s20 offen lds
    v_mfma_f32_16x16x32_bf16 v[60:63], a[240:243], v[40:43], v[60:63]
    ds_read_b128 v[32:35], v17 offset:4096
    v_mfma_f32_16x16x32_bf16 v[64:67], a[244:247], v[40:43], v[64:67]
    s_waitcnt lgkmcnt(4)
    v_mfma_f32_16x16x32_bf16 v[52:55], a[248:251], v[44:47], v[52:55]
    ds_read_b128 v[36:39], v18 offset:0
    v_mfma_f32_16x16x32_bf16 v[56:59], a[252:255], v[44:47], v[56:59]
    v_mfma_f32_16x16x32_bf16 v[60:63], a[248:251], v[48:51], v[60:63]
    ds_read_b128 v[40:43], v18 offset:4096
    v_mfma_f32_16x16x32_bf16 v[64:67], a[252:255], v[48:51], v[64:67]
    s_waitcnt lgkmcnt(4)
    s_add_u32 s22, s22, 1
    s_cmp_ge_u32 s22, s23
    s_cbranch_scc1 L_fl0_226
    v_mfma_f32_16x16x32_bf16 v[68:71], a[0:3], v[20:23], 0
    ds_read_b128 v[44:47], v19 offset:0
    s_add_u32 m0, s21, 33792
    s_sub_u32 s39, s22, 1
    v_mfma_f32_16x16x32_bf16 v[72:75], a[4:7], v[20:23], 0
    buffer_load_dwordx4 v9, s[8:11], s20 offen lds
    s_bitcmp1_b32 s39, 1
    s_cselect_b32 s38, s55, s54
    v_mfma_f32_16x16x32_bf16 v[76:79], a[0:3], v[24:27], 0
    ds_read_b128 v[48:51], v19 offset:4096
    v_mfma_f32_16x16x32_bf16 v[80:83], a[4:7], v[24:27], 0
    s_waitcnt lgkmcnt(4)
    s_add_u32 s38, s38, s44
    v_mfma_f32_16x16x32_bf16 v[68:71], a[8:11], v[28:31], v[68:71]
    ds_read_b128 v[20:23], v16 offset:256
    s_lshl_b32 s42, s39, 20
    v_mfma_f32_16x16x32_bf16 v[72:75], a[12:15], v[28:31], v[72:75]
    s_add_u32 s38, s38, s42
    s_lshl_b32 s39, s39, 7
    v_mfma_f32_16x16x32_bf16 v[76:79], a[8:11], v[32:35], v[76:79]
    ds_read_b128 v[24:27], v16 offset:4352
    s_add_u32 s39, s39, 0x5900000
    s_cmp_eq_u32 s37, 0
    s_cselect_b32 s38, 0x7ff00000, s38
    s_cselect_b32 s39, 0x7ff00000, s39
    v_mfma_f32_16x16x32_bf16 v[80:83], a[12:15], v[32:35], v[80:83]
    s_waitcnt lgkmcnt(4)
    v_mfma_f32_16x16x32_bf16 v[68:71], a[16:19], v[36:39], v[68:71]
    ds_read_b128 v[28:31], v17 offset:256
    s_add_u32 m0, s21, 34816
    v_mfma_f32_16x16x32_bf16 v[72:75], a[20:23], v[36:39], v[72:75]
    buffer_load_dwordx4 v10, s[8:11], s20 offen lds
    v_mfma_f32_16x16x32_bf16 v[76:79], a[16:19], v[40:43], v[76:79]
    ds_read_b128 v[32:35], v17 offset:4352
    v_cvt_pk_bf16_f32 v88, v52, v53
    v_mfma_f32_16x16x32_bf16 v[80:83], a[20:23], v[40:43], v[80:83]
    s_waitcnt lgkmcnt(4)
    v_cvt_pk_bf16_f32 v89, v54, v55
    v_cvt_pk_bf16_f32 v90, v56, v57
    v_mfma_f32_16x16x32_bf16 v[68:71], a[24:27], v[44:47], v[68:71]
    ds_read_b128 v[36:39], v18 offset:256
    v_cvt_pk_bf16_f32 v91, v58, v59
    v_mfma_f32_16x16x32_bf16 v[72:75], a[28:31], v[44:47], v[72:75]
    buffer_store_dwordx4 v[88:91], v86, s[12:15], s38 offen offset:0 sc1
    v_mfma_f32_16x16x32_bf16 v[76:79], a[24:27], v[48:51], v[76:79]
    ds_read_b128 v[40:43], v18 offset:4352
    v_cvt_pk_bf16_f32 v92, v60, v61
    v_mfma_f32_16x16x32_bf16 v[80:83], a[28:31], v[48:51], v[80:83]
    s_waitcnt lgkmcnt(4)
    v_cvt_pk_bf16_f32 v93, v62, v63
    v_mfma_f32_16x16x32_bf16 v[68:71], a[32:35], v[20:23], v[68:71]
    ds_read_b128 v[44:47], v19 offset:256
    s_add_u32 m0, s21, 35840
    v_mfma_f32_16x16x32_bf16 v[72:75], a[36:39], v[20:23], v[72:75]
    buffer_load_dwordx4 v11, s[8:11], s20 offen lds
    v_mfma_f32_16x16x32_bf16 v[76:79], a[32:35], v[24:27], v[76:79]
    ds_read_b128 v[48:51], v19 offset:4352
    v_cvt_pk_bf16_f32 v94, v64, v65
    v_mfma_f32_16x16x32_bf16 v[80:83], a[36:39], v[24:27], v[80:83]
    s_waitcnt lgkmcnt(4)
    v_cvt_pk_bf16_f32 v95, v66, v67
    v_mfma_f32_16x16x32_bf16 v[68:71], a[40:43], v[28:31], v[68:71]
    s_waitcnt vmcnt(20)
    s_barrier
    ds_read_b128 v[20:23], v16 offset:16384
    v_mfma_f32_16x16x32_bf16 v[72:75], a[44:47], v[28:31], v[72:75]
    s_add_u32 s20, s20, 512
    buffer_store_dwordx4 v[92:95], v86, s[12:15], s38 offen offset:128 sc1
    v_mfma_f32_16x16x32_bf16 v[76:79], a[40:43], v[32:35], v[76:79]
    ds_read_b128 v[24:27], v16 offset:20480
    s_add_u32 s42, s38, 0x8000000
    v_mfma_f32_16x16x32_bf16 v[80:83], a[44:47], v[32:35], v[80:83]
    s_waitcnt lgkmcnt(4)
    s_cmp_le_u32 s22, 52
    s_cbranch_scc1 L_nokm_231
    buffer_store_dwordx4 v[96:99], v100, s[12:15], s42 offen offset:3072 sc1
L_nokm_231:
    v_mfma_f32_16x16x32_bf16 v[68:71], a[48:51], v[36:39], v[68:71]
    ds_read_b128 v[28:31], v17 offset:16384
    s_add_u32 m0, s21, 49152
    v_mfma_f32_16x16x32_bf16 v[72:75], a[52:55], v[36:39], v[72:75]
    buffer_load_dwordx4 v8, s[8:11], s20 offen lds
    v_mfma_f32_16x16x32_bf16 v[76:79], a[48:51], v[40:43], v[76:79]
    ds_read_b128 v[32:35], v17 offset:20480
    v_mfma_f32_16x16x32_bf16 v[80:83], a[52:55], v[40:43], v[80:83]
    s_waitcnt lgkmcnt(4)
    v_mfma_f32_16x16x32_bf16 v[68:71], a[56:59], v[44:47], v[68:71]
    ds_read_b128 v[36:39], v18 offset:16384
    v_mfma_f32_16x16x32_bf16 v[72:75], a[60:63], v[44:47], v[72:75]
    buffer_store_dwordx2 v[96:97], v101, s[12:15], s42 offen offset:0 sc1
    v_mfma_f32_16x16x32_bf16 v[76:79], a[56:59], v[48:51], v[76:79]
    ds_read_b128 v[40:43], v18 offset:20480
    v_mfma_f32_16x16x32_bf16 v[80:83], a[60:63], v[48:51], v[80:83]
    s_waitcnt lgkmcnt(4)
    v_mfma_f32_16x16x32_bf16 v[68:71], a[64:67], v[20:23], v[68:71]
    ds_read_b128 v[44:47], v19 offset:16384
    s_add_u32 m0, s21, 50176
    v_mfma_f32_16x16x32_bf16 v[72:75], a[68:71], v[20:23], v[72:75]
    buffer_load_dwordx4 v9, s[8:11], s20 offen lds
    v_mfma_f32_16x16x32_bf16 v[76:79], a[64:67], v[24:27], v[76:79]
    ds_read_b128 v[48:51], v19 offset:20480
    v_mfma_f32_16x16x32_bf16 v[80:83], a[68:71], v[24:27], v[80:83]
    s_waitcnt lgkmcnt(4)
    v_mfma_f32_16x16x32_bf16 v[68:71], a[72:75], v[28:31], v[68:71]
    ds_read_b128 v[20:23], v16 offset:16640
    v_mfma_f32_16x16x32_bf16 v[72:75], a[76:79], v[28:31], v[72:75]
    v_mfma_f32_16x16x32_bf16 v[76:79], a[72:75], v[32:35], v[76:79]
    ds_read_b128 v[24:27], v16 offset:20736
    s_add_u32 s24, s24, 1
    v_mfma_f32_16x16x32_bf16 v[80:83], a[76:79], v[32:35], v[80:83]
    s_waitcnt lgkmcnt(4)
    v_mfma_f32_16x16x32_bf16 v[68:71], a[80:83], v[36:39], v[68:71]
    ds_read_b128 v[28:31], v17 offset:16640
    s_add_u32 m0, s21, 51200
    v_mfma_f32_16x16x32_bf16 v[72:75], a[84:87], v[36:39], v[72:75]
    buffer_load_dwordx4 v10, s[8:11], s20 offen lds
    v_mfma_f32_16x16x32_bf16 v[76:79], a[80:83], v[40:43], v[76:79]
    ds_read_b128 v[32:35], v17 offset:20736
    v_mfma_f32_16x16x32_bf16 v[80:83], a[84:87], v[40:43], v[80:83]
    s_waitcnt lgkmcnt(4)
    s_min_u32 s24, s24, 63
    v_mfma_f32_16x16x32_bf16 v[68:71], a[88:91], v[44:47], v[68:71]
    ds_read_b128 v[36:39], v18 offset:16640
    v_mfma_f32_16x16x32_bf16 v[72:75], a[92:95], v[44:47], v[72:75]
    v_mfma_f32_16x16x32_bf16 v[76:79], a[88:91], v[48:51], v[76:79]
    ds_read_b128 v[40:43], v18 offset:20736
    s_lshl_b32 s53, s24, 16
    v_mfma_f32_16x16x32_bf16 v[80:83], a[92:95], v[48:51], v[80:83]
    s_waitcnt lgkmcnt(4)
    v_mfma_f32_16x16x32_bf16 v[68:71], a[96:99], v[20:23], v[68:71]
    ds_read_b128 v[44:47], v19 offset:16640
    s_add_u32 m0, s21, 52224
    v_mfma_f32_16x16x32_bf16 v[72:75], a[100:103], v[20:23], v[72:75]
    buffer_load_dwordx4 v11, s[8:11], s20 offen lds
    v_mfma_f32_16x16x32_bf16 v[76:79], a[96:99], v[24:27], v[76:79]
    ds_read_b128 v[48:51], v19 offset:20736
    v_mfma_f32_16x16x32_bf16 v[80:83], a[100:103], v[24:27], v[80:83]
    s_waitcnt lgkmcnt(4)
    v_mfma_f32_16x16x32_bf16 v[68:71], a[104:107], v[28:31], v[68:71]
    s_waitcnt vmcnt(20)
    s_barrier
    ds_read_b128 v[20:23], v16 offset:32768
    v_mfma_f32_16x16x32_bf16 v[72:75], a[108:111], v[28:31], v[72:75]
    s_mov_b32 s20, s53
    v_mfma_f32_16x16x32_bf16 v[76:79], a[104:107], v[32:35], v[76:79]
    ds_read_b128 v[24:27], v16 offset:36864
    v_mfma_f32_16x16x32_bf16 v[80:83], a[108:111], v[32:35], v[80:83]
    s_waitcnt lgkmcnt(4)
    v_mfma_f32_16x16x32_bf16 v[68:71], a[112:115], v[36:39], v[68:71]
    ds_read_b128 v[28:31], v17 offset:32768
    s_add_u32 m0, s21, 65536
    v_mfma_f32_16x16x32_bf16 v[72:75], a[116:119], v[36:39], v[72:75]
    buffer_load_dwordx4 v8, s[8:11], s20 offen lds
    v_mfma_f32_16x16x32_bf16 v[76:79], a[112:115], v[40:43], v[76:79]
    ds_read_b128 v[32:35], v17 offset:36864
    v_mfma_f32_16x16x32_bf16 v[80:83], a[116:119], v[40:43], v[80:83]
    s_waitcnt lgkmcnt(4)
    v_mfma_f32_16x16x32_bf16 v[68:71], a[120:123], v[44:47], v[68:71]
    ds_read_b128 v[36:39], v18 offset:32768
    v_mfma_f32_16x16x32_bf16 v[72:75], a[124:127], v[44:47], v[72:75]
    v_mfma_f32_16x16x32_bf16 v[76:79], a[120:123], v[48:51], v[76:79]
    ds_read_b128 v[40:43], v18 offset:36864
    v_mfma_f32_16x16x32_bf16 v[80:83], a[124:127], v[48:51], v[80:83]
    s_waitcnt lgkmcnt(4)
    v_mfma_f32_16x16x32_bf16 v[68:71], a[128:131], v[20:23], v[68:71]
    ds_read_b128 v[44:47], v19 offset:32768
    s_add_u32 m0, s21, 66560
    v_mfma_f32_16x16x32_bf16 v[72:75], a[132:135], v[20:23], v[72:75]
    buffer_load_dwordx4 v9, s[8:11], s20 offen lds
    v_mfma_f32_16x16x32_bf16 v[76:79], a[128:131], v[24:27], v[76:79]
    ds_read_b128 v[48:51], v19 offset:36864
    v_mfma_f32_16x16x32_bf16 v[80:83], a[132:135], v[24:27], v[80:83]
    s_waitcnt lgkmcnt(4)
    v_mfma_f32_16x16x32_bf16 v[68:71], a[136:139], v[28:31], v[68:71]
    ds_read_b128 v[20:23], v16 offset:33024
    v_mfma_f32_16x16x32_bf16 v[72:75], a[140:143], v[28:31], v[72:75]
    v_mfma_f32_16x16x32_bf16 v[76:79], a[136:139], v[32:35], v[76:79]
    ds_read_b128 v[24:27], v16 offset:37120
    v_mfma_f32_16x16x32_bf16 v[80:83], a[140:143], v[32:35], v[80:83]
    s_waitcnt lgkmcnt(4)
    v_mfma_f32_16x16x32_bf16 v[68:71], a[144:147], v[36:39], v[68:71]
    ds_read_b128 v[28:31], v17 offset:33024
    s_add_u32 m0, s21, 67584
    v_mfma_f32_16x16x32_bf16 v[72:75], a[148:151], v[36:39], v[72:75]
    buffer_load_dwordx4 v10, s[8:11], s20 offen lds
    v_mfma_f32_16x16x32_bf16 v[76:79], a[144:147], v[40:43], v[76:79]
    ds_read_b128 v[32:35], v17 offset:37120
    v_mfma_f32_16x16x32_bf16 v[80:83], a[148:151], v[40:43], v[80:83]
    s_waitcnt lgkmcnt(4)
    v_mfma_f32_16x16x32_bf16 v[68:71], a[152:155], v[44:47], v[68:71]
    ds_read_b128 v[36:39], v18 offset:33024
    v_mfma_f32_16x16x32_bf16 v[72:75], a[156:159], v[44:47], v[72:75]
    v_mfma_f32_16x16x32_bf16 v[76:79], a[152:155], v[48:51], v[76:79]
    ds_read_b128 v[40:43], v18 offset:37120
    v_mfma_f32_16x16x32_bf16 v[80:83], a[156:159], v[48:51], v[80:83]
    s_waitcnt lgkmcnt(4)
    v_mfma_f32_16x16x32_bf16 v[68:71], a[160:163], v[20:23], v[68:71]
    ds_read_b128 v[44:47], v19 offset:33024
    s_add_u32 m0, s21, 68608
    v_mfma_f32_16x16x32_bf16 v[72:75], a[164:167], v[20:23], v[72:75]
    buffer_load_dwordx4 v11, s[8:11], s20 offen lds
    v_mfma_f32_16x16x32_bf16 v[76:79], a[160:163], v[24:27], v[76:79]
    ds_read_b128 v[48:51], v19 offset:37120
    v_mfma_f32_16x16x32_bf16 v[80:83], a[164:167], v[24:27], v[80:83]
    s_waitcnt lgkmcnt(4)
    v_mfma_f32_16x16x32_bf16 v[68:71], a[168:171], v[28:31], v[68:71]
    s_waitcnt vmcnt(7)
    s_barrier
    ds_read_b128 v[20:23], v16 offset:49152
    v_mfma_f32_16x16x32_bf16 v[72:75], a[172:175], v[28:31], v[72:75]
    s_add_u32 s20, s20, 512
    buffer_atomic_add v84, v85, s[12:15], s39 offen sc1
    v_mfma_f32_16x16x32_bf16 v[76:79], a[168:171], v[32:35], v[76:79]
    ds_read_b128 v[24:27], v16 offset:53248
    s_mov_b32 s37, 1
    v_mfma_f32_16x16x32_bf16 v[80:83], a[172:175], v[32:35], v[80:83]
    s_waitcnt lgkmcnt(4)
    v_mfma_f32_16x16x32_bf16 v[68:71], a[176:179], v[36:39], v[68:71]
    ds_read_b128 v[28:31], v17 offset:49152
    s_add_u32 m0, s21, 81920
    v_mfma_f32_16x16x32_bf16 v[72:75], a[180:183], v[36:39], v[72:75]
    buffer_load_dwordx4 v8, s[8:11], s20 offen lds
    v_mfma_f32_16x16x32_bf16 v[76:79], a[176:179], v[40:43], v[76:79]
    ds_read_b128 v[32:35], v17 offset:53248
    v_mfma_f32_16x16x32_bf16 v[80:83], a[180:183], v[40:43], v[80:83]
    s_waitcnt lgkmcnt(4)
    v_mfma_f32_16x16x32_bf16 v[68:71], a[184:187], v[44:47], v[68:71]
    ds_read_b128 v[36:39], v18 offset:49152
    v_mfma_f32_16x16x32_bf16 v[72:75], a[188:191], v[44:47], v[72:75]
    v_mfma_f32_16x16x32_bf16 v[76:79], a[184:187], v[48:51], v[76:79]
    ds_read_b128 v[40:43], v18 offset:53248
    v_mfma_f32_16x16x32_bf16 v[80:83], a[188:191], v[48:51], v[80:83]
    s_waitcnt lgkmcnt(4)
    v_mfma_f32_16x16x32_bf16 v[68:71], a[192:195], v[20:23], v[68:71]
    ds_read_b128 v[44:47], v19 offset:49152
    s_add_u32 m0, s21, 82944
    v_mfma_f32_16x16x32_bf16 v[72:75], a[196:199], v[20:23], v[72:75]
    buffer_load_dwordx4 v9, s[8:11], s20 offen lds
    v_mfma_f32_16x16x32_bf16 v[76:79], a[192:195], v[24:27], v[76:79]
    ds_read_b128 v[48:51], v19 offset:53248
    v_mfma_f32_16x16x32_bf16 v[80:83], a[196:199], v[24:27], v[80:83]
    s_waitcnt lgkmcnt(4)
    v_mfma_f32_16x16x32_bf16 v[68:71], a[200:203], v[28:31], v[68:71]
    ds_read_b128 v[20:23], v16 offset:49408
    v_mfma_f32_16x16x32_bf16 v[72:75], a[204:207], v[28:31], v[72:75]
    v_mfma_f32_16x16x32_bf16 v[76:79], a[200:203], v[32:35], v[76:79]
    ds_read_b128 v[24:27], v16 offset:53504
    v_mfma_f32_16x16x32_bf16 v[80:83], a[204:207], v[32:35], v[80:83]
    s_waitcnt lgkmcnt(4)
    v_mfma_f32_16x16x32_bf16 v[68:71], a[208:211], v[36:39], v[68:71]
    ds_read_b128 v[28:31], v17 offset:49408
    s_add_u32 m0, s21, 83968
    v_mfma_f32_16x16x32_bf16 v[72:75], a[212:215], v[36:39], v[72:75]
    buffer_load_dwordx4 v10, s[8:11], s20 offen lds
    v_mfma_f32_16x16x32_bf16 v[76:79], a[208:211], v[40:43], v[76:79]
    ds_read_b128 v[32:35], v17 offset:53504
    v_mfma_f32_16x16x32_bf16 v[80:83], a[212:215], v[40:43], v[80:83]
    s_waitcnt lgkmcnt(4)
    v_mfma_f32_16x16x32_bf16 v[68:71], a[216:219], v[44:47], v[68:71]
    ds_read_b128 v[36:39], v18 offset:49408
    v_mfma_f32_16x16x32_bf16 v[72:75], a[220:223], v[44:47], v[72:75]
    v_mfma_f32_16x16x32_bf16 v[76:79], a[216:219], v[48:51], v[76:79]
    ds_read_b128 v[40:43], v18 offset:53504
    v_mfma_f32_16x16x32_bf16 v[80:83], a[220:223], v[48:51], v[80:83]
    s_waitcnt lgkmcnt(4)
    v_mfma_f32_16x16x32_bf16 v[68:71], a[224:227], v[20:23], v[68:71]
    ds_read_b128 v[44:47], v19 offset:49408
    s_add_u32 m0, s21, 84992
    v_mfma_f32_16x16x32_bf16 v[72:75], a[228:231], v[20:23], v[72:75]
    buffer_load_dwordx4 v11, s[8:11], s20 offen lds
    v_mfma_f32_16x16x32_bf16 v[76:79], a[224:227], v[24:27], v[76:79]
    ds_read_b128 v[48:51], v19 offset:53504
    v_mfma_f32_16x16x32_bf16 v[80:83], a[228:231], v[24:27], v[80:83]
    s_waitcnt lgkmcnt(4)
    v_mfma_f32_16x16x32_bf16 v[68:71], a[232:235], v[28:31], v[68:71]
    s_waitcnt vmcnt(20)
    s_barrier
    ds_read_b128 v[20:23], v12 offset:0
    v_mfma_f32_16x16x32_bf16 v[72:75], a[236:239], v[28:31], v[72:75]
    s_add_u32 s20, s20, 512
    v_mfma_f32_16x16x32_bf16 v[76:79], a[232:235], v[32:35], v[76:79]
    ds_read_b128 v[24:27], v12 offset:4096
    v_mfma_f32_16x16x32_bf16 v[80:83], a[236:239], v[32:35], v[80:83]
    s_waitcnt lgkmcnt(4)
    v_mfma_f32_16x16x32_bf16 v[68:71], a[240:243], v[36:39], v[68:71]
    ds_read_b128 v[28:31], v13 offset:0
    s_add_u32 m0, s21, 98304
    v_mfma_f32_16x16x32_bf16 v[72:75], a[244:247], v[36:39], v[72:75]
    buffer_load_dwordx4 v8, s[8:11], s20 offen lds
    v_mfma_f32_16x16x32_bf16 v[76:79], a[240:243], v[40:43], v[76:79]
    ds_read_b128 v[32:35], v13 offset:4096
    v_mfma_f32_16x16x32_bf16 v[80:83], a[244:247], v[40:43], v[80:83]
    s_waitcnt lgkmcnt(4)
    v_mfma_f32_16x16x32_bf16 v[68:71], a[248:251], v[44:47], v[68:71]
    ds_read_b128 v[36:39], v14 offset:0
    v_mfma_f32_16x16x32_bf16 v[72:75], a[252:255], v[44:47], v[72:75]
    v_mfma_f32_16x16x32_bf16 v[76:79], a[248:251], v[48:51], v[76:79]
    ds_read_b128 v[40:43], v14 offset:4096
    v_mfma_f32_16x16x32_bf16 v[80:83], a[252:255], v[48:51], v[80:83]
    s_waitcnt lgkmcnt(4)
    s_add_u32 s22, s22, 1
    s_cmp_ge_u32 s22, s23
    s_cbranch_scc0 L_st_229
L_fl1_227:
    s_waitcnt lgkmcnt(0)
    s_nop 7
    s_sub_u32 s39, s22, 1
    s_bitcmp1_b32 s39, 1
    s_cselect_b32 s38, s55, s54
    s_add_u32 s38, s38, s44
    s_lshl_b32 s42, s39, 20
    s_add_u32 s38, s38, s42
    s_lshl_b32 s39, s39, 7
    s_add_u32 s39, s39, 0x5900000
    s_cmp_eq_u32 s37, 0
    s_cselect_b32 s38, 0x7ff00000, s38
    s_cselect_b32 s39, 0x7ff00000, s39
    v_cvt_pk_bf16_f32 v88, v68, v69
    v_cvt_pk_bf16_f32 v89, v70, v71
    v_cvt_pk_bf16_f32 v90, v72, v73
    v_cvt_pk_bf16_f32 v91, v74, v75
    buffer_store_dwordx4 v[88:91], v86, s[12:15], s38 offen offset:0 sc1
    v_cvt_pk_bf16_f32 v92, v76, v77
    v_cvt_pk_bf16_f32 v93, v78, v79
    v_cvt_pk_bf16_f32 v94, v80, v81
    v_cvt_pk_bf16_f32 v95, v82, v83
    buffer_store_dwordx4 v[92:95], v86, s[12:15], s38 offen offset:128 sc1
    s_add_u32 s42, s38, 0x8000000
    s_cmp_le_u32 s22, 52
    s_cbranch_scc1 L_nokm_232
    buffer_store_dwordx4 v[96:99], v100, s[12:15], s42 offen offset:3072 sc1
L_nokm_232:
    buffer_store_dwordx2 v[96:97], v101, s[12:15], s42 offen offset:0 sc1
    s_waitcnt vmcnt(0)
    s_barrier
    buffer_atomic_add v84, v85, s[12:15], s39 offen sc1
    s_mov_b32 s37, 1
    s_branch L_ste_228
L_fl0_226:
    s_waitcnt lgkmcnt(0)
    s_nop 7
    s_sub_u32 s39, s22, 1
    s_bitcmp1_b32 s39, 1
    s_cselect_b32 s38, s55, s54
    s_add_u32 s38, s38, s44
    s_lshl_b32 s42, s39, 20
    s_add_u32 s38, s38, s42
    s_lshl_b32 s39, s39, 7
    s_add_u32 s39, s39, 0x5900000
    s_cmp_eq_u32 s37, 0
    s_cselect_b32 s38, 0x7ff00000, s38
    s_cselect_b32 s39, 0x7ff00000, s39
    v_cvt_pk_bf16_f32 v88, v52, v53
    v_cvt_pk_bf16_f32 v89, v54, v55
    v_cvt_pk_bf16_f32 v90, v56, v57
    v_cvt_pk_bf16_f32 v91, v58, v59
    buffer_store_dwordx4 v[88:91], v86, s[12:15], s38 offen offset:0 sc1
    v_cvt_pk_bf16_f32 v92, v60, v61
    v_cvt_pk_bf16_f32 v93, v62, v63
    v_cvt_pk_bf16_f32 v94, v64, v65
    v_cvt_pk_bf16_f32 v95, v66, v67
    buffer_store_dwordx4 v[92:95], v86, s[12:15], s38 offen offset:128 sc1
    s_add_u32 s42, s38, 0x8000000
    s_cmp_le_u32 s22, 52
    s_cbranch_scc1 L_nokm_233
    buffer_store_dwordx4 v[96:99], v100, s[12:15], s42 offen offset:3072 sc1
L_nokm_233:
    buffer_store_dwordx2 v[96:97], v101, s[12:15], s42 offen offset:0 sc1
    s_waitcnt vmcnt(0)
    s_barrier
    buffer_atomic_add v84, v85, s[12:15], s39 offen sc1
    s_mov_b32 s37, 1
L_ste_228:
    s_branch L_op_223
L_v_219:
    v_mov_b32 v96, 0xff81ff81
    v_mov_b32 v97, 0xff81ff81
    v_mov_b32 v98, 0xff81ff81
    v_mov_b32 v99, 0xff81ff81
    v_and_b32 v100, 63, v0
    v_lshlrev_b32 v101, 3, v100
    v_lshlrev_b32 v100, 4, v100
    s_barrier
    s_add_u32 m0, s21, 0
    s_nop 0
    buffer_load_dwordx4 v8, s[8:11], s20 offen lds
    s_add_u32 m0, s21, 1024
    s_nop 0
    buffer_load_dwordx4 v9, s[8:11], s20 offen lds
    s_add_u32 m0, s21, 2048
    s_nop 0
    buffer_load_dwordx4 v10, s[8:11], s20 offen lds
    s_add_u32 m0, s21, 3072
    s_nop 0
    buffer_load_dwordx4 v11, s[8:11], s20 offen lds
    s_add_u32 s20, s20, 512
    s_add_u32 m0, s21, 16384
    s_nop 0
    buffer_load_dwordx4 v8, s[8:11], s20 offen lds
    s_add_u32 m0, s21, 17408
    s_nop 0
    buffer_load_dwordx4 v9, s[8:11], s20 offen lds
    s_add_u32 m0, s21, 18432
    s_nop 0
    buffer_load_dwordx4 v10, s[8:11], s20 offen lds
    s_add_u32 m0, s21, 19456
    s_nop 0
    buffer_load_dwordx4 v11, s[8:11], s20 offen lds
    s_add_u32 s20, s20, 512
    s_add_u32 m0, s21, 32768
    s_nop 0
    buffer_load_dwordx4 v8, s[8:11], s20 offen lds
    s_add_u32 m0, s21, 33792
    s_nop 0
    buffer_load_dwordx4 v9, s[8:11], s20 offen lds
    s_add_u32 m0, s21, 34816
    s_nop 0
    buffer_load_dwordx4 v10, s[8:11], s20 offen lds
    s_add_u32 m0, s21, 35840
    s_nop 0
    buffer_load_dwordx4 v11, s[8:11], s20 offen lds
    s_add_u32 s20, s20, 512
    s_add_u32 m0, s21, 49152
    s_nop 0
    buffer_load_dwordx4 v8, s[8:11], s20 offen lds
    s_add_u32 m0, s21, 50176
    s_nop 0
    buffer_load_dwordx4 v9, s[8:11], s20 offen lds
    s_add_u32 m0, s21, 51200
    s_nop 0
    buffer_load_dwordx4 v10, s[8:11], s20 offen lds
    s_add_u32 m0, s21, 52224
    s_nop 0
    buffer_load_dwordx4 v11, s[8:11], s20 offen lds
    s_add_u32 s24, s24, 1
    s_min_u32 s24, s24, 63
    s_lshl_b32 s53, s24, 16
    s_mov_b32 s20, s53
    s_add_u32 m0, s21, 65536
    s_nop 0
    buffer_load_dwordx4 v8, s[8:11], s20 offen lds
    s_add_u32 m0, s21, 66560
    s_nop 0
    buffer_load_dwordx4 v9, s[8:11], s20 offen lds
    s_add_u32 m0, s21, 67584
    s_nop 0
    buffer_load_dwordx4 v10, s[8:11], s20 offen lds
    s_add_u32 m0, s21, 68608
    s_nop 0
    buffer_load_dwordx4 v11, s[8:11], s20 offen lds
    s_add_u32 s20, s20, 512
    s_add_u32 m0, s21, 81920
    s_nop 0
    buffer_load_dwordx4 v8, s[8:11], s20 offen lds
    s_add_u32 m0, s21, 82944
    s_nop 0
    buffer_load_dwordx4 v9, s[8:11], s20 offen lds
    s_add_u32 m0, s21, 83968
    s_nop 0
    buffer_load_dwordx4 v10, s[8:11], s20 offen lds
    s_add_u32 m0, s21, 84992
    s_nop 0
    buffer_load_dwordx4 v11, s[8:11], s20 offen lds
    s_add_u32 s20, s20, 512
    s_add_u32 m0, s21, 98304
    s_nop 0
    buffer_load_dwordx4 v8, s[8:11], s20 offen lds
    s_waitcnt vmcnt(21)
    s_barrier
    ds_read_b128 v[20:23], v12 offset:0
    ds_read_b128 v[24:27], v12 offset:4096
    ds_read_b128 v[28:31], v13 offset:0
    ds_read_b128 v[32:35], v13 offset:4096
    ds_read_b128 v[36:39], v14 offset:0
    ds_read_b128 v[40:43], v14 offset:4096
    s_waitcnt lgkmcnt(4)
L_st_237:
    v_mfma_f32_16x16x32_bf16 v[52:55], v[20:23], a[0:3], 0
    ds_read_b128 v[44:47], v15 offset:0
    s_add_u32 m0, s21, 99328
    s_sub_u32 s39, s22, 1
    v_mfma_f32_16x16x32_bf16 v[56:59], v[20:23], a[4:7], 0
    buffer_load_dwordx4 v9, s[8:11], s20 offen lds
    s_bitcmp1_b32 s39, 1
    s_cselect_b32 s38, s55, s54
    v_mfma_f32_16x16x32_bf16 v[60:63], v[24:27], a[0:3], 0
    ds_read_b128 v[48:51], v15 offset:4096
    v_mfma_f32_16x16x32_bf16 v[64:67], v[24:27], a[4:7], 0
    s_waitcnt lgkmcnt(4)
    s_add_u32 s38, s38, s44
    v_mfma_f32_16x16x32_bf16 v[52:55], v[28:31], a[8:11], v[52:55]
    ds_read_b128 v[20:23], v12 offset:256
    s_lshl_b32 s42, s39, 20
    v_mfma_f32_16x16x32_bf16 v[56:59], v[28:31], a[12:15], v[56:59]
    s_add_u32 s38, s38, s42
    s_lshl_b32 s39, s39, 7
    v_mfma_f32_16x16x32_bf16 v[60:63], v[32:35], a[8:11], v[60:63]
    ds_read_b128 v[24:27], v12 offset:4352
    s_add_u32 s39, s39, 0x5900000
    s_cmp_eq_u32 s37, 0
    s_cselect_b32 s38, 0x7ff00000, s38
    s_cselect_b32 s39, 0x7ff00000, s39
    v_mfma_f32_16x16x32_bf16 v[64:67], v[32:35], a[12:15], v[64:67]
    s_waitcnt lgkmcnt(4)
    v_mfma_f32_16x16x32_bf16 v[52:55], v[36:39], a[16:19], v[52:55]
    ds_read_b128 v[28:31], v13 offset:256
    s_add_u32 m0, s21, 100352
    v_mfma_f32_16x16x32_bf16 v[56:59], v[36:39], a[20:23], v[56:59]
    buffer_load_dwordx4 v10, s[8:11], s20 offen lds
    v_mfma_f32_16x16x32_bf16 v[60:63], v[40:43], a[16:19], v[60:63]
    ds_read_b128 v[32:35], v13 offset:4352
    v_cvt_pk_bf16_f32 v88, v68, v69
    v_mfma_f32_16x16x32_bf16 v[64:67], v[40:43], a[20:23], v[64:67]
    s_waitcnt lgkmcnt(4)
    v_cvt_pk_bf16_f32 v89, v70, v71
    v_cvt_pk_bf16_f32 v90, v76, v77
    v_mfma_f32_16x16x32_bf16 v[52:55], v[44:47], a[24:27], v[52:55]
    ds_read_b128 v[36:39], v14 offset:256
    v_cvt_pk_bf16_f32 v91, v78, v79
    v_mfma_f32_16x16x32_bf16 v[56:59], v[44:47], a[28:31], v[56:59]
    buffer_store_dwordx4 v[88:91], v86, s[12:15], s38 offen offset:2048 sc1
    v_mfma_f32_16x16x32_bf16 v[60:63], v[48:51], a[24:27], v[60:63]
    ds_read_b128 v[40:43], v14 offset:4352
    v_cvt_pk_bf16_f32 v92, v72, v73
    v_mfma_f32_16x16x32_bf16 v[64:67], v[48:51], a[28:31], v[64:67]
    s_waitcnt lgkmcnt(4)
    v_cvt_pk_bf16_f32 v93, v74, v75
    v_mfma_f32_16x16x32_bf16 v[52:55], v[20:23], a[32:35], v[52:55]
    ds_read_b128 v[44:47], v15 offset:256
    s_add_u32 m0, s21, 101376
    v_mfma_f32_16x16x32_bf16 v[56:59], v[20:23], a[36:39], v[56:59]
    buffer_load_dwordx4 v11, s[8:11], s20 offen lds
    v_mfma_f32_16x16x32_bf16 v[60:63], v[24:27], a[32:35], v[60:63]
    ds_read_b128 v[48:51], v15 offset:4352
    v_cvt_pk_bf16_f32 v94, v80, v81
    v_mfma_f32_16x16x32_bf16 v[64:67], v[24:27], a[36:39], v[64:67]
    s_waitcnt lgkmcnt(4)
    v_cvt_pk_bf16_f32 v95, v82, v83
    v_mfma_f32_16x16x32_bf16 v[52:55], v[28:31], a[40:43], v[52:55]
    s_waitcnt vmcnt(20)
    s_barrier
    ds_read_b128 v[20:23], v12 offset:16384
    v_mfma_f32_16x16x32_bf16 v[56:59], v[28:31], a[44:47], v[56:59]
    s_add_u32 s20, s20, 512
    buffer_store_dwordx4 v[92:95], v86, s[12:15], s38 offen offset:2176 sc1
    v_mfma_f32_16x16x32_bf16 v[60:63], v[32:35], a[40:43], v[60:63]
    ds_read_b128 v[24:27], v12 offset:20480
    s_add_u32 s42, s38, 0x8000000
    v_mfma_f32_16x16x32_bf16 v[64:67], v[32:35], a[44:47], v[64:67]
    s_waitcnt lgkmcnt(4)
    v_mfma_f32_16x16x32_bf16 v[52:55], v[36:39], a[48:51], v[52:55]
    ds_read_b128 v[28:31], v13 offset:16384
    s_add_u32 m0, s21, 114688
    v_mfma_f32_16x16x32_bf16 v[56:59], v[36:39], a[52:55], v[56:59]
    buffer_load_dwordx4 v8, s[8:11], s20 offen lds
    v_mfma_f32_16x16x32_bf16 v[60:63], v[40:43], a[48:51], v[60:63]
    ds_read_b128 v[32:35], v13 offset:20480
    v_mfma_f32_16x16x32_bf16 v[64:67], v[40:43], a[52:55], v[64:67]
    s_waitcnt lgkmcnt(4)
    v_mfma_f32_16x16x32_bf16 v[52:55], v[44:47], a[56:59], v[52:55]
    ds_read_b128 v[36:39], v14 offset:16384
    v_mfma_f32_16x16x32_bf16 v[56:59], v[44:47], a[60:63], v[56:59]
    buffer_store_dwordx2 v[96:97], v101, s[12:15], s42 offen offset:512 sc1
    v_mfma_f32_16x16x32_bf16 v[60:63], v[48:51], a[56:59], v[60:63]
    ds_read_b128 v[40:43], v14 offset:20480
    v_mfma_f32_16x16x32_bf16 v[64:67], v[48:51], a[60:63], v[64:67]
    s_waitcnt lgkmcnt(4)
    v_mfma_f32_16x16x32_bf16 v[52:55], v[20:23], a[64:67], v[52:55]
    ds_read_b128 v[44:47], v15 offset:16384
    s_add_u32 m0, s21, 115712
    v_mfma_f32_16x16x32_bf16 v[56:59], v[20:23], a[68:71], v[56:59]
    buffer_load_dwordx4 v9, s[8:11], s20 offen lds
    v_mfma_f32_16x16x32_bf16 v[60:63], v[24:27], a[64:67], v[60:63]
    ds_read_b128 v[48:51], v15 offset:20480
    v_mfma_f32_16x16x32_bf16 v[64:67], v[24:27], a[68:71], v[64:67]
    s_waitcnt lgkmcnt(4)
    v_mfma_f32_16x16x32_bf16 v[52:55], v[28:31], a[72:75], v[52:55]
    ds_read_b128 v[20:23], v12 offset:16640
    v_mfma_f32_16x16x32_bf16 v[56:59], v[28:31], a[76:79], v[56:59]
    v_mfma_f32_16x16x32_bf16 v[60:63], v[32:35], a[72:75], v[60:63]
    ds_read_b128 v[24:27], v12 offset:20736
    s_add_u32 s24, s24, 1
    v_mfma_f32_16x16x32_bf16 v[64:67], v[32:35], a[76:79], v[64:67]
    s_waitcnt lgkmcnt(4)
    v_mfma_f32_16x16x32_bf16 v[52:55], v[36:39], a[80:83], v[52:55]
    ds_read_b128 v[28:31], v13 offset:16640
    s_add_u32 m0, s21, 116736
    v_mfma_f32_16x16x32_bf16 v[56:59], v[36:39], a[84:87], v[56:59]
    buffer_load_dwordx4 v10, s[8:11], s20 offen lds
    v_mfma_f32_16x16x32_bf16 v[60:63], v[40:43], a[80:83], v[60:63]
    ds_read_b128 v[32:35], v13 offset:20736
    v_mfma_f32_16x16x32_bf16 v[64:67], v[40:43], a[84:87], v[64:67]
    s_waitcnt lgkmcnt(4)
    s_min_u32 s24, s24, 63
    v_mfma_f32_16x16x32_bf16 v[52:55], v[44:47], a[88:91], v[52:55]
    ds_read_b128 v[36:39], v14 offset:16640
    v_mfma_f32_16x16x32_bf16 v[56:59], v[44:47], a[92:95], v[56:59]
    v_mfma_f32_16x16x32_bf16 v[60:63], v[48:51], a[88:91], v[60:63]
    ds_read_b128 v[40:43], v14 offset:20736
    s_lshl_b32 s53, s24, 16
    v_mfma_f32_16x16x32_bf16 v[64:67], v[48:51], a[92:95], v[64:67]
    s_waitcnt lgkmcnt(4)
    v_mfma_f32_16x16x32_bf16 v[52:55], v[20:23], a[96:99], v[52:55]
    ds_read_b128 v[44:47], v15 offset:16640
    s_add_u32 m0, s21, 117760
    v_mfma_f32_16x16x32_bf16 v[56:59], v[20:23], a[100:103], v[56:59]
    buffer_load_dwordx4 v11, s[8:11], s20 offen lds
    v_mfma_f32_16x16x32_bf16 v[60:63], v[24:27], a[96:99], v[60:63]
    ds_read_b128 v[48:51], v15 offset:20736
    v_mfma_f32_16x16x32_bf16 v[64:67], v[24:27], a[100:103], v[64:67]
    s_waitcnt lgkmcnt(4)
    v_mfma_f32_16x16x32_bf16 v[52:55], v[28:31], a[104:107], v[52:55]
    s_waitcnt vmcnt(20)
    s_barrier
    ds_read_b128 v[20:23], v12 offset:32768
    v_mfma_f32_16x16x32_bf16 v[56:59], v[28:31], a[108:111], v[56:59]
    s_mov_b32 s20, s53
    v_mfma_f32_16x16x32_bf16 v[60:63], v[32:35], a[104:107], v[60:63]
    ds_read_b128 v[24:27], v12 offset:36864
    v_mfma_f32_16x16x32_bf16 v[64:67], v[32:35], a[108:111], v[64:67]
    s_waitcnt lgkmcnt(4)
    v_mfma_f32_16x16x32_bf16 v[52:55], v[36:39], a[112:115], v[52:55]
    ds_read_b128 v[28:31], v13 offset:32768
    s_add_u32 m0, s21, 0
    v_mfma_f32_16x16x32_bf16 v[56:59], v[36:39], a[116:119], v[56:59]
    buffer_load_dwordx4 v8, s[8:11], s20 offen lds
    v_mfma_f32_16x16x32_bf16 v[60:63], v[40:43], a[112:115], v[60:63]
    ds_read_b128 v[32:35], v13 offset:36864
    v_mfma_f32_16x16x32_bf16 v[64:67], v[40:43], a[116:119], v[64:67]
    s_waitcnt lgkmcnt(4)
    v_mfma_f32_16x16x32_bf16 v[52:55], v[44:47], a[120:123], v[52:55]
    ds_read_b128 v[36:39], v14 offset:32768
    v_mfma_f32_16x16x32_bf16 v[56:59], v[44:47], a[124:127], v[56:59]
    v_mfma_f32_16x16x32_bf16 v[60:63], v[48:51], a[120:123], v[60:63]
    ds_read_b128 v[40:43], v14 offset:36864
    v_mfma_f32_16x16x32_bf16 v[64:67], v[48:51], a[124:127], v[64:67]
    s_waitcnt lgkmcnt(4)
    v_mfma_f32_16x16x32_bf16 v[52:55], v[20:23], a[128:131], v[52:55]
    ds_read_b128 v[44:47], v15 offset:32768
    s_add_u32 m0, s21, 1024
    v_mfma_f32_16x16x32_bf16 v[56:59], v[20:23], a[132:135], v[56:59]
    buffer_load_dwordx4 v9, s[8:11], s20 offen lds
    v_mfma_f32_16x16x32_bf16 v[60:63], v[24:27], a[128:131], v[60:63]
    ds_read_b128 v[48:51], v15 offset:36864
    v_mfma_f32_16x16x32_bf16 v[64:67], v[24:27], a[132:135], v[64:67]
    s_waitcnt lgkmcnt(4)
    v_mfma_f32_16x16x32_bf16 v[52:55], v[28:31], a[136:139], v[52:55]
    ds_read_b128 v[20:23], v12 offset:33024
    v_mfma_f32_16x16x32_bf16 v[56:59], v[28:31], a[140:143], v[56:59]
    v_mfma_f32_16x16x32_bf16 v[60:63], v[32:35], a[136:139], v[60:63]
    ds_read_b128 v[24:27], v12 offset:37120
    v_mfma_f32_16x16x32_bf16 v[64:67], v[32:35], a[140:143], v[64:67]
    s_waitcnt lgkmcnt(4)
    v_mfma_f32_16x16x32_bf16 v[52:55], v[36:39], a[144:147], v[52:55]
    ds_read_b128 v[28:31], v13 offset:33024
    s_add_u32 m0, s21, 2048
    v_mfma_f32_16x16x32_bf16 v[56:59], v[36:39], a[148:151], v[56:59]
    buffer_load_dwordx4 v10, s[8:11], s20 offen lds
    v_mfma_f32_16x16x32_bf16 v[60:63], v[40:43], a[144:147], v[60:63]
    ds_read_b128 v[32:35], v13 offset:37120
    v_mfma_f32_16x16x32_bf16 v[64:67], v[40:43], a[148:151], v[64:67]
    s_waitcnt lgkmcnt(4)
    v_mfma_f32_16x16x32_bf16 v[52:55], v[44:47], a[152:155], v[52:55]
    ds_read_b128 v[36:39], v14 offset:33024
    v_mfma_f32_16x16x32_bf16 v[56:59], v[44:47], a[156:159], v[56:59]
    v_mfma_f32_16x16x32_bf16 v[60:63], v[48:51], a[152:155], v[60:63]
    ds_read_b128 v[40:43], v14 offset:37120
    v_mfma_f32_16x16x32_bf16 v[64:67], v[48:51], a[156:159], v[64:67]
    s_waitcnt lgkmcnt(4)
    v_mfma_f32_16x16x32_bf16 v[52:55], v[20:23], a[160:163], v[52:55]
    ds_read_b128 v[44:47], v15 offset:33024
    s_add_u32 m0, s21, 3072
    v_mfma_f32_16x16x32_bf16 v[56:59], v[20:23], a[164:167], v[56:59]
    buffer_load_dwordx4 v11, s[8:11], s20 offen lds
    v_mfma_f32_16x16x32_bf16 v[60:63], v[24:27], a[160:163], v[60:63]
    ds_read_b128 v[48:51], v15 offset:37120
    v_mfma_f32_16x16x32_bf16 v[64:67], v[24:27], a[164:167], v[64:67]
    s_waitcnt lgkmcnt(4)
    v_mfma_f32_16x16x32_bf16 v[52:55], v[28:31], a[168:171], v[52:55]
    s_waitcnt vmcnt(7)
    s_barrier
    ds_read_b128 v[20:23], v12 offset:49152
    v_mfma_f32_16x16x32_bf16 v[56:59], v[28:31], a[172:175], v[56:59]
    s_add_u32 s20, s20, 512
    buffer_atomic_add v84, v85, s[12:15], s39 offen sc1
    v_mfma_f32_16x16x32_bf16 v[60:63], v[32:35], a[168:171], v[60:63]
    ds_read_b128 v[24:27], v12 offset:53248
    s_mov_b32 s37, 1
    v_mfma_f32_16x16x32_bf16 v[64:67], v[32:35], a[172:175], v[64:67]
    s_waitcnt lgkmcnt(4)
    v_mfma_f32_16x16x32_bf16 v[52:55], v[36:39], a[176:179], v[52:55]
    ds_read_b128 v[28:31], v13 offset:49152
    s_add_u32 m0, s21, 16384
    v_mfma_f32_16x16x32_bf16 v[56:59], v[36:39], a[180:183], v[56:59]
    buffer_load_dwordx4 v8, s[8:11], s20 offen lds
    v_mfma_f32_16x16x32_bf16 v[60:63], v[40:43], a[176:179], v[60:63]
    ds_read_b128 v[32:35], v13 offset:53248
    v_mfma_f32_16x16x32_bf16 v[64:67], v[40:43], a[180:183], v[64:67]
    s_waitcnt lgkmcnt(4)
    v_mfma_f32_16x16x32_bf16 v[52:55], v[44:47], a[184:187], v[52:55]
    ds_read_b128 v[36:39], v14 offset:49152
    v_mfma_f32_16x16x32_bf16 v[56:59], v[44:47], a[188:191], v[56:59]
    v_mfma_f32_16x16x32_bf16 v[60:63], v[48:51], a[184:187], v[60:63]
    ds_read_b128 v[40:43], v14 offset:53248
    v_mfma_f32_16x16x32_bf16 v[64:67], v[48:51], a[188:191], v[64:67]
    s_waitcnt lgkmcnt(4)
    v_mfma_f32_16x16x32_bf16 v[52:55], v[20:23], a[192:195], v[52:55]
    ds_read_b128 v[44:47], v15 offset:49152
    s_add_u32 m0, s21, 17408
    v_mfma_f32_16x16x32_bf16 v[56:59], v[20:23], a[196:199], v[56:59]
    buffer_load_dwordx4 v9, s[8:11], s20 offen lds
    v_mfma_f32_16x16x32_bf16 v[60:63], v[24:27], a[192:195], v[60:63]
    ds_read_b128 v[48:51], v15 offset:53248
    v_mfma_f32_16x16x32_bf16 v[64:67], v[24:27], a[196:199], v[64:67]
    s_waitcnt lgkmcnt(4)
    v_mfma_f32_16x16x32_bf16 v[52:55], v[28:31], a[200:203], v[52:55]
    ds_read_b128 v[20:23], v12 offset:49408
    v_mfma_f32_16x16x32_bf16 v[56:59], v[28:31], a[204:207], v[56:59]
    v_mfma_f32_16x16x32_bf16 v[60:63], v[32:35], a[200:203], v[60:63]
    ds_read_b128 v[24:27], v12 offset:53504
    v_mfma_f32_16x16x32_bf16 v[64:67], v[32:35], a[204:207], v[64:67]
    s_waitcnt lgkmcnt(4)
    v_mfma_f32_16x16x32_bf16 v[52:55], v[36:39], a[208:211], v[52:55]
    ds_read_b128 v[28:31], v13 offset:49408
    s_add_u32 m0, s21, 18432
    v_mfma_f32_16x16x32_bf16 v[56:59], v[36:39], a[212:215], v[56:59]
    buffer_load_dwordx4 v10, s[8:11], s20 offen lds
    v_mfma_f32_16x16x32_bf16 v[60:63], v[40:43], a[208:211], v[60:63]
    ds_read_b128 v[32:35], v13 offset:53504
    v_mfma_f32_16x16x32_bf16 v[64:67], v[40:43], a[212:215], v[64:67]
    s_waitcnt lgkmcnt(4)
    v_mfma_f32_16x16x32_bf16 v[52:55], v[44:47], a[216:219], v[52:55]
    ds_read_b128 v[36:39], v14 offset:49408
    v_mfma_f32_16x16x32_bf16 v[56:59], v[44:47], a[220:223], v[56:59]
    v_mfma_f32_16x16x32_bf16 v[60:63], v[48:51], a[216:219], v[60:63]
    ds_read_b128 v[40:43], v14 offset:53504
    v_mfma_f32_16x16x32_bf16 v[64:67], v[48:51], a[220:223], v[64:67]
    s_waitcnt lgkmcnt(4)
    v_mfma_f32_16x16x32_bf16 v[52:55], v[20:23], a[224:227], v[52:55]
    ds_read_b128 v[44:47], v15 offset:49408
    s_add_u32 m0, s21, 19456
    v_mfma_f32_16x16x32_bf16 v[56:59], v[20:23], a[228:231], v[56:59]
    buffer_load_dwordx4 v11, s[8:11], s20 offen lds
    v_mfma_f32_16x16x32_bf16 v[60:63], v[24:27], a[224:227], v[60:63]
    ds_read_b128 v[48:51], v15 offset:53504
    v_mfma_f32_16x16x32_bf16 v[64:67], v[24:27], a[228:231], v[64:67]
    s_waitcnt lgkmcnt(4)
    v_mfma_f32_16x16x32_bf16 v[52:55], v[28:31], a[232:235], v[52:55]
    s_waitcnt vmcnt(20)
    s_barrier
    ds_read_b128 v[20:23], v16 offset:0
    v_mfma_f32_16x16x32_bf16 v[56:59], v[28:31], a[236:239], v[56:59]
    s_add_u32 s20, s20, 512
    v_mfma_f32_16x16x32_bf16 v[60:63], v[32:35], a[232:235], v[60:63]
    ds_read_b128 v[24:27], v16 offset:4096
    v_mfma_f32_16x16x32_bf16 v[64:67], v[32:35], a[236:239], v[64:67]
    s_waitcnt lgkmcnt(4)
    v_mfma_f32_16x16x32_bf16 v[52:55], v[36:39], a[240:243], v[52:55]
    ds_read_b128 v[28:31], v17 offset:0
    s_add_u32 m0, s21, 32768
    v_mfma_f32_16x16x32_bf16 v[56:59], v[36:39], a[244:247], v[56:59]
    buffer_load_dwordx4 v8, s[8:11], s20 offen lds
    v_mfma_f32_16x16x32_bf16 v[60:63], v[40:43], a[240:243], v[60:63]
    ds_read_b128 v[32:35], v17 offset:4096
    v_mfma_f32_16x16x32_bf16 v[64:67], v[40:43], a[244:247], v[64:67]
    s_waitcnt lgkmcnt(4)
    v_mfma_f32_16x16x32_bf16 v[52:55], v[44:47], a[248:251], v[52:55]
    ds_read_b128 v[36:39], v18 offset:0
    v_mfma_f32_16x16x32_bf16 v[56:59], v[44:47], a[252:255], v[56:59]
    v_mfma_f32_16x16x32_bf16 v[60:63], v[48:51], a[248:251], v[60:63]
    ds_read_b128 v[40:43], v18 offset:4096
    v_mfma_f32_16x16x32_bf16 v[64:67], v[48:51], a[252:255], v[64:67]
    s_waitcnt lgkmcnt(4)
    s_add_u32 s22, s22, 1
    s_cmp_ge_u32 s22, s23
    s_cbranch_scc1 L_fl0_234
    v_mfma_f32_16x16x32_bf16 v[68:71], v[20:23], a[0:3], 0
    ds_read_b128 v[44:47], v19 offset:0
    s_add_u32 m0, s21, 33792
    s_sub_u32 s39, s22, 1
    v_mfma_f32_16x16x32_bf16 v[72:75], v[20:23], a[4:7], 0
    buffer_load_dwordx4 v9, s[8:11], s20 offen lds
    s_bitcmp1_b32 s39, 1
    s_cselect_b32 s38, s55, s54
    v_mfma_f32_16x16x32_bf16 v[76:79], v[24:27], a[0:3], 0
    ds_read_b128 v[48:51], v19 offset:4096
    v_mfma_f32_16x16x32_bf16 v[80:83], v[24:27], a[4:7], 0
    s_waitcnt lgkmcnt(4)
    s_add_u32 s38, s38, s44
    v_mfma_f32_16x16x32_bf16 v[68:71], v[28:31], a[8:11], v[68:71]
    ds_read_b128 v[20:23], v16 offset:256
    s_lshl_b32 s42, s39, 20
    v_mfma_f32_16x16x32_bf16 v[72:75], v[28:31], a[12:15], v[72:75]
    s_add_u32 s38, s38, s42
    s_lshl_b32 s39, s39, 7
    v_mfma_f32_16x16x32_bf16 v[76:79], v[32:35], a[8:11], v[76:79]
    ds_read_b128 v[24:27], v16 offset:4352
    s_add_u32 s39, s39, 0x5900000
    s_cmp_eq_u32 s37, 0
    s_cselect_b32 s38, 0x7ff00000, s38
    s_cselect_b32 s39, 0x7ff00000, s39
    v_mfma_f32_16x16x32_bf16 v[80:83], v[32:35], a[12:15], v[80:83]
    s_waitcnt lgkmcnt(4)
    v_mfma_f32_16x16x32_bf16 v[68:71], v[36:39], a[16:19], v[68:71]
    ds_read_b128 v[28:31], v17 offset:256
    s_add_u32 m0, s21, 34816
    v_mfma_f32_16x16x32_bf16 v[72:75], v[36:39], a[20:23], v[72:75]
    buffer_load_dwordx4 v10, s[8:11], s20 offen lds
    v_mfma_f32_16x16x32_bf16 v[76:79], v[40:43], a[16:19], v[76:79]
    ds_read_b128 v[32:35], v17 offset:4352
    v_cvt_pk_bf16_f32 v88, v52, v53
    v_mfma_f32_16x16x32_bf16 v[80:83], v[40:43], a[20:23], v[80:83]
    s_waitcnt lgkmcnt(4)
    v_cvt_pk_bf16_f32 v89, v54, v55
    v_cvt_pk_bf16_f32 v90, v60, v61
    v_mfma_f32_16x16x32_bf16 v[68:71], v[44:47], a[24:27], v[68:71]
    ds_read_b128 v[36:39], v18 offset:256
    v_cvt_pk_bf16_f32 v91, v62, v63
    v_mfma_f32_16x16x32_bf16 v[72:75], v[44:47], a[28:31], v[72:75]
    buffer_store_dwordx4 v[88:91], v86, s[12:15], s38 offen offset:2048 sc1
    v_mfma_f32_16x16x32_bf16 v[76:79], v[48:51], a[24:27], v[76:79]
    ds_read_b128 v[40:43], v18 offset:4352
    v_cvt_pk_bf16_f32 v92, v56, v57
    v_mfma_f32_16x16x32_bf16 v[80:83], v[48:51], a[28:31], v[80:83]
    s_waitcnt lgkmcnt(4)
    v_cvt_pk_bf16_f32 v93, v58, v59
    v_mfma_f32_16x16x32_bf16 v[68:71], v[20:23], a[32:35], v[68:71]
    ds_read_b128 v[44:47], v19 offset:256
    s_add_u32 m0, s21, 35840
    v_mfma_f32_16x16x32_bf16 v[72:75], v[20:23], a[36:39], v[72:75]
    buffer_load_dwordx4 v11, s[8:11], s20 offen lds
    v_mfma_f32_16x16x32_bf16 v[76:79], v[24:27], a[32:35], v[76:79]
    ds_read_b128 v[48:51], v19 offset:4352
    v_cvt_pk_bf16_f32 v94, v64, v65
    v_mfma_f32_16x16x32_bf16 v[80:83], v[24:27], a[36:39], v[80:83]
    s_waitcnt lgkmcnt(4)
    v_cvt_pk_bf16_f32 v95, v66, v67
    v_mfma_f32_16x16x32_bf16 v[68:71], v[28:31], a[40:43], v[68:71]
    s_waitcnt vmcnt(20)
    s_barrier
    ds_read_b128 v[20:23], v16 offset:16384
    v_mfma_f32_16x16x32_bf16 v[72:75], v[28:31], a[44:47], v[72:75]
    s_add_u32 s20, s20, 512
    buffer_store_dwordx4 v[92:95], v86, s[12:15], s38 offen offset:2176 sc1
    v_mfma_f32_16x16x32_bf16 v[76:79], v[32:35], a[40:43], v[76:79]
    ds_read_b128 v[24:27], v16 offset:20480
    s_add_u32 s42, s38, 0x8000000
    v_mfma_f32_16x16x32_bf16 v[80:83], v[32:35], a[44:47], v[80:83]
    s_waitcnt lgkmcnt(4)
    v_mfma_f32_16x16x32_bf16 v[68:71], v[36:39], a[48:51], v[68:71]
    ds_read_b128 v[28:31], v17 offset:16384
    s_add_u32 m0, s21, 49152
    v_mfma_f32_16x16x32_bf16 v[72:75], v[36:39], a[52:55], v[72:75]
    buffer_load_dwordx4 v8, s[8:11], s20 offen lds
    v_mfma_f32_16x16x32_bf16 v[76:79], v[40:43], a[48:51], v[76:79]
    ds_read_b128 v[32:35], v17 offset:20480
    v_mfma_f32_16x16x32_bf16 v[80:83], v[40:43], a[52:55], v[80:83]
    s_waitcnt lgkmcnt(4)
    v_mfma_f32_16x16x32_bf16 v[68:71], v[44:47], a[56:59], v[68:71]
    ds_read_b128 v[36:39], v18 offset:16384
    v_mfma_f32_16x16x32_bf16 v[72:75], v[44:47], a[60:63], v[72:75]
    buffer_store_dwordx2 v[96:97], v101, s[12:15], s42 offen offset:512 sc1
    v_mfma_f32_16x16x32_bf16 v[76:79], v[48:51], a[56:59], v[76:79]
    ds_read_b128 v[40:43], v18 offset:20480
    v_mfma_f32_16x16x32_bf16 v[80:83], v[48:51], a[60:63], v[80:83]
    s_waitcnt lgkmcnt(4)
    v_mfma_f32_16x16x32_bf16 v[68:71], v[20:23], a[64:67], v[68:71]
    ds_read_b128 v[44:47], v19 offset:16384
    s_add_u32 m0, s21, 50176
    v_mfma_f32_16x16x32_bf16 v[72:75], v[20:23], a[68:71], v[72:75]
    buffer_load_dwordx4 v9, s[8:11], s20 offen lds
    v_mfma_f32_16x16x32_bf16 v[76:79], v[24:27], a[64:67], v[76:79]
    ds_read_b128 v[48:51], v19 offset:20480
    v_mfma_f32_16x16x32_bf16 v[80:83], v[24:27], a[68:71], v[80:83]
    s_waitcnt lgkmcnt(4)
    v_mfma_f32_16x16x32_bf16 v[68:71], v[28:31], a[72:75], v[68:71]
    ds_read_b128 v[20:23], v16 offset:16640
    v_mfma_f32_16x16x32_bf16 v[72:75], v[28:31], a[76:79], v[72:75]
    v_mfma_f32_16x16x32_bf16 v[76:79], v[32:35], a[72:75], v[76:79]
    ds_read_b128 v[24:27], v16 offset:20736
    s_add_u32 s24, s24, 1
    v_mfma_f32_16x16x32_bf16 v[80:83], v[32:35], a[76:79], v[80:83]
    s_waitcnt lgkmcnt(4)
    v_mfma_f32_16x16x32_bf16 v[68:71], v[36:39], a[80:83], v[68:71]
    ds_read_b128 v[28:31], v17 offset:16640
    s_add_u32 m0, s21, 51200
    v_mfma_f32_16x16x32_bf16 v[72:75], v[36:39], a[84:87], v[72:75]
    buffer_load_dwordx4 v10, s[8:11], s20 offen lds
    v_mfma_f32_16x16x32_bf16 v[76:79], v[40:43], a[80:83], v[76:79]
    ds_read_b128 v[32:35], v17 offset:20736
    v_mfma_f32_16x16x32_bf16 v[80:83], v[40:43], a[84:87], v[80:83]
    s_waitcnt lgkmcnt(4)
    s_min_u32 s24, s24, 63
    v_mfma_f32_16x16x32_bf16 v[68:71], v[44:47], a[88:91], v[68:71]
    ds_read_b128 v[36:39], v18 offset:16640
    v_mfma_f32_16x16x32_bf16 v[72:75], v[44:47], a[92:95], v[72:75]
    v_mfma_f32_16x16x32_bf16 v[76:79], v[48:51], a[88:91], v[76:79]
    ds_read_b128 v[40:43], v18 offset:20736
    s_lshl_b32 s53, s24, 16
    v_mfma_f32_16x16x32_bf16 v[80:83], v[48:51], a[92:95], v[80:83]
    s_waitcnt lgkmcnt(4)
    v_mfma_f32_16x16x32_bf16 v[68:71], v[20:23], a[96:99], v[68:71]
    ds_read_b128 v[44:47], v19 offset:16640
    s_add_u32 m0, s21, 52224
    v_mfma_f32_16x16x32_bf16 v[72:75], v[20:23], a[100:103], v[72:75]
    buffer_load_dwordx4 v11, s[8:11], s20 offen lds
    v_mfma_f32_16x16x32_bf16 v[76:79], v[24:27], a[96:99], v[76:79]
    ds_read_b128 v[48:51], v19 offset:20736
    v_mfma_f32_16x16x32_bf16 v[80:83], v[24:27], a[100:103], v[80:83]
    s_waitcnt lgkmcnt(4)
    v_mfma_f32_16x16x32_bf16 v[68:71], v[28:31], a[104:107], v[68:71]
    s_waitcnt vmcnt(20)
    s_barrier
    ds_read_b128 v[20:23], v16 offset:32768
    v_mfma_f32_16x16x32_bf16 v[72:75], v[28:31], a[108:111], v[72:75]
    s_mov_b32 s20, s53
    v_mfma_f32_16x16x32_bf16 v[76:79], v[32:35], a[104:107], v[76:79]
    ds_read_b128 v[24:27], v16 offset:36864
    v_mfma_f32_16x16x32_bf16 v[80:83], v[32:35], a[108:111], v[80:83]
    s_waitcnt lgkmcnt(4)
    v_mfma_f32_16x16x32_bf16 v[68:71], v[36:39], a[112:115], v[68:71]
    ds_read_b128 v[28:31], v17 offset:32768
    s_add_u32 m0, s21, 65536
    v_mfma_f32_16x16x32_bf16 v[72:75], v[36:39], a[116:119], v[72:75]
    buffer_load_dwordx4 v8, s[8:11], s20 offen lds
    v_mfma_f32_16x16x32_bf16 v[76:79], v[40:43], a[112:115], v[76:79]
    ds_read_b128 v[32:35], v17 offset:36864
    v_mfma_f32_16x16x32_bf16 v[80:83], v[40:43], a[116:119], v[80:83]
    s_waitcnt lgkmcnt(4)
    v_mfma_f32_16x16x32_bf16 v[68:71], v[44:47], a[120:123], v[68:71]
    ds_read_b128 v[36:39], v18 offset:32768
    v_mfma_f32_16x16x32_bf16 v[72:75], v[44:47], a[124:127], v[72:75]
    v_mfma_f32_16x16x32_bf16 v[76:79], v[48:51], a[120:123], v[76:79]
    ds_read_b128 v[40:43], v18 offset:36864
    v_mfma_f32_16x16x32_bf16 v[80:83], v[48:51], a[124:127], v[80:83]
    s_waitcnt lgkmcnt(4)
    v_mfma_f32_16x16x32_bf16 v[68:71], v[20:23], a[128:131], v[68:71]
    ds_read_b128 v[44:47], v19 offset:32768
    s_add_u32 m0, s21, 66560
    v_mfma_f32_16x16x32_bf16 v[72:75], v[20:23], a[132:135], v[72:75]
    buffer_load_dwordx4 v9, s[8:11], s20 offen lds
    v_mfma_f32_16x16x32_bf16 v[76:79], v[24:27], a[128:131], v[76:79]
    ds_read_b128 v[48:51], v19 offset:36864
    v_mfma_f32_16x16x32_bf16 v[80:83], v[24:27], a[132:135], v[80:83]
    s_waitcnt lgkmcnt(4)
    v_mfma_f32_16x16x32_bf16 v[68:71], v[28:31], a[136:139], v[68:71]
    ds_read_b128 v[20:23], v16 offset:33024
    v_mfma_f32_16x16x32_bf16 v[72:75], v[28:31], a[140:143], v[72:75]
    v_mfma_f32_16x16x32_bf16 v[76:79], v[32:35], a[136:139], v[76:79]
    ds_read_b128 v[24:27], v16 offset:37120
    v_mfma_f32_16x16x32_bf16 v[80:83], v[32:35], a[140:143], v[80:83]
    s_waitcnt lgkmcnt(4)
    v_mfma_f32_16x16x32_bf16 v[68:71], v[36:39], a[144:147], v[68:71]
    ds_read_b128 v[28:31], v17 offset:33024
    s_add_u32 m0, s21, 67584
    v_mfma_f32_16x16x32_bf16 v[72:75], v[36:39], a[148:151], v[72:75]
    buffer_load_dwordx4 v10, s[8:11], s20 offen lds
    v_mfma_f32_16x16x32_bf16 v[76:79], v[40:43], a[144:147], v[76:79]
    ds_read_b128 v[32:35], v17 offset:37120
    v_mfma_f32_16x16x32_bf16 v[80:83], v[40:43], a[148:151], v[80:83]
    s_waitcnt lgkmcnt(4)
    v_mfma_f32_16x16x32_bf16 v[68:71], v[44:47], a[152:155], v[68:71]
    ds_read_b128 v[36:39], v18 offset:33024
    v_mfma_f32_16x16x32_bf16 v[72:75], v[44:47], a[156:159], v[72:75]
    v_mfma_f32_16x16x32_bf16 v[76:79], v[48:51], a[152:155], v[76:79]
    ds_read_b128 v[40:43], v18 offset:37120
    v_mfma_f32_16x16x32_bf16 v[80:83], v[48:51], a[156:159], v[80:83]
    s_waitcnt lgkmcnt(4)
    v_mfma_f32_16x16x32_bf16 v[68:71], v[20:23], a[160:163], v[68:71]
    ds_read_b128 v[44:47], v19 offset:33024
    s_add_u32 m0, s21, 68608
    v_mfma_f32_16x16x32_bf16 v[72:75], v[20:23], a[164:167], v[72:75]
    buffer_load_dwordx4 v11, s[8:11], s20 offen lds
    v_mfma_f32_16x16x32_bf16 v[76:79], v[24:27], a[160:163], v[76:79]
    ds_read_b128 v[48:51], v19 offset:37120
    v_mfma_f32_16x16x32_bf16 v[80:83], v[24:27], a[164:167], v[80:83]
    s_waitcnt lgkmcnt(4)
    v_mfma_f32_16x16x32_bf16 v[68:71], v[28:31], a[168:171], v[68:71]
    s_waitcnt vmcnt(7)
    s_barrier
    ds_read_b128 v[20:23], v16 offset:49152
    v_mfma_f32_16x16x32_bf16 v[72:75], v[28:31], a[172:175], v[72:75]
    s_add_u32 s20, s20, 512
    buffer_atomic_add v84, v85, s[12:15], s39 offen sc1
    v_mfma_f32_16x16x32_bf16 v[76:79], v[32:35], a[168:171], v[76:79]
    ds_read_b128 v[24:27], v16 offset:53248
    s_mov_b32 s37, 1
    v_mfma_f32_16x16x32_bf16 v[80:83], v[32:35], a[172:175], v[80:83]
    s_waitcnt lgkmcnt(4)
    v_mfma_f32_16x16x32_bf16 v[68:71], v[36:39], a[176:179], v[68:71]
    ds_read_b128 v[28:31], v17 offset:49152
    s_add_u32 m0, s21, 81920
    v_mfma_f32_16x16x32_bf16 v[72:75], v[36:39], a[180:183], v[72:75]
    buffer_load_dwordx4 v8, s[8:11], s20 offen lds
    v_mfma_f32_16x16x32_bf16 v[76:79], v[40:43], a[176:179], v[76:79]
    ds_read_b128 v[32:35], v17 offset:53248
    v_mfma_f32_16x16x32_bf16 v[80:83], v[40:43], a[180:183], v[80:83]
    s_waitcnt lgkmcnt(4)
    v_mfma_f32_16x16x32_bf16 v[68:71], v[44:47], a[184:187], v[68:71]
    ds_read_b128 v[36:39], v18 offset:49152
    v_mfma_f32_16x16x32_bf16 v[72:75], v[44:47], a[188:191], v[72:75]
    v_mfma_f32_16x16x32_bf16 v[76:79], v[48:51], a[184:187], v[76:79]
    ds_read_b128 v[40:43], v18 offset:53248
    v_mfma_f32_16x16x32_bf16 v[80:83], v[48:51], a[188:191], v[80:83]
    s_waitcnt lgkmcnt(4)
    v_mfma_f32_16x16x32_bf16 v[68:71], v[20:23], a[192:195], v[68:71]
    ds_read_b128 v[44:47], v19 offset:49152
    s_add_u32 m0, s21, 82944
    v_mfma_f32_16x16x32_bf16 v[72:75], v[20:23], a[196:199], v[72:75]
    buffer_load_dwordx4 v9, s[8:11], s20 offen lds
    v_mfma_f32_16x16x32_bf16 v[76:79], v[24:27], a[192:195], v[76:79]
    ds_read_b128 v[48:51], v19 offset:53248
    v_mfma_f32_16x16x32_bf16 v[80:83], v[24:27], a[196:199], v[80:83]
    s_waitcnt lgkmcnt(4)
    v_mfma_f32_16x16x32_bf16 v[68:71], v[28:31], a[200:203], v[68:71]
    ds_read_b128 v[20:23], v16 offset:49408
    v_mfma_f32_16x16x32_bf16 v[72:75], v[28:31], a[204:207], v[72:75]
    v_mfma_f32_16x16x32_bf16 v[76:79], v[32:35], a[200:203], v[76:79]
    ds_read_b128 v[24:27], v16 offset:53504
    v_mfma_f32_16x16x32_bf16 v[80:83], v[32:35], a[204:207], v[80:83]
    s_waitcnt lgkmcnt(4)
    v_mfma_f32_16x16x32_bf16 v[68:71], v[36:39], a[208:211], v[68:71]
    ds_read_b128 v[28:31], v17 offset:49408
    s_add_u32 m0, s21, 83968
    v_mfma_f32_16x16x32_bf16 v[72:75], v[36:39], a[212:215], v[72:75]
    buffer_load_dwordx4 v10, s[8:11], s20 offen lds
    v_mfma_f32_16x16x32_bf16 v[76:79], v[40:43], a[208:211], v[76:79]
    ds_read_b128 v[32:35], v17 offset:53504
    v_mfma_f32_16x16x32_bf16 v[80:83], v[40:43], a[212:215], v[80:83]
    s_waitcnt lgkmcnt(4)
    v_mfma_f32_16x16x32_bf16 v[68:71], v[44:47], a[216:219], v[68:71]
    ds_read_b128 v[36:39], v18 offset:49408
    v_mfma_f32_16x16x32_bf16 v[72:75], v[44:47], a[220:223], v[72:75]
    v_mfma_f32_16x16x32_bf16 v[76:79], v[48:51], a[216:219], v[76:79]
    ds_read_b128 v[40:43], v18 offset:53504
    v_mfma_f32_16x16x32_bf16 v[80:83], v[48:51], a[220:223], v[80:83]
    s_waitcnt lgkmcnt(4)
    v_mfma_f32_16x16x32_bf16 v[68:71], v[20:23], a[224:227], v[68:71]
    ds_read_b128 v[44:47], v19 offset:49408
    s_add_u32 m0, s21, 84992
    v_mfma_f32_16x16x32_bf16 v[72:75], v[20:23], a[228:231], v[72:75]
    buffer_load_dwordx4 v11, s[8:11], s20 offen lds
    v_mfma_f32_16x16x32_bf16 v[76:79], v[24:27], a[224:227], v[76:79]
    ds_read_b128 v[48:51], v19 offset:53504
    v_mfma_f32_16x16x32_bf16 v[80:83], v[24:27], a[228:231], v[80:83]
    s_waitcnt lgkmcnt(4)
    v_mfma_f32_16x16x32_bf16 v[68:71], v[28:31], a[232:235], v[68:71]
    s_waitcnt vmcnt(20)
    s_barrier
    ds_read_b128 v[20:23], v12 offset:0
    v_mfma_f32_16x16x32_bf16 v[72:75], v[28:31], a[236:239], v[72:75]
    s_add_u32 s20, s20, 512
    v_mfma_f32_16x16x32_bf16 v[76:79], v[32:35], a[232:235], v[76:79]
    ds_read_b128 v[24:27], v12 offset:4096
    v_mfma_f32_16x16x32_bf16 v[80:83], v[32:35], a[236:239], v[80:83]
    s_waitcnt lgkmcnt(4)
    v_mfma_f32_16x16x32_bf16 v[68:71], v[36:39], a[240:243], v[68:71]
    ds_read_b128 v[28:31], v13 offset:0
    s_add_u32 m0, s21, 98304
    v_mfma_f32_16x16x32_bf16 v[72:75], v[36:39], a[244:247], v[72:75]
    buffer_load_dwordx4 v8, s[8:11], s20 offen lds
    v_mfma_f32_16x16x32_bf16 v[76:79], v[40:43], a[240:243], v[76:79]
    ds_read_b128 v[32:35], v13 offset:4096
    v_mfma_f32_16x16x32_bf16 v[80:83], v[40:43], a[244:247], v[80:83]
    s_waitcnt lgkmcnt(4)
    v_mfma_f32_16x16x32_bf16 v[68:71], v[44:47], a[248:251], v[68:71]
    ds_read_b128 v[36:39], v14 offset:0
    v_mfma_f32_16x16x32_bf16 v[72:75], v[44:47], a[252:255], v[72:75]
    v_mfma_f32_16x16x32_bf16 v[76:79], v[48:51], a[248:251], v[76:79]
    ds_read_b128 v[40:43], v14 offset:4096
    v_mfma_f32_16x16x32_bf16 v[80:83], v[48:51], a[252:255], v[80:83]
    s_waitcnt lgkmcnt(4)
    s_add_u32 s22, s22, 1
    s_cmp_ge_u32 s22, s23
    s_cbranch_scc0 L_st_237
L_fl1_235:
    s_waitcnt lgkmcnt(0)
    s_nop 7
    s_sub_u32 s39, s22, 1
    s_bitcmp1_b32 s39, 1
    s_cselect_b32 s38, s55, s54
    s_add_u32 s38, s38, s44
    s_lshl_b32 s42, s39, 20
    s_add_u32 s38, s38, s42
    s_lshl_b32 s39, s39, 7
    s_add_u32 s39, s39, 0x5900000
    s_cmp_eq_u32 s37, 0
    s_cselect_b32 s38, 0x7ff00000, s38
    s_cselect_b32 s39, 0x7ff00000, s39
    v_cvt_pk_bf16_f32 v88, v68, v69
    v_cvt_pk_bf16_f32 v89, v70, v71
    v_cvt_pk_bf16_f32 v90, v76, v77
    v_cvt_pk_bf16_f32 v91, v78, v79
    buffer_store_dwordx4 v[88:91], v86, s[12:15], s38 offen offset:2048 sc1
    v_cvt_pk_bf16_f32 v92, v72, v73
    v_cvt_pk_bf16_f32 v93, v74, v75
    v_cvt_pk_bf16_f32 v94, v80, v81
    v_cvt_pk_bf16_f32 v95, v82, v83
    buffer_store_dwordx4 v[92:95], v86, s[12:15], s38 offen offset:2176 sc1
    s_add_u32 s42, s38, 0x8000000
    buffer_store_dwordx2 v[96:97], v101, s[12:15], s42 offen offset:512 sc1
    s_waitcnt vmcnt(0)
    s_barrier
    buffer_atomic_add v84, v85, s[12:15], s39 offen sc1
    s_mov_b32 s37, 1
    s_branch L_ste_236
L_fl0_234:
    s_waitcnt lgkmcnt(0)
    s_nop 7
    s_sub_u32 s39, s22, 1
    s_bitcmp1_b32 s39, 1
    s_cselect_b32 s38, s55, s54
    s_add_u32 s38, s38, s44
    s_lshl_b32 s42, s39, 20
    s_add_u32 s38, s38, s42
    s_lshl_b32 s39, s39, 7
    s_add_u32 s39, s39, 0x5900000
    s_cmp_eq_u32 s37, 0
    s_cselect_b32 s38, 0x7ff00000, s38
    s_cselect_b32 s39, 0x7ff00000, s39
    v_cvt_pk_bf16_f32 v88, v52, v53
    v_cvt_pk_bf16_f32 v89, v54, v55
    v_cvt_pk_bf16_f32 v90, v60, v61
    v_cvt_pk_bf16_f32 v91, v62, v63
    buffer_store_dwordx4 v[88:91], v86, s[12:15], s38 offen offset:2048 sc1
    v_cvt_pk_bf16_f32 v92, v56, v57
    v_cvt_pk_bf16_f32 v93, v58, v59
    v_cvt_pk_bf16_f32 v94, v64, v65
    v_cvt_pk_bf16_f32 v95, v66, v67
    buffer_store_dwordx4 v[92:95], v86, s[12:15], s38 offen offset:2176 sc1
    s_add_u32 s42, s38, 0x8000000
    buffer_store_dwordx2 v[96:97], v101, s[12:15], s42 offen offset:512 sc1
    s_waitcnt vmcnt(0)
    s_barrier
    buffer_atomic_add v84, v85, s[12:15], s39 offen sc1
    s_mov_b32 s37, 1
L_ste_236:
    s_branch L_op_223
L_q_220:
    v_and_b32 v1, 31, v0
    v_bfe_u32 v2, v0, 5, 1
    v_and_b32 v96, 63, v0
    v_lshlrev_b32 v96, 4, v96
    v_and_b32 v4, 7, v1
    v_lshlrev_b32 v4, 4, v4
    s_lshl_b32 s7, s49, 12
    s_add_u32 s7, s7, 0x21000
    v_lshl_add_u32 v97, v2, 7, v4
    v_add_u32 v97, s7, v97
    v_bfe_u32 v5, v1, 2, 1
    v_lshlrev_b32 v5, 4, v5
    v_lshrrev_b32 v6, 3, v1
    v_lshl_add_u32 v5, v6, 2, v5
    v_and_b32 v6, 3, v1
    v_add_u32 v5, v5, v6
    v_lshlrev_b32 v5, 4, v5
    v_lshl_add_u32 v98, v2, 9, v5
    v_lshl_add_u32 v99, v2, 3, v5
    v_add_u32 v99, s7, v99
    v_lshlrev_b32 v4, 4, v1
    v_lshl_add_u32 v100, v2, 10, v4
    v_and_b32 v85, 63, v0
    v_min_u32 v85, 1, v85
    v_lshlrev_b32 v85, 30, v85
    v_lshlrev_b32 v4, 2, v2
    v_sub_u32 v4, v1, v4
    v_mov_b32 v5, 0xff800000
    v_cmp_gt_i32 vcc, 0, v4
    s_nop 1
    v_cndmask_b32 v240, 0, v5, vcc
    v_cmp_gt_i32 vcc, 1, v4
    s_nop 1
    v_cndmask_b32 v241, 0, v5, vcc
    v_cmp_gt_i32 vcc, 2, v4
    s_nop 1
    v_cndmask_b32 v242, 0, v5, vcc
    v_cmp_gt_i32 vcc, 3, v4
    s_nop 1
    v_cndmask_b32 v243, 0, v5, vcc
    v_cmp_gt_i32 vcc, 8, v4
    s_nop 1
    v_cndmask_b32 v244, 0, v5, vcc
    v_cmp_gt_i32 vcc, 9, v4
    s_nop 1
    v_cndmask_b32 v245, 0, v5, vcc
    v_cmp_gt_i32 vcc, 10, v4
    s_nop 1
    v_cndmask_b32 v246, 0, v5, vcc
    v_cmp_gt_i32 vcc, 11, v4
    s_nop 1
    v_cndmask_b32 v247, 0, v5, vcc
    v_cmp_gt_i32 vcc, 16, v4
    s_nop 1
    v_cndmask_b32 v248, 0, v5, vcc
    v_cmp_gt_i32 vcc, 17, v4
    s_nop 1
    v_cndmask_b32 v249, 0, v5, vcc
    v_cmp_gt_i32 vcc, 18, v4
    s_nop 1
    v_cndmask_b32 v250, 0, v5, vcc
    v_cmp_gt_i32 vcc, 19, v4
    s_nop 1
    v_cndmask_b32 v251, 0, v5, vcc
    v_cmp_gt_i32 vcc, 24, v4
    s_nop 1
    v_cndmask_b32 v252, 0, v5, vcc
    v_cmp_gt_i32 vcc, 25, v4
    s_nop 1
    v_cndmask_b32 v253, 0, v5, vcc
    v_cmp_gt_i32 vcc, 26, v4
    s_nop 1
    v_cndmask_b32 v254, 0, v5, vcc
    v_cmp_gt_i32 vcc, 27, v4
    s_nop 1
    v_cndmask_b32 v255, 0, v5, vcc
    s_mov_b32 s47, 0
    v_mov_b32 v102, 0x20000
    v_lshl_add_u32 v101, v0, 2, v102
    v_mov_b32 v103, 4
    v_mov_b32 v87, 0
    s_mov_b32 s48, 0x40000000
    s_mov_b32 s50, 0x40000000
    s_mov_b32 s51, 0x40000000
    s_mov_b32 s94, 0x40000000
    s_mov_b32 s45, 0
    s_mov_b64 s[56:57], 0
    s_mov_b64 s[58:59], 0
    s_barrier
    s_add_u32 m0, s21, 0
    s_nop 0
    buffer_load_dwordx4 v8, s[8:11], s20 offen lds
    s_add_u32 m0, s21, 1024
    s_nop 0
    buffer_load_dwordx4 v9, s[8:11], s20 offen lds
    s_add_u32 m0, s21, 2048
    s_nop 0
    buffer_load_dwordx4 v10, s[8:11], s20 offen lds
    s_add_u32 m0, s21, 3072
    s_nop 0
    buffer_load_dwordx4 v11, s[8:11], s20 offen lds
    s_add_u32 s20, s20, 512
    s_add_u32 m0, s21, 16384
    s_nop 0
    buffer_load_dwordx4 v8, s[8:11], s20 offen lds
    s_add_u32 m0, s21, 17408
    s_nop 0
    buffer_load_dwordx4 v9, s[8:11], s20 offen lds
    s_add_u32 m0, s21, 18432
    s_nop 0
    buffer_load_dwordx4 v10, s[8:11], s20 offen lds
    s_add_u32 m0, s21, 19456
    s_nop 0
    buffer_load_dwordx4 v11, s[8:11], s20 offen lds
    s_add_u32 s20, s20, 512
    s_add_u32 m0, s21, 32768
    s_nop 0
    buffer_load_dwordx4 v8, s[8:11], s20 offen lds
    s_add_u32 m0, s21, 33792
    s_nop 0
    buffer_load_dwordx4 v9, s[8:11], s20 offen lds
    s_add_u32 m0, s21, 34816
    s_nop 0
    buffer_load_dwordx4 v10, s[8:11], s20 offen lds
    s_add_u32 m0, s21, 35840
    s_nop 0
    buffer_load_dwordx4 v11, s[8:11], s20 offen lds
    s_add_u32 s20, s20, 512
    s_add_u32 m0, s21, 49152
    s_nop 0
    buffer_load_dwordx4 v8, s[8:11], s20 offen lds
    s_add_u32 m0, s21, 50176
    s_nop 0
    buffer_load_dwordx4 v9, s[8:11], s20 offen lds
    s_add_u32 m0, s21, 51200
    s_nop 0
    buffer_load_dwordx4 v10, s[8:11], s20 offen lds
    s_add_u32 m0, s21, 52224
    s_nop 0
    buffer_load_dwordx4 v11, s[8:11], s20 offen lds
    s_add_u32 s24, s24, 1
    s_min_u32 s24, s24, 63
    s_lshl_b32 s53, s24, 16
    s_mov_b32 s20, s53
    s_add_u32 m0, s21, 65536
    s_nop 0
    buffer_load_dwordx4 v8, s[8:11], s20 offen lds
    s_add_u32 m0, s21, 66560
    s_nop 0
    buffer_load_dwordx4 v9, s[8:11], s20 offen lds
    s_add_u32 m0, s21, 67584
    s_nop 0
    buffer_load_dwordx4 v10, s[8:11], s20 offen lds
    s_add_u32 m0, s21, 68608
    s_nop 0
    buffer_load_dwordx4 v11, s[8:11], s20 offen lds
    s_add_u32 s20, s20, 512
    s_add_u32 m0, s21, 81920
    s_nop 0
    buffer_load_dwordx4 v8, s[8:11], s20 offen lds
    s_add_u32 m0, s21, 82944
    s_nop 0
    buffer_load_dwordx4 v9, s[8:11], s20 offen lds
    s_add_u32 m0, s21, 83968
    s_nop 0
    buffer_load_dwordx4 v10, s[8:11], s20 offen lds
    s_add_u32 m0, s21, 84992
    s_nop 0
    buffer_load_dwordx4 v11, s[8:11], s20 offen lds
    s_add_u32 s20, s20, 512
    s_add_u32 m0, s21, 98304
    s_nop 0
    buffer_load_dwordx4 v8, s[8:11], s20 offen lds
    s_waitcnt vmcnt(0)
    s_barrier
    ds_read_b128 v[20:23], v12 offset:0
    ds_read_b128 v[24:27], v12 offset:4096
    ds_read_b128 v[28:31], v13 offset:0
    ds_read_b128 v[32:35], v13 offset:4096
    ds_read_b128 v[36:39], v14 offset:0
    ds_read_b128 v[40:43], v14 offset:4096
    s_waitcnt lgkmcnt(4)
L_st_243:
    v_mfma_f32_16x16x32_bf16 v[52:55], a[0:3], v[20:23], 0
    ds_read_b128 v[44:47], v15 offset:0
    s_add_u32 m0, s21, 99328
    s_sub_u32 s39, s22, 1
    v_mfma_f32_16x16x32_bf16 v[56:59], a[4:7], v[20:23], 0
    buffer_load_dwordx4 v9, s[8:11], s20 offen lds
    v_mfma_f32_16x16x32_bf16 v[60:63], a[0:3], v[24:27], 0
    ds_read_b128 v[48:51], v15 offset:4096
    s_bitcmp1_b32 s39, 1
    s_cselect_b32 s38, s54, s55
    v_mfma_f32_16x16x32_bf16 v[64:67], a[4:7], v[24:27], 0
    s_waitcnt lgkmcnt(4)
    v_mfma_f32_16x16x32_bf16 v[52:55], a[8:11], v[28:31], v[52:55]
    ds_read_b128 v[20:23], v12 offset:256
    s_add_u32 s38, s38, s44
    s_waitcnt vmcnt(5)
    v_mfma_f32_16x16x32_bf16 v[56:59], a[12:15], v[28:31], v[56:59]
    s_lshl_b32 s42, s39, 20
    s_add_u32 s38, s38, s42
    ds_write_b32 v101, v87
    v_mfma_f32_16x16x32_bf16 v[60:63], a[8:11], v[32:35], v[60:63]
    ds_read_b128 v[24:27], v12 offset:4352
    s_cmp_eq_u32 s37, 0
    s_cselect_b32 s38, 0x7ff00000, s38
    v_mfma_f32_16x16x32_bf16 v[64:67], a[12:15], v[32:35], v[64:67]
    s_waitcnt lgkmcnt(4)
    v_mfma_f32_16x16x32_bf16 v[52:55], a[16:19], v[36:39], v[52:55]
    ds_read_b128 v[28:31], v13 offset:256
    s_add_u32 m0, s21, 100352
    v_mfma_f32_16x16x32_bf16 v[56:59], a[20:23], v[36:39], v[56:59]
    buffer_load_dwordx4 v10, s[8:11], s20 offen lds
    s_mov_b32 s37, 1
    v_mfma_f32_16x16x32_bf16 v[60:63], a[16:19], v[40:43], v[60:63]
    ds_read_b128 v[32:35], v13 offset:4352
    v_cvt_pk_bf16_f32 v88, v68, v69
    v_mfma_f32_16x16x32_bf16 v[64:67], a[20:23], v[40:43], v[64:67]
    s_waitcnt lgkmcnt(4)
    v_cvt_pk_bf16_f32 v89, v70, v71
    v_mfma_f32_16x16x32_bf16 v[52:55], a[24:27], v[44:47], v[52:55]
    ds_read_b128 v[36:39], v14 offset:256
    v_cvt_pk_bf16_f32 v90, v72, v73
    v_mfma_f32_16x16x32_bf16 v[56:59], a[28:31], v[44:47], v[56:59]
    v_cvt_pk_bf16_f32 v91, v74, v75
    v_mfma_f32_16x16x32_bf16 v[60:63], a[24:27], v[48:51], v[60:63]
    ds_read_b128 v[40:43], v14 offset:4352
    buffer_store_dwordx4 v[88:91], v86, s[12:15], s38 offen offset:0
    v_mfma_f32_16x16x32_bf16 v[64:67], a[28:31], v[48:51], v[64:67]
    s_waitcnt lgkmcnt(4)
    v_cvt_pk_bf16_f32 v92, v76, v77
    v_cvt_pk_bf16_f32 v93, v78, v79
    v_mfma_f32_16x16x32_bf16 v[52:55], a[32:35], v[20:23], v[52:55]
    ds_read_b128 v[44:47], v15 offset:256
    s_add_u32 m0, s21, 101376
    v_mfma_f32_16x16x32_bf16 v[56:59], a[36:39], v[20:23], v[56:59]
    buffer_load_dwordx4 v11, s[8:11], s20 offen lds
    v_cvt_pk_bf16_f32 v94, v80, v81
    v_mfma_f32_16x16x32_bf16 v[60:63], a[32:35], v[24:27], v[60:63]
    ds_read_b128 v[48:51], v15 offset:4352
    v_cvt_pk_bf16_f32 v95, v82, v83
    v_mfma_f32_16x16x32_bf16 v[64:67], a[36:39], v[24:27], v[64:67]
    s_waitcnt lgkmcnt(4)
    buffer_store_dwordx4 v[92:95], v86, s[12:15], s38 offen offset:128
    v_mfma_f32_16x16x32_bf16 v[52:55], a[40:43], v[28:31], v[52:55]
    s_waitcnt vmcnt(44)
    s_barrier
    ds_read_b128 v[20:23], v12 offset:16384
    v_mfma_f32_16x16x32_bf16 v[56:59], a[44:47], v[28:31], v[56:59]
    s_add_u32 s20, s20, 512
    v_mfma_f32_16x16x32_bf16 v[60:63], a[40:43], v[32:35], v[60:63]
    ds_read_b128 v[24:27], v12 offset:20480
    ds_read_b32 v87, v102
    v_mfma_f32_16x16x32_bf16 v[64:67], a[44:47], v[32:35], v[64:67]
    s_waitcnt lgkmcnt(4)
    v_mfma_f32_16x16x32_bf16 v[52:55], a[48:51], v[36:39], v[52:55]
    ds_read_b128 v[28:31], v13 offset:16384
    s_add_u32 m0, s21, 114688
    v_mfma_f32_16x16x32_bf16 v[56:59], a[52:55], v[36:39], v[56:59]
    buffer_load_dwordx4 v8, s[8:11], s20 offen lds
    v_mfma_f32_16x16x32_bf16 v[60:63], a[48:51], v[40:43], v[60:63]
    ds_read_b128 v[32:35], v13 offset:20480
    v_mfma_f32_16x16x32_bf16 v[64:67], a[52:55], v[40:43], v[64:67]
    s_waitcnt lgkmcnt(4)
    v_mfma_f32_16x16x32_bf16 v[52:55], a[56:59], v[44:47], v[52:55]
    ds_read_b128 v[36:39], v14 offset:16384
    v_mfma_f32_16x16x32_bf16 v[56:59], a[60:63], v[44:47], v[56:59]
    v_mfma_f32_16x16x32_bf16 v[60:63], a[56:59], v[48:51], v[60:63]
    ds_read_b128 v[40:43], v14 offset:20480
    v_mfma_f32_16x16x32_bf16 v[64:67], a[60:63], v[48:51], v[64:67]
    s_waitcnt lgkmcnt(4)
    v_mfma_f32_16x16x32_bf16 v[52:55], a[64:67], v[20:23], v[52:55]
    ds_read_b128 v[44:47], v15 offset:16384
    s_add_u32 m0, s21, 115712
    v_mfma_f32_16x16x32_bf16 v[56:59], a[68:71], v[20:23], v[56:59]
    buffer_load_dwordx4 v9, s[8:11], s20 offen lds
    v_mfma_f32_16x16x32_bf16 v[60:63], a[64:67], v[24:27], v[60:63]
    ds_read_b128 v[48:51], v15 offset:20480
    s_waitcnt vmcnt(13)
    s_branch L_att_238
L_attr_239:
    v_mfma_f32_16x16x32_bf16 v[64:67], a[68:71], v[24:27], v[64:67]
    s_waitcnt lgkmcnt(4)
    s_add_u32 s43, s94, 0
    s_mov_b64 exec, s[58:59]
    buffer_store_dwordx4 v[168:171], v100, s[12:15], s43 offen offset:2048 sc1
    s_mov_b64 exec, -1
    v_mfma_f32_16x16x32_bf16 v[52:55], a[72:75], v[28:31], v[52:55]
    ds_read_b128 v[20:23], v12 offset:16640
    v_mfma_f32_16x16x32_bf16 v[56:59], a[76:79], v[28:31], v[56:59]
    v_mfma_f32_16x16x32_bf16 v[60:63], a[72:75], v[32:35], v[60:63]
    ds_read_b128 v[24:27], v12 offset:20736
    s_add_u32 s43, s50, 0
    s_mov_b64 exec, s[56:57]
    buffer_load_dwordx4 v[136:139], v96, s[12:15], s43 offen offset:0
    s_mov_b64 exec, -1
    v_mfma_f32_16x16x32_bf16 v[64:67], a[76:79], v[32:35], v[64:67]
    s_waitcnt lgkmcnt(4)
    s_add_u32 s24, s24, 1
    v_mfma_f32_16x16x32_bf16 v[52:55], a[80:83], v[36:39], v[52:55]
    ds_read_b128 v[28:31], v13 offset:16640
    s_add_u32 m0, s21, 116736
    v_mfma_f32_16x16x32_bf16 v[56:59], a[84:87], v[36:39], v[56:59]
    buffer_load_dwordx4 v10, s[8:11], s20 offen lds
    v_mfma_f32_16x16x32_bf16 v[60:63], a[80:83], v[40:43], v[60:63]
    ds_read_b128 v[32:35], v13 offset:20736
    v_mfma_f32_16x16x32_bf16 v[64:67], a[84:87], v[40:43], v[64:67]
    s_waitcnt lgkmcnt(4)
    s_add_u32 s43, s50, 0
    s_mov_b64 exec, s[56:57]
    buffer_load_dwordx4 v[140:143], v96, s[12:15], s43 offen offset:1024
    s_mov_b64 exec, -1
    v_mfma_f32_16x16x32_bf16 v[52:55], a[88:91], v[44:47], v[52:55]
    ds_read_b128 v[36:39], v14 offset:16640
    s_min_u32 s24, s24, 63
    v_mfma_f32_16x16x32_bf16 v[56:59], a[92:95], v[44:47], v[56:59]
    s_lshl_b32 s53, s24, 16
    v_mfma_f32_16x16x32_bf16 v[60:63], a[88:91], v[48:51], v[60:63]
    ds_read_b128 v[40:43], v14 offset:20736
    s_add_u32 s43, s94, 0
    s_mov_b64 exec, s[58:59]
    buffer_store_dwordx4 v[172:175], v100, s[12:15], s43 offen offset:2560 sc1
    s_mov_b64 exec, -1
    v_mfma_f32_16x16x32_bf16 v[64:67], a[92:95], v[48:51], v[64:67]
    s_waitcnt lgkmcnt(4)
    v_mfma_f32_16x16x32_bf16 v[52:55], a[96:99], v[20:23], v[52:55]
    ds_read_b128 v[44:47], v15 offset:16640
    s_add_u32 m0, s21, 117760
    v_mfma_f32_16x16x32_bf16 v[56:59], a[100:103], v[20:23], v[56:59]
    buffer_load_dwordx4 v11, s[8:11], s20 offen lds
    v_mfma_f32_16x16x32_bf16 v[60:63], a[96:99], v[24:27], v[60:63]
    ds_read_b128 v[48:51], v15 offset:20736
    v_mfma_f32_16x16x32_bf16 v[64:67], a[100:103], v[24:27], v[64:67]
    s_waitcnt lgkmcnt(4)
    s_add_u32 s43, s48, 0
    s_mov_b64 exec, s[56:57]
    buffer_load_dwordx4 v[104:107], v96, s[12:15], s43 offen offset:0
    s_mov_b64 exec, -1
    v_mfma_f32_16x16x32_bf16 v[52:55], a[104:107], v[28:31], v[52:55]
    s_waitcnt vmcnt(43)
    s_barrier
    ds_read_b128 v[20:23], v12 offset:32768
    v_mfma_f32_16x16x32_bf16 v[56:59], a[108:111], v[28:31], v[56:59]
    s_mov_b32 s20, s53
    v_mfma_f32_16x16x32_bf16 v[60:63], a[104:107], v[32:35], v[60:63]
    ds_read_b128 v[24:27], v12 offset:36864
    s_add_u32 s43, s48, 0
    s_mov_b64 exec, s[56:57]
    buffer_load_dwordx4 v[108:111], v96, s[12:15], s43 offen offset:1024
    s_mov_b64 exec, -1
    v_mfma_f32_16x16x32_bf16 v[64:67], a[108:111], v[32:35], v[64:67]
    s_waitcnt lgkmcnt(4)
    v_mfma_f32_16x16x32_bf16 v[52:55], a[112:115], v[36:39], v[52:55]
    ds_read_b128 v[28:31], v13 offset:32768
    s_add_u32 m0, s21, 0
    v_mfma_f32_16x16x32_bf16 v[56:59], a[116:119], v[36:39], v[56:59]
    buffer_load_dwordx4 v8, s[8:11], s20 offen lds
    v_mfma_f32_16x16x32_bf16 v[60:63], a[112:115], v[40:43], v[60:63]
    ds_read_b128 v[32:35], v13 offset:36864
    v_mfma_f32_16x16x32_bf16 v[64:67], a[116:119], v[40:43], v[64:67]
    s_waitcnt lgkmcnt(4)
    s_add_u32 s43, s94, 4096
    s_mov_b64 exec, s[58:59]
    buffer_store_dwordx4 v[176:179], v100, s[12:15], s43 offen offset:2048 sc1
    s_mov_b64 exec, -1
    v_mfma_f32_16x16x32_bf16 v[52:55], a[120:123], v[44:47], v[52:55]
    ds_read_b128 v[36:39], v14 offset:32768
    v_mfma_f32_16x16x32_bf16 v[56:59], a[124:127], v[44:47], v[56:59]
    v_mfma_f32_16x16x32_bf16 v[60:63], a[120:123], v[48:51], v[60:63]
    ds_read_b128 v[40:43], v14 offset:36864
    v_mfma_f32_16x16x32_bf16 v[64:67], a[124:127], v[48:51], v[64:67]
    s_waitcnt lgkmcnt(4)
    v_mfma_f32_16x16x32_bf16 v[52:55], a[128:131], v[20:23], v[52:55]
    ds_read_b128 v[44:47], v15 offset:32768
    s_add_u32 m0, s21, 1024
    v_mfma_f32_16x16x32_bf16 v[56:59], a[132:135], v[20:23], v[56:59]
    buffer_load_dwordx4 v9, s[8:11], s20 offen lds
    v_mfma_f32_16x16x32_bf16 v[60:63], a[128:131], v[24:27], v[60:63]
    ds_read_b128 v[48:51], v15 offset:36864
    v_mfma_f32_16x16x32_bf16 v[64:67], a[132:135], v[24:27], v[64:67]
    s_waitcnt lgkmcnt(4)
    s_add_u32 s43, s50, 4096
    s_mov_b64 exec, s[56:57]
    buffer_load_dwordx4 v[144:147], v96, s[12:15], s43 offen offset:0
    s_mov_b64 exec, -1
    v_mfma_f32_16x16x32_bf16 v[52:55], a[136:139], v[28:31], v[52:55]
    ds_read_b128 v[20:23], v12 offset:33024
    v_mfma_f32_16x16x32_bf16 v[56:59], a[140:143], v[28:31], v[56:59]
    v_mfma_f32_16x16x32_bf16 v[60:63], a[136:139], v[32:35], v[60:63]
    ds_read_b128 v[24:27], v12 offset:37120
    s_add_u32 s43, s94, 4096
    s_mov_b64 exec, s[58:59]
    buffer_store_dwordx4 v[180:183], v100, s[12:15], s43 offen offset:2560 sc1
    s_mov_b64 exec, -1
    v_mfma_f32_16x16x32_bf16 v[64:67], a[140:143], v[32:35], v[64:67]
    s_waitcnt lgkmcnt(4)
    v_mfma_f32_16x16x32_bf16 v[52:55], a[144:147], v[36:39], v[52:55]
    ds_read_b128 v[28:31], v13 offset:33024
    s_add_u32 m0, s21, 2048
    v_mfma_f32_16x16x32_bf16 v[56:59], a[148:151], v[36:39], v[56:59]
    buffer_load_dwordx4 v10, s[8:11], s20 offen lds
    v_mfma_f32_16x16x32_bf16 v[60:63], a[144:147], v[40:43], v[60:63]
    ds_read_b128 v[32:35], v13 offset:37120
    v_mfma_f32_16x16x32_bf16 v[64:67], a[148:151], v[40:43], v[64:67]
    s_waitcnt lgkmcnt(4)
    s_add_u32 s43, s50, 4096
    s_mov_b64 exec, s[56:57]
    buffer_load_dwordx4 v[148:151], v96, s[12:15], s43 offen offset:1024
    s_mov_b64 exec, -1
    v_mfma_f32_16x16x32_bf16 v[52:55], a[152:155], v[44:47], v[52:55]
    ds_read_b128 v[36:39], v14 offset:33024
    v_mfma_f32_16x16x32_bf16 v[56:59], a[156:159], v[44:47], v[56:59]
    v_mfma_f32_16x16x32_bf16 v[60:63], a[152:155], v[48:51], v[60:63]
    ds_read_b128 v[40:43], v14 offset:37120
    s_add_u32 s43, s48, 4096
    s_mov_b64 exec, s[56:57]
    buffer_load_dwordx4 v[112:115], v96, s[12:15], s43 offen offset:0
    s_mov_b64 exec, -1
    v_mfma_f32_16x16x32_bf16 v[64:67], a[156:159], v[48:51], v[64:67]
    s_waitcnt lgkmcnt(4)
    v_mfma_f32_16x16x32_bf16 v[52:55], a[160:163], v[20:23], v[52:55]
    ds_read_b128 v[44:47], v15 offset:33024
    s_add_u32 m0, s21, 3072
    v_mfma_f32_16x16x32_bf16 v[56:59], a[164:167], v[20:23], v[56:59]
    buffer_load_dwordx4 v11, s[8:11], s20 offen lds
    v_mfma_f32_16x16x32_bf16 v[60:63], a[160:163], v[24:27], v[60:63]
    ds_read_b128 v[48:51], v15 offset:37120
    v_mfma_f32_16x16x32_bf16 v[64:67], a[164:167], v[24:27], v[64:67]
    s_waitcnt lgkmcnt(4)
    s_add_u32 s43, s94, 16384
    s_mov_b64 exec, s[58:59]
    buffer_store_dwordx4 v[184:187], v100, s[12:15], s43 offen offset:2048 sc1
    s_mov_b64 exec, -1
    v_mfma_f32_16x16x32_bf16 v[52:55], a[168:171], v[28:31], v[52:55]
    s_waitcnt vmcnt(42)
    s_barrier
    ds_read_b128 v[20:23], v12 offset:49152
    v_mfma_f32_16x16x32_bf16 v[56:59], a[172:175], v[28:31], v[56:59]
    s_add_u32 s20, s20, 512
    v_mfma_f32_16x16x32_bf16 v[60:63], a[168:171], v[32:35], v[60:63]
    ds_read_b128 v[24:27], v12 offset:53248
    s_add_u32 s43, s48, 4096
    s_mov_b64 exec, s[56:57]
    buffer_load_dwordx4 v[116:119], v96, s[12:15], s43 offen offset:1024
    s_mov_b64 exec, -1
    v_mfma_f32_16x16x32_bf16 v[64:67], a[172:175], v[32:35], v[64:67]
    s_waitcnt lgkmcnt(4)
    v_mfma_f32_16x16x32_bf16 v[52:55], a[176:179], v[36:39], v[52:55]
    ds_read_b128 v[28:31], v13 offset:49152
    s_add_u32 m0, s21, 16384
    v_mfma_f32_16x16x32_bf16 v[56:59], a[180:183], v[36:39], v[56:59]
    buffer_load_dwordx4 v8, s[8:11], s20 offen lds
    v_mfma_f32_16x16x32_bf16 v[60:63], a[176:179], v[40:43], v[60:63]
    ds_read_b128 v[32:35], v13 offset:53248
    v_mfma_f32_16x16x32_bf16 v[64:67], a[180:183], v[40:43], v[64:67]
    s_waitcnt lgkmcnt(4)
    s_add_u32 s43, s94, 16384
    s_mov_b64 exec, s[58:59]
    buffer_store_dwordx4 v[188:191], v100, s[12:15], s43 offen offset:2560 sc1
    s_mov_b64 exec, -1
    v_mfma_f32_16x16x32_bf16 v[52:55], a[184:187], v[44:47], v[52:55]
    ds_read_b128 v[36:39], v14 offset:49152
    v_mfma_f32_16x16x32_bf16 v[56:59], a[188:191], v[44:47], v[56:59]
    v_mfma_f32_16x16x32_bf16 v[60:63], a[184:187], v[48:51], v[60:63]
    ds_read_b128 v[40:43], v14 offset:53248
    s_add_u32 s43, s50, 16384
    s_mov_b64 exec, s[56:57]
    buffer_load_dwordx4 v[152:155], v96, s[12:15], s43 offen offset:0
    s_mov_b64 exec, -1
    v_mfma_f32_16x16x32_bf16 v[64:67], a[188:191], v[48:51], v[64:67]
    s_waitcnt lgkmcnt(4)
    v_mfma_f32_16x16x32_bf16 v[52:55], a[192:195], v[20:23], v[52:55]
    ds_read_b128 v[44:47], v15 offset:49152
    s_add_u32 m0, s21, 17408
    v_mfma_f32_16x16x32_bf16 v[56:59], a[196:199], v[20:23], v[56:59]
    buffer_load_dwordx4 v9, s[8:11], s20 offen lds
    v_mfma_f32_16x16x32_bf16 v[60:63], a[192:195], v[24:27], v[60:63]
    ds_read_b128 v[48:51], v15 offset:53248
    v_mfma_f32_16x16x32_bf16 v[64:67], a[196:199], v[24:27], v[64:67]
    s_waitcnt lgkmcnt(4)
    v_mfma_f32_16x16x32_bf16 v[52:55], a[200:203], v[28:31], v[52:55]
    ds_read_b128 v[20:23], v12 offset:49408
    v_mfma_f32_16x16x32_bf16 v[56:59], a[204:207], v[28:31], v[56:59]
    v_mfma_f32_16x16x32_bf16 v[60:63], a[200:203], v[32:35], v[60:63]
    ds_read_b128 v[24:27], v12 offset:53504
    s_add_u32 s43, s94, 20480
    s_mov_b64 exec, s[58:59]
    buffer_store_dwordx4 v[192:195], v100, s[12:15], s43 offen offset:2048 sc1
    s_mov_b64 exec, -1
    v_mfma_f32_16x16x32_bf16 v[64:67], a[204:207], v[32:35], v[64:67]
    s_waitcnt lgkmcnt(4)
    v_mfma_f32_16x16x32_bf16 v[52:55], a[208:211], v[36:39], v[52:55]
    ds_read_b128 v[28:31], v13 offset:49408
    s_add_u32 m0, s21, 18432
    v_mfma_f32_16x16x32_bf16 v[56:59], a[212:215], v[36:39], v[56:59]
    buffer_load_dwordx4 v10, s[8:11], s20 offen lds
    v_mfma_f32_16x16x32_bf16 v[60:63], a[208:211], v[40:43], v[60:63]
    ds_read_b128 v[32:35], v13 offset:53504
    v_mfma_f32_16x16x32_bf16 v[64:67], a[212:215], v[40:43], v[64:67]
    s_waitcnt lgkmcnt(4)
    s_add_u32 s43, s50, 16384
    s_mov_b64 exec, s[56:57]
    buffer_load_dwordx4 v[156:159], v96, s[12:15], s43 offen offset:1024
    s_mov_b64 exec, -1
    v_mfma_f32_16x16x32_bf16 v[52:55], a[216:219], v[44:47], v[52:55]
    ds_read_b128 v[36:39], v14 offset:49408
    v_mfma_f32_16x16x32_bf16 v[56:59], a[220:223], v[44:47], v[56:59]
    v_mfma_f32_16x16x32_bf16 v[60:63], a[216:219], v[48:51], v[60:63]
    ds_read_b128 v[40:43], v14 offset:53504
    s_add_u32 s43, s48, 16384
    s_mov_b64 exec, s[56:57]
    buffer_load_dwordx4 v[120:123], v96, s[12:15], s43 offen offset:0
    s_mov_b64 exec, -1
    v_mfma_f32_16x16x32_bf16 v[64:67], a[220:223], v[48:51], v[64:67]
    s_waitcnt lgkmcnt(4)
    v_mfma_f32_16x16x32_bf16 v[52:55], a[224:227], v[20:23], v[52:55]
    ds_read_b128 v[44:47], v15 offset:49408
    s_add_u32 m0, s21, 19456
    v_mfma_f32_16x16x32_bf16 v[56:59], a[228:231], v[20:23], v[56:59]
    buffer_load_dwordx4 v11, s[8:11], s20 offen lds
    v_mfma_f32_16x16x32_bf16 v[60:63], a[224:227], v[24:27], v[60:63]
    ds_read_b128 v[48:51], v15 offset:53504
    v_mfma_f32_16x16x32_bf16 v[64:67], a[228:231], v[24:27], v[64:67]
    s_waitcnt lgkmcnt(4)
    s_add_u32 s43, s94, 20480
    s_mov_b64 exec, s[58:59]
    buffer_store_dwordx4 v[196:199], v100, s[12:15], s43 offen offset:2560 sc1
    s_mov_b64 exec, -1
    v_mfma_f32_16x16x32_bf16 v[52:55], a[232:235], v[28:31], v[52:55]
    s_waitcnt vmcnt(43)
    s_barrier
    ds_read_b128 v[20:23], v16 offset:0
    v_mfma_f32_16x16x32_bf16 v[56:59], a[236:239], v[28:31], v[56:59]
    s_add_u32 s20, s20, 512
    v_mfma_f32_16x16x32_bf16 v[60:63], a[232:235], v[32:35], v[60:63]
    ds_read_b128 v[24:27], v16 offset:4096
    s_add_u32 s43, s48, 16384
    s_mov_b64 exec, s[56:57]
    buffer_load_dwordx4 v[124:127], v96, s[12:15], s43 offen offset:1024
    s_mov_b64 exec, -1
    v_mfma_f32_16x16x32_bf16 v[64:67], a[236:239], v[32:35], v[64:67]
    s_waitcnt lgkmcnt(4)
    v_mfma_f32_16x16x32_bf16 v[52:55], a[240:243], v[36:39], v[52:55]
    ds_read_b128 v[28:31], v17 offset:0
    s_add_u32 m0, s21, 32768
    v_mfma_f32_16x16x32_bf16 v[56:59], a[244:247], v[36:39], v[56:59]
    buffer_load_dwordx4 v8, s[8:11], s20 offen lds
    v_mfma_f32_16x16x32_bf16 v[60:63], a[240:243], v[40:43], v[60:63]
    ds_read_b128 v[32:35], v17 offset:4096
    v_mfma_f32_16x16x32_bf16 v[64:67], a[244:247], v[40:43], v[64:67]
    s_waitcnt lgkmcnt(4)
    v_mfma_f32_16x16x32_bf16 v[52:55], a[248:251], v[44:47], v[52:55]
    ds_read_b128 v[36:39], v18 offset:0
    v_mfma_f32_16x16x32_bf16 v[56:59], a[252:255], v[44:47], v[56:59]
    v_mfma_f32_16x16x32_bf16 v[60:63], a[248:251], v[48:51], v[60:63]
    ds_read_b128 v[40:43], v18 offset:4096
    v_mfma_f32_16x16x32_bf16 v[64:67], a[252:255], v[48:51], v[64:67]
    s_waitcnt lgkmcnt(4)
    s_add_u32 s22, s22, 1
    s_cmp_ge_u32 s22, s23
    s_cbranch_scc1 L_fl0_240
    v_mfma_f32_16x16x32_bf16 v[68:71], a[0:3], v[20:23], 0
    ds_read_b128 v[44:47], v19 offset:0
    s_add_u32 m0, s21, 33792
    s_sub_u32 s39, s22, 1
    v_mfma_f32_16x16x32_bf16 v[72:75], a[4:7], v[20:23], 0
    buffer_load_dwordx4 v9, s[8:11], s20 offen lds
    s_bitcmp1_b32 s39, 1
    s_cselect_b32 s38, s54, s55
    v_mfma_f32_16x16x32_bf16 v[76:79], a[0:3], v[24:27], 0
    ds_read_b128 v[48:51], v19 offset:4096
    v_mfma_f32_16x16x32_bf16 v[80:83], a[4:7], v[24:27], 0
    s_waitcnt lgkmcnt(4)
    s_add_u32 s43, s50, 20480
    s_mov_b64 exec, s[56:57]
    buffer_load_dwordx4 v[160:163], v96, s[12:15], s43 offen offset:0
    s_mov_b64 exec, -1
    v_mfma_f32_16x16x32_bf16 v[68:71], a[8:11], v[28:31], v[68:71]
    ds_read_b128 v[20:23], v16 offset:256
    s_add_u32 s38, s38, s44
    v_mfma_f32_16x16x32_bf16 v[72:75], a[12:15], v[28:31], v[72:75]
    s_lshl_b32 s42, s39, 20
    s_add_u32 s38, s38, s42
    v_mfma_f32_16x16x32_bf16 v[76:79], a[8:11], v[32:35], v[76:79]
    ds_read_b128 v[24:27], v16 offset:4352
    s_add_u32 s43, s50, 20480
    s_mov_b64 exec, s[56:57]
    buffer_load_dwordx4 v[164:167], v96, s[12:15], s43 offen offset:1024
    s_mov_b64 exec, -1
    v_mfma_f32_16x16x32_bf16 v[80:83], a[12:15], v[32:35], v[80:83]
    s_waitcnt lgkmcnt(4)
    s_cmp_eq_u32 s37, 0
    s_cselect_b32 s38, 0x7ff00000, s38
    v_mfma_f32_16x16x32_bf16 v[68:71], a[16:19], v[36:39], v[68:71]
    ds_read_b128 v[28:31], v17 offset:256
    s_add_u32 m0, s21, 34816
    v_mfma_f32_16x16x32_bf16 v[72:75], a[20:23], v[36:39], v[72:75]
    buffer_load_dwordx4 v10, s[8:11], s20 offen lds
    s_mov_b32 s37, 1
    v_mfma_f32_16x16x32_bf16 v[76:79], a[16:19], v[40:43], v[76:79]
    ds_read_b128 v[32:35], v17 offset:4352
    v_cvt_pk_bf16_f32 v88, v52, v53
    v_mfma_f32_16x16x32_bf16 v[80:83], a[20:23], v[40:43], v[80:83]
    s_waitcnt lgkmcnt(4)
    s_add_u32 s43, s48, 20480
    s_mov_b64 exec, s[56:57]
    buffer_load_dwordx4 v[128:131], v96, s[12:15], s43 offen offset:0
    s_mov_b64 exec, -1
    v_mfma_f32_16x16x32_bf16 v[68:71], a[24:27], v[44:47], v[68:71]
    ds_read_b128 v[36:39], v18 offset:256
    v_cvt_pk_bf16_f32 v89, v54, v55
    v_cvt_pk_bf16_f32 v90, v56, v57
    v_mfma_f32_16x16x32_bf16 v[72:75], a[28:31], v[44:47], v[72:75]
    v_cvt_pk_bf16_f32 v91, v58, v59
    v_mfma_f32_16x16x32_bf16 v[76:79], a[24:27], v[48:51], v[76:79]
    ds_read_b128 v[40:43], v18 offset:4352
    buffer_store_dwordx4 v[88:91], v86, s[12:15], s38 offen offset:0
    v_mfma_f32_16x16x32_bf16 v[80:83], a[28:31], v[48:51], v[80:83]
    s_waitcnt lgkmcnt(4)
    v_cvt_pk_bf16_f32 v92, v60, v61
    v_cvt_pk_bf16_f32 v93, v62, v63
    v_mfma_f32_16x16x32_bf16 v[68:71], a[32:35], v[20:23], v[68:71]
    ds_read_b128 v[44:47], v19 offset:256
    s_add_u32 m0, s21, 35840
    v_mfma_f32_16x16x32_bf16 v[72:75], a[36:39], v[20:23], v[72:75]
    buffer_load_dwordx4 v11, s[8:11], s20 offen lds
    v_cvt_pk_bf16_f32 v94, v64, v65
    v_mfma_f32_16x16x32_bf16 v[76:79], a[32:35], v[24:27], v[76:79]
    ds_read_b128 v[48:51], v19 offset:4352
    v_cvt_pk_bf16_f32 v95, v66, v67
    v_mfma_f32_16x16x32_bf16 v[80:83], a[36:39], v[24:27], v[80:83]
    s_waitcnt lgkmcnt(4)
    buffer_store_dwordx4 v[92:95], v86, s[12:15], s38 offen offset:128
    v_mfma_f32_16x16x32_bf16 v[68:71], a[40:43], v[28:31], v[68:71]
    s_waitcnt vmcnt(47)
    s_barrier
    ds_read_b128 v[20:23], v16 offset:16384
    v_mfma_f32_16x16x32_bf16 v[72:75], a[44:47], v[28:31], v[72:75]
    s_add_u32 s20, s20, 512
    v_mfma_f32_16x16x32_bf16 v[76:79], a[40:43], v[32:35], v[76:79]
    ds_read_b128 v[24:27], v16 offset:20480
    s_add_u32 s43, s48, 20480
    s_mov_b64 exec, s[56:57]
    buffer_load_dwordx4 v[132:135], v96, s[12:15], s43 offen offset:1024
    s_mov_b64 exec, -1
    v_mfma_f32_16x16x32_bf16 v[80:83], a[44:47], v[32:35], v[80:83]
    s_waitcnt lgkmcnt(4)
    v_mfma_f32_16x16x32_bf16 v[68:71], a[48:51], v[36:39], v[68:71]
    ds_read_b128 v[28:31], v17 offset:16384
    s_add_u32 m0, s21, 49152
    v_mfma_f32_16x16x32_bf16 v[72:75], a[52:55], v[36:39], v[72:75]
    buffer_load_dwordx4 v8, s[8:11], s20 offen lds
    v_mfma_f32_16x16x32_bf16 v[76:79], a[48:51], v[40:43], v[76:79]
    ds_read_b128 v[32:35], v17 offset:20480
    v_mfma_f32_16x16x32_bf16 v[80:83], a[52:55], v[40:43], v[80:83]
    s_waitcnt lgkmcnt(4)
    s_add_u32 s43, s48, 0
    s_mov_b64 exec, s[56:57]
    buffer_load_dwordx4 v[168:171], v98, s[12:15], s43 offen offset:2048
    s_mov_b64 exec, -1
    v_mfma_f32_16x16x32_bf16 v[68:71], a[56:59], v[44:47], v[68:71]
    ds_read_b128 v[36:39], v18 offset:16384
    v_mfma_f32_16x16x32_bf16 v[72:75], a[60:63], v[44:47], v[72:75]
    v_mfma_f32_16x16x32_bf16 v[76:79], a[56:59], v[48:51], v[76:79]
    ds_read_b128 v[40:43], v18 offset:20480
    s_add_u32 s43, s48, 0
    s_mov_b64 exec, s[56:57]
    buffer_load_dwordx4 v[172:175], v98, s[12:15], s43 offen offset:3072
    s_mov_b64 exec, -1
    v_mfma_f32_16x16x32_bf16 v[80:83], a[60:63], v[48:51], v[80:83]
    s_waitcnt lgkmcnt(4)
    v_mfma_f32_16x16x32_bf16 v[68:71], a[64:67], v[20:23], v[68:71]
    ds_read_b128 v[44:47], v19 offset:16384
    s_add_u32 m0, s21, 50176
    v_mfma_f32_16x16x32_bf16 v[72:75], a[68:71], v[20:23], v[72:75]
    buffer_load_dwordx4 v9, s[8:11], s20 offen lds
    v_mfma_f32_16x16x32_bf16 v[76:79], a[64:67], v[24:27], v[76:79]
    ds_read_b128 v[48:51], v19 offset:20480
    v_mfma_f32_16x16x32_bf16 v[80:83], a[68:71], v[24:27], v[80:83]
    s_waitcnt lgkmcnt(4)
    s_add_u32 s43, s48, 4096
    s_mov_b64 exec, s[56:57]
    buffer_load_dwordx4 v[176:179], v98, s[12:15], s43 offen offset:2048
    s_mov_b64 exec, -1
    v_mfma_f32_16x16x32_bf16 v[68:71], a[72:75], v[28:31], v[68:71]
    ds_read_b128 v[20:23], v16 offset:16640
    v_mfma_f32_16x16x32_bf16 v[72:75], a[76:79], v[28:31], v[72:75]
    v_mfma_f32_16x16x32_bf16 v[76:79], a[72:75], v[32:35], v[76:79]
    ds_read_b128 v[24:27], v16 offset:20736
    s_add_u32 s43, s48, 4096
    s_mov_b64 exec, s[56:57]
    buffer_load_dwordx4 v[180:183], v98, s[12:15], s43 offen offset:3072
    s_mov_b64 exec, -1
    v_mfma_f32_16x16x32_bf16 v[80:83], a[76:79], v[32:35], v[80:83]
    s_waitcnt lgkmcnt(4)
    s_add_u32 s24, s24, 1
    v_mfma_f32_16x16x32_bf16 v[68:71], a[80:83], v[36:39], v[68:71]
    ds_read_b128 v[28:31], v17 offset:16640
    s_add_u32 m0, s21, 51200
    v_mfma_f32_16x16x32_bf16 v[72:75], a[84:87], v[36:39], v[72:75]
    buffer_load_dwordx4 v10, s[8:11], s20 offen lds
    v_mfma_f32_16x16x32_bf16 v[76:79], a[80:83], v[40:43], v[76:79]
    ds_read_b128 v[32:35], v17 offset:20736
    v_mfma_f32_16x16x32_bf16 v[80:83], a[84:87], v[40:43], v[80:83]
    s_waitcnt lgkmcnt(4)
    s_add_u32 s43, s48, 16384
    s_mov_b64 exec, s[56:57]
    buffer_load_dwordx4 v[184:187], v98, s[12:15], s43 offen offset:2048
    s_mov_b64 exec, -1
    v_mfma_f32_16x16x32_bf16 v[68:71], a[88:91], v[44:47], v[68:71]
    ds_read_b128 v[36:39], v18 offset:16640
    s_min_u32 s24, s24, 63
    v_mfma_f32_16x16x32_bf16 v[72:75], a[92:95], v[44:47], v[72:75]
    s_lshl_b32 s53, s24, 16
    v_mfma_f32_16x16x32_bf16 v[76:79], a[88:91], v[48:51], v[76:79]
    ds_read_b128 v[40:43], v18 offset:20736
    s_add_u32 s43, s48, 16384
    s_mov_b64 exec, s[56:57]
    buffer_load_dwordx4 v[188:191], v98, s[12:15], s43 offen offset:3072
    s_mov_b64 exec, -1
    v_mfma_f32_16x16x32_bf16 v[80:83], a[92:95], v[48:51], v[80:83]
    s_waitcnt lgkmcnt(4)
    v_mfma_f32_16x16x32_bf16 v[68:71], a[96:99], v[20:23], v[68:71]
    ds_read_b128 v[44:47], v19 offset:16640
    s_add_u32 m0, s21, 52224
    v_mfma_f32_16x16x32_bf16 v[72:75], a[100:103], v[20:23], v[72:75]
    buffer_load_dwordx4 v11, s[8:11], s20 offen lds
    v_mfma_f32_16x16x32_bf16 v[76:79], a[96:99], v[24:27], v[76:79]
    ds_read_b128 v[48:51], v19 offset:20736
    s_waitcnt vmcnt(21)
    v_mfma_f32_16x16x32_bf16 v[80:83], a[100:103], v[24:27], v[80:83]
    s_waitcnt lgkmcnt(4)
    s_add_u32 s43, s48, 20480
    s_mov_b64 exec, s[56:57]
    buffer_load_dwordx4 v[192:195], v98, s[12:15], s43 offen offset:2048
    s_mov_b64 exec, -1
    v_mfma_f32_16x16x32_bf16 v[68:71], a[104:107], v[28:31], v[68:71]
    s_waitcnt vmcnt(54)
    s_barrier
    ds_read_b128 v[20:23], v16 offset:32768
    v_mfma_f32_16x16x32_bf16 v[72:75], a[108:111], v[28:31], v[72:75]
    s_mov_b32 s20, s53
    v_mfma_f32_16x16x32_bf16 v[76:79], a[104:107], v[32:35], v[76:79]
    ds_read_b128 v[24:27], v16 offset:36864
    buffer_atomic_add v84, v85, s[12:15], s51 offen sc1
    v_mfma_f32_16x16x32_bf16 v[80:83], a[108:111], v[32:35], v[80:83]
    s_waitcnt lgkmcnt(4)
    s_mov_b32 s51, 0x40000000
    v_mfma_f32_16x16x32_bf16 v[68:71], a[112:115], v[36:39], v[68:71]
    ds_read_b128 v[28:31], v17 offset:32768
    s_add_u32 m0, s21, 65536
    v_mfma_f32_16x16x32_bf16 v[72:75], a[116:119], v[36:39], v[72:75]
    buffer_load_dwordx4 v8, s[8:11], s20 offen lds
    v_mfma_f32_16x16x32_bf16 v[76:79], a[112:115], v[40:43], v[76:79]
    ds_read_b128 v[32:35], v17 offset:36864
    v_mfma_f32_16x16x32_bf16 v[80:83], a[116:119], v[40:43], v[80:83]
    s_waitcnt lgkmcnt(4)
    s_add_u32 s43, s48, 20480
    s_mov_b64 exec, s[56:57]
    buffer_load_dwordx4 v[196:199], v98, s[12:15], s43 offen offset:3072
    s_mov_b64 exec, -1
    v_mfma_f32_16x16x32_bf16 v[68:71], a[120:123], v[44:47], v[68:71]
    ds_read_b128 v[36:39], v18 offset:32768
    v_mfma_f32_16x16x32_bf16 v[72:75], a[124:127], v[44:47], v[72:75]
    v_mfma_f32_16x16x32_bf16 v[76:79], a[120:123], v[48:51], v[76:79]
    ds_read_b128 v[40:43], v18 offset:36864
    s_add_u32 m0, s7, 0
    s_add_u32 s43, s48, 0x8000c00
    s_mov_b64 exec, s[56:57]
    buffer_load_dwordx4 v96, s[12:15], s43 offen sc1 lds
    s_mov_b64 exec, -1
    v_mfma_f32_16x16x32_bf16 v[80:83], a[124:127], v[48:51], v[80:83]
    s_waitcnt lgkmcnt(4)
    v_mfma_f32_16x16x32_bf16 v[68:71], a[128:131], v[20:23], v[68:71]
    ds_read_b128 v[44:47], v19 offset:32768
    s_add_u32 m0, s21, 66560
    v_mfma_f32_16x16x32_bf16 v[72:75], a[132:135], v[20:23], v[72:75]
    buffer_load_dwordx4 v9, s[8:11], s20 offen lds
    v_mfma_f32_16x16x32_bf16 v[76:79], a[128:131], v[24:27], v[76:79]
    ds_read_b128 v[48:51], v19 offset:36864
    v_mfma_f32_16x16x32_bf16 v[80:83], a[132:135], v[24:27], v[80:83]
    s_waitcnt lgkmcnt(4)
    v_mfma_f32_16x16x32_bf16 v[68:71], a[136:139], v[28:31], v[68:71]
    ds_read_b128 v[20:23], v16 offset:33024
    v_mfma_f32_16x16x32_bf16 v[72:75], a[140:143], v[28:31], v[72:75]
    v_mfma_f32_16x16x32_bf16 v[76:79], a[136:139], v[32:35], v[76:79]
    ds_read_b128 v[24:27], v16 offset:37120
    s_add_u32 m0, s7, 1024
    s_add_u32 s43, s48, 0x8001c00
    s_mov_b64 exec, s[56:57]
    buffer_load_dwordx4 v96, s[12:15], s43 offen sc1 lds
    s_mov_b64 exec, -1
    v_mfma_f32_16x16x32_bf16 v[80:83], a[140:143], v[32:35], v[80:83]
    s_waitcnt lgkmcnt(4)
    v_mfma_f32_16x16x32_bf16 v[68:71], a[144:147], v[36:39], v[68:71]
    ds_read_b128 v[28:31], v17 offset:33024
    s_add_u32 m0, s21, 67584
    v_mfma_f32_16x16x32_bf16 v[72:75], a[148:151], v[36:39], v[72:75]
    buffer_load_dwordx4 v10, s[8:11], s20 offen lds
    v_mfma_f32_16x16x32_bf16 v[76:79], a[144:147], v[40:43], v[76:79]
    ds_read_b128 v[32:35], v17 offset:37120
    v_mfma_f32_16x16x32_bf16 v[80:83], a[148:151], v[40:43], v[80:83]
    s_waitcnt lgkmcnt(4)
    s_add_u32 m0, s7, 2048
    s_add_u32 s43, s48, 0x8004c00
    s_mov_b64 exec, s[56:57]
    buffer_load_dwordx4 v96, s[12:15], s43 offen sc1 lds
    s_mov_b64 exec, -1
    v_mfma_f32_16x16x32_bf16 v[68:71], a[152:155], v[44:47], v[68:71]
    ds_read_b128 v[36:39], v18 offset:33024
    v_mfma_f32_16x16x32_bf16 v[72:75], a[156:159], v[44:47], v[72:75]
    v_mfma_f32_16x16x32_bf16 v[76:79], a[152:155], v[48:51], v[76:79]
    ds_read_b128 v[40:43], v18 offset:37120
    v_mfma_f32_16x16x32_bf16 v[80:83], a[156:159], v[48:51], v[80:83]
    s_waitcnt lgkmcnt(4)
    v_mfma_f32_16x16x32_bf16 v[68:71], a[160:163], v[20:23], v[68:71]
    ds_read_b128 v[44:47], v19 offset:33024
    s_add_u32 m0, s21, 68608
    v_mfma_f32_16x16x32_bf16 v[72:75], a[164:167], v[20:23], v[72:75]
    buffer_load_dwordx4 v11, s[8:11], s20 offen lds
    v_mfma_f32_16x16x32_bf16 v[76:79], a[160:163], v[24:27], v[76:79]
    ds_read_b128 v[48:51], v19 offset:37120
    v_mfma_f32_16x16x32_bf16 v[80:83], a[164:167], v[24:27], v[80:83]
    s_waitcnt lgkmcnt(4)
    s_add_u32 m0, s7, 3072
    s_add_u32 s43, s48, 0x8005c00
    s_mov_b64 exec, s[56:57]
    buffer_load_dwordx4 v96, s[12:15], s43 offen sc1 lds
    s_mov_b64 exec, -1
    v_mfma_f32_16x16x32_bf16 v[68:71], a[168:171], v[28:31], v[68:71]
    s_waitcnt vmcnt(55)
    s_barrier
    ds_read_b128 v[20:23], v16 offset:49152
    v_mfma_f32_16x16x32_bf16 v[72:75], a[172:175], v[28:31], v[72:75]
    s_add_u32 s20, s20, 512
    v_mfma_f32_16x16x32_bf16 v[76:79], a[168:171], v[32:35], v[76:79]
    ds_read_b128 v[24:27], v16 offset:53248
    v_mfma_f32_16x16x32_bf16 v[80:83], a[172:175], v[32:35], v[80:83]
    s_waitcnt lgkmcnt(4)
    v_mfma_f32_16x16x32_bf16 v[68:71], a[176:179], v[36:39], v[68:71]
    ds_read_b128 v[28:31], v17 offset:49152
    s_add_u32 m0, s21, 81920
    v_mfma_f32_16x16x32_bf16 v[72:75], a[180:183], v[36:39], v[72:75]
    buffer_load_dwordx4 v8, s[8:11], s20 offen lds
    v_mfma_f32_16x16x32_bf16 v[76:79], a[176:179], v[40:43], v[76:79]
    ds_read_b128 v[32:35], v17 offset:53248
    v_mfma_f32_16x16x32_bf16 v[80:83], a[180:183], v[40:43], v[80:83]
    s_waitcnt lgkmcnt(4)
    buffer_load_dword v87, v103, s[32:35], 0 offen sc1
    v_mfma_f32_16x16x32_bf16 v[68:71], a[184:187], v[44:47], v[68:71]
    ds_read_b128 v[36:39], v18 offset:49152
    v_mfma_f32_16x16x32_bf16 v[72:75], a[188:191], v[44:47], v[72:75]
    v_mfma_f32_16x16x32_bf16 v[76:79], a[184:187], v[48:51], v[76:79]
    ds_read_b128 v[40:43], v18 offset:53248
    v_mfma_f32_16x16x32_bf16 v[80:83], a[188:191], v[48:51], v[80:83]
    s_waitcnt lgkmcnt(4)
    v_mfma_f32_16x16x32_bf16 v[68:71], a[192:195], v[20:23], v[68:71]
    ds_read_b128 v[44:47], v19 offset:49152
    s_add_u32 m0, s21, 82944
    v_mfma_f32_16x16x32_bf16 v[72:75], a[196:199], v[20:23], v[72:75]
    buffer_load_dwordx4 v9, s[8:11], s20 offen lds
    v_mfma_f32_16x16x32_bf16 v[76:79], a[192:195], v[24:27], v[76:79]
    ds_read_b128 v[48:51], v19 offset:53248
    v_mfma_f32_16x16x32_bf16 v[80:83], a[196:199], v[24:27], v[80:83]
    s_waitcnt lgkmcnt(4)
    v_mfma_f32_16x16x32_bf16 v[68:71], a[200:203], v[28:31], v[68:71]
    ds_read_b128 v[20:23], v16 offset:49408
    v_mfma_f32_16x16x32_bf16 v[72:75], a[204:207], v[28:31], v[72:75]
    v_mfma_f32_16x16x32_bf16 v[76:79], a[200:203], v[32:35], v[76:79]
    ds_read_b128 v[24:27], v16 offset:53504
    v_mfma_f32_16x16x32_bf16 v[80:83], a[204:207], v[32:35], v[80:83]
    s_waitcnt lgkmcnt(4)
    v_mfma_f32_16x16x32_bf16 v[68:71], a[208:211], v[36:39], v[68:71]
    ds_read_b128 v[28:31], v17 offset:49408
    s_add_u32 m0, s21, 83968
    v_mfma_f32_16x16x32_bf16 v[72:75], a[212:215], v[36:39], v[72:75]
    buffer_load_dwordx4 v10, s[8:11], s20 offen lds
    v_mfma_f32_16x16x32_bf16 v[76:79], a[208:211], v[40:43], v[76:79]
    ds_read_b128 v[32:35], v17 offset:53504
    v_mfma_f32_16x16x32_bf16 v[80:83], a[212:215], v[40:43], v[80:83]
    s_waitcnt lgkmcnt(4)
    v_mfma_f32_16x16x32_bf16 v[68:71], a[216:219], v[44:47], v[68:71]
    ds_read_b128 v[36:39], v18 offset:49408
    v_mfma_f32_16x16x32_bf16 v[72:75], a[220:223], v[44:47], v[72:75]
    v_mfma_f32_16x16x32_bf16 v[76:79], a[216:219], v[48:51], v[76:79]
    ds_read_b128 v[40:43], v18 offset:53504
    v_mfma_f32_16x16x32_bf16 v[80:83], a[220:223], v[48:51], v[80:83]
    s_waitcnt lgkmcnt(4)
    v_mfma_f32_16x16x32_bf16 v[68:71], a[224:227], v[20:23], v[68:71]
    ds_read_b128 v[44:47], v19 offset:49408
    s_add_u32 m0, s21, 84992
    v_mfma_f32_16x16x32_bf16 v[72:75], a[228:231], v[20:23], v[72:75]
    buffer_load_dwordx4 v11, s[8:11], s20 offen lds
    v_mfma_f32_16x16x32_bf16 v[76:79], a[224:227], v[24:27], v[76:79]
    ds_read_b128 v[48:51], v19 offset:53504
    v_mfma_f32_16x16x32_bf16 v[80:83], a[228:231], v[24:27], v[80:83]
    s_waitcnt lgkmcnt(4)
    v_mfma_f32_16x16x32_bf16 v[68:71], a[232:235], v[28:31], v[68:71]
    s_waitcnt vmcnt(49)
    s_barrier
    ds_read_b128 v[20:23], v12 offset:0
    v_mfma_f32_16x16x32_bf16 v[72:75], a[236:239], v[28:31], v[72:75]
    s_add_u32 s20, s20, 512
    v_mfma_f32_16x16x32_bf16 v[76:79], a[232:235], v[32:35], v[76:79]
    ds_read_b128 v[24:27], v12 offset:4096
    v_mfma_f32_16x16x32_bf16 v[80:83], a[236:239], v[32:35], v[80:83]
    s_waitcnt lgkmcnt(4)
    v_mfma_f32_16x16x32_bf16 v[68:71], a[240:243], v[36:39], v[68:71]
    ds_read_b128 v[28:31], v13 offset:0
    s_add_u32 m0, s21, 98304
    v_mfma_f32_16x16x32_bf16 v[72:75], a[244:247], v[36:39], v[72:75]
    buffer_load_dwordx4 v8, s[8:11], s20 offen lds
    v_mfma_f32_16x16x32_bf16 v[76:79], a[240:243], v[40:43], v[76:79]
    ds_read_b128 v[32:35], v13 offset:4096
    v_mfma_f32_16x16x32_bf16 v[80:83], a[244:247], v[40:43], v[80:83]
    s_waitcnt lgkmcnt(4)
    v_mfma_f32_16x16x32_bf16 v[68:71], a[248:251], v[44:47], v[68:71]
    ds_read_b128 v[36:39], v14 offset:0
    v_mfma_f32_16x16x32_bf16 v[72:75], a[252:255], v[44:47], v[72:75]
    v_mfma_f32_16x16x32_bf16 v[76:79], a[248:251], v[48:51], v[76:79]
    ds_read_b128 v[40:43], v14 offset:4096
    v_mfma_f32_16x16x32_bf16 v[80:83], a[252:255], v[48:51], v[80:83]
    s_waitcnt lgkmcnt(4)
    s_add_u32 s22, s22, 1
    s_cmp_ge_u32 s22, s23
    s_cbranch_scc0 L_st_243
L_fl1_241:
    s_waitcnt lgkmcnt(0)
    s_nop 7
    s_sub_u32 s39, s22, 1
    s_bitcmp1_b32 s39, 1
    s_cselect_b32 s38, s54, s55
    s_add_u32 s38, s38, s44
    s_lshl_b32 s42, s39, 20
    s_add_u32 s38, s38, s42
    s_cmp_eq_u32 s37, 0
    s_cselect_b32 s38, 0x7ff00000, s38
    s_mov_b32 s37, 1
    v_cvt_pk_bf16_f32 v88, v68, v69
    v_cvt_pk_bf16_f32 v89, v70, v71
    v_cvt_pk_bf16_f32 v90, v72, v73
    v_cvt_pk_bf16_f32 v91, v74, v75
    buffer_store_dwordx4 v[88:91], v86, s[12:15], s38 offen offset:0
    v_cvt_pk_bf16_f32 v92, v76, v77
    v_cvt_pk_bf16_f32 v93, v78, v79
    v_cvt_pk_bf16_f32 v94, v80, v81
    v_cvt_pk_bf16_f32 v95, v82, v83
    buffer_store_dwordx4 v[92:95], v86, s[12:15], s38 offen offset:128
    s_waitcnt vmcnt(0)
    s_barrier
    s_mov_b32 s25, 0x5901f80
    v_mov_b32 v2, 0
L_pl_247:
    buffer_load_dword v1, v2, s[12:15], s25 offen sc1
    s_add_u32 s36, s36, 1
    s_cmp_gt_u32 s36, 0x100000
    s_cbranch_scc1 chain_kernel_wend
    s_waitcnt vmcnt(0)
    v_readfirstlane_b32 s26, v1
    s_cmp_ge_u32 s26, 64
    s_cbranch_scc1 L_plok_248
    s_sleep 4
    s_branch L_pl_247
L_plok_248:
L_att_238:
    s_waitcnt lgkmcnt(0)
    s_cmp_eq_u32 s45, 0
    s_cselect_b64 s[58:59], 0, -1
    s_cbranch_scc1 L_anext_244
    s_add_u32 s38, s47, s49
    s_mov_b32 s28, 0x3fb8aa3b
    s_mov_b32 s29, 0x3db504f3
    s_cmp_ge_u32 s22, 64
    s_cbranch_scc1 L_asrv_249
    ds_read_b64 v[216:217], v99 offset:512
    ds_read_b64 v[218:219], v99 offset:1536
    ds_read_b64 v[220:221], v99 offset:2560
    ds_read_b64 v[222:223], v99 offset:3584
    v_mfma_f32_32x32x16_bf16 v[200:215], v[104:107], v[136:139], v[240:255]
    v_mfma_f32_32x32x16_bf16 v[200:215], v[108:111], v[140:143], v[200:215]
    ds_read_b128 v[104:107], v97 offset:0
    v_mfma_f32_32x32x16_bf16 v[200:215], v[112:115], v[144:147], v[200:215]
    ds_read_b128 v[108:111], v97 offset:256
    v_mfma_f32_32x32x16_bf16 v[200:215], v[116:119], v[148:151], v[200:215]
    ds_read_b128 v[112:115], v97 offset:1024
    v_mfma_f32_32x32x16_bf16 v[200:215], v[120:123], v[152:155], v[200:215]
    ds_read_b128 v[116:119], v97 offset:1280
    v_mfma_f32_32x32x16_bf16 v[200:215], v[124:127], v[156:159], v[200:215]
    ds_read_b128 v[120:123], v97 offset:2048
    v_mfma_f32_32x32x16_bf16 v[200:215], v[128:131], v[160:163], v[200:215]
    ds_read_b128 v[124:127], v97 offset:2304
    v_mfma_f32_32x32x16_bf16 v[200:215], v[132:135], v[164:167], v[200:215]
    ds_read_b128 v[128:131], v97 offset:3072
    ds_read_b128 v[132:135], v97 offset:3328
    s_waitcnt lgkmcnt(2)
    v_mfma_f32_32x32x16_bf16 v[68:83], v[104:107], v[136:139], 0
    s_nop 0
    v_mfma_f32_32x32x16_bf16 v[68:83], v[108:111], v[140:143], v[68:83]
    v_cvt_pk_bf16_f32 v200, 0, v200
    v_cvt_pk_bf16_f32 v201, 0, v201
    v_cvt_pk_bf16_f32 v202, 0, v202
    v_cvt_pk_bf16_f32 v203, 0, v203
    v_cvt_pk_bf16_f32 v204, 0, v204
    v_cvt_pk_bf16_f32 v205, 0, v205
    v_cvt_pk_bf16_f32 v206, 0, v206
    v_cvt_pk_bf16_f32 v207, 0, v207
    s_nop 0
    v_mfma_f32_32x32x16_bf16 v[68:83], v[112:115], v[144:147], v[68:83]
    v_cvt_pk_bf16_f32 v208, 0, v208
    v_cvt_pk_bf16_f32 v209, 0, v209
    v_cvt_pk_bf16_f32 v210, 0, v210
    v_cvt_pk_bf16_f32 v211, 0, v211
    v_cvt_pk_bf16_f32 v212, 0, v212
    v_cvt_pk_bf16_f32 v213, 0, v213
    v_cvt_pk_bf16_f32 v214, 0, v214
    v_cvt_pk_bf16_f32 v215, 0, v215
    s_nop 0
    v_mfma_f32_32x32x16_bf16 v[68:83], v[116:119], v[148:151], v[68:83]
    v_mul_f32 v200, s29, v200
    v_mul_f32 v201, s29, v201
    v_mul_f32 v202, s29, v202
    v_mul_f32 v203, s29, v203
    v_mul_f32 v204, s29, v204
    v_mul_f32 v205, s29, v205
    v_mul_f32 v206, s29, v206
    v_mul_f32 v207, s29, v207
    s_nop 0
    v_mfma_f32_32x32x16_bf16 v[68:83], v[120:123], v[152:155], v[68:83]
    v_mul_f32 v208, s29, v208
    v_mul_f32 v209, s29, v209
    v_mul_f32 v210, s29, v210
    v_mul_f32 v211, s29, v211
    v_mul_f32 v212, s29, v212
    v_mul_f32 v213, s29, v213
    v_mul_f32 v214, s29, v214
    v_mul_f32 v215, s29, v215
    s_nop 0
    v_mfma_f32_32x32x16_bf16 v[68:83], v[124:127], v[156:159], v[68:83]
    v_cvt_pk_bf16_f32 v200, 0, v200
    v_cvt_pk_bf16_f32 v201, 0, v201
    v_cvt_pk_bf16_f32 v202, 0, v202
    v_cvt_pk_bf16_f32 v203, 0, v203
    v_cvt_pk_bf16_f32 v204, 0, v204
    v_cvt_pk_bf16_f32 v205, 0, v205
    v_cvt_pk_bf16_f32 v206, 0, v206
    v_cvt_pk_bf16_f32 v207, 0, v207
    s_waitcnt lgkmcnt(1)
    v_mfma_f32_32x32x16_bf16 v[68:83], v[128:131], v[160:163], v[68:83]
    v_cvt_pk_bf16_f32 v208, 0, v208
    v_cvt_pk_bf16_f32 v209, 0, v209
    v_cvt_pk_bf16_f32 v210, 0, v210
    v_cvt_pk_bf16_f32 v211, 0, v211
    v_cvt_pk_bf16_f32 v212, 0, v212
    v_cvt_pk_bf16_f32 v213, 0, v213
    v_cvt_pk_bf16_f32 v214, 0, v214
    v_cvt_pk_bf16_f32 v215, 0, v215
    s_waitcnt lgkmcnt(0)
    v_mfma_f32_32x32x16_bf16 v[68:83], v[132:135], v[164:167], v[68:83]
    v_max3_f32 v234, v200, v201, v202
    v_max3_f32 v235, v203, v204, v205
    v_max3_f32 v234, v234, v206, v207
    v_max3_f32 v235, v235, v208, v209
    v_max3_f32 v234, v234, v210, v211
    v_max3_f32 v235, v235, v212, v213
    v_max3_f32 v234, v234, v214, v215
    s_nop 7
    s_branch L_atail_250
L_asrv_249:
    v_mfma_f32_32x32x16_bf16 v[200:215], v[104:107], v[136:139], v[240:255]
    v_mfma_f32_32x32x16_bf16 v[200:215], v[108:111], v[140:143], v[200:215]
    v_mfma_f32_32x32x16_bf16 v[200:215], v[112:115], v[144:147], v[200:215]
    v_mfma_f32_32x32x16_bf16 v[200:215], v[116:119], v[148:151], v[200:215]
    v_mfma_f32_32x32x16_bf16 v[200:215], v[120:123], v[152:155], v[200:215]
    v_mfma_f32_32x32x16_bf16 v[200:215], v[124:127], v[156:159], v[200:215]
    v_mfma_f32_32x32x16_bf16 v[200:215], v[128:131], v[160:163], v[200:215]
    v_mfma_f32_32x32x16_bf16 v[200:215], v[132:135], v[164:167], v[200:215]
    s_nop 11
    v_cvt_pk_bf16_f32 v200, 0, v200
    v_cvt_pk_bf16_f32 v201, 0, v201
    v_cvt_pk_bf16_f32 v202, 0, v202
    v_cvt_pk_bf16_f32 v203, 0, v203
    v_cvt_pk_bf16_f32 v204, 0, v204
    v_cvt_pk_bf16_f32 v205, 0, v205
    v_cvt_pk_bf16_f32 v206, 0, v206
    v_cvt_pk_bf16_f32 v207, 0, v207
    v_cvt_pk_bf16_f32 v208, 0, v208
    v_cvt_pk_bf16_f32 v209, 0, v209
    v_cvt_pk_bf16_f32 v210, 0, v210
    v_cvt_pk_bf16_f32 v211, 0, v211
    v_cvt_pk_bf16_f32 v212, 0, v212
    v_cvt_pk_bf16_f32 v213, 0, v213
    v_cvt_pk_bf16_f32 v214, 0, v214
    v_cvt_pk_bf16_f32 v215, 0, v215
    v_mul_f32 v200, s29, v200
    v_mul_f32 v201, s29, v201
    v_mul_f32 v202, s29, v202
    v_mul_f32 v203, s29, v203
    v_mul_f32 v204, s29, v204
    v_mul_f32 v205, s29, v205
    v_mul_f32 v206, s29, v206
    v_mul_f32 v207, s29, v207
    v_mul_f32 v208, s29, v208
    v_mul_f32 v209, s29, v209
    v_mul_f32 v210, s29, v210
    v_mul_f32 v211, s29, v211
    v_mul_f32 v212, s29, v212
    v_mul_f32 v213, s29, v213
    v_mul_f32 v214, s29, v214
    v_mul_f32 v215, s29, v215
    v_cvt_pk_bf16_f32 v200, 0, v200
    v_cvt_pk_bf16_f32 v201, 0, v201
    v_cvt_pk_bf16_f32 v202, 0, v202
    v_cvt_pk_bf16_f32 v203, 0, v203
    v_cvt_pk_bf16_f32 v204, 0, v204
    v_cvt_pk_bf16_f32 v205, 0, v205
    v_cvt_pk_bf16_f32 v206, 0, v206
    v_cvt_pk_bf16_f32 v207, 0, v207
    v_cvt_pk_bf16_f32 v208, 0, v208
    v_cvt_pk_bf16_f32 v209, 0, v209
    v_cvt_pk_bf16_f32 v210, 0, v210
    v_cvt_pk_bf16_f32 v211, 0, v211
    v_cvt_pk_bf16_f32 v212, 0, v212
    v_cvt_pk_bf16_f32 v213, 0, v213
    v_cvt_pk_bf16_f32 v214, 0, v214
    v_cvt_pk_bf16_f32 v215, 0, v215
    v_max3_f32 v234, v200, v201, v202
    v_max3_f32 v235, v203, v204, v205
    v_max3_f32 v234, v234, v206, v207
    v_max3_f32 v235, v235, v208, v209
    v_max3_f32 v234, v234, v210, v211
    v_max3_f32 v235, v235, v212, v213
    v_max3_f32 v234, v234, v214, v215
    s_add_u32 s27, s38, 1
    s_sub_u32 s26, s38, 1
    s_min_u32 s26, s26, 61
    s_cmp_ge_u32 s38, 52
    s_cselect_b32 s27, s26, s27
    v_mov_b32 v2, 4
L_cw_251:
    buffer_load_dword v1, v2, s[32:35], 0 offen sc1
    s_add_u32 s36, s36, 1
    s_cmp_gt_u32 s36, 0x100000
    s_cbranch_scc1 chain_kernel_wend
    s_waitcnt vmcnt(0)
    v_readfirstlane_b32 s25, v1
    s_cmp_ge_u32 s25, s27
    s_cbranch_scc1 L_cwok_252
    s_sleep 4
    s_branch L_cw_251
L_cwok_252:
    s_add_u32 m0, s7, 0
    s_add_u32 s43, s48, 0x8000c00
    buffer_load_dwordx4 v96, s[12:15], s43 offen sc1 lds
    s_add_u32 m0, s7, 1024
    s_add_u32 s43, s48, 0x8001c00
    buffer_load_dwordx4 v96, s[12:15], s43 offen sc1 lds
    s_add_u32 m0, s7, 2048
    s_add_u32 s43, s48, 0x8004c00
    buffer_load_dwordx4 v96, s[12:15], s43 offen sc1 lds
    s_add_u32 m0, s7, 3072
    s_add_u32 s43, s48, 0x8005c00
    buffer_load_dwordx4 v96, s[12:15], s43 offen sc1 lds
    s_add_u32 s36, s36, 1
    s_cmp_gt_u32 s36, 0x100000
    s_cbranch_scc1 chain_kernel_wend
    s_waitcnt vmcnt(0)
    ds_read_b128 v[104:107], v97 offset:0
    ds_read_b128 v[108:111], v97 offset:256
    ds_read_b64 v[216:217], v99 offset:512
    ds_read_b128 v[112:115], v97 offset:1024
    ds_read_b128 v[116:119], v97 offset:1280
    ds_read_b64 v[218:219], v99 offset:1536
    ds_read_b128 v[120:123], v97 offset:2048
    ds_read_b128 v[124:127], v97 offset:2304
    ds_read_b64 v[220:221], v99 offset:2560
    ds_read_b128 v[128:131], v97 offset:3072
    ds_read_b128 v[132:135], v97 offset:3328
    ds_read_b64 v[222:223], v99 offset:3584
    v_mov_b32 v1, 0
    s_waitcnt lgkmcnt(11)
    v_mfma_f32_32x32x16_bf16 v[68:83], v[104:107], v[136:139], 0
    v_max3_u32 v1, v1, v104, v105
    v_max3_u32 v1, v1, v106, v107
    s_waitcnt lgkmcnt(9)
    v_mfma_f32_32x32x16_bf16 v[68:83], v[108:111], v[140:143], v[68:83]
    v_max3_u32 v1, v1, v108, v109
    v_max3_u32 v1, v1, v110, v111
    v_max3_u32 v1, v1, v216, v217
    s_waitcnt lgkmcnt(8)
    v_mfma_f32_32x32x16_bf16 v[68:83], v[112:115], v[144:147], v[68:83]
    v_max3_u32 v1, v1, v112, v113
    v_max3_u32 v1, v1, v114, v115
    s_waitcnt lgkmcnt(6)
    v_mfma_f32_32x32x16_bf16 v[68:83], v[116:119], v[148:151], v[68:83]
    v_max3_u32 v1, v1, v116, v117
    v_max3_u32 v1, v1, v118, v119
    v_max3_u32 v1, v1, v218, v219
    s_waitcnt lgkmcnt(5)
    v_mfma_f32_32x32x16_bf16 v[68:83], v[120:123], v[152:155], v[68:83]
    v_max3_u32 v1, v1, v120, v121
    v_max3_u32 v1, v1, v122, v123
    s_waitcnt lgkmcnt(3)
    v_mfma_f32_32x32x16_bf16 v[68:83], v[124:127], v[156:159], v[68:83]
    v_max3_u32 v1, v1, v124, v125
    v_max3_u32 v1, v1, v126, v127
    v_max3_u32 v1, v1, v220, v221
    s_waitcnt lgkmcnt(2)
    v_mfma_f32_32x32x16_bf16 v[68:83], v[128:131], v[160:163], v[68:83]
    v_max3_u32 v1, v1, v128, v129
    v_max3_u32 v1, v1, v130, v131
    s_waitcnt lgkmcnt(0)
    v_mfma_f32_32x32x16_bf16 v[68:83], v[132:135], v[164:167], v[68:83]
    v_max3_u32 v1, v1, v132, v133
    v_max3_u32 v1, v1, v134, v135
    v_max3_u32 v1, v1, v222, v223
    v_cmp_eq_u32 vcc, 0xff81ff81, v1
    s_cbranch_vccnz L_cwok_252
    s_nop 4
    s_cmp_ge_u32 s47, 60
    s_cbranch_scc1 L_atail_250
    s_add_u32 s43, s50, 4194304
    buffer_load_dwordx4 a[32:35], v96, s[12:15], s43 offen offset:0
    s_add_u32 s43, s50, 4194304
    buffer_load_dwordx4 a[36:39], v96, s[12:15], s43 offen offset:1024
    s_add_u32 s43, s48, 4194304
    buffer_load_dwordx4 a[0:3], v96, s[12:15], s43 offen offset:0
    s_add_u32 s43, s48, 4194304
    buffer_load_dwordx4 a[4:7], v96, s[12:15], s43 offen offset:1024
    s_add_u32 s43, s50, 4198400
    buffer_load_dwordx4 a[40:43], v96, s[12:15], s43 offen offset:0
    s_add_u32 s43, s50, 4198400
    buffer_load_dwordx4 a[44:47], v96, s[12:15], s43 offen offset:1024
    s_add_u32 s43, s48, 4198400
    buffer_load_dwordx4 a[8:11], v96, s[12:15], s43 offen offset:0
    s_add_u32 s43, s48, 4198400
    buffer_load_dwordx4 a[12:15], v96, s[12:15], s43 offen offset:1024
    s_add_u32 s43, s50, 4210688
    buffer_load_dwordx4 a[48:51], v96, s[12:15], s43 offen offset:0
    s_add_u32 s43, s50, 4210688
    buffer_load_dwordx4 a[52:55], v96, s[12:15], s43 offen offset:1024
    s_add_u32 s43, s48, 4210688
    buffer_load_dwordx4 a[16:19], v96, s[12:15], s43 offen offset:0
    s_add_u32 s43, s48, 4210688
    buffer_load_dwordx4 a[20:23], v96, s[12:15], s43 offen offset:1024
    s_add_u32 s43, s50, 4214784
    buffer_load_dwordx4 a[56:59], v96, s[12:15], s43 offen offset:0
    s_add_u32 s43, s50, 4214784
    buffer_load_dwordx4 a[60:63], v96, s[12:15], s43 offen offset:1024
    s_add_u32 s43, s48, 4214784
    buffer_load_dwordx4 a[24:27], v96, s[12:15], s43 offen offset:0
    s_add_u32 s43, s48, 4214784
    buffer_load_dwordx4 a[28:31], v96, s[12:15], s43 offen offset:1024
    s_add_u32 s43, s48, 4194304
    buffer_load_dwordx4 a[64:67], v98, s[12:15], s43 offen offset:2048
    s_add_u32 s43, s48, 4194304
    buffer_load_dwordx4 a[68:71], v98, s[12:15], s43 offen offset:3072
    s_add_u32 s43, s48, 4198400
    buffer_load_dwordx4 a[72:75], v98, s[12:15], s43 offen offset:2048
    s_add_u32 s43, s48, 4198400
    buffer_load_dwordx4 a[76:79], v98, s[12:15], s43 offen offset:3072
    s_add_u32 s43, s48, 4210688
    buffer_load_dwordx4 a[80:83], v98, s[12:15], s43 offen offset:2048
    s_add_u32 s43, s48, 4210688
    buffer_load_dwordx4 a[84:87], v98, s[12:15], s43 offen offset:3072
    s_add_u32 s43, s48, 4214784
    buffer_load_dwordx4 a[88:91], v98, s[12:15], s43 offen offset:2048
    s_add_u32 s43, s48, 4214784
    buffer_load_dwordx4 a[92:95], v98, s[12:15], s43 offen offset:3072
L_atail_250:
    v_cvt_pk_bf16_f32 v68, 0, v68
    v_cvt_pk_bf16_f32 v69, 0, v69
    v_cvt_pk_bf16_f32 v70, 0, v70
    v_cvt_pk_bf16_f32 v71, 0, v71
    v_mul_f32 v68, s29, v68
    v_mul_f32 v69, s29, v69
    v_mul_f32 v70, s29, v70
    v_mul_f32 v71, s29, v71
    v_cvt_pk_bf16_f32 v68, 0, v68
    v_cvt_pk_bf16_f32 v69, 0, v69
    v_cvt_pk_bf16_f32 v70, 0, v70
    v_cvt_pk_bf16_f32 v71, 0, v71
    v_max3_f32 v235, v235, v68, v69
    v_max3_f32 v234, v234, v70, v71
    v_max_f32 v234, v234, v235
    v_mov_b32 v235, v234
    s_nop 1
    v_permlane32_swap_b32 v234, v235
    s_nop 0
    v_max_f32 v234, v234, v235
    v_mul_f32 v234, s28, v234
    v_fma_f32 v200, v200, s28, -v234
    v_fma_f32 v201, v201, s28, -v234
    v_fma_f32 v202, v202, s28, -v234
    v_fma_f32 v203, v203, s28, -v234
    v_fma_f32 v204, v204, s28, -v234
    v_fma_f32 v205, v205, s28, -v234
    v_fma_f32 v206, v206, s28, -v234
    v_fma_f32 v207, v207, s28, -v234
    v_fma_f32 v208, v208, s28, -v234
    v_fma_f32 v209, v209, s28, -v234
    v_fma_f32 v210, v210, s28, -v234
    v_fma_f32 v211, v211, s28, -v234
    v_fma_f32 v212, v212, s28, -v234
    v_fma_f32 v213, v213, s28, -v234
    v_fma_f32 v214, v214, s28, -v234
    v_fma_f32 v215, v215, s28, -v234
    v_fma_f32 v68, v68, s28, -v234
    v_fma_f32 v69, v69, s28, -v234
    v_fma_f32 v70, v70, s28, -v234
    v_fma_f32 v71, v71, s28, -v234
    v_exp_f32 v200, v200
    v_exp_f32 v201, v201
    v_exp_f32 v202, v202
    v_exp_f32 v203, v203
    v_exp_f32 v204, v204
    v_exp_f32 v205, v205
    v_exp_f32 v206, v206
    v_exp_f32 v207, v207
    v_exp_f32 v208, v208
    v_exp_f32 v209, v209
    v_exp_f32 v210, v210
    v_exp_f32 v211, v211
    v_exp_f32 v212, v212
    v_exp_f32 v213, v213
    v_exp_f32 v214, v214
    v_exp_f32 v215, v215
    v_exp_f32 v68, v68
    v_exp_f32 v69, v69
    v_exp_f32 v70, v70
    v_exp_f32 v71, v71
    v_pk_add_f32 v[236:237], v[200:201], v[202:203]
    v_pk_add_f32 v[236:237], v[236:237], v[204:205]
    v_pk_add_f32 v[236:237], v[236:237], v[206:207]
    v_pk_add_f32 v[236:237], v[236:237], v[208:209]
    v_pk_add_f32 v[236:237], v[236:237], v[210:211]
    v_pk_add_f32 v[236:237], v[236:237], v[212:213]
    v_pk_add_f32 v[236:237], v[236:237], v[214:215]
    v_pk_add_f32 v[236:237], v[236:237], v[68:69]
    v_pk_add_f32 v[236:237], v[236:237], v[70:71]
    v_add_f32 v236, v236, v237
    v_mov_b32 v235, v236
    s_nop 1
    v_permlane32_swap_b32 v236, v235
    s_nop 0
    v_add_f32 v236, v236, v235
    v_rcp_f32 v236, v236
    s_nop 0
    v_pk_mul_f32 v[200:201], v[200:201], v[236:237] op_sel_hi:[1,0]
    v_pk_mul_f32 v[202:203], v[202:203], v[236:237] op_sel_hi:[1,0]
    v_pk_mul_f32 v[204:205], v[204:205], v[236:237] op_sel_hi:[1,0]
    v_pk_mul_f32 v[206:207], v[206:207], v[236:237] op_sel_hi:[1,0]
    v_pk_mul_f32 v[208:209], v[208:209], v[236:237] op_sel_hi:[1,0]
    v_pk_mul_f32 v[210:211], v[210:211], v[236:237] op_sel_hi:[1,0]
    v_pk_mul_f32 v[212:213], v[212:213], v[236:237] op_sel_hi:[1,0]
    v_pk_mul_f32 v[214:215], v[214:215], v[236:237] op_sel_hi:[1,0]
    v_pk_mul_f32 v[68:69], v[68:69], v[236:237] op_sel_hi:[1,0]
    v_pk_mul_f32 v[70:71], v[70:71], v[236:237] op_sel_hi:[1,0]
    v_cvt_pk_bf16_f32 v224, v200, v201
    v_cvt_pk_bf16_f32 v225, v202, v203
    v_cvt_pk_bf16_f32 v226, v204, v205
    v_cvt_pk_bf16_f32 v227, v206, v207
    v_cvt_pk_bf16_f32 v228, v208, v209
    v_cvt_pk_bf16_f32 v229, v210, v211
    v_cvt_pk_bf16_f32 v230, v212, v213
    v_cvt_pk_bf16_f32 v231, v214, v215
    v_cvt_pk_bf16_f32 v232, v68, v69
    v_cvt_pk_bf16_f32 v233, v70, v71
    s_nop 1
    v_mfma_f32_32x32x16_bf16 v[104:119], v[168:171], v[224:227], 0
    v_mfma_f32_32x32x16_bf16 v[104:119], v[172:175], v[228:231], v[104:119]
    s_lshl_b32 s25, s38, 9
    s_lshr_b32 s26, s46, 3
    s_lshl_b32 s26, s26, 7
    s_add_u32 s25, s25, s26
    v_mfma_f32_32x32x8_bf16 v[104:119], v[216:217], v[232:233], v[104:119]
    s_add_u32 s51, s25, 0x5904000
    s_mov_b32 s94, s50
    s_add_u32 s47, s47, 4
    v_mfma_f32_32x32x16_bf16 v[120:135], v[176:179], v[224:227], 0
    v_mfma_f32_32x32x16_bf16 v[120:135], v[180:183], v[228:231], v[120:135]
    v_cvt_pk_bf16_f32 v168, v104, v105
    v_cvt_pk_bf16_f32 v169, v106, v107
    v_cvt_pk_bf16_f32 v170, v108, v109
    v_cvt_pk_bf16_f32 v171, v110, v111
    v_mfma_f32_32x32x8_bf16 v[120:135], v[218:219], v[232:233], v[120:135]
    v_cvt_pk_bf16_f32 v172, v112, v113
    v_cvt_pk_bf16_f32 v173, v114, v115
    v_cvt_pk_bf16_f32 v174, v116, v117
    v_cvt_pk_bf16_f32 v175, v118, v119
    v_mfma_f32_32x32x16_bf16 v[136:151], v[184:187], v[224:227], 0
    v_mfma_f32_32x32x16_bf16 v[136:151], v[188:191], v[228:231], v[136:151]
    v_cvt_pk_bf16_f32 v176, v120, v121
    v_cvt_pk_bf16_f32 v177, v122, v123
    v_cvt_pk_bf16_f32 v178, v124, v125
    v_cvt_pk_bf16_f32 v179, v126, v127
    v_mfma_f32_32x32x8_bf16 v[136:151], v[220:221], v[232:233], v[136:151]
    v_cvt_pk_bf16_f32 v180, v128, v129
    v_cvt_pk_bf16_f32 v181, v130, v131
    v_cvt_pk_bf16_f32 v182, v132, v133
    v_cvt_pk_bf16_f32 v183, v134, v135
    v_mfma_f32_32x32x16_bf16 v[152:167], v[192:195], v[224:227], 0
    v_mfma_f32_32x32x16_bf16 v[152:167], v[196:199], v[228:231], v[152:167]
    v_cvt_pk_bf16_f32 v184, v136, v137
    v_cvt_pk_bf16_f32 v185, v138, v139
    v_cvt_pk_bf16_f32 v186, v140, v141
    v_cvt_pk_bf16_f32 v187, v142, v143
    v_mfma_f32_32x32x8_bf16 v[152:167], v[222:223], v[232:233], v[152:167]
    v_cvt_pk_bf16_f32 v188, v144, v145
    v_cvt_pk_bf16_f32 v189, v146, v147
    v_cvt_pk_bf16_f32 v190, v148, v149
    v_cvt_pk_bf16_f32 v191, v150, v151
    s_nop 7
    v_cvt_pk_bf16_f32 v192, v152, v153
    v_cvt_pk_bf16_f32 v193, v154, v155
    v_cvt_pk_bf16_f32 v194, v156, v157
    v_cvt_pk_bf16_f32 v195, v158, v159
    v_cvt_pk_bf16_f32 v196, v160, v161
    v_cvt_pk_bf16_f32 v197, v162, v163
    v_cvt_pk_bf16_f32 v198, v164, v165
    v_cvt_pk_bf16_f32 v199, v166, v167
L_anext_244:
    s_add_u32 s27, s47, s49
    s_lshl_b32 s25, s27, 20
    s_lshl_b32 s26, s46, 15
    s_add_u32 s25, s25, s26
    s_bitcmp1_b32 s27, 1
    s_cselect_b32 s48, s55, s54
    s_cselect_b32 s50, s54, s55
    s_add_u32 s48, s48, s25
    s_add_u32 s50, s50, s25
    s_cmp_ge_u32 s22, 64
    s_cbranch_scc1 L_aserve_245
    v_readfirstlane_b32 s25, v87
    s_and_b32 s26, s46, 1
    s_mul_i32 s26, s26, 2
    s_sub_u32 s25, s25, s26
    s_sub_u32 s26, s22, 3
    s_min_i32 s25, s25, s26
    s_add_u32 s26, s47, 4
    s_cmp_ge_i32 s25, s26
    s_cselect_b32 s45, 1, 0
    s_cselect_b64 s[56:57], -1, 0
    s_cselect_b32 s48, s48, 0x40000000
    s_cselect_b32 s50, s50, 0x40000000
    s_branch L_attr_239
L_aserve_245:
    s_cmp_eq_u32 s45, 0
    s_cbranch_scc1 L_afirst_253
    s_add_u32 s43, s94, 0
    buffer_store_dwordx4 v[168:171], v100, s[12:15], s43 offen offset:2048 sc1
    s_add_u32 s43, s94, 0
    buffer_store_dwordx4 v[172:175], v100, s[12:15], s43 offen offset:2560 sc1
    s_add_u32 s43, s94, 4096
    buffer_store_dwordx4 v[176:179], v100, s[12:15], s43 offen offset:2048 sc1
    s_add_u32 s43, s94, 4096
    buffer_store_dwordx4 v[180:183], v100, s[12:15], s43 offen offset:2560 sc1
    s_add_u32 s43, s94, 16384
    buffer_store_dwordx4 v[184:187], v100, s[12:15], s43 offen offset:2048 sc1
    s_add_u32 s43, s94, 16384
    buffer_store_dwordx4 v[188:191], v100, s[12:15], s43 offen offset:2560 sc1
    s_add_u32 s43, s94, 20480
    buffer_store_dwordx4 v[192:195], v100, s[12:15], s43 offen offset:2048 sc1
    s_add_u32 s43, s94, 20480
    buffer_store_dwordx4 v[196:199], v100, s[12:15], s43 offen offset:2560 sc1
    s_mov_b32 s94, 0x40000000
    s_waitcnt vmcnt(0)
    buffer_atomic_add v84, v85, s[12:15], s51 offen sc1
    s_cmp_ge_u32 s47, 64
    s_cbranch_scc1 L_afin_246
    v_accvgpr_read_b32 v104, a0
    v_accvgpr_read_b32 v105, a1
    v_accvgpr_read_b32 v106, a2
    v_accvgpr_read_b32 v107, a3
    v_accvgpr_read_b32 v108, a4
    v_accvgpr_read_b32 v109, a5
    v_accvgpr_read_b32 v110, a6
    v_accvgpr_read_b32 v111, a7
    v_accvgpr_read_b32 v112, a8
    v_accvgpr_read_b32 v113, a9
    v_accvgpr_read_b32 v114, a10
    v_accvgpr_read_b32 v115, a11
    v_accvgpr_read_b32 v116, a12
    v_accvgpr_read_b32 v117, a13
    v_accvgpr_read_b32 v118, a14
    v_accvgpr_read_b32 v119, a15
    v_accvgpr_read_b32 v120, a16
    v_accvgpr_read_b32 v121, a17
    v_accvgpr_read_b32 v122, a18
    v_accvgpr_read_b32 v123, a19
    v_accvgpr_read_b32 v124, a20
    v_accvgpr_read_b32 v125, a21
    v_accvgpr_read_b32 v126, a22
    v_accvgpr_read_b32 v127, a23
    v_accvgpr_read_b32 v128, a24
    v_accvgpr_read_b32 v129, a25
    v_accvgpr_read_b32 v130, a26
    v_accvgpr_read_b32 v131, a27
    v_accvgpr_read_b32 v132, a28
    v_accvgpr_read_b32 v133, a29
    v_accvgpr_read_b32 v134, a30
    v_accvgpr_read_b32 v135, a31
    v_accvgpr_read_b32 v136, a32
    v_accvgpr_read_b32 v137, a33
    v_accvgpr_read_b32 v138, a34
    v_accvgpr_read_b32 v139, a35
    v_accvgpr_read_b32 v140, a36
    v_accvgpr_read_b32 v141, a37
    v_accvgpr_read_b32 v142, a38
    v_accvgpr_read_b32 v143, a39
    v_accvgpr_read_b32 v144, a40
    v_accvgpr_read_b32 v145, a41
    v_accvgpr_read_b32 v146, a42
    v_accvgpr_read_b32 v147, a43
    v_accvgpr_read_b32 v148, a44
    v_accvgpr_read_b32 v149, a45
    v_accvgpr_read_b32 v150, a46
    v_accvgpr_read_b32 v151, a47
    v_accvgpr_read_b32 v152, a48
    v_accvgpr_read_b32 v153, a49
    v_accvgpr_read_b32 v154, a50
    v_accvgpr_read_b32 v155, a51
    v_accvgpr_read_b32 v156, a52
    v_accvgpr_read_b32 v157, a53
    v_accvgpr_read_b32 v158, a54
    v_accvgpr_read_b32 v159, a55
    v_accvgpr_read_b32 v160, a56
    v_accvgpr_read_b32 v161, a57
    v_accvgpr_read_b32 v162, a58
    v_accvgpr_read_b32 v163, a59
    v_accvgpr_read_b32 v164, a60
    v_accvgpr_read_b32 v165, a61
    v_accvgpr_read_b32 v166, a62
    v_accvgpr_read_b32 v167, a63
    v_accvgpr_read_b32 v168, a64
    v_accvgpr_read_b32 v169, a65
    v_accvgpr_read_b32 v170, a66
    v_accvgpr_read_b32 v171, a67
    v_accvgpr_read_b32 v172, a68
    v_accvgpr_read_b32 v173, a69
    v_accvgpr_read_b32 v174, a70
    v_accvgpr_read_b32 v175, a71
    v_accvgpr_read_b32 v176, a72
    v_accvgpr_read_b32 v177, a73
    v_accvgpr_read_b32 v178, a74
    v_accvgpr_read_b32 v179, a75
    v_accvgpr_read_b32 v180, a76
    v_accvgpr_read_b32 v181, a77
    v_accvgpr_read_b32 v182, a78
    v_accvgpr_read_b32 v183, a79
    v_accvgpr_read_b32 v184, a80
    v_accvgpr_read_b32 v185, a81
    v_accvgpr_read_b32 v186, a82
    v_accvgpr_read_b32 v187, a83
    v_accvgpr_read_b32 v188, a84
    v_accvgpr_read_b32 v189, a85
    v_accvgpr_read_b32 v190, a86
    v_accvgpr_read_b32 v191, a87
    v_accvgpr_read_b32 v192, a88
    v_accvgpr_read_b32 v193, a89
    v_accvgpr_read_b32 v194, a90
    v_accvgpr_read_b32 v195, a91
    v_accvgpr_read_b32 v196, a92
    v_accvgpr_read_b32 v197, a93
    v_accvgpr_read_b32 v198, a94
    v_accvgpr_read_b32 v199, a95
    s_branch L_att_238
L_afirst_253:
    s_add_u32 s43, s50, 0
    buffer_load_dwordx4 v[136:139], v96, s[12:15], s43 offen offset:0
    s_add_u32 s43, s50, 0
    buffer_load_dwordx4 v[140:143], v96, s[12:15], s43 offen offset:1024
    s_add_u32 s43, s48, 0
    buffer_load_dwordx4 v[104:107], v96, s[12:15], s43 offen offset:0
    s_add_u32 s43, s48, 0
    buffer_load_dwordx4 v[108:111], v96, s[12:15], s43 offen offset:1024
    s_add_u32 s43, s50, 4096
    buffer_load_dwordx4 v[144:147], v96, s[12:15], s43 offen offset:0
    s_add_u32 s43, s50, 4096
    buffer_load_dwordx4 v[148:151], v96, s[12:15], s43 offen offset:1024
    s_add_u32 s43, s48, 4096
    buffer_load_dwordx4 v[112:115], v96, s[12:15], s43 offen offset:0
    s_add_u32 s43, s48, 4096
    buffer_load_dwordx4 v[116:119], v96, s[12:15], s43 offen offset:1024
    s_add_u32 s43, s50, 16384
    buffer_load_dwordx4 v[152:155], v96, s[12:15], s43 offen offset:0
    s_add_u32 s43, s50, 16384
    buffer_load_dwordx4 v[156:159], v96, s[12:15], s43 offen offset:1024
    s_add_u32 s43, s48, 16384
    buffer_load_dwordx4 v[120:123], v96, s[12:15], s43 offen offset:0
    s_add_u32 s43, s48, 16384
    buffer_load_dwordx4 v[124:127], v96, s[12:15], s43 offen offset:1024
    s_add_u32 s43, s50, 20480
    buffer_load_dwordx4 v[160:163], v96, s[12:15], s43 offen offset:0
    s_add_u32 s43, s50, 20480
    buffer_load_dwordx4 v[164:167], v96, s[12:15], s43 offen offset:1024
    s_add_u32 s43, s48, 20480
    buffer_load_dwordx4 v[128:131], v96, s[12:15], s43 offen offset:0
    s_add_u32 s43, s48, 20480
    buffer_load_dwordx4 v[132:135], v96, s[12:15], s43 offen offset:1024
    s_add_u32 s43, s48, 0
    buffer_load_dwordx4 v[168:171], v98, s[12:15], s43 offen offset:2048
    s_add_u32 s43, s48, 0
    buffer_load_dwordx4 v[172:175], v98, s[12:15], s43 offen offset:3072
    s_add_u32 s43, s48, 4096
    buffer_load_dwordx4 v[176:179], v98, s[12:15], s43 offen offset:2048
    s_add_u32 s43, s48, 4096
    buffer_load_dwordx4 v[180:183], v98, s[12:15], s43 offen offset:3072
    s_add_u32 s43, s48, 16384
    buffer_load_dwordx4 v[184:187], v98, s[12:15], s43 offen offset:2048
    s_add_u32 s43, s48, 16384
    buffer_load_dwordx4 v[188:191], v98, s[12:15], s43 offen offset:3072
    s_add_u32 s43, s48, 20480
    buffer_load_dwordx4 v[192:195], v98, s[12:15], s43 offen offset:2048
    s_add_u32 s43, s48, 20480
    buffer_load_dwordx4 v[196:199], v98, s[12:15], s43 offen offset:3072
    s_mov_b32 s45, 1
    s_waitcnt vmcnt(0)
    s_branch L_att_238
L_afin_246:
    s_branch L_ste_242
L_fl0_240:
    s_waitcnt lgkmcnt(0)
    s_nop 7
L_ste_242:
    s_branch chain_kernel_wend
L_g1_221:
    s_cmp_ge_u32 s41, 16
    s_cbranch_scc1 L_g2_222
    s_mov_b32 s8, s64
    s_and_b32 s9, s65, 0xffff
    s_mov_b32 s10, 0x400000
    s_mov_b32 s11, 0x00020000
    v_lshlrev_b32 v1, 4, v0
    s_lshl_b32 s25, s41, 12
    buffer_load_dwordx4 v[52:55], v1, s[8:11], s25 offen
    s_add_u32 s25, s25, 65536
    buffer_load_dwordx4 v[52:55], v1, s[8:11], s25 offen
    s_add_u32 s25, s25, 65536
    buffer_load_dwordx4 v[52:55], v1, s[8:11], s25 offen
    s_add_u32 s25, s25, 65536
    buffer_load_dwordx4 v[52:55], v1, s[8:11], s25 offen
    s_add_u32 s25, s25, 65536
    s_lshl_b32 s46, s41, 6
    s_lshl_b32 s25, s49, 4
    s_add_u32 s46, s46, s25
    v_and_b32 v1, 15, v0
    v_add_u32 v1, s46, v1
    v_bfe_u32 v2, v0, 4, 2
    v_lshlrev_b32 v3, 1, v1
    s_mov_b32 s16, s66
    s_and_b32 s17, s67, 0xffff
    s_mov_b32 s18, 0x800
    s_mov_b32 s19, 0x00020000
    buffer_load_ushort v128, v3, s[16:19], 0 offen
    s_mov_b32 s16, s68
    s_and_b32 s17, s69, 0xffff
    s_mov_b32 s18, 0x800
    s_mov_b32 s19, 0x00020000
    buffer_load_ushort v129, v3, s[16:19], 0 offen
    s_mov_b32 s16, s78
    s_and_b32 s17, s79, 0xffff
    s_mov_b32 s18, 0x800
    s_mov_b32 s19, 0x00020000
    buffer_load_ushort v130, v3, s[16:19], 0 offen
    s_mov_b32 s16, s70
    s_and_b32 s17, s71, 0xffff
    s_mov_b32 s18, 0x200000
    s_mov_b32 s19, 0x00020000
    s_mov_b32 s32, s72
    s_and_b32 s33, s73, 0xffff
    s_mov_b32 s34, 0x200000
    s_mov_b32 s35, 0x00020000
    s_lshl_b32 s25, s49, 11
    s_add_u32 s25, s25, 0x20000
    v_bfe_u32 v5, v0, 1, 2
    v_xor_b32 v5, v5, v2
    v_lshlrev_b32 v5, 4, v5
    v_and_b32 v6, 15, v0
    v_lshl_add_u32 v5, v6, 6, v5
    v_add_u32 v116, s25, v5
    v_bfe_u32 v5, v0, 5, 1
    v_bfe_u32 v6, v0, 2, 2
    v_lshl_add_u32 v5, v5, 3, v6
    v_lshlrev_b32 v5, 6, v5
    v_bfe_u32 v7, v0, 4, 1
    v_lshlrev_b32 v7, 1, v7
    v_bfe_u32 v117, v0, 1, 1
    v_add_u32 v7, v7, v117
    v_lshrrev_b32 v6, 1, v6
    v_xor_b32 v7, v7, v6
    v_lshl_add_u32 v5, v7, 4, v5
    v_and_b32 v6, 1, v0
    v_lshl_add_u32 v5, v6, 3, v5
    v_add_u32 v117, s25, v5
    v_xor_b32 v118, 32, v117
    s_lshl_b32 s25, s46, 6
    v_and_b32 v5, 63, v0
    v_lshlrev_b32 v5, 4, v5
    v_add_u32 v86, s25, v5
    v_and_b32 v1, 31, v0
    v_bfe_u32 v2, v0, 5, 1
    v_add_u32 v3, 0, v2
    v_xor_b32 v4, v3, v1
    v_lshlrev_b32 v4, 4, v4
    v_add_u32 v3, s46, v3
    v_lshl_add_u32 v20, v3, 11, v4
    v_add_u32 v3, 2, v2
    v_xor_b32 v4, v3, v1
    v_lshlrev_b32 v4, 4, v4
    v_add_u32 v3, s46, v3
    v_lshl_add_u32 v21, v3, 11, v4
    v_add_u32 v3, 4, v2
    v_xor_b32 v4, v3, v1
    v_lshlrev_b32 v4, 4, v4
    v_add_u32 v3, s46, v3
    v_lshl_add_u32 v22, v3, 11, v4
    v_add_u32 v3, 6, v2
    v_xor_b32 v4, v3, v1
    v_lshlrev_b32 v4, 4, v4
    v_add_u32 v3, s46, v3
    v_lshl_add_u32 v23, v3, 11, v4
    v_add_u32 v3, 8, v2
    v_xor_b32 v4, v3, v1
    v_lshlrev_b32 v4, 4, v4
    v_add_u32 v3, s46, v3
    v_lshl_add_u32 v24, v3, 11, v4
    v_add_u32 v3, 10, v2
    v_xor_b32 v4, v3, v1
    v_lshlrev_b32 v4, 4, v4
    v_add_u32 v3, s46, v3
    v_lshl_add_u32 v25, v3, 11, v4
    v_add_u32 v3, 12, v2
    v_xor_b32 v4, v3, v1
    v_lshlrev_b32 v4, 4, v4
    v_add_u32 v3, s46, v3
    v_lshl_add_u32 v26, v3, 11, v4
    v_add_u32 v3, 14, v2
    v_xor_b32 v4, v3, v1
    v_lshlrev_b32 v4, 4, v4
    v_add_u32 v3, s46, v3
    v_lshl_add_u32 v27, v3, 11, v4
    v_and_b32 v1, 15, v0
    v_bfe_u32 v2, v0, 4, 2
    v_lshrrev_b32 v3, 6, v0
    v_lshlrev_b32 v3, 15, v3
    v_lshl_add_u32 v3, v1, 9, v3
    v_add_u32 v4, 0, v2
    v_xor_b32 v4, v4, v1
    v_lshl_add_u32 v28, v4, 4, v3
    v_add_u32 v4, 4, v2
    v_xor_b32 v4, v4, v1
    v_lshl_add_u32 v29, v4, 4, v3
    v_add_u32 v4, 8, v2
    v_xor_b32 v4, v4, v1
    v_lshl_add_u32 v30, v4, 4, v3
    v_add_u32 v4, 12, v2
    v_xor_b32 v4, v4, v1
    v_lshl_add_u32 v31, v4, 4, v3
    s_lshl_b32 s26, s49, 15
    s_barrier
    s_mov_b32 s27, 0
    s_add_u32 m0, s26, 0
    s_nop 0
    buffer_load_dwordx4 v20, s[16:19], s27 offen nt lds
    s_add_u32 m0, s26, 1024
    s_nop 0
    buffer_load_dwordx4 v21, s[16:19], s27 offen nt lds
    s_add_u32 m0, s26, 2048
    s_nop 0
    buffer_load_dwordx4 v22, s[16:19], s27 offen nt lds
    s_add_u32 m0, s26, 3072
    s_nop 0
    buffer_load_dwordx4 v23, s[16:19], s27 offen nt lds
    s_add_u32 m0, s26, 4096
    s_nop 0
    buffer_load_dwordx4 v24, s[16:19], s27 offen nt lds
    s_add_u32 m0, s26, 5120
    s_nop 0
    buffer_load_dwordx4 v25, s[16:19], s27 offen nt lds
    s_add_u32 m0, s26, 6144
    s_nop 0
    buffer_load_dwordx4 v26, s[16:19], s27 offen nt lds
    s_add_u32 m0, s26, 7168
    s_nop 0
    buffer_load_dwordx4 v27, s[16:19], s27 offen nt lds
    s_mov_b32 s27, 0
    s_add_u32 m0, s26, 8192
    s_nop 0
    buffer_load_dwordx4 v20, s[32:35], s27 offen nt lds
    s_add_u32 m0, s26, 9216
    s_nop 0
    buffer_load_dwordx4 v21, s[32:35], s27 offen nt lds
    s_add_u32 m0, s26, 10240
    s_nop 0
    buffer_load_dwordx4 v22, s[32:35], s27 offen nt lds
    s_add_u32 m0, s26, 11264
    s_nop 0
    buffer_load_dwordx4 v23, s[32:35], s27 offen nt lds
    s_add_u32 m0, s26, 12288
    s_nop 0
    buffer_load_dwordx4 v24, s[32:35], s27 offen nt lds
    s_add_u32 m0, s26, 13312
    s_nop 0
    buffer_load_dwordx4 v25, s[32:35], s27 offen nt lds
    s_add_u32 m0, s26, 14336
    s_nop 0
    buffer_load_dwordx4 v26, s[32:35], s27 offen nt lds
    s_add_u32 m0, s26, 15360
    s_nop 0
    buffer_load_dwordx4 v27, s[32:35], s27 offen nt lds
    s_mov_b32 s27, 512
    s_add_u32 m0, s26, 16384
    s_nop 0
    buffer_load_dwordx4 v20, s[16:19], s27 offen nt lds
    s_add_u32 m0, s26, 17408
    s_nop 0
    buffer_load_dwordx4 v21, s[16:19], s27 offen nt lds
    s_add_u32 m0, s26, 18432
    s_nop 0
    buffer_load_dwordx4 v22, s[16:19], s27 offen nt lds
    s_add_u32 m0, s26, 19456
    s_nop 0
    buffer_load_dwordx4 v23, s[16:19], s27 offen nt lds
    s_add_u32 m0, s26, 20480
    s_nop 0
    buffer_load_dwordx4 v24, s[16:19], s27 offen nt lds
    s_add_u32 m0, s26, 21504
    s_nop 0
    buffer_load_dwordx4 v25, s[16:19], s27 offen nt lds
    s_add_u32 m0, s26, 22528
    s_nop 0
    buffer_load_dwordx4 v26, s[16:19], s27 offen nt lds
    s_add_u32 m0, s26, 23552
    s_nop 0
    buffer_load_dwordx4 v27, s[16:19], s27 offen nt lds
    s_mov_b32 s27, 512
    s_add_u32 m0, s26, 24576
    s_nop 0
    buffer_load_dwordx4 v20, s[32:35], s27 offen nt lds
    s_add_u32 m0, s26, 25600
    s_nop 0
    buffer_load_dwordx4 v21, s[32:35], s27 offen nt lds
    s_add_u32 m0, s26, 26624
    s_nop 0
    buffer_load_dwordx4 v22, s[32:35], s27 offen nt lds
    s_add_u32 m0, s26, 27648
    s_nop 0
    buffer_load_dwordx4 v23, s[32:35], s27 offen nt lds
    s_add_u32 m0, s26, 28672
    s_nop 0
    buffer_load_dwordx4 v24, s[32:35], s27 offen nt lds
    s_add_u32 m0, s26, 29696
    s_nop 0
    buffer_load_dwordx4 v25, s[32:35], s27 offen nt lds
    s_add_u32 m0, s26, 30720
    s_nop 0
    buffer_load_dwordx4 v26, s[32:35], s27 offen nt lds
    s_add_u32 m0, s26, 31744
    s_nop 0
    buffer_load_dwordx4 v27, s[32:35], s27 offen nt lds
    s_waitcnt vmcnt(16)
    ds_read_b128 a[0:3], v28 offset:0
    ds_read_b128 a[4:7], v28 offset:8192
    ds_read_b128 a[8:11], v29 offset:0
    ds_read_b128 a[12:15], v29 offset:8192
    ds_read_b128 a[16:19], v30 offset:0
    ds_read_b128 a[20:23], v30 offset:8192
    ds_read_b128 a[24:27], v31 offset:0
    ds_read_b128 a[28:31], v31 offset:8192
    s_waitcnt lgkmcnt(0)
    ds_read_b128 a[32:35], v28 offset:256
    ds_read_b128 a[36:39], v28 offset:8448
    ds_read_b128 a[40:43], v29 offset:256
    ds_read_b128 a[44:47], v29 offset:8448
    ds_read_b128 a[48:51], v30 offset:256
    ds_read_b128 a[52:55], v30 offset:8448
    ds_read_b128 a[56:59], v31 offset:256
    ds_read_b128 a[60:63], v31 offset:8448
    s_waitcnt lgkmcnt(0)
    s_mov_b32 s27, 1024
    s_add_u32 m0, s26, 0
    s_nop 0
    buffer_load_dwordx4 v20, s[16:19], s27 offen nt lds
    s_add_u32 m0, s26, 1024
    s_nop 0
    buffer_load_dwordx4 v21, s[16:19], s27 offen nt lds
    s_add_u32 m0, s26, 2048
    s_nop 0
    buffer_load_dwordx4 v22, s[16:19], s27 offen nt lds
    s_add_u32 m0, s26, 3072
    s_nop 0
    buffer_load_dwordx4 v23, s[16:19], s27 offen nt lds
    s_add_u32 m0, s26, 4096
    s_nop 0
    buffer_load_dwordx4 v24, s[16:19], s27 offen nt lds
    s_add_u32 m0, s26, 5120
    s_nop 0
    buffer_load_dwordx4 v25, s[16:19], s27 offen nt lds
    s_add_u32 m0, s26, 6144
    s_nop 0
    buffer_load_dwordx4 v26, s[16:19], s27 offen nt lds
    s_add_u32 m0, s26, 7168
    s_nop 0
    buffer_load_dwordx4 v27, s[16:19], s27 offen nt lds
    s_mov_b32 s27, 1024
    s_add_u32 m0, s26, 8192
    s_nop 0
    buffer_load_dwordx4 v20, s[32:35], s27 offen nt lds
    s_add_u32 m0, s26, 9216
    s_nop 0
    buffer_load_dwordx4 v21, s[32:35], s27 offen nt lds
    s_add_u32 m0, s26, 10240
    s_nop 0
    buffer_load_dwordx4 v22, s[32:35], s27 offen nt lds
    s_add_u32 m0, s26, 11264
    s_nop 0
    buffer_load_dwordx4 v23, s[32:35], s27 offen nt lds
    s_add_u32 m0, s26, 12288
    s_nop 0
    buffer_load_dwordx4 v24, s[32:35], s27 offen nt lds
    s_add_u32 m0, s26, 13312
    s_nop 0
    buffer_load_dwordx4 v25, s[32:35], s27 offen nt lds
    s_add_u32 m0, s26, 14336
    s_nop 0
    buffer_load_dwordx4 v26, s[32:35], s27 offen nt lds
    s_add_u32 m0, s26, 15360
    s_nop 0
    buffer_load_dwordx4 v27, s[32:35], s27 offen nt lds
    s_waitcnt vmcnt(16)
    ds_read_b128 a[64:67], v28 offset:16384
    ds_read_b128 a[68:71], v28 offset:24576
    ds_read_b128 a[72:75], v29 offset:16384
    ds_read_b128 a[76:79], v29 offset:24576
    ds_read_b128 a[80:83], v30 offset:16384
    ds_read_b128 a[84:87], v30 offset:24576
    ds_read_b128 a[88:91], v31 offset:16384
    ds_read_b128 a[92:95], v31 offset:24576
    s_waitcnt lgkmcnt(0)
    ds_read_b128 a[96:99], v28 offset:16640
    ds_read_b128 a[100:103], v28 offset:24832
    ds_read_b128 a[104:107], v29 offset:16640
    ds_read_b128 a[108:111], v29 offset:24832
    ds_read_b128 a[112:115], v30 offset:16640
    ds_read_b128 a[116:119], v30 offset:24832
    ds_read_b128 a[120:123], v31 offset:16640
    ds_read_b128 a[124:127], v31 offset:24832
    s_waitcnt lgkmcnt(0)
    s_mov_b32 s27, 1536
    s_add_u32 m0, s26, 16384
    s_nop 0
    buffer_load_dwordx4 v20, s[16:19], s27 offen nt lds
    s_add_u32 m0, s26, 17408
    s_nop 0
    buffer_load_dwordx4 v21, s[16:19], s27 offen nt lds
    s_add_u32 m0, s26, 18432
    s_nop 0
    buffer_load_dwordx4 v22, s[16:19], s27 offen nt lds
    s_add_u32 m0, s26, 19456
    s_nop 0
    buffer_load_dwordx4 v23, s[16:19], s27 offen nt lds
    s_add_u32 m0, s26, 20480
    s_nop 0
    buffer_load_dwordx4 v24, s[16:19], s27 offen nt lds
    s_add_u32 m0, s26, 21504
    s_nop 0
    buffer_load_dwordx4 v25, s[16:19], s27 offen nt lds
    s_add_u32 m0, s26, 22528
    s_nop 0
    buffer_load_dwordx4 v26, s[16:19], s27 offen nt lds
    s_add_u32 m0, s26, 23552
    s_nop 0
    buffer_load_dwordx4 v27, s[16:19], s27 offen nt lds
    s_mov_b32 s27, 1536
    s_add_u32 m0, s26, 24576
    s_nop 0
    buffer_load_dwordx4 v20, s[32:35], s27 offen nt lds
    s_add_u32 m0, s26, 25600
    s_nop 0
    buffer_load_dwordx4 v21, s[32:35], s27 offen nt lds
    s_add_u32 m0, s26, 26624
    s_nop 0
    buffer_load_dwordx4 v22, s[32:35], s27 offen nt lds
    s_add_u32 m0, s26, 27648
    s_nop 0
    buffer_load_dwordx4 v23, s[32:35], s27 offen nt lds
    s_add_u32 m0, s26, 28672
    s_nop 0
    buffer_load_dwordx4 v24, s[32:35], s27 offen nt lds
    s_add_u32 m0, s26, 29696
    s_nop 0
    buffer_load_dwordx4 v25, s[32:35], s27 offen nt lds
    s_add_u32 m0, s26, 30720
    s_nop 0
    buffer_load_dwordx4 v26, s[32:35], s27 offen nt lds
    s_add_u32 m0, s26, 31744
    s_nop 0
    buffer_load_dwordx4 v27, s[32:35], s27 offen nt lds
    s_waitcnt vmcnt(16)
    ds_read_b128 a[128:131], v28 offset:0
    ds_read_b128 a[132:135], v28 offset:8192
    ds_read_b128 a[136:139], v29 offset:0
    ds_read_b128 a[140:143], v29 offset:8192
    ds_read_b128 a[144:147], v30 offset:0
    ds_read_b128 a[148:151], v30 offset:8192
    ds_read_b128 a[152:155], v31 offset:0
    ds_read_b128 a[156:159], v31 offset:8192
    s_waitcnt lgkmcnt(0)
    ds_read_b128 a[160:163], v28 offset:256
    ds_read_b128 a[164:167], v28 offset:8448
    ds_read_b128 a[168:171], v29 offset:256
    ds_read_b128 a[172:175], v29 offset:8448
    ds_read_b128 a[176:179], v30 offset:256
    ds_read_b128 a[180:183], v30 offset:8448
    ds_read_b128 a[184:187], v31 offset:256
    ds_read_b128 a[188:191], v31 offset:8448
    s_waitcnt lgkmcnt(0)
    s_waitcnt vmcnt(0)
    ds_read_b128 a[192:195], v28 offset:16384
    ds_read_b128 a[196:199], v28 offset:24576
    ds_read_b128 a[200:203], v29 offset:16384
    ds_read_b128 a[204:207], v29 offset:24576
    ds_read_b128 a[208:211], v30 offset:16384
    ds_read_b128 a[212:215], v30 offset:24576
    ds_read_b128 a[216:219], v31 offset:16384
    ds_read_b128 a[220:223], v31 offset:24576
    s_waitcnt lgkmcnt(0)
    ds_read_b128 a[224:227], v28 offset:16640
    ds_read_b128 a[228:231], v28 offset:24832
    ds_read_b128 a[232:235], v29 offset:16640
    ds_read_b128 a[236:239], v29 offset:24832
    ds_read_b128 a[240:243], v30 offset:16640
    ds_read_b128 a[244:247], v30 offset:24832
    ds_read_b128 a[248:251], v31 offset:16640
    ds_read_b128 a[252:255], v31 offset:24832
    s_waitcnt lgkmcnt(0)
    v_lshlrev_b32 v128, 16, v128
    v_lshlrev_b32 v129, 16, v129
    v_lshlrev_b32 v130, 16, v130
    v_mul_f32 v131, 0x3fb8aa3b, v130
    v_exp_f32 v131, v131
    s_nop 0
    v_cvt_pk_bf16_f32 v131, 0, v131
    v_mul_f32 v132, v131, v128
    v_mul_f32 v133, v131, v129
    v_mul_f32 v132, 0x3fb8aa3b, v132
    v_exp_f32 v132, v132
    v_mul_f32 v133, 0x3e22f983, v133
    v_fract_f32 v133, v133
    v_cos_f32 v134, v133
    v_sin_f32 v133, v133
    s_nop 0
    v_mul_f32 v88, v132, v134
    v_mul_f32 v89, v132, v133
    v_add_f32 v131, -1.0, v88
    v_mul_f32 v132, v131, v128
    v_fma_f32 v132, v89, v129, v132
    v_mul_f32 v133, v89, v128
    v_fma_f32 v133, -v131, v129, v133
    v_mul_f32 v134, v128, v128
    v_fma_f32 v134, v129, v129, v134
    v_rcp_f32 v134, v134
    s_nop 0
    v_add_f32 v134, v134, v134
    v_mul_f32 v90, v132, v134
    v_mul_f32 v91, v133, v134
    v_mov_b32 v92, v88
    v_mov_b32 v93, v89
    v_mul_f32 v131, v93, v93
    v_mul_f32 v93, v92, v93
    v_fma_f32 v92, v92, v92, -v131
    v_add_f32 v93, v93, v93
    v_mul_f32 v131, v93, v93
    v_mul_f32 v93, v92, v93
    v_fma_f32 v92, v92, v92, -v131
    v_add_f32 v93, v93, v93
    v_mul_f32 v131, v93, v93
    v_mul_f32 v93, v92, v93
    v_fma_f32 v92, v92, v92, -v131
    v_add_f32 v93, v93, v93
    v_xor_b32 v152, 0x80000000, v89
    v_xor_b32 v153, 0x80000000, v93
    v_xor_b32 v154, 0x80000000, v90
    v_xor_b32 v155, 0x80000000, v91
    v_mul_f32 v156, v88, v90
    v_mul_f32 v157, v88, v91
    v_fmac_f32 v156, v152, v91
    v_fmac_f32 v157, v89, v90
    v_mul_f32 v158, v88, v156
    v_mul_f32 v159, v88, v157
    v_fmac_f32 v158, v152, v157
    v_fmac_f32 v159, v89, v156
    v_mul_f32 v160, v88, v158
    v_mul_f32 v161, v88, v159
    v_fmac_f32 v160, v152, v159
    v_fmac_f32 v161, v89, v158
    v_mul_f32 v162, v88, v160
    v_mul_f32 v163, v88, v161
    v_fmac_f32 v162, v152, v161
    v_fmac_f32 v163, v89, v160
    v_mul_f32 v164, v88, v162
    v_mul_f32 v165, v88, v163
    v_fmac_f32 v164, v152, v163
    v_fmac_f32 v165, v89, v162
    v_mul_f32 v166, v88, v164
    v_mul_f32 v167, v88, v165
    v_fmac_f32 v166, v152, v165
    v_fmac_f32 v167, v89, v164
    v_mul_f32 v168, v88, v166
    v_mul_f32 v169, v88, v167
    v_fmac_f32 v168, v152, v167
    v_fmac_f32 v169, v89, v166
    v_mul_f32 v170, v88, v168
    v_mul_f32 v171, v88, v169
    v_fmac_f32 v170, v152, v169
    v_fmac_f32 v171, v89, v168
    v_mov_b32 v94, 0
    v_mov_b32 v95, 0
    v_mov_b32 v68, 0
    v_mov_b32 v69, 0
    v_mov_b32 v70, 0
    v_mov_b32 v71, 0
    v_mov_b32 v72, 0
    v_mov_b32 v73, 0
    v_mov_b32 v74, 0
    v_mov_b32 v75, 0
    v_mov_b32 v76, 0
    v_mov_b32 v77, 0
    v_mov_b32 v78, 0
    v_mov_b32 v79, 0
    v_mov_b32 v80, 0
    v_mov_b32 v81, 0
    v_mov_b32 v82, 0
    v_mov_b32 v83, 0
    s_lshl_b32 s21, s49, 12
    v_and_b32 v1, 63, v0
    v_and_b32 v2, 15, v0
    v_bfe_u32 v3, v0, 4, 2
    v_lshrrev_b32 v4, 6, v0
    v_lshrrev_b32 v5, 5, v1
    v_lshl_add_u32 v5, v4, 3, v5
    v_add_u32 v5, 0, v5
    v_and_b32 v6, 3, v5
    v_lshrrev_b32 v7, 3, v5
    v_lshl_add_u32 v6, v7, 2, v6
    v_and_b32 v7, 31, v1
    v_xor_b32 v6, v6, v7
    v_lshlrev_b32 v6, 4, v6
    v_lshl_add_u32 v8, v5, 11, v6
    v_lshrrev_b32 v5, 5, v1
    v_lshl_add_u32 v5, v4, 3, v5
    v_add_u32 v5, 2, v5
    v_and_b32 v6, 3, v5
    v_lshrrev_b32 v7, 3, v5
    v_lshl_add_u32 v6, v7, 2, v6
    v_and_b32 v7, 31, v1
    v_xor_b32 v6, v6, v7
    v_lshlrev_b32 v6, 4, v6
    v_lshl_add_u32 v9, v5, 11, v6
    v_lshrrev_b32 v5, 5, v1
    v_lshl_add_u32 v5, v4, 3, v5
    v_add_u32 v5, 4, v5
    v_and_b32 v6, 3, v5
    v_lshrrev_b32 v7, 3, v5
    v_lshl_add_u32 v6, v7, 2, v6
    v_and_b32 v7, 31, v1
    v_xor_b32 v6, v6, v7
    v_lshlrev_b32 v6, 4, v6
    v_lshl_add_u32 v10, v5, 11, v6
    v_lshrrev_b32 v5, 5, v1
    v_lshl_add_u32 v5, v4, 3, v5
    v_add_u32 v5, 6, v5
    v_and_b32 v6, 3, v5
    v_lshrrev_b32 v7, 3, v5
    v_lshl_add_u32 v6, v7, 2, v6
    v_and_b32 v7, 31, v1
    v_xor_b32 v6, v6, v7
    v_lshlrev_b32 v6, 4, v6
    v_lshl_add_u32 v11, v5, 11, v6
    v_and_b32 v5, 12, v2
    v_add_u32 v5, v5, v2
    v_add_u32 v6, 0, v3
    v_xor_b32 v6, v6, v2
    v_lshlrev_b32 v6, 4, v6
    v_lshl_add_u32 v12, v5, 9, v6
    v_add_u32 v6, 4, v3
    v_xor_b32 v6, v6, v2
    v_lshlrev_b32 v6, 4, v6
    v_lshl_add_u32 v13, v5, 9, v6
    v_add_u32 v6, 8, v3
    v_xor_b32 v6, v6, v2
    v_lshlrev_b32 v6, 4, v6
    v_lshl_add_u32 v14, v5, 9, v6
    v_add_u32 v6, 12, v3
    v_xor_b32 v6, v6, v2
    v_lshlrev_b32 v6, 4, v6
    v_lshl_add_u32 v15, v5, 9, v6
    v_add_u32 v16, 0x10000, v12
    v_add_u32 v17, 0x10000, v13
    v_add_u32 v18, 0x10000, v14
    v_add_u32 v19, 0x10000, v15
    s_mov_b32 s32, s98
    s_and_b32 s33, s99, 0xffff
    s_mov_b32 s34, 0x100
    s_mov_b32 s35, 0x00020000
    s_mov_b32 s25, 0
    v_mov_b32 v2, 0
L_pl_254:
    buffer_load_dword v1, v2, s[32:35], s25 offen sc1
    s_add_u32 s36, s36, 1
    s_cmp_gt_u32 s36, 0x100000
    s_cbranch_scc1 chain_kernel_wend
    s_waitcnt vmcnt(0)
    v_readfirstlane_b32 s26, v1
    s_and_b32 s27, s26, 0xffff
    s_cmp_ge_u32 s27, 256
    s_cbranch_scc1 L_plok_255
    s_sleep 4
    s_branch L_pl_254
L_plok_255:
    s_lshr_b32 s25, s26, 16
    s_cmp_gt_u32 s25, 16
    s_cselect_b32 s25, 0x2000, 0x0
    s_add_u32 s54, s100, 0x1fffff
    s_and_b32 s54, s54, 0xffe00000
    s_sub_u32 s55, s54, s100
    s_add_u32 s54, s55, s25
    s_xor_b32 s25, s25, 0x2000
    s_add_u32 s55, s55, s25
    s_mov_b32 s56, 0xffff0000
    s_mov_b32 s57, 0xffffffff
    s_mov_b32 s58, 0x0
    s_mov_b32 s59, 0xffffffff
    s_mov_b32 s60, 0x0
    s_mov_b32 s61, 0xffff0000
    s_mov_b32 s22, 0
    s_mov_b32 s24, 0
    s_mov_b32 s20, 0
    s_mov_b32 s37, 0
    s_mov_b32 s23, 64
    s_mov_b32 s38, 0x7ff00000
    s_mov_b32 s39, 0x7ff00000
    s_mov_b32 s43, 0x7ff00000
    s_barrier
    s_add_u32 m0, s21, 0
    s_nop 0
    buffer_load_dwordx4 v8, s[8:11], s20 offen lds
    s_add_u32 m0, s21, 1024
    s_nop 0
    buffer_load_dwordx4 v9, s[8:11], s20 offen lds
    s_add_u32 m0, s21, 2048
    s_nop 0
    buffer_load_dwordx4 v10, s[8:11], s20 offen lds
    s_add_u32 m0, s21, 3072
    s_nop 0
    buffer_load_dwordx4 v11, s[8:11], s20 offen lds
    s_add_u32 s20, s20, 512
    s_add_u32 m0, s21, 16384
    s_nop 0
    buffer_load_dwordx4 v8, s[8:11], s20 offen lds
    s_add_u32 m0, s21, 17408
    s_nop 0
    buffer_load_dwordx4 v9, s[8:11], s20 offen lds
    s_add_u32 m0, s21, 18432
    s_nop 0
    buffer_load_dwordx4 v10, s[8:11], s20 offen lds
    s_add_u32 m0, s21, 19456
    s_nop 0
    buffer_load_dwordx4 v11, s[8:11], s20 offen lds
    s_add_u32 s20, s20, 512
    s_add_u32 m0, s21, 32768
    s_nop 0
    buffer_load_dwordx4 v8, s[8:11], s20 offen lds
    s_add_u32 m0, s21, 33792
    s_nop 0
    buffer_load_dwordx4 v9, s[8:11], s20 offen lds
    s_add_u32 m0, s21, 34816
    s_nop 0
    buffer_load_dwordx4 v10, s[8:11], s20 offen lds
    s_add_u32 m0, s21, 35840
    s_nop 0
    buffer_load_dwordx4 v11, s[8:11], s20 offen lds
    s_add_u32 s20, s20, 512
    s_add_u32 m0, s21, 49152
    s_nop 0
    buffer_load_dwordx4 v8, s[8:11], s20 offen lds
    s_add_u32 m0, s21, 50176
    s_nop 0
    buffer_load_dwordx4 v9, s[8:11], s20 offen lds
    s_add_u32 m0, s21, 51200
    s_nop 0
    buffer_load_dwordx4 v10, s[8:11], s20 offen lds
    s_add_u32 m0, s21, 52224
    s_nop 0
    buffer_load_dwordx4 v11, s[8:11], s20 offen lds
    s_add_u32 s24, s24, 1
    s_min_u32 s24, s24, 63
    s_lshl_b32 s53, s24, 16
    s_mov_b32 s20, s53
    s_add_u32 m0, s21, 65536
    s_nop 0
    buffer_load_dwordx4 v8, s[8:11], s20 offen lds
    s_add_u32 m0, s21, 66560
    s_nop 0
    buffer_load_dwordx4 v9, s[8:11], s20 offen lds
    s_add_u32 m0, s21, 67584
    s_nop 0
    buffer_load_dwordx4 v10, s[8:11], s20 offen lds
    s_add_u32 m0, s21, 68608
    s_nop 0
    buffer_load_dwordx4 v11, s[8:11], s20 offen lds
    s_add_u32 s20, s20, 512
    s_add_u32 m0, s21, 81920
    s_nop 0
    buffer_load_dwordx4 v8, s[8:11], s20 offen lds
    s_add_u32 m0, s21, 82944
    s_nop 0
    buffer_load_dwordx4 v9, s[8:11], s20 offen lds
    s_add_u32 m0, s21, 83968
    s_nop 0
    buffer_load_dwordx4 v10, s[8:11], s20 offen lds
    s_add_u32 m0, s21, 84992
    s_nop 0
    buffer_load_dwordx4 v11, s[8:11], s20 offen lds
    s_add_u32 s20, s20, 512
    s_add_u32 m0, s21, 98304
    s_nop 0
    buffer_load_dwordx4 v8, s[8:11], s20 offen lds
    s_waitcnt vmcnt(21)
    s_barrier
    ds_read_b128 v[20:23], v12 offset:0
    ds_read_b128 v[24:27], v12 offset:2048
    ds_read_b128 v[28:31], v13 offset:0
    ds_read_b128 v[32:35], v13 offset:2048
    ds_read_b128 v[36:39], v14 offset:0
    ds_read_b128 v[40:43], v14 offset:2048
    s_waitcnt lgkmcnt(4)
L_st_259:
    v_mfma_f32_16x16x32_bf16 v[52:55], v[20:23], a[0:3], 0
    ds_read_b128 v[44:47], v15 offset:0
    s_add_u32 m0, s21, 99328
    v_mfma_f32_16x16x32_bf16 v[56:59], v[20:23], a[4:7], 0
    buffer_load_dwordx4 v9, s[8:11], s20 offen lds
    v_mfma_f32_16x16x32_bf16 v[60:63], v[24:27], a[0:3], 0
    ds_read_b128 v[48:51], v15 offset:2048
    v_mfma_f32_16x16x32_bf16 v[64:67], v[24:27], a[4:7], 0
    s_waitcnt lgkmcnt(4)
    v_fmac_f32 v69, v88, v68
    v_fmac_f32 v73, v88, v72
    v_mfma_f32_16x16x32_bf16 v[52:55], v[28:31], a[8:11], v[52:55]
    ds_read_b128 v[20:23], v12 offset:256
    s_waitcnt lgkmcnt(7)
    v_mul_f32 v128, v90, v68
    v_mfma_f32_16x16x32_bf16 v[56:59], v[28:31], a[12:15], v[56:59]
    buffer_store_dwordx4 v[144:147], v86, s[12:15], s38 offen sc1
    v_mfma_f32_16x16x32_bf16 v[60:63], v[32:35], a[8:11], v[60:63]
    ds_read_b128 v[24:27], v12 offset:2304
    v_mul_f32 v136, v154, v72
    v_fmac_f32 v69, v152, v72
    v_mfma_f32_16x16x32_bf16 v[64:67], v[32:35], a[12:15], v[64:67]
    s_waitcnt lgkmcnt(4)
    v_fmac_f32 v73, v89, v68
    v_mfma_f32_16x16x32_bf16 v[52:55], v[36:39], a[16:19], v[52:55]
    ds_read_b128 v[28:31], v13 offset:256
    s_add_u32 m0, s21, 100352
    v_fmac_f32 v128, v155, v72
    v_mfma_f32_16x16x32_bf16 v[56:59], v[36:39], a[20:23], v[56:59]
    buffer_load_dwordx4 v10, s[8:11], s20 offen lds
    v_fmac_f32 v136, v155, v68
    v_mfma_f32_16x16x32_bf16 v[60:63], v[40:43], a[16:19], v[60:63]
    ds_read_b128 v[32:35], v13 offset:2304
    v_fmac_f32 v70, v88, v69
    v_mfma_f32_16x16x32_bf16 v[64:67], v[40:43], a[20:23], v[64:67]
    s_waitcnt lgkmcnt(4)
    v_fmac_f32 v74, v88, v73
    v_mul_f32 v129, v90, v69
    v_mfma_f32_16x16x32_bf16 v[52:55], v[44:47], a[24:27], v[52:55]
    ds_read_b128 v[36:39], v14 offset:256
    v_mul_f32 v137, v154, v73
    v_mfma_f32_16x16x32_bf16 v[56:59], v[44:47], a[28:31], v[56:59]
    buffer_store_dwordx4 v[148:151], v86, s[12:15], s43 offen sc1
    v_fmac_f32 v70, v152, v73
    v_mfma_f32_16x16x32_bf16 v[60:63], v[48:51], a[24:27], v[60:63]
    ds_read_b128 v[40:43], v14 offset:2304
    v_fmac_f32 v74, v89, v69
    v_mfma_f32_16x16x32_bf16 v[64:67], v[48:51], a[28:31], v[64:67]
    s_waitcnt lgkmcnt(4)
    v_fmac_f32 v129, v155, v73
    v_fmac_f32 v137, v155, v69
    v_mfma_f32_16x16x32_bf16 v[52:55], v[20:23], a[32:35], v[52:55]
    ds_read_b128 v[44:47], v15 offset:256
    s_add_u32 m0, s21, 101376
    v_fmac_f32 v71, v88, v70
    v_mfma_f32_16x16x32_bf16 v[56:59], v[20:23], a[36:39], v[56:59]
    buffer_load_dwordx4 v11, s[8:11], s20 offen lds
    v_mfma_f32_16x16x32_bf16 v[60:63], v[24:27], a[32:35], v[60:63]
    ds_read_b128 v[48:51], v15 offset:2304
    v_fmac_f32 v75, v88, v74
    v_mul_f32 v130, v90, v70
    v_mfma_f32_16x16x32_bf16 v[64:67], v[24:27], a[36:39], v[64:67]
    s_waitcnt lgkmcnt(4)
    v_mul_f32 v138, v154, v74
    v_mfma_f32_16x16x32_bf16 v[52:55], v[28:31], a[40:43], v[52:55]
    s_waitcnt vmcnt(20)
    s_barrier
    ds_read_b128 v[20:23], v12 offset:16384
    v_mfma_f32_16x16x32_bf16 v[56:59], v[28:31], a[44:47], v[56:59]
    s_add_u32 s20, s20, 512
    v_fmac_f32 v71, v152, v74
    v_fmac_f32 v75, v89, v70
    v_mfma_f32_16x16x32_bf16 v[60:63], v[32:35], a[40:43], v[60:63]
    ds_read_b128 v[24:27], v12 offset:18432
    v_fmac_f32 v130, v155, v74
    v_mfma_f32_16x16x32_bf16 v[64:67], v[32:35], a[44:47], v[64:67]
    s_waitcnt lgkmcnt(4)
    v_fmac_f32 v138, v155, v70
    v_fmac_f32 v76, v88, v71
    v_mfma_f32_16x16x32_bf16 v[52:55], v[36:39], a[48:51], v[52:55]
    ds_read_b128 v[28:31], v13 offset:16384
    s_add_u32 m0, s21, 114688
    v_mfma_f32_16x16x32_bf16 v[56:59], v[36:39], a[52:55], v[56:59]
    buffer_load_dwordx4 v8, s[8:11], s20 offen lds
    v_fmac_f32 v80, v88, v75
    v_mfma_f32_16x16x32_bf16 v[60:63], v[40:43], a[48:51], v[60:63]
    ds_read_b128 v[32:35], v13 offset:18432
    v_mul_f32 v131, v90, v71
    v_mul_f32 v139, v154, v75
    v_mfma_f32_16x16x32_bf16 v[64:67], v[40:43], a[52:55], v[64:67]
    s_waitcnt lgkmcnt(4)
    v_fmac_f32 v76, v152, v75
    v_mfma_f32_16x16x32_bf16 v[52:55], v[44:47], a[56:59], v[52:55]
    ds_read_b128 v[36:39], v14 offset:16384
    v_fmac_f32 v80, v89, v71
    v_fmac_f32 v131, v155, v75
    v_mfma_f32_16x16x32_bf16 v[56:59], v[44:47], a[60:63], v[56:59]
    v_fmac_f32 v139, v155, v71
    v_fmac_f32 v77, v88, v76
    v_mfma_f32_16x16x32_bf16 v[60:63], v[48:51], a[56:59], v[60:63]
    ds_read_b128 v[40:43], v14 offset:18432
    v_fmac_f32 v81, v88, v80
    v_mfma_f32_16x16x32_bf16 v[64:67], v[48:51], a[60:63], v[64:67]
    s_waitcnt lgkmcnt(4)
    v_mul_f32 v132, v90, v76
    v_mul_f32 v140, v154, v80
    v_mfma_f32_16x16x32_bf16 v[52:55], v[20:23], a[64:67], v[52:55]
    ds_read_b128 v[44:47], v15 offset:16384
    s_add_u32 m0, s21, 115712
    v_mfma_f32_16x16x32_bf16 v[56:59], v[20:23], a[68:71], v[56:59]
    buffer_load_dwordx4 v9, s[8:11], s20 offen lds
    v_fmac_f32 v77, v152, v80
    v_mfma_f32_16x16x32_bf16 v[60:63], v[24:27], a[64:67], v[60:63]
    ds_read_b128 v[48:51], v15 offset:18432
    v_fmac_f32 v81, v89, v76
    v_fmac_f32 v132, v155, v80
    v_mfma_f32_16x16x32_bf16 v[64:67], v[24:27], a[68:71], v[64:67]
    s_waitcnt lgkmcnt(4)
    v_fmac_f32 v140, v155, v76
    v_mfma_f32_16x16x32_bf16 v[52:55], v[28:31], a[72:75], v[52:55]
    ds_read_b128 v[20:23], v12 offset:16640
    v_fmac_f32 v78, v88, v77
    v_fmac_f32 v82, v88, v81
    v_mfma_f32_16x16x32_bf16 v[56:59], v[28:31], a[76:79], v[56:59]
    v_mul_f32 v133, v90, v77
    v_mul_f32 v141, v154, v81
    v_mfma_f32_16x16x32_bf16 v[60:63], v[32:35], a[72:75], v[60:63]
    ds_read_b128 v[24:27], v12 offset:18688
    s_add_u32 s24, s24, 1
    v_fmac_f32 v78, v152, v81
    v_mfma_f32_16x16x32_bf16 v[64:67], v[32:35], a[76:79], v[64:67]
    s_waitcnt lgkmcnt(4)
    v_fmac_f32 v82, v89, v77
    v_mfma_f32_16x16x32_bf16 v[52:55], v[36:39], a[80:83], v[52:55]
    ds_read_b128 v[28:31], v13 offset:16640
    s_add_u32 m0, s21, 116736
    v_fmac_f32 v133, v155, v81
    v_mfma_f32_16x16x32_bf16 v[56:59], v[36:39], a[84:87], v[56:59]
    buffer_load_dwordx4 v10, s[8:11], s20 offen lds
    v_mfma_f32_16x16x32_bf16 v[60:63], v[40:43], a[80:83], v[60:63]
    ds_read_b128 v[32:35], v13 offset:18688
    v_fmac_f32 v141, v155, v77
    v_fmac_f32 v79, v88, v78
    v_mfma_f32_16x16x32_bf16 v[64:67], v[40:43], a[84:87], v[64:67]
    s_waitcnt lgkmcnt(4)
    s_min_u32 s24, s24, 63
    v_fmac_f32 v83, v88, v82
    v_mfma_f32_16x16x32_bf16 v[52:55], v[44:47], a[88:91], v[52:55]
    ds_read_b128 v[36:39], v14 offset:16640
    v_mul_f32 v134, v90, v78
    v_mfma_f32_16x16x32_bf16 v[56:59], v[44:47], a[92:95], v[56:59]
    v_mul_f32 v142, v154, v82
    v_fmac_f32 v79, v152, v82
    v_mfma_f32_16x16x32_bf16 v[60:63], v[48:51], a[88:91], v[60:63]
    ds_read_b128 v[40:43], v14 offset:18688
    s_lshl_b32 s53, s24, 16
    v_fmac_f32 v83, v89, v78
    v_mfma_f32_16x16x32_bf16 v[64:67], v[48:51], a[92:95], v[64:67]
    s_waitcnt lgkmcnt(4)
    v_fmac_f32 v134, v155, v82
    v_fmac_f32 v142, v155, v78
    v_mfma_f32_16x16x32_bf16 v[52:55], v[20:23], a[96:99], v[52:55]
    ds_read_b128 v[44:47], v15 offset:16640
    s_add_u32 m0, s21, 117760
    v_mfma_f32_16x16x32_bf16 v[56:59], v[20:23], a[100:103], v[56:59]
    buffer_load_dwordx4 v11, s[8:11], s20 offen lds
    v_mov_b32 v102, v79
    v_mfma_f32_16x16x32_bf16 v[60:63], v[24:27], a[96:99], v[60:63]
    ds_read_b128 v[48:51], v15 offset:18688
    v_mov_b32 v103, v79
    v_mfma_f32_16x16x32_bf16 v[64:67], v[24:27], a[100:103], v[64:67]
    s_waitcnt lgkmcnt(4)
    v_mov_b32 v106, v83
    v_mov_b32 v107, v83
    v_mfma_f32_16x16x32_bf16 v[52:55], v[28:31], a[104:107], v[52:55]
    s_waitcnt vmcnt(20)
    s_barrier
    ds_read_b128 v[20:23], v12 offset:32768
    v_mfma_f32_16x16x32_bf16 v[56:59], v[28:31], a[108:111], v[56:59]
    s_mov_b32 s20, s53
    v_mul_f32 v135, v90, v79
    v_mfma_f32_16x16x32_bf16 v[60:63], v[32:35], a[104:107], v[60:63]
    ds_read_b128 v[24:27], v12 offset:34816
    v_mul_f32 v143, v154, v83
    v_permlane16_swap_b32 v102, v103
    v_mfma_f32_16x16x32_bf16 v[64:67], v[32:35], a[108:111], v[64:67]
    s_waitcnt lgkmcnt(4)
    v_permlane16_swap_b32 v106, v107
    v_mfma_f32_16x16x32_bf16 v[52:55], v[36:39], a[112:115], v[52:55]
    ds_read_b128 v[28:31], v13 offset:32768
    s_add_u32 m0, s21, 0
    v_mov_b32 v104, v102
    v_mfma_f32_16x16x32_bf16 v[56:59], v[36:39], a[116:119], v[56:59]
    buffer_load_dwordx4 v8, s[8:11], s20 offen lds
    v_mov_b32 v105, v103
    v_mfma_f32_16x16x32_bf16 v[60:63], v[40:43], a[112:115], v[60:63]
    ds_read_b128 v[32:35], v13 offset:34816
    v_mov_b32 v108, v106
    v_mfma_f32_16x16x32_bf16 v[64:67], v[40:43], a[116:119], v[64:67]
    s_waitcnt lgkmcnt(4)
    v_mov_b32 v109, v107
    v_fmac_f32 v135, v155, v83
    v_mfma_f32_16x16x32_bf16 v[52:55], v[44:47], a[120:123], v[52:55]
    ds_read_b128 v[36:39], v14 offset:32768
    v_fmac_f32 v143, v155, v79
    v_mfma_f32_16x16x32_bf16 v[56:59], v[44:47], a[124:127], v[56:59]
    v_permlane32_swap_b32 v102, v104
    v_permlane32_swap_b32 v103, v105
    v_mfma_f32_16x16x32_bf16 v[60:63], v[48:51], a[120:123], v[60:63]
    ds_read_b128 v[40:43], v14 offset:34816
    v_permlane32_swap_b32 v106, v108
    v_permlane32_swap_b32 v107, v109
    v_mfma_f32_16x16x32_bf16 v[64:67], v[48:51], a[124:127], v[64:67]
    s_waitcnt lgkmcnt(4)
    v_fmac_f32 v102, v92, v94
    v_mfma_f32_16x16x32_bf16 v[52:55], v[20:23], a[128:131], v[52:55]
    ds_read_b128 v[44:47], v15 offset:32768
    s_add_u32 m0, s21, 1024
    v_fmac_f32 v106, v92, v95
    v_mfma_f32_16x16x32_bf16 v[56:59], v[20:23], a[132:135], v[56:59]
    buffer_load_dwordx4 v9, s[8:11], s20 offen lds
    v_fmac_f32 v102, v153, v95
    v_mfma_f32_16x16x32_bf16 v[60:63], v[24:27], a[128:131], v[60:63]
    ds_read_b128 v[48:51], v15 offset:34816
    v_fmac_f32 v106, v93, v94
    v_mfma_f32_16x16x32_bf16 v[64:67], v[24:27], a[132:135], v[64:67]
    s_waitcnt lgkmcnt(4)
    v_cndmask_b32 v96, v94, v102, s[56:57]
    v_cndmask_b32 v97, v95, v106, s[56:57]
    v_mfma_f32_16x16x32_bf16 v[52:55], v[28:31], a[136:139], v[52:55]
    ds_read_b128 v[20:23], v12 offset:33024
    v_fmac_f32 v103, v92, v102
    v_mfma_f32_16x16x32_bf16 v[56:59], v[28:31], a[140:143], v[56:59]
    v_fmac_f32 v107, v92, v106
    v_fmac_f32 v103, v153, v106
    v_mfma_f32_16x16x32_bf16 v[60:63], v[32:35], a[136:139], v[60:63]
    ds_read_b128 v[24:27], v12 offset:35072
    v_fmac_f32 v107, v93, v102
    v_cndmask_b32 v96, v96, v103, s[58:59]
    v_mfma_f32_16x16x32_bf16 v[64:67], v[32:35], a[140:143], v[64:67]
    s_waitcnt lgkmcnt(4)
    v_cndmask_b32 v97, v97, v107, s[58:59]
    v_mfma_f32_16x16x32_bf16 v[52:55], v[36:39], a[144:147], v[52:55]
    ds_read_b128 v[28:31], v13 offset:33024
    s_add_u32 m0, s21, 2048
    v_fmac_f32 v104, v92, v103
    v_mfma_f32_16x16x32_bf16 v[56:59], v[36:39], a[148:151], v[56:59]
    buffer_load_dwordx4 v10, s[8:11], s20 offen lds
    v_fmac_f32 v108, v92, v107
    v_mfma_f32_16x16x32_bf16 v[60:63], v[40:43], a[144:147], v[60:63]
    ds_read_b128 v[32:35], v13 offset:35072
    v_fmac_f32 v104, v153, v107
    v_mfma_f32_16x16x32_bf16 v[64:67], v[40:43], a[148:151], v[64:67]
    s_waitcnt lgkmcnt(4)
    v_fmac_f32 v108, v93, v103
    v_cndmask_b32 v96, v96, v104, s[60:61]
    v_mfma_f32_16x16x32_bf16 v[52:55], v[44:47], a[152:155], v[52:55]
    ds_read_b128 v[36:39], v14 offset:33024
    v_cndmask_b32 v97, v97, v108, s[60:61]
    v_mfma_f32_16x16x32_bf16 v[56:59], v[44:47], a[156:159], v[56:59]
    v_fmac_f32 v105, v92, v104
    v_fmac_f32 v109, v92, v108
    v_mfma_f32_16x16x32_bf16 v[60:63], v[48:51], a[152:155], v[60:63]
    ds_read_b128 v[40:43], v14 offset:35072
    v_fmac_f32 v105, v153, v108
    v_fmac_f32 v109, v93, v104
    v_mfma_f32_16x16x32_bf16 v[64:67], v[48:51], a[156:159], v[64:67]
    s_waitcnt lgkmcnt(4)
    v_xor_b32 v98, 0x80000000, v96
    v_mfma_f32_16x16x32_bf16 v[52:55], v[20:23], a[160:163], v[52:55]
    ds_read_b128 v[44:47], v15 offset:33024
    s_add_u32 m0, s21, 3072
    v_xor_b32 v99, 0x80000000, v97
    v_mfma_f32_16x16x32_bf16 v[56:59], v[20:23], a[164:167], v[56:59]
    buffer_load_dwordx4 v11, s[8:11], s20 offen lds
    v_mov_b32 v94, v105
    v_mfma_f32_16x16x32_bf16 v[60:63], v[24:27], a[160:163], v[60:63]
    ds_read_b128 v[48:51], v15 offset:35072
    v_mov_b32 v95, v109
    v_mfma_f32_16x16x32_bf16 v[64:67], v[24:27], a[164:167], v[64:67]
    s_waitcnt lgkmcnt(4)
    v_fmac_f32 v128, v156, v96
    v_fmac_f32 v136, v156, v99
    v_mfma_f32_16x16x32_bf16 v[52:55], v[28:31], a[168:171], v[52:55]
    s_waitcnt vmcnt(9)
    s_barrier
    ds_read_b128 v[20:23], v12 offset:49152
    v_mfma_f32_16x16x32_bf16 v[56:59], v[28:31], a[172:175], v[56:59]
    s_add_u32 s20, s20, 512
    buffer_atomic_add v84, v85, s[12:15], s39 offen sc1
    v_mfma_f32_16x16x32_bf16 v[60:63], v[32:35], a[168:171], v[60:63]
    ds_read_b128 v[24:27], v12 offset:51200
    v_fmac_f32 v128, v157, v99
    v_mfma_f32_16x16x32_bf16 v[64:67], v[32:35], a[172:175], v[64:67]
    s_waitcnt lgkmcnt(4)
    v_fmac_f32 v136, v157, v98
    v_fmac_f32 v129, v158, v96
    v_mfma_f32_16x16x32_bf16 v[52:55], v[36:39], a[176:179], v[52:55]
    ds_read_b128 v[28:31], v13 offset:49152
    s_add_u32 m0, s21, 16384
    v_mfma_f32_16x16x32_bf16 v[56:59], v[36:39], a[180:183], v[56:59]
    buffer_load_dwordx4 v8, s[8:11], s20 offen lds
    v_fmac_f32 v137, v158, v99
    v_mfma_f32_16x16x32_bf16 v[60:63], v[40:43], a[176:179], v[60:63]
    ds_read_b128 v[32:35], v13 offset:51200
    v_fmac_f32 v129, v159, v99
    v_fmac_f32 v137, v159, v98
    v_mfma_f32_16x16x32_bf16 v[64:67], v[40:43], a[180:183], v[64:67]
    s_waitcnt lgkmcnt(4)
    v_cvt_pk_bf16_f32 v120, v128, v129
    v_mfma_f32_16x16x32_bf16 v[52:55], v[44:47], a[184:187], v[52:55]
    ds_read_b128 v[36:39], v14 offset:49152
    v_cvt_pk_bf16_f32 v124, v136, v137
    v_fmac_f32 v130, v160, v96
    v_mfma_f32_16x16x32_bf16 v[56:59], v[44:47], a[188:191], v[56:59]
    v_fmac_f32 v138, v160, v99
    v_fmac_f32 v130, v161, v99
    v_mfma_f32_16x16x32_bf16 v[60:63], v[48:51], a[184:187], v[60:63]
    ds_read_b128 v[40:43], v14 offset:51200
    v_fmac_f32 v138, v161, v98
    v_mfma_f32_16x16x32_bf16 v[64:67], v[48:51], a[188:191], v[64:67]
    s_waitcnt lgkmcnt(4)
    v_fmac_f32 v131, v162, v96
    v_fmac_f32 v139, v162, v99
    v_mfma_f32_16x16x32_bf16 v[52:55], v[20:23], a[192:195], v[52:55]
    ds_read_b128 v[44:47], v15 offset:49152
    s_add_u32 m0, s21, 17408
    v_mfma_f32_16x16x32_bf16 v[56:59], v[20:23], a[196:199], v[56:59]
    buffer_load_dwordx4 v9, s[8:11], s20 offen lds
    v_fmac_f32 v131, v163, v99
    v_mfma_f32_16x16x32_bf16 v[60:63], v[24:27], a[192:195], v[60:63]
    ds_read_b128 v[48:51], v15 offset:51200
    v_fmac_f32 v139, v163, v98
    v_cvt_pk_bf16_f32 v121, v130, v131
    v_mfma_f32_16x16x32_bf16 v[64:67], v[24:27], a[196:199], v[64:67]
    s_waitcnt lgkmcnt(4)
    v_cvt_pk_bf16_f32 v125, v138, v139
    v_mfma_f32_16x16x32_bf16 v[52:55], v[28:31], a[200:203], v[52:55]
    ds_read_b128 v[20:23], v12 offset:49408
    v_fmac_f32 v132, v164, v96
    v_fmac_f32 v140, v164, v99
    v_mfma_f32_16x16x32_bf16 v[56:59], v[28:31], a[204:207], v[56:59]
    v_fmac_f32 v132, v165, v99
    v_fmac_f32 v140, v165, v98
    v_mfma_f32_16x16x32_bf16 v[60:63], v[32:35], a[200:203], v[60:63]
    ds_read_b128 v[24:27], v12 offset:51456
    v_fmac_f32 v133, v166, v96
    v_mfma_f32_16x16x32_bf16 v[64:67], v[32:35], a[204:207], v[64:67]
    s_waitcnt lgkmcnt(4)
    v_fmac_f32 v141, v166, v99
    v_fmac_f32 v133, v167, v99
    v_mfma_f32_16x16x32_bf16 v[52:55], v[36:39], a[208:211], v[52:55]
    ds_read_b128 v[28:31], v13 offset:49408
    s_add_u32 m0, s21, 18432
    v_mfma_f32_16x16x32_bf16 v[56:59], v[36:39], a[212:215], v[56:59]
    buffer_load_dwordx4 v10, s[8:11], s20 offen lds
    v_fmac_f32 v141, v167, v98
    v_mfma_f32_16x16x32_bf16 v[60:63], v[40:43], a[208:211], v[60:63]
    ds_read_b128 v[32:35], v13 offset:51456
    v_cvt_pk_bf16_f32 v122, v132, v133
    v_cvt_pk_bf16_f32 v126, v140, v141
    v_mfma_f32_16x16x32_bf16 v[64:67], v[40:43], a[212:215], v[64:67]
    s_waitcnt lgkmcnt(4)
    v_fmac_f32 v134, v168, v96
    v_mfma_f32_16x16x32_bf16 v[52:55], v[44:47], a[216:219], v[52:55]
    ds_read_b128 v[36:39], v14 offset:49408
    v_fmac_f32 v142, v168, v99
    v_fmac_f32 v134, v169, v99
    v_mfma_f32_16x16x32_bf16 v[56:59], v[44:47], a[220:223], v[56:59]
    v_fmac_f32 v142, v169, v98
    v_fmac_f32 v135, v170, v96
    v_mfma_f32_16x16x32_bf16 v[60:63], v[48:51], a[216:219], v[60:63]
    ds_read_b128 v[40:43], v14 offset:51456
    v_fmac_f32 v143, v170, v99
    v_mfma_f32_16x16x32_bf16 v[64:67], v[48:51], a[220:223], v[64:67]
    s_waitcnt lgkmcnt(4)
    v_fmac_f32 v135, v171, v99
    v_fmac_f32 v143, v171, v98
    v_mfma_f32_16x16x32_bf16 v[52:55], v[20:23], a[224:227], v[52:55]
    ds_read_b128 v[44:47], v15 offset:49408
    s_add_u32 m0, s21, 19456
    v_mfma_f32_16x16x32_bf16 v[56:59], v[20:23], a[228:231], v[56:59]
    buffer_load_dwordx4 v11, s[8:11], s20 offen lds
    v_cvt_pk_bf16_f32 v123, v134, v135
    v_mfma_f32_16x16x32_bf16 v[60:63], v[24:27], a[224:227], v[60:63]
    ds_read_b128 v[48:51], v15 offset:51456
    v_cvt_pk_bf16_f32 v127, v142, v143
    ds_write_b128 v116, v[120:123] offset:0
    v_mfma_f32_16x16x32_bf16 v[64:67], v[24:27], a[228:231], v[64:67]
    s_waitcnt lgkmcnt(4)
    ds_write_b128 v116, v[124:127] offset:1024
    v_mfma_f32_16x16x32_bf16 v[52:55], v[28:31], a[232:235], v[52:55]
    s_waitcnt vmcnt(20)
    s_barrier
    ds_read_b128 v[20:23], v16 offset:0
    v_mfma_f32_16x16x32_bf16 v[56:59], v[28:31], a[236:239], v[56:59]
    s_add_u32 s20, s20, 512
    ds_read_b64_tr_b16 v[144:145], v117 offset:0
    ds_read_b64_tr_b16 v[146:147], v118 offset:256
    v_mfma_f32_16x16x32_bf16 v[60:63], v[32:35], a[232:235], v[60:63]
    ds_read_b128 v[24:27], v16 offset:2048
    ds_read_b64_tr_b16 v[148:149], v117 offset:1024
    v_mfma_f32_16x16x32_bf16 v[64:67], v[32:35], a[236:239], v[64:67]
    s_waitcnt lgkmcnt(4)
    ds_read_b64_tr_b16 v[150:151], v118 offset:1280
    v_mfma_f32_16x16x32_bf16 v[52:55], v[36:39], a[240:243], v[52:55]
    ds_read_b128 v[28:31], v17 offset:0
    s_add_u32 m0, s21, 32768
    s_sub_u32 s39, s22, 1
    v_mfma_f32_16x16x32_bf16 v[56:59], v[36:39], a[244:247], v[56:59]
    buffer_load_dwordx4 v8, s[8:11], s20 offen lds
    s_lshl_b32 s38, s39, 17
    v_mfma_f32_16x16x32_bf16 v[60:63], v[40:43], a[240:243], v[60:63]
    ds_read_b128 v[32:35], v17 offset:2048
    s_add_u32 s38, s38, 0x4400000
    v_mfma_f32_16x16x32_bf16 v[64:67], v[40:43], a[244:247], v[64:67]
    s_waitcnt lgkmcnt(4)
    s_add_u32 s43, s38, 0x10000
    s_lshl_b32 s39, s39, 7
    v_mfma_f32_16x16x32_bf16 v[52:55], v[44:47], a[248:251], v[52:55]
    ds_read_b128 v[36:39], v18 offset:0
    s_add_u32 s39, s39, 0x5902000
    v_mfma_f32_16x16x32_bf16 v[56:59], v[44:47], a[252:255], v[56:59]
    s_cmp_eq_u32 s37, 0
    s_cselect_b32 s38, 0x7ff00000, s38
    s_cselect_b32 s39, 0x7ff00000, s39
    s_cselect_b32 s43, 0x7ff00000, s43
    v_mfma_f32_16x16x32_bf16 v[60:63], v[48:51], a[248:251], v[60:63]
    ds_read_b128 v[40:43], v18 offset:2048
    v_mfma_f32_16x16x32_bf16 v[64:67], v[48:51], a[252:255], v[64:67]
    s_waitcnt lgkmcnt(4)
    s_mov_b32 s37, 1
    s_add_u32 s22, s22, 1
    s_cmp_ge_u32 s22, s23
    s_cbranch_scc1 L_fl0_256
    v_mfma_f32_16x16x32_bf16 v[68:71], v[20:23], a[0:3], 0
    ds_read_b128 v[44:47], v19 offset:0
    s_add_u32 m0, s21, 33792
    v_mfma_f32_16x16x32_bf16 v[72:75], v[20:23], a[4:7], 0
    buffer_load_dwordx4 v9, s[8:11], s20 offen lds
    v_mfma_f32_16x16x32_bf16 v[76:79], v[24:27], a[0:3], 0
    ds_read_b128 v[48:51], v19 offset:2048
    v_mfma_f32_16x16x32_bf16 v[80:83], v[24:27], a[4:7], 0
    s_waitcnt lgkmcnt(4)
    v_fmac_f32 v53, v88, v52
    v_fmac_f32 v57, v88, v56
    v_mfma_f32_16x16x32_bf16 v[68:71], v[28:31], a[8:11], v[68:71]
    ds_read_b128 v[20:23], v16 offset:256
    s_waitcnt lgkmcnt(7)
    v_mul_f32 v128, v90, v52
    v_mfma_f32_16x16x32_bf16 v[72:75], v[28:31], a[12:15], v[72:75]
    buffer_store_dwordx4 v[144:147], v86, s[12:15], s38 offen sc1
    v_mfma_f32_16x16x32_bf16 v[76:79], v[32:35], a[8:11], v[76:79]
    ds_read_b128 v[24:27], v16 offset:2304
    v_mul_f32 v136, v154, v56
    v_fmac_f32 v53, v152, v56
    v_mfma_f32_16x16x32_bf16 v[80:83], v[32:35], a[12:15], v[80:83]
    s_waitcnt lgkmcnt(4)
    v_fmac_f32 v57, v89, v52
    v_mfma_f32_16x16x32_bf16 v[68:71], v[36:39], a[16:19], v[68:71]
    ds_read_b128 v[28:31], v17 offset:256
    s_add_u32 m0, s21, 34816
    v_fmac_f32 v128, v155, v56
    v_mfma_f32_16x16x32_bf16 v[72:75], v[36:39], a[20:23], v[72:75]
    buffer_load_dwordx4 v10, s[8:11], s20 offen lds
    v_fmac_f32 v136, v155, v52
    v_mfma_f32_16x16x32_bf16 v[76:79], v[40:43], a[16:19], v[76:79]
    ds_read_b128 v[32:35], v17 offset:2304
    v_fmac_f32 v54, v88, v53
    v_mfma_f32_16x16x32_bf16 v[80:83], v[40:43], a[20:23], v[80:83]
    s_waitcnt lgkmcnt(4)
    v_fmac_f32 v58, v88, v57
    v_mul_f32 v129, v90, v53
    v_mfma_f32_16x16x32_bf16 v[68:71], v[44:47], a[24:27], v[68:71]
    ds_read_b128 v[36:39], v18 offset:256
    v_mul_f32 v137, v154, v57
    v_mfma_f32_16x16x32_bf16 v[72:75], v[44:47], a[28:31], v[72:75]
    buffer_store_dwordx4 v[148:151], v86, s[12:15], s43 offen sc1
    v_fmac_f32 v54, v152, v57
    v_mfma_f32_16x16x32_bf16 v[76:79], v[48:51], a[24:27], v[76:79]
    ds_read_b128 v[40:43], v18 offset:2304
    v_fmac_f32 v58, v89, v53
    v_mfma_f32_16x16x32_bf16 v[80:83], v[48:51], a[28:31], v[80:83]
    s_waitcnt lgkmcnt(4)
    v_fmac_f32 v129, v155, v57
    v_fmac_f32 v137, v155, v53
    v_mfma_f32_16x16x32_bf16 v[68:71], v[20:23], a[32:35], v[68:71]
    ds_read_b128 v[44:47], v19 offset:256
    s_add_u32 m0, s21, 35840
    v_fmac_f32 v55, v88, v54
    v_mfma_f32_16x16x32_bf16 v[72:75], v[20:23], a[36:39], v[72:75]
    buffer_load_dwordx4 v11, s[8:11], s20 offen lds
    v_mfma_f32_16x16x32_bf16 v[76:79], v[24:27], a[32:35], v[76:79]
    ds_read_b128 v[48:51], v19 offset:2304
    v_fmac_f32 v59, v88, v58
    v_mul_f32 v130, v90, v54
    v_mfma_f32_16x16x32_bf16 v[80:83], v[24:27], a[36:39], v[80:83]
    s_waitcnt lgkmcnt(4)
    v_mul_f32 v138, v154, v58
    v_mfma_f32_16x16x32_bf16 v[68:71], v[28:31], a[40:43], v[68:71]
    s_waitcnt vmcnt(20)
    s_barrier
    ds_read_b128 v[20:23], v16 offset:16384
    v_mfma_f32_16x16x32_bf16 v[72:75], v[28:31], a[44:47], v[72:75]
    s_add_u32 s20, s20, 512
    v_fmac_f32 v55, v152, v58
    v_fmac_f32 v59, v89, v54
    v_mfma_f32_16x16x32_bf16 v[76:79], v[32:35], a[40:43], v[76:79]
    ds_read_b128 v[24:27], v16 offset:18432
    v_fmac_f32 v130, v155, v58
    v_mfma_f32_16x16x32_bf16 v[80:83], v[32:35], a[44:47], v[80:83]
    s_waitcnt lgkmcnt(4)
    v_fmac_f32 v138, v155, v54
    v_fmac_f32 v60, v88, v55
    v_mfma_f32_16x16x32_bf16 v[68:71], v[36:39], a[48:51], v[68:71]
    ds_read_b128 v[28:31], v17 offset:16384
    s_add_u32 m0, s21, 49152
    v_mfma_f32_16x16x32_bf16 v[72:75], v[36:39], a[52:55], v[72:75]
    buffer_load_dwordx4 v8, s[8:11], s20 offen lds
    v_fmac_f32 v64, v88, v59
    v_mfma_f32_16x16x32_bf16 v[76:79], v[40:43], a[48:51], v[76:79]
    ds_read_b128 v[32:35], v17 offset:18432
    v_mul_f32 v131, v90, v55
    v_mul_f32 v139, v154, v59
    v_mfma_f32_16x16x32_bf16 v[80:83], v[40:43], a[52:55], v[80:83]
    s_waitcnt lgkmcnt(4)
    v_fmac_f32 v60, v152, v59
    v_mfma_f32_16x16x32_bf16 v[68:71], v[44:47], a[56:59], v[68:71]
    ds_read_b128 v[36:39], v18 offset:16384
    v_fmac_f32 v64, v89, v55
    v_fmac_f32 v131, v155, v59
    v_mfma_f32_16x16x32_bf16 v[72:75], v[44:47], a[60:63], v[72:75]
    v_fmac_f32 v139, v155, v55
    v_fmac_f32 v61, v88, v60
    v_mfma_f32_16x16x32_bf16 v[76:79], v[48:51], a[56:59], v[76:79]
    ds_read_b128 v[40:43], v18 offset:18432
    v_fmac_f32 v65, v88, v64
    v_mfma_f32_16x16x32_bf16 v[80:83], v[48:51], a[60:63], v[80:83]
    s_waitcnt lgkmcnt(4)
    v_mul_f32 v132, v90, v60
    v_mul_f32 v140, v154, v64
    v_mfma_f32_16x16x32_bf16 v[68:71], v[20:23], a[64:67], v[68:71]
    ds_read_b128 v[44:47], v19 offset:16384
    s_add_u32 m0, s21, 50176
    v_mfma_f32_16x16x32_bf16 v[72:75], v[20:23], a[68:71], v[72:75]
    buffer_load_dwordx4 v9, s[8:11], s20 offen lds
    v_fmac_f32 v61, v152, v64
    v_mfma_f32_16x16x32_bf16 v[76:79], v[24:27], a[64:67], v[76:79]
    ds_read_b128 v[48:51], v19 offset:18432
    v_fmac_f32 v65, v89, v60
    v_fmac_f32 v132, v155, v64
    v_mfma_f32_16x16x32_bf16 v[80:83], v[24:27], a[68:71], v[80:83]
    s_waitcnt lgkmcnt(4)
    v_fmac_f32 v140, v155, v60
    v_mfma_f32_16x16x32_bf16 v[68:71], v[28:31], a[72:75], v[68:71]
    ds_read_b128 v[20:23], v16 offset:16640
    v_fmac_f32 v62, v88, v61
    v_fmac_f32 v66, v88, v65
    v_mfma_f32_16x16x32_bf16 v[72:75], v[28:31], a[76:79], v[72:75]
    v_mul_f32 v133, v90, v61
    v_mul_f32 v141, v154, v65
    v_mfma_f32_16x16x32_bf16 v[76:79], v[32:35], a[72:75], v[76:79]
    ds_read_b128 v[24:27], v16 offset:18688
    s_add_u32 s24, s24, 1
    v_fmac_f32 v62, v152, v65
    v_mfma_f32_16x16x32_bf16 v[80:83], v[32:35], a[76:79], v[80:83]
    s_waitcnt lgkmcnt(4)
    v_fmac_f32 v66, v89, v61
    v_mfma_f32_16x16x32_bf16 v[68:71], v[36:39], a[80:83], v[68:71]
    ds_read_b128 v[28:31], v17 offset:16640
    s_add_u32 m0, s21, 51200
    v_fmac_f32 v133, v155, v65
    v_mfma_f32_16x16x32_bf16 v[72:75], v[36:39], a[84:87], v[72:75]
    buffer_load_dwordx4 v10, s[8:11], s20 offen lds
    v_mfma_f32_16x16x32_bf16 v[76:79], v[40:43], a[80:83], v[76:79]
    ds_read_b128 v[32:35], v17 offset:18688
    v_fmac_f32 v141, v155, v61
    v_fmac_f32 v63, v88, v62
    v_mfma_f32_16x16x32_bf16 v[80:83], v[40:43], a[84:87], v[80:83]
    s_waitcnt lgkmcnt(4)
    s_min_u32 s24, s24, 63
    v_fmac_f32 v67, v88, v66
    v_mfma_f32_16x16x32_bf16 v[68:71], v[44:47], a[88:91], v[68:71]
    ds_read_b128 v[36:39], v18 offset:16640
    v_mul_f32 v134, v90, v62
    v_mfma_f32_16x16x32_bf16 v[72:75], v[44:47], a[92:95], v[72:75]
    v_mul_f32 v142, v154, v66
    v_fmac_f32 v63, v152, v66
    v_mfma_f32_16x16x32_bf16 v[76:79], v[48:51], a[88:91], v[76:79]
    ds_read_b128 v[40:43], v18 offset:18688
    s_lshl_b32 s53, s24, 16
    v_fmac_f32 v67, v89, v62
    v_mfma_f32_16x16x32_bf16 v[80:83], v[48:51], a[92:95], v[80:83]
    s_waitcnt lgkmcnt(4)
    v_fmac_f32 v134, v155, v66
    v_fmac_f32 v142, v155, v62
    v_mfma_f32_16x16x32_bf16 v[68:71], v[20:23], a[96:99], v[68:71]
    ds_read_b128 v[44:47], v19 offset:16640
    s_add_u32 m0, s21, 52224
    v_mfma_f32_16x16x32_bf16 v[72:75], v[20:23], a[100:103], v[72:75]
    buffer_load_dwordx4 v11, s[8:11], s20 offen lds
    v_mov_b32 v102, v63
    v_mfma_f32_16x16x32_bf16 v[76:79], v[24:27], a[96:99], v[76:79]
    ds_read_b128 v[48:51], v19 offset:18688
    v_mov_b32 v103, v63
    v_mfma_f32_16x16x32_bf16 v[80:83], v[24:27], a[100:103], v[80:83]
    s_waitcnt lgkmcnt(4)
    v_mov_b32 v106, v67
    v_mov_b32 v107, v67
    v_mfma_f32_16x16x32_bf16 v[68:71], v[28:31], a[104:107], v[68:71]
    s_waitcnt vmcnt(20)
    s_barrier
    ds_read_b128 v[20:23], v16 offset:32768
    v_mfma_f32_16x16x32_bf16 v[72:75], v[28:31], a[108:111], v[72:75]
    s_mov_b32 s20, s53
    v_mul_f32 v135, v90, v63
    v_mfma_f32_16x16x32_bf16 v[76:79], v[32:35], a[104:107], v[76:79]
    ds_read_b128 v[24:27], v16 offset:34816
    v_mul_f32 v143, v154, v67
    v_permlane16_swap_b32 v102, v103
    v_mfma_f32_16x16x32_bf16 v[80:83], v[32:35], a[108:111], v[80:83]
    s_waitcnt lgkmcnt(4)
    v_permlane16_swap_b32 v106, v107
    v_mfma_f32_16x16x32_bf16 v[68:71], v[36:39], a[112:115], v[68:71]
    ds_read_b128 v[28:31], v17 offset:32768
    s_add_u32 m0, s21, 65536
    v_mov_b32 v104, v102
    v_mfma_f32_16x16x32_bf16 v[72:75], v[36:39], a[116:119], v[72:75]
    buffer_load_dwordx4 v8, s[8:11], s20 offen lds
    v_mov_b32 v105, v103
    v_mfma_f32_16x16x32_bf16 v[76:79], v[40:43], a[112:115], v[76:79]
    ds_read_b128 v[32:35], v17 offset:34816
    v_mov_b32 v108, v106
    v_mfma_f32_16x16x32_bf16 v[80:83], v[40:43], a[116:119], v[80:83]
    s_waitcnt lgkmcnt(4)
    v_mov_b32 v109, v107
    v_fmac_f32 v135, v155, v67
    v_mfma_f32_16x16x32_bf16 v[68:71], v[44:47], a[120:123], v[68:71]
    ds_read_b128 v[36:39], v18 offset:32768
    v_fmac_f32 v143, v155, v63
    v_mfma_f32_16x16x32_bf16 v[72:75], v[44:47], a[124:127], v[72:75]
    v_permlane32_swap_b32 v102, v104
    v_permlane32_swap_b32 v103, v105
    v_mfma_f32_16x16x32_bf16 v[76:79], v[48:51], a[120:123], v[76:79]
    ds_read_b128 v[40:43], v18 offset:34816
    v_permlane32_swap_b32 v106, v108
    v_permlane32_swap_b32 v107, v109
    v_mfma_f32_16x16x32_bf16 v[80:83], v[48:51], a[124:127], v[80:83]
    s_waitcnt lgkmcnt(4)
    v_fmac_f32 v102, v92, v94
    v_mfma_f32_16x16x32_bf16 v[68:71], v[20:23], a[128:131], v[68:71]
    ds_read_b128 v[44:47], v19 offset:32768
    s_add_u32 m0, s21, 66560
    v_fmac_f32 v106, v92, v95
    v_mfma_f32_16x16x32_bf16 v[72:75], v[20:23], a[132:135], v[72:75]
    buffer_load_dwordx4 v9, s[8:11], s20 offen lds
    v_fmac_f32 v102, v153, v95
    v_mfma_f32_16x16x32_bf16 v[76:79], v[24:27], a[128:131], v[76:79]
    ds_read_b128 v[48:51], v19 offset:34816
    v_fmac_f32 v106, v93, v94
    v_mfma_f32_16x16x32_bf16 v[80:83], v[24:27], a[132:135], v[80:83]
    s_waitcnt lgkmcnt(4)
    v_cndmask_b32 v96, v94, v102, s[56:57]
    v_cndmask_b32 v97, v95, v106, s[56:57]
    v_mfma_f32_16x16x32_bf16 v[68:71], v[28:31], a[136:139], v[68:71]
    ds_read_b128 v[20:23], v16 offset:33024
    v_fmac_f32 v103, v92, v102
    v_mfma_f32_16x16x32_bf16 v[72:75], v[28:31], a[140:143], v[72:75]
    v_fmac_f32 v107, v92, v106
    v_fmac_f32 v103, v153, v106
    v_mfma_f32_16x16x32_bf16 v[76:79], v[32:35], a[136:139], v[76:79]
    ds_read_b128 v[24:27], v16 offset:35072
    v_fmac_f32 v107, v93, v102
    v_cndmask_b32 v96, v96, v103, s[58:59]
    v_mfma_f32_16x16x32_bf16 v[80:83], v[32:35], a[140:143], v[80:83]
    s_waitcnt lgkmcnt(4)
    v_cndmask_b32 v97, v97, v107, s[58:59]
    v_mfma_f32_16x16x32_bf16 v[68:71], v[36:39], a[144:147], v[68:71]
    ds_read_b128 v[28:31], v17 offset:33024
    s_add_u32 m0, s21, 67584
    v_fmac_f32 v104, v92, v103
    v_mfma_f32_16x16x32_bf16 v[72:75], v[36:39], a[148:151], v[72:75]
    buffer_load_dwordx4 v10, s[8:11], s20 offen lds
    v_fmac_f32 v108, v92, v107
    v_mfma_f32_16x16x32_bf16 v[76:79], v[40:43], a[144:147], v[76:79]
    ds_read_b128 v[32:35], v17 offset:35072
    v_fmac_f32 v104, v153, v107
    v_mfma_f32_16x16x32_bf16 v[80:83], v[40:43], a[148:151], v[80:83]
    s_waitcnt lgkmcnt(4)
    v_fmac_f32 v108, v93, v103
    v_cndmask_b32 v96, v96, v104, s[60:61]
    v_mfma_f32_16x16x32_bf16 v[68:71], v[44:47], a[152:155], v[68:71]
    ds_read_b128 v[36:39], v18 offset:33024
    v_cndmask_b32 v97, v97, v108, s[60:61]
    v_mfma_f32_16x16x32_bf16 v[72:75], v[44:47], a[156:159], v[72:75]
    v_fmac_f32 v105, v92, v104
    v_fmac_f32 v109, v92, v108
    v_mfma_f32_16x16x32_bf16 v[76:79], v[48:51], a[152:155], v[76:79]
    ds_read_b128 v[40:43], v18 offset:35072
    v_fmac_f32 v105, v153, v108
    v_fmac_f32 v109, v93, v104
    v_mfma_f32_16x16x32_bf16 v[80:83], v[48:51], a[156:159], v[80:83]
    s_waitcnt lgkmcnt(4)
    v_xor_b32 v98, 0x80000000, v96
    v_mfma_f32_16x16x32_bf16 v[68:71], v[20:23], a[160:163], v[68:71]
    ds_read_b128 v[44:47], v19 offset:33024
    s_add_u32 m0, s21, 68608
    v_xor_b32 v99, 0x80000000, v97
    v_mfma_f32_16x16x32_bf16 v[72:75], v[20:23], a[164:167], v[72:75]
    buffer_load_dwordx4 v11, s[8:11], s20 offen lds
    v_mov_b32 v94, v105
    v_mfma_f32_16x16x32_bf16 v[76:79], v[24:27], a[160:163], v[76:79]
    ds_read_b128 v[48:51], v19 offset:35072
    v_mov_b32 v95, v109
    v_mfma_f32_16x16x32_bf16 v[80:83], v[24:27], a[164:167], v[80:83]
    s_waitcnt lgkmcnt(4)
    v_fmac_f32 v128, v156, v96
    v_fmac_f32 v136, v156, v99
    v_mfma_f32_16x16x32_bf16 v[68:71], v[28:31], a[168:171], v[68:71]
    s_waitcnt vmcnt(9)
    s_barrier
    ds_read_b128 v[20:23], v16 offset:49152
    v_mfma_f32_16x16x32_bf16 v[72:75], v[28:31], a[172:175], v[72:75]
    s_add_u32 s20, s20, 512
    buffer_atomic_add v84, v85, s[12:15], s39 offen sc1
    v_mfma_f32_16x16x32_bf16 v[76:79], v[32:35], a[168:171], v[76:79]
    ds_read_b128 v[24:27], v16 offset:51200
    v_fmac_f32 v128, v157, v99
    v_mfma_f32_16x16x32_bf16 v[80:83], v[32:35], a[172:175], v[80:83]
    s_waitcnt lgkmcnt(4)
    v_fmac_f32 v136, v157, v98
    v_fmac_f32 v129, v158, v96
    v_mfma_f32_16x16x32_bf16 v[68:71], v[36:39], a[176:179], v[68:71]
    ds_read_b128 v[28:31], v17 offset:49152
    s_add_u32 m0, s21, 81920
    v_mfma_f32_16x16x32_bf16 v[72:75], v[36:39], a[180:183], v[72:75]
    buffer_load_dwordx4 v8, s[8:11], s20 offen lds
    v_fmac_f32 v137, v158, v99
    v_mfma_f32_16x16x32_bf16 v[76:79], v[40:43], a[176:179], v[76:79]
    ds_read_b128 v[32:35], v17 offset:51200
    v_fmac_f32 v129, v159, v99
    v_fmac_f32 v137, v159, v98
    v_mfma_f32_16x16x32_bf16 v[80:83], v[40:43], a[180:183], v[80:83]
    s_waitcnt lgkmcnt(4)
    v_cvt_pk_bf16_f32 v120, v128, v129
    v_mfma_f32_16x16x32_bf16 v[68:71], v[44:47], a[184:187], v[68:71]
    ds_read_b128 v[36:39], v18 offset:49152
    v_cvt_pk_bf16_f32 v124, v136, v137
    v_fmac_f32 v130, v160, v96
    v_mfma_f32_16x16x32_bf16 v[72:75], v[44:47], a[188:191], v[72:75]
    v_fmac_f32 v138, v160, v99
    v_fmac_f32 v130, v161, v99
    v_mfma_f32_16x16x32_bf16 v[76:79], v[48:51], a[184:187], v[76:79]
    ds_read_b128 v[40:43], v18 offset:51200
    v_fmac_f32 v138, v161, v98
    v_mfma_f32_16x16x32_bf16 v[80:83], v[48:51], a[188:191], v[80:83]
    s_waitcnt lgkmcnt(4)
    v_fmac_f32 v131, v162, v96
    v_fmac_f32 v139, v162, v99
    v_mfma_f32_16x16x32_bf16 v[68:71], v[20:23], a[192:195], v[68:71]
    ds_read_b128 v[44:47], v19 offset:49152
    s_add_u32 m0, s21, 82944
    v_mfma_f32_16x16x32_bf16 v[72:75], v[20:23], a[196:199], v[72:75]
    buffer_load_dwordx4 v9, s[8:11], s20 offen lds
    v_fmac_f32 v131, v163, v99
    v_mfma_f32_16x16x32_bf16 v[76:79], v[24:27], a[192:195], v[76:79]
    ds_read_b128 v[48:51], v19 offset:51200
    v_fmac_f32 v139, v163, v98
    v_cvt_pk_bf16_f32 v121, v130, v131
    v_mfma_f32_16x16x32_bf16 v[80:83], v[24:27], a[196:199], v[80:83]
    s_waitcnt lgkmcnt(4)
    v_cvt_pk_bf16_f32 v125, v138, v139
    v_mfma_f32_16x16x32_bf16 v[68:71], v[28:31], a[200:203], v[68:71]
    ds_read_b128 v[20:23], v16 offset:49408
    v_fmac_f32 v132, v164, v96
    v_fmac_f32 v140, v164, v99
    v_mfma_f32_16x16x32_bf16 v[72:75], v[28:31], a[204:207], v[72:75]
    v_fmac_f32 v132, v165, v99
    v_fmac_f32 v140, v165, v98
    v_mfma_f32_16x16x32_bf16 v[76:79], v[32:35], a[200:203], v[76:79]
    ds_read_b128 v[24:27], v16 offset:51456
    v_fmac_f32 v133, v166, v96
    v_mfma_f32_16x16x32_bf16 v[80:83], v[32:35], a[204:207], v[80:83]
    s_waitcnt lgkmcnt(4)
    v_fmac_f32 v141, v166, v99
    v_fmac_f32 v133, v167, v99
    v_mfma_f32_16x16x32_bf16 v[68:71], v[36:39], a[208:211], v[68:71]
    ds_read_b128 v[28:31], v17 offset:49408
    s_add_u32 m0, s21, 83968
    v_mfma_f32_16x16x32_bf16 v[72:75], v[36:39], a[212:215], v[72:75]
    buffer_load_dwordx4 v10, s[8:11], s20 offen lds
    v_fmac_f32 v141, v167, v98
    v_mfma_f32_16x16x32_bf16 v[76:79], v[40:43], a[208:211], v[76:79]
    ds_read_b128 v[32:35], v17 offset:51456
    v_cvt_pk_bf16_f32 v122, v132, v133
    v_cvt_pk_bf16_f32 v126, v140, v141
    v_mfma_f32_16x16x32_bf16 v[80:83], v[40:43], a[212:215], v[80:83]
    s_waitcnt lgkmcnt(4)
    v_fmac_f32 v134, v168, v96
    v_mfma_f32_16x16x32_bf16 v[68:71], v[44:47], a[216:219], v[68:71]
    ds_read_b128 v[36:39], v18 offset:49408
    v_fmac_f32 v142, v168, v99
    v_fmac_f32 v134, v169, v99
    v_mfma_f32_16x16x32_bf16 v[72:75], v[44:47], a[220:223], v[72:75]
    v_fmac_f32 v142, v169, v98
    v_fmac_f32 v135, v170, v96
    v_mfma_f32_16x16x32_bf16 v[76:79], v[48:51], a[216:219], v[76:79]
    ds_read_b128 v[40:43], v18 offset:51456
    v_fmac_f32 v143, v170, v99
    v_mfma_f32_16x16x32_bf16 v[80:83], v[48:51], a[220:223], v[80:83]
    s_waitcnt lgkmcnt(4)
    v_fmac_f32 v135, v171, v99
    v_fmac_f32 v143, v171, v98
    v_mfma_f32_16x16x32_bf16 v[68:71], v[20:23], a[224:227], v[68:71]
    ds_read_b128 v[44:47], v19 offset:49408
    s_add_u32 m0, s21, 84992
    v_mfma_f32_16x16x32_bf16 v[72:75], v[20:23], a[228:231], v[72:75]
    buffer_load_dwordx4 v11, s[8:11], s20 offen lds
    v_cvt_pk_bf16_f32 v123, v134, v135
    v_mfma_f32_16x16x32_bf16 v[76:79], v[24:27], a[224:227], v[76:79]
    ds_read_b128 v[48:51], v19 offset:51456
    v_cvt_pk_bf16_f32 v127, v142, v143
    ds_write_b128 v116, v[120:123] offset:0
    v_mfma_f32_16x16x32_bf16 v[80:83], v[24:27], a[228:231], v[80:83]
    s_waitcnt lgkmcnt(4)
    ds_write_b128 v116, v[124:127] offset:1024
    v_mfma_f32_16x16x32_bf16 v[68:71], v[28:31], a[232:235], v[68:71]
    s_waitcnt vmcnt(20)
    s_barrier
    ds_read_b128 v[20:23], v12 offset:0
    v_mfma_f32_16x16x32_bf16 v[72:75], v[28:31], a[236:239], v[72:75]
    s_add_u32 s20, s20, 512
    ds_read_b64_tr_b16 v[144:145], v117 offset:0
    ds_read_b64_tr_b16 v[146:147], v118 offset:256
    v_mfma_f32_16x16x32_bf16 v[76:79], v[32:35], a[232:235], v[76:79]
    ds_read_b128 v[24:27], v12 offset:2048
    ds_read_b64_tr_b16 v[148:149], v117 offset:1024
    v_mfma_f32_16x16x32_bf16 v[80:83], v[32:35], a[236:239], v[80:83]
    s_waitcnt lgkmcnt(4)
    ds_read_b64_tr_b16 v[150:151], v118 offset:1280
    v_mfma_f32_16x16x32_bf16 v[68:71], v[36:39], a[240:243], v[68:71]
    ds_read_b128 v[28:31], v13 offset:0
    s_add_u32 m0, s21, 98304
    s_sub_u32 s39, s22, 1
    v_mfma_f32_16x16x32_bf16 v[72:75], v[36:39], a[244:247], v[72:75]
    buffer_load_dwordx4 v8, s[8:11], s20 offen lds
    s_lshl_b32 s38, s39, 17
    v_mfma_f32_16x16x32_bf16 v[76:79], v[40:43], a[240:243], v[76:79]
    ds_read_b128 v[32:35], v13 offset:2048
    s_add_u32 s38, s38, 0x4400000
    v_mfma_f32_16x16x32_bf16 v[80:83], v[40:43], a[244:247], v[80:83]
    s_waitcnt lgkmcnt(4)
    s_add_u32 s43, s38, 0x10000
    s_lshl_b32 s39, s39, 7
    v_mfma_f32_16x16x32_bf16 v[68:71], v[44:47], a[248:251], v[68:71]
    ds_read_b128 v[36:39], v14 offset:0
    s_add_u32 s39, s39, 0x5902000
    v_mfma_f32_16x16x32_bf16 v[72:75], v[44:47], a[252:255], v[72:75]
    s_cmp_eq_u32 s37, 0
    s_cselect_b32 s38, 0x7ff00000, s38
    s_cselect_b32 s39, 0x7ff00000, s39
    s_cselect_b32 s43, 0x7ff00000, s43
    v_mfma_f32_16x16x32_bf16 v[76:79], v[48:51], a[248:251], v[76:79]
    ds_read_b128 v[40:43], v14 offset:2048
    v_mfma_f32_16x16x32_bf16 v[80:83], v[48:51], a[252:255], v[80:83]
    s_waitcnt lgkmcnt(4)
    s_mov_b32 s37, 1
    s_add_u32 s22, s22, 1
    s_cmp_ge_u32 s22, s23
    s_cbranch_scc0 L_st_259
L_fl1_257:
    s_waitcnt lgkmcnt(0)
    s_nop 7
    s_waitcnt lgkmcnt(0)
    buffer_store_dwordx4 v[144:147], v86, s[12:15], s38 offen sc1
    buffer_store_dwordx4 v[148:151], v86, s[12:15], s43 offen sc1
    s_waitcnt vmcnt(0)
    s_barrier
    buffer_atomic_add v84, v85, s[12:15], s39 offen sc1
    v_fmac_f32 v69, v88, v68
    v_fmac_f32 v73, v88, v72
    v_mul_f32 v128, v90, v68
    v_mul_f32 v136, v154, v72
    v_fmac_f32 v69, v152, v72
    v_fmac_f32 v73, v89, v68
    v_fmac_f32 v128, v155, v72
    v_fmac_f32 v136, v155, v68
    v_fmac_f32 v70, v88, v69
    v_fmac_f32 v74, v88, v73
    v_mul_f32 v129, v90, v69
    v_mul_f32 v137, v154, v73
    v_fmac_f32 v70, v152, v73
    v_fmac_f32 v74, v89, v69
    v_fmac_f32 v129, v155, v73
    v_fmac_f32 v137, v155, v69
    v_fmac_f32 v71, v88, v70
    v_fmac_f32 v75, v88, v74
    v_mul_f32 v130, v90, v70
    v_mul_f32 v138, v154, v74
    v_fmac_f32 v71, v152, v74
    v_fmac_f32 v75, v89, v70
    v_fmac_f32 v130, v155, v74
    v_fmac_f32 v138, v155, v70
    v_fmac_f32 v76, v88, v71
    v_fmac_f32 v80, v88, v75
    v_mul_f32 v131, v90, v71
    v_mul_f32 v139, v154, v75
    v_fmac_f32 v76, v152, v75
    v_fmac_f32 v80, v89, v71
    v_fmac_f32 v131, v155, v75
    v_fmac_f32 v139, v155, v71
    v_fmac_f32 v77, v88, v76
    v_fmac_f32 v81, v88, v80
    v_mul_f32 v132, v90, v76
    v_mul_f32 v140, v154, v80
    v_fmac_f32 v77, v152, v80
    v_fmac_f32 v81, v89, v76
    v_fmac_f32 v132, v155, v80
    v_fmac_f32 v140, v155, v76
    v_fmac_f32 v78, v88, v77
    v_fmac_f32 v82, v88, v81
    v_mul_f32 v133, v90, v77
    v_mul_f32 v141, v154, v81
    v_fmac_f32 v78, v152, v81
    v_fmac_f32 v82, v89, v77
    v_fmac_f32 v133, v155, v81
    v_fmac_f32 v141, v155, v77
    v_fmac_f32 v79, v88, v78
    v_fmac_f32 v83, v88, v82
    v_mul_f32 v134, v90, v78
    v_mul_f32 v142, v154, v82
    v_fmac_f32 v79, v152, v82
    v_fmac_f32 v83, v89, v78
    v_fmac_f32 v134, v155, v82
    v_fmac_f32 v142, v155, v78
    v_mov_b32 v102, v79
    v_mov_b32 v103, v79
    v_mov_b32 v106, v83
    v_mov_b32 v107, v83
    v_mul_f32 v135, v90, v79
    v_mul_f32 v143, v154, v83
    v_permlane16_swap_b32 v102, v103
    v_permlane16_swap_b32 v106, v107
    v_mov_b32 v104, v102
    v_mov_b32 v105, v103
    v_mov_b32 v108, v106
    v_mov_b32 v109, v107
    v_fmac_f32 v135, v155, v83
    v_fmac_f32 v143, v155, v79
    v_permlane32_swap_b32 v102, v104
    v_permlane32_swap_b32 v103, v105
    v_permlane32_swap_b32 v106, v108
    v_permlane32_swap_b32 v107, v109
    v_fmac_f32 v102, v92, v94
    v_fmac_f32 v106, v92, v95
    v_fmac_f32 v102, v153, v95
    v_fmac_f32 v106, v93, v94
    v_cndmask_b32 v96, v94, v102, s[56:57]
    v_cndmask_b32 v97, v95, v106, s[56:57]
    v_fmac_f32 v103, v92, v102
    v_fmac_f32 v107, v92, v106
    v_fmac_f32 v103, v153, v106
    v_fmac_f32 v107, v93, v102
    v_cndmask_b32 v96, v96, v103, s[58:59]
    v_cndmask_b32 v97, v97, v107, s[58:59]
    v_fmac_f32 v104, v92, v103
    v_fmac_f32 v108, v92, v107
    v_fmac_f32 v104, v153, v107
    v_fmac_f32 v108, v93, v103
    v_cndmask_b32 v96, v96, v104, s[60:61]
    v_cndmask_b32 v97, v97, v108, s[60:61]
    v_fmac_f32 v105, v92, v104
    v_fmac_f32 v109, v92, v108
    v_fmac_f32 v105, v153, v108
    v_fmac_f32 v109, v93, v104
    v_xor_b32 v98, 0x80000000, v96
    v_xor_b32 v99, 0x80000000, v97
    v_mov_b32 v94, v105
    v_mov_b32 v95, v109
    v_fmac_f32 v128, v156, v96
    v_fmac_f32 v136, v156, v99
    v_fmac_f32 v128, v157, v99
    v_fmac_f32 v136, v157, v98
    v_fmac_f32 v129, v158, v96
    v_fmac_f32 v137, v158, v99
    v_fmac_f32 v129, v159, v99
    v_fmac_f32 v137, v159, v98
    v_cvt_pk_bf16_f32 v120, v128, v129
    v_cvt_pk_bf16_f32 v124, v136, v137
    v_fmac_f32 v130, v160, v96
    v_fmac_f32 v138, v160, v99
    v_fmac_f32 v130, v161, v99
    v_fmac_f32 v138, v161, v98
    v_fmac_f32 v131, v162, v96
    v_fmac_f32 v139, v162, v99
    v_fmac_f32 v131, v163, v99
    v_fmac_f32 v139, v163, v98
    v_cvt_pk_bf16_f32 v121, v130, v131
    v_cvt_pk_bf16_f32 v125, v138, v139
    v_fmac_f32 v132, v164, v96
    v_fmac_f32 v140, v164, v99
    v_fmac_f32 v132, v165, v99
    v_fmac_f32 v140, v165, v98
    v_fmac_f32 v133, v166, v96
    v_fmac_f32 v141, v166, v99
    v_fmac_f32 v133, v167, v99
    v_fmac_f32 v141, v167, v98
    v_cvt_pk_bf16_f32 v122, v132, v133
    v_cvt_pk_bf16_f32 v126, v140, v141
    v_fmac_f32 v134, v168, v96
    v_fmac_f32 v142, v168, v99
    v_fmac_f32 v134, v169, v99
    v_fmac_f32 v142, v169, v98
    v_fmac_f32 v135, v170, v96
    v_fmac_f32 v143, v170, v99
    v_fmac_f32 v135, v171, v99
    v_fmac_f32 v143, v171, v98
    v_cvt_pk_bf16_f32 v123, v134, v135
    v_cvt_pk_bf16_f32 v127, v142, v143
    ds_write_b128 v116, v[120:123] offset:0
    ds_write_b128 v116, v[124:127] offset:1024
    ds_read_b64_tr_b16 v[144:145], v117 offset:0
    ds_read_b64_tr_b16 v[146:147], v118 offset:256
    ds_read_b64_tr_b16 v[148:149], v117 offset:1024
    ds_read_b64_tr_b16 v[150:151], v118 offset:1280
    s_sub_u32 s39, s22, 1
    s_lshl_b32 s38, s39, 17
    s_add_u32 s38, s38, 0x4400000
    s_add_u32 s43, s38, 0x10000
    s_lshl_b32 s39, s39, 7
    s_add_u32 s39, s39, 0x5902000
    s_cmp_eq_u32 s37, 0
    s_cselect_b32 s38, 0x7ff00000, s38
    s_cselect_b32 s39, 0x7ff00000, s39
    s_cselect_b32 s43, 0x7ff00000, s43
    s_mov_b32 s37, 1
    s_waitcnt lgkmcnt(0)
    buffer_store_dwordx4 v[144:147], v86, s[12:15], s38 offen sc1
    buffer_store_dwordx4 v[148:151], v86, s[12:15], s43 offen sc1
    s_waitcnt vmcnt(0)
    s_barrier
    buffer_atomic_add v84, v85, s[12:15], s39 offen sc1
    s_branch L_ste_258
L_fl0_256:
    s_waitcnt lgkmcnt(0)
    s_nop 7
    s_waitcnt lgkmcnt(0)
    buffer_store_dwordx4 v[144:147], v86, s[12:15], s38 offen sc1
    buffer_store_dwordx4 v[148:151], v86, s[12:15], s43 offen sc1
    s_waitcnt vmcnt(0)
    s_barrier
    buffer_atomic_add v84, v85, s[12:15], s39 offen sc1
    v_fmac_f32 v53, v88, v52
    v_fmac_f32 v57, v88, v56
    v_mul_f32 v128, v90, v52
    v_mul_f32 v136, v154, v56
    v_fmac_f32 v53, v152, v56
    v_fmac_f32 v57, v89, v52
    v_fmac_f32 v128, v155, v56
    v_fmac_f32 v136, v155, v52
    v_fmac_f32 v54, v88, v53
    v_fmac_f32 v58, v88, v57
    v_mul_f32 v129, v90, v53
    v_mul_f32 v137, v154, v57
    v_fmac_f32 v54, v152, v57
    v_fmac_f32 v58, v89, v53
    v_fmac_f32 v129, v155, v57
    v_fmac_f32 v137, v155, v53
    v_fmac_f32 v55, v88, v54
    v_fmac_f32 v59, v88, v58
    v_mul_f32 v130, v90, v54
    v_mul_f32 v138, v154, v58
    v_fmac_f32 v55, v152, v58
    v_fmac_f32 v59, v89, v54
    v_fmac_f32 v130, v155, v58
    v_fmac_f32 v138, v155, v54
    v_fmac_f32 v60, v88, v55
    v_fmac_f32 v64, v88, v59
    v_mul_f32 v131, v90, v55
    v_mul_f32 v139, v154, v59
    v_fmac_f32 v60, v152, v59
    v_fmac_f32 v64, v89, v55
    v_fmac_f32 v131, v155, v59
    v_fmac_f32 v139, v155, v55
    v_fmac_f32 v61, v88, v60
    v_fmac_f32 v65, v88, v64
    v_mul_f32 v132, v90, v60
    v_mul_f32 v140, v154, v64
    v_fmac_f32 v61, v152, v64
    v_fmac_f32 v65, v89, v60
    v_fmac_f32 v132, v155, v64
    v_fmac_f32 v140, v155, v60
    v_fmac_f32 v62, v88, v61
    v_fmac_f32 v66, v88, v65
    v_mul_f32 v133, v90, v61
    v_mul_f32 v141, v154, v65
    v_fmac_f32 v62, v152, v65
    v_fmac_f32 v66, v89, v61
    v_fmac_f32 v133, v155, v65
    v_fmac_f32 v141, v155, v61
    v_fmac_f32 v63, v88, v62
    v_fmac_f32 v67, v88, v66
    v_mul_f32 v134, v90, v62
    v_mul_f32 v142, v154, v66
    v_fmac_f32 v63, v152, v66
    v_fmac_f32 v67, v89, v62
    v_fmac_f32 v134, v155, v66
    v_fmac_f32 v142, v155, v62
    v_mov_b32 v102, v63
    v_mov_b32 v103, v63
    v_mov_b32 v106, v67
    v_mov_b32 v107, v67
    v_mul_f32 v135, v90, v63
    v_mul_f32 v143, v154, v67
    v_permlane16_swap_b32 v102, v103
    v_permlane16_swap_b32 v106, v107
    v_mov_b32 v104, v102
    v_mov_b32 v105, v103
    v_mov_b32 v108, v106
    v_mov_b32 v109, v107
    v_fmac_f32 v135, v155, v67
    v_fmac_f32 v143, v155, v63
    v_permlane32_swap_b32 v102, v104
    v_permlane32_swap_b32 v103, v105
    v_permlane32_swap_b32 v106, v108
    v_permlane32_swap_b32 v107, v109
    v_fmac_f32 v102, v92, v94
    v_fmac_f32 v106, v92, v95
    v_fmac_f32 v102, v153, v95
    v_fmac_f32 v106, v93, v94
    v_cndmask_b32 v96, v94, v102, s[56:57]
    v_cndmask_b32 v97, v95, v106, s[56:57]
    v_fmac_f32 v103, v92, v102
    v_fmac_f32 v107, v92, v106
    v_fmac_f32 v103, v153, v106
    v_fmac_f32 v107, v93, v102
    v_cndmask_b32 v96, v96, v103, s[58:59]
    v_cndmask_b32 v97, v97, v107, s[58:59]
    v_fmac_f32 v104, v92, v103
    v_fmac_f32 v108, v92, v107
    v_fmac_f32 v104, v153, v107
    v_fmac_f32 v108, v93, v103
    v_cndmask_b32 v96, v96, v104, s[60:61]
    v_cndmask_b32 v97, v97, v108, s[60:61]
    v_fmac_f32 v105, v92, v104
    v_fmac_f32 v109, v92, v108
    v_fmac_f32 v105, v153, v108
    v_fmac_f32 v109, v93, v104
    v_xor_b32 v98, 0x80000000, v96
    v_xor_b32 v99, 0x80000000, v97
    v_mov_b32 v94, v105
    v_mov_b32 v95, v109
    v_fmac_f32 v128, v156, v96
    v_fmac_f32 v136, v156, v99
    v_fmac_f32 v128, v157, v99
    v_fmac_f32 v136, v157, v98
    v_fmac_f32 v129, v158, v96
    v_fmac_f32 v137, v158, v99
    v_fmac_f32 v129, v159, v99
    v_fmac_f32 v137, v159, v98
    v_cvt_pk_bf16_f32 v120, v128, v129
    v_cvt_pk_bf16_f32 v124, v136, v137
    v_fmac_f32 v130, v160, v96
    v_fmac_f32 v138, v160, v99
    v_fmac_f32 v130, v161, v99
    v_fmac_f32 v138, v161, v98
    v_fmac_f32 v131, v162, v96
    v_fmac_f32 v139, v162, v99
    v_fmac_f32 v131, v163, v99
    v_fmac_f32 v139, v163, v98
    v_cvt_pk_bf16_f32 v121, v130, v131
    v_cvt_pk_bf16_f32 v125, v138, v139
    v_fmac_f32 v132, v164, v96
    v_fmac_f32 v140, v164, v99
    v_fmac_f32 v132, v165, v99
    v_fmac_f32 v140, v165, v98
    v_fmac_f32 v133, v166, v96
    v_fmac_f32 v141, v166, v99
    v_fmac_f32 v133, v167, v99
    v_fmac_f32 v141, v167, v98
    v_cvt_pk_bf16_f32 v122, v132, v133
    v_cvt_pk_bf16_f32 v126, v140, v141
    v_fmac_f32 v134, v168, v96
    v_fmac_f32 v142, v168, v99
    v_fmac_f32 v134, v169, v99
    v_fmac_f32 v142, v169, v98
    v_fmac_f32 v135, v170, v96
    v_fmac_f32 v143, v170, v99
    v_fmac_f32 v135, v171, v99
    v_fmac_f32 v143, v171, v98
    v_cvt_pk_bf16_f32 v123, v134, v135
    v_cvt_pk_bf16_f32 v127, v142, v143
    ds_write_b128 v116, v[120:123] offset:0
    ds_write_b128 v116, v[124:127] offset:1024
    ds_read_b64_tr_b16 v[144:145], v117 offset:0
    ds_read_b64_tr_b16 v[146:147], v118 offset:256
    ds_read_b64_tr_b16 v[148:149], v117 offset:1024
    ds_read_b64_tr_b16 v[150:151], v118 offset:1280
    s_sub_u32 s39, s22, 1
    s_lshl_b32 s38, s39, 17
    s_add_u32 s38, s38, 0x4400000
    s_add_u32 s43, s38, 0x10000
    s_lshl_b32 s39, s39, 7
    s_add_u32 s39, s39, 0x5902000
    s_cmp_eq_u32 s37, 0
    s_cselect_b32 s38, 0x7ff00000, s38
    s_cselect_b32 s39, 0x7ff00000, s39
    s_cselect_b32 s43, 0x7ff00000, s43
    s_mov_b32 s37, 1
    s_waitcnt lgkmcnt(0)
    buffer_store_dwordx4 v[144:147], v86, s[12:15], s38 offen sc1
    buffer_store_dwordx4 v[148:151], v86, s[12:15], s43 offen sc1
    s_waitcnt vmcnt(0)
    s_barrier
    buffer_atomic_add v84, v85, s[12:15], s39 offen sc1
L_ste_258:
    s_branch L_op_223
L_g2_222:
    s_and_b32 s46, s41, 15
    s_mov_b32 s32, s64
    s_and_b32 s33, s65, 0xffff
    s_mov_b32 s34, 0x400000
    s_mov_b32 s35, 0x00020000
    v_lshlrev_b32 v1, 4, v0
    s_lshl_b32 s25, s46, 12
L_warm_260:
    buffer_load_dwordx4 v[20:23], v1, s[32:35], s25 offen
    s_add_u32 s25, s25, 0x10000
    buffer_load_dwordx4 v[24:27], v1, s[32:35], s25 offen
    s_add_u32 s25, s25, 0x10000
    buffer_load_dwordx4 v[28:31], v1, s[32:35], s25 offen
    s_add_u32 s25, s25, 0x10000
    buffer_load_dwordx4 v[32:35], v1, s[32:35], s25 offen
    s_add_u32 s25, s25, 0x10000
    buffer_load_dwordx4 v[36:39], v1, s[32:35], s25 offen
    s_add_u32 s25, s25, 0x10000
    buffer_load_dwordx4 v[40:43], v1, s[32:35], s25 offen
    s_add_u32 s25, s25, 0x10000
    buffer_load_dwordx4 v[44:47], v1, s[32:35], s25 offen
    s_add_u32 s25, s25, 0x10000
    buffer_load_dwordx4 v[48:51], v1, s[32:35], s25 offen
    s_add_u32 s25, s25, 0x10000
    buffer_load_dwordx4 v[52:55], v1, s[32:35], s25 offen
    s_add_u32 s25, s25, 0x10000
    buffer_load_dwordx4 v[56:59], v1, s[32:35], s25 offen
    s_add_u32 s25, s25, 0x10000
    buffer_load_dwordx4 v[60:63], v1, s[32:35], s25 offen
    s_add_u32 s25, s25, 0x10000
    buffer_load_dwordx4 v[64:67], v1, s[32:35], s25 offen
    s_add_u32 s25, s25, 0x10000
    buffer_load_dwordx4 v[68:71], v1, s[32:35], s25 offen
    s_add_u32 s25, s25, 0x10000
    buffer_load_dwordx4 v[72:75], v1, s[32:35], s25 offen
    s_add_u32 s25, s25, 0x10000
    buffer_load_dwordx4 v[76:79], v1, s[32:35], s25 offen
    s_add_u32 s25, s25, 0x10000
    buffer_load_dwordx4 v[80:83], v1, s[32:35], s25 offen
    s_add_u32 s25, s25, 0x10000
    s_waitcnt vmcnt(16)
    s_cmp_lt_u32 s25, 0x400000
    s_cbranch_scc1 L_warm_260
    s_waitcnt vmcnt(0)
    s_mov_b32 s32, s98
    s_and_b32 s33, s99, 0xffff
    s_mov_b32 s34, 0x100
    s_mov_b32 s35, 0x00020000
    s_mov_b32 s25, 0
    v_mov_b32 v2, 0
L_pl_261:
    buffer_load_dword v1, v2, s[32:35], s25 offen sc1
    s_add_u32 s36, s36, 1
    s_cmp_gt_u32 s36, 0x100000
    s_cbranch_scc1 chain_kernel_wend
    s_waitcnt vmcnt(0)
    v_readfirstlane_b32 s26, v1
    s_and_b32 s27, s26, 0xffff
    s_cmp_ge_u32 s27, 256
    s_cbranch_scc1 L_plok_262
    s_sleep 4
    s_branch L_pl_261
L_plok_262:
    s_lshr_b32 s25, s26, 16
    s_cmp_gt_u32 s25, 16
    s_cselect_b32 s25, 0x2000, 0x0
    s_add_u32 s54, s100, 0x1fffff
    s_and_b32 s54, s54, 0xffe00000
    s_sub_u32 s55, s54, s100
    s_add_u32 s54, s55, s25
    s_xor_b32 s25, s25, 0x2000
    s_add_u32 s55, s55, s25
    s_lshl_b32 s44, s46, 15
    s_lshl_b32 s25, s49, 13
    s_add_u32 s44, s44, s25
    s_xor_b32 s45, s44, 0x8000
    s_add_u32 s44, s44, 0x6800000
    s_add_u32 s45, s45, 0x6800000
    s_lshr_b32 s48, s46, 1
    s_lshl_b32 s48, s48, 7
    s_add_u32 s48, s48, 0x590d000
    v_mov_b32 v104, 0
    v_mov_b32 v105, 0
    v_mov_b32 v106, 0
    v_mov_b32 v107, 0
    v_and_b32 v2, 63, v0
    v_lshlrev_b32 v3, 4, v2
    v_lshlrev_b32 v112, 4, v2
    s_add_u32 s28, s44, 0
    buffer_store_dwordx4 v[104:107], v3, s[12:15], s28 offen sc1
    s_add_u32 s28, s44, 1024
    buffer_store_dwordx4 v[104:107], v3, s[12:15], s28 offen sc1
    s_add_u32 s28, s44, 2048
    buffer_store_dwordx4 v[104:107], v3, s[12:15], s28 offen sc1
    s_add_u32 s28, s44, 3072
    buffer_store_dwordx4 v[104:107], v3, s[12:15], s28 offen sc1
    s_add_u32 s28, s44, 4096
    buffer_store_dwordx4 v[104:107], v3, s[12:15], s28 offen sc1
    s_add_u32 s28, s44, 5120
    buffer_store_dwordx4 v[104:107], v3, s[12:15], s28 offen sc1
    s_add_u32 s28, s44, 6144
    buffer_store_dwordx4 v[104:107], v3, s[12:15], s28 offen sc1
    s_add_u32 s28, s44, 7168
    buffer_store_dwordx4 v[104:107], v3, s[12:15], s28 offen sc1
    v_lshrrev_b32 v1, 6, v0
    v_lshlrev_b32 v1, 11, v1
    v_add_u32 v1, 0x21000, v1
    v_bfe_u32 v2, v0, 3, 3
    v_lshlrev_b32 v2, 4, v2
    v_xor_b32 v2, v2, v3
    v_add_u32 v113, v1, v2
    v_and_b32 v2, 15, v0
    v_lshl_add_u32 v1, v2, 7, v1
    v_bfe_u32 v2, v0, 4, 2
    v_lshlrev_b32 v2, 1, v2
    v_and_b32 v3, 7, v0
    v_xor_b32 v2, v2, v3
    v_lshl_add_u32 v114, v2, 4, v1
    v_xor_b32 v115, 16, v114
    s_waitcnt vmcnt(0)
    s_barrier
    buffer_atomic_add v84, v85, s[12:15], s48 offen sc1
    v_mov_b32 v2, 0
L_pl_263:
    buffer_load_dword v1, v2, s[12:15], s48 offen sc1
    s_add_u32 s36, s36, 1
    s_cmp_gt_u32 s36, 0x100000
    s_cbranch_scc1 chain_kernel_wend
    s_waitcnt vmcnt(0)
    v_readfirstlane_b32 s26, v1
    s_cmp_ge_u32 s26, 2
    s_cbranch_scc1 L_plok_264
    s_sleep 4
    s_branch L_pl_263
L_plok_264:
    s_and_b32 s47, s46, 1
    s_cmp_eq_u32 s47, 1
    s_cselect_b32 s16, s76, s74
    s_cselect_b32 s17, s77, s75
    s_and_b32 s17, s17, 0xffff
    s_mov_b32 s18, 0x200000
    s_mov_b32 s19, 0x00020000
    s_lshr_b32 s25, s46, 1
    s_lshl_b32 s25, s25, 7
    s_lshl_b32 s26, s49, 5
    s_add_u32 s25, s25, s26
    v_and_b32 v5, 7, v0
    v_lshl_add_u32 v5, v5, 2, s25
    s_lshl_b32 s26, s47, 4
    v_bfe_u32 v6, v0, 3, 3
    v_add_u32 v6, s26, v6
    v_lshlrev_b32 v7, 1, v5
    v_lshl_add_u32 v136, v6, 11, v7
    v_add_u32 v137, 0x4000, v136
    v_lshlrev_b32 v5, 2, v5
    v_lshl_add_u32 v138, v6, 13, v5
    v_add_u32 v139, 0x10000, v138
    s_mov_b32 s32, s80
    s_and_b32 s33, s81, 0xffff
    s_mov_b32 s34, 0x800
    s_mov_b32 s35, 0x00020000
    buffer_load_dwordx2 v[132:133], v7, s[32:35], 0 offen
    v_and_b32 v1, 31, v0
    v_bfe_u32 v2, v0, 5, 1
    v_add_u32 v3, 0, v2
    v_xor_b32 v4, v3, v1
    v_lshlrev_b32 v4, 4, v4
    v_and_b32 v5, 12, v3
    v_add_u32 v3, v3, v5
    v_add_u32 v3, s25, v3
    v_lshl_add_u32 v20, v3, 11, v4
    v_add_u32 v3, 2, v2
    v_xor_b32 v4, v3, v1
    v_lshlrev_b32 v4, 4, v4
    v_and_b32 v5, 12, v3
    v_add_u32 v3, v3, v5
    v_add_u32 v3, s25, v3
    v_lshl_add_u32 v21, v3, 11, v4
    v_add_u32 v3, 4, v2
    v_xor_b32 v4, v3, v1
    v_lshlrev_b32 v4, 4, v4
    v_and_b32 v5, 12, v3
    v_add_u32 v3, v3, v5
    v_add_u32 v3, s25, v3
    v_lshl_add_u32 v22, v3, 11, v4
    v_add_u32 v3, 6, v2
    v_xor_b32 v4, v3, v1
    v_lshlrev_b32 v4, 4, v4
    v_and_b32 v5, 12, v3
    v_add_u32 v3, v3, v5
    v_add_u32 v3, s25, v3
    v_lshl_add_u32 v23, v3, 11, v4
    v_add_u32 v3, 8, v2
    v_xor_b32 v4, v3, v1
    v_lshlrev_b32 v4, 4, v4
    v_and_b32 v5, 12, v3
    v_add_u32 v3, v3, v5
    v_add_u32 v3, s25, v3
    v_lshl_add_u32 v24, v3, 11, v4
    v_add_u32 v3, 10, v2
    v_xor_b32 v4, v3, v1
    v_lshlrev_b32 v4, 4, v4
    v_and_b32 v5, 12, v3
    v_add_u32 v3, v3, v5
    v_add_u32 v3, s25, v3
    v_lshl_add_u32 v25, v3, 11, v4
    v_add_u32 v3, 12, v2
    v_xor_b32 v4, v3, v1
    v_lshlrev_b32 v4, 4, v4
    v_and_b32 v5, 12, v3
    v_add_u32 v3, v3, v5
    v_add_u32 v3, s25, v3
    v_lshl_add_u32 v26, v3, 11, v4
    v_add_u32 v3, 14, v2
    v_xor_b32 v4, v3, v1
    v_lshlrev_b32 v4, 4, v4
    v_and_b32 v5, 12, v3
    v_add_u32 v3, v3, v5
    v_add_u32 v3, s25, v3
    v_lshl_add_u32 v27, v3, 11, v4
    v_and_b32 v1, 15, v0
    v_bfe_u32 v2, v0, 4, 2
    v_lshrrev_b32 v3, 6, v0
    v_lshlrev_b32 v3, 15, v3
    v_lshl_add_u32 v3, v1, 9, v3
    v_add_u32 v4, 0, v2
    v_xor_b32 v4, v4, v1
    v_lshl_add_u32 v28, v4, 4, v3
    v_add_u32 v4, 4, v2
    v_xor_b32 v4, v4, v1
    v_lshl_add_u32 v29, v4, 4, v3
    v_add_u32 v4, 8, v2
    v_xor_b32 v4, v4, v1
    v_lshl_add_u32 v30, v4, 4, v3
    v_add_u32 v4, 12, v2
    v_xor_b32 v4, v4, v1
    v_lshl_add_u32 v31, v4, 4, v3
    s_lshl_b32 s26, s49, 15
    s_barrier
    s_mov_b32 s27, 0
    s_add_u32 m0, s26, 0
    s_nop 0
    buffer_load_dwordx4 v20, s[16:19], s27 offen nt lds
    s_add_u32 m0, s26, 1024
    s_nop 0
    buffer_load_dwordx4 v21, s[16:19], s27 offen nt lds
    s_add_u32 m0, s26, 2048
    s_nop 0
    buffer_load_dwordx4 v22, s[16:19], s27 offen nt lds
    s_add_u32 m0, s26, 3072
    s_nop 0
    buffer_load_dwordx4 v23, s[16:19], s27 offen nt lds
    s_add_u32 m0, s26, 4096
    s_nop 0
    buffer_load_dwordx4 v24, s[16:19], s27 offen nt lds
    s_add_u32 m0, s26, 5120
    s_nop 0
    buffer_load_dwordx4 v25, s[16:19], s27 offen nt lds
    s_add_u32 m0, s26, 6144
    s_nop 0
    buffer_load_dwordx4 v26, s[16:19], s27 offen nt lds
    s_add_u32 m0, s26, 7168
    s_nop 0
    buffer_load_dwordx4 v27, s[16:19], s27 offen nt lds
    s_mov_b32 s27, 8192
    s_add_u32 m0, s26, 8192
    s_nop 0
    buffer_load_dwordx4 v20, s[16:19], s27 offen nt lds
    s_add_u32 m0, s26, 9216
    s_nop 0
    buffer_load_dwordx4 v21, s[16:19], s27 offen nt lds
    s_add_u32 m0, s26, 10240
    s_nop 0
    buffer_load_dwordx4 v22, s[16:19], s27 offen nt lds
    s_add_u32 m0, s26, 11264
    s_nop 0
    buffer_load_dwordx4 v23, s[16:19], s27 offen nt lds
    s_add_u32 m0, s26, 12288
    s_nop 0
    buffer_load_dwordx4 v24, s[16:19], s27 offen nt lds
    s_add_u32 m0, s26, 13312
    s_nop 0
    buffer_load_dwordx4 v25, s[16:19], s27 offen nt lds
    s_add_u32 m0, s26, 14336
    s_nop 0
    buffer_load_dwordx4 v26, s[16:19], s27 offen nt lds
    s_add_u32 m0, s26, 15360
    s_nop 0
    buffer_load_dwordx4 v27, s[16:19], s27 offen nt lds
    s_mov_b32 s27, 512
    s_add_u32 m0, s26, 16384
    s_nop 0
    buffer_load_dwordx4 v20, s[16:19], s27 offen nt lds
    s_add_u32 m0, s26, 17408
    s_nop 0
    buffer_load_dwordx4 v21, s[16:19], s27 offen nt lds
    s_add_u32 m0, s26, 18432
    s_nop 0
    buffer_load_dwordx4 v22, s[16:19], s27 offen nt lds
    s_add_u32 m0, s26, 19456
    s_nop 0
    buffer_load_dwordx4 v23, s[16:19], s27 offen nt lds
    s_add_u32 m0, s26, 20480
    s_nop 0
    buffer_load_dwordx4 v24, s[16:19], s27 offen nt lds
    s_add_u32 m0, s26, 21504
    s_nop 0
    buffer_load_dwordx4 v25, s[16:19], s27 offen nt lds
    s_add_u32 m0, s26, 22528
    s_nop 0
    buffer_load_dwordx4 v26, s[16:19], s27 offen nt lds
    s_add_u32 m0, s26, 23552
    s_nop 0
    buffer_load_dwordx4 v27, s[16:19], s27 offen nt lds
    s_mov_b32 s27, 8704
    s_add_u32 m0, s26, 24576
    s_nop 0
    buffer_load_dwordx4 v20, s[16:19], s27 offen nt lds
    s_add_u32 m0, s26, 25600
    s_nop 0
    buffer_load_dwordx4 v21, s[16:19], s27 offen nt lds
    s_add_u32 m0, s26, 26624
    s_nop 0
    buffer_load_dwordx4 v22, s[16:19], s27 offen nt lds
    s_add_u32 m0, s26, 27648
    s_nop 0
    buffer_load_dwordx4 v23, s[16:19], s27 offen nt lds
    s_add_u32 m0, s26, 28672
    s_nop 0
    buffer_load_dwordx4 v24, s[16:19], s27 offen nt lds
    s_add_u32 m0, s26, 29696
    s_nop 0
    buffer_load_dwordx4 v25, s[16:19], s27 offen nt lds
    s_add_u32 m0, s26, 30720
    s_nop 0
    buffer_load_dwordx4 v26, s[16:19], s27 offen nt lds
    s_add_u32 m0, s26, 31744
    s_nop 0
    buffer_load_dwordx4 v27, s[16:19], s27 offen nt lds
    s_waitcnt vmcnt(16)
    ds_read_b128 a[0:3], v28 offset:0
    ds_read_b128 a[4:7], v28 offset:8192
    ds_read_b128 a[8:11], v29 offset:0
    ds_read_b128 a[12:15], v29 offset:8192
    ds_read_b128 a[16:19], v30 offset:0
    ds_read_b128 a[20:23], v30 offset:8192
    ds_read_b128 a[24:27], v31 offset:0
    ds_read_b128 a[28:31], v31 offset:8192
    s_waitcnt lgkmcnt(0)
    ds_read_b128 a[32:35], v28 offset:256
    ds_read_b128 a[36:39], v28 offset:8448
    ds_read_b128 a[40:43], v29 offset:256
    ds_read_b128 a[44:47], v29 offset:8448
    ds_read_b128 a[48:51], v30 offset:256
    ds_read_b128 a[52:55], v30 offset:8448
    ds_read_b128 a[56:59], v31 offset:256
    ds_read_b128 a[60:63], v31 offset:8448
    s_waitcnt lgkmcnt(0)
    s_mov_b32 s27, 1024
    s_add_u32 m0, s26, 0
    s_nop 0
    buffer_load_dwordx4 v20, s[16:19], s27 offen nt lds
    s_add_u32 m0, s26, 1024
    s_nop 0
    buffer_load_dwordx4 v21, s[16:19], s27 offen nt lds
    s_add_u32 m0, s26, 2048
    s_nop 0
    buffer_load_dwordx4 v22, s[16:19], s27 offen nt lds
    s_add_u32 m0, s26, 3072
    s_nop 0
    buffer_load_dwordx4 v23, s[16:19], s27 offen nt lds
    s_add_u32 m0, s26, 4096
    s_nop 0
    buffer_load_dwordx4 v24, s[16:19], s27 offen nt lds
    s_add_u32 m0, s26, 5120
    s_nop 0
    buffer_load_dwordx4 v25, s[16:19], s27 offen nt lds
    s_add_u32 m0, s26, 6144
    s_nop 0
    buffer_load_dwordx4 v26, s[16:19], s27 offen nt lds
    s_add_u32 m0, s26, 7168
    s_nop 0
    buffer_load_dwordx4 v27, s[16:19], s27 offen nt lds
    s_mov_b32 s27, 9216
    s_add_u32 m0, s26, 8192
    s_nop 0
    buffer_load_dwordx4 v20, s[16:19], s27 offen nt lds
    s_add_u32 m0, s26, 9216
    s_nop 0
    buffer_load_dwordx4 v21, s[16:19], s27 offen nt lds
    s_add_u32 m0, s26, 10240
    s_nop 0
    buffer_load_dwordx4 v22, s[16:19], s27 offen nt lds
    s_add_u32 m0, s26, 11264
    s_nop 0
    buffer_load_dwordx4 v23, s[16:19], s27 offen nt lds
    s_add_u32 m0, s26, 12288
    s_nop 0
    buffer_load_dwordx4 v24, s[16:19], s27 offen nt lds
    s_add_u32 m0, s26, 13312
    s_nop 0
    buffer_load_dwordx4 v25, s[16:19], s27 offen nt lds
    s_add_u32 m0, s26, 14336
    s_nop 0
    buffer_load_dwordx4 v26, s[16:19], s27 offen nt lds
    s_add_u32 m0, s26, 15360
    s_nop 0
    buffer_load_dwordx4 v27, s[16:19], s27 offen nt lds
    s_waitcnt vmcnt(16)
    ds_read_b128 a[64:67], v28 offset:16384
    ds_read_b128 a[68:71], v28 offset:24576
    ds_read_b128 a[72:75], v29 offset:16384
    ds_read_b128 a[76:79], v29 offset:24576
    ds_read_b128 a[80:83], v30 offset:16384
    ds_read_b128 a[84:87], v30 offset:24576
    ds_read_b128 a[88:91], v31 offset:16384
    ds_read_b128 a[92:95], v31 offset:24576
    s_waitcnt lgkmcnt(0)
    ds_read_b128 a[96:99], v28 offset:16640
    ds_read_b128 a[100:103], v28 offset:24832
    ds_read_b128 a[104:107], v29 offset:16640
    ds_read_b128 a[108:111], v29 offset:24832
    ds_read_b128 a[112:115], v30 offset:16640
    ds_read_b128 a[116:119], v30 offset:24832
    ds_read_b128 a[120:123], v31 offset:16640
    ds_read_b128 a[124:127], v31 offset:24832
    s_waitcnt lgkmcnt(0)
    s_mov_b32 s27, 1536
    s_add_u32 m0, s26, 16384
    s_nop 0
    buffer_load_dwordx4 v20, s[16:19], s27 offen nt lds
    s_add_u32 m0, s26, 17408
    s_nop 0
    buffer_load_dwordx4 v21, s[16:19], s27 offen nt lds
    s_add_u32 m0, s26, 18432
    s_nop 0
    buffer_load_dwordx4 v22, s[16:19], s27 offen nt lds
    s_add_u32 m0, s26, 19456
    s_nop 0
    buffer_load_dwordx4 v23, s[16:19], s27 offen nt lds
    s_add_u32 m0, s26, 20480
    s_nop 0
    buffer_load_dwordx4 v24, s[16:19], s27 offen nt lds
    s_add_u32 m0, s26, 21504
    s_nop 0
    buffer_load_dwordx4 v25, s[16:19], s27 offen nt lds
    s_add_u32 m0, s26, 22528
    s_nop 0
    buffer_load_dwordx4 v26, s[16:19], s27 offen nt lds
    s_add_u32 m0, s26, 23552
    s_nop 0
    buffer_load_dwordx4 v27, s[16:19], s27 offen nt lds
    s_mov_b32 s27, 9728
    s_add_u32 m0, s26, 24576
    s_nop 0
    buffer_load_dwordx4 v20, s[16:19], s27 offen nt lds
    s_add_u32 m0, s26, 25600
    s_nop 0
    buffer_load_dwordx4 v21, s[16:19], s27 offen nt lds
    s_add_u32 m0, s26, 26624
    s_nop 0
    buffer_load_dwordx4 v22, s[16:19], s27 offen nt lds
    s_add_u32 m0, s26, 27648
    s_nop 0
    buffer_load_dwordx4 v23, s[16:19], s27 offen nt lds
    s_add_u32 m0, s26, 28672
    s_nop 0
    buffer_load_dwordx4 v24, s[16:19], s27 offen nt lds
    s_add_u32 m0, s26, 29696
    s_nop 0
    buffer_load_dwordx4 v25, s[16:19], s27 offen nt lds
    s_add_u32 m0, s26, 30720
    s_nop 0
    buffer_load_dwordx4 v26, s[16:19], s27 offen nt lds
    s_add_u32 m0, s26, 31744
    s_nop 0
    buffer_load_dwordx4 v27, s[16:19], s27 offen nt lds
    s_waitcnt vmcnt(16)
    ds_read_b128 a[128:131], v28 offset:0
    ds_read_b128 a[132:135], v28 offset:8192
    ds_read_b128 a[136:139], v29 offset:0
    ds_read_b128 a[140:143], v29 offset:8192
    ds_read_b128 a[144:147], v30 offset:0
    ds_read_b128 a[148:151], v30 offset:8192
    ds_read_b128 a[152:155], v31 offset:0
    ds_read_b128 a[156:159], v31 offset:8192
    s_waitcnt lgkmcnt(0)
    ds_read_b128 a[160:163], v28 offset:256
    ds_read_b128 a[164:167], v28 offset:8448
    ds_read_b128 a[168:171], v29 offset:256
    ds_read_b128 a[172:175], v29 offset:8448
    ds_read_b128 a[176:179], v30 offset:256
    ds_read_b128 a[180:183], v30 offset:8448
    ds_read_b128 a[184:187], v31 offset:256
    ds_read_b128 a[188:191], v31 offset:8448
    s_waitcnt lgkmcnt(0)
    s_waitcnt vmcnt(0)
    ds_read_b128 a[192:195], v28 offset:16384
    ds_read_b128 a[196:199], v28 offset:24576
    ds_read_b128 a[200:203], v29 offset:16384
    ds_read_b128 a[204:207], v29 offset:24576
    ds_read_b128 a[208:211], v30 offset:16384
    ds_read_b128 a[212:215], v30 offset:24576
    ds_read_b128 a[216:219], v31 offset:16384
    ds_read_b128 a[220:223], v31 offset:24576
    s_waitcnt lgkmcnt(0)
    ds_read_b128 a[224:227], v28 offset:16640
    ds_read_b128 a[228:231], v28 offset:24832
    ds_read_b128 a[232:235], v29 offset:16640
    ds_read_b128 a[236:239], v29 offset:24832
    ds_read_b128 a[240:243], v30 offset:16640
    ds_read_b128 a[244:247], v30 offset:24832
    ds_read_b128 a[248:251], v31 offset:16640
    ds_read_b128 a[252:255], v31 offset:24832
    s_waitcnt lgkmcnt(0)
    v_lshlrev_b32 v128, 16, v132
    v_and_b32 v129, 0xffff0000, v132
    v_lshlrev_b32 v130, 16, v133
    v_and_b32 v131, 0xffff0000, v133
    s_mov_b32 s48, 0x5902000
    s_lshl_b32 s50, s47, 16
    s_add_u32 s50, s50, 0x4400000
    s_mov_b32 s8, s100
    s_and_b32 s9, s101, 0xffff
    s_mov_b32 s10, 0x10000000
    s_mov_b32 s11, 0x00020000
    s_mov_b32 s16, s96
    s_and_b32 s17, s97, 0xffff
    s_mov_b32 s18, 0x1000000
    s_mov_b32 s19, 0x00020000
    s_mov_b32 s32, s64
    s_and_b32 s33, s65, 0xffff
    s_mov_b32 s34, 0x400000
    s_mov_b32 s35, 0x00020000
    s_lshl_b32 s47, s47, 8
    s_lshl_b32 s21, s49, 12
    v_and_b32 v1, 63, v0
    v_and_b32 v2, 15, v0
    v_bfe_u32 v3, v0, 4, 2
    v_lshrrev_b32 v4, 6, v0
    v_lshlrev_b32 v5, 4, v1
    v_lshl_add_u32 v5, v4, 12, v5
    v_add_u32 v8, 0, v5
    v_add_u32 v9, 1024, v5
    v_add_u32 v10, 2048, v5
    v_add_u32 v11, 3072, v5
    v_lshlrev_b32 v5, 4, v2
    v_lshl_add_u32 v5, v3, 9, v5
    v_xor_b32 v12, s47, v5
    v_xor_b32 v13, 0x100, v12
    v_add_u32 v16, 0x10000, v12
    v_add_u32 v17, 0x10000, v13
    s_mov_b32 s23, 64
    s_mov_b32 s52, 0
    v_mov_b32 v4, 0
    s_sub_u32 s61, s23, 1
    s_mov_b32 s22, 0
    s_mov_b32 s24, 0
    s_add_u32 s51, s24, 1
    s_min_u32 s51, s51, s61
    s_lshl_b32 s51, s51, 7
    s_add_u32 s51, s51, s48
L_gw_266:
    buffer_load_dword v87, v4, s[12:15], s51 offen sc1
    s_add_u32 s36, s36, 1
    s_cmp_gt_u32 s36, 0x100000
    s_cbranch_scc1 chain_kernel_wend
    s_waitcnt vmcnt(0)
    v_readfirstlane_b32 s30, v87
    s_cmp_lt_u32 s30, 16
    s_cbranch_scc0 L_rgo_265
    s_sleep 1
    s_branch L_gw_266
L_rgo_265:
    s_add_u32 s51, s24, 1
    s_min_u32 s51, s51, s61
    s_lshl_b32 s51, s51, 7
    s_add_u32 s51, s51, s48
    buffer_load_dword v87, v4, s[12:15], s51 offen sc1
    s_mov_b32 s37, 0
    s_mov_b32 s7, 0
    v_mov_b32 v88, 0
    v_mov_b32 v89, 0
    v_mov_b32 v90, 0
    v_mov_b32 v91, 0
    v_mov_b32 v92, 0
    v_mov_b32 v93, 0
    v_mov_b32 v94, 0
    v_mov_b32 v95, 0
    s_lshl_b32 s53, s24, 17
    s_add_u32 s53, s53, s50
    s_mov_b32 s20, s53
    s_mov_b32 s39, 0x7ff00000
    s_mov_b32 s42, 0x7ff00000
    s_mov_b32 s43, 0x7ff00000
    s_barrier
    s_add_u32 m0, s21, 0
    s_nop 0
    buffer_load_dwordx4 v8, s[8:11], s20 offen lds
    s_add_u32 m0, s21, 1024
    s_nop 0
    buffer_load_dwordx4 v9, s[8:11], s20 offen lds
    s_add_u32 m0, s21, 2048
    s_nop 0
    buffer_load_dwordx4 v10, s[8:11], s20 offen lds
    s_add_u32 m0, s21, 3072
    s_nop 0
    buffer_load_dwordx4 v11, s[8:11], s20 offen lds
    s_add_u32 s20, s20, 16384
    s_add_u32 m0, s21, 16384
    s_nop 0
    buffer_load_dwordx4 v8, s[8:11], s20 offen lds
    s_add_u32 m0, s21, 17408
    s_nop 0
    buffer_load_dwordx4 v9, s[8:11], s20 offen lds
    s_add_u32 m0, s21, 18432
    s_nop 0
    buffer_load_dwordx4 v10, s[8:11], s20 offen lds
    s_add_u32 m0, s21, 19456
    s_nop 0
    buffer_load_dwordx4 v11, s[8:11], s20 offen lds
    s_add_u32 s20, s20, 16384
    s_add_u32 m0, s21, 32768
    s_nop 0
    buffer_load_dwordx4 v8, s[8:11], s20 offen lds
    s_add_u32 m0, s21, 33792
    s_nop 0
    buffer_load_dwordx4 v9, s[8:11], s20 offen lds
    s_add_u32 m0, s21, 34816
    s_nop 0
    buffer_load_dwordx4 v10, s[8:11], s20 offen lds
    s_add_u32 m0, s21, 35840
    s_nop 0
    buffer_load_dwordx4 v11, s[8:11], s20 offen lds
    s_add_u32 s20, s20, 16384
    s_add_u32 m0, s21, 49152
    s_nop 0
    buffer_load_dwordx4 v8, s[8:11], s20 offen lds
    s_waitcnt vmcnt(0)
    s_barrier
    ds_read_b128 v[20:23], v12 offset:0
    ds_read_b128 v[24:27], v13 offset:0
    ds_read_b128 v[28:31], v12 offset:2048
    ds_read_b128 v[32:35], v13 offset:2048
    ds_read_b128 v[36:39], v12 offset:4096
    ds_read_b128 v[40:43], v13 offset:4096
    s_waitcnt lgkmcnt(4)
L_st_270:
    v_mfma_f32_16x16x32_bf16 v[52:55], a[0:3], v[20:23], 0
    ds_read_b128 v[44:47], v12 offset:6144
    s_add_u32 m0, s21, 50176
    v_mfma_f32_16x16x32_bf16 v[56:59], a[4:7], v[20:23], 0
    buffer_load_dwordx4 v9, s[8:11], s20 offen lds
    v_mfma_f32_16x16x32_bf16 v[60:63], a[0:3], v[24:27], 0
    ds_read_b128 v[48:51], v13 offset:6144
    s_sub_u32 s38, s22, 1
    v_mfma_f32_16x16x32_bf16 v[64:67], a[4:7], v[24:27], 0
    s_waitcnt lgkmcnt(4)
    s_and_b32 s31, s38, 3
    v_mfma_f32_16x16x32_bf16 v[52:55], a[8:11], v[28:31], v[52:55]
    ds_read_b128 v[20:23], v12 offset:8192
    s_lshl_b32 s31, s31, 11
    v_mfma_f32_16x16x32_bf16 v[56:59], a[12:15], v[28:31], v[56:59]
    buffer_load_dwordx2 v[132:133], v136, s[32:35], s42 offen
    v_mfma_f32_16x16x32_bf16 v[60:63], a[8:11], v[32:35], v[60:63]
    ds_read_b128 v[24:27], v13 offset:8192
    s_add_u32 s24, s24, 1
    v_mfma_f32_16x16x32_bf16 v[64:67], a[12:15], v[32:35], v[64:67]
    s_waitcnt lgkmcnt(4)
    s_min_u32 s24, s24, s61
    v_mfma_f32_16x16x32_bf16 v[52:55], a[16:19], v[36:39], v[52:55]
    ds_read_b128 v[28:31], v12 offset:10240
    s_add_u32 m0, s21, 51200
    s_lshl_b32 s53, s24, 17
    v_mfma_f32_16x16x32_bf16 v[56:59], a[20:23], v[36:39], v[56:59]
    buffer_load_dwordx4 v10, s[8:11], s20 offen lds
    v_mfma_f32_16x16x32_bf16 v[60:63], a[16:19], v[40:43], v[60:63]
    ds_read_b128 v[32:35], v13 offset:10240
    s_add_u32 s53, s53, s50
    v_mfma_f32_16x16x32_bf16 v[64:67], a[20:23], v[40:43], v[64:67]
    s_waitcnt lgkmcnt(4)
    s_waitcnt vmcnt(11)
    v_mfma_f32_16x16x32_bf16 v[52:55], a[24:27], v[44:47], v[52:55]
    ds_read_b128 v[36:39], v12 offset:12288
    v_readfirstlane_b32 s30, v87
    v_mfma_f32_16x16x32_bf16 v[56:59], a[28:31], v[44:47], v[56:59]
    s_nop 0
    buffer_load_dwordx2 v[134:135], v137, s[32:35], s42 offen
    v_mfma_f32_16x16x32_bf16 v[60:63], a[24:27], v[48:51], v[60:63]
    ds_read_b128 v[40:43], v13 offset:12288
    s_nop 0
    v_mfma_f32_16x16x32_bf16 v[64:67], a[28:31], v[48:51], v[64:67]
    s_waitcnt lgkmcnt(4)
    s_cmp_lt_u32 s30, 16
    s_cbranch_scc1 L_gw_274
L_gok_273:
    v_mfma_f32_16x16x32_bf16 v[52:55], a[32:35], v[20:23], v[52:55]
    ds_read_b128 v[44:47], v12 offset:14336
    s_add_u32 m0, s21, 52224
    v_mfma_f32_16x16x32_bf16 v[56:59], a[36:39], v[20:23], v[56:59]
    buffer_load_dwordx4 v11, s[8:11], s20 offen lds
    v_mfma_f32_16x16x32_bf16 v[60:63], a[32:35], v[24:27], v[60:63]
    ds_read_b128 v[48:51], v13 offset:14336
    s_bfe_u32 s38, s38, 0x10002
    v_mfma_f32_16x16x32_bf16 v[64:67], a[36:39], v[24:27], v[64:67]
    s_waitcnt lgkmcnt(4)
    s_xor_b32 s38, s38, 1
    v_mfma_f32_16x16x32_bf16 v[52:55], a[40:43], v[28:31], v[52:55]
    s_waitcnt vmcnt(14)
    s_barrier
    ds_read_b128 v[20:23], v12 offset:16384
    v_mfma_f32_16x16x32_bf16 v[56:59], a[44:47], v[28:31], v[56:59]
    s_mov_b32 s20, s53
    s_cmp_eq_u32 s37, 0
    s_cselect_b32 s31, 0x40000000, s31
    s_cselect_b32 s38, 0, s38
    v_mfma_f32_16x16x32_bf16 v[60:63], a[40:43], v[32:35], v[60:63]
    ds_read_b128 v[24:27], v13 offset:16384
    v_mfma_f32_16x16x32_bf16 v[64:67], a[44:47], v[32:35], v[64:67]
    s_waitcnt lgkmcnt(4)
    v_mfma_f32_16x16x32_bf16 v[52:55], a[48:51], v[36:39], v[52:55]
    ds_read_b128 v[28:31], v12 offset:18432
    s_add_u32 m0, s21, 65536
    v_mfma_f32_16x16x32_bf16 v[56:59], a[52:55], v[36:39], v[56:59]
    buffer_load_dwordx4 v8, s[8:11], s20 offen lds
    v_mfma_f32_16x16x32_bf16 v[60:63], a[48:51], v[40:43], v[60:63]
    ds_read_b128 v[32:35], v13 offset:18432
    v_cvt_pk_bf16_f32 v104, v76, v77
    v_mfma_f32_16x16x32_bf16 v[64:67], a[52:55], v[40:43], v[64:67]
    s_waitcnt lgkmcnt(4)
    v_cvt_pk_bf16_f32 v105, v78, v79
    v_mfma_f32_16x16x32_bf16 v[52:55], a[56:59], v[44:47], v[52:55]
    ds_read_b128 v[36:39], v12 offset:20480
    v_cvt_pk_bf16_f32 v106, v80, v81
    v_mfma_f32_16x16x32_bf16 v[56:59], a[60:63], v[44:47], v[56:59]
    v_cvt_pk_bf16_f32 v107, v82, v83
    v_and_or_b32 v104, v104, -2, s38
    v_mfma_f32_16x16x32_bf16 v[60:63], a[56:59], v[48:51], v[60:63]
    ds_read_b128 v[40:43], v13 offset:20480
    v_and_or_b32 v105, v105, -2, s38
    v_mfma_f32_16x16x32_bf16 v[64:67], a[60:63], v[48:51], v[64:67]
    s_waitcnt lgkmcnt(4)
    v_and_or_b32 v106, v106, -2, s38
    v_mfma_f32_16x16x32_bf16 v[52:55], a[64:67], v[20:23], v[52:55]
    ds_read_b128 v[44:47], v12 offset:22528
    s_add_u32 m0, s21, 66560
    v_mfma_f32_16x16x32_bf16 v[56:59], a[68:71], v[20:23], v[56:59]
    buffer_load_dwordx4 v9, s[8:11], s20 offen lds
    v_mfma_f32_16x16x32_bf16 v[60:63], a[64:67], v[24:27], v[60:63]
    ds_read_b128 v[48:51], v13 offset:22528
    v_and_or_b32 v107, v107, -2, s38
    v_mfma_f32_16x16x32_bf16 v[64:67], a[68:71], v[24:27], v[64:67]
    s_waitcnt lgkmcnt(4)
    s_add_u32 s29, s45, s31
    v_mfma_f32_16x16x32_bf16 v[52:55], a[72:75], v[28:31], v[52:55]
    ds_read_b128 v[20:23], v12 offset:24576
    v_mfma_f32_16x16x32_bf16 v[56:59], a[76:79], v[28:31], v[56:59]
    buffer_store_dwordx4 v[104:107], v112, s[12:15], s29 offen offset:0 sc1
    v_mfma_f32_16x16x32_bf16 v[60:63], a[72:75], v[32:35], v[60:63]
    ds_read_b128 v[24:27], v13 offset:24576
    v_mfma_f32_16x16x32_bf16 v[64:67], a[76:79], v[32:35], v[64:67]
    s_waitcnt lgkmcnt(4)
    v_mfma_f32_16x16x32_bf16 v[52:55], a[80:83], v[36:39], v[52:55]
    ds_read_b128 v[28:31], v12 offset:26624
    s_add_u32 m0, s21, 67584
    v_mfma_f32_16x16x32_bf16 v[56:59], a[84:87], v[36:39], v[56:59]
    buffer_load_dwordx4 v10, s[8:11], s20 offen lds
    v_mfma_f32_16x16x32_bf16 v[60:63], a[80:83], v[40:43], v[60:63]
    ds_read_b128 v[32:35], v13 offset:26624
    v_mfma_f32_16x16x32_bf16 v[64:67], a[84:87], v[40:43], v[64:67]
    s_waitcnt lgkmcnt(4)
    v_mfma_f32_16x16x32_bf16 v[52:55], a[88:91], v[44:47], v[52:55]
    ds_read_b128 v[36:39], v12 offset:28672
    v_mfma_f32_16x16x32_bf16 v[56:59], a[92:95], v[44:47], v[56:59]
    v_mfma_f32_16x16x32_bf16 v[60:63], a[88:91], v[48:51], v[60:63]
    ds_read_b128 v[40:43], v13 offset:28672
    v_mfma_f32_16x16x32_bf16 v[64:67], a[92:95], v[48:51], v[64:67]
    s_waitcnt lgkmcnt(4)
    v_mfma_f32_16x16x32_bf16 v[52:55], a[96:99], v[20:23], v[52:55]
    ds_read_b128 v[44:47], v12 offset:30720
    s_add_u32 m0, s21, 68608
    v_mfma_f32_16x16x32_bf16 v[56:59], a[100:103], v[20:23], v[56:59]
    buffer_load_dwordx4 v11, s[8:11], s20 offen lds
    v_mfma_f32_16x16x32_bf16 v[60:63], a[96:99], v[24:27], v[60:63]
    ds_read_b128 v[48:51], v13 offset:30720
    v_mfma_f32_16x16x32_bf16 v[64:67], a[100:103], v[24:27], v[64:67]
    s_waitcnt lgkmcnt(4)
    v_mfma_f32_16x16x32_bf16 v[52:55], a[104:107], v[28:31], v[52:55]
    s_waitcnt vmcnt(12)
    s_barrier
    ds_read_b128 v[20:23], v12 offset:32768
    v_mfma_f32_16x16x32_bf16 v[56:59], a[108:111], v[28:31], v[56:59]
    s_add_u32 s20, s20, 16384
    v_mfma_f32_16x16x32_bf16 v[60:63], a[104:107], v[32:35], v[60:63]
    ds_read_b128 v[24:27], v13 offset:32768
    s_waitcnt vmcnt(10)
    v_xor_b32 v124, s7, v88
    v_mfma_f32_16x16x32_bf16 v[64:67], a[108:111], v[32:35], v[64:67]
    s_waitcnt lgkmcnt(4)
    v_bitop3_b32 v124, v124, v89, s7 bitop3:0xf6
    v_mfma_f32_16x16x32_bf16 v[52:55], a[112:115], v[36:39], v[52:55]
    ds_read_b128 v[28:31], v12 offset:34816
    s_add_u32 m0, s21, 81920
    v_bitop3_b32 v124, v124, v90, s7 bitop3:0xf6
    v_mfma_f32_16x16x32_bf16 v[56:59], a[116:119], v[36:39], v[56:59]
    buffer_load_dwordx4 v8, s[8:11], s20 offen lds
    v_bitop3_b32 v124, v124, v91, s7 bitop3:0xf6
    v_mfma_f32_16x16x32_bf16 v[60:63], a[112:115], v[40:43], v[60:63]
    ds_read_b128 v[32:35], v13 offset:34816
    v_and_b32 v124, 1, v124
    v_mfma_f32_16x16x32_bf16 v[64:67], a[116:119], v[40:43], v[64:67]
    s_waitcnt lgkmcnt(4)
    v_cmp_ne_u32 vcc, 0, v124
    s_nop 0
    v_mfma_f32_16x16x32_bf16 v[52:55], a[120:123], v[44:47], v[52:55]
    ds_read_b128 v[36:39], v12 offset:36864
    s_nop 0
    v_mfma_f32_16x16x32_bf16 v[56:59], a[124:127], v[44:47], v[56:59]
    s_nop 0
    s_cbranch_vccnz L_rbad_271
L_rok_272:
    v_mfma_f32_16x16x32_bf16 v[60:63], a[120:123], v[48:51], v[60:63]
    ds_read_b128 v[40:43], v13 offset:36864
    v_lshlrev_b32 v124, 16, v88
    v_mfma_f32_16x16x32_bf16 v[64:67], a[124:127], v[48:51], v[64:67]
    s_waitcnt lgkmcnt(4)
    v_and_b32 v125, 0xffff0000, v88
    v_mfma_f32_16x16x32_bf16 v[52:55], a[128:131], v[20:23], v[52:55]
    ds_read_b128 v[44:47], v12 offset:38912
    s_add_u32 m0, s21, 82944
    v_add_f32 v96, v116, v124
    v_mfma_f32_16x16x32_bf16 v[56:59], a[132:135], v[20:23], v[56:59]
    buffer_load_dwordx4 v9, s[8:11], s20 offen lds
    v_add_f32 v97, v117, v125
    v_mfma_f32_16x16x32_bf16 v[60:63], a[128:131], v[24:27], v[60:63]
    ds_read_b128 v[48:51], v13 offset:38912
    v_lshlrev_b32 v124, 16, v89
    v_mfma_f32_16x16x32_bf16 v[64:67], a[132:135], v[24:27], v[64:67]
    s_waitcnt lgkmcnt(4)
    v_and_b32 v125, 0xffff0000, v89
    v_add_f32 v98, v118, v124
    v_mfma_f32_16x16x32_bf16 v[52:55], a[136:139], v[28:31], v[52:55]
    ds_read_b128 v[20:23], v12 offset:40960
    v_add_f32 v99, v119, v125
    v_mfma_f32_16x16x32_bf16 v[56:59], a[140:143], v[28:31], v[56:59]
    v_lshlrev_b32 v124, 16, v90
    v_and_b32 v125, 0xffff0000, v90
    v_mfma_f32_16x16x32_bf16 v[60:63], a[136:139], v[32:35], v[60:63]
    ds_read_b128 v[24:27], v13 offset:40960
    s_add_u32 s51, s24, 1
    v_add_f32 v100, v120, v124
    v_mfma_f32_16x16x32_bf16 v[64:67], a[140:143], v[32:35], v[64:67]
    s_waitcnt lgkmcnt(4)
    v_add_f32 v101, v121, v125
    v_mfma_f32_16x16x32_bf16 v[52:55], a[144:147], v[36:39], v[52:55]
    ds_read_b128 v[28:31], v12 offset:43008
    s_add_u32 m0, s21, 83968
    v_lshlrev_b32 v124, 16, v91
    v_mfma_f32_16x16x32_bf16 v[56:59], a[148:151], v[36:39], v[56:59]
    buffer_load_dwordx4 v10, s[8:11], s20 offen lds
    v_and_b32 v125, 0xffff0000, v91
    v_mfma_f32_16x16x32_bf16 v[60:63], a[144:147], v[40:43], v[60:63]
    ds_read_b128 v[32:35], v13 offset:43008
    s_min_u32 s51, s51, s61
    v_add_f32 v102, v122, v124
    v_mfma_f32_16x16x32_bf16 v[64:67], a[148:151], v[40:43], v[64:67]
    s_waitcnt lgkmcnt(4)
    v_add_f32 v103, v123, v125
    v_mfma_f32_16x16x32_bf16 v[52:55], a[152:155], v[44:47], v[52:55]
    ds_read_b128 v[36:39], v12 offset:45056
    ds_write_b128 v114, v[96:99]
    ds_write_b128 v115, v[100:103]
    v_mfma_f32_16x16x32_bf16 v[56:59], a[156:159], v[44:47], v[56:59]
    s_lshl_b32 s51, s51, 7
    ds_read_b128 v[88:91], v113 offset:0
    v_mfma_f32_16x16x32_bf16 v[60:63], a[152:155], v[48:51], v[60:63]
    ds_read_b128 v[40:43], v13 offset:45056
    ds_read_b128 v[92:95], v113 offset:1024
    v_mfma_f32_16x16x32_bf16 v[64:67], a[156:159], v[48:51], v[64:67]
    s_waitcnt lgkmcnt(4)
    s_add_u32 s51, s51, s48
    v_mfma_f32_16x16x32_bf16 v[52:55], a[160:163], v[20:23], v[52:55]
    ds_read_b128 v[44:47], v12 offset:47104
    s_add_u32 m0, s21, 84992
    v_mfma_f32_16x16x32_bf16 v[56:59], a[164:167], v[20:23], v[56:59]
    buffer_load_dwordx4 v11, s[8:11], s20 offen lds
    v_mfma_f32_16x16x32_bf16 v[60:63], a[160:163], v[24:27], v[60:63]
    ds_read_b128 v[48:51], v13 offset:47104
    s_waitcnt lgkmcnt(2)
    s_waitcnt vmcnt(10)
    v_mfma_f32_16x16x32_bf16 v[64:67], a[164:167], v[24:27], v[64:67]
    s_waitcnt lgkmcnt(4)
    v_lshlrev_b32 v140, 16, v132
    v_and_b32 v141, 0xffff0000, v132
    v_mfma_f32_16x16x32_bf16 v[52:55], a[168:171], v[28:31], v[52:55]
    s_waitcnt vmcnt(9)
    s_barrier
    ds_read_b128 v[20:23], v12 offset:49152
    v_mul_f32 v140, v140, v128
    v_mfma_f32_16x16x32_bf16 v[56:59], a[172:175], v[28:31], v[56:59]
    s_add_u32 s20, s20, 16384
    buffer_load_dword v87, v4, s[12:15], s51 offen sc1
    v_mfma_f32_16x16x32_bf16 v[60:63], a[168:171], v[32:35], v[60:63]
    ds_read_b128 v[24:27], v13 offset:49152
    v_mul_f32 v141, v141, v129
    v_cvt_pk_bf16_f32 v140, 0, v140
    v_mfma_f32_16x16x32_bf16 v[64:67], a[172:175], v[32:35], v[64:67]
    s_waitcnt lgkmcnt(4)
    v_cvt_pk_bf16_f32 v141, 0, v141
    v_add_f32 v96, v88, v140
    v_mfma_f32_16x16x32_bf16 v[52:55], a[176:179], v[36:39], v[52:55]
    ds_read_b128 v[28:31], v12 offset:51200
    s_add_u32 m0, s21, 98304
    v_add_f32 v97, v89, v141
    v_mfma_f32_16x16x32_bf16 v[56:59], a[180:183], v[36:39], v[56:59]
    buffer_load_dwordx4 v8, s[8:11], s20 offen lds
    v_lshlrev_b32 v140, 16, v133
    v_and_b32 v141, 0xffff0000, v133
    v_mfma_f32_16x16x32_bf16 v[60:63], a[176:179], v[40:43], v[60:63]
    ds_read_b128 v[32:35], v13 offset:51200
    v_mul_f32 v140, v140, v130
    v_mul_f32 v141, v141, v131
    v_mfma_f32_16x16x32_bf16 v[64:67], a[180:183], v[40:43], v[64:67]
    s_waitcnt lgkmcnt(4)
    v_cvt_pk_bf16_f32 v140, 0, v140
    v_mfma_f32_16x16x32_bf16 v[52:55], a[184:187], v[44:47], v[52:55]
    ds_read_b128 v[36:39], v12 offset:53248
    v_cvt_pk_bf16_f32 v141, 0, v141
    v_add_f32 v98, v90, v140
    v_mfma_f32_16x16x32_bf16 v[56:59], a[188:191], v[44:47], v[56:59]
    v_add_f32 v99, v91, v141
    buffer_store_dwordx4 v[96:99], v138, s[16:19], s43 offen
    v_mfma_f32_16x16x32_bf16 v[60:63], a[184:187], v[48:51], v[60:63]
    ds_read_b128 v[40:43], v13 offset:53248
    v_lshlrev_b32 v140, 16, v134
    v_and_b32 v141, 0xffff0000, v134
    v_mfma_f32_16x16x32_bf16 v[64:67], a[188:191], v[48:51], v[64:67]
    s_waitcnt lgkmcnt(4)
    v_mul_f32 v140, v140, v128
    v_mfma_f32_16x16x32_bf16 v[52:55], a[192:195], v[20:23], v[52:55]
    ds_read_b128 v[44:47], v12 offset:55296
    s_add_u32 m0, s21, 99328
    v_mfma_f32_16x16x32_bf16 v[56:59], a[196:199], v[20:23], v[56:59]
    buffer_load_dwordx4 v9, s[8:11], s20 offen lds
    v_mul_f32 v141, v141, v129
    v_mfma_f32_16x16x32_bf16 v[60:63], a[192:195], v[24:27], v[60:63]
    ds_read_b128 v[48:51], v13 offset:55296
    v_cvt_pk_bf16_f32 v140, 0, v140
    v_mfma_f32_16x16x32_bf16 v[64:67], a[196:199], v[24:27], v[64:67]
    s_waitcnt lgkmcnt(4)
    v_cvt_pk_bf16_f32 v141, 0, v141
    v_mfma_f32_16x16x32_bf16 v[52:55], a[200:203], v[28:31], v[52:55]
    ds_read_b128 v[20:23], v12 offset:57344
    v_add_f32 v100, v92, v140
    v_mfma_f32_16x16x32_bf16 v[56:59], a[204:207], v[28:31], v[56:59]
    v_add_f32 v101, v93, v141
    v_lshlrev_b32 v140, 16, v135
    v_mfma_f32_16x16x32_bf16 v[60:63], a[200:203], v[32:35], v[60:63]
    ds_read_b128 v[24:27], v13 offset:57344
    v_and_b32 v141, 0xffff0000, v135
    v_mfma_f32_16x16x32_bf16 v[64:67], a[204:207], v[32:35], v[64:67]
    s_waitcnt lgkmcnt(4)
    v_mul_f32 v140, v140, v130
    v_mfma_f32_16x16x32_bf16 v[52:55], a[208:211], v[36:39], v[52:55]
    ds_read_b128 v[28:31], v12 offset:59392
    s_add_u32 m0, s21, 100352
    v_mul_f32 v141, v141, v131
    v_mfma_f32_16x16x32_bf16 v[56:59], a[212:215], v[36:39], v[56:59]
    buffer_load_dwordx4 v10, s[8:11], s20 offen lds
    v_mfma_f32_16x16x32_bf16 v[60:63], a[208:211], v[40:43], v[60:63]
    ds_read_b128 v[32:35], v13 offset:59392
    v_cvt_pk_bf16_f32 v140, 0, v140
    v_cvt_pk_bf16_f32 v141, 0, v141
    v_mfma_f32_16x16x32_bf16 v[64:67], a[212:215], v[40:43], v[64:67]
    s_waitcnt lgkmcnt(4)
    v_add_f32 v102, v94, v140
    v_mfma_f32_16x16x32_bf16 v[52:55], a[216:219], v[44:47], v[52:55]
    ds_read_b128 v[36:39], v12 offset:61440
    v_add_f32 v103, v95, v141
    v_mfma_f32_16x16x32_bf16 v[56:59], a[220:223], v[44:47], v[56:59]
    buffer_store_dwordx4 v[100:103], v139, s[16:19], s43 offen
    v_mfma_f32_16x16x32_bf16 v[60:63], a[216:219], v[48:51], v[60:63]
    ds_read_b128 v[40:43], v13 offset:61440
    v_mfma_f32_16x16x32_bf16 v[64:67], a[220:223], v[48:51], v[64:67]
    s_waitcnt lgkmcnt(4)
    v_mfma_f32_16x16x32_bf16 v[52:55], a[224:227], v[20:23], v[52:55]
    ds_read_b128 v[44:47], v12 offset:63488
    s_add_u32 m0, s21, 101376
    v_mov_b32 v116, v68
    v_mfma_f32_16x16x32_bf16 v[56:59], a[228:231], v[20:23], v[56:59]
    buffer_load_dwordx4 v11, s[8:11], s20 offen lds
    v_mov_b32 v117, v69
    v_mfma_f32_16x16x32_bf16 v[60:63], a[224:227], v[24:27], v[60:63]
    ds_read_b128 v[48:51], v13 offset:63488
    v_mov_b32 v118, v70
    v_mov_b32 v119, v71
    v_mfma_f32_16x16x32_bf16 v[64:67], a[228:231], v[24:27], v[64:67]
    s_waitcnt lgkmcnt(4)
    v_mov_b32 v120, v72
    v_mfma_f32_16x16x32_bf16 v[52:55], a[232:235], v[28:31], v[52:55]
    s_waitcnt vmcnt(11)
    s_barrier
    ds_read_b128 v[20:23], v16 offset:0
    v_mfma_f32_16x16x32_bf16 v[56:59], a[236:239], v[28:31], v[56:59]
    s_add_u32 s20, s20, 16384
    v_mov_b32 v121, v73
    v_mov_b32 v122, v74
    v_mfma_f32_16x16x32_bf16 v[60:63], a[232:235], v[32:35], v[60:63]
    ds_read_b128 v[24:27], v17 offset:0
    v_mov_b32 v123, v75
    v_mfma_f32_16x16x32_bf16 v[64:67], a[236:239], v[32:35], v[64:67]
    s_waitcnt lgkmcnt(4)
    s_mov_b32 s7, s38
    s_add_u32 s39, s44, s31
    v_mfma_f32_16x16x32_bf16 v[52:55], a[240:243], v[36:39], v[52:55]
    ds_read_b128 v[28:31], v16 offset:2048
    s_add_u32 m0, s21, 114688
    v_mfma_f32_16x16x32_bf16 v[56:59], a[244:247], v[36:39], v[56:59]
    buffer_load_dwordx4 v8, s[8:11], s20 offen lds
    s_sub_u32 s43, s22, 1
    v_mfma_f32_16x16x32_bf16 v[60:63], a[240:243], v[40:43], v[60:63]
    ds_read_b128 v[32:35], v17 offset:2048
    s_lshl_b32 s42, s43, 16
    s_lshl_b32 s43, s43, 18
    v_mfma_f32_16x16x32_bf16 v[64:67], a[244:247], v[40:43], v[64:67]
    s_waitcnt lgkmcnt(4)
    s_cmp_eq_u32 s37, 0
    s_cselect_b32 s42, 0x7ff00000, s42
    s_cselect_b32 s43, 0x7ff00000, s43
    v_mfma_f32_16x16x32_bf16 v[52:55], a[248:251], v[44:47], v[52:55]
    ds_read_b128 v[36:39], v16 offset:4096
    v_mfma_f32_16x16x32_bf16 v[56:59], a[252:255], v[44:47], v[56:59]
    buffer_load_dwordx4 v[88:91], v112, s[12:15], s39 offen offset:0 sc1
    v_mfma_f32_16x16x32_bf16 v[60:63], a[248:251], v[48:51], v[60:63]
    ds_read_b128 v[40:43], v17 offset:4096
    s_mov_b32 s37, 1
    v_mfma_f32_16x16x32_bf16 v[64:67], a[252:255], v[48:51], v[64:67]
    s_waitcnt lgkmcnt(4)
    s_add_u32 s22, s22, 1
    s_cmp_ge_u32 s22, s23
    s_cbranch_scc1 L_fl0_267
    v_mfma_f32_16x16x32_bf16 v[68:71], a[0:3], v[20:23], 0
    ds_read_b128 v[44:47], v16 offset:6144
    s_add_u32 m0, s21, 115712
    v_mfma_f32_16x16x32_bf16 v[72:75], a[4:7], v[20:23], 0
    buffer_load_dwordx4 v9, s[8:11], s20 offen lds
    v_mfma_f32_16x16x32_bf16 v[76:79], a[0:3], v[24:27], 0
    ds_read_b128 v[48:51], v17 offset:6144
    s_sub_u32 s38, s22, 1
    v_mfma_f32_16x16x32_bf16 v[80:83], a[4:7], v[24:27], 0
    s_waitcnt lgkmcnt(4)
    s_and_b32 s31, s38, 3
    v_mfma_f32_16x16x32_bf16 v[68:71], a[8:11], v[28:31], v[68:71]
    ds_read_b128 v[20:23], v16 offset:8192
    s_lshl_b32 s31, s31, 11
    v_mfma_f32_16x16x32_bf16 v[72:75], a[12:15], v[28:31], v[72:75]
    buffer_load_dwordx2 v[132:133], v136, s[32:35], s42 offen
    v_mfma_f32_16x16x32_bf16 v[76:79], a[8:11], v[32:35], v[76:79]
    ds_read_b128 v[24:27], v17 offset:8192
    s_add_u32 s24, s24, 1
    v_mfma_f32_16x16x32_bf16 v[80:83], a[12:15], v[32:35], v[80:83]
    s_waitcnt lgkmcnt(4)
    s_min_u32 s24, s24, s61
    v_mfma_f32_16x16x32_bf16 v[68:71], a[16:19], v[36:39], v[68:71]
    ds_read_b128 v[28:31], v16 offset:10240
    s_add_u32 m0, s21, 116736
    s_lshl_b32 s53, s24, 17
    v_mfma_f32_16x16x32_bf16 v[72:75], a[20:23], v[36:39], v[72:75]
    buffer_load_dwordx4 v10, s[8:11], s20 offen lds
    v_mfma_f32_16x16x32_bf16 v[76:79], a[16:19], v[40:43], v[76:79]
    ds_read_b128 v[32:35], v17 offset:10240
    s_add_u32 s53, s53, s50
    v_mfma_f32_16x16x32_bf16 v[80:83], a[20:23], v[40:43], v[80:83]
    s_waitcnt lgkmcnt(4)
    s_waitcnt vmcnt(11)
    v_mfma_f32_16x16x32_bf16 v[68:71], a[24:27], v[44:47], v[68:71]
    ds_read_b128 v[36:39], v16 offset:12288
    v_readfirstlane_b32 s30, v87
    v_mfma_f32_16x16x32_bf16 v[72:75], a[28:31], v[44:47], v[72:75]
    s_nop 0
    buffer_load_dwordx2 v[134:135], v137, s[32:35], s42 offen
    v_mfma_f32_16x16x32_bf16 v[76:79], a[24:27], v[48:51], v[76:79]
    ds_read_b128 v[40:43], v17 offset:12288
    s_nop 0
    v_mfma_f32_16x16x32_bf16 v[80:83], a[28:31], v[48:51], v[80:83]
    s_waitcnt lgkmcnt(4)
    s_cmp_lt_u32 s30, 16
    s_cbranch_scc1 L_gw_278
L_gok_277:
    v_mfma_f32_16x16x32_bf16 v[68:71], a[32:35], v[20:23], v[68:71]
    ds_read_b128 v[44:47], v16 offset:14336
    s_add_u32 m0, s21, 117760
    v_mfma_f32_16x16x32_bf16 v[72:75], a[36:39], v[20:23], v[72:75]
    buffer_load_dwordx4 v11, s[8:11], s20 offen lds
    v_mfma_f32_16x16x32_bf16 v[76:79], a[32:35], v[24:27], v[76:79]
    ds_read_b128 v[48:51], v17 offset:14336
    s_bfe_u32 s38, s38, 0x10002
    v_mfma_f32_16x16x32_bf16 v[80:83], a[36:39], v[24:27], v[80:83]
    s_waitcnt lgkmcnt(4)
    s_xor_b32 s38, s38, 1
    v_mfma_f32_16x16x32_bf16 v[68:71], a[40:43], v[28:31], v[68:71]
    s_waitcnt vmcnt(14)
    s_barrier
    ds_read_b128 v[20:23], v16 offset:16384
    v_mfma_f32_16x16x32_bf16 v[72:75], a[44:47], v[28:31], v[72:75]
    s_mov_b32 s20, s53
    s_cmp_eq_u32 s37, 0
    s_cselect_b32 s31, 0x40000000, s31
    s_cselect_b32 s38, 0, s38
    v_mfma_f32_16x16x32_bf16 v[76:79], a[40:43], v[32:35], v[76:79]
    ds_read_b128 v[24:27], v17 offset:16384
    v_mfma_f32_16x16x32_bf16 v[80:83], a[44:47], v[32:35], v[80:83]
    s_waitcnt lgkmcnt(4)
    v_mfma_f32_16x16x32_bf16 v[68:71], a[48:51], v[36:39], v[68:71]
    ds_read_b128 v[28:31], v16 offset:18432
    s_add_u32 m0, s21, 0
    v_mfma_f32_16x16x32_bf16 v[72:75], a[52:55], v[36:39], v[72:75]
    buffer_load_dwordx4 v8, s[8:11], s20 offen lds
    v_mfma_f32_16x16x32_bf16 v[76:79], a[48:51], v[40:43], v[76:79]
    ds_read_b128 v[32:35], v17 offset:18432
    v_cvt_pk_bf16_f32 v104, v60, v61
    v_mfma_f32_16x16x32_bf16 v[80:83], a[52:55], v[40:43], v[80:83]
    s_waitcnt lgkmcnt(4)
    v_cvt_pk_bf16_f32 v105, v62, v63
    v_mfma_f32_16x16x32_bf16 v[68:71], a[56:59], v[44:47], v[68:71]
    ds_read_b128 v[36:39], v16 offset:20480
    v_cvt_pk_bf16_f32 v106, v64, v65
    v_mfma_f32_16x16x32_bf16 v[72:75], a[60:63], v[44:47], v[72:75]
    v_cvt_pk_bf16_f32 v107, v66, v67
    v_and_or_b32 v104, v104, -2, s38
    v_mfma_f32_16x16x32_bf16 v[76:79], a[56:59], v[48:51], v[76:79]
    ds_read_b128 v[40:43], v17 offset:20480
    v_and_or_b32 v105, v105, -2, s38
    v_mfma_f32_16x16x32_bf16 v[80:83], a[60:63], v[48:51], v[80:83]
    s_waitcnt lgkmcnt(4)
    v_and_or_b32 v106, v106, -2, s38
    v_mfma_f32_16x16x32_bf16 v[68:71], a[64:67], v[20:23], v[68:71]
    ds_read_b128 v[44:47], v16 offset:22528
    s_add_u32 m0, s21, 1024
    v_mfma_f32_16x16x32_bf16 v[72:75], a[68:71], v[20:23], v[72:75]
    buffer_load_dwordx4 v9, s[8:11], s20 offen lds
    v_mfma_f32_16x16x32_bf16 v[76:79], a[64:67], v[24:27], v[76:79]
    ds_read_b128 v[48:51], v17 offset:22528
    v_and_or_b32 v107, v107, -2, s38
    v_mfma_f32_16x16x32_bf16 v[80:83], a[68:71], v[24:27], v[80:83]
    s_waitcnt lgkmcnt(4)
    s_add_u32 s29, s45, s31
    v_mfma_f32_16x16x32_bf16 v[68:71], a[72:75], v[28:31], v[68:71]
    ds_read_b128 v[20:23], v16 offset:24576
    v_mfma_f32_16x16x32_bf16 v[72:75], a[76:79], v[28:31], v[72:75]
    buffer_store_dwordx4 v[104:107], v112, s[12:15], s29 offen offset:0 sc1
    v_mfma_f32_16x16x32_bf16 v[76:79], a[72:75], v[32:35], v[76:79]
    ds_read_b128 v[24:27], v17 offset:24576
    v_mfma_f32_16x16x32_bf16 v[80:83], a[76:79], v[32:35], v[80:83]
    s_waitcnt lgkmcnt(4)
    v_mfma_f32_16x16x32_bf16 v[68:71], a[80:83], v[36:39], v[68:71]
    ds_read_b128 v[28:31], v16 offset:26624
    s_add_u32 m0, s21, 2048
    v_mfma_f32_16x16x32_bf16 v[72:75], a[84:87], v[36:39], v[72:75]
    buffer_load_dwordx4 v10, s[8:11], s20 offen lds
    v_mfma_f32_16x16x32_bf16 v[76:79], a[80:83], v[40:43], v[76:79]
    ds_read_b128 v[32:35], v17 offset:26624
    v_mfma_f32_16x16x32_bf16 v[80:83], a[84:87], v[40:43], v[80:83]
    s_waitcnt lgkmcnt(4)
    v_mfma_f32_16x16x32_bf16 v[68:71], a[88:91], v[44:47], v[68:71]
    ds_read_b128 v[36:39], v16 offset:28672
    v_mfma_f32_16x16x32_bf16 v[72:75], a[92:95], v[44:47], v[72:75]
    v_mfma_f32_16x16x32_bf16 v[76:79], a[88:91], v[48:51], v[76:79]
    ds_read_b128 v[40:43], v17 offset:28672
    v_mfma_f32_16x16x32_bf16 v[80:83], a[92:95], v[48:51], v[80:83]
    s_waitcnt lgkmcnt(4)
    v_mfma_f32_16x16x32_bf16 v[68:71], a[96:99], v[20:23], v[68:71]
    ds_read_b128 v[44:47], v16 offset:30720
    s_add_u32 m0, s21, 3072
    v_mfma_f32_16x16x32_bf16 v[72:75], a[100:103], v[20:23], v[72:75]
    buffer_load_dwordx4 v11, s[8:11], s20 offen lds
    v_mfma_f32_16x16x32_bf16 v[76:79], a[96:99], v[24:27], v[76:79]
    ds_read_b128 v[48:51], v17 offset:30720
    v_mfma_f32_16x16x32_bf16 v[80:83], a[100:103], v[24:27], v[80:83]
    s_waitcnt lgkmcnt(4)
    v_mfma_f32_16x16x32_bf16 v[68:71], a[104:107], v[28:31], v[68:71]
    s_waitcnt vmcnt(12)
    s_barrier
    ds_read_b128 v[20:23], v16 offset:32768
    v_mfma_f32_16x16x32_bf16 v[72:75], a[108:111], v[28:31], v[72:75]
    s_add_u32 s20, s20, 16384
    v_mfma_f32_16x16x32_bf16 v[76:79], a[104:107], v[32:35], v[76:79]
    ds_read_b128 v[24:27], v17 offset:32768
    s_waitcnt vmcnt(10)
    v_xor_b32 v124, s7, v88
    v_mfma_f32_16x16x32_bf16 v[80:83], a[108:111], v[32:35], v[80:83]
    s_waitcnt lgkmcnt(4)
    v_bitop3_b32 v124, v124, v89, s7 bitop3:0xf6
    v_mfma_f32_16x16x32_bf16 v[68:71], a[112:115], v[36:39], v[68:71]
    ds_read_b128 v[28:31], v16 offset:34816
    s_add_u32 m0, s21, 16384
    v_bitop3_b32 v124, v124, v90, s7 bitop3:0xf6
    v_mfma_f32_16x16x32_bf16 v[72:75], a[116:119], v[36:39], v[72:75]
    buffer_load_dwordx4 v8, s[8:11], s20 offen lds
    v_bitop3_b32 v124, v124, v91, s7 bitop3:0xf6
    v_mfma_f32_16x16x32_bf16 v[76:79], a[112:115], v[40:43], v[76:79]
    ds_read_b128 v[32:35], v17 offset:34816
    v_and_b32 v124, 1, v124
    v_mfma_f32_16x16x32_bf16 v[80:83], a[116:119], v[40:43], v[80:83]
    s_waitcnt lgkmcnt(4)
    v_cmp_ne_u32 vcc, 0, v124
    s_nop 0
    v_mfma_f32_16x16x32_bf16 v[68:71], a[120:123], v[44:47], v[68:71]
    ds_read_b128 v[36:39], v16 offset:36864
    s_nop 0
    v_mfma_f32_16x16x32_bf16 v[72:75], a[124:127], v[44:47], v[72:75]
    s_nop 0
    s_cbranch_vccnz L_rbad_275
L_rok_276:
    v_mfma_f32_16x16x32_bf16 v[76:79], a[120:123], v[48:51], v[76:79]
    ds_read_b128 v[40:43], v17 offset:36864
    v_lshlrev_b32 v124, 16, v88
    v_mfma_f32_16x16x32_bf16 v[80:83], a[124:127], v[48:51], v[80:83]
    s_waitcnt lgkmcnt(4)
    v_and_b32 v125, 0xffff0000, v88
    v_mfma_f32_16x16x32_bf16 v[68:71], a[128:131], v[20:23], v[68:71]
    ds_read_b128 v[44:47], v16 offset:38912
    s_add_u32 m0, s21, 17408
    v_add_f32 v96, v116, v124
    v_mfma_f32_16x16x32_bf16 v[72:75], a[132:135], v[20:23], v[72:75]
    buffer_load_dwordx4 v9, s[8:11], s20 offen lds
    v_add_f32 v97, v117, v125
    v_mfma_f32_16x16x32_bf16 v[76:79], a[128:131], v[24:27], v[76:79]
    ds_read_b128 v[48:51], v17 offset:38912
    v_lshlrev_b32 v124, 16, v89
    v_mfma_f32_16x16x32_bf16 v[80:83], a[132:135], v[24:27], v[80:83]
    s_waitcnt lgkmcnt(4)
    v_and_b32 v125, 0xffff0000, v89
    v_add_f32 v98, v118, v124
    v_mfma_f32_16x16x32_bf16 v[68:71], a[136:139], v[28:31], v[68:71]
    ds_read_b128 v[20:23], v16 offset:40960
    v_add_f32 v99, v119, v125
    v_mfma_f32_16x16x32_bf16 v[72:75], a[140:143], v[28:31], v[72:75]
    v_lshlrev_b32 v124, 16, v90
    v_and_b32 v125, 0xffff0000, v90
    v_mfma_f32_16x16x32_bf16 v[76:79], a[136:139], v[32:35], v[76:79]
    ds_read_b128 v[24:27], v17 offset:40960
    s_add_u32 s51, s24, 1
    v_add_f32 v100, v120, v124
    v_mfma_f32_16x16x32_bf16 v[80:83], a[140:143], v[32:35], v[80:83]
    s_waitcnt lgkmcnt(4)
    v_add_f32 v101, v121, v125
    v_mfma_f32_16x16x32_bf16 v[68:71], a[144:147], v[36:39], v[68:71]
    ds_read_b128 v[28:31], v16 offset:43008
    s_add_u32 m0, s21, 18432
    v_lshlrev_b32 v124, 16, v91
    v_mfma_f32_16x16x32_bf16 v[72:75], a[148:151], v[36:39], v[72:75]
    buffer_load_dwordx4 v10, s[8:11], s20 offen lds
    v_and_b32 v125, 0xffff0000, v91
    v_mfma_f32_16x16x32_bf16 v[76:79], a[144:147], v[40:43], v[76:79]
    ds_read_b128 v[32:35], v17 offset:43008
    s_min_u32 s51, s51, s61
    v_add_f32 v102, v122, v124
    v_mfma_f32_16x16x32_bf16 v[80:83], a[148:151], v[40:43], v[80:83]
    s_waitcnt lgkmcnt(4)
    v_add_f32 v103, v123, v125
    v_mfma_f32_16x16x32_bf16 v[68:71], a[152:155], v[44:47], v[68:71]
    ds_read_b128 v[36:39], v16 offset:45056
    ds_write_b128 v114, v[96:99]
    ds_write_b128 v115, v[100:103]
    v_mfma_f32_16x16x32_bf16 v[72:75], a[156:159], v[44:47], v[72:75]
    s_lshl_b32 s51, s51, 7
    ds_read_b128 v[88:91], v113 offset:0
    v_mfma_f32_16x16x32_bf16 v[76:79], a[152:155], v[48:51], v[76:79]
    ds_read_b128 v[40:43], v17 offset:45056
    ds_read_b128 v[92:95], v113 offset:1024
    v_mfma_f32_16x16x32_bf16 v[80:83], a[156:159], v[48:51], v[80:83]
    s_waitcnt lgkmcnt(4)
    s_add_u32 s51, s51, s48
    v_mfma_f32_16x16x32_bf16 v[68:71], a[160:163], v[20:23], v[68:71]
    ds_read_b128 v[44:47], v16 offset:47104
    s_add_u32 m0, s21, 19456
    v_mfma_f32_16x16x32_bf16 v[72:75], a[164:167], v[20:23], v[72:75]
    buffer_load_dwordx4 v11, s[8:11], s20 offen lds
    v_mfma_f32_16x16x32_bf16 v[76:79], a[160:163], v[24:27], v[76:79]
    ds_read_b128 v[48:51], v17 offset:47104
    s_waitcnt lgkmcnt(2)
    s_waitcnt vmcnt(10)
    v_mfma_f32_16x16x32_bf16 v[80:83], a[164:167], v[24:27], v[80:83]
    s_waitcnt lgkmcnt(4)
    v_lshlrev_b32 v140, 16, v132
    v_and_b32 v141, 0xffff0000, v132
    v_mfma_f32_16x16x32_bf16 v[68:71], a[168:171], v[28:31], v[68:71]
    s_waitcnt vmcnt(9)
    s_barrier
    ds_read_b128 v[20:23], v16 offset:49152
    v_mul_f32 v140, v140, v128
    v_mfma_f32_16x16x32_bf16 v[72:75], a[172:175], v[28:31], v[72:75]
    s_add_u32 s20, s20, 16384
    buffer_load_dword v87, v4, s[12:15], s51 offen sc1
    v_mfma_f32_16x16x32_bf16 v[76:79], a[168:171], v[32:35], v[76:79]
    ds_read_b128 v[24:27], v17 offset:49152
    v_mul_f32 v141, v141, v129
    v_cvt_pk_bf16_f32 v140, 0, v140
    v_mfma_f32_16x16x32_bf16 v[80:83], a[172:175], v[32:35], v[80:83]
    s_waitcnt lgkmcnt(4)
    v_cvt_pk_bf16_f32 v141, 0, v141
    v_add_f32 v96, v88, v140
    v_mfma_f32_16x16x32_bf16 v[68:71], a[176:179], v[36:39], v[68:71]
    ds_read_b128 v[28:31], v16 offset:51200
    s_add_u32 m0, s21, 32768
    v_add_f32 v97, v89, v141
    v_mfma_f32_16x16x32_bf16 v[72:75], a[180:183], v[36:39], v[72:75]
    buffer_load_dwordx4 v8, s[8:11], s20 offen lds
    v_lshlrev_b32 v140, 16, v133
    v_and_b32 v141, 0xffff0000, v133
    v_mfma_f32_16x16x32_bf16 v[76:79], a[176:179], v[40:43], v[76:79]
    ds_read_b128 v[32:35], v17 offset:51200
    v_mul_f32 v140, v140, v130
    v_mul_f32 v141, v141, v131
    v_mfma_f32_16x16x32_bf16 v[80:83], a[180:183], v[40:43], v[80:83]
    s_waitcnt lgkmcnt(4)
    v_cvt_pk_bf16_f32 v140, 0, v140
    v_mfma_f32_16x16x32_bf16 v[68:71], a[184:187], v[44:47], v[68:71]
    ds_read_b128 v[36:39], v16 offset:53248
    v_cvt_pk_bf16_f32 v141, 0, v141
    v_add_f32 v98, v90, v140
    v_mfma_f32_16x16x32_bf16 v[72:75], a[188:191], v[44:47], v[72:75]
    v_add_f32 v99, v91, v141
    buffer_store_dwordx4 v[96:99], v138, s[16:19], s43 offen
    v_mfma_f32_16x16x32_bf16 v[76:79], a[184:187], v[48:51], v[76:79]
    ds_read_b128 v[40:43], v17 offset:53248
    v_lshlrev_b32 v140, 16, v134
    v_and_b32 v141, 0xffff0000, v134
    v_mfma_f32_16x16x32_bf16 v[80:83], a[188:191], v[48:51], v[80:83]
    s_waitcnt lgkmcnt(4)
    v_mul_f32 v140, v140, v128
    v_mfma_f32_16x16x32_bf16 v[68:71], a[192:195], v[20:23], v[68:71]
    ds_read_b128 v[44:47], v16 offset:55296
    s_add_u32 m0, s21, 33792
    v_mfma_f32_16x16x32_bf16 v[72:75], a[196:199], v[20:23], v[72:75]
    buffer_load_dwordx4 v9, s[8:11], s20 offen lds
    v_mul_f32 v141, v141, v129
    v_mfma_f32_16x16x32_bf16 v[76:79], a[192:195], v[24:27], v[76:79]
    ds_read_b128 v[48:51], v17 offset:55296
    v_cvt_pk_bf16_f32 v140, 0, v140
    v_mfma_f32_16x16x32_bf16 v[80:83], a[196:199], v[24:27], v[80:83]
    s_waitcnt lgkmcnt(4)
    v_cvt_pk_bf16_f32 v141, 0, v141
    v_mfma_f32_16x16x32_bf16 v[68:71], a[200:203], v[28:31], v[68:71]
    ds_read_b128 v[20:23], v16 offset:57344
    v_add_f32 v100, v92, v140
    v_mfma_f32_16x16x32_bf16 v[72:75], a[204:207], v[28:31], v[72:75]
    v_add_f32 v101, v93, v141
    v_lshlrev_b32 v140, 16, v135
    v_mfma_f32_16x16x32_bf16 v[76:79], a[200:203], v[32:35], v[76:79]
    ds_read_b128 v[24:27], v17 offset:57344
    v_and_b32 v141, 0xffff0000, v135
    v_mfma_f32_16x16x32_bf16 v[80:83], a[204:207], v[32:35], v[80:83]
    s_waitcnt lgkmcnt(4)
    v_mul_f32 v140, v140, v130
    v_mfma_f32_16x16x32_bf16 v[68:71], a[208:211], v[36:39], v[68:71]
    ds_read_b128 v[28:31], v16 offset:59392
    s_add_u32 m0, s21, 34816
    v_mul_f32 v141, v141, v131
    v_mfma_f32_16x16x32_bf16 v[72:75], a[212:215], v[36:39], v[72:75]
    buffer_load_dwordx4 v10, s[8:11], s20 offen lds
    v_mfma_f32_16x16x32_bf16 v[76:79], a[208:211], v[40:43], v[76:79]
    ds_read_b128 v[32:35], v17 offset:59392
    v_cvt_pk_bf16_f32 v140, 0, v140
    v_cvt_pk_bf16_f32 v141, 0, v141
    v_mfma_f32_16x16x32_bf16 v[80:83], a[212:215], v[40:43], v[80:83]
    s_waitcnt lgkmcnt(4)
    v_add_f32 v102, v94, v140
    v_mfma_f32_16x16x32_bf16 v[68:71], a[216:219], v[44:47], v[68:71]
    ds_read_b128 v[36:39], v16 offset:61440
    v_add_f32 v103, v95, v141
    v_mfma_f32_16x16x32_bf16 v[72:75], a[220:223], v[44:47], v[72:75]
    buffer_store_dwordx4 v[100:103], v139, s[16:19], s43 offen
    v_mfma_f32_16x16x32_bf16 v[76:79], a[216:219], v[48:51], v[76:79]
    ds_read_b128 v[40:43], v17 offset:61440
    v_mfma_f32_16x16x32_bf16 v[80:83], a[220:223], v[48:51], v[80:83]
    s_waitcnt lgkmcnt(4)
    v_mfma_f32_16x16x32_bf16 v[68:71], a[224:227], v[20:23], v[68:71]
    ds_read_b128 v[44:47], v16 offset:63488
    s_add_u32 m0, s21, 35840
    v_mov_b32 v116, v52
    v_mfma_f32_16x16x32_bf16 v[72:75], a[228:231], v[20:23], v[72:75]
    buffer_load_dwordx4 v11, s[8:11], s20 offen lds
    v_mov_b32 v117, v53
    v_mfma_f32_16x16x32_bf16 v[76:79], a[224:227], v[24:27], v[76:79]
    ds_read_b128 v[48:51], v17 offset:63488
    v_mov_b32 v118, v54
    v_mov_b32 v119, v55
    v_mfma_f32_16x16x32_bf16 v[80:83], a[228:231], v[24:27], v[80:83]
    s_waitcnt lgkmcnt(4)
    v_mov_b32 v120, v56
    v_mfma_f32_16x16x32_bf16 v[68:71], a[232:235], v[28:31], v[68:71]
    s_waitcnt vmcnt(11)
    s_barrier
    ds_read_b128 v[20:23], v12 offset:0
    v_mfma_f32_16x16x32_bf16 v[72:75], a[236:239], v[28:31], v[72:75]
    s_add_u32 s20, s20, 16384
    v_mov_b32 v121, v57
    v_mov_b32 v122, v58
    v_mfma_f32_16x16x32_bf16 v[76:79], a[232:235], v[32:35], v[76:79]
    ds_read_b128 v[24:27], v13 offset:0
    v_mov_b32 v123, v59
    v_mfma_f32_16x16x32_bf16 v[80:83], a[236:239], v[32:35], v[80:83]
    s_waitcnt lgkmcnt(4)
    s_mov_b32 s7, s38
    s_add_u32 s39, s44, s31
    v_mfma_f32_16x16x32_bf16 v[68:71], a[240:243], v[36:39], v[68:71]
    ds_read_b128 v[28:31], v12 offset:2048
    s_add_u32 m0, s21, 49152
    v_mfma_f32_16x16x32_bf16 v[72:75], a[244:247], v[36:39], v[72:75]
    buffer_load_dwordx4 v8, s[8:11], s20 offen lds
    s_sub_u32 s43, s22, 1
    v_mfma_f32_16x16x32_bf16 v[76:79], a[240:243], v[40:43], v[76:79]
    ds_read_b128 v[32:35], v13 offset:2048
    s_lshl_b32 s42, s43, 16
    s_lshl_b32 s43, s43, 18
    v_mfma_f32_16x16x32_bf16 v[80:83], a[244:247], v[40:43], v[80:83]
    s_waitcnt lgkmcnt(4)
    s_cmp_eq_u32 s37, 0
    s_cselect_b32 s42, 0x7ff00000, s42
    s_cselect_b32 s43, 0x7ff00000, s43
    v_mfma_f32_16x16x32_bf16 v[68:71], a[248:251], v[44:47], v[68:71]
    ds_read_b128 v[36:39], v12 offset:4096
    v_mfma_f32_16x16x32_bf16 v[72:75], a[252:255], v[44:47], v[72:75]
    buffer_load_dwordx4 v[88:91], v112, s[12:15], s39 offen offset:0 sc1
    v_mfma_f32_16x16x32_bf16 v[76:79], a[248:251], v[48:51], v[76:79]
    ds_read_b128 v[40:43], v13 offset:4096
    s_mov_b32 s37, 1
    v_mfma_f32_16x16x32_bf16 v[80:83], a[252:255], v[48:51], v[80:83]
    s_waitcnt lgkmcnt(4)
    s_add_u32 s22, s22, 1
    s_cmp_ge_u32 s22, s23
    s_cbranch_scc0 L_st_270
L_fl1_268:
    s_waitcnt lgkmcnt(0)
    s_nop 7
    s_sub_u32 s38, s22, 1
    s_and_b32 s31, s38, 3
    s_lshl_b32 s31, s31, 11
    s_bfe_u32 s38, s38, 0x10002
    s_xor_b32 s38, s38, 1
    s_cmp_eq_u32 s37, 0
    s_cselect_b32 s31, 0x40000000, s31
    s_cselect_b32 s38, 0, s38
    v_cvt_pk_bf16_f32 v104, v76, v77
    v_cvt_pk_bf16_f32 v105, v78, v79
    v_cvt_pk_bf16_f32 v106, v80, v81
    v_cvt_pk_bf16_f32 v107, v82, v83
    v_and_or_b32 v104, v104, -2, s38
    v_and_or_b32 v105, v105, -2, s38
    v_and_or_b32 v106, v106, -2, s38
    v_and_or_b32 v107, v107, -2, s38
    s_add_u32 s29, s45, s31
    buffer_store_dwordx4 v[104:107], v112, s[12:15], s29 offen offset:0 sc1
    buffer_load_dwordx2 v[132:133], v136, s[32:35], s42 offen
    buffer_load_dwordx2 v[134:135], v137, s[32:35], s42 offen
    s_waitcnt vmcnt(0)
    v_xor_b32 v124, s7, v88
    v_bitop3_b32 v124, v124, v89, s7 bitop3:0xf6
    v_bitop3_b32 v124, v124, v90, s7 bitop3:0xf6
    v_bitop3_b32 v124, v124, v91, s7 bitop3:0xf6
    v_and_b32 v124, 1, v124
    v_cmp_ne_u32 vcc, 0, v124
    s_nop 0
    s_nop 0
    s_nop 0
    s_cbranch_vccnz L_rbad_279
L_rok_280:
    v_lshlrev_b32 v124, 16, v88
    v_and_b32 v125, 0xffff0000, v88
    v_add_f32 v96, v116, v124
    v_add_f32 v97, v117, v125
    v_lshlrev_b32 v124, 16, v89
    v_and_b32 v125, 0xffff0000, v89
    v_add_f32 v98, v118, v124
    v_add_f32 v99, v119, v125
    v_lshlrev_b32 v124, 16, v90
    v_and_b32 v125, 0xffff0000, v90
    v_add_f32 v100, v120, v124
    v_add_f32 v101, v121, v125
    v_lshlrev_b32 v124, 16, v91
    v_and_b32 v125, 0xffff0000, v91
    v_add_f32 v102, v122, v124
    v_add_f32 v103, v123, v125
    ds_write_b128 v114, v[96:99]
    ds_write_b128 v115, v[100:103]
    ds_read_b128 v[88:91], v113 offset:0
    ds_read_b128 v[92:95], v113 offset:1024
    s_waitcnt lgkmcnt(0)
    s_waitcnt vmcnt(0)
    v_lshlrev_b32 v140, 16, v132
    v_and_b32 v141, 0xffff0000, v132
    v_mul_f32 v140, v140, v128
    v_mul_f32 v141, v141, v129
    v_cvt_pk_bf16_f32 v140, 0, v140
    v_cvt_pk_bf16_f32 v141, 0, v141
    v_add_f32 v96, v88, v140
    v_add_f32 v97, v89, v141
    v_lshlrev_b32 v140, 16, v133
    v_and_b32 v141, 0xffff0000, v133
    v_mul_f32 v140, v140, v130
    v_mul_f32 v141, v141, v131
    v_cvt_pk_bf16_f32 v140, 0, v140
    v_cvt_pk_bf16_f32 v141, 0, v141
    v_add_f32 v98, v90, v140
    v_add_f32 v99, v91, v141
    buffer_store_dwordx4 v[96:99], v138, s[16:19], s43 offen
    v_lshlrev_b32 v140, 16, v134
    v_and_b32 v141, 0xffff0000, v134
    v_mul_f32 v140, v140, v128
    v_mul_f32 v141, v141, v129
    v_cvt_pk_bf16_f32 v140, 0, v140
    v_cvt_pk_bf16_f32 v141, 0, v141
    v_add_f32 v100, v92, v140
    v_add_f32 v101, v93, v141
    v_lshlrev_b32 v140, 16, v135
    v_and_b32 v141, 0xffff0000, v135
    v_mul_f32 v140, v140, v130
    v_mul_f32 v141, v141, v131
    v_cvt_pk_bf16_f32 v140, 0, v140
    v_cvt_pk_bf16_f32 v141, 0, v141
    v_add_f32 v102, v94, v140
    v_add_f32 v103, v95, v141
    buffer_store_dwordx4 v[100:103], v139, s[16:19], s43 offen
    v_mov_b32 v116, v68
    v_mov_b32 v117, v69
    v_mov_b32 v118, v70
    v_mov_b32 v119, v71
    v_mov_b32 v120, v72
    v_mov_b32 v121, v73
    v_mov_b32 v122, v74
    v_mov_b32 v123, v75
    s_mov_b32 s7, s38
    s_add_u32 s39, s44, s31
    s_sub_u32 s43, s22, 1
    s_lshl_b32 s42, s43, 16
    s_lshl_b32 s43, s43, 18
    s_cmp_eq_u32 s37, 0
    s_cselect_b32 s42, 0x7ff00000, s42
    s_cselect_b32 s43, 0x7ff00000, s43
    buffer_load_dwordx4 v[88:91], v112, s[12:15], s39 offen offset:0 sc1
    s_mov_b32 s37, 1
    buffer_load_dwordx2 v[132:133], v136, s[32:35], s42 offen
    buffer_load_dwordx2 v[134:135], v137, s[32:35], s42 offen
    s_waitcnt vmcnt(0)
    v_xor_b32 v124, s7, v88
    v_bitop3_b32 v124, v124, v89, s7 bitop3:0xf6
    v_bitop3_b32 v124, v124, v90, s7 bitop3:0xf6
    v_bitop3_b32 v124, v124, v91, s7 bitop3:0xf6
    v_and_b32 v124, 1, v124
    v_cmp_ne_u32 vcc, 0, v124
    s_nop 0
    s_nop 0
    s_nop 0
    s_cbranch_vccnz L_rbad_281
L_rok_282:
    v_lshlrev_b32 v124, 16, v88
    v_and_b32 v125, 0xffff0000, v88
    v_add_f32 v96, v116, v124
    v_add_f32 v97, v117, v125
    v_lshlrev_b32 v124, 16, v89
    v_and_b32 v125, 0xffff0000, v89
    v_add_f32 v98, v118, v124
    v_add_f32 v99, v119, v125
    v_lshlrev_b32 v124, 16, v90
    v_and_b32 v125, 0xffff0000, v90
    v_add_f32 v100, v120, v124
    v_add_f32 v101, v121, v125
    v_lshlrev_b32 v124, 16, v91
    v_and_b32 v125, 0xffff0000, v91
    v_add_f32 v102, v122, v124
    v_add_f32 v103, v123, v125
    ds_write_b128 v114, v[96:99]
    ds_write_b128 v115, v[100:103]
    ds_read_b128 v[88:91], v113 offset:0
    ds_read_b128 v[92:95], v113 offset:1024
    s_waitcnt lgkmcnt(0)
    s_waitcnt vmcnt(0)
    v_lshlrev_b32 v140, 16, v132
    v_and_b32 v141, 0xffff0000, v132
    v_mul_f32 v140, v140, v128
    v_mul_f32 v141, v141, v129
    v_cvt_pk_bf16_f32 v140, 0, v140
    v_cvt_pk_bf16_f32 v141, 0, v141
    v_add_f32 v96, v88, v140
    v_add_f32 v97, v89, v141
    v_lshlrev_b32 v140, 16, v133
    v_and_b32 v141, 0xffff0000, v133
    v_mul_f32 v140, v140, v130
    v_mul_f32 v141, v141, v131
    v_cvt_pk_bf16_f32 v140, 0, v140
    v_cvt_pk_bf16_f32 v141, 0, v141
    v_add_f32 v98, v90, v140
    v_add_f32 v99, v91, v141
    buffer_store_dwordx4 v[96:99], v138, s[16:19], s43 offen
    v_lshlrev_b32 v140, 16, v134
    v_and_b32 v141, 0xffff0000, v134
    v_mul_f32 v140, v140, v128
    v_mul_f32 v141, v141, v129
    v_cvt_pk_bf16_f32 v140, 0, v140
    v_cvt_pk_bf16_f32 v141, 0, v141
    v_add_f32 v100, v92, v140
    v_add_f32 v101, v93, v141
    v_lshlrev_b32 v140, 16, v135
    v_and_b32 v141, 0xffff0000, v135
    v_mul_f32 v140, v140, v130
    v_mul_f32 v141, v141, v131
    v_cvt_pk_bf16_f32 v140, 0, v140
    v_cvt_pk_bf16_f32 v141, 0, v141
    v_add_f32 v102, v94, v140
    v_add_f32 v103, v95, v141
    buffer_store_dwordx4 v[100:103], v139, s[16:19], s43 offen
    s_branch L_ste_269
L_rbad_271:
    buffer_load_dwordx4 v[88:91], v112, s[12:15], s39 offen offset:0 sc1
    s_add_u32 s36, s36, 1
    s_cmp_gt_u32 s36, 0x100000
    s_cbranch_scc1 chain_kernel_wend
    s_waitcnt vmcnt(0)
    v_xor_b32 v124, s7, v88
    v_bitop3_b32 v124, v124, v89, s7 bitop3:0xf6
    v_bitop3_b32 v124, v124, v90, s7 bitop3:0xf6
    v_bitop3_b32 v124, v124, v91, s7 bitop3:0xf6
    v_and_b32 v124, 1, v124
    v_cmp_ne_u32 vcc, 0, v124
    s_cbranch_vccnz L_rbad_271
    s_branch L_rok_272
L_gw_274:
    buffer_load_dword v87, v4, s[12:15], s51 offen sc1
    s_add_u32 s36, s36, 1
    s_cmp_gt_u32 s36, 0x100000
    s_cbranch_scc1 chain_kernel_wend
    s_waitcnt vmcnt(0)
    v_readfirstlane_b32 s30, v87
    s_cmp_lt_u32 s30, 16
    s_cbranch_scc0 L_gok_273
    s_sleep 1
    s_branch L_gw_274
L_rbad_275:
    buffer_load_dwordx4 v[88:91], v112, s[12:15], s39 offen offset:0 sc1
    s_add_u32 s36, s36, 1
    s_cmp_gt_u32 s36, 0x100000
    s_cbranch_scc1 chain_kernel_wend
    s_waitcnt vmcnt(0)
    v_xor_b32 v124, s7, v88
    v_bitop3_b32 v124, v124, v89, s7 bitop3:0xf6
    v_bitop3_b32 v124, v124, v90, s7 bitop3:0xf6
    v_bitop3_b32 v124, v124, v91, s7 bitop3:0xf6
    v_and_b32 v124, 1, v124
    v_cmp_ne_u32 vcc, 0, v124
    s_cbranch_vccnz L_rbad_275
    s_branch L_rok_276
L_gw_278:
    buffer_load_dword v87, v4, s[12:15], s51 offen sc1
    s_add_u32 s36, s36, 1
    s_cmp_gt_u32 s36, 0x100000
    s_cbranch_scc1 chain_kernel_wend
    s_waitcnt vmcnt(0)
    v_readfirstlane_b32 s30, v87
    s_cmp_lt_u32 s30, 16
    s_cbranch_scc0 L_gok_277
    s_sleep 1
    s_branch L_gw_278
L_rbad_279:
    buffer_load_dwordx4 v[88:91], v112, s[12:15], s39 offen offset:0 sc1
    s_add_u32 s36, s36, 1
    s_cmp_gt_u32 s36, 0x100000
    s_cbranch_scc1 chain_kernel_wend
    s_waitcnt vmcnt(0)
    v_xor_b32 v124, s7, v88
    v_bitop3_b32 v124, v124, v89, s7 bitop3:0xf6
    v_bitop3_b32 v124, v124, v90, s7 bitop3:0xf6
    v_bitop3_b32 v124, v124, v91, s7 bitop3:0xf6
    v_and_b32 v124, 1, v124
    v_cmp_ne_u32 vcc, 0, v124
    s_cbranch_vccnz L_rbad_279
    s_branch L_rok_280
L_rbad_281:
    buffer_load_dwordx4 v[88:91], v112, s[12:15], s39 offen offset:0 sc1
    s_add_u32 s36, s36, 1
    s_cmp_gt_u32 s36, 0x100000
    s_cbranch_scc1 chain_kernel_wend
    s_waitcnt vmcnt(0)
    v_xor_b32 v124, s7, v88
    v_bitop3_b32 v124, v124, v89, s7 bitop3:0xf6
    v_bitop3_b32 v124, v124, v90, s7 bitop3:0xf6
    v_bitop3_b32 v124, v124, v91, s7 bitop3:0xf6
    v_and_b32 v124, 1, v124
    v_cmp_ne_u32 vcc, 0, v124
    s_cbranch_vccnz L_rbad_281
    s_branch L_rok_282
L_fl0_267:
    s_waitcnt lgkmcnt(0)
    s_nop 7
    s_sub_u32 s38, s22, 1
    s_and_b32 s31, s38, 3
    s_lshl_b32 s31, s31, 11
    s_bfe_u32 s38, s38, 0x10002
    s_xor_b32 s38, s38, 1
    s_cmp_eq_u32 s37, 0
    s_cselect_b32 s31, 0x40000000, s31
    s_cselect_b32 s38, 0, s38
    v_cvt_pk_bf16_f32 v104, v60, v61
    v_cvt_pk_bf16_f32 v105, v62, v63
    v_cvt_pk_bf16_f32 v106, v64, v65
    v_cvt_pk_bf16_f32 v107, v66, v67
    v_and_or_b32 v104, v104, -2, s38
    v_and_or_b32 v105, v105, -2, s38
    v_and_or_b32 v106, v106, -2, s38
    v_and_or_b32 v107, v107, -2, s38
    s_add_u32 s29, s45, s31
    buffer_store_dwordx4 v[104:107], v112, s[12:15], s29 offen offset:0 sc1
    buffer_load_dwordx2 v[132:133], v136, s[32:35], s42 offen
    buffer_load_dwordx2 v[134:135], v137, s[32:35], s42 offen
    s_waitcnt vmcnt(0)
    v_xor_b32 v124, s7, v88
    v_bitop3_b32 v124, v124, v89, s7 bitop3:0xf6
    v_bitop3_b32 v124, v124, v90, s7 bitop3:0xf6
    v_bitop3_b32 v124, v124, v91, s7 bitop3:0xf6
    v_and_b32 v124, 1, v124
    v_cmp_ne_u32 vcc, 0, v124
    s_nop 0
    s_nop 0
    s_nop 0
    s_cbranch_vccnz L_rbad_283
L_rok_284:
    v_lshlrev_b32 v124, 16, v88
    v_and_b32 v125, 0xffff0000, v88
    v_add_f32 v96, v116, v124
    v_add_f32 v97, v117, v125
    v_lshlrev_b32 v124, 16, v89
    v_and_b32 v125, 0xffff0000, v89
    v_add_f32 v98, v118, v124
    v_add_f32 v99, v119, v125
    v_lshlrev_b32 v124, 16, v90
    v_and_b32 v125, 0xffff0000, v90
    v_add_f32 v100, v120, v124
    v_add_f32 v101, v121, v125
    v_lshlrev_b32 v124, 16, v91
    v_and_b32 v125, 0xffff0000, v91
    v_add_f32 v102, v122, v124
    v_add_f32 v103, v123, v125
    ds_write_b128 v114, v[96:99]
    ds_write_b128 v115, v[100:103]
    ds_read_b128 v[88:91], v113 offset:0
    ds_read_b128 v[92:95], v113 offset:1024
    s_waitcnt lgkmcnt(0)
    s_waitcnt vmcnt(0)
    v_lshlrev_b32 v140, 16, v132
    v_and_b32 v141, 0xffff0000, v132
    v_mul_f32 v140, v140, v128
    v_mul_f32 v141, v141, v129
    v_cvt_pk_bf16_f32 v140, 0, v140
    v_cvt_pk_bf16_f32 v141, 0, v141
    v_add_f32 v96, v88, v140
    v_add_f32 v97, v89, v141
    v_lshlrev_b32 v140, 16, v133
    v_and_b32 v141, 0xffff0000, v133
    v_mul_f32 v140, v140, v130
    v_mul_f32 v141, v141, v131
    v_cvt_pk_bf16_f32 v140, 0, v140
    v_cvt_pk_bf16_f32 v141, 0, v141
    v_add_f32 v98, v90, v140
    v_add_f32 v99, v91, v141
    buffer_store_dwordx4 v[96:99], v138, s[16:19], s43 offen
    v_lshlrev_b32 v140, 16, v134
    v_and_b32 v141, 0xffff0000, v134
    v_mul_f32 v140, v140, v128
    v_mul_f32 v141, v141, v129
    v_cvt_pk_bf16_f32 v140, 0, v140
    v_cvt_pk_bf16_f32 v141, 0, v141
    v_add_f32 v100, v92, v140
    v_add_f32 v101, v93, v141
    v_lshlrev_b32 v140, 16, v135
    v_and_b32 v141, 0xffff0000, v135
    v_mul_f32 v140, v140, v130
    v_mul_f32 v141, v141, v131
    v_cvt_pk_bf16_f32 v140, 0, v140
    v_cvt_pk_bf16_f32 v141, 0, v141
    v_add_f32 v102, v94, v140
    v_add_f32 v103, v95, v141
    buffer_store_dwordx4 v[100:103], v139, s[16:19], s43 offen
    v_mov_b32 v116, v52
    v_mov_b32 v117, v53
    v_mov_b32 v118, v54
    v_mov_b32 v119, v55
    v_mov_b32 v120, v56
    v_mov_b32 v121, v57
    v_mov_b32 v122, v58
    v_mov_b32 v123, v59
    s_mov_b32 s7, s38
    s_add_u32 s39, s44, s31
    s_sub_u32 s43, s22, 1
    s_lshl_b32 s42, s43, 16
    s_lshl_b32 s43, s43, 18
    s_cmp_eq_u32 s37, 0
    s_cselect_b32 s42, 0x7ff00000, s42
    s_cselect_b32 s43, 0x7ff00000, s43
    buffer_load_dwordx4 v[88:91], v112, s[12:15], s39 offen offset:0 sc1
    s_mov_b32 s37, 1
    buffer_load_dwordx2 v[132:133], v136, s[32:35], s42 offen
    buffer_load_dwordx2 v[134:135], v137, s[32:35], s42 offen
    s_waitcnt vmcnt(0)
    v_xor_b32 v124, s7, v88
    v_bitop3_b32 v124, v124, v89, s7 bitop3:0xf6
    v_bitop3_b32 v124, v124, v90, s7 bitop3:0xf6
    v_bitop3_b32 v124, v124, v91, s7 bitop3:0xf6
    v_and_b32 v124, 1, v124
    v_cmp_ne_u32 vcc, 0, v124
    s_nop 0
    s_nop 0
    s_nop 0
    s_cbranch_vccnz L_rbad_285
L_rok_286:
    v_lshlrev_b32 v124, 16, v88
    v_and_b32 v125, 0xffff0000, v88
    v_add_f32 v96, v116, v124
    v_add_f32 v97, v117, v125
    v_lshlrev_b32 v124, 16, v89
    v_and_b32 v125, 0xffff0000, v89
    v_add_f32 v98, v118, v124
    v_add_f32 v99, v119, v125
    v_lshlrev_b32 v124, 16, v90
    v_and_b32 v125, 0xffff0000, v90
    v_add_f32 v100, v120, v124
    v_add_f32 v101, v121, v125
    v_lshlrev_b32 v124, 16, v91
    v_and_b32 v125, 0xffff0000, v91
    v_add_f32 v102, v122, v124
    v_add_f32 v103, v123, v125
    ds_write_b128 v114, v[96:99]
    ds_write_b128 v115, v[100:103]
    ds_read_b128 v[88:91], v113 offset:0
    ds_read_b128 v[92:95], v113 offset:1024
    s_waitcnt lgkmcnt(0)
    s_waitcnt vmcnt(0)
    v_lshlrev_b32 v140, 16, v132
    v_and_b32 v141, 0xffff0000, v132
    v_mul_f32 v140, v140, v128
    v_mul_f32 v141, v141, v129
    v_cvt_pk_bf16_f32 v140, 0, v140
    v_cvt_pk_bf16_f32 v141, 0, v141
    v_add_f32 v96, v88, v140
    v_add_f32 v97, v89, v141
    v_lshlrev_b32 v140, 16, v133
    v_and_b32 v141, 0xffff0000, v133
    v_mul_f32 v140, v140, v130
    v_mul_f32 v141, v141, v131
    v_cvt_pk_bf16_f32 v140, 0, v140
    v_cvt_pk_bf16_f32 v141, 0, v141
    v_add_f32 v98, v90, v140
    v_add_f32 v99, v91, v141
    buffer_store_dwordx4 v[96:99], v138, s[16:19], s43 offen
    v_lshlrev_b32 v140, 16, v134
    v_and_b32 v141, 0xffff0000, v134
    v_mul_f32 v140, v140, v128
    v_mul_f32 v141, v141, v129
    v_cvt_pk_bf16_f32 v140, 0, v140
    v_cvt_pk_bf16_f32 v141, 0, v141
    v_add_f32 v100, v92, v140
    v_add_f32 v101, v93, v141
    v_lshlrev_b32 v140, 16, v135
    v_and_b32 v141, 0xffff0000, v135
    v_mul_f32 v140, v140, v130
    v_mul_f32 v141, v141, v131
    v_cvt_pk_bf16_f32 v140, 0, v140
    v_cvt_pk_bf16_f32 v141, 0, v141
    v_add_f32 v102, v94, v140
    v_add_f32 v103, v95, v141
    buffer_store_dwordx4 v[100:103], v139, s[16:19], s43 offen
    s_branch L_ste_269
L_rbad_283:
    buffer_load_dwordx4 v[88:91], v112, s[12:15], s39 offen offset:0 sc1
    s_add_u32 s36, s36, 1
    s_cmp_gt_u32 s36, 0x100000
    s_cbranch_scc1 chain_kernel_wend
    s_waitcnt vmcnt(0)
    v_xor_b32 v124, s7, v88
    v_bitop3_b32 v124, v124, v89, s7 bitop3:0xf6
    v_bitop3_b32 v124, v124, v90, s7 bitop3:0xf6
    v_bitop3_b32 v124, v124, v91, s7 bitop3:0xf6
    v_and_b32 v124, 1, v124
    v_cmp_ne_u32 vcc, 0, v124
    s_cbranch_vccnz L_rbad_283
    s_branch L_rok_284
L_rbad_285:
    buffer_load_dwordx4 v[88:91], v112, s[12:15], s39 offen offset:0 sc1
    s_add_u32 s36, s36, 1
    s_cmp_gt_u32 s36, 0x100000
    s_cbranch_scc1 chain_kernel_wend
    s_waitcnt vmcnt(0)
    v_xor_b32 v124, s7, v88
    v_bitop3_b32 v124, v124, v89, s7 bitop3:0xf6
    v_bitop3_b32 v124, v124, v90, s7 bitop3:0xf6
    v_bitop3_b32 v124, v124, v91, s7 bitop3:0xf6
    v_and_b32 v124, 1, v124
    v_cmp_ne_u32 vcc, 0, v124
    s_cbranch_vccnz L_rbad_285
    s_branch L_rok_286
L_ste_269:
L_op_223:
    s_mov_b32 s38, s41
    s_and_b32 s39, s38, 3
    s_lshr_b32 s42, s38, 2
    s_lshl_b32 s44, s40, 5
    s_add_u32 s44, s44, s38
    s_lshl_b32 s44, s44, 15
    s_lshl_b32 s25, s49, 13
    s_add_u32 s44, s44, s25
    s_xor_b32 s45, s44, 0x8000
    s_add_u32 s45, s45, 0x6900000
    s_xor_b32 s46, s44, 0x10000
    s_add_u32 s46, s46, 0x6900000
    s_xor_b32 s47, s44, 0x18000
    s_add_u32 s47, s47, 0x6900000
    s_add_u32 s44, s44, 0x6900000
    s_lshl_b32 s48, s40, 3
    s_lshr_b32 s25, s38, 2
    s_add_u32 s48, s48, s25
    s_lshl_b32 s48, s48, 7
    s_add_u32 s48, s48, 0x590c000
    s_mov_b32 s16, s92
    s_and_b32 s17, s93, 0xffff
    s_mov_b32 s18, 0x800000
    s_mov_b32 s19, 0x00020000
    s_lshl_b32 s50, s39, 21
    s_lshl_b32 s25, s42, 8
    s_add_u32 s50, s50, s25
    v_mov_b32 v104, 0
    v_mov_b32 v105, 0
    v_mov_b32 v106, 0
    v_mov_b32 v107, 0
    v_and_b32 v2, 63, v0
    v_lshlrev_b32 v3, 4, v2
    v_lshlrev_b32 v112, 3, v2
    s_add_u32 s28, s44, 0
    buffer_store_dwordx4 v[104:107], v3, s[12:15], s28 offen sc1
    s_add_u32 s28, s44, 1024
    buffer_store_dwordx4 v[104:107], v3, s[12:15], s28 offen sc1
    s_add_u32 s28, s44, 2048
    buffer_store_dwordx4 v[104:107], v3, s[12:15], s28 offen sc1
    s_add_u32 s28, s44, 3072
    buffer_store_dwordx4 v[104:107], v3, s[12:15], s28 offen sc1
    s_add_u32 s28, s44, 4096
    buffer_store_dwordx4 v[104:107], v3, s[12:15], s28 offen sc1
    s_add_u32 s28, s44, 5120
    buffer_store_dwordx4 v[104:107], v3, s[12:15], s28 offen sc1
    s_add_u32 s28, s44, 6144
    buffer_store_dwordx4 v[104:107], v3, s[12:15], s28 offen sc1
    s_add_u32 s28, s44, 7168
    buffer_store_dwordx4 v[104:107], v3, s[12:15], s28 offen sc1
    v_lshrrev_b32 v1, 6, v0
    v_lshlrev_b32 v1, 11, v1
    v_add_u32 v1, 0x21000, v1
    v_add_u32 v113, v1, v3
    v_and_b32 v2, 15, v0
    v_lshl_add_u32 v1, v2, 2, v1
    v_bfe_u32 v2, v0, 4, 2
    v_lshl_add_u32 v114, v2, 7, v1
    v_and_b32 v1, 15, v0
    v_bfe_u32 v2, v0, 4, 2
    v_lshrrev_b32 v3, 6, v0
    v_lshlrev_b32 v4, 2, v2
    v_xor_b32 v4, v4, v1
    v_lshlrev_b32 v4, 4, v4
    v_lshl_add_u32 v5, v3, 5, v2
    s_mov_b32 s25, 2048
    v_mul_lo_u32 v5, v5, s25
    v_add_u32 v20, v5, v4
    v_bfe_u32 v4, v0, 2, 2
    v_lshl_add_u32 v5, v2, 3, v4
    v_lshlrev_b32 v5, 8, v5
    v_xor_b32 v4, v4, v3
    v_lshl_add_u32 v5, v4, 6, v5
    v_and_b32 v4, 3, v0
    v_lshl_add_u32 v5, v4, 3, v5
    v_mov_b32 v21, v5
    v_add_u32 v22, 32, v21
    v_add_u32 v23, 0x10000, v21
    v_add_u32 v24, 0x10000, v22
    s_lshl_b32 s26, s49, 13
    s_mov_b32 s25, s50
    s_barrier
    s_add_u32 m0, s26, 0
    s_add_u32 s27, s25, 0
    buffer_load_dwordx4 v20, s[16:19], s27 offen lds
    s_add_u32 m0, s26, 1024
    s_add_u32 s27, s25, 8192
    buffer_load_dwordx4 v20, s[16:19], s27 offen lds
    s_add_u32 m0, s26, 2048
    s_add_u32 s27, s25, 16384
    buffer_load_dwordx4 v20, s[16:19], s27 offen lds
    s_add_u32 m0, s26, 3072
    s_add_u32 s27, s25, 24576
    buffer_load_dwordx4 v20, s[16:19], s27 offen lds
    s_add_u32 m0, s26, 4096
    s_add_u32 s27, s25, 32768
    buffer_load_dwordx4 v20, s[16:19], s27 offen lds
    s_add_u32 m0, s26, 5120
    s_add_u32 s27, s25, 40960
    buffer_load_dwordx4 v20, s[16:19], s27 offen lds
    s_add_u32 m0, s26, 6144
    s_add_u32 s27, s25, 49152
    buffer_load_dwordx4 v20, s[16:19], s27 offen lds
    s_add_u32 m0, s26, 7168
    s_add_u32 s27, s25, 57344
    buffer_load_dwordx4 v20, s[16:19], s27 offen lds
    s_add_u32 m0, s26, 32768
    s_add_u32 s27, s25, 262144
    buffer_load_dwordx4 v20, s[16:19], s27 offen lds
    s_add_u32 m0, s26, 33792
    s_add_u32 s27, s25, 270336
    buffer_load_dwordx4 v20, s[16:19], s27 offen lds
    s_add_u32 m0, s26, 34816
    s_add_u32 s27, s25, 278528
    buffer_load_dwordx4 v20, s[16:19], s27 offen lds
    s_add_u32 m0, s26, 35840
    s_add_u32 s27, s25, 286720
    buffer_load_dwordx4 v20, s[16:19], s27 offen lds
    s_add_u32 m0, s26, 36864
    s_add_u32 s27, s25, 294912
    buffer_load_dwordx4 v20, s[16:19], s27 offen lds
    s_add_u32 m0, s26, 37888
    s_add_u32 s27, s25, 303104
    buffer_load_dwordx4 v20, s[16:19], s27 offen lds
    s_add_u32 m0, s26, 38912
    s_add_u32 s27, s25, 311296
    buffer_load_dwordx4 v20, s[16:19], s27 offen lds
    s_add_u32 m0, s26, 39936
    s_add_u32 s27, s25, 319488
    buffer_load_dwordx4 v20, s[16:19], s27 offen lds
    s_add_u32 m0, s26, 65536
    s_add_u32 s27, s25, 524288
    buffer_load_dwordx4 v20, s[16:19], s27 offen lds
    s_add_u32 m0, s26, 66560
    s_add_u32 s27, s25, 532480
    buffer_load_dwordx4 v20, s[16:19], s27 offen lds
    s_add_u32 m0, s26, 67584
    s_add_u32 s27, s25, 540672
    buffer_load_dwordx4 v20, s[16:19], s27 offen lds
    s_add_u32 m0, s26, 68608
    s_add_u32 s27, s25, 548864
    buffer_load_dwordx4 v20, s[16:19], s27 offen lds
    s_add_u32 m0, s26, 69632
    s_add_u32 s27, s25, 557056
    buffer_load_dwordx4 v20, s[16:19], s27 offen lds
    s_add_u32 m0, s26, 70656
    s_add_u32 s27, s25, 565248
    buffer_load_dwordx4 v20, s[16:19], s27 offen lds
    s_add_u32 m0, s26, 71680
    s_add_u32 s27, s25, 573440
    buffer_load_dwordx4 v20, s[16:19], s27 offen lds
    s_add_u32 m0, s26, 72704
    s_add_u32 s27, s25, 581632
    buffer_load_dwordx4 v20, s[16:19], s27 offen lds
    s_add_u32 m0, s26, 98304
    s_add_u32 s27, s25, 786432
    buffer_load_dwordx4 v20, s[16:19], s27 offen lds
    s_add_u32 m0, s26, 99328
    s_add_u32 s27, s25, 794624
    buffer_load_dwordx4 v20, s[16:19], s27 offen lds
    s_add_u32 m0, s26, 100352
    s_add_u32 s27, s25, 802816
    buffer_load_dwordx4 v20, s[16:19], s27 offen lds
    s_add_u32 m0, s26, 101376
    s_add_u32 s27, s25, 811008
    buffer_load_dwordx4 v20, s[16:19], s27 offen lds
    s_add_u32 m0, s26, 102400
    s_add_u32 s27, s25, 819200
    buffer_load_dwordx4 v20, s[16:19], s27 offen lds
    s_add_u32 m0, s26, 103424
    s_add_u32 s27, s25, 827392
    buffer_load_dwordx4 v20, s[16:19], s27 offen lds
    s_add_u32 m0, s26, 104448
    s_add_u32 s27, s25, 835584
    buffer_load_dwordx4 v20, s[16:19], s27 offen lds
    s_add_u32 m0, s26, 105472
    s_add_u32 s27, s25, 843776
    buffer_load_dwordx4 v20, s[16:19], s27 offen lds
    s_waitcnt vmcnt(24)
    s_barrier
    buffer_atomic_add v84, v85, s[12:15], s48 offen sc1
    ds_read_b64_tr_b16 a[0:1], v21 offset:0
    ds_read_b64_tr_b16 a[2:3], v21 offset:1024
    ds_read_b64_tr_b16 a[4:5], v22 offset:0
    ds_read_b64_tr_b16 a[6:7], v22 offset:1024
    ds_read_b64_tr_b16 a[8:9], v21 offset:8192
    ds_read_b64_tr_b16 a[10:11], v21 offset:9216
    ds_read_b64_tr_b16 a[12:13], v22 offset:8192
    ds_read_b64_tr_b16 a[14:15], v22 offset:9216
    s_waitcnt lgkmcnt(0)
    ds_read_b64_tr_b16 a[16:17], v21 offset:16384
    ds_read_b64_tr_b16 a[18:19], v21 offset:17408
    ds_read_b64_tr_b16 a[20:21], v22 offset:16384
    ds_read_b64_tr_b16 a[22:23], v22 offset:17408
    ds_read_b64_tr_b16 a[24:25], v21 offset:24576
    ds_read_b64_tr_b16 a[26:27], v21 offset:25600
    ds_read_b64_tr_b16 a[28:29], v22 offset:24576
    ds_read_b64_tr_b16 a[30:31], v22 offset:25600
    s_waitcnt lgkmcnt(0)
    s_barrier
    s_add_u32 m0, s26, 0
    s_add_u32 s27, s25, 1048576
    buffer_load_dwordx4 v20, s[16:19], s27 offen lds
    s_add_u32 m0, s26, 1024
    s_add_u32 s27, s25, 1056768
    buffer_load_dwordx4 v20, s[16:19], s27 offen lds
    s_add_u32 m0, s26, 2048
    s_add_u32 s27, s25, 1064960
    buffer_load_dwordx4 v20, s[16:19], s27 offen lds
    s_add_u32 m0, s26, 3072
    s_add_u32 s27, s25, 1073152
    buffer_load_dwordx4 v20, s[16:19], s27 offen lds
    s_add_u32 m0, s26, 4096
    s_add_u32 s27, s25, 1081344
    buffer_load_dwordx4 v20, s[16:19], s27 offen lds
    s_add_u32 m0, s26, 5120
    s_add_u32 s27, s25, 1089536
    buffer_load_dwordx4 v20, s[16:19], s27 offen lds
    s_add_u32 m0, s26, 6144
    s_add_u32 s27, s25, 1097728
    buffer_load_dwordx4 v20, s[16:19], s27 offen lds
    s_add_u32 m0, s26, 7168
    s_add_u32 s27, s25, 1105920
    buffer_load_dwordx4 v20, s[16:19], s27 offen lds
    s_waitcnt vmcnt(24)
    s_barrier
    ds_read_b64_tr_b16 a[32:33], v21 offset:32768
    ds_read_b64_tr_b16 a[34:35], v21 offset:33792
    ds_read_b64_tr_b16 a[36:37], v22 offset:32768
    ds_read_b64_tr_b16 a[38:39], v22 offset:33792
    ds_read_b64_tr_b16 a[40:41], v21 offset:40960
    ds_read_b64_tr_b16 a[42:43], v21 offset:41984
    ds_read_b64_tr_b16 a[44:45], v22 offset:40960
    ds_read_b64_tr_b16 a[46:47], v22 offset:41984
    s_waitcnt lgkmcnt(0)
    ds_read_b64_tr_b16 a[48:49], v21 offset:49152
    ds_read_b64_tr_b16 a[50:51], v21 offset:50176
    ds_read_b64_tr_b16 a[52:53], v22 offset:49152
    ds_read_b64_tr_b16 a[54:55], v22 offset:50176
    ds_read_b64_tr_b16 a[56:57], v21 offset:57344
    ds_read_b64_tr_b16 a[58:59], v21 offset:58368
    ds_read_b64_tr_b16 a[60:61], v22 offset:57344
    ds_read_b64_tr_b16 a[62:63], v22 offset:58368
    s_waitcnt lgkmcnt(0)
    s_barrier
    s_add_u32 m0, s26, 32768
    s_add_u32 s27, s25, 1310720
    buffer_load_dwordx4 v20, s[16:19], s27 offen lds
    s_add_u32 m0, s26, 33792
    s_add_u32 s27, s25, 1318912
    buffer_load_dwordx4 v20, s[16:19], s27 offen lds
    s_add_u32 m0, s26, 34816
    s_add_u32 s27, s25, 1327104
    buffer_load_dwordx4 v20, s[16:19], s27 offen lds
    s_add_u32 m0, s26, 35840
    s_add_u32 s27, s25, 1335296
    buffer_load_dwordx4 v20, s[16:19], s27 offen lds
    s_add_u32 m0, s26, 36864
    s_add_u32 s27, s25, 1343488
    buffer_load_dwordx4 v20, s[16:19], s27 offen lds
    s_add_u32 m0, s26, 37888
    s_add_u32 s27, s25, 1351680
    buffer_load_dwordx4 v20, s[16:19], s27 offen lds
    s_add_u32 m0, s26, 38912
    s_add_u32 s27, s25, 1359872
    buffer_load_dwordx4 v20, s[16:19], s27 offen lds
    s_add_u32 m0, s26, 39936
    s_add_u32 s27, s25, 1368064
    buffer_load_dwordx4 v20, s[16:19], s27 offen lds
    s_waitcnt vmcnt(24)
    s_barrier
    ds_read_b64_tr_b16 a[64:65], v23 offset:0
    ds_read_b64_tr_b16 a[66:67], v23 offset:1024
    ds_read_b64_tr_b16 a[68:69], v24 offset:0
    ds_read_b64_tr_b16 a[70:71], v24 offset:1024
    ds_read_b64_tr_b16 a[72:73], v23 offset:8192
    ds_read_b64_tr_b16 a[74:75], v23 offset:9216
    ds_read_b64_tr_b16 a[76:77], v24 offset:8192
    ds_read_b64_tr_b16 a[78:79], v24 offset:9216
    s_waitcnt lgkmcnt(0)
    ds_read_b64_tr_b16 a[80:81], v23 offset:16384
    ds_read_b64_tr_b16 a[82:83], v23 offset:17408
    ds_read_b64_tr_b16 a[84:85], v24 offset:16384
    ds_read_b64_tr_b16 a[86:87], v24 offset:17408
    ds_read_b64_tr_b16 a[88:89], v23 offset:24576
    ds_read_b64_tr_b16 a[90:91], v23 offset:25600
    ds_read_b64_tr_b16 a[92:93], v24 offset:24576
    ds_read_b64_tr_b16 a[94:95], v24 offset:25600
    s_waitcnt lgkmcnt(0)
    s_barrier
    s_add_u32 m0, s26, 65536
    s_add_u32 s27, s25, 1572864
    buffer_load_dwordx4 v20, s[16:19], s27 offen lds
    s_add_u32 m0, s26, 66560
    s_add_u32 s27, s25, 1581056
    buffer_load_dwordx4 v20, s[16:19], s27 offen lds
    s_add_u32 m0, s26, 67584
    s_add_u32 s27, s25, 1589248
    buffer_load_dwordx4 v20, s[16:19], s27 offen lds
    s_add_u32 m0, s26, 68608
    s_add_u32 s27, s25, 1597440
    buffer_load_dwordx4 v20, s[16:19], s27 offen lds
    s_add_u32 m0, s26, 69632
    s_add_u32 s27, s25, 1605632
    buffer_load_dwordx4 v20, s[16:19], s27 offen lds
    s_add_u32 m0, s26, 70656
    s_add_u32 s27, s25, 1613824
    buffer_load_dwordx4 v20, s[16:19], s27 offen lds
    s_add_u32 m0, s26, 71680
    s_add_u32 s27, s25, 1622016
    buffer_load_dwordx4 v20, s[16:19], s27 offen lds
    s_add_u32 m0, s26, 72704
    s_add_u32 s27, s25, 1630208
    buffer_load_dwordx4 v20, s[16:19], s27 offen lds
    s_waitcnt vmcnt(24)
    s_barrier
    ds_read_b64_tr_b16 a[96:97], v23 offset:32768
    ds_read_b64_tr_b16 a[98:99], v23 offset:33792
    ds_read_b64_tr_b16 a[100:101], v24 offset:32768
    ds_read_b64_tr_b16 a[102:103], v24 offset:33792
    ds_read_b64_tr_b16 a[104:105], v23 offset:40960
    ds_read_b64_tr_b16 a[106:107], v23 offset:41984
    ds_read_b64_tr_b16 a[108:109], v24 offset:40960
    ds_read_b64_tr_b16 a[110:111], v24 offset:41984
    s_waitcnt lgkmcnt(0)
    ds_read_b64_tr_b16 a[112:113], v23 offset:49152
    ds_read_b64_tr_b16 a[114:115], v23 offset:50176
    ds_read_b64_tr_b16 a[116:117], v24 offset:49152
    ds_read_b64_tr_b16 a[118:119], v24 offset:50176
    ds_read_b64_tr_b16 a[120:121], v23 offset:57344
    ds_read_b64_tr_b16 a[122:123], v23 offset:58368
    ds_read_b64_tr_b16 a[124:125], v24 offset:57344
    ds_read_b64_tr_b16 a[126:127], v24 offset:58368
    s_waitcnt lgkmcnt(0)
    s_barrier
    s_add_u32 m0, s26, 98304
    s_add_u32 s27, s25, 1835008
    buffer_load_dwordx4 v20, s[16:19], s27 offen lds
    s_add_u32 m0, s26, 99328
    s_add_u32 s27, s25, 1843200
    buffer_load_dwordx4 v20, s[16:19], s27 offen lds
    s_add_u32 m0, s26, 100352
    s_add_u32 s27, s25, 1851392
    buffer_load_dwordx4 v20, s[16:19], s27 offen lds
    s_add_u32 m0, s26, 101376
    s_add_u32 s27, s25, 1859584
    buffer_load_dwordx4 v20, s[16:19], s27 offen lds
    s_add_u32 m0, s26, 102400
    s_add_u32 s27, s25, 1867776
    buffer_load_dwordx4 v20, s[16:19], s27 offen lds
    s_add_u32 m0, s26, 103424
    s_add_u32 s27, s25, 1875968
    buffer_load_dwordx4 v20, s[16:19], s27 offen lds
    s_add_u32 m0, s26, 104448
    s_add_u32 s27, s25, 1884160
    buffer_load_dwordx4 v20, s[16:19], s27 offen lds
    s_add_u32 m0, s26, 105472
    s_add_u32 s27, s25, 1892352
    buffer_load_dwordx4 v20, s[16:19], s27 offen lds
    s_waitcnt vmcnt(24)
    s_barrier
    ds_read_b64_tr_b16 a[128:129], v21 offset:0
    ds_read_b64_tr_b16 a[130:131], v21 offset:1024
    ds_read_b64_tr_b16 a[132:133], v22 offset:0
    ds_read_b64_tr_b16 a[134:135], v22 offset:1024
    ds_read_b64_tr_b16 a[136:137], v21 offset:8192
    ds_read_b64_tr_b16 a[138:139], v21 offset:9216
    ds_read_b64_tr_b16 a[140:141], v22 offset:8192
    ds_read_b64_tr_b16 a[142:143], v22 offset:9216
    s_waitcnt lgkmcnt(0)
    ds_read_b64_tr_b16 a[144:145], v21 offset:16384
    ds_read_b64_tr_b16 a[146:147], v21 offset:17408
    ds_read_b64_tr_b16 a[148:149], v22 offset:16384
    ds_read_b64_tr_b16 a[150:151], v22 offset:17408
    ds_read_b64_tr_b16 a[152:153], v21 offset:24576
    ds_read_b64_tr_b16 a[154:155], v21 offset:25600
    ds_read_b64_tr_b16 a[156:157], v22 offset:24576
    ds_read_b64_tr_b16 a[158:159], v22 offset:25600
    s_waitcnt lgkmcnt(0)
    s_waitcnt vmcnt(16)
    s_barrier
    ds_read_b64_tr_b16 a[160:161], v21 offset:32768
    ds_read_b64_tr_b16 a[162:163], v21 offset:33792
    ds_read_b64_tr_b16 a[164:165], v22 offset:32768
    ds_read_b64_tr_b16 a[166:167], v22 offset:33792
    ds_read_b64_tr_b16 a[168:169], v21 offset:40960
    ds_read_b64_tr_b16 a[170:171], v21 offset:41984
    ds_read_b64_tr_b16 a[172:173], v22 offset:40960
    ds_read_b64_tr_b16 a[174:175], v22 offset:41984
    s_waitcnt lgkmcnt(0)
    ds_read_b64_tr_b16 a[176:177], v21 offset:49152
    ds_read_b64_tr_b16 a[178:179], v21 offset:50176
    ds_read_b64_tr_b16 a[180:181], v22 offset:49152
    ds_read_b64_tr_b16 a[182:183], v22 offset:50176
    ds_read_b64_tr_b16 a[184:185], v21 offset:57344
    ds_read_b64_tr_b16 a[186:187], v21 offset:58368
    ds_read_b64_tr_b16 a[188:189], v22 offset:57344
    ds_read_b64_tr_b16 a[190:191], v22 offset:58368
    s_waitcnt lgkmcnt(0)
    s_waitcnt vmcnt(8)
    s_barrier
    ds_read_b64_tr_b16 a[192:193], v23 offset:0
    ds_read_b64_tr_b16 a[194:195], v23 offset:1024
    ds_read_b64_tr_b16 a[196:197], v24 offset:0
    ds_read_b64_tr_b16 a[198:199], v24 offset:1024
    ds_read_b64_tr_b16 a[200:201], v23 offset:8192
    ds_read_b64_tr_b16 a[202:203], v23 offset:9216
    ds_read_b64_tr_b16 a[204:205], v24 offset:8192
    ds_read_b64_tr_b16 a[206:207], v24 offset:9216
    s_waitcnt lgkmcnt(0)
    ds_read_b64_tr_b16 a[208:209], v23 offset:16384
    ds_read_b64_tr_b16 a[210:211], v23 offset:17408
    ds_read_b64_tr_b16 a[212:213], v24 offset:16384
    ds_read_b64_tr_b16 a[214:215], v24 offset:17408
    ds_read_b64_tr_b16 a[216:217], v23 offset:24576
    ds_read_b64_tr_b16 a[218:219], v23 offset:25600
    ds_read_b64_tr_b16 a[220:221], v24 offset:24576
    ds_read_b64_tr_b16 a[222:223], v24 offset:25600
    s_waitcnt lgkmcnt(0)
    s_waitcnt vmcnt(0)
    s_barrier
    ds_read_b64_tr_b16 a[224:225], v23 offset:32768
    ds_read_b64_tr_b16 a[226:227], v23 offset:33792
    ds_read_b64_tr_b16 a[228:229], v24 offset:32768
    ds_read_b64_tr_b16 a[230:231], v24 offset:33792
    ds_read_b64_tr_b16 a[232:233], v23 offset:40960
    ds_read_b64_tr_b16 a[234:235], v23 offset:41984
    ds_read_b64_tr_b16 a[236:237], v24 offset:40960
    ds_read_b64_tr_b16 a[238:239], v24 offset:41984
    s_waitcnt lgkmcnt(0)
    ds_read_b64_tr_b16 a[240:241], v23 offset:49152
    ds_read_b64_tr_b16 a[242:243], v23 offset:50176
    ds_read_b64_tr_b16 a[244:245], v24 offset:49152
    ds_read_b64_tr_b16 a[246:247], v24 offset:50176
    ds_read_b64_tr_b16 a[248:249], v23 offset:57344
    ds_read_b64_tr_b16 a[250:251], v23 offset:58368
    ds_read_b64_tr_b16 a[252:253], v24 offset:57344
    ds_read_b64_tr_b16 a[254:255], v24 offset:58368
    s_waitcnt lgkmcnt(0)
    v_mov_b32 v2, 0
L_pl_287:
    buffer_load_dword v1, v2, s[12:15], s48 offen sc1
    s_add_u32 s36, s36, 1
    s_cmp_gt_u32 s36, 0x100000
    s_cbranch_scc1 chain_kernel_wend
    s_waitcnt vmcnt(0)
    v_readfirstlane_b32 s26, v1
    s_cmp_ge_u32 s26, 4
    s_cbranch_scc1 L_plok_288
    s_sleep 4
    s_branch L_pl_287
L_plok_288:
    s_lshl_b32 s25, s42, 9
    s_lshl_b32 s26, s49, 7
    s_add_u32 s25, s25, s26
    s_lshl_b32 s26, s39, 13
    s_add_u32 s25, s25, s26
    s_add_u32 s25, s25, 4096
    v_bfe_u32 v1, v0, 3, 3
    v_and_b32 v2, 7, v0
    v_lshlrev_b32 v1, 15, v1
    v_lshl_add_u32 v1, v2, 4, v1
    v_add_u32 v128, s25, v1
    s_lshl_b32 s48, s39, 7
    s_add_u32 s48, s48, 0x5904000
    s_lshl_b32 s50, s39, 18
    s_add_u32 s50, s50, 2048
    s_mov_b32 s8, s100
    s_and_b32 s9, s101, 0xffff
    s_mov_b32 s10, 0x10000000
    s_mov_b32 s11, 0x00020000
    s_mov_b32 s16, s96
    s_and_b32 s17, s97, 0xffff
    s_mov_b32 s18, 0x1000000
    s_mov_b32 s19, 0x00020000
    s_lshl_b32 s39, s39, 4
    s_lshl_b32 s21, s49, 12
    v_and_b32 v1, 63, v0
    v_and_b32 v2, 15, v0
    v_bfe_u32 v3, v0, 4, 2
    v_lshrrev_b32 v4, 6, v0
    v_lshlrev_b32 v5, 4, v1
    v_lshl_add_u32 v5, v4, 14, v5
    v_add_u32 v8, 0, v5
    v_add_u32 v9, 1024, v5
    v_add_u32 v10, 4096, v5
    v_add_u32 v11, 5120, v5
    v_lshlrev_b32 v5, 4, v2
    v_lshl_add_u32 v5, v3, 9, v5
    v_xor_b32 v12, s39, v5
    v_xor_b32 v13, 0x100, v12
    v_add_u32 v16, 0x10000, v12
    v_add_u32 v17, 0x10000, v13
    s_cmp_lt_u32 s41, 16
    s_cselect_b32 s25, 18, 30
    s_lshr_b32 s26, s25, 1
    s_sub_u32 s95, s40, s26
    s_add_u32 s25, s25, 2
    s_cmp_eq_u32 s40, 3
    s_cselect_b32 s95, s25, s95
    s_cselect_b32 s94, 0, s40
    s_sub_u32 s23, 66, s95
    s_mul_i32 s23, s23, 43691
    s_lshr_b32 s23, s23, 17
    s_mov_b32 s52, 0
    v_mov_b32 v4, 0
    s_sub_u32 s61, s23, 1
    s_mov_b32 s22, 0
    s_mov_b32 s24, 0
    s_add_u32 s51, s24, 0
    s_min_u32 s51, s51, s61
    s_mul_i32 s3, s51, 3
    s_add_u32 s3, s3, s95
    s_lshl1_add_u32 s51, s51, s94
    s_max_i32 s51, s51, s3
    s_lshl_b32 s51, s51, 9
    s_add_u32 s51, s51, s48
L_gw_290:
    buffer_load_dword v87, v4, s[12:15], s51 offen sc1
    s_add_u32 s36, s36, 1
    s_cmp_gt_u32 s36, 0x100000
    s_cbranch_scc1 chain_kernel_wend
    s_waitcnt vmcnt(0)
    v_readfirstlane_b32 s30, v87
    s_cmp_lt_u32 s30, 8
    s_cbranch_scc0 L_rgo_289
    s_sleep 1
    s_branch L_gw_290
L_rgo_289:
    s_add_u32 s51, s24, 1
    s_min_u32 s51, s51, s61
    s_mul_i32 s3, s51, 3
    s_add_u32 s3, s3, s95
    s_lshl1_add_u32 s51, s51, s94
    s_max_i32 s51, s51, s3
    s_lshl_b32 s51, s51, 9
    s_add_u32 s51, s51, s48
    buffer_load_dword v87, v4, s[12:15], s51 offen sc1
    s_mov_b32 s37, 0
    s_mov_b32 s7, 0
    v_mov_b32 v88, 0
    v_mov_b32 v89, 0
    v_mov_b32 v90, 0
    v_mov_b32 v91, 0
    v_mov_b32 v92, 0
    v_mov_b32 v93, 0
    v_mov_b32 v94, 0
    v_mov_b32 v95, 0
    s_mov_b32 s30, s24
    s_mul_i32 s3, s30, 3
    s_add_u32 s3, s3, s95
    s_lshl1_add_u32 s30, s30, s94
    s_max_i32 s30, s30, s3
    s_bitcmp1_b32 s30, 1
    s_cselect_b32 s53, s54, s55
    s_lshl_b32 s30, s30, 20
    s_add_u32 s53, s53, s30
    s_add_u32 s53, s53, s50
    s_mov_b32 s20, s53
    s_mov_b32 s39, 0x7ff00000
    s_mov_b32 s42, 0x7ff00000
    s_mov_b32 s43, 0x7ff00000
    s_barrier
    s_add_u32 m0, s21, 0
    s_nop 0
    buffer_load_dwordx4 v8, s[8:11], s20 offen lds
    s_add_u32 m0, s21, 1024
    s_nop 0
    buffer_load_dwordx4 v9, s[8:11], s20 offen lds
    s_add_u32 m0, s21, 2048
    s_nop 0
    buffer_load_dwordx4 v10, s[8:11], s20 offen lds
    s_add_u32 m0, s21, 3072
    s_nop 0
    buffer_load_dwordx4 v11, s[8:11], s20 offen lds
    s_add_u32 s20, s20, 65536
    s_add_u32 m0, s21, 16384
    s_nop 0
    buffer_load_dwordx4 v8, s[8:11], s20 offen lds
    s_add_u32 m0, s21, 17408
    s_nop 0
    buffer_load_dwordx4 v9, s[8:11], s20 offen lds
    s_add_u32 m0, s21, 18432
    s_nop 0
    buffer_load_dwordx4 v10, s[8:11], s20 offen lds
    s_add_u32 m0, s21, 19456
    s_nop 0
    buffer_load_dwordx4 v11, s[8:11], s20 offen lds
    s_add_u32 s20, s20, 65536
    s_add_u32 m0, s21, 32768
    s_nop 0
    buffer_load_dwordx4 v8, s[8:11], s20 offen lds
    s_add_u32 m0, s21, 33792
    s_nop 0
    buffer_load_dwordx4 v9, s[8:11], s20 offen lds
    s_add_u32 m0, s21, 34816
    s_nop 0
    buffer_load_dwordx4 v10, s[8:11], s20 offen lds
    s_add_u32 m0, s21, 35840
    s_nop 0
    buffer_load_dwordx4 v11, s[8:11], s20 offen lds
    s_add_u32 s20, s20, 65536
    s_add_u32 m0, s21, 49152
    s_nop 0
    buffer_load_dwordx4 v8, s[8:11], s20 offen lds
    s_waitcnt vmcnt(0)
    s_barrier
    ds_read_b128 v[20:23], v12 offset:0
    ds_read_b128 v[24:27], v13 offset:0
    ds_read_b128 v[28:31], v12 offset:2048
    ds_read_b128 v[32:35], v13 offset:2048
    ds_read_b128 v[36:39], v12 offset:4096
    ds_read_b128 v[40:43], v13 offset:4096
    s_waitcnt lgkmcnt(4)
L_st_294:
    v_mfma_f32_16x16x32_bf16 v[52:55], v[20:23], a[0:3], 0
    ds_read_b128 v[44:47], v12 offset:6144
    s_add_u32 m0, s21, 50176
    s_sub_u32 s38, s22, 1
    v_mfma_f32_16x16x32_bf16 v[56:59], v[20:23], a[4:7], 0
    buffer_load_dwordx4 v9, s[8:11], s20 offen lds
    s_and_b32 s31, s38, 3
    v_mfma_f32_16x16x32_bf16 v[60:63], v[24:27], a[0:3], 0
    ds_read_b128 v[48:51], v13 offset:6144
    s_lshl_b32 s31, s31, 11
    v_mfma_f32_16x16x32_bf16 v[64:67], v[24:27], a[4:7], 0
    s_waitcnt lgkmcnt(4)
    s_bfe_u32 s38, s38, 0x10002
    s_xor_b32 s38, s38, 1
    v_mfma_f32_16x16x32_bf16 v[52:55], v[28:31], a[8:11], v[52:55]
    ds_read_b128 v[20:23], v12 offset:8192
    s_cmp_eq_u32 s37, 0
    s_cselect_b32 s31, 0x40000000, s31
    s_cselect_b32 s38, 0, s38
    v_mfma_f32_16x16x32_bf16 v[56:59], v[28:31], a[12:15], v[56:59]
    v_mfma_f32_16x16x32_bf16 v[60:63], v[32:35], a[8:11], v[60:63]
    ds_read_b128 v[24:27], v13 offset:8192
    s_add_u32 s24, s24, 1
    s_min_u32 s24, s24, s61
    v_mfma_f32_16x16x32_bf16 v[64:67], v[32:35], a[12:15], v[64:67]
    s_waitcnt lgkmcnt(4)
    s_mov_b32 s30, s24
    s_mul_i32 s3, s30, 3
    v_mfma_f32_16x16x32_bf16 v[52:55], v[36:39], a[16:19], v[52:55]
    ds_read_b128 v[28:31], v12 offset:10240
    s_add_u32 m0, s21, 51200
    v_cvt_pk_bf16_f32 v104, v69, v73
    v_mfma_f32_16x16x32_bf16 v[56:59], v[36:39], a[20:23], v[56:59]
    buffer_load_dwordx4 v10, s[8:11], s20 offen lds
    s_add_u32 s3, s3, s95
    v_mfma_f32_16x16x32_bf16 v[60:63], v[40:43], a[16:19], v[60:63]
    ds_read_b128 v[32:35], v13 offset:10240
    s_lshl1_add_u32 s30, s30, s94
    s_max_i32 s30, s30, s3
    v_mfma_f32_16x16x32_bf16 v[64:67], v[40:43], a[20:23], v[64:67]
    s_waitcnt lgkmcnt(4)
    s_bitcmp1_b32 s30, 1
    s_cselect_b32 s53, s54, s55
    v_mfma_f32_16x16x32_bf16 v[52:55], v[44:47], a[24:27], v[52:55]
    ds_read_b128 v[36:39], v12 offset:12288
    s_lshl_b32 s30, s30, 20
    v_cvt_pk_bf16_f32 v105, v77, v81
    v_mfma_f32_16x16x32_bf16 v[56:59], v[44:47], a[28:31], v[56:59]
    s_add_u32 s53, s53, s30
    s_add_u32 s53, s53, s50
    v_and_or_b32 v104, v104, -2, s38
    v_mfma_f32_16x16x32_bf16 v[60:63], v[48:51], a[24:27], v[60:63]
    ds_read_b128 v[40:43], v13 offset:12288
    s_waitcnt vmcnt(11)
    v_mfma_f32_16x16x32_bf16 v[64:67], v[48:51], a[28:31], v[64:67]
    s_waitcnt lgkmcnt(4)
    v_readfirstlane_b32 s30, v87
    s_nop 0
    v_mfma_f32_16x16x32_bf16 v[52:55], v[20:23], a[32:35], v[52:55]
    ds_read_b128 v[44:47], v12 offset:14336
    s_add_u32 m0, s21, 52224
    s_nop 0
    v_mfma_f32_16x16x32_bf16 v[56:59], v[20:23], a[36:39], v[56:59]
    buffer_load_dwordx4 v11, s[8:11], s20 offen lds
    v_and_or_b32 v105, v105, -2, s38
    v_mfma_f32_16x16x32_bf16 v[60:63], v[24:27], a[32:35], v[60:63]
    ds_read_b128 v[48:51], v13 offset:14336
    s_cmp_lt_u32 s30, 8
    s_cbranch_scc1 L_gw_298
L_gok_297:
    v_mfma_f32_16x16x32_bf16 v[64:67], v[24:27], a[36:39], v[64:67]
    s_waitcnt lgkmcnt(4)
    s_add_u32 s29, s45, s31
    v_mfma_f32_16x16x32_bf16 v[52:55], v[28:31], a[40:43], v[52:55]
    s_waitcnt vmcnt(13)
    s_barrier
    ds_read_b128 v[20:23], v12 offset:16384
    v_mfma_f32_16x16x32_bf16 v[56:59], v[28:31], a[44:47], v[56:59]
    s_mov_b32 s20, s53
    buffer_store_dwordx2 v[104:105], v112, s[12:15], s29 offen offset:0 sc1
    v_mfma_f32_16x16x32_bf16 v[60:63], v[32:35], a[40:43], v[60:63]
    ds_read_b128 v[24:27], v13 offset:16384
    v_cvt_pk_bf16_f32 v106, v70, v74
    v_mfma_f32_16x16x32_bf16 v[64:67], v[32:35], a[44:47], v[64:67]
    s_waitcnt lgkmcnt(4)
    v_cvt_pk_bf16_f32 v107, v78, v82
    v_mfma_f32_16x16x32_bf16 v[52:55], v[36:39], a[48:51], v[52:55]
    ds_read_b128 v[28:31], v12 offset:18432
    s_add_u32 m0, s21, 65536
    v_mfma_f32_16x16x32_bf16 v[56:59], v[36:39], a[52:55], v[56:59]
    buffer_load_dwordx4 v8, s[8:11], s20 offen lds
    v_mfma_f32_16x16x32_bf16 v[60:63], v[40:43], a[48:51], v[60:63]
    ds_read_b128 v[32:35], v13 offset:18432
    v_and_or_b32 v106, v106, -2, s38
    v_mfma_f32_16x16x32_bf16 v[64:67], v[40:43], a[52:55], v[64:67]
    s_waitcnt lgkmcnt(4)
    v_and_or_b32 v107, v107, -2, s38
    v_mfma_f32_16x16x32_bf16 v[52:55], v[44:47], a[56:59], v[52:55]
    ds_read_b128 v[36:39], v12 offset:20480
    s_add_u32 s29, s46, s31
    v_mfma_f32_16x16x32_bf16 v[56:59], v[44:47], a[60:63], v[56:59]
    buffer_store_dwordx2 v[106:107], v112, s[12:15], s29 offen offset:512 sc1
    v_mfma_f32_16x16x32_bf16 v[60:63], v[48:51], a[56:59], v[60:63]
    ds_read_b128 v[40:43], v13 offset:20480
    v_cvt_pk_bf16_f32 v108, v71, v75
    v_mfma_f32_16x16x32_bf16 v[64:67], v[48:51], a[60:63], v[64:67]
    s_waitcnt lgkmcnt(4)
    v_cvt_pk_bf16_f32 v109, v79, v83
    v_mfma_f32_16x16x32_bf16 v[52:55], v[20:23], a[64:67], v[52:55]
    ds_read_b128 v[44:47], v12 offset:22528
    s_add_u32 m0, s21, 66560
    v_mfma_f32_16x16x32_bf16 v[56:59], v[20:23], a[68:71], v[56:59]
    buffer_load_dwordx4 v9, s[8:11], s20 offen lds
    v_mfma_f32_16x16x32_bf16 v[60:63], v[24:27], a[64:67], v[60:63]
    ds_read_b128 v[48:51], v13 offset:22528
    v_and_or_b32 v108, v108, -2, s38
    v_mfma_f32_16x16x32_bf16 v[64:67], v[24:27], a[68:71], v[64:67]
    s_waitcnt lgkmcnt(4)
    v_and_or_b32 v109, v109, -2, s38
    v_mfma_f32_16x16x32_bf16 v[52:55], v[28:31], a[72:75], v[52:55]
    ds_read_b128 v[20:23], v12 offset:24576
    s_add_u32 s29, s47, s31
    v_mfma_f32_16x16x32_bf16 v[56:59], v[28:31], a[76:79], v[56:59]
    buffer_store_dwordx2 v[108:109], v112, s[12:15], s29 offen offset:1024 sc1
    v_mfma_f32_16x16x32_bf16 v[60:63], v[32:35], a[72:75], v[60:63]
    ds_read_b128 v[24:27], v13 offset:24576
    v_mfma_f32_16x16x32_bf16 v[64:67], v[32:35], a[76:79], v[64:67]
    s_waitcnt lgkmcnt(4)
    v_mfma_f32_16x16x32_bf16 v[52:55], v[36:39], a[80:83], v[52:55]
    ds_read_b128 v[28:31], v12 offset:26624
    s_add_u32 m0, s21, 67584
    v_mfma_f32_16x16x32_bf16 v[56:59], v[36:39], a[84:87], v[56:59]
    buffer_load_dwordx4 v10, s[8:11], s20 offen lds
    v_mfma_f32_16x16x32_bf16 v[60:63], v[40:43], a[80:83], v[60:63]
    ds_read_b128 v[32:35], v13 offset:26624
    v_mfma_f32_16x16x32_bf16 v[64:67], v[40:43], a[84:87], v[64:67]
    s_waitcnt lgkmcnt(4)
    v_mfma_f32_16x16x32_bf16 v[52:55], v[44:47], a[88:91], v[52:55]
    ds_read_b128 v[36:39], v12 offset:28672
    v_mfma_f32_16x16x32_bf16 v[56:59], v[44:47], a[92:95], v[56:59]
    v_mfma_f32_16x16x32_bf16 v[60:63], v[48:51], a[88:91], v[60:63]
    ds_read_b128 v[40:43], v13 offset:28672
    v_mfma_f32_16x16x32_bf16 v[64:67], v[48:51], a[92:95], v[64:67]
    s_waitcnt lgkmcnt(4)
    v_mfma_f32_16x16x32_bf16 v[52:55], v[20:23], a[96:99], v[52:55]
    ds_read_b128 v[44:47], v12 offset:30720
    s_add_u32 m0, s21, 68608
    v_mfma_f32_16x16x32_bf16 v[56:59], v[20:23], a[100:103], v[56:59]
    buffer_load_dwordx4 v11, s[8:11], s20 offen lds
    v_mfma_f32_16x16x32_bf16 v[60:63], v[24:27], a[96:99], v[60:63]
    ds_read_b128 v[48:51], v13 offset:30720
    v_mfma_f32_16x16x32_bf16 v[64:67], v[24:27], a[100:103], v[64:67]
    s_waitcnt lgkmcnt(4)
    v_mfma_f32_16x16x32_bf16 v[52:55], v[28:31], a[104:107], v[52:55]
    s_waitcnt vmcnt(13)
    s_barrier
    ds_read_b128 v[20:23], v12 offset:32768
    v_mfma_f32_16x16x32_bf16 v[56:59], v[28:31], a[108:111], v[56:59]
    s_add_u32 s20, s20, 65536
    v_mfma_f32_16x16x32_bf16 v[60:63], v[32:35], a[104:107], v[60:63]
    ds_read_b128 v[24:27], v13 offset:32768
    v_mfma_f32_16x16x32_bf16 v[64:67], v[32:35], a[108:111], v[64:67]
    s_waitcnt lgkmcnt(4)
    v_mfma_f32_16x16x32_bf16 v[52:55], v[36:39], a[112:115], v[52:55]
    ds_read_b128 v[28:31], v12 offset:34816
    s_add_u32 m0, s21, 81920
    s_waitcnt vmcnt(10)
    v_mfma_f32_16x16x32_bf16 v[56:59], v[36:39], a[116:119], v[56:59]
    buffer_load_dwordx4 v8, s[8:11], s20 offen lds
    v_xor_b32 v124, s7, v88
    v_mfma_f32_16x16x32_bf16 v[60:63], v[40:43], a[112:115], v[60:63]
    ds_read_b128 v[32:35], v13 offset:34816
    v_bitop3_b32 v124, v124, v89, s7 bitop3:0xf6
    v_bitop3_b32 v124, v124, v90, s7 bitop3:0xf6
    v_mfma_f32_16x16x32_bf16 v[64:67], v[40:43], a[116:119], v[64:67]
    s_waitcnt lgkmcnt(4)
    v_bitop3_b32 v124, v124, v91, s7 bitop3:0xf6
    v_mfma_f32_16x16x32_bf16 v[52:55], v[44:47], a[120:123], v[52:55]
    ds_read_b128 v[36:39], v12 offset:36864
    v_bitop3_b32 v124, v124, v92, s7 bitop3:0xf6
    v_bitop3_b32 v124, v124, v93, s7 bitop3:0xf6
    v_mfma_f32_16x16x32_bf16 v[56:59], v[44:47], a[124:127], v[56:59]
    v_and_b32 v124, 1, v124
    v_cmp_ne_u32 vcc, 0, v124
    v_mfma_f32_16x16x32_bf16 v[60:63], v[48:51], a[120:123], v[60:63]
    ds_read_b128 v[40:43], v13 offset:36864
    s_nop 0
    s_nop 0
    v_mfma_f32_16x16x32_bf16 v[64:67], v[48:51], a[124:127], v[64:67]
    s_waitcnt lgkmcnt(4)
    s_nop 0
    s_cbranch_vccnz L_rbad_295
L_rok_296:
    v_mfma_f32_16x16x32_bf16 v[52:55], v[20:23], a[128:131], v[52:55]
    ds_read_b128 v[44:47], v12 offset:38912
    s_add_u32 m0, s21, 82944
    v_mfma_f32_16x16x32_bf16 v[56:59], v[20:23], a[132:135], v[56:59]
    buffer_load_dwordx4 v9, s[8:11], s20 offen lds
    v_mfma_f32_16x16x32_bf16 v[60:63], v[24:27], a[128:131], v[60:63]
    ds_read_b128 v[48:51], v13 offset:38912
    v_lshlrev_b32 v124, 16, v88
    v_and_b32 v125, 0xffff0000, v88
    v_mfma_f32_16x16x32_bf16 v[64:67], v[24:27], a[132:135], v[64:67]
    s_waitcnt lgkmcnt(4)
    v_add_f32 v96, v116, v124
    v_mfma_f32_16x16x32_bf16 v[52:55], v[28:31], a[136:139], v[52:55]
    ds_read_b128 v[20:23], v12 offset:40960
    v_add_f32 v97, v117, v125
    v_lshlrev_b32 v124, 16, v89
    v_mfma_f32_16x16x32_bf16 v[56:59], v[28:31], a[140:143], v[56:59]
    v_and_b32 v125, 0xffff0000, v89
    v_add_f32 v98, v118, v124
    v_mfma_f32_16x16x32_bf16 v[60:63], v[32:35], a[136:139], v[60:63]
    ds_read_b128 v[24:27], v13 offset:40960
    s_add_u32 s51, s24, 1
    v_add_f32 v99, v119, v125
    v_mfma_f32_16x16x32_bf16 v[64:67], v[32:35], a[140:143], v[64:67]
    s_waitcnt lgkmcnt(4)
    s_min_u32 s51, s51, s61
    v_lshlrev_b32 v124, 16, v90
    v_mfma_f32_16x16x32_bf16 v[52:55], v[36:39], a[144:147], v[52:55]
    ds_read_b128 v[28:31], v12 offset:43008
    s_add_u32 m0, s21, 83968
    v_and_b32 v125, 0xffff0000, v90
    v_mfma_f32_16x16x32_bf16 v[56:59], v[36:39], a[148:151], v[56:59]
    buffer_load_dwordx4 v10, s[8:11], s20 offen lds
    v_add_f32 v96, v96, v124
    v_mfma_f32_16x16x32_bf16 v[60:63], v[40:43], a[144:147], v[60:63]
    ds_read_b128 v[32:35], v13 offset:43008
    s_mul_i32 s3, s51, 3
    v_mfma_f32_16x16x32_bf16 v[64:67], v[40:43], a[148:151], v[64:67]
    s_waitcnt lgkmcnt(4)
    v_add_f32 v97, v97, v125
    v_lshlrev_b32 v124, 16, v91
    v_mfma_f32_16x16x32_bf16 v[52:55], v[44:47], a[152:155], v[52:55]
    ds_read_b128 v[36:39], v12 offset:45056
    s_add_u32 s3, s3, s95
    v_and_b32 v125, 0xffff0000, v91
    v_mfma_f32_16x16x32_bf16 v[56:59], v[44:47], a[156:159], v[56:59]
    s_lshl1_add_u32 s51, s51, s94
    s_max_i32 s51, s51, s3
    v_add_f32 v98, v98, v124
    v_mfma_f32_16x16x32_bf16 v[60:63], v[48:51], a[152:155], v[60:63]
    ds_read_b128 v[40:43], v13 offset:45056
    v_add_f32 v99, v99, v125
    v_mfma_f32_16x16x32_bf16 v[64:67], v[48:51], a[156:159], v[64:67]
    s_waitcnt lgkmcnt(4)
    s_lshl_b32 s51, s51, 9
    v_lshlrev_b32 v124, 16, v92
    v_mfma_f32_16x16x32_bf16 v[52:55], v[20:23], a[160:163], v[52:55]
    ds_read_b128 v[44:47], v12 offset:47104
    s_add_u32 m0, s21, 84992
    v_and_b32 v125, 0xffff0000, v92
    v_mfma_f32_16x16x32_bf16 v[56:59], v[20:23], a[164:167], v[56:59]
    buffer_load_dwordx4 v11, s[8:11], s20 offen lds
    v_add_f32 v96, v96, v124
    v_mfma_f32_16x16x32_bf16 v[60:63], v[24:27], a[160:163], v[60:63]
    ds_read_b128 v[48:51], v13 offset:47104
    s_add_u32 s51, s51, s48
    v_mfma_f32_16x16x32_bf16 v[64:67], v[24:27], a[164:167], v[64:67]
    s_waitcnt lgkmcnt(4)
    v_add_f32 v97, v97, v125
    v_lshlrev_b32 v124, 16, v93
    v_mfma_f32_16x16x32_bf16 v[52:55], v[28:31], a[168:171], v[52:55]
    s_waitcnt vmcnt(11)
    s_barrier
    ds_read_b128 v[20:23], v12 offset:49152
    v_mfma_f32_16x16x32_bf16 v[56:59], v[28:31], a[172:175], v[56:59]
    s_add_u32 s20, s20, 65536
    buffer_load_dword v87, v4, s[12:15], s51 offen sc1
    v_mfma_f32_16x16x32_bf16 v[60:63], v[32:35], a[168:171], v[60:63]
    ds_read_b128 v[24:27], v13 offset:49152
    v_and_b32 v125, 0xffff0000, v93
    v_add_f32 v98, v98, v124
    v_mfma_f32_16x16x32_bf16 v[64:67], v[32:35], a[172:175], v[64:67]
    s_waitcnt lgkmcnt(4)
    v_add_f32 v99, v99, v125
    v_mfma_f32_16x16x32_bf16 v[52:55], v[36:39], a[176:179], v[52:55]
    ds_read_b128 v[28:31], v12 offset:51200
    s_add_u32 m0, s21, 98304
    ds_write2_b32 v114, v96, v97 offset0:0 offset1:16
    v_mfma_f32_16x16x32_bf16 v[56:59], v[36:39], a[180:183], v[56:59]
    buffer_load_dwordx4 v8, s[8:11], s20 offen lds
    ds_write2_b32 v114, v98, v99 offset0:128 offset1:144
    v_mfma_f32_16x16x32_bf16 v[60:63], v[40:43], a[176:179], v[60:63]
    ds_read_b128 v[32:35], v13 offset:51200
    ds_read_b128 v[88:91], v113 offset:0
    v_mfma_f32_16x16x32_bf16 v[64:67], v[40:43], a[180:183], v[64:67]
    s_waitcnt lgkmcnt(4)
    v_mfma_f32_16x16x32_bf16 v[52:55], v[44:47], a[184:187], v[52:55]
    ds_read_b128 v[36:39], v12 offset:53248
    v_mfma_f32_16x16x32_bf16 v[56:59], v[44:47], a[188:191], v[56:59]
    v_mfma_f32_16x16x32_bf16 v[60:63], v[48:51], a[184:187], v[60:63]
    ds_read_b128 v[40:43], v13 offset:53248
    s_waitcnt lgkmcnt(2)
    v_mfma_f32_16x16x32_bf16 v[64:67], v[48:51], a[188:191], v[64:67]
    s_waitcnt lgkmcnt(4)
    v_cvt_pk_bf16_f32 v96, 0, v88
    v_mfma_f32_16x16x32_bf16 v[52:55], v[20:23], a[192:195], v[52:55]
    ds_read_b128 v[44:47], v12 offset:55296
    s_add_u32 m0, s21, 99328
    v_mfma_f32_16x16x32_bf16 v[56:59], v[20:23], a[196:199], v[56:59]
    buffer_load_dwordx4 v9, s[8:11], s20 offen lds
    v_mfma_f32_16x16x32_bf16 v[60:63], v[24:27], a[192:195], v[60:63]
    ds_read_b128 v[48:51], v13 offset:55296
    v_cvt_pk_bf16_f32 v97, 0, v89
    v_mfma_f32_16x16x32_bf16 v[64:67], v[24:27], a[196:199], v[64:67]
    s_waitcnt lgkmcnt(4)
    v_cvt_pk_bf16_f32 v98, 0, v90
    v_mfma_f32_16x16x32_bf16 v[52:55], v[28:31], a[200:203], v[52:55]
    ds_read_b128 v[20:23], v12 offset:57344
    v_cvt_pk_bf16_f32 v99, 0, v91
    v_mfma_f32_16x16x32_bf16 v[56:59], v[28:31], a[204:207], v[56:59]
    buffer_store_dwordx4 v[96:99], v128, s[16:19], s43 offen
    v_mfma_f32_16x16x32_bf16 v[60:63], v[32:35], a[200:203], v[60:63]
    ds_read_b128 v[24:27], v13 offset:57344
    v_mfma_f32_16x16x32_bf16 v[64:67], v[32:35], a[204:207], v[64:67]
    s_waitcnt lgkmcnt(4)
    v_mfma_f32_16x16x32_bf16 v[52:55], v[36:39], a[208:211], v[52:55]
    ds_read_b128 v[28:31], v12 offset:59392
    s_add_u32 m0, s21, 100352
    v_mov_b32 v116, v68
    v_mov_b32 v117, v72
    v_mfma_f32_16x16x32_bf16 v[56:59], v[36:39], a[212:215], v[56:59]
    buffer_load_dwordx4 v10, s[8:11], s20 offen lds
    v_mov_b32 v118, v76
    v_mov_b32 v119, v80
    v_mfma_f32_16x16x32_bf16 v[60:63], v[40:43], a[208:211], v[60:63]
    ds_read_b128 v[32:35], v13 offset:59392
    s_mov_b32 s7, s38
    s_add_u32 s39, s44, s31
    s_sub_u32 s43, s22, 1
    v_mfma_f32_16x16x32_bf16 v[64:67], v[40:43], a[212:215], v[64:67]
    s_waitcnt lgkmcnt(4)
    s_mul_i32 s3, s43, 3
    s_add_u32 s3, s3, s95
    s_lshl1_add_u32 s43, s43, s94
    v_mfma_f32_16x16x32_bf16 v[52:55], v[44:47], a[216:219], v[52:55]
    ds_read_b128 v[36:39], v12 offset:61440
    s_max_i32 s43, s43, s3
    s_lshl_b32 s43, s43, 18
    s_cmp_eq_u32 s37, 0
    s_cselect_b32 s43, 0x7ff00000, s43
    v_mfma_f32_16x16x32_bf16 v[56:59], v[44:47], a[220:223], v[56:59]
    buffer_load_dwordx2 v[88:89], v112, s[12:15], s39 offen offset:0 sc1
    v_mfma_f32_16x16x32_bf16 v[60:63], v[48:51], a[216:219], v[60:63]
    ds_read_b128 v[40:43], v13 offset:61440
    v_mfma_f32_16x16x32_bf16 v[64:67], v[48:51], a[220:223], v[64:67]
    s_waitcnt lgkmcnt(4)
    v_mfma_f32_16x16x32_bf16 v[52:55], v[20:23], a[224:227], v[52:55]
    ds_read_b128 v[44:47], v12 offset:63488
    s_add_u32 m0, s21, 101376
    v_mfma_f32_16x16x32_bf16 v[56:59], v[20:23], a[228:231], v[56:59]
    buffer_load_dwordx4 v11, s[8:11], s20 offen lds
    v_mfma_f32_16x16x32_bf16 v[60:63], v[24:27], a[224:227], v[60:63]
    ds_read_b128 v[48:51], v13 offset:63488
    v_mfma_f32_16x16x32_bf16 v[64:67], v[24:27], a[228:231], v[64:67]
    s_waitcnt lgkmcnt(4)
    v_mfma_f32_16x16x32_bf16 v[52:55], v[28:31], a[232:235], v[52:55]
    s_waitcnt vmcnt(11)
    s_barrier
    ds_read_b128 v[20:23], v16 offset:0
    v_mfma_f32_16x16x32_bf16 v[56:59], v[28:31], a[236:239], v[56:59]
    s_add_u32 s20, s20, 65536
    buffer_load_dwordx2 v[90:91], v112, s[12:15], s39 offen offset:512 sc1
    v_mfma_f32_16x16x32_bf16 v[60:63], v[32:35], a[232:235], v[60:63]
    ds_read_b128 v[24:27], v17 offset:0
    v_mfma_f32_16x16x32_bf16 v[64:67], v[32:35], a[236:239], v[64:67]
    s_waitcnt lgkmcnt(4)
    v_mfma_f32_16x16x32_bf16 v[52:55], v[36:39], a[240:243], v[52:55]
    ds_read_b128 v[28:31], v16 offset:2048
    s_add_u32 m0, s21, 114688
    v_mfma_f32_16x16x32_bf16 v[56:59], v[36:39], a[244:247], v[56:59]
    buffer_load_dwordx4 v8, s[8:11], s20 offen lds
    v_mfma_f32_16x16x32_bf16 v[60:63], v[40:43], a[240:243], v[60:63]
    ds_read_b128 v[32:35], v17 offset:2048
    v_mfma_f32_16x16x32_bf16 v[64:67], v[40:43], a[244:247], v[64:67]
    s_waitcnt lgkmcnt(4)
    v_mfma_f32_16x16x32_bf16 v[52:55], v[44:47], a[248:251], v[52:55]
    ds_read_b128 v[36:39], v16 offset:4096
    v_mfma_f32_16x16x32_bf16 v[56:59], v[44:47], a[252:255], v[56:59]
    buffer_load_dwordx2 v[92:93], v112, s[12:15], s39 offen offset:1024 sc1
    v_mfma_f32_16x16x32_bf16 v[60:63], v[48:51], a[248:251], v[60:63]
    ds_read_b128 v[40:43], v17 offset:4096
    s_mov_b32 s37, 1
    v_mfma_f32_16x16x32_bf16 v[64:67], v[48:51], a[252:255], v[64:67]
    s_waitcnt lgkmcnt(4)
    s_add_u32 s22, s22, 1
    s_cmp_ge_u32 s22, s23
    s_cbranch_scc1 L_fl0_291
    v_mfma_f32_16x16x32_bf16 v[68:71], v[20:23], a[0:3], 0
    ds_read_b128 v[44:47], v16 offset:6144
    s_add_u32 m0, s21, 115712
    s_sub_u32 s38, s22, 1
    v_mfma_f32_16x16x32_bf16 v[72:75], v[20:23], a[4:7], 0
    buffer_load_dwordx4 v9, s[8:11], s20 offen lds
    s_and_b32 s31, s38, 3
    v_mfma_f32_16x16x32_bf16 v[76:79], v[24:27], a[0:3], 0
    ds_read_b128 v[48:51], v17 offset:6144
    s_lshl_b32 s31, s31, 11
    v_mfma_f32_16x16x32_bf16 v[80:83], v[24:27], a[4:7], 0
    s_waitcnt lgkmcnt(4)
    s_bfe_u32 s38, s38, 0x10002
    s_xor_b32 s38, s38, 1
    v_mfma_f32_16x16x32_bf16 v[68:71], v[28:31], a[8:11], v[68:71]
    ds_read_b128 v[20:23], v16 offset:8192
    s_cmp_eq_u32 s37, 0
    s_cselect_b32 s31, 0x40000000, s31
    s_cselect_b32 s38, 0, s38
    v_mfma_f32_16x16x32_bf16 v[72:75], v[28:31], a[12:15], v[72:75]
    v_mfma_f32_16x16x32_bf16 v[76:79], v[32:35], a[8:11], v[76:79]
    ds_read_b128 v[24:27], v17 offset:8192
    s_add_u32 s24, s24, 1
    s_min_u32 s24, s24, s61
    v_mfma_f32_16x16x32_bf16 v[80:83], v[32:35], a[12:15], v[80:83]
    s_waitcnt lgkmcnt(4)
    s_mov_b32 s30, s24
    s_mul_i32 s3, s30, 3
    v_mfma_f32_16x16x32_bf16 v[68:71], v[36:39], a[16:19], v[68:71]
    ds_read_b128 v[28:31], v16 offset:10240
    s_add_u32 m0, s21, 116736
    v_cvt_pk_bf16_f32 v104, v53, v57
    v_mfma_f32_16x16x32_bf16 v[72:75], v[36:39], a[20:23], v[72:75]
    buffer_load_dwordx4 v10, s[8:11], s20 offen lds
    s_add_u32 s3, s3, s95
    v_mfma_f32_16x16x32_bf16 v[76:79], v[40:43], a[16:19], v[76:79]
    ds_read_b128 v[32:35], v17 offset:10240
    s_lshl1_add_u32 s30, s30, s94
    s_max_i32 s30, s30, s3
    v_mfma_f32_16x16x32_bf16 v[80:83], v[40:43], a[20:23], v[80:83]
    s_waitcnt lgkmcnt(4)
    s_bitcmp1_b32 s30, 1
    s_cselect_b32 s53, s54, s55
    v_mfma_f32_16x16x32_bf16 v[68:71], v[44:47], a[24:27], v[68:71]
    ds_read_b128 v[36:39], v16 offset:12288
    s_lshl_b32 s30, s30, 20
    v_cvt_pk_bf16_f32 v105, v61, v65
    v_mfma_f32_16x16x32_bf16 v[72:75], v[44:47], a[28:31], v[72:75]
    s_add_u32 s53, s53, s30
    s_add_u32 s53, s53, s50
    v_and_or_b32 v104, v104, -2, s38
    v_mfma_f32_16x16x32_bf16 v[76:79], v[48:51], a[24:27], v[76:79]
    ds_read_b128 v[40:43], v17 offset:12288
    s_waitcnt vmcnt(11)
    v_mfma_f32_16x16x32_bf16 v[80:83], v[48:51], a[28:31], v[80:83]
    s_waitcnt lgkmcnt(4)
    v_readfirstlane_b32 s30, v87
    s_nop 0
    v_mfma_f32_16x16x32_bf16 v[68:71], v[20:23], a[32:35], v[68:71]
    ds_read_b128 v[44:47], v16 offset:14336
    s_add_u32 m0, s21, 117760
    s_nop 0
    v_mfma_f32_16x16x32_bf16 v[72:75], v[20:23], a[36:39], v[72:75]
    buffer_load_dwordx4 v11, s[8:11], s20 offen lds
    v_and_or_b32 v105, v105, -2, s38
    v_mfma_f32_16x16x32_bf16 v[76:79], v[24:27], a[32:35], v[76:79]
    ds_read_b128 v[48:51], v17 offset:14336
    s_cmp_lt_u32 s30, 8
    s_cbranch_scc1 L_gw_302
L_gok_301:
    v_mfma_f32_16x16x32_bf16 v[80:83], v[24:27], a[36:39], v[80:83]
    s_waitcnt lgkmcnt(4)
    s_add_u32 s29, s45, s31
    v_mfma_f32_16x16x32_bf16 v[68:71], v[28:31], a[40:43], v[68:71]
    s_waitcnt vmcnt(13)
    s_barrier
    ds_read_b128 v[20:23], v16 offset:16384
    v_mfma_f32_16x16x32_bf16 v[72:75], v[28:31], a[44:47], v[72:75]
    s_mov_b32 s20, s53
    buffer_store_dwordx2 v[104:105], v112, s[12:15], s29 offen offset:0 sc1
    v_mfma_f32_16x16x32_bf16 v[76:79], v[32:35], a[40:43], v[76:79]
    ds_read_b128 v[24:27], v17 offset:16384
    v_cvt_pk_bf16_f32 v106, v54, v58
    v_mfma_f32_16x16x32_bf16 v[80:83], v[32:35], a[44:47], v[80:83]
    s_waitcnt lgkmcnt(4)
    v_cvt_pk_bf16_f32 v107, v62, v66
    v_mfma_f32_16x16x32_bf16 v[68:71], v[36:39], a[48:51], v[68:71]
    ds_read_b128 v[28:31], v16 offset:18432
    s_add_u32 m0, s21, 0
    v_mfma_f32_16x16x32_bf16 v[72:75], v[36:39], a[52:55], v[72:75]
    buffer_load_dwordx4 v8, s[8:11], s20 offen lds
    v_mfma_f32_16x16x32_bf16 v[76:79], v[40:43], a[48:51], v[76:79]
    ds_read_b128 v[32:35], v17 offset:18432
    v_and_or_b32 v106, v106, -2, s38
    v_mfma_f32_16x16x32_bf16 v[80:83], v[40:43], a[52:55], v[80:83]
    s_waitcnt lgkmcnt(4)
    v_and_or_b32 v107, v107, -2, s38
    v_mfma_f32_16x16x32_bf16 v[68:71], v[44:47], a[56:59], v[68:71]
    ds_read_b128 v[36:39], v16 offset:20480
    s_add_u32 s29, s46, s31
    v_mfma_f32_16x16x32_bf16 v[72:75], v[44:47], a[60:63], v[72:75]
    buffer_store_dwordx2 v[106:107], v112, s[12:15], s29 offen offset:512 sc1
    v_mfma_f32_16x16x32_bf16 v[76:79], v[48:51], a[56:59], v[76:79]
    ds_read_b128 v[40:43], v17 offset:20480
    v_cvt_pk_bf16_f32 v108, v55, v59
    v_mfma_f32_16x16x32_bf16 v[80:83], v[48:51], a[60:63], v[80:83]
    s_waitcnt lgkmcnt(4)
    v_cvt_pk_bf16_f32 v109, v63, v67
    v_mfma_f32_16x16x32_bf16 v[68:71], v[20:23], a[64:67], v[68:71]
    ds_read_b128 v[44:47], v16 offset:22528
    s_add_u32 m0, s21, 1024
    v_mfma_f32_16x16x32_bf16 v[72:75], v[20:23], a[68:71], v[72:75]
    buffer_load_dwordx4 v9, s[8:11], s20 offen lds
    v_mfma_f32_16x16x32_bf16 v[76:79], v[24:27], a[64:67], v[76:79]
    ds_read_b128 v[48:51], v17 offset:22528
    v_and_or_b32 v108, v108, -2, s38
    v_mfma_f32_16x16x32_bf16 v[80:83], v[24:27], a[68:71], v[80:83]
    s_waitcnt lgkmcnt(4)
    v_and_or_b32 v109, v109, -2, s38
    v_mfma_f32_16x16x32_bf16 v[68:71], v[28:31], a[72:75], v[68:71]
    ds_read_b128 v[20:23], v16 offset:24576
    s_add_u32 s29, s47, s31
    v_mfma_f32_16x16x32_bf16 v[72:75], v[28:31], a[76:79], v[72:75]
    buffer_store_dwordx2 v[108:109], v112, s[12:15], s29 offen offset:1024 sc1
    v_mfma_f32_16x16x32_bf16 v[76:79], v[32:35], a[72:75], v[76:79]
    ds_read_b128 v[24:27], v17 offset:24576
    v_mfma_f32_16x16x32_bf16 v[80:83], v[32:35], a[76:79], v[80:83]
    s_waitcnt lgkmcnt(4)
    v_mfma_f32_16x16x32_bf16 v[68:71], v[36:39], a[80:83], v[68:71]
    ds_read_b128 v[28:31], v16 offset:26624
    s_add_u32 m0, s21, 2048
    v_mfma_f32_16x16x32_bf16 v[72:75], v[36:39], a[84:87], v[72:75]
    buffer_load_dwordx4 v10, s[8:11], s20 offen lds
    v_mfma_f32_16x16x32_bf16 v[76:79], v[40:43], a[80:83], v[76:79]
    ds_read_b128 v[32:35], v17 offset:26624
    v_mfma_f32_16x16x32_bf16 v[80:83], v[40:43], a[84:87], v[80:83]
    s_waitcnt lgkmcnt(4)
    v_mfma_f32_16x16x32_bf16 v[68:71], v[44:47], a[88:91], v[68:71]
    ds_read_b128 v[36:39], v16 offset:28672
    v_mfma_f32_16x16x32_bf16 v[72:75], v[44:47], a[92:95], v[72:75]
    v_mfma_f32_16x16x32_bf16 v[76:79], v[48:51], a[88:91], v[76:79]
    ds_read_b128 v[40:43], v17 offset:28672
    v_mfma_f32_16x16x32_bf16 v[80:83], v[48:51], a[92:95], v[80:83]
    s_waitcnt lgkmcnt(4)
    v_mfma_f32_16x16x32_bf16 v[68:71], v[20:23], a[96:99], v[68:71]
    ds_read_b128 v[44:47], v16 offset:30720
    s_add_u32 m0, s21, 3072
    v_mfma_f32_16x16x32_bf16 v[72:75], v[20:23], a[100:103], v[72:75]
    buffer_load_dwordx4 v11, s[8:11], s20 offen lds
    v_mfma_f32_16x16x32_bf16 v[76:79], v[24:27], a[96:99], v[76:79]
    ds_read_b128 v[48:51], v17 offset:30720
    v_mfma_f32_16x16x32_bf16 v[80:83], v[24:27], a[100:103], v[80:83]
    s_waitcnt lgkmcnt(4)
    v_mfma_f32_16x16x32_bf16 v[68:71], v[28:31], a[104:107], v[68:71]
    s_waitcnt vmcnt(13)
    s_barrier
    ds_read_b128 v[20:23], v16 offset:32768
    v_mfma_f32_16x16x32_bf16 v[72:75], v[28:31], a[108:111], v[72:75]
    s_add_u32 s20, s20, 65536
    v_mfma_f32_16x16x32_bf16 v[76:79], v[32:35], a[104:107], v[76:79]
    ds_read_b128 v[24:27], v17 offset:32768
    v_mfma_f32_16x16x32_bf16 v[80:83], v[32:35], a[108:111], v[80:83]
    s_waitcnt lgkmcnt(4)
    v_mfma_f32_16x16x32_bf16 v[68:71], v[36:39], a[112:115], v[68:71]
    ds_read_b128 v[28:31], v16 offset:34816
    s_add_u32 m0, s21, 16384
    s_waitcnt vmcnt(10)
    v_mfma_f32_16x16x32_bf16 v[72:75], v[36:39], a[116:119], v[72:75]
    buffer_load_dwordx4 v8, s[8:11], s20 offen lds
    v_xor_b32 v124, s7, v88
    v_mfma_f32_16x16x32_bf16 v[76:79], v[40:43], a[112:115], v[76:79]
    ds_read_b128 v[32:35], v17 offset:34816
    v_bitop3_b32 v124, v124, v89, s7 bitop3:0xf6
    v_bitop3_b32 v124, v124, v90, s7 bitop3:0xf6
    v_mfma_f32_16x16x32_bf16 v[80:83], v[40:43], a[116:119], v[80:83]
    s_waitcnt lgkmcnt(4)
    v_bitop3_b32 v124, v124, v91, s7 bitop3:0xf6
    v_mfma_f32_16x16x32_bf16 v[68:71], v[44:47], a[120:123], v[68:71]
    ds_read_b128 v[36:39], v16 offset:36864
    v_bitop3_b32 v124, v124, v92, s7 bitop3:0xf6
    v_bitop3_b32 v124, v124, v93, s7 bitop3:0xf6
    v_mfma_f32_16x16x32_bf16 v[72:75], v[44:47], a[124:127], v[72:75]
    v_and_b32 v124, 1, v124
    v_cmp_ne_u32 vcc, 0, v124
    v_mfma_f32_16x16x32_bf16 v[76:79], v[48:51], a[120:123], v[76:79]
    ds_read_b128 v[40:43], v17 offset:36864
    s_nop 0
    s_nop 0
    v_mfma_f32_16x16x32_bf16 v[80:83], v[48:51], a[124:127], v[80:83]
    s_waitcnt lgkmcnt(4)
    s_nop 0
    s_cbranch_vccnz L_rbad_299
L_rok_300:
    v_mfma_f32_16x16x32_bf16 v[68:71], v[20:23], a[128:131], v[68:71]
    ds_read_b128 v[44:47], v16 offset:38912
    s_add_u32 m0, s21, 17408
    v_mfma_f32_16x16x32_bf16 v[72:75], v[20:23], a[132:135], v[72:75]
    buffer_load_dwordx4 v9, s[8:11], s20 offen lds
    v_mfma_f32_16x16x32_bf16 v[76:79], v[24:27], a[128:131], v[76:79]
    ds_read_b128 v[48:51], v17 offset:38912
    v_lshlrev_b32 v124, 16, v88
    v_and_b32 v125, 0xffff0000, v88
    v_mfma_f32_16x16x32_bf16 v[80:83], v[24:27], a[132:135], v[80:83]
    s_waitcnt lgkmcnt(4)
    v_add_f32 v96, v116, v124
    v_mfma_f32_16x16x32_bf16 v[68:71], v[28:31], a[136:139], v[68:71]
    ds_read_b128 v[20:23], v16 offset:40960
    v_add_f32 v97, v117, v125
    v_lshlrev_b32 v124, 16, v89
    v_mfma_f32_16x16x32_bf16 v[72:75], v[28:31], a[140:143], v[72:75]
    v_and_b32 v125, 0xffff0000, v89
    v_add_f32 v98, v118, v124
    v_mfma_f32_16x16x32_bf16 v[76:79], v[32:35], a[136:139], v[76:79]
    ds_read_b128 v[24:27], v17 offset:40960
    s_add_u32 s51, s24, 1
    v_add_f32 v99, v119, v125
    v_mfma_f32_16x16x32_bf16 v[80:83], v[32:35], a[140:143], v[80:83]
    s_waitcnt lgkmcnt(4)
    s_min_u32 s51, s51, s61
    v_lshlrev_b32 v124, 16, v90
    v_mfma_f32_16x16x32_bf16 v[68:71], v[36:39], a[144:147], v[68:71]
    ds_read_b128 v[28:31], v16 offset:43008
    s_add_u32 m0, s21, 18432
    v_and_b32 v125, 0xffff0000, v90
    v_mfma_f32_16x16x32_bf16 v[72:75], v[36:39], a[148:151], v[72:75]
    buffer_load_dwordx4 v10, s[8:11], s20 offen lds
    v_add_f32 v96, v96, v124
    v_mfma_f32_16x16x32_bf16 v[76:79], v[40:43], a[144:147], v[76:79]
    ds_read_b128 v[32:35], v17 offset:43008
    s_mul_i32 s3, s51, 3
    v_mfma_f32_16x16x32_bf16 v[80:83], v[40:43], a[148:151], v[80:83]
    s_waitcnt lgkmcnt(4)
    v_add_f32 v97, v97, v125
    v_lshlrev_b32 v124, 16, v91
    v_mfma_f32_16x16x32_bf16 v[68:71], v[44:47], a[152:155], v[68:71]
    ds_read_b128 v[36:39], v16 offset:45056
    s_add_u32 s3, s3, s95
    v_and_b32 v125, 0xffff0000, v91
    v_mfma_f32_16x16x32_bf16 v[72:75], v[44:47], a[156:159], v[72:75]
    s_lshl1_add_u32 s51, s51, s94
    s_max_i32 s51, s51, s3
    v_add_f32 v98, v98, v124
    v_mfma_f32_16x16x32_bf16 v[76:79], v[48:51], a[152:155], v[76:79]
    ds_read_b128 v[40:43], v17 offset:45056
    v_add_f32 v99, v99, v125
    v_mfma_f32_16x16x32_bf16 v[80:83], v[48:51], a[156:159], v[80:83]
    s_waitcnt lgkmcnt(4)
    s_lshl_b32 s51, s51, 9
    v_lshlrev_b32 v124, 16, v92
    v_mfma_f32_16x16x32_bf16 v[68:71], v[20:23], a[160:163], v[68:71]
    ds_read_b128 v[44:47], v16 offset:47104
    s_add_u32 m0, s21, 19456
    v_and_b32 v125, 0xffff0000, v92
    v_mfma_f32_16x16x32_bf16 v[72:75], v[20:23], a[164:167], v[72:75]
    buffer_load_dwordx4 v11, s[8:11], s20 offen lds
    v_add_f32 v96, v96, v124
    v_mfma_f32_16x16x32_bf16 v[76:79], v[24:27], a[160:163], v[76:79]
    ds_read_b128 v[48:51], v17 offset:47104
    s_add_u32 s51, s51, s48
    v_mfma_f32_16x16x32_bf16 v[80:83], v[24:27], a[164:167], v[80:83]
    s_waitcnt lgkmcnt(4)
    v_add_f32 v97, v97, v125
    v_lshlrev_b32 v124, 16, v93
    v_mfma_f32_16x16x32_bf16 v[68:71], v[28:31], a[168:171], v[68:71]
    s_waitcnt vmcnt(11)
    s_barrier
    ds_read_b128 v[20:23], v16 offset:49152
    v_mfma_f32_16x16x32_bf16 v[72:75], v[28:31], a[172:175], v[72:75]
    s_add_u32 s20, s20, 65536
    buffer_load_dword v87, v4, s[12:15], s51 offen sc1
    v_mfma_f32_16x16x32_bf16 v[76:79], v[32:35], a[168:171], v[76:79]
    ds_read_b128 v[24:27], v17 offset:49152
    v_and_b32 v125, 0xffff0000, v93
    v_add_f32 v98, v98, v124
    v_mfma_f32_16x16x32_bf16 v[80:83], v[32:35], a[172:175], v[80:83]
    s_waitcnt lgkmcnt(4)
    v_add_f32 v99, v99, v125
    v_mfma_f32_16x16x32_bf16 v[68:71], v[36:39], a[176:179], v[68:71]
    ds_read_b128 v[28:31], v16 offset:51200
    s_add_u32 m0, s21, 32768
    ds_write2_b32 v114, v96, v97 offset0:0 offset1:16
    v_mfma_f32_16x16x32_bf16 v[72:75], v[36:39], a[180:183], v[72:75]
    buffer_load_dwordx4 v8, s[8:11], s20 offen lds
    ds_write2_b32 v114, v98, v99 offset0:128 offset1:144
    v_mfma_f32_16x16x32_bf16 v[76:79], v[40:43], a[176:179], v[76:79]
    ds_read_b128 v[32:35], v17 offset:51200
    ds_read_b128 v[88:91], v113 offset:0
    v_mfma_f32_16x16x32_bf16 v[80:83], v[40:43], a[180:183], v[80:83]
    s_waitcnt lgkmcnt(4)
    v_mfma_f32_16x16x32_bf16 v[68:71], v[44:47], a[184:187], v[68:71]
    ds_read_b128 v[36:39], v16 offset:53248
    v_mfma_f32_16x16x32_bf16 v[72:75], v[44:47], a[188:191], v[72:75]
    v_mfma_f32_16x16x32_bf16 v[76:79], v[48:51], a[184:187], v[76:79]
    ds_read_b128 v[40:43], v17 offset:53248
    s_waitcnt lgkmcnt(2)
    v_mfma_f32_16x16x32_bf16 v[80:83], v[48:51], a[188:191], v[80:83]
    s_waitcnt lgkmcnt(4)
    v_cvt_pk_bf16_f32 v96, 0, v88
    v_mfma_f32_16x16x32_bf16 v[68:71], v[20:23], a[192:195], v[68:71]
    ds_read_b128 v[44:47], v16 offset:55296
    s_add_u32 m0, s21, 33792
    v_mfma_f32_16x16x32_bf16 v[72:75], v[20:23], a[196:199], v[72:75]
    buffer_load_dwordx4 v9, s[8:11], s20 offen lds
    v_mfma_f32_16x16x32_bf16 v[76:79], v[24:27], a[192:195], v[76:79]
    ds_read_b128 v[48:51], v17 offset:55296
    v_cvt_pk_bf16_f32 v97, 0, v89
    v_mfma_f32_16x16x32_bf16 v[80:83], v[24:27], a[196:199], v[80:83]
    s_waitcnt lgkmcnt(4)
    v_cvt_pk_bf16_f32 v98, 0, v90
    v_mfma_f32_16x16x32_bf16 v[68:71], v[28:31], a[200:203], v[68:71]
    ds_read_b128 v[20:23], v16 offset:57344
    v_cvt_pk_bf16_f32 v99, 0, v91
    v_mfma_f32_16x16x32_bf16 v[72:75], v[28:31], a[204:207], v[72:75]
    buffer_store_dwordx4 v[96:99], v128, s[16:19], s43 offen
    v_mfma_f32_16x16x32_bf16 v[76:79], v[32:35], a[200:203], v[76:79]
    ds_read_b128 v[24:27], v17 offset:57344
    v_mfma_f32_16x16x32_bf16 v[80:83], v[32:35], a[204:207], v[80:83]
    s_waitcnt lgkmcnt(4)
    v_mfma_f32_16x16x32_bf16 v[68:71], v[36:39], a[208:211], v[68:71]
    ds_read_b128 v[28:31], v16 offset:59392
    s_add_u32 m0, s21, 34816
    v_mov_b32 v116, v52
    v_mov_b32 v117, v56
    v_mfma_f32_16x16x32_bf16 v[72:75], v[36:39], a[212:215], v[72:75]
    buffer_load_dwordx4 v10, s[8:11], s20 offen lds
    v_mov_b32 v118, v60
    v_mov_b32 v119, v64
    v_mfma_f32_16x16x32_bf16 v[76:79], v[40:43], a[208:211], v[76:79]
    ds_read_b128 v[32:35], v17 offset:59392
    s_mov_b32 s7, s38
    s_add_u32 s39, s44, s31
    s_sub_u32 s43, s22, 1
    v_mfma_f32_16x16x32_bf16 v[80:83], v[40:43], a[212:215], v[80:83]
    s_waitcnt lgkmcnt(4)
    s_mul_i32 s3, s43, 3
    s_add_u32 s3, s3, s95
    s_lshl1_add_u32 s43, s43, s94
    v_mfma_f32_16x16x32_bf16 v[68:71], v[44:47], a[216:219], v[68:71]
    ds_read_b128 v[36:39], v16 offset:61440
    s_max_i32 s43, s43, s3
    s_lshl_b32 s43, s43, 18
    s_cmp_eq_u32 s37, 0
    s_cselect_b32 s43, 0x7ff00000, s43
    v_mfma_f32_16x16x32_bf16 v[72:75], v[44:47], a[220:223], v[72:75]
    buffer_load_dwordx2 v[88:89], v112, s[12:15], s39 offen offset:0 sc1
    v_mfma_f32_16x16x32_bf16 v[76:79], v[48:51], a[216:219], v[76:79]
    ds_read_b128 v[40:43], v17 offset:61440
    v_mfma_f32_16x16x32_bf16 v[80:83], v[48:51], a[220:223], v[80:83]
    s_waitcnt lgkmcnt(4)
    v_mfma_f32_16x16x32_bf16 v[68:71], v[20:23], a[224:227], v[68:71]
    ds_read_b128 v[44:47], v16 offset:63488
    s_add_u32 m0, s21, 35840
    v_mfma_f32_16x16x32_bf16 v[72:75], v[20:23], a[228:231], v[72:75]
    buffer_load_dwordx4 v11, s[8:11], s20 offen lds
    v_mfma_f32_16x16x32_bf16 v[76:79], v[24:27], a[224:227], v[76:79]
    ds_read_b128 v[48:51], v17 offset:63488
    v_mfma_f32_16x16x32_bf16 v[80:83], v[24:27], a[228:231], v[80:83]
    s_waitcnt lgkmcnt(4)
    v_mfma_f32_16x16x32_bf16 v[68:71], v[28:31], a[232:235], v[68:71]
    s_waitcnt vmcnt(11)
    s_barrier
    ds_read_b128 v[20:23], v12 offset:0
    v_mfma_f32_16x16x32_bf16 v[72:75], v[28:31], a[236:239], v[72:75]
    s_add_u32 s20, s20, 65536
    buffer_load_dwordx2 v[90:91], v112, s[12:15], s39 offen offset:512 sc1
    v_mfma_f32_16x16x32_bf16 v[76:79], v[32:35], a[232:235], v[76:79]
    ds_read_b128 v[24:27], v13 offset:0
    v_mfma_f32_16x16x32_bf16 v[80:83], v[32:35], a[236:239], v[80:83]
    s_waitcnt lgkmcnt(4)
    v_mfma_f32_16x16x32_bf16 v[68:71], v[36:39], a[240:243], v[68:71]
    ds_read_b128 v[28:31], v12 offset:2048
    s_add_u32 m0, s21, 49152
    v_mfma_f32_16x16x32_bf16 v[72:75], v[36:39], a[244:247], v[72:75]
    buffer_load_dwordx4 v8, s[8:11], s20 offen lds
    v_mfma_f32_16x16x32_bf16 v[76:79], v[40:43], a[240:243], v[76:79]
    ds_read_b128 v[32:35], v13 offset:2048
    v_mfma_f32_16x16x32_bf16 v[80:83], v[40:43], a[244:247], v[80:83]
    s_waitcnt lgkmcnt(4)
    v_mfma_f32_16x16x32_bf16 v[68:71], v[44:47], a[248:251], v[68:71]
    ds_read_b128 v[36:39], v12 offset:4096
    v_mfma_f32_16x16x32_bf16 v[72:75], v[44:47], a[252:255], v[72:75]
    buffer_load_dwordx2 v[92:93], v112, s[12:15], s39 offen offset:1024 sc1
    v_mfma_f32_16x16x32_bf16 v[76:79], v[48:51], a[248:251], v[76:79]
    ds_read_b128 v[40:43], v13 offset:4096
    s_mov_b32 s37, 1
    v_mfma_f32_16x16x32_bf16 v[80:83], v[48:51], a[252:255], v[80:83]
    s_waitcnt lgkmcnt(4)
    s_add_u32 s22, s22, 1
    s_cmp_ge_u32 s22, s23
    s_cbranch_scc0 L_st_294
L_fl1_292:
    s_waitcnt lgkmcnt(0)
    s_nop 7
    s_sub_u32 s38, s22, 1
    s_and_b32 s31, s38, 3
    s_lshl_b32 s31, s31, 11
    s_bfe_u32 s38, s38, 0x10002
    s_xor_b32 s38, s38, 1
    s_cmp_eq_u32 s37, 0
    s_cselect_b32 s31, 0x40000000, s31
    s_cselect_b32 s38, 0, s38
    v_cvt_pk_bf16_f32 v104, v69, v73
    v_cvt_pk_bf16_f32 v105, v77, v81
    v_and_or_b32 v104, v104, -2, s38
    v_and_or_b32 v105, v105, -2, s38
    s_add_u32 s29, s45, s31
    buffer_store_dwordx2 v[104:105], v112, s[12:15], s29 offen offset:0 sc1
    v_cvt_pk_bf16_f32 v106, v70, v74
    v_cvt_pk_bf16_f32 v107, v78, v82
    v_and_or_b32 v106, v106, -2, s38
    v_and_or_b32 v107, v107, -2, s38
    s_add_u32 s29, s46, s31
    buffer_store_dwordx2 v[106:107], v112, s[12:15], s29 offen offset:512 sc1
    v_cvt_pk_bf16_f32 v108, v71, v75
    v_cvt_pk_bf16_f32 v109, v79, v83
    v_and_or_b32 v108, v108, -2, s38
    v_and_or_b32 v109, v109, -2, s38
    s_add_u32 s29, s47, s31
    buffer_store_dwordx2 v[108:109], v112, s[12:15], s29 offen offset:1024 sc1
    s_waitcnt vmcnt(0)
    v_xor_b32 v124, s7, v88
    v_bitop3_b32 v124, v124, v89, s7 bitop3:0xf6
    v_bitop3_b32 v124, v124, v90, s7 bitop3:0xf6
    v_bitop3_b32 v124, v124, v91, s7 bitop3:0xf6
    v_bitop3_b32 v124, v124, v92, s7 bitop3:0xf6
    v_bitop3_b32 v124, v124, v93, s7 bitop3:0xf6
    v_and_b32 v124, 1, v124
    v_cmp_ne_u32 vcc, 0, v124
    s_nop 0
    s_nop 0
    s_nop 0
    s_cbranch_vccnz L_rbad_303
L_rok_304:
    v_lshlrev_b32 v124, 16, v88
    v_and_b32 v125, 0xffff0000, v88
    v_add_f32 v96, v116, v124
    v_add_f32 v97, v117, v125
    v_lshlrev_b32 v124, 16, v89
    v_and_b32 v125, 0xffff0000, v89
    v_add_f32 v98, v118, v124
    v_add_f32 v99, v119, v125
    v_lshlrev_b32 v124, 16, v90
    v_and_b32 v125, 0xffff0000, v90
    v_add_f32 v96, v96, v124
    v_add_f32 v97, v97, v125
    v_lshlrev_b32 v124, 16, v91
    v_and_b32 v125, 0xffff0000, v91
    v_add_f32 v98, v98, v124
    v_add_f32 v99, v99, v125
    v_lshlrev_b32 v124, 16, v92
    v_and_b32 v125, 0xffff0000, v92
    v_add_f32 v96, v96, v124
    v_add_f32 v97, v97, v125
    v_lshlrev_b32 v124, 16, v93
    v_and_b32 v125, 0xffff0000, v93
    v_add_f32 v98, v98, v124
    v_add_f32 v99, v99, v125
    ds_write2_b32 v114, v96, v97 offset0:0 offset1:16
    ds_write2_b32 v114, v98, v99 offset0:128 offset1:144
    ds_read_b128 v[88:91], v113 offset:0
    s_waitcnt lgkmcnt(0)
    v_cvt_pk_bf16_f32 v96, 0, v88
    v_cvt_pk_bf16_f32 v97, 0, v89
    v_cvt_pk_bf16_f32 v98, 0, v90
    v_cvt_pk_bf16_f32 v99, 0, v91
    buffer_store_dwordx4 v[96:99], v128, s[16:19], s43 offen
    v_mov_b32 v116, v68
    v_mov_b32 v117, v72
    v_mov_b32 v118, v76
    v_mov_b32 v119, v80
    s_mov_b32 s7, s38
    s_add_u32 s39, s44, s31
    s_sub_u32 s43, s22, 1
    s_mul_i32 s3, s43, 3
    s_add_u32 s3, s3, s95
    s_lshl1_add_u32 s43, s43, s94
    s_max_i32 s43, s43, s3
    s_lshl_b32 s43, s43, 18
    s_cmp_eq_u32 s37, 0
    s_cselect_b32 s43, 0x7ff00000, s43
    buffer_load_dwordx2 v[88:89], v112, s[12:15], s39 offen offset:0 sc1
    buffer_load_dwordx2 v[90:91], v112, s[12:15], s39 offen offset:512 sc1
    buffer_load_dwordx2 v[92:93], v112, s[12:15], s39 offen offset:1024 sc1
    s_mov_b32 s37, 1
    s_waitcnt vmcnt(0)
    v_xor_b32 v124, s7, v88
    v_bitop3_b32 v124, v124, v89, s7 bitop3:0xf6
    v_bitop3_b32 v124, v124, v90, s7 bitop3:0xf6
    v_bitop3_b32 v124, v124, v91, s7 bitop3:0xf6
    v_bitop3_b32 v124, v124, v92, s7 bitop3:0xf6
    v_bitop3_b32 v124, v124, v93, s7 bitop3:0xf6
    v_and_b32 v124, 1, v124
    v_cmp_ne_u32 vcc, 0, v124
    s_nop 0
    s_nop 0
    s_nop 0
    s_cbranch_vccnz L_rbad_305
L_rok_306:
    v_lshlrev_b32 v124, 16, v88
    v_and_b32 v125, 0xffff0000, v88
    v_add_f32 v96, v116, v124
    v_add_f32 v97, v117, v125
    v_lshlrev_b32 v124, 16, v89
    v_and_b32 v125, 0xffff0000, v89
    v_add_f32 v98, v118, v124
    v_add_f32 v99, v119, v125
    v_lshlrev_b32 v124, 16, v90
    v_and_b32 v125, 0xffff0000, v90
    v_add_f32 v96, v96, v124
    v_add_f32 v97, v97, v125
    v_lshlrev_b32 v124, 16, v91
    v_and_b32 v125, 0xffff0000, v91
    v_add_f32 v98, v98, v124
    v_add_f32 v99, v99, v125
    v_lshlrev_b32 v124, 16, v92
    v_and_b32 v125, 0xffff0000, v92
    v_add_f32 v96, v96, v124
    v_add_f32 v97, v97, v125
    v_lshlrev_b32 v124, 16, v93
    v_and_b32 v125, 0xffff0000, v93
    v_add_f32 v98, v98, v124
    v_add_f32 v99, v99, v125
    ds_write2_b32 v114, v96, v97 offset0:0 offset1:16
    ds_write2_b32 v114, v98, v99 offset0:128 offset1:144
    ds_read_b128 v[88:91], v113 offset:0
    s_waitcnt lgkmcnt(0)
    v_cvt_pk_bf16_f32 v96, 0, v88
    v_cvt_pk_bf16_f32 v97, 0, v89
    v_cvt_pk_bf16_f32 v98, 0, v90
    v_cvt_pk_bf16_f32 v99, 0, v91
    buffer_store_dwordx4 v[96:99], v128, s[16:19], s43 offen
    s_branch L_ste_293
L_rbad_295:
    buffer_load_dwordx2 v[88:89], v112, s[12:15], s39 offen offset:0 sc1
    buffer_load_dwordx2 v[90:91], v112, s[12:15], s39 offen offset:512 sc1
    buffer_load_dwordx2 v[92:93], v112, s[12:15], s39 offen offset:1024 sc1
    s_add_u32 s36, s36, 1
    s_cmp_gt_u32 s36, 0x100000
    s_cbranch_scc1 chain_kernel_wend
    s_waitcnt vmcnt(0)
    v_xor_b32 v124, s7, v88
    v_bitop3_b32 v124, v124, v89, s7 bitop3:0xf6
    v_bitop3_b32 v124, v124, v90, s7 bitop3:0xf6
    v_bitop3_b32 v124, v124, v91, s7 bitop3:0xf6
    v_bitop3_b32 v124, v124, v92, s7 bitop3:0xf6
    v_bitop3_b32 v124, v124, v93, s7 bitop3:0xf6
    v_and_b32 v124, 1, v124
    v_cmp_ne_u32 vcc, 0, v124
    s_cbranch_vccnz L_rbad_295
    s_branch L_rok_296
L_gw_298:
    buffer_load_dword v87, v4, s[12:15], s51 offen sc1
    s_add_u32 s36, s36, 1
    s_cmp_gt_u32 s36, 0x100000
    s_cbranch_scc1 chain_kernel_wend
    s_waitcnt vmcnt(0)
    v_readfirstlane_b32 s30, v87
    s_cmp_lt_u32 s30, 8
    s_cbranch_scc0 L_gok_297
    s_sleep 1
    s_branch L_gw_298
L_rbad_299:
    buffer_load_dwordx2 v[88:89], v112, s[12:15], s39 offen offset:0 sc1
    buffer_load_dwordx2 v[90:91], v112, s[12:15], s39 offen offset:512 sc1
    buffer_load_dwordx2 v[92:93], v112, s[12:15], s39 offen offset:1024 sc1
    s_add_u32 s36, s36, 1
    s_cmp_gt_u32 s36, 0x100000
    s_cbranch_scc1 chain_kernel_wend
    s_waitcnt vmcnt(0)
    v_xor_b32 v124, s7, v88
    v_bitop3_b32 v124, v124, v89, s7 bitop3:0xf6
    v_bitop3_b32 v124, v124, v90, s7 bitop3:0xf6
    v_bitop3_b32 v124, v124, v91, s7 bitop3:0xf6
    v_bitop3_b32 v124, v124, v92, s7 bitop3:0xf6
    v_bitop3_b32 v124, v124, v93, s7 bitop3:0xf6
    v_and_b32 v124, 1, v124
    v_cmp_ne_u32 vcc, 0, v124
    s_cbranch_vccnz L_rbad_299
    s_branch L_rok_300
L_gw_302:
    buffer_load_dword v87, v4, s[12:15], s51 offen sc1
    s_add_u32 s36, s36, 1
    s_cmp_gt_u32 s36, 0x100000
    s_cbranch_scc1 chain_kernel_wend
    s_waitcnt vmcnt(0)
    v_readfirstlane_b32 s30, v87
    s_cmp_lt_u32 s30, 8
    s_cbranch_scc0 L_gok_301
    s_sleep 1
    s_branch L_gw_302
L_rbad_303:
    buffer_load_dwordx2 v[88:89], v112, s[12:15], s39 offen offset:0 sc1
    buffer_load_dwordx2 v[90:91], v112, s[12:15], s39 offen offset:512 sc1
    buffer_load_dwordx2 v[92:93], v112, s[12:15], s39 offen offset:1024 sc1
    s_add_u32 s36, s36, 1
    s_cmp_gt_u32 s36, 0x100000
    s_cbranch_scc1 chain_kernel_wend
    s_waitcnt vmcnt(0)
    v_xor_b32 v124, s7, v88
    v_bitop3_b32 v124, v124, v89, s7 bitop3:0xf6
    v_bitop3_b32 v124, v124, v90, s7 bitop3:0xf6
    v_bitop3_b32 v124, v124, v91, s7 bitop3:0xf6
    v_bitop3_b32 v124, v124, v92, s7 bitop3:0xf6
    v_bitop3_b32 v124, v124, v93, s7 bitop3:0xf6
    v_and_b32 v124, 1, v124
    v_cmp_ne_u32 vcc, 0, v124
    s_cbranch_vccnz L_rbad_303
    s_branch L_rok_304
L_rbad_305:
    buffer_load_dwordx2 v[88:89], v112, s[12:15], s39 offen offset:0 sc1
    buffer_load_dwordx2 v[90:91], v112, s[12:15], s39 offen offset:512 sc1
    buffer_load_dwordx2 v[92:93], v112, s[12:15], s39 offen offset:1024 sc1
    s_add_u32 s36, s36, 1
    s_cmp_gt_u32 s36, 0x100000
    s_cbranch_scc1 chain_kernel_wend
    s_waitcnt vmcnt(0)
    v_xor_b32 v124, s7, v88
    v_bitop3_b32 v124, v124, v89, s7 bitop3:0xf6
    v_bitop3_b32 v124, v124, v90, s7 bitop3:0xf6
    v_bitop3_b32 v124, v124, v91, s7 bitop3:0xf6
    v_bitop3_b32 v124, v124, v92, s7 bitop3:0xf6
    v_bitop3_b32 v124, v124, v93, s7 bitop3:0xf6
    v_and_b32 v124, 1, v124
    v_cmp_ne_u32 vcc, 0, v124
    s_cbranch_vccnz L_rbad_305
    s_branch L_rok_306
L_fl0_291:
    s_waitcnt lgkmcnt(0)
    s_nop 7
    s_sub_u32 s38, s22, 1
    s_and_b32 s31, s38, 3
    s_lshl_b32 s31, s31, 11
    s_bfe_u32 s38, s38, 0x10002
    s_xor_b32 s38, s38, 1
    s_cmp_eq_u32 s37, 0
    s_cselect_b32 s31, 0x40000000, s31
    s_cselect_b32 s38, 0, s38
    v_cvt_pk_bf16_f32 v104, v53, v57
    v_cvt_pk_bf16_f32 v105, v61, v65
    v_and_or_b32 v104, v104, -2, s38
    v_and_or_b32 v105, v105, -2, s38
    s_add_u32 s29, s45, s31
    buffer_store_dwordx2 v[104:105], v112, s[12:15], s29 offen offset:0 sc1
    v_cvt_pk_bf16_f32 v106, v54, v58
    v_cvt_pk_bf16_f32 v107, v62, v66
    v_and_or_b32 v106, v106, -2, s38
    v_and_or_b32 v107, v107, -2, s38
    s_add_u32 s29, s46, s31
    buffer_store_dwordx2 v[106:107], v112, s[12:15], s29 offen offset:512 sc1
    v_cvt_pk_bf16_f32 v108, v55, v59
    v_cvt_pk_bf16_f32 v109, v63, v67
    v_and_or_b32 v108, v108, -2, s38
    v_and_or_b32 v109, v109, -2, s38
    s_add_u32 s29, s47, s31
    buffer_store_dwordx2 v[108:109], v112, s[12:15], s29 offen offset:1024 sc1
    s_waitcnt vmcnt(0)
    v_xor_b32 v124, s7, v88
    v_bitop3_b32 v124, v124, v89, s7 bitop3:0xf6
    v_bitop3_b32 v124, v124, v90, s7 bitop3:0xf6
    v_bitop3_b32 v124, v124, v91, s7 bitop3:0xf6
    v_bitop3_b32 v124, v124, v92, s7 bitop3:0xf6
    v_bitop3_b32 v124, v124, v93, s7 bitop3:0xf6
    v_and_b32 v124, 1, v124
    v_cmp_ne_u32 vcc, 0, v124
    s_nop 0
    s_nop 0
    s_nop 0
    s_cbranch_vccnz L_rbad_307
L_rok_308:
    v_lshlrev_b32 v124, 16, v88
    v_and_b32 v125, 0xffff0000, v88
    v_add_f32 v96, v116, v124
    v_add_f32 v97, v117, v125
    v_lshlrev_b32 v124, 16, v89
    v_and_b32 v125, 0xffff0000, v89
    v_add_f32 v98, v118, v124
    v_add_f32 v99, v119, v125
    v_lshlrev_b32 v124, 16, v90
    v_and_b32 v125, 0xffff0000, v90
    v_add_f32 v96, v96, v124
    v_add_f32 v97, v97, v125
    v_lshlrev_b32 v124, 16, v91
    v_and_b32 v125, 0xffff0000, v91
    v_add_f32 v98, v98, v124
    v_add_f32 v99, v99, v125
    v_lshlrev_b32 v124, 16, v92
    v_and_b32 v125, 0xffff0000, v92
    v_add_f32 v96, v96, v124
    v_add_f32 v97, v97, v125
    v_lshlrev_b32 v124, 16, v93
    v_and_b32 v125, 0xffff0000, v93
    v_add_f32 v98, v98, v124
    v_add_f32 v99, v99, v125
    ds_write2_b32 v114, v96, v97 offset0:0 offset1:16
    ds_write2_b32 v114, v98, v99 offset0:128 offset1:144
    ds_read_b128 v[88:91], v113 offset:0
    s_waitcnt lgkmcnt(0)
    v_cvt_pk_bf16_f32 v96, 0, v88
    v_cvt_pk_bf16_f32 v97, 0, v89
    v_cvt_pk_bf16_f32 v98, 0, v90
    v_cvt_pk_bf16_f32 v99, 0, v91
    buffer_store_dwordx4 v[96:99], v128, s[16:19], s43 offen
    v_mov_b32 v116, v52
    v_mov_b32 v117, v56
    v_mov_b32 v118, v60
    v_mov_b32 v119, v64
    s_mov_b32 s7, s38
    s_add_u32 s39, s44, s31
    s_sub_u32 s43, s22, 1
    s_mul_i32 s3, s43, 3
    s_add_u32 s3, s3, s95
    s_lshl1_add_u32 s43, s43, s94
    s_max_i32 s43, s43, s3
    s_lshl_b32 s43, s43, 18
    s_cmp_eq_u32 s37, 0
    s_cselect_b32 s43, 0x7ff00000, s43
    buffer_load_dwordx2 v[88:89], v112, s[12:15], s39 offen offset:0 sc1
    buffer_load_dwordx2 v[90:91], v112, s[12:15], s39 offen offset:512 sc1
    buffer_load_dwordx2 v[92:93], v112, s[12:15], s39 offen offset:1024 sc1
    s_mov_b32 s37, 1
    s_waitcnt vmcnt(0)
    v_xor_b32 v124, s7, v88
    v_bitop3_b32 v124, v124, v89, s7 bitop3:0xf6
    v_bitop3_b32 v124, v124, v90, s7 bitop3:0xf6
    v_bitop3_b32 v124, v124, v91, s7 bitop3:0xf6
    v_bitop3_b32 v124, v124, v92, s7 bitop3:0xf6
    v_bitop3_b32 v124, v124, v93, s7 bitop3:0xf6
    v_and_b32 v124, 1, v124
    v_cmp_ne_u32 vcc, 0, v124
    s_nop 0
    s_nop 0
    s_nop 0
    s_cbranch_vccnz L_rbad_309
L_rok_310:
    v_lshlrev_b32 v124, 16, v88
    v_and_b32 v125, 0xffff0000, v88
    v_add_f32 v96, v116, v124
    v_add_f32 v97, v117, v125
    v_lshlrev_b32 v124, 16, v89
    v_and_b32 v125, 0xffff0000, v89
    v_add_f32 v98, v118, v124
    v_add_f32 v99, v119, v125
    v_lshlrev_b32 v124, 16, v90
    v_and_b32 v125, 0xffff0000, v90
    v_add_f32 v96, v96, v124
    v_add_f32 v97, v97, v125
    v_lshlrev_b32 v124, 16, v91
    v_and_b32 v125, 0xffff0000, v91
    v_add_f32 v98, v98, v124
    v_add_f32 v99, v99, v125
    v_lshlrev_b32 v124, 16, v92
    v_and_b32 v125, 0xffff0000, v92
    v_add_f32 v96, v96, v124
    v_add_f32 v97, v97, v125
    v_lshlrev_b32 v124, 16, v93
    v_and_b32 v125, 0xffff0000, v93
    v_add_f32 v98, v98, v124
    v_add_f32 v99, v99, v125
    ds_write2_b32 v114, v96, v97 offset0:0 offset1:16
    ds_write2_b32 v114, v98, v99 offset0:128 offset1:144
    ds_read_b128 v[88:91], v113 offset:0
    s_waitcnt lgkmcnt(0)
    v_cvt_pk_bf16_f32 v96, 0, v88
    v_cvt_pk_bf16_f32 v97, 0, v89
    v_cvt_pk_bf16_f32 v98, 0, v90
    v_cvt_pk_bf16_f32 v99, 0, v91
    buffer_store_dwordx4 v[96:99], v128, s[16:19], s43 offen
    s_branch L_ste_293
L_rbad_307:
    buffer_load_dwordx2 v[88:89], v112, s[12:15], s39 offen offset:0 sc1
    buffer_load_dwordx2 v[90:91], v112, s[12:15], s39 offen offset:512 sc1
    buffer_load_dwordx2 v[92:93], v112, s[12:15], s39 offen offset:1024 sc1
    s_add_u32 s36, s36, 1
    s_cmp_gt_u32 s36, 0x100000
    s_cbranch_scc1 chain_kernel_wend
    s_waitcnt vmcnt(0)
    v_xor_b32 v124, s7, v88
    v_bitop3_b32 v124, v124, v89, s7 bitop3:0xf6
    v_bitop3_b32 v124, v124, v90, s7 bitop3:0xf6
    v_bitop3_b32 v124, v124, v91, s7 bitop3:0xf6
    v_bitop3_b32 v124, v124, v92, s7 bitop3:0xf6
    v_bitop3_b32 v124, v124, v93, s7 bitop3:0xf6
    v_and_b32 v124, 1, v124
    v_cmp_ne_u32 vcc, 0, v124
    s_cbranch_vccnz L_rbad_307
    s_branch L_rok_308
L_rbad_309:
    buffer_load_dwordx2 v[88:89], v112, s[12:15], s39 offen offset:0 sc1
    buffer_load_dwordx2 v[90:91], v112, s[12:15], s39 offen offset:512 sc1
    buffer_load_dwordx2 v[92:93], v112, s[12:15], s39 offen offset:1024 sc1
    s_add_u32 s36, s36, 1
    s_cmp_gt_u32 s36, 0x100000
    s_cbranch_scc1 chain_kernel_wend
    s_waitcnt vmcnt(0)
    v_xor_b32 v124, s7, v88
    v_bitop3_b32 v124, v124, v89, s7 bitop3:0xf6
    v_bitop3_b32 v124, v124, v90, s7 bitop3:0xf6
    v_bitop3_b32 v124, v124, v91, s7 bitop3:0xf6
    v_bitop3_b32 v124, v124, v92, s7 bitop3:0xf6
    v_bitop3_b32 v124, v124, v93, s7 bitop3:0xf6
    v_and_b32 v124, 1, v124
    v_cmp_ne_u32 vcc, 0, v124
    s_cbranch_vccnz L_rbad_309
    s_branch L_rok_310
L_ste_293:
chain_kernel_wend:
chain_kernel_end:
    s_endpgm
.section .rodata,"a"
.p2align 6
.amdhsa_kernel chain_kernel
  .amdhsa_next_free_vgpr 512
  .amdhsa_next_free_sgpr 102
  .amdhsa_accum_offset 256
  .amdhsa_group_segment_fixed_size 0
  .amdhsa_kernarg_size 152
  .amdhsa_user_sgpr_count 2
  .amdhsa_user_sgpr_kernarg_segment_ptr 1
  .amdhsa_system_sgpr_workgroup_id_x 1
  .amdhsa_float_denorm_mode_32 3
  .amdhsa_float_denorm_mode_16_64 3
.end_amdhsa_kernel
```

```asm
; @launch kernel=chain_kernel grid=(256,1,1) block=(256,1,1) lds=163840
.amdgcn_target "amdgcn-amd-amdhsa--gfx950"
.text
.globl chain_kernel
.p2align 8
.type chain_kernel,@function
chain_kernel:
    s_cmp_lt_u32 s2, 256
    s_cbranch_scc1 chain_kernel_go
chain_kernel_end0:
    s_endpgm
chain_kernel_go:
    s_load_dwordx16 s[64:79], s[0:1], 0
    s_load_dwordx16 s[80:95], s[0:1], 64
    s_load_dwordx4 s[96:99], s[0:1], 128
    s_load_dwordx2 s[100:101], s[0:1], 144
    s_waitcnt lgkmcnt(0)
    s_getpc_b64 s[4:5]
L_pc_1:
    s_lshr_b32 s3, s2, 3
    s_and_b32 s3, s3, 31
    s_lshl_b32 s3, s3, 6
    v_and_b32 v14, 63, v0
    v_add_u32 v14, s3, v14
    v_lshlrev_b32 v14, 6, v14
    v_min_u32 v14, chain_kernel_end - L_pc_1, v14
    global_load_dword v15, v14, s[4:5]
    s_getreg_b32 s16, hwreg(HW_REG_XCC_ID)
    s_and_b32 s16, s16, 7
    v_lshrrev_b32 v3, 6, v0
    s_mov_b32 s12, s98
    s_and_b32 s13, s99, 0xffff
    s_mov_b32 s14, 0x100
    s_mov_b32 s15, 0x00020000
    v_readfirstlane_b32 s18, v3
    s_lshl_b32 s3, s16, 5
    v_mov_b32 v12, 1
    v_lshlrev_b32 v13, 8, v0
    buffer_atomic_add v12, v13, s[12:15], s3 offen offset:24 sc0 sc1
    s_add_u32 s8, s100, 0x5000000
    s_addc_u32 s9, s101, 0
    s_and_b32 s9, s9, 0xffff
    s_mov_b32 s10, 0x180000
    s_mov_b32 s11, 0x00020000
    s_lshl_b32 s3, s2, 13
    v_lshlrev_b32 v1, 4, v0
    v_mov_b32 v4, 0xff81ff81
    v_mov_b32 v5, 0xff81ff81
    v_mov_b32 v6, 0xff81ff81
    v_mov_b32 v7, 0xff81ff81
    buffer_store_dwordx4 v[4:7], v1, s[8:11], s3 offen sc1
    s_add_u32 s3, s3, 4096
    buffer_store_dwordx4 v[4:7], v1, s[8:11], s3 offen sc1
    s_add_u32 s3, s3, 4096
    s_add_u32 s8, s100, 0x8000000
    s_addc_u32 s9, s101, 0
    s_and_b32 s9, s9, 0xffff
    s_mov_b32 s10, 0x4600000
    s_mov_b32 s11, 0x00020000
    s_add_u32 s4, s8, 0x1fffff
    s_and_b32 s4, s4, 0xffe00000
    s_sub_u32 s4, s4, s8
    s_add_u32 s8, s100, 0x5900000
    s_addc_u32 s9, s101, 0
    s_and_b32 s9, s9, 0xffff
    s_mov_b32 s10, 0x10000
    s_mov_b32 s11, 0x00020000
    s_lshl_b32 s3, s2, 12
    v_mov_b32 v8, 0
    v_mov_b32 v9, 0
    v_mov_b32 v10, 0
    v_mov_b32 v11, 0
    buffer_store_dwordx4 v[8:11], v1, s[8:11], s3 offen sc1
    s_cmp_lg_u32 s18, 1
    s_cbranch_scc1 L_role_2
    s_mov_b32 s7, 1
    s_cmp_lg_u32 s16, 7
    s_cbranch_scc1 L_rolew_3
    s_lshr_b32 s6, s2, 7
    s_lshl_b32 s6, s6, 8
    s_add_u32 s4, s4, s6
    s_and_b32 s5, s2, 127
    s_lshl_b32 s5, s5, 14
    s_add_u32 s5, s5, s4
    s_add_u32 s5, s5, 0xc000800
    s_add_u32 s12, s100, s5
    s_addc_u32 s13, s101, 0
    s_mov_b32 s5, 0
    s_mov_b32 s6, 0
    s_atomic_add s5, s[12:13], 0x0 glc
    s_atomic_add s6, s[12:13], 0x2000 glc
    s_mov_b32 s24, -1
    s_mov_b32 s25, -1
    s_waitcnt lgkmcnt(0)
    s_mov_b32 s5, 0
    s_memtime s[20:21]
    s_waitcnt lgkmcnt(0)
    s_atomic_add s5, s[12:13], 0x0 glc
    s_waitcnt lgkmcnt(0)
    s_memtime s[22:23]
    s_waitcnt lgkmcnt(0)
    s_sub_u32 s22, s22, s20
    s_min_u32 s24, s24, s22
    s_mov_b32 s5, 0
    s_memtime s[20:21]
    s_waitcnt lgkmcnt(0)
    s_atomic_add s5, s[12:13], 0x2000 glc
    s_waitcnt lgkmcnt(0)
    s_memtime s[22:23]
    s_waitcnt lgkmcnt(0)
    s_sub_u32 s22, s22, s20
    s_min_u32 s25, s25, s22
    s_cmp_gt_u32 s25, s24
    s_cselect_b32 s7, 0x10001, 1
L_rolew_3:
L_role_2:
    v_lshlrev_b32 v2, 2, v0
    s_waitcnt vmcnt(0)
    ds_write_b32 v2, v12 offset:0
    s_waitcnt lgkmcnt(0)
    s_barrier
    v_mov_b32 v2, 0
    ds_read_b32 v4, v2 offset:0
    s_waitcnt lgkmcnt(0)
    v_readfirstlane_b32 s17, v4
    s_cmp_lg_u32 s18, 1
    s_cbranch_scc1 L_nosig_4
    s_cmp_lt_u32 s17, 32
    s_cbranch_scc1 L_noovf_5
    s_mov_b32 s5, 1
    s_atomic_add s5, s[98:99], 0x8 glc
    s_waitcnt lgkmcnt(0)
L_noovf_5:
    s_atomic_add s7, s[98:99], 0x0
L_nosig_4:
    s_cmp_lt_u32 s17, 32
    s_cbranch_scc1 L_hasrole_6
    s_mov_b32 s12, s98
    s_and_b32 s13, s99, 0xffff
    s_mov_b32 s14, 0x100
    s_mov_b32 s15, 0x00020000
    v_and_b32 v1, 7, v0
    v_lshlrev_b32 v1, 5, v1
    v_mov_b32 v2, 0
    s_mov_b32 s3, 0
L_ovw_7:
    buffer_load_dword v4, v2, s[12:15], 0 offen sc1
    s_add_u32 s3, s3, 1
    s_cmp_gt_u32 s3, 0x100000
    s_cbranch_scc1 chain_kernel_end0
    s_waitcnt vmcnt(0)
    v_readfirstlane_b32 s5, v4
    s_and_b32 s5, s5, 0xffff
    s_cmp_lt_u32 s5, 256
    s_cbranch_scc1 L_ovw_7
    buffer_load_dword v4, v1, s[12:15], 0 offen offset:24 sc1
    s_sub_u32 s17, s17, 32
    s_waitcnt vmcnt(0)
    v_readlane_b32 s20, v4, 0
    v_readlane_b32 s21, v4, 1
    v_readlane_b32 s22, v4, 2
    v_readlane_b32 s23, v4, 3
    v_readlane_b32 s24, v4, 4
    v_readlane_b32 s25, v4, 5
    v_readlane_b32 s26, v4, 6
    v_readlane_b32 s27, v4, 7
    s_max_u32 s5, s20, 32
    s_sub_u32 s5, s5, 32
    s_cmp_gt_u32 s16, 0
    s_cselect_b32 s5, s5, 0
    s_add_u32 s17, s17, s5
    s_max_u32 s5, s21, 32
    s_sub_u32 s5, s5, 32
    s_cmp_gt_u32 s16, 1
    s_cselect_b32 s5, s5, 0
    s_add_u32 s17, s17, s5
    s_max_u32 s5, s22, 32
    s_sub_u32 s5, s5, 32
    s_cmp_gt_u32 s16, 2
    s_cselect_b32 s5, s5, 0
    s_add_u32 s17, s17, s5
    s_max_u32 s5, s23, 32
    s_sub_u32 s5, s5, 32
    s_cmp_gt_u32 s16, 3
    s_cselect_b32 s5, s5, 0
    s_add_u32 s17, s17, s5
    s_max_u32 s5, s24, 32
    s_sub_u32 s5, s5, 32
    s_cmp_gt_u32 s16, 4
    s_cselect_b32 s5, s5, 0
    s_add_u32 s17, s17, s5
    s_max_u32 s5, s25, 32
    s_sub_u32 s5, s5, 32
    s_cmp_gt_u32 s16, 5
    s_cselect_b32 s5, s5, 0
    s_add_u32 s17, s17, s5
    s_max_u32 s5, s26, 32
    s_sub_u32 s5, s5, 32
    s_cmp_gt_u32 s16, 6
    s_cselect_b32 s5, s5, 0
    s_add_u32 s17, s17, s5
    s_min_u32 s5, s20, 32
    s_add_u32 s17, s17, s5
    s_mov_b32 s16, 0
    s_cmp_lt_u32 s17, 32
    s_cbranch_scc1 L_hasrole_6
    s_sub_u32 s17, s17, 32
    s_min_u32 s5, s21, 32
    s_add_u32 s17, s17, s5
    s_mov_b32 s16, 1
    s_cmp_lt_u32 s17, 32
    s_cbranch_scc1 L_hasrole_6
    s_sub_u32 s17, s17, 32
    s_min_u32 s5, s22, 32
    s_add_u32 s17, s17, s5
    s_mov_b32 s16, 2
    s_cmp_lt_u32 s17, 32
    s_cbranch_scc1 L_hasrole_6
    s_sub_u32 s17, s17, 32
    s_min_u32 s5, s23, 32
    s_add_u32 s17, s17, s5
    s_mov_b32 s16, 3
    s_cmp_lt_u32 s17, 32
    s_cbranch_scc1 L_hasrole_6
    s_sub_u32 s17, s17, 32
    s_min_u32 s5, s24, 32
    s_add_u32 s17, s17, s5
    s_mov_b32 s16, 4
    s_cmp_lt_u32 s17, 32
    s_cbranch_scc1 L_hasrole_6
    s_sub_u32 s17, s17, 32
    s_min_u32 s5, s25, 32
    s_add_u32 s17, s17, s5
    s_mov_b32 s16, 5
    s_cmp_lt_u32 s17, 32
    s_cbranch_scc1 L_hasrole_6
    s_sub_u32 s17, s17, 32
    s_min_u32 s5, s26, 32
    s_add_u32 s17, s17, s5
    s_mov_b32 s16, 6
    s_cmp_lt_u32 s17, 32
    s_cbranch_scc1 L_hasrole_6
    s_sub_u32 s17, s17, 32
    s_min_u32 s5, s27, 32
    s_add_u32 s17, s17, s5
    s_mov_b32 s16, 7
    s_cmp_lt_u32 s17, 32
    s_cbranch_scc1 L_hasrole_6
    s_sub_u32 s17, s17, 32
    s_branch chain_kernel_end0
L_hasrole_6:
    s_cmp_ge_u32 s16, 4
    s_cbranch_scc1 chain_kernel_worker
    s_mov_b32 s8, s100
    s_and_b32 s9, s101, 0xffff
    s_mov_b32 s10, 0x10000000
    s_mov_b32 s11, 0x00020000
    s_mov_b32 s33, 0
    s_mov_b32 s24, 0xff00ff
    s_mov_b32 s25, 0xff00ff
    s_mov_b32 s26, 0xff00ff00
    s_mov_b32 s27, 0xff00ff00
    s_mov_b32 s28, 0x0
    s_mov_b32 s29, 0xff00ff
    s_mov_b32 s48, 0xffffffff
    s_mov_b32 s49, 0x0
    s_mov_b32 s50, 0xffff
    s_mov_b32 s51, 0x0
    s_mov_b32 s44, 0x3e0293ee
    s_mov_b32 s45, 0x3e0293ee
    s_mov_b32 s46, 0x3db504f3
    s_mov_b32 s47, 0x3db504f3
    s_mov_b32 s34, 0xff81ff81
    s_lshl_b32 s36, s16, 14
    s_add_u32 s36, s36, 0x5000000
    s_lshl_b32 s37, s16, 16
    s_add_u32 s37, s37, 0x5040000
    v_mov_b32 v36, s34
    v_mov_b32 v44, 0x3f803f80
    v_mov_b32 v37, s34
    v_mov_b32 v45, 0x3f803f80
    v_mov_b32 v38, s34
    v_mov_b32 v46, 0x3f803f80
    v_mov_b32 v39, s34
    v_mov_b32 v47, 0x3f803f80
    v_and_b32 v250, 63, v0
    v_and_b32 v248, 15, v0
    v_bfe_u32 v249, v0, 4, 2
    v_lshrrev_b32 v251, 6, v0
    v_lshlrev_b32 v1, 4, v250
    s_lshl_b32 s20, s16, 10
    s_lshl_b32 s21, s17, 5
    s_add_u32 s20, s20, s21
    s_and_b32 s30, s17, 3
    v_lshl_add_u32 v252, v251, 12, v1
    s_add_u32 s21, s30, 0
    s_and_b32 s21, s21, 3
    s_lshl_b32 s21, s21, 10
    v_add_u32 v2, s21, v252
    s_add_u32 s21, s30, 1
    s_and_b32 s21, s21, 3
    s_lshl_b32 s21, s21, 10
    v_add_u32 v3, s21, v252
    s_add_u32 s21, s30, 2
    s_and_b32 s21, s21, 3
    s_lshl_b32 s21, s21, 10
    v_add_u32 v4, s21, v252
    s_add_u32 s21, s30, 3
    s_and_b32 s21, s21, 3
    s_lshl_b32 s21, s21, 10
    v_add_u32 v5, s21, v252
    v_mov_b32 v6, 0x44444444
    v_mov_b32 v252, 0xeeeeeeee
    v_cndmask_b32 v6, v6, v252, s[26:27]
    v_bfe_u32 v252, v250, 1, 3
    v_and_b32 v253, 1, v250
    v_lshlrev_b32 v33, 11, v252
    v_lshl_add_u32 v33, v253, 3, v33
    v_lshl_add_u32 v33, v249, 4, v33
    s_xor_b32 s22, s17, 8
    s_lshl_b32 s21, s22, 6
    v_add_u32 v33, s21, v33
    v_lshlrev_b32 v8, 3, v250
    s_xor_b32 s21, s17, 2
    s_lshl_b32 s21, s21, 9
    v_add_u32 v28, s21, v8
    s_lshl_b32 s22, s22, 9
    v_add_u32 v8, s22, v8
    v_lshlrev_b32 v11, 4, v248
    v_lshl_add_u32 v11, v249, 7, v11
    v_add_u32 v11, s21, v11
    s_lshr_b32 s22, s17, 2
    s_lshl_b32 s22, s22, 13
    s_add_u32 s21, s17, 0
    s_and_b32 s21, s21, 3
    s_lshl_b32 s21, s21, 10
    s_add_u32 s21, s21, s22
    v_add_u32 v9, s21, v1
    s_add_u32 s21, s17, 1
    s_and_b32 s21, s21, 3
    s_lshl_b32 s21, s21, 10
    s_add_u32 s21, s21, s22
    v_add_u32 v13, s21, v1
    s_add_u32 s21, s17, 2
    s_and_b32 s21, s21, 3
    s_lshl_b32 s21, s21, 10
    s_add_u32 s21, s21, s22
    v_add_u32 v14, s21, v1
    s_add_u32 s21, s17, 3
    s_and_b32 s21, s21, 3
    s_lshl_b32 s21, s21, 10
    s_add_u32 s21, s21, s22
    v_add_u32 v15, s21, v1
    s_add_u32 s22, s22, 4096
    v_add_u32 v16, s22, v1
    s_and_b32 s21, s17, 3
    s_lshl_b32 s21, s21, 8
    s_add_u32 s21, s21, s22
    v_and_b32 v253, 1, v249
    v_lshlrev_b32 v10, 4, v248
    v_lshl_add_u32 v10, v253, 7, v10
    v_add_u32 v10, s21, v10
    v_lshl_add_u32 v20, v251, 11, v1
    v_lshrrev_b32 v252, 1, v249
    v_lshl_add_u32 v252, v251, 1, v252
    v_lshlrev_b32 v21, 10, v252
    v_lshl_add_u32 v21, v248, 5, v21
    v_lshl_add_u32 v21, v253, 4, v21
    v_add_u32 v21, 8192, v21
    v_lshlrev_b32 v22, 5, v248
    v_lshl_add_u32 v22, v249, 3, v22
    v_add_u32 v22, 8192, v22
    v_lshrrev_b32 v253, 2, v248
    v_and_b32 v252, 3, v248
    v_lshl_add_u32 v253, v253, 3, v252
    v_add_u32 v25, 24576, v1
    v_add_u32 v26, 26624, v1
    v_lshlrev_b32 v32, 4, v253
    v_lshl_add_u32 v29, v249, 9, v32
    v_lshl_add_u32 v32, v249, 2, v32
    v_add_u32 v32, 33792, v32
    s_add_u32 s21, s16, 0
    s_and_b32 s21, s21, 3
    s_lshl_b32 s21, s21, 18
    s_lshr_b32 s22, s17, 1
    s_lshl_b32 s22, s22, 14
    s_add_u32 s21, s21, s22
    s_and_b32 s22, s17, 1
    s_lshl_b32 s22, s22, 12
    s_add_u32 s23, s21, s22
    v_lshl_add_u32 v12, v250, 3, s23
    s_add_u32 s21, s16, 1
    s_and_b32 s21, s21, 3
    s_lshl_b32 s21, s21, 18
    s_lshr_b32 s22, s17, 1
    s_lshl_b32 s22, s22, 14
    s_add_u32 s21, s21, s22
    s_and_b32 s22, s17, 1
    s_lshl_b32 s22, s22, 12
    s_add_u32 s21, s21, s22
    v_lshl_add_u32 v17, v250, 3, s21
    s_add_u32 s21, s16, 2
    s_and_b32 s21, s21, 3
    s_lshl_b32 s21, s21, 18
    s_lshr_b32 s22, s17, 1
    s_lshl_b32 s22, s22, 14
    s_add_u32 s21, s21, s22
    s_and_b32 s22, s17, 1
    s_lshl_b32 s22, s22, 12
    s_add_u32 s21, s21, s22
    v_lshl_add_u32 v18, v250, 3, s21
    s_add_u32 s21, s16, 3
    s_and_b32 s21, s21, 3
    s_lshl_b32 s21, s21, 18
    s_lshr_b32 s22, s17, 1
    s_lshl_b32 s22, s22, 14
    s_add_u32 s21, s21, s22
    s_and_b32 s22, s17, 1
    s_lshl_b32 s22, s22, 12
    s_add_u32 s21, s21, s22
    v_lshl_add_u32 v19, v250, 3, s21
    s_xor_b32 s21, s23, 0x4000
    v_add_u32 v29, s21, v29
    v_add_u32 v31, s21, v1
    v_and_b32 v253, 8, v248
    v_add_u32 v253, v253, v248
    v_lshlrev_b32 v27, 4, v253
    v_lshl_add_u32 v27, v249, 9, v27
    v_add_u32 v27, s23, v27
    v_bfe_u32 v253, v248, 2, 1
    v_lshl_add_u32 v252, v252, 1, v253
    v_cndmask_b32 v252, v248, v252, s[26:27]
    v_lshlrev_b32 v30, 4, v252
    v_lshl_add_u32 v30, v249, 7, v30
    v_add_u32 v30, s23, v30
    v_and_b32 v253, 1, v252
    v_lshlrev_b32 v253, 4, v253
    v_mov_b32 v254, 0x3f80
    v_lshlrev_b32 v254, v253, v254
    v_lshrrev_b32 v253, 2, v252
    v_xor_b32 v253, v253, v249
    v_and_b32 v253, 1, v253
    v_bfe_u32 v252, v252, 1, 1
    v_lshl_add_u32 v252, v253, 2, v252
    v_lshrrev_b32 v253, 3, v248
    v_lshl_add_u32 v252, v253, 1, v252
    v_cmp_eq_u32 vcc, 0, v252
    s_nop 1
    v_cndmask_b32 v40, 0, v254, vcc
    v_cmp_eq_u32 vcc, 1, v252
    s_nop 1
    v_cndmask_b32 v41, 0, v254, vcc
    v_cmp_eq_u32 vcc, 2, v252
    s_nop 1
    v_cndmask_b32 v42, 0, v254, vcc
    v_cmp_eq_u32 vcc, 3, v252
    s_nop 1
    v_cndmask_b32 v43, 0, v254, vcc
    v_bfe_u32 v248, v0, 4, 2
    v_lshlrev_b32 v250, 1, v248
    v_bfe_u32 v248, v0, 2, 1
    v_add_u32 v250, v250, v248
    v_bfe_u32 v248, v0, 3, 1
    v_lshl_add_u32 v250, v248, 3, v250
    v_lshrrev_b32 v248, 6, v0
    v_lshl_add_u32 v250, v248, 8, v250
    v_and_b32 v249, 3, v0
    v_lshlrev_b32 v251, 13, v250
    v_lshl_add_u32 v251, v249, 4, v251
    s_lshl_b32 s21, s20, 1
    v_add_u32 v251, s21, v251
    s_lshl_b32 s21, s16, 10
    v_add_u32 v252, s21, v250
    v_lshlrev_b32 v252, 11, v252
    v_lshl_add_u32 v252, v249, 4, v252
    s_xor_b32 s21, s17, 8
    s_lshl_b32 s21, s21, 6
    v_add_u32 v252, s21, v252
    v_bfe_u32 v248, v0, 4, 2
    v_lshlrev_b32 v248, 3, v248
    v_bfe_u32 v242, v0, 2, 2
    v_add_u32 v248, v248, v242
    v_lshlrev_b32 v242, 6, v248
    v_lshrrev_b32 v248, 6, v0
    v_lshl_add_u32 v242, v248, 14, v242
    v_lshl_add_u32 v240, v249, 3, v242
    v_and_b32 v241, 2, v249
    v_lshl_add_u32 v240, v241, 3, v240
    v_lshl_add_u32 v242, v249, 4, v242
    v_add_u32 v241, 0x10000, v240
    v_add_u32 v243, 0x10000, v242
    v_lshl_add_u32 v244, v248, 14, v1
    v_add_u32 v245, 0x10000, v244
    s_lshl_b32 s22, s18, 14
    s_add_u32 s22, s22, 32768
    s_and_b32 s23, s17, 14
    s_cmp_eq_u32 s23, 6
    s_cselect_b64 vcc, 0, -1
    v_xor_b32 v253, 128, v251
    s_mov_b32 s12, s88
    s_and_b32 s13, s89, 0xffff
    s_mov_b32 s14, 0x800000
    s_mov_b32 s15, 0x00020000
    s_add_u32 m0, s22, 0
    s_add_u32 s23, s30, 0
    s_and_b32 s23, s23, 3
    s_lshl_b32 s23, s23, 2
    s_add_u32 s23, s23, 0
    s_mul_i32 s23, s23, 131072
    buffer_load_dwordx4 v251, s[12:15], s23 offen lds
    s_add_u32 m0, s22, 1024
    s_add_u32 s23, s30, 0
    s_and_b32 s23, s23, 3
    s_lshl_b32 s23, s23, 2
    s_add_u32 s23, s23, 1
    s_mul_i32 s23, s23, 131072
    buffer_load_dwordx4 v251, s[12:15], s23 offen lds
    s_add_u32 m0, s22, 2048
    s_add_u32 s23, s30, 0
    s_and_b32 s23, s23, 3
    s_lshl_b32 s23, s23, 2
    s_add_u32 s23, s23, 2
    s_mul_i32 s23, s23, 131072
    buffer_load_dwordx4 v251, s[12:15], s23 offen lds
    s_add_u32 m0, s22, 3072
    s_add_u32 s23, s30, 0
    s_and_b32 s23, s23, 3
    s_lshl_b32 s23, s23, 2
    s_add_u32 s23, s23, 3
    s_mul_i32 s23, s23, 131072
    buffer_load_dwordx4 v251, s[12:15], s23 offen lds
    s_add_u32 m0, s22, 4096
    s_add_u32 s23, s30, 1
    s_and_b32 s23, s23, 3
    s_lshl_b32 s23, s23, 2
    s_add_u32 s23, s23, 0
    s_mul_i32 s23, s23, 131072
    buffer_load_dwordx4 v251, s[12:15], s23 offen lds
    s_add_u32 m0, s22, 5120
    s_add_u32 s23, s30, 1
    s_and_b32 s23, s23, 3
    s_lshl_b32 s23, s23, 2
    s_add_u32 s23, s23, 1
    s_mul_i32 s23, s23, 131072
    buffer_load_dwordx4 v251, s[12:15], s23 offen lds
    s_add_u32 m0, s22, 6144
    s_add_u32 s23, s30, 1
    s_and_b32 s23, s23, 3
    s_lshl_b32 s23, s23, 2
    s_add_u32 s23, s23, 2
    s_mul_i32 s23, s23, 131072
    buffer_load_dwordx4 v251, s[12:15], s23 offen lds
    s_add_u32 m0, s22, 7168
    s_add_u32 s23, s30, 1
    s_and_b32 s23, s23, 3
    s_lshl_b32 s23, s23, 2
    s_add_u32 s23, s23, 3
    s_mul_i32 s23, s23, 131072
    buffer_load_dwordx4 v251, s[12:15], s23 offen lds
    s_add_u32 m0, s22, 8192
    s_add_u32 s23, s30, 2
    s_and_b32 s23, s23, 3
    s_lshl_b32 s23, s23, 2
    s_add_u32 s23, s23, 0
    s_mul_i32 s23, s23, 131072
    buffer_load_dwordx4 v251, s[12:15], s23 offen lds
    s_add_u32 m0, s22, 9216
    s_add_u32 s23, s30, 2
    s_and_b32 s23, s23, 3
    s_lshl_b32 s23, s23, 2
    s_add_u32 s23, s23, 1
    s_mul_i32 s23, s23, 131072
    buffer_load_dwordx4 v251, s[12:15], s23 offen lds
    s_add_u32 m0, s22, 10240
    s_add_u32 s23, s30, 2
    s_and_b32 s23, s23, 3
    s_lshl_b32 s23, s23, 2
    s_add_u32 s23, s23, 2
    s_mul_i32 s23, s23, 131072
    buffer_load_dwordx4 v251, s[12:15], s23 offen lds
    s_add_u32 m0, s22, 11264
    s_add_u32 s23, s30, 2
    s_and_b32 s23, s23, 3
    s_lshl_b32 s23, s23, 2
    s_add_u32 s23, s23, 3
    s_mul_i32 s23, s23, 131072
    buffer_load_dwordx4 v251, s[12:15], s23 offen lds
    s_add_u32 m0, s22, 12288
    s_add_u32 s23, s30, 3
    s_and_b32 s23, s23, 3
    s_lshl_b32 s23, s23, 2
    s_add_u32 s23, s23, 0
    s_mul_i32 s23, s23, 131072
    buffer_load_dwordx4 v251, s[12:15], s23 offen lds
    s_add_u32 m0, s22, 13312
    s_add_u32 s23, s30, 3
    s_and_b32 s23, s23, 3
    s_lshl_b32 s23, s23, 2
    s_add_u32 s23, s23, 1
    s_mul_i32 s23, s23, 131072
    buffer_load_dwordx4 v251, s[12:15], s23 offen lds
    s_add_u32 m0, s22, 14336
    s_add_u32 s23, s30, 3
    s_and_b32 s23, s23, 3
    s_lshl_b32 s23, s23, 2
    s_add_u32 s23, s23, 2
    s_mul_i32 s23, s23, 131072
    buffer_load_dwordx4 v251, s[12:15], s23 offen lds
    s_add_u32 m0, s22, 15360
    s_add_u32 s23, s30, 3
    s_and_b32 s23, s23, 3
    s_lshl_b32 s23, s23, 2
    s_add_u32 s23, s23, 3
    s_mul_i32 s23, s23, 131072
    buffer_load_dwordx4 v251, s[12:15], s23 offen lds
    s_mov_b32 s12, s90
    s_and_b32 s13, s91, 0xffff
    s_mov_b32 s14, 0x800000
    s_mov_b32 s15, 0x00020000
    s_add_u32 m0, s22, 65536
    s_add_u32 s23, s30, 0
    s_and_b32 s23, s23, 3
    s_lshl_b32 s23, s23, 2
    s_add_u32 s23, s23, 0
    s_mul_i32 s23, s23, 131072
    buffer_load_dwordx4 v253, s[12:15], s23 offen lds
    s_add_u32 m0, s22, 66560
    s_add_u32 s23, s30, 0
    s_and_b32 s23, s23, 3
    s_lshl_b32 s23, s23, 2
    s_add_u32 s23, s23, 1
    s_mul_i32 s23, s23, 131072
    buffer_load_dwordx4 v253, s[12:15], s23 offen lds
    s_add_u32 m0, s22, 67584
    s_add_u32 s23, s30, 0
    s_and_b32 s23, s23, 3
    s_lshl_b32 s23, s23, 2
    s_add_u32 s23, s23, 2
    s_mul_i32 s23, s23, 131072
    buffer_load_dwordx4 v253, s[12:15], s23 offen lds
    s_add_u32 m0, s22, 68608
    s_add_u32 s23, s30, 0
    s_and_b32 s23, s23, 3
    s_lshl_b32 s23, s23, 2
    s_add_u32 s23, s23, 3
    s_mul_i32 s23, s23, 131072
    buffer_load_dwordx4 v253, s[12:15], s23 offen lds
    s_add_u32 m0, s22, 69632
    s_add_u32 s23, s30, 1
    s_and_b32 s23, s23, 3
    s_lshl_b32 s23, s23, 2
    s_add_u32 s23, s23, 0
    s_mul_i32 s23, s23, 131072
    buffer_load_dwordx4 v253, s[12:15], s23 offen lds
    s_add_u32 m0, s22, 70656
    s_add_u32 s23, s30, 1
    s_and_b32 s23, s23, 3
    s_lshl_b32 s23, s23, 2
    s_add_u32 s23, s23, 1
    s_mul_i32 s23, s23, 131072
    buffer_load_dwordx4 v253, s[12:15], s23 offen lds
    s_add_u32 m0, s22, 71680
    s_add_u32 s23, s30, 1
    s_and_b32 s23, s23, 3
    s_lshl_b32 s23, s23, 2
    s_add_u32 s23, s23, 2
    s_mul_i32 s23, s23, 131072
    buffer_load_dwordx4 v253, s[12:15], s23 offen lds
    s_add_u32 m0, s22, 72704
    s_add_u32 s23, s30, 1
    s_and_b32 s23, s23, 3
    s_lshl_b32 s23, s23, 2
    s_add_u32 s23, s23, 3
    s_mul_i32 s23, s23, 131072
    buffer_load_dwordx4 v253, s[12:15], s23 offen lds
    s_add_u32 m0, s22, 73728
    s_add_u32 s23, s30, 2
    s_and_b32 s23, s23, 3
    s_lshl_b32 s23, s23, 2
    s_add_u32 s23, s23, 0
    s_mul_i32 s23, s23, 131072
    buffer_load_dwordx4 v253, s[12:15], s23 offen lds
    s_add_u32 m0, s22, 74752
    s_add_u32 s23, s30, 2
    s_and_b32 s23, s23, 3
    s_lshl_b32 s23, s23, 2
    s_add_u32 s23, s23, 1
    s_mul_i32 s23, s23, 131072
    buffer_load_dwordx4 v253, s[12:15], s23 offen lds
    s_add_u32 m0, s22, 75776
    s_add_u32 s23, s30, 2
    s_and_b32 s23, s23, 3
    s_lshl_b32 s23, s23, 2
    s_add_u32 s23, s23, 2
    s_mul_i32 s23, s23, 131072
    buffer_load_dwordx4 v253, s[12:15], s23 offen lds
    s_add_u32 m0, s22, 76800
    s_add_u32 s23, s30, 2
    s_and_b32 s23, s23, 3
    s_lshl_b32 s23, s23, 2
    s_add_u32 s23, s23, 3
    s_mul_i32 s23, s23, 131072
    buffer_load_dwordx4 v253, s[12:15], s23 offen lds
    s_add_u32 m0, s22, 77824
    s_add_u32 s23, s30, 3
    s_and_b32 s23, s23, 3
    s_lshl_b32 s23, s23, 2
    s_add_u32 s23, s23, 0
    s_mul_i32 s23, s23, 131072
    buffer_load_dwordx4 v253, s[12:15], s23 offen lds
    s_add_u32 m0, s22, 78848
    s_add_u32 s23, s30, 3
    s_and_b32 s23, s23, 3
    s_lshl_b32 s23, s23, 2
    s_add_u32 s23, s23, 1
    s_mul_i32 s23, s23, 131072
    buffer_load_dwordx4 v253, s[12:15], s23 offen lds
    s_add_u32 m0, s22, 79872
    s_add_u32 s23, s30, 3
    s_and_b32 s23, s23, 3
    s_lshl_b32 s23, s23, 2
    s_add_u32 s23, s23, 2
    s_mul_i32 s23, s23, 131072
    buffer_load_dwordx4 v253, s[12:15], s23 offen lds
    s_add_u32 m0, s22, 80896
    s_add_u32 s23, s30, 3
    s_and_b32 s23, s23, 3
    s_lshl_b32 s23, s23, 2
    s_add_u32 s23, s23, 3
    s_mul_i32 s23, s23, 131072
    buffer_load_dwordx4 v253, s[12:15], s23 offen lds
    s_mov_b32 s12, s86
    s_and_b32 s13, s87, 0xffff
    s_mov_b32 s14, 0x800000
    s_mov_b32 s15, 0x00020000
    s_add_u32 s23, s30, 0
    s_and_b32 s23, s23, 3
    s_lshl_b32 s23, s23, 2
    s_add_u32 s23, s23, 0
    s_mul_i32 s23, s23, 131072
    buffer_load_dwordx4 v[112:115], v251, s[12:15], s23 offen
    s_add_u32 s23, s30, 0
    s_and_b32 s23, s23, 3
    s_lshl_b32 s23, s23, 2
    s_add_u32 s23, s23, 1
    s_mul_i32 s23, s23, 131072
    buffer_load_dwordx4 v[116:119], v251, s[12:15], s23 offen
    s_add_u32 s23, s30, 0
    s_and_b32 s23, s23, 3
    s_lshl_b32 s23, s23, 2
    s_add_u32 s23, s23, 2
    s_mul_i32 s23, s23, 131072
    buffer_load_dwordx4 v[120:123], v251, s[12:15], s23 offen
    s_add_u32 s23, s30, 0
    s_and_b32 s23, s23, 3
    s_lshl_b32 s23, s23, 2
    s_add_u32 s23, s23, 3
    s_mul_i32 s23, s23, 131072
    buffer_load_dwordx4 v[124:127], v251, s[12:15], s23 offen
    s_add_u32 s23, s30, 1
    s_and_b32 s23, s23, 3
    s_lshl_b32 s23, s23, 2
    s_add_u32 s23, s23, 0
    s_mul_i32 s23, s23, 131072
    buffer_load_dwordx4 v[128:131], v251, s[12:15], s23 offen
    s_add_u32 s23, s30, 1
    s_and_b32 s23, s23, 3
    s_lshl_b32 s23, s23, 2
    s_add_u32 s23, s23, 1
    s_mul_i32 s23, s23, 131072
    buffer_load_dwordx4 v[132:135], v251, s[12:15], s23 offen
    s_add_u32 s23, s30, 1
    s_and_b32 s23, s23, 3
    s_lshl_b32 s23, s23, 2
    s_add_u32 s23, s23, 2
    s_mul_i32 s23, s23, 131072
    buffer_load_dwordx4 v[136:139], v251, s[12:15], s23 offen
    s_add_u32 s23, s30, 1
    s_and_b32 s23, s23, 3
    s_lshl_b32 s23, s23, 2
    s_add_u32 s23, s23, 3
    s_mul_i32 s23, s23, 131072
    buffer_load_dwordx4 v[140:143], v251, s[12:15], s23 offen
    s_add_u32 s23, s30, 2
    s_and_b32 s23, s23, 3
    s_lshl_b32 s23, s23, 2
    s_add_u32 s23, s23, 0
    s_mul_i32 s23, s23, 131072
    buffer_load_dwordx4 v[144:147], v251, s[12:15], s23 offen
    s_add_u32 s23, s30, 2
    s_and_b32 s23, s23, 3
    s_lshl_b32 s23, s23, 2
    s_add_u32 s23, s23, 1
    s_mul_i32 s23, s23, 131072
    buffer_load_dwordx4 v[148:151], v251, s[12:15], s23 offen
    s_add_u32 s23, s30, 2
    s_and_b32 s23, s23, 3
    s_lshl_b32 s23, s23, 2
    s_add_u32 s23, s23, 2
    s_mul_i32 s23, s23, 131072
    buffer_load_dwordx4 v[152:155], v251, s[12:15], s23 offen
    s_add_u32 s23, s30, 2
    s_and_b32 s23, s23, 3
    s_lshl_b32 s23, s23, 2
    s_add_u32 s23, s23, 3
    s_mul_i32 s23, s23, 131072
    buffer_load_dwordx4 v[156:159], v251, s[12:15], s23 offen
    s_add_u32 s23, s30, 3
    s_and_b32 s23, s23, 3
    s_lshl_b32 s23, s23, 2
    s_add_u32 s23, s23, 0
    s_mul_i32 s23, s23, 131072
    buffer_load_dwordx4 v[160:163], v251, s[12:15], s23 offen
    s_add_u32 s23, s30, 3
    s_and_b32 s23, s23, 3
    s_lshl_b32 s23, s23, 2
    s_add_u32 s23, s23, 1
    s_mul_i32 s23, s23, 131072
    buffer_load_dwordx4 v[164:167], v251, s[12:15], s23 offen
    s_add_u32 s23, s30, 3
    s_and_b32 s23, s23, 3
    s_lshl_b32 s23, s23, 2
    s_add_u32 s23, s23, 2
    s_mul_i32 s23, s23, 131072
    buffer_load_dwordx4 v[168:171], v251, s[12:15], s23 offen
    s_add_u32 s23, s30, 3
    s_and_b32 s23, s23, 3
    s_lshl_b32 s23, s23, 2
    s_add_u32 s23, s23, 3
    s_mul_i32 s23, s23, 131072
    buffer_load_dwordx4 v[172:175], v251, s[12:15], s23 offen
    s_waitcnt vmcnt(32)
    s_mov_b32 s12, s92
    s_and_b32 s13, s93, 0xffff
    s_mov_b32 s14, 0x800000
    s_mov_b32 s15, 0x00020000
    s_add_u32 s23, s30, 0
    s_and_b32 s23, s23, 3
    s_lshl_b32 s23, s23, 2
    s_add_u32 s23, s23, 0
    s_mul_i32 s23, s23, 32768
    buffer_load_dwordx4 v[48:51], v252, s[12:15], s23 offen
    s_add_u32 s23, s30, 0
    s_and_b32 s23, s23, 3
    s_lshl_b32 s23, s23, 2
    s_add_u32 s23, s23, 1
    s_mul_i32 s23, s23, 32768
    buffer_load_dwordx4 v[52:55], v252, s[12:15], s23 offen
    s_add_u32 s23, s30, 0
    s_and_b32 s23, s23, 3
    s_lshl_b32 s23, s23, 2
    s_add_u32 s23, s23, 2
    s_mul_i32 s23, s23, 32768
    buffer_load_dwordx4 v[56:59], v252, s[12:15], s23 offen
    s_add_u32 s23, s30, 0
    s_and_b32 s23, s23, 3
    s_lshl_b32 s23, s23, 2
    s_add_u32 s23, s23, 3
    s_mul_i32 s23, s23, 32768
    buffer_load_dwordx4 v[60:63], v252, s[12:15], s23 offen
    s_add_u32 s23, s30, 1
    s_and_b32 s23, s23, 3
    s_lshl_b32 s23, s23, 2
    s_add_u32 s23, s23, 0
    s_mul_i32 s23, s23, 32768
    buffer_load_dwordx4 v[64:67], v252, s[12:15], s23 offen
    s_add_u32 s23, s30, 1
    s_and_b32 s23, s23, 3
    s_lshl_b32 s23, s23, 2
    s_add_u32 s23, s23, 1
    s_mul_i32 s23, s23, 32768
    buffer_load_dwordx4 v[68:71], v252, s[12:15], s23 offen
    s_add_u32 s23, s30, 1
    s_and_b32 s23, s23, 3
    s_lshl_b32 s23, s23, 2
    s_add_u32 s23, s23, 2
    s_mul_i32 s23, s23, 32768
    buffer_load_dwordx4 v[72:75], v252, s[12:15], s23 offen
    s_add_u32 s23, s30, 1
    s_and_b32 s23, s23, 3
    s_lshl_b32 s23, s23, 2
    s_add_u32 s23, s23, 3
    s_mul_i32 s23, s23, 32768
    buffer_load_dwordx4 v[76:79], v252, s[12:15], s23 offen
    s_add_u32 s23, s30, 2
    s_and_b32 s23, s23, 3
    s_lshl_b32 s23, s23, 2
    s_add_u32 s23, s23, 0
    s_mul_i32 s23, s23, 32768
    buffer_load_dwordx4 v[80:83], v252, s[12:15], s23 offen
    s_add_u32 s23, s30, 2
    s_and_b32 s23, s23, 3
    s_lshl_b32 s23, s23, 2
    s_add_u32 s23, s23, 1
    s_mul_i32 s23, s23, 32768
    buffer_load_dwordx4 v[84:87], v252, s[12:15], s23 offen
    s_add_u32 s23, s30, 2
    s_and_b32 s23, s23, 3
    s_lshl_b32 s23, s23, 2
    s_add_u32 s23, s23, 2
    s_mul_i32 s23, s23, 32768
    buffer_load_dwordx4 v[88:91], v252, s[12:15], s23 offen
    s_add_u32 s23, s30, 2
    s_and_b32 s23, s23, 3
    s_lshl_b32 s23, s23, 2
    s_add_u32 s23, s23, 3
    s_mul_i32 s23, s23, 32768
    buffer_load_dwordx4 v[92:95], v252, s[12:15], s23 offen
    s_add_u32 s23, s30, 3
    s_and_b32 s23, s23, 3
    s_lshl_b32 s23, s23, 2
    s_add_u32 s23, s23, 0
    s_mul_i32 s23, s23, 32768
    buffer_load_dwordx4 v[96:99], v252, s[12:15], s23 offen
    s_add_u32 s23, s30, 3
    s_and_b32 s23, s23, 3
    s_lshl_b32 s23, s23, 2
    s_add_u32 s23, s23, 1
    s_mul_i32 s23, s23, 32768
    buffer_load_dwordx4 v[100:103], v252, s[12:15], s23 offen
    s_add_u32 s23, s30, 3
    s_and_b32 s23, s23, 3
    s_lshl_b32 s23, s23, 2
    s_add_u32 s23, s23, 2
    s_mul_i32 s23, s23, 32768
    buffer_load_dwordx4 v[104:107], v252, s[12:15], s23 offen
    s_add_u32 s23, s30, 3
    s_and_b32 s23, s23, 3
    s_lshl_b32 s23, s23, 2
    s_add_u32 s23, s23, 3
    s_mul_i32 s23, s23, 32768
    buffer_load_dwordx4 v[108:111], v252, s[12:15], s23 offen
    ds_read_b64_tr_b16 a[64:65], v240 offset:32768
    ds_read_b64_tr_b16 a[66:67], v240 offset:33024
    ds_read_b64_tr_b16 a[68:69], v240 offset:34816
    ds_read_b64_tr_b16 a[70:71], v240 offset:35072
    ds_read_b64_tr_b16 a[96:97], v240 offset:32784
    ds_read_b64_tr_b16 a[98:99], v240 offset:33040
    ds_read_b64_tr_b16 a[100:101], v240 offset:34832
    ds_read_b64_tr_b16 a[102:103], v240 offset:35088
    s_waitcnt lgkmcnt(0)
    ds_read_b64_tr_b16 a[72:73], v240 offset:36864
    ds_read_b64_tr_b16 a[74:75], v240 offset:37120
    ds_read_b64_tr_b16 a[76:77], v240 offset:38912
    ds_read_b64_tr_b16 a[78:79], v240 offset:39168
    ds_read_b64_tr_b16 a[104:105], v240 offset:36880
    ds_read_b64_tr_b16 a[106:107], v240 offset:37136
    ds_read_b64_tr_b16 a[108:109], v240 offset:38928
    ds_read_b64_tr_b16 a[110:111], v240 offset:39184
    s_waitcnt lgkmcnt(0)
    ds_read_b64_tr_b16 a[80:81], v240 offset:40960
    ds_read_b64_tr_b16 a[82:83], v240 offset:41216
    ds_read_b64_tr_b16 a[84:85], v240 offset:43008
    ds_read_b64_tr_b16 a[86:87], v240 offset:43264
    ds_read_b64_tr_b16 a[112:113], v240 offset:40976
    ds_read_b64_tr_b16 a[114:115], v240 offset:41232
    ds_read_b64_tr_b16 a[116:117], v240 offset:43024
    ds_read_b64_tr_b16 a[118:119], v240 offset:43280
    s_waitcnt lgkmcnt(0)
    ds_read_b64_tr_b16 a[88:89], v240 offset:45056
    ds_read_b64_tr_b16 a[90:91], v240 offset:45312
    ds_read_b64_tr_b16 a[92:93], v240 offset:47104
    ds_read_b64_tr_b16 a[94:95], v240 offset:47360
    ds_read_b64_tr_b16 a[120:121], v240 offset:45072
    ds_read_b64_tr_b16 a[122:123], v240 offset:45328
    ds_read_b64_tr_b16 a[124:125], v240 offset:47120
    ds_read_b64_tr_b16 a[126:127], v240 offset:47376
    s_waitcnt lgkmcnt(0)
    s_waitcnt vmcnt(32)
    ds_read_b64_tr_b16 a[128:129], v243 offset:32768
    ds_read_b64_tr_b16 a[130:131], v243 offset:33024
    ds_read_b64_tr_b16 a[132:133], v243 offset:34816
    ds_read_b64_tr_b16 a[134:135], v243 offset:35072
    ds_read_b64_tr_b16 a[160:161], v243 offset:32776
    ds_read_b64_tr_b16 a[162:163], v243 offset:33032
    ds_read_b64_tr_b16 a[164:165], v243 offset:34824
    ds_read_b64_tr_b16 a[166:167], v243 offset:35080
    s_waitcnt lgkmcnt(0)
    ds_read_b64_tr_b16 a[136:137], v243 offset:36864
    ds_read_b64_tr_b16 a[138:139], v243 offset:37120
    ds_read_b64_tr_b16 a[140:141], v243 offset:38912
    ds_read_b64_tr_b16 a[142:143], v243 offset:39168
    ds_read_b64_tr_b16 a[168:169], v243 offset:36872
    ds_read_b64_tr_b16 a[170:171], v243 offset:37128
    ds_read_b64_tr_b16 a[172:173], v243 offset:38920
    ds_read_b64_tr_b16 a[174:175], v243 offset:39176
    s_waitcnt lgkmcnt(0)
    ds_read_b64_tr_b16 a[144:145], v243 offset:40960
    ds_read_b64_tr_b16 a[146:147], v243 offset:41216
    ds_read_b64_tr_b16 a[148:149], v243 offset:43008
    ds_read_b64_tr_b16 a[150:151], v243 offset:43264
    ds_read_b64_tr_b16 a[176:177], v243 offset:40968
    ds_read_b64_tr_b16 a[178:179], v243 offset:41224
    ds_read_b64_tr_b16 a[180:181], v243 offset:43016
    ds_read_b64_tr_b16 a[182:183], v243 offset:43272
    s_waitcnt lgkmcnt(0)
    ds_read_b64_tr_b16 a[152:153], v243 offset:45056
    ds_read_b64_tr_b16 a[154:155], v243 offset:45312
    ds_read_b64_tr_b16 a[156:157], v243 offset:47104
    ds_read_b64_tr_b16 a[158:159], v243 offset:47360
    ds_read_b64_tr_b16 a[184:185], v243 offset:45064
    ds_read_b64_tr_b16 a[186:187], v243 offset:45320
    ds_read_b64_tr_b16 a[188:189], v243 offset:47112
    ds_read_b64_tr_b16 a[190:191], v243 offset:47368
    s_waitcnt lgkmcnt(0)
    s_waitcnt vmcnt(16)
    ds_write_b128 v244, v[112:115] offset:32768
    ds_write_b128 v244, v[116:119] offset:33792
    ds_write_b128 v244, v[120:123] offset:34816
    ds_write_b128 v244, v[124:127] offset:35840
    ds_write_b128 v244, v[128:131] offset:36864
    ds_write_b128 v244, v[132:135] offset:37888
    ds_write_b128 v244, v[136:139] offset:38912
    ds_write_b128 v244, v[140:143] offset:39936
    ds_write_b128 v244, v[144:147] offset:40960
    ds_write_b128 v244, v[148:151] offset:41984
    ds_write_b128 v244, v[152:155] offset:43008
    ds_write_b128 v244, v[156:159] offset:44032
    ds_write_b128 v244, v[160:163] offset:45056
    ds_write_b128 v244, v[164:167] offset:46080
    ds_write_b128 v244, v[168:171] offset:47104
    ds_write_b128 v244, v[172:175] offset:48128
    s_waitcnt lgkmcnt(0)
    ds_read_b64_tr_b16 a[0:1], v240 offset:32768
    ds_read_b64_tr_b16 a[2:3], v240 offset:33024
    ds_read_b64_tr_b16 a[4:5], v240 offset:34816
    ds_read_b64_tr_b16 a[6:7], v240 offset:35072
    ds_read_b64_tr_b16 a[32:33], v240 offset:32784
    ds_read_b64_tr_b16 a[34:35], v240 offset:33040
    ds_read_b64_tr_b16 a[36:37], v240 offset:34832
    ds_read_b64_tr_b16 a[38:39], v240 offset:35088
    s_waitcnt lgkmcnt(0)
    ds_read_b64_tr_b16 a[8:9], v240 offset:36864
    ds_read_b64_tr_b16 a[10:11], v240 offset:37120
    ds_read_b64_tr_b16 a[12:13], v240 offset:38912
    ds_read_b64_tr_b16 a[14:15], v240 offset:39168
    ds_read_b64_tr_b16 a[40:41], v240 offset:36880
    ds_read_b64_tr_b16 a[42:43], v240 offset:37136
    ds_read_b64_tr_b16 a[44:45], v240 offset:38928
    ds_read_b64_tr_b16 a[46:47], v240 offset:39184
    s_waitcnt lgkmcnt(0)
    ds_read_b64_tr_b16 a[16:17], v240 offset:40960
    ds_read_b64_tr_b16 a[18:19], v240 offset:41216
    ds_read_b64_tr_b16 a[20:21], v240 offset:43008
    ds_read_b64_tr_b16 a[22:23], v240 offset:43264
    ds_read_b64_tr_b16 a[48:49], v240 offset:40976
    ds_read_b64_tr_b16 a[50:51], v240 offset:41232
    ds_read_b64_tr_b16 a[52:53], v240 offset:43024
    ds_read_b64_tr_b16 a[54:55], v240 offset:43280
    s_waitcnt lgkmcnt(0)
    ds_read_b64_tr_b16 a[24:25], v240 offset:45056
    ds_read_b64_tr_b16 a[26:27], v240 offset:45312
    ds_read_b64_tr_b16 a[28:29], v240 offset:47104
    ds_read_b64_tr_b16 a[30:31], v240 offset:47360
    ds_read_b64_tr_b16 a[56:57], v240 offset:45072
    ds_read_b64_tr_b16 a[58:59], v240 offset:45328
    ds_read_b64_tr_b16 a[60:61], v240 offset:47120
    ds_read_b64_tr_b16 a[62:63], v240 offset:47376
    s_waitcnt lgkmcnt(0)
    s_waitcnt vmcnt(0)
    ds_write_b128 v245, v[48:51] offset:32768
    ds_write_b128 v245, v[52:55] offset:33792
    ds_write_b128 v245, v[56:59] offset:34816
    ds_write_b128 v245, v[60:63] offset:35840
    ds_write_b128 v245, v[64:67] offset:36864
    ds_write_b128 v245, v[68:71] offset:37888
    ds_write_b128 v245, v[72:75] offset:38912
    ds_write_b128 v245, v[76:79] offset:39936
    ds_write_b128 v245, v[80:83] offset:40960
    ds_write_b128 v245, v[84:87] offset:41984
    ds_write_b128 v245, v[88:91] offset:43008
    ds_write_b128 v245, v[92:95] offset:44032
    ds_write_b128 v245, v[96:99] offset:45056
    ds_write_b128 v245, v[100:103] offset:46080
    ds_write_b128 v245, v[104:107] offset:47104
    ds_write_b128 v245, v[108:111] offset:48128
    s_waitcnt lgkmcnt(0)
    ds_read_b64_tr_b16 a[192:193], v243 offset:32768
    ds_read_b64_tr_b16 a[194:195], v243 offset:33024
    ds_read_b64_tr_b16 a[196:197], v243 offset:34816
    ds_read_b64_tr_b16 a[198:199], v243 offset:35072
    ds_read_b64_tr_b16 a[224:225], v243 offset:32776
    ds_read_b64_tr_b16 a[226:227], v243 offset:33032
    ds_read_b64_tr_b16 a[228:229], v243 offset:34824
    ds_read_b64_tr_b16 a[230:231], v243 offset:35080
    s_waitcnt lgkmcnt(0)
    ds_read_b64_tr_b16 a[200:201], v243 offset:36864
    ds_read_b64_tr_b16 a[202:203], v243 offset:37120
    ds_read_b64_tr_b16 a[204:205], v243 offset:38912
    ds_read_b64_tr_b16 a[206:207], v243 offset:39168
    ds_read_b64_tr_b16 a[232:233], v243 offset:36872
    ds_read_b64_tr_b16 a[234:235], v243 offset:37128
    ds_read_b64_tr_b16 a[236:237], v243 offset:38920
    ds_read_b64_tr_b16 a[238:239], v243 offset:39176
    s_waitcnt lgkmcnt(0)
    ds_read_b64_tr_b16 a[208:209], v243 offset:40960
    ds_read_b64_tr_b16 a[210:211], v243 offset:41216
    ds_read_b64_tr_b16 a[212:213], v243 offset:43008
    ds_read_b64_tr_b16 a[214:215], v243 offset:43264
    ds_read_b64_tr_b16 a[240:241], v243 offset:40968
    ds_read_b64_tr_b16 a[242:243], v243 offset:41224
    ds_read_b64_tr_b16 a[244:245], v243 offset:43016
    ds_read_b64_tr_b16 a[246:247], v243 offset:43272
    s_waitcnt lgkmcnt(0)
    ds_read_b64_tr_b16 a[216:217], v243 offset:45056
    ds_read_b64_tr_b16 a[218:219], v243 offset:45312
    ds_read_b64_tr_b16 a[220:221], v243 offset:47104
    ds_read_b64_tr_b16 a[222:223], v243 offset:47360
    ds_read_b64_tr_b16 a[248:249], v243 offset:45064
    ds_read_b64_tr_b16 a[250:251], v243 offset:45320
    ds_read_b64_tr_b16 a[252:253], v243 offset:47112
    ds_read_b64_tr_b16 a[254:255], v243 offset:47368
    s_waitcnt lgkmcnt(0)
    v_bfe_u32 v249, v0, 1, 1
    v_lshlrev_b32 v249, 4, v249
    v_mov_b32 v250, 0x3f80
    v_lshlrev_b32 v250, v249, v250
    v_bfe_u32 v248, v0, 3, 1
    v_bfe_u32 v249, v0, 4, 1
    v_xor_b32 v249, v249, v248
    v_bfe_u32 v248, v0, 2, 1
    v_lshl_add_u32 v248, v249, 2, v248
    v_and_b32 v249, 1, v0
    v_lshl_add_u32 v248, v249, 1, v248
    v_cmp_eq_u32 vcc, 0, v248
    s_nop 1
    v_cndmask_b32 v252, 0, v250, vcc
    v_cmp_eq_u32 vcc, 1, v248
    s_nop 1
    v_cndmask_b32 v253, 0, v250, vcc
    v_cmp_eq_u32 vcc, 2, v248
    s_nop 1
    v_cndmask_b32 v254, 0, v250, vcc
    v_cmp_eq_u32 vcc, 3, v248
    s_nop 1
    v_cndmask_b32 v255, 0, v250, vcc
    v_mov_b32 v64, 0
    v_mov_b32 v65, 0
    v_mov_b32 v66, 0
    v_mov_b32 v67, 0
    v_mov_b32 v68, 0
    v_mov_b32 v69, 0
    v_mov_b32 v70, 0
    v_mov_b32 v71, 0
    v_mov_b32 v72, 0
    v_mov_b32 v73, 0
    v_mov_b32 v74, 0
    v_mov_b32 v75, 0
    v_mov_b32 v76, 0
    v_mov_b32 v77, 0
    v_mov_b32 v78, 0
    v_mov_b32 v79, 0
    v_mov_b32 v80, 0
    v_mov_b32 v81, 0
    v_mov_b32 v82, 0
    v_mov_b32 v83, 0
    v_mov_b32 v84, 0
    v_mov_b32 v85, 0
    v_mov_b32 v86, 0
    v_mov_b32 v87, 0
    v_mov_b32 v145, 0
    v_mov_b32 v147, 0
    v_mov_b32 v165, 0
    s_bitcmp1_b32 s17, 2
    s_cbranch_scc1 L_cwarme_9
    s_lshr_b32 s20, s17, 3
    s_lshl_b32 s20, s20, 2
    s_and_b32 s21, s17, 3
    s_add_u32 s20, s20, s21
    s_lshl_b32 s21, s16, 4
    s_add_u32 s20, s20, s21
    s_lshl_b32 s20, s20, 12
    v_lshlrev_b32 v34, 4, v0
    s_mov_b32 s12, s82
    s_and_b32 s13, s83, 0xffff
    s_mov_b32 s14, 0x400000
    s_mov_b32 s15, 0x00020000
    s_mov_b32 s56, s64
    s_and_b32 s57, s65, 0xffff
    s_mov_b32 s58, 0x400000
    s_mov_b32 s59, 0x00020000
    buffer_load_dwordx4 v[168:171], v34, s[12:15], s20 offen
    s_add_u32 s20, s20, 0x40000
    buffer_load_dwordx4 v[168:171], v34, s[12:15], s20 offen
    s_add_u32 s20, s20, 0x40000
    buffer_load_dwordx4 v[168:171], v34, s[12:15], s20 offen
    s_add_u32 s20, s20, 0x40000
    buffer_load_dwordx4 v[168:171], v34, s[12:15], s20 offen
    s_add_u32 s20, s20, 0x40000
    buffer_load_dwordx4 v[168:171], v34, s[12:15], s20 offen
    s_add_u32 s20, s20, 0x40000
    buffer_load_dwordx4 v[168:171], v34, s[12:15], s20 offen
    s_add_u32 s20, s20, 0x40000
    buffer_load_dwordx4 v[168:171], v34, s[12:15], s20 offen
    s_add_u32 s20, s20, 0x40000
    buffer_load_dwordx4 v[168:171], v34, s[12:15], s20 offen
    s_add_u32 s20, s20, 0x40000
    buffer_load_dwordx4 v[168:171], v34, s[12:15], s20 offen
    s_add_u32 s20, s20, 0x40000
    buffer_load_dwordx4 v[168:171], v34, s[12:15], s20 offen
    s_add_u32 s20, s20, 0x40000
    buffer_load_dwordx4 v[168:171], v34, s[12:15], s20 offen
    s_add_u32 s20, s20, 0x40000
    buffer_load_dwordx4 v[168:171], v34, s[12:15], s20 offen
    s_add_u32 s20, s20, 0x40000
    buffer_load_dwordx4 v[168:171], v34, s[12:15], s20 offen
    s_add_u32 s20, s20, 0x40000
    buffer_load_dwordx4 v[168:171], v34, s[12:15], s20 offen
    s_add_u32 s20, s20, 0x40000
    buffer_load_dwordx4 v[168:171], v34, s[12:15], s20 offen
    s_add_u32 s20, s20, 0x40000
    buffer_load_dwordx4 v[168:171], v34, s[12:15], s20 offen
    s_add_u32 s20, s20, 0x40000
L_cwarme_9:
    s_mov_b32 s12, s84
    s_and_b32 s13, s85, 0xffff
    s_mov_b32 s14, 0x4000
    s_mov_b32 s15, 0x00020000
    buffer_load_dwordx2 v[168:169], v33, s[12:15], 0 offen
    s_waitcnt vmcnt(0)
    s_mov_b32 s12, s98
    s_and_b32 s13, s99, 0xffff
    s_mov_b32 s14, 0x100
    s_mov_b32 s15, 0x00020000
    s_mov_b32 s19, 0
    s_mov_b32 s53, 1
    s_mov_b32 s43, 24576
    s_add_u32 s54, s100, 0x5900000
    s_addc_u32 s55, s101, 0
    v_mov_b32 v34, 0
L_dw_10:
    buffer_load_dword v35, v34, s[12:15], 0 offen sc1
    s_add_u32 s33, s33, 1
    s_cmp_gt_u32 s33, 0x100000
    s_waitcnt vmcnt(0)
    s_cbranch_scc1 chain_kernel_abort
    v_readfirstlane_b32 s20, v35
    s_and_b32 s22, s20, 0xffff
    s_cmp_ge_u32 s22, 256
    s_cbranch_scc1 L_dwok_11
    s_sleep 2
    s_branch L_dw_10
L_dwok_11:
    s_lshr_b32 s21, s20, 16
    s_cmp_gt_u32 s21, 16
    s_cselect_b32 s21, 0x2000, 0x0
    s_add_u32 s35, s100, 0x1fffff
    s_and_b32 s35, s35, 0xffe00000
    s_sub_u32 s52, s35, s100
    s_add_u32 s35, s52, s21
    s_xor_b32 s21, s21, 0x2000
    s_add_u32 s52, s52, s21
    buffer_load_dword v35, v34, s[12:15], 0 offen offset:8 sc1
    s_waitcnt vmcnt(0)
    v_readfirstlane_b32 s32, v35
    s_mov_b32 s31, s35
    s_cmp_lg_u32 s18, 3
    s_cbranch_scc1 L_init3_12
    s_lshl_b32 s21, s19, 7
    s_add_u32 s21, s21, 0x5900000
    v_mov_b32 v34, 0
L_dw_13:
    buffer_load_dword v35, v34, s[8:11], s21 offen sc1
    s_add_u32 s33, s33, 1
    s_cmp_gt_u32 s33, 0x100000
    s_waitcnt vmcnt(0)
    s_cbranch_scc1 chain_kernel_abort
    v_readfirstlane_b32 s20, v35
    s_cmp_ge_u32 s20, 64
    s_cbranch_scc1 L_dwok_14
    s_sleep 2
    s_branch L_dw_13
L_dwok_14:
    s_add_u32 m0, s43, 0
    s_nop 0
    buffer_load_dwordx4 v27, s[8:11], s31 offen offset:0 lds
    s_add_u32 m0, s43, 896
    s_nop 0
    buffer_load_dwordx4 v27, s[8:11], s31 offen offset:128 lds
    s_add_u32 m0, s43, 0
    s_nop 0
    buffer_load_dwordx4 v29, s[8:11], s31 offen offset:2048 lds
    s_add_u32 m0, s43, 960
    s_nop 0
    buffer_load_dwordx4 v29, s[8:11], s31 offen offset:2112 lds
    s_xor_b32 s43, s43, 4096
    s_waitcnt vmcnt(0)
L_init3_12:
    s_and_b32 s20, s19, 3
    s_lshl_b32 s21, s20, 16
    s_add_u32 s38, s36, s21
    s_add_u32 s41, s38, 0x140000
    s_lshl_b32 s21, s20, 18
    s_add_u32 s40, s37, s21
    s_add_u32 s42, s31, 0x8000000
    s_add_u32 s21, s19, 1
    s_bitcmp1_b32 s21, 1
    s_cselect_b32 s31, s52, s35
    s_lshl_b32 s21, s21, 20
    s_add_u32 s31, s31, s21
    s_add_u32 s20, s20, 1
    s_and_b32 s20, s20, 3
    s_lshl_b32 s20, s20, 16
    s_add_u32 s39, s36, s20
    s_cmp_lg_u32 s18, 0
    s_cbranch_scc1 L_init_15
    v_cmp_eq_u32 vcc, s34, v168
    s_nop 1
    v_cndmask_b32 v168, v168, -1, vcc
    v_cmp_eq_u32 vcc, s34, v169
    s_nop 1
    v_cndmask_b32 v169, v169, -1, vcc
    buffer_store_dwordx2 v[168:169], v8, s[8:11], s38 offen sc1
    s_xor_b32 s43, s43, 4096
    s_setprio 3
L_init_15:
    s_barrier
    s_cmp_lg_u32 s32, 0
    s_cbranch_scc1 L_slow_16
L_step_17:
    s_nop 15
    s_nop 7
L_step_17_nd:
    buffer_load_dwordx4 v[48:51], v2, s[8:11], s38 offen sc1
    v_mov_b32 v88, 0
    v_mov_b32 v89, 0
    v_mov_b32 v90, 0
    v_mov_b32 v91, 0
    v_mov_b32 v92, 0
    v_mov_b32 v93, 0
    v_mov_b32 v94, 0
    v_mov_b32 v95, 0
    ds_read_b128 v[116:119], v25
    ds_read_b128 v[120:123], v25 offset:1024
    v_xor_b32 v25, 0x1000, v25
    s_nop 0
    buffer_load_dwordx4 v[52:55], v3, s[8:11], s38 offen sc1
    s_nop 11
    buffer_load_dwordx4 v[56:59], v4, s[8:11], s38 offen sc1
    s_nop 11
    buffer_load_dwordx4 v[60:63], v5, s[8:11], s38 offen sc1
    s_waitcnt vmcnt(3)
    v_max3_u32 v7, v48, v49, v50
    v_max_u32 v7, v7, v51
    v_cmp_eq_u32 vcc, s34, v7
    s_cbranch_vccnz L_q_a_24
L_v_a_25:
    v_smfmac_f32_16x16x64_bf16 v[64:67], v[48:51], a[0:7], v6
    s_waitcnt vmcnt(2)
    v_max3_u32 v7, v52, v53, v54
    v_max_u32 v7, v7, v55
    v_smfmac_f32_16x16x64_bf16 v[68:71], v[48:51], a[64:71], v6
    v_cmp_eq_u32 vcc, s34, v7
    v_smfmac_f32_16x16x64_bf16 v[72:75], v[48:51], a[32:39], v6
    v_smfmac_f32_16x16x64_bf16 v[76:79], v[48:51], a[96:103], v6
    s_cbranch_vccnz L_q_a_26
L_v_a_27:
    v_smfmac_f32_16x16x64_bf16 v[64:67], v[52:55], a[8:15], v6
    s_waitcnt vmcnt(1)
    v_max3_u32 v7, v56, v57, v58
    v_max_u32 v7, v7, v59
    v_smfmac_f32_16x16x64_bf16 v[68:71], v[52:55], a[72:79], v6
    v_cmp_eq_u32 vcc, s34, v7
    v_smfmac_f32_16x16x64_bf16 v[72:75], v[52:55], a[40:47], v6
    v_smfmac_f32_16x16x64_bf16 v[76:79], v[52:55], a[104:111], v6
    s_cbranch_vccnz L_q_a_28
L_v_a_29:
    v_smfmac_f32_16x16x64_bf16 v[64:67], v[56:59], a[16:23], v6
    s_waitcnt vmcnt(0)
    v_max3_u32 v7, v60, v61, v62
    v_max_u32 v7, v7, v63
    v_smfmac_f32_16x16x64_bf16 v[68:71], v[56:59], a[80:87], v6
    v_cmp_eq_u32 vcc, s34, v7
    v_smfmac_f32_16x16x64_bf16 v[72:75], v[56:59], a[48:55], v6
    v_smfmac_f32_16x16x64_bf16 v[76:79], v[56:59], a[112:119], v6
    s_cbranch_vccnz L_q_a_30
L_v_a_31:
    v_smfmac_f32_16x16x64_bf16 v[64:67], v[60:63], a[24:31], v6
    v_smfmac_f32_16x16x64_bf16 v[68:71], v[60:63], a[88:95], v6
    v_smfmac_f32_16x16x64_bf16 v[72:75], v[60:63], a[56:63], v6
    v_smfmac_f32_16x16x64_bf16 v[76:79], v[60:63], a[120:127], v6
L_gd_a_23:
    v_cvt_pk_bf16_f32 v96, v64, v65
    v_cvt_pk_bf16_f32 v97, v66, v67
    v_cvt_pk_bf16_f32 v98, v68, v69
    v_cvt_pk_bf16_f32 v99, v70, v71
    s_cmp_lg_u32 s18, 0
    v_cvt_pk_bf16_f32 v100, v72, v73
    v_mfma_f32_16x16x32_bf16 v[104:107], v[96:99], v[40:43], 0
    v_cvt_pk_bf16_f32 v101, v74, v75
    v_cvt_pk_bf16_f32 v102, v76, v77
    v_cvt_pk_bf16_f32 v103, v78, v79
    s_nop 1
    v_mfma_f32_16x16x32_bf16 v[108:111], v[100:103], v[40:43], 0
    s_cbranch_scc0 L_help1_18_w0
    s_nop 0
    ds_write_b128 v20, v[104:107]
    s_nop 4
    ds_write_b128 v20, v[108:111] offset:1024
    s_waitcnt lgkmcnt(0)
    s_barrier
    v_smfmac_f32_16x16x64_bf16 v[80:83], v[48:51], a[128:135], v6
    v_smfmac_f32_16x16x64_bf16 v[84:87], v[48:51], a[160:167], v6
    v_smfmac_f32_16x16x64_bf16 v[80:83], v[52:55], a[136:143], v6
    v_smfmac_f32_16x16x64_bf16 v[84:87], v[52:55], a[168:175], v6
    v_smfmac_f32_16x16x64_bf16 v[80:83], v[56:59], a[144:151], v6
    v_smfmac_f32_16x16x64_bf16 v[84:87], v[56:59], a[176:183], v6
    v_smfmac_f32_16x16x64_bf16 v[80:83], v[60:63], a[152:159], v6
    v_smfmac_f32_16x16x64_bf16 v[84:87], v[60:63], a[184:191], v6
    s_nop 4
    ds_write_b128 v21, v[80:83]
    s_nop 1
    ds_write_b128 v21, v[84:87] offset:512
    s_waitcnt lgkmcnt(0)
L_bar2b_116_2:
    s_barrier
    s_cmp_eq_u32 s18, 1
    s_cbranch_scc1 L_vred_115
L_bar2b_116:
    s_waitcnt lgkmcnt(0)
    s_barrier
    s_cmp_eq_u32 s19, 63
    s_cbranch_scc1 L_fin_22
    s_cmp_lg_u32 s18, 2
    s_cbranch_scc1 L_poe_117
    s_sub_u32 s20, s19, 1
    s_and_b32 s20, s20, 3
    s_lshl_b32 s21, s20, 16
    s_add_u32 s21, s21, s36
    s_add_u32 s22, s21, 0x140000
    s_lshl_b32 s23, s20, 18
    s_add_u32 s23, s23, s37
    buffer_store_dwordx2 v[36:37], v8, s[8:11], s21 offen
    buffer_store_dwordx2 v[36:37], v28, s[8:11], s22 offen
    buffer_store_dwordx4 v[36:39], v9, s[8:11], s23 offen
    s_mov_b64 exec, s[28:29]
    buffer_store_dwordx4 v[36:39], v10, s[8:11], s23 offen
    s_mov_b64 exec, -1
L_poe_117:
    s_cmp_lg_u32 s18, 3
    s_cbranch_scc1 L_bar3_19
    s_cmp_ge_u32 s19, 2
    s_cbranch_scc1 L_gated_118
    s_add_u32 s23, s19, 1
    s_lshl_b32 s21, s23, 7
    s_add_u32 s21, s21, 0x5900000
    v_mov_b32 v34, 0
L_dw_119:
    buffer_load_dword v35, v34, s[8:11], s21 offen sc1
    s_add_u32 s33, s33, 1
    s_cmp_gt_u32 s33, 0x100000
    s_waitcnt vmcnt(0)
    s_cbranch_scc1 chain_kernel_abort
    v_readfirstlane_b32 s20, v35
    s_cmp_ge_u32 s20, 64
    s_cbranch_scc1 L_dwok_120
    s_sleep 2
    s_branch L_dw_119
L_dwok_120:
L_gated_118:
    s_add_u32 m0, s43, 0
    s_nop 0
    buffer_load_dwordx4 v27, s[8:11], s31 offen offset:0 lds
    s_add_u32 m0, s43, 896
    s_nop 0
    buffer_load_dwordx4 v27, s[8:11], s31 offen offset:128 lds
    s_add_u32 m0, s43, 0
    s_nop 0
    buffer_load_dwordx4 v29, s[8:11], s31 offen offset:2048 lds
    s_add_u32 m0, s43, 960
    s_nop 0
    buffer_load_dwordx4 v29, s[8:11], s31 offen offset:2112 lds
    s_xor_b32 s43, s43, 4096
    s_branch L_bar3_19
L_vred_115:
    ds_read_b64 v[168:169], v22 offset:0
    ds_read_b64 v[170:171], v22 offset:512
    ds_read_b64 v[172:173], v22 offset:1024
    ds_read_b64 v[174:175], v22 offset:1536
    ds_read_b64 v[176:177], v22 offset:2048
    ds_read_b64 v[178:179], v22 offset:2560
    ds_read_b64 v[180:181], v22 offset:3072
    ds_read_b64 v[182:183], v22 offset:3584
    ds_read_b64 v[184:185], v22 offset:4096
    ds_read_b64 v[186:187], v22 offset:4608
    ds_read_b64 v[188:189], v22 offset:5120
    ds_read_b64 v[190:191], v22 offset:5632
    ds_read_b64 v[192:193], v22 offset:6144
    ds_read_b64 v[194:195], v22 offset:6656
    ds_read_b64 v[196:197], v22 offset:7168
    s_waitcnt lgkmcnt(11)
    ds_read_b64 v[198:199], v22 offset:7680
    s_waitcnt lgkmcnt(8)
    v_pk_add_f32 v[168:169], v[168:169], v[172:173]
    v_pk_add_f32 v[170:171], v[170:171], v[174:175]
    v_pk_add_f32 v[176:177], v[176:177], v[180:181]
    v_pk_add_f32 v[178:179], v[178:179], v[182:183]
    v_pk_add_f32 v[168:169], v[168:169], v[176:177]
    v_pk_add_f32 v[170:171], v[170:171], v[178:179]
    s_waitcnt lgkmcnt(0)
    v_pk_add_f32 v[184:185], v[184:185], v[188:189]
    v_pk_add_f32 v[186:187], v[186:187], v[190:191]
    v_pk_add_f32 v[192:193], v[192:193], v[196:197]
    v_pk_add_f32 v[194:195], v[194:195], v[198:199]
    v_pk_add_f32 v[168:169], v[168:169], v[184:185]
    v_pk_add_f32 v[170:171], v[170:171], v[186:187]
    v_pk_add_f32 v[168:169], v[168:169], v[192:193]
    v_pk_add_f32 v[170:171], v[170:171], v[194:195]
    v_cvt_pk_bf16_f32 v144, v168, v169
    v_cvt_pk_bf16_f32 v146, v170, v171
    ds_write2_b32 v32, v144, v146 offset0:0 offset1:16
    s_branch L_bar2b_116
L_help1_18_w0:
    v_smfmac_f32_16x16x64_bf16 v[80:83], v[48:51], a[128:135], v6
    v_smfmac_f32_16x16x64_bf16 v[84:87], v[48:51], a[160:167], v6
    v_smfmac_f32_16x16x64_bf16 v[80:83], v[52:55], a[136:143], v6
    v_smfmac_f32_16x16x64_bf16 v[84:87], v[52:55], a[168:175], v6
    v_smfmac_f32_16x16x64_bf16 v[80:83], v[56:59], a[144:151], v6
    v_smfmac_f32_16x16x64_bf16 v[84:87], v[56:59], a[176:183], v6
    v_smfmac_f32_16x16x64_bf16 v[80:83], v[60:63], a[152:159], v6
    v_smfmac_f32_16x16x64_bf16 v[84:87], v[60:63], a[184:191], v6
    s_nop 4
    ds_write_b128 v21, v[80:83]
    s_nop 1
    ds_write_b128 v21, v[84:87] offset:512
    s_barrier
    ds_read_b128 v[168:171], v1 offset:2048
    ds_read_b128 v[172:175], v1 offset:3072
    ds_read_b128 v[176:179], v1 offset:4096
    ds_read_b128 v[180:183], v1 offset:5120
    ds_read_b128 v[184:187], v1 offset:6144
    ds_read_b128 v[188:191], v1 offset:7168
    s_waitcnt lgkmcnt(4)
    v_pk_add_f32 v[104:105], v[104:105], v[168:169]
    v_pk_add_f32 v[106:107], v[106:107], v[170:171]
    v_pk_add_f32 v[108:109], v[108:109], v[172:173]
    v_pk_add_f32 v[110:111], v[110:111], v[174:175]
    s_waitcnt lgkmcnt(2)
    v_pk_add_f32 v[104:105], v[104:105], v[176:177]
    v_pk_add_f32 v[106:107], v[106:107], v[178:179]
    v_pk_add_f32 v[108:109], v[108:109], v[180:181]
    v_pk_add_f32 v[110:111], v[110:111], v[182:183]
    s_waitcnt lgkmcnt(0)
    v_pk_add_f32 v[104:105], v[104:105], v[184:185]
    v_pk_add_f32 v[106:107], v[106:107], v[186:187]
    v_pk_add_f32 v[108:109], v[108:109], v[188:189]
    v_pk_add_f32 v[110:111], v[110:111], v[190:191]
    v_cvt_pk_bf16_f32 v112, v104, v105
    v_cvt_pk_bf16_f32 v113, v106, v107
    v_cvt_pk_bf16_f32 v114, v108, v109
    v_cvt_pk_bf16_f32 v115, v110, v111
    s_mov_b64 exec, s[28:29]
    s_nop 0
    v_mfma_f32_16x16x32_bf16 v[132:135], v[112:115], v[112:115], 0
    v_mfma_f32_16x16x32_bf16 v[124:127], v[116:119], v[112:115], 0
    v_mfma_f32_16x16x32_bf16 v[128:131], v[120:123], v[112:115], 0
    s_nop 3
    buffer_store_dwordx4 v[132:135], v10, s[8:11], s40 offen
    s_mov_b64 exec, s[24:25]
    buffer_store_dwordx4 v[124:127], v9, s[8:11], s40 offen
    s_nop 0
    buffer_store_dwordx4 v[128:131], v9, s[8:11], s40 offen offset:128
    s_mov_b64 exec, -1
    ds_write_b128 v1, v[112:115] offset:32768
    ds_read_b128 v[136:139], v26 offset:0
    ds_read_b128 v[140:143], v26 offset:1024
    v_mov_b32_dpp v124, v128 row_shr:8 row_mask:0xf bank_mask:0xc
    v_mov_b32_dpp v125, v129 row_shr:8 row_mask:0xf bank_mask:0xc
    v_mov_b32_dpp v126, v130 row_shr:8 row_mask:0xf bank_mask:0xc
    v_mov_b32_dpp v127, v131 row_shr:8 row_mask:0xf bank_mask:0xc
    v_xor_b32 v26, 0x1000, v26
    s_cmp_eq_u32 s19, 63
    s_cbranch_scc1 L_bar2b_116_2
    s_nop 11
    buffer_load_dwordx4 v[200:203], v16, s[8:11], s40 offen sc1
    buffer_load_dwordx4 v[204:207], v13, s[8:11], s40 offen sc1
    buffer_load_dwordx4 v[208:211], v14, s[8:11], s40 offen sc1
    buffer_load_dwordx4 v[212:215], v15, s[8:11], s40 offen sc1
    s_barrier
    s_nop 15
    s_nop 13
    buffer_load_dwordx4 v[216:219], v16, s[8:11], s40 offen sc1
    buffer_load_dwordx4 v[220:223], v13, s[8:11], s40 offen sc1
    buffer_load_dwordx4 v[224:227], v14, s[8:11], s40 offen sc1
    buffer_load_dwordx4 v[228:231], v15, s[8:11], s40 offen sc1
    s_waitcnt vmcnt(7)
    v_permlane32_swap_b32 v200, v202
    v_permlane32_swap_b32 v201, v203
    s_waitcnt vmcnt(6)
    v_pk_add_f32 v[154:155], v[200:201], v[202:203]
    v_pk_add_f32 v[148:149], v[124:125], v[204:205]
    v_pk_add_f32 v[150:151], v[126:127], v[206:207]
    v_permlane16_swap_b32 v154, v155
    s_waitcnt vmcnt(5)
    v_pk_add_f32 v[148:149], v[148:149], v[208:209]
    v_pk_add_f32 v[150:151], v[150:151], v[210:211]
    v_add_f32 v152, v154, v155
    s_waitcnt vmcnt(4)
    v_pk_add_f32 v[148:149], v[148:149], v[212:213]
    v_pk_add_f32 v[150:151], v[150:151], v[214:215]
    v_pk_add_f32 v[154:155], v[148:149], v[150:151]
    v_add_f32 v154, v154, v152
    v_cmp_u_f32 vcc, v154, v155
    v_max3_f32 v154, v148, v149, v150
    v_max3_f32 v154, v154, v151, v152
    s_nop 1
    v_max_f32_dpp v154, v154, v154 row_ror:8 row_mask:0xf bank_mask:0xf
    s_cbranch_vccnz L_cf_122
L_chead_124:
    v_mov_b32 v156, v154
    s_waitcnt lgkmcnt(0)
    s_barrier
    v_permlane16_swap_b32 v154, v156
    v_max_f32 v154, v154, v156
    v_mov_b32 v156, v154
    ds_read_b32 v144, v32
    ds_read_b32 v146, v32 offset:64
    v_permlane32_swap_b32 v154, v156
    v_max_f32 v154, v154, v156
    v_mul_f32 v154, s44, v154
    v_fma_f32 v152, v152, s44, -v154
    v_exp_f32 v152, v152
    v_pk_fma_f32 v[148:149], v[148:149], s[44:45], v[154:155] op_sel_hi:[1,1,0] neg_lo:[0,0,1] neg_hi:[0,0,1]
    v_pk_fma_f32 v[150:151], v[150:151], s[44:45], v[154:155] op_sel_hi:[1,1,0] neg_lo:[0,0,1] neg_hi:[0,0,1]
    v_mov_b32_dpp v156, v152 row_ror:8 row_mask:0xf bank_mask:0xf
    v_exp_f32 v148, v148
    v_cvt_pk_bf16_f32 v164, v152, v156
    v_exp_f32 v149, v149
    v_exp_f32 v150, v150
    v_mfma_f32_16x16x16_bf16 v[176:179], v[44:45], v[164:165], 0
    v_exp_f32 v151, v151
    s_waitcnt lgkmcnt(0)
    v_cvt_pk_bf16_f32 v160, v148, v149
    v_mfma_f32_16x16x16_bf16 v[168:171], v[144:145], v[164:165], 0
    v_cvt_pk_bf16_f32 v161, v150, v151
    v_mov_b32_dpp v162, v160 row_ror:8 row_mask:0xf bank_mask:0xf
    v_mfma_f32_16x16x16_bf16 v[172:175], v[146:147], v[164:165], 0
    v_mov_b32_dpp v163, v161 row_ror:8 row_mask:0xf bank_mask:0xf
    s_nop 0
    s_mov_b64 exec, s[24:25]
    v_mfma_f32_16x16x32_bf16 v[176:179], v[44:47], v[160:163], v[176:179]
    v_mfma_f32_16x16x32_bf16 v[168:171], v[136:139], v[160:163], v[168:171]
    v_mfma_f32_16x16x32_bf16 v[172:175], v[140:143], v[160:163], v[172:175]
    s_nop 3
    v_rcp_f32 v176, v176
    s_nop 0
    v_pk_mul_f32 v[168:169], v[168:169], v[176:177] op_sel_hi:[1,0]
    v_pk_mul_f32 v[170:171], v[170:171], v[176:177] op_sel_hi:[1,0]
    v_pk_mul_f32 v[172:173], v[172:173], v[176:177] op_sel_hi:[1,0]
    v_pk_mul_f32 v[174:175], v[174:175], v[176:177] op_sel_hi:[1,0]
    v_cvt_pk_bf16_f32 v180, v168, v169
    v_cvt_pk_bf16_f32 v181, v170, v171
    v_cvt_pk_bf16_f32 v182, v172, v173
    v_cvt_pk_bf16_f32 v183, v174, v175
    buffer_store_dwordx4 v[180:183], v11, s[8:11], s41 offen
    s_mov_b64 exec, -1
    s_barrier
    s_nop 15
    s_nop 3
    s_branch L_bar3_19_e
L_bar3_19:
    s_waitcnt lgkmcnt(0)
    s_barrier
    s_nop 15
    s_nop 7
L_bar3_19_e:
    buffer_load_dwordx4 v[48:51], v2, s[8:11], s41 offen sc1
    v_mov_b32 v64, 0
    v_mov_b32 v65, 0
    v_mov_b32 v66, 0
    v_mov_b32 v67, 0
    v_mov_b32 v68, 0
    v_mov_b32 v69, 0
    v_mov_b32 v70, 0
    v_mov_b32 v71, 0
    v_mov_b32 v72, 0
    v_mov_b32 v73, 0
    v_mov_b32 v74, 0
    v_mov_b32 v75, 0
    buffer_load_dwordx4 v[52:55], v3, s[8:11], s41 offen sc1
    v_mov_b32 v76, 0
    v_mov_b32 v77, 0
    v_mov_b32 v78, 0
    v_mov_b32 v79, 0
    v_mov_b32 v80, 0
    v_mov_b32 v81, 0
    v_mov_b32 v82, 0
    v_mov_b32 v83, 0
    v_mov_b32 v84, 0
    v_mov_b32 v85, 0
    v_mov_b32 v86, 0
    v_mov_b32 v87, 0
    buffer_load_dwordx4 v[56:59], v4, s[8:11], s41 offen sc1
    s_nop 11
    buffer_load_dwordx4 v[60:63], v5, s[8:11], s41 offen sc1
    s_waitcnt vmcnt(3)
    v_max3_u32 v7, v48, v49, v50
    v_max_u32 v7, v7, v51
    v_cmp_eq_u32 vcc, s34, v7
    s_cbranch_vccnz L_q_e_126
L_v_e_127:
    v_smfmac_f32_16x16x64_bf16 v[88:91], v[48:51], a[192:199], v6
    s_waitcnt vmcnt(2)
    v_max3_u32 v7, v52, v53, v54
    v_max_u32 v7, v7, v55
    v_cmp_eq_u32 vcc, s34, v7
    v_smfmac_f32_16x16x64_bf16 v[92:95], v[48:51], a[224:231], v6
    s_cbranch_vccnz L_q_e_128
L_v_e_129:
    v_smfmac_f32_16x16x64_bf16 v[88:91], v[52:55], a[200:207], v6
    s_waitcnt vmcnt(1)
    v_max3_u32 v7, v56, v57, v58
    v_max_u32 v7, v7, v59
    v_cmp_eq_u32 vcc, s34, v7
    v_smfmac_f32_16x16x64_bf16 v[92:95], v[52:55], a[232:239], v6
    s_cbranch_vccnz L_q_e_130
L_v_e_131:
    v_smfmac_f32_16x16x64_bf16 v[88:91], v[56:59], a[208:215], v6
    s_waitcnt vmcnt(0)
    v_max3_u32 v7, v60, v61, v62
    v_max_u32 v7, v7, v63
    v_cmp_eq_u32 vcc, s34, v7
    v_smfmac_f32_16x16x64_bf16 v[92:95], v[56:59], a[240:247], v6
    s_cbranch_vccnz L_q_e_132
L_v_e_133:
    v_smfmac_f32_16x16x64_bf16 v[88:91], v[60:63], a[216:223], v6
    v_smfmac_f32_16x16x64_bf16 v[92:95], v[60:63], a[248:255], v6
L_gd_e_125:
    s_add_u32 s19, s19, 1
    s_cmp_lg_u32 s18, 0
    s_nop 2
    v_cvt_pk_bf16_f32 v96, v88, v89
    v_cvt_pk_bf16_f32 v97, v90, v91
    s_nop 0
    v_cvt_pk_bf16_f32 v98, v92, v93
    v_cvt_pk_bf16_f32 v99, v94, v95
    s_nop 1
    v_mfma_f32_16x16x32_bf16 v[104:107], v[96:99], v[252:255], 0
    s_cbranch_scc1 L_help2_20
    s_barrier
    ds_read_b128 v[172:175], v1 offset:18432
    ds_read_b128 v[176:179], v1 offset:20480
    ds_read_b128 v[180:183], v1 offset:22528
    s_waitcnt lgkmcnt(2)
    v_pk_add_f32 v[168:169], v[104:105], v[172:173]
    v_pk_add_f32 v[170:171], v[106:107], v[174:175]
    s_waitcnt lgkmcnt(1)
    v_pk_add_f32 v[168:169], v[168:169], v[176:177]
    v_pk_add_f32 v[170:171], v[170:171], v[178:179]
    s_waitcnt lgkmcnt(0)
    v_pk_add_f32 v[168:169], v[168:169], v[180:181]
    v_pk_add_f32 v[170:171], v[170:171], v[182:183]
    v_cvt_pk_bf16_f32 v96, v168, v169
    v_cvt_pk_bf16_f32 v97, v170, v171
    buffer_store_dwordx2 v[96:97], v12, s[8:11], s42 offen offset:0 sc1
    buffer_store_dwordx2 v[96:97], v12, s[8:11], s42 offen offset:512 sc1
    s_mov_b32 s22, s42
    s_mov_b32 s23, s39
    s_and_b32 s20, s19, 3
    s_lshl_b32 s21, s20, 16
    s_add_u32 s38, s36, s21
    s_add_u32 s41, s38, 0x140000
    s_lshl_b32 s21, s20, 18
    s_add_u32 s40, s37, s21
    s_add_u32 s42, s31, 0x8000000
    s_add_u32 s21, s19, 1
    s_bitcmp1_b32 s21, 1
    s_cselect_b32 s31, s52, s35
    s_lshl_b32 s21, s21, 20
    s_add_u32 s31, s31, s21
    s_add_u32 s20, s20, 1
    s_and_b32 s20, s20, 3
    s_lshl_b32 s20, s20, 16
    s_add_u32 s39, s36, s20
    s_nop 15
    s_nop 15
    s_nop 15
    buffer_load_dwordx2 v[200:201], v17, s[8:11], s22 offen offset:0 sc1
    buffer_load_dwordx2 v[202:203], v18, s[8:11], s22 offen offset:0 sc1
    buffer_load_dwordx2 v[204:205], v19, s[8:11], s22 offen offset:0 sc1
    s_nop 15
    s_nop 15
    s_nop 15
    s_nop 11
    buffer_load_dwordx2 v[212:213], v17, s[8:11], s22 offen offset:512 sc1
    buffer_load_dwordx2 v[214:215], v18, s[8:11], s22 offen offset:512 sc1
    buffer_load_dwordx2 v[216:217], v19, s[8:11], s22 offen offset:512 sc1
    ds_read_b128 v[172:175], v1 offset:33792
    s_mov_b64 exec, s[26:27]
    s_waitcnt lgkmcnt(1)
    buffer_store_dwordx4 v[112:115], v30, s[8:11], s22 offen offset:3072 sc1
    s_mov_b64 exec, s[48:49]
    s_waitcnt lgkmcnt(0)
    buffer_store_dwordx4 v[172:175], v31, s[8:11], s22 offen offset:3584 sc1
    s_mov_b64 exec, -1
    s_waitcnt vmcnt(7)
    v_lshlrev_b32 v100, 16, v200
    v_and_b32 v101, 0xffff0000, v200
    v_lshlrev_b32 v102, 16, v201
    v_and_b32 v103, 0xffff0000, v201
    v_pk_add_f32 v[148:149], v[168:169], v[100:101]
    v_pk_add_f32 v[150:151], v[170:171], v[102:103]
    s_waitcnt vmcnt(6)
    v_lshlrev_b32 v100, 16, v202
    v_and_b32 v101, 0xffff0000, v202
    v_lshlrev_b32 v102, 16, v203
    v_and_b32 v103, 0xffff0000, v203
    v_pk_add_f32 v[148:149], v[148:149], v[100:101]
    v_pk_add_f32 v[150:151], v[150:151], v[102:103]
    s_waitcnt vmcnt(5)
    v_lshlrev_b32 v100, 16, v204
    v_and_b32 v101, 0xffff0000, v204
    v_lshlrev_b32 v102, 16, v205
    v_and_b32 v103, 0xffff0000, v205
    v_pk_add_f32 v[148:149], v[148:149], v[100:101]
    v_pk_add_f32 v[150:151], v[150:151], v[102:103]
    v_cmp_u_f32 vcc, v148, v150
    v_cvt_pk_bf16_f32 v180, v148, v149
    v_cvt_pk_bf16_f32 v181, v150, v151
    s_cbranch_vccnz L_gf_217
L_gok_218:
    buffer_store_dwordx2 v[180:181], v8, s[8:11], s23 offen
    s_barrier
    s_branch L_step_17
L_help2_20:
    s_nop 2
    ds_write_b128 v20, v[104:107] offset:16384
    s_waitcnt lgkmcnt(0)
    s_barrier
    s_and_b32 s20, s19, 3
    s_lshl_b32 s21, s20, 16
    s_add_u32 s38, s36, s21
    s_add_u32 s41, s38, 0x140000
    s_lshl_b32 s21, s20, 18
    s_add_u32 s40, s37, s21
    s_add_u32 s42, s31, 0x8000000
    s_add_u32 s21, s19, 1
    s_bitcmp1_b32 s21, 1
    s_cselect_b32 s31, s52, s35
    s_lshl_b32 s21, s21, 20
    s_add_u32 s31, s31, s21
    s_add_u32 s20, s20, 1
    s_and_b32 s20, s20, 3
    s_lshl_b32 s20, s20, 16
    s_add_u32 s39, s36, s20
    s_cmp_eq_u32 s18, 3
    s_cbranch_scc1 L_w3_221
    s_xor_b32 s20, s18, 2
    s_or_b32 s20, s20, s16
    s_or_b32 s20, s20, s17
    s_cbranch_scc1 L_bar4_21
    s_cmp_lt_u32 s19, 3
    s_cbranch_scc1 L_bar4_21
    s_atomic_add s53, s[98:99], 0x4
    s_branch L_bar4_21
L_w3_221:
    s_or_b32 s20, s16, s17
    s_cbranch_scc1 L_bar4_21
    s_add_u32 s23, s19, 2
    s_min_u32 s23, s23, 63
    s_lshl_b32 s21, s23, 7
    v_mov_b32 v34, 0
L_dw_222:
    s_load_dword s20, s[54:55], s21 glc
    s_add_u32 s33, s33, 1
    s_cmp_gt_u32 s33, 0x100000
    s_waitcnt lgkmcnt(0)
    s_cbranch_scc1 chain_kernel_abort
    s_cmp_ge_u32 s20, 64
    s_cbranch_scc1 L_dwok_223
    s_sleep 2
    s_branch L_dw_222
L_dwok_223:
L_bar4_21:
    s_barrier
    s_branch L_step_17
L_fin_22:
    s_cmp_lg_u32 s18, 2
    s_cbranch_scc1 chain_kernel_done
    ds_read_b128 v[168:171], v1 offset:32768
    ds_read_b128 v[172:175], v1 offset:33792
    s_mov_b64 exec, s[26:27]
    s_waitcnt lgkmcnt(1)
    buffer_store_dwordx4 v[168:171], v30, s[8:11], s42 offen offset:3072 sc1
    s_mov_b64 exec, s[48:49]
    s_waitcnt lgkmcnt(0)
    buffer_store_dwordx4 v[172:175], v31, s[8:11], s42 offen offset:3584 sc1
    s_mov_b64 exec, -1
    s_branch chain_kernel_done
L_q_a_30:
    buffer_load_dwordx4 v[60:63], v5, s[8:11], s38 offen sc1
    s_waitcnt vmcnt(0)
    v_max3_u32 v7, v60, v61, v62
    v_max_u32 v7, v7, v63
    v_cmp_eq_u32 vcc, s34, v7
    s_cbranch_vccnz L_q_a_32
    s_branch L_v_a_31
L_q_a_32:
    buffer_load_dwordx4 v[60:63], v5, s[8:11], s38 offen sc1
    s_waitcnt vmcnt(2)
    v_max3_u32 v7, v60, v61, v62
    v_max_u32 v7, v7, v63
    v_cmp_eq_u32 vcc, s34, v7
    s_cbranch_vccz L_ok_a_33
    s_add_u32 s33, s33, 1
    s_cmp_gt_u32 s33, 0x100000
    s_cbranch_scc0 L_q_a_32
    s_branch chain_kernel_abort
L_ok_a_33:
    v_smfmac_f32_16x16x64_bf16 v[64:67], v[60:63], a[24:31], v6
    v_smfmac_f32_16x16x64_bf16 v[68:71], v[60:63], a[88:95], v6
    v_smfmac_f32_16x16x64_bf16 v[72:75], v[60:63], a[56:63], v6
    v_smfmac_f32_16x16x64_bf16 v[76:79], v[60:63], a[120:127], v6
    s_branch L_gd_a_23
L_q_a_28:
    buffer_load_dwordx4 v[56:59], v4, s[8:11], s38 offen sc1
    s_waitcnt vmcnt(1)
    v_max3_u32 v7, v60, v61, v62
    v_max_u32 v7, v7, v63
    v_cmp_eq_u32 vcc, s34, v7
    s_cbranch_vccnz L_q_a_34
L_v_a_35:
    v_smfmac_f32_16x16x64_bf16 v[64:67], v[60:63], a[24:31], v6
    s_waitcnt vmcnt(0)
    v_max3_u32 v7, v56, v57, v58
    v_max_u32 v7, v7, v59
    v_smfmac_f32_16x16x64_bf16 v[68:71], v[60:63], a[88:95], v6
    v_cmp_eq_u32 vcc, s34, v7
    v_smfmac_f32_16x16x64_bf16 v[72:75], v[60:63], a[56:63], v6
    v_smfmac_f32_16x16x64_bf16 v[76:79], v[60:63], a[120:127], v6
    s_cbranch_vccnz L_q_a_36
L_v_a_37:
    v_smfmac_f32_16x16x64_bf16 v[64:67], v[56:59], a[16:23], v6
    v_smfmac_f32_16x16x64_bf16 v[68:71], v[56:59], a[80:87], v6
    v_smfmac_f32_16x16x64_bf16 v[72:75], v[56:59], a[48:55], v6
    v_smfmac_f32_16x16x64_bf16 v[76:79], v[56:59], a[112:119], v6
    s_branch L_gd_a_23
L_q_a_36:
    buffer_load_dwordx4 v[56:59], v4, s[8:11], s38 offen sc1
    s_waitcnt vmcnt(2)
    v_max3_u32 v7, v56, v57, v58
    v_max_u32 v7, v7, v59
    v_cmp_eq_u32 vcc, s34, v7
    s_cbranch_vccz L_ok_a_38
    s_add_u32 s33, s33, 1
    s_cmp_gt_u32 s33, 0x100000
    s_cbranch_scc0 L_q_a_36
    s_branch chain_kernel_abort
L_ok_a_38:
    v_smfmac_f32_16x16x64_bf16 v[64:67], v[56:59], a[16:23], v6
    v_smfmac_f32_16x16x64_bf16 v[68:71], v[56:59], a[80:87], v6
    v_smfmac_f32_16x16x64_bf16 v[72:75], v[56:59], a[48:55], v6
    v_smfmac_f32_16x16x64_bf16 v[76:79], v[56:59], a[112:119], v6
    s_branch L_gd_a_23
L_q_a_34:
    buffer_load_dwordx4 v[60:63], v5, s[8:11], s38 offen sc1
    s_waitcnt vmcnt(1)
    v_max3_u32 v7, v56, v57, v58
    v_max_u32 v7, v7, v59
    v_cmp_eq_u32 vcc, s34, v7
    s_cbranch_vccnz L_q_a_39
L_v_a_40:
    v_smfmac_f32_16x16x64_bf16 v[64:67], v[56:59], a[16:23], v6
    s_waitcnt vmcnt(0)
    v_max3_u32 v7, v60, v61, v62
    v_max_u32 v7, v7, v63
    v_smfmac_f32_16x16x64_bf16 v[68:71], v[56:59], a[80:87], v6
    v_cmp_eq_u32 vcc, s34, v7
    v_smfmac_f32_16x16x64_bf16 v[72:75], v[56:59], a[48:55], v6
    v_smfmac_f32_16x16x64_bf16 v[76:79], v[56:59], a[112:119], v6
    s_cbranch_vccnz L_q_a_32
    s_branch L_v_a_31
L_q_a_39:
    buffer_load_dwordx4 v[56:59], v4, s[8:11], s38 offen sc1
    s_waitcnt vmcnt(2)
    v_max3_u32 v7, v60, v61, v62
    v_max_u32 v7, v7, v63
    v_cmp_eq_u32 vcc, s34, v7
    s_cbranch_vccz L_ok_a_41
    buffer_load_dwordx4 v[60:63], v5, s[8:11], s38 offen sc1
    s_waitcnt vmcnt(2)
    v_max3_u32 v7, v56, v57, v58
    v_max_u32 v7, v7, v59
    v_cmp_eq_u32 vcc, s34, v7
    s_cbranch_vccz L_ok_a_42
    s_add_u32 s33, s33, 1
    s_cmp_gt_u32 s33, 0x100000
    s_cbranch_scc0 L_q_a_39
    s_branch chain_kernel_abort
L_ok_a_41:
    v_smfmac_f32_16x16x64_bf16 v[64:67], v[60:63], a[24:31], v6
    v_smfmac_f32_16x16x64_bf16 v[68:71], v[60:63], a[88:95], v6
    v_smfmac_f32_16x16x64_bf16 v[72:75], v[60:63], a[56:63], v6
    v_smfmac_f32_16x16x64_bf16 v[76:79], v[60:63], a[120:127], v6
    s_branch L_q_a_36
L_ok_a_42:
    v_smfmac_f32_16x16x64_bf16 v[64:67], v[56:59], a[16:23], v6
    v_smfmac_f32_16x16x64_bf16 v[68:71], v[56:59], a[80:87], v6
    v_smfmac_f32_16x16x64_bf16 v[72:75], v[56:59], a[48:55], v6
    v_smfmac_f32_16x16x64_bf16 v[76:79], v[56:59], a[112:119], v6
    s_branch L_q_a_32
L_q_a_26:
    buffer_load_dwordx4 v[52:55], v3, s[8:11], s38 offen sc1
    s_waitcnt vmcnt(2)
    v_max3_u32 v7, v56, v57, v58
    v_max_u32 v7, v7, v59
    v_cmp_eq_u32 vcc, s34, v7
    s_cbranch_vccnz L_q_a_43
L_v_a_44:
    v_smfmac_f32_16x16x64_bf16 v[64:67], v[56:59], a[16:23], v6
    s_waitcnt vmcnt(1)
    v_max3_u32 v7, v60, v61, v62
    v_max_u32 v7, v7, v63
    v_smfmac_f32_16x16x64_bf16 v[68:71], v[56:59], a[80:87], v6
    v_cmp_eq_u32 vcc, s34, v7
    v_smfmac_f32_16x16x64_bf16 v[72:75], v[56:59], a[48:55], v6
    v_smfmac_f32_16x16x64_bf16 v[76:79], v[56:59], a[112:119], v6
    s_cbranch_vccnz L_q_a_45
L_v_a_46:
    v_smfmac_f32_16x16x64_bf16 v[64:67], v[60:63], a[24:31], v6
    s_waitcnt vmcnt(0)
    v_max3_u32 v7, v52, v53, v54
    v_max_u32 v7, v7, v55
    v_smfmac_f32_16x16x64_bf16 v[68:71], v[60:63], a[88:95], v6
    v_cmp_eq_u32 vcc, s34, v7
    v_smfmac_f32_16x16x64_bf16 v[72:75], v[60:63], a[56:63], v6
    v_smfmac_f32_16x16x64_bf16 v[76:79], v[60:63], a[120:127], v6
    s_cbranch_vccnz L_q_a_47
L_v_a_48:
    v_smfmac_f32_16x16x64_bf16 v[64:67], v[52:55], a[8:15], v6
    v_smfmac_f32_16x16x64_bf16 v[68:71], v[52:55], a[72:79], v6
    v_smfmac_f32_16x16x64_bf16 v[72:75], v[52:55], a[40:47], v6
    v_smfmac_f32_16x16x64_bf16 v[76:79], v[52:55], a[104:111], v6
    s_branch L_gd_a_23
L_q_a_47:
    buffer_load_dwordx4 v[52:55], v3, s[8:11], s38 offen sc1
    s_waitcnt vmcnt(2)
    v_max3_u32 v7, v52, v53, v54
    v_max_u32 v7, v7, v55
    v_cmp_eq_u32 vcc, s34, v7
    s_cbranch_vccz L_ok_a_49
    s_add_u32 s33, s33, 1
    s_cmp_gt_u32 s33, 0x100000
    s_cbranch_scc0 L_q_a_47
    s_branch chain_kernel_abort
L_ok_a_49:
    v_smfmac_f32_16x16x64_bf16 v[64:67], v[52:55], a[8:15], v6
    v_smfmac_f32_16x16x64_bf16 v[68:71], v[52:55], a[72:79], v6
    v_smfmac_f32_16x16x64_bf16 v[72:75], v[52:55], a[40:47], v6
    v_smfmac_f32_16x16x64_bf16 v[76:79], v[52:55], a[104:111], v6
    s_branch L_gd_a_23
L_q_a_45:
    buffer_load_dwordx4 v[60:63], v5, s[8:11], s38 offen sc1
    s_waitcnt vmcnt(1)
    v_max3_u32 v7, v52, v53, v54
    v_max_u32 v7, v7, v55
    v_cmp_eq_u32 vcc, s34, v7
    s_cbranch_vccnz L_q_a_50
L_v_a_51:
    v_smfmac_f32_16x16x64_bf16 v[64:67], v[52:55], a[8:15], v6
    s_waitcnt vmcnt(0)
    v_max3_u32 v7, v60, v61, v62
    v_max_u32 v7, v7, v63
    v_smfmac_f32_16x16x64_bf16 v[68:71], v[52:55], a[72:79], v6
    v_cmp_eq_u32 vcc, s34, v7
    v_smfmac_f32_16x16x64_bf16 v[72:75], v[52:55], a[40:47], v6
    v_smfmac_f32_16x16x64_bf16 v[76:79], v[52:55], a[104:111], v6
    s_cbranch_vccnz L_q_a_32
    s_branch L_v_a_31
L_q_a_50:
    buffer_load_dwordx4 v[52:55], v3, s[8:11], s38 offen sc1
    s_waitcnt vmcnt(2)
    v_max3_u32 v7, v60, v61, v62
    v_max_u32 v7, v7, v63
    v_cmp_eq_u32 vcc, s34, v7
    s_cbranch_vccz L_ok_a_52
    buffer_load_dwordx4 v[60:63], v5, s[8:11], s38 offen sc1
    s_waitcnt vmcnt(2)
    v_max3_u32 v7, v52, v53, v54
    v_max_u32 v7, v7, v55
    v_cmp_eq_u32 vcc, s34, v7
    s_cbranch_vccz L_ok_a_53
    s_add_u32 s33, s33, 1
    s_cmp_gt_u32 s33, 0x100000
    s_cbranch_scc0 L_q_a_50
    s_branch chain_kernel_abort
L_ok_a_52:
    v_smfmac_f32_16x16x64_bf16 v[64:67], v[60:63], a[24:31], v6
    v_smfmac_f32_16x16x64_bf16 v[68:71], v[60:63], a[88:95], v6
    v_smfmac_f32_16x16x64_bf16 v[72:75], v[60:63], a[56:63], v6
    v_smfmac_f32_16x16x64_bf16 v[76:79], v[60:63], a[120:127], v6
    s_branch L_q_a_47
L_ok_a_53:
    v_smfmac_f32_16x16x64_bf16 v[64:67], v[52:55], a[8:15], v6
    v_smfmac_f32_16x16x64_bf16 v[68:71], v[52:55], a[72:79], v6
    v_smfmac_f32_16x16x64_bf16 v[72:75], v[52:55], a[40:47], v6
    v_smfmac_f32_16x16x64_bf16 v[76:79], v[52:55], a[104:111], v6
    s_branch L_q_a_32
L_q_a_43:
    buffer_load_dwordx4 v[56:59], v4, s[8:11], s38 offen sc1
    s_waitcnt vmcnt(2)
    v_max3_u32 v7, v60, v61, v62
    v_max_u32 v7, v7, v63
    v_cmp_eq_u32 vcc, s34, v7
    s_cbranch_vccnz L_q_a_54
L_v_a_55:
    v_smfmac_f32_16x16x64_bf16 v[64:67], v[60:63], a[24:31], v6
    s_waitcnt vmcnt(1)
    v_max3_u32 v7, v52, v53, v54
    v_max_u32 v7, v7, v55
    v_smfmac_f32_16x16x64_bf16 v[68:71], v[60:63], a[88:95], v6
    v_cmp_eq_u32 vcc, s34, v7
    v_smfmac_f32_16x16x64_bf16 v[72:75], v[60:63], a[56:63], v6
    v_smfmac_f32_16x16x64_bf16 v[76:79], v[60:63], a[120:127], v6
    s_cbranch_vccnz L_q_a_56
L_v_a_57:
    v_smfmac_f32_16x16x64_bf16 v[64:67], v[52:55], a[8:15], v6
    s_waitcnt vmcnt(0)
    v_max3_u32 v7, v56, v57, v58
    v_max_u32 v7, v7, v59
    v_smfmac_f32_16x16x64_bf16 v[68:71], v[52:55], a[72:79], v6
    v_cmp_eq_u32 vcc, s34, v7
    v_smfmac_f32_16x16x64_bf16 v[72:75], v[52:55], a[40:47], v6
    v_smfmac_f32_16x16x64_bf16 v[76:79], v[52:55], a[104:111], v6
    s_cbranch_vccnz L_q_a_36
    s_branch L_v_a_37
L_q_a_56:
    buffer_load_dwordx4 v[52:55], v3, s[8:11], s38 offen sc1
    s_waitcnt vmcnt(2)
    v_max3_u32 v7, v56, v57, v58
    v_max_u32 v7, v7, v59
    v_cmp_eq_u32 vcc, s34, v7
    s_cbranch_vccz L_ok_a_58
    buffer_load_dwordx4 v[56:59], v4, s[8:11], s38 offen sc1
    s_waitcnt vmcnt(2)
    v_max3_u32 v7, v52, v53, v54
    v_max_u32 v7, v7, v55
    v_cmp_eq_u32 vcc, s34, v7
    s_cbranch_vccz L_ok_a_59
    s_add_u32 s33, s33, 1
    s_cmp_gt_u32 s33, 0x100000
    s_cbranch_scc0 L_q_a_56
    s_branch chain_kernel_abort
L_ok_a_58:
    v_smfmac_f32_16x16x64_bf16 v[64:67], v[56:59], a[16:23], v6
    v_smfmac_f32_16x16x64_bf16 v[68:71], v[56:59], a[80:87], v6
    v_smfmac_f32_16x16x64_bf16 v[72:75], v[56:59], a[48:55], v6
    v_smfmac_f32_16x16x64_bf16 v[76:79], v[56:59], a[112:119], v6
    s_branch L_q_a_47
L_ok_a_59:
    v_smfmac_f32_16x16x64_bf16 v[64:67], v[52:55], a[8:15], v6
    v_smfmac_f32_16x16x64_bf16 v[68:71], v[52:55], a[72:79], v6
    v_smfmac_f32_16x16x64_bf16 v[72:75], v[52:55], a[40:47], v6
    v_smfmac_f32_16x16x64_bf16 v[76:79], v[52:55], a[104:111], v6
    s_branch L_q_a_36
L_q_a_54:
    buffer_load_dwordx4 v[60:63], v5, s[8:11], s38 offen sc1
    s_waitcnt vmcnt(2)
    v_max3_u32 v7, v52, v53, v54
    v_max_u32 v7, v7, v55
    v_cmp_eq_u32 vcc, s34, v7
    s_cbranch_vccnz L_q_a_60
L_v_a_61:
    v_smfmac_f32_16x16x64_bf16 v[64:67], v[52:55], a[8:15], v6
    s_waitcnt vmcnt(1)
    v_max3_u32 v7, v56, v57, v58
    v_max_u32 v7, v7, v59
    v_smfmac_f32_16x16x64_bf16 v[68:71], v[52:55], a[72:79], v6
    v_cmp_eq_u32 vcc, s34, v7
    v_smfmac_f32_16x16x64_bf16 v[72:75], v[52:55], a[40:47], v6
    v_smfmac_f32_16x16x64_bf16 v[76:79], v[52:55], a[104:111], v6
    s_cbranch_vccnz L_q_a_39
    s_branch L_v_a_40
L_q_a_60:
    buffer_load_dwordx4 v[52:55], v3, s[8:11], s38 offen sc1
    s_waitcnt vmcnt(2)
    v_max3_u32 v7, v56, v57, v58
    v_max_u32 v7, v7, v59
    v_cmp_eq_u32 vcc, s34, v7
    s_cbranch_vccz L_ok_a_62
    buffer_load_dwordx4 v[56:59], v4, s[8:11], s38 offen sc1
    s_waitcnt vmcnt(2)
    v_max3_u32 v7, v60, v61, v62
    v_max_u32 v7, v7, v63
    v_cmp_eq_u32 vcc, s34, v7
    s_cbranch_vccz L_ok_a_63
    buffer_load_dwordx4 v[60:63], v5, s[8:11], s38 offen sc1
    s_waitcnt vmcnt(2)
    v_max3_u32 v7, v52, v53, v54
    v_max_u32 v7, v7, v55
    v_cmp_eq_u32 vcc, s34, v7
    s_cbranch_vccz L_ok_a_64
    s_add_u32 s33, s33, 1
    s_cmp_gt_u32 s33, 0x100000
    s_cbranch_scc0 L_q_a_60
    s_branch chain_kernel_abort
L_ok_a_62:
    v_smfmac_f32_16x16x64_bf16 v[64:67], v[56:59], a[16:23], v6
    v_smfmac_f32_16x16x64_bf16 v[68:71], v[56:59], a[80:87], v6
    v_smfmac_f32_16x16x64_bf16 v[72:75], v[56:59], a[48:55], v6
    v_smfmac_f32_16x16x64_bf16 v[76:79], v[56:59], a[112:119], v6
    s_branch L_q_a_50
L_ok_a_63:
    v_smfmac_f32_16x16x64_bf16 v[64:67], v[60:63], a[24:31], v6
    v_smfmac_f32_16x16x64_bf16 v[68:71], v[60:63], a[88:95], v6
    v_smfmac_f32_16x16x64_bf16 v[72:75], v[60:63], a[56:63], v6
    v_smfmac_f32_16x16x64_bf16 v[76:79], v[60:63], a[120:127], v6
    s_branch L_q_a_56
L_ok_a_64:
    v_smfmac_f32_16x16x64_bf16 v[64:67], v[52:55], a[8:15], v6
    v_smfmac_f32_16x16x64_bf16 v[68:71], v[52:55], a[72:79], v6
    v_smfmac_f32_16x16x64_bf16 v[72:75], v[52:55], a[40:47], v6
    v_smfmac_f32_16x16x64_bf16 v[76:79], v[52:55], a[104:111], v6
    s_branch L_q_a_39
L_q_a_24:
    buffer_load_dwordx4 v[48:51], v2, s[8:11], s38 offen sc1
    s_waitcnt vmcnt(3)
    v_max3_u32 v7, v52, v53, v54
    v_max_u32 v7, v7, v55
    v_cmp_eq_u32 vcc, s34, v7
    s_cbranch_vccnz L_q_a_65
L_v_a_66:
    v_smfmac_f32_16x16x64_bf16 v[64:67], v[52:55], a[8:15], v6
    s_waitcnt vmcnt(2)
    v_max3_u32 v7, v56, v57, v58
    v_max_u32 v7, v7, v59
    v_smfmac_f32_16x16x64_bf16 v[68:71], v[52:55], a[72:79], v6
    v_cmp_eq_u32 vcc, s34, v7
    v_smfmac_f32_16x16x64_bf16 v[72:75], v[52:55], a[40:47], v6
    v_smfmac_f32_16x16x64_bf16 v[76:79], v[52:55], a[104:111], v6
    s_cbranch_vccnz L_q_a_67
L_v_a_68:
    v_smfmac_f32_16x16x64_bf16 v[64:67], v[56:59], a[16:23], v6
    s_waitcnt vmcnt(1)
    v_max3_u32 v7, v60, v61, v62
    v_max_u32 v7, v7, v63
    v_smfmac_f32_16x16x64_bf16 v[68:71], v[56:59], a[80:87], v6
    v_cmp_eq_u32 vcc, s34, v7
    v_smfmac_f32_16x16x64_bf16 v[72:75], v[56:59], a[48:55], v6
    v_smfmac_f32_16x16x64_bf16 v[76:79], v[56:59], a[112:119], v6
    s_cbranch_vccnz L_q_a_69
L_v_a_70:
    v_smfmac_f32_16x16x64_bf16 v[64:67], v[60:63], a[24:31], v6
    s_waitcnt vmcnt(0)
    v_max3_u32 v7, v48, v49, v50
    v_max_u32 v7, v7, v51
    v_smfmac_f32_16x16x64_bf16 v[68:71], v[60:63], a[88:95], v6
    v_cmp_eq_u32 vcc, s34, v7
    v_smfmac_f32_16x16x64_bf16 v[72:75], v[60:63], a[56:63], v6
    v_smfmac_f32_16x16x64_bf16 v[76:79], v[60:63], a[120:127], v6
    s_cbranch_vccnz L_q_a_71
L_v_a_72:
    v_smfmac_f32_16x16x64_bf16 v[64:67], v[48:51], a[0:7], v6
    v_smfmac_f32_16x16x64_bf16 v[68:71], v[48:51], a[64:71], v6
    v_smfmac_f32_16x16x64_bf16 v[72:75], v[48:51], a[32:39], v6
    v_smfmac_f32_16x16x64_bf16 v[76:79], v[48:51], a[96:103], v6
    s_branch L_gd_a_23
L_q_a_71:
    buffer_load_dwordx4 v[48:51], v2, s[8:11], s38 offen sc1
    s_waitcnt vmcnt(2)
    v_max3_u32 v7, v48, v49, v50
    v_max_u32 v7, v7, v51
    v_cmp_eq_u32 vcc, s34, v7
    s_cbranch_vccz L_ok_a_73
    s_add_u32 s33, s33, 1
    s_cmp_gt_u32 s33, 0x100000
    s_cbranch_scc0 L_q_a_71
    s_branch chain_kernel_abort
L_ok_a_73:
    v_smfmac_f32_16x16x64_bf16 v[64:67], v[48:51], a[0:7], v6
    v_smfmac_f32_16x16x64_bf16 v[68:71], v[48:51], a[64:71], v6
    v_smfmac_f32_16x16x64_bf16 v[72:75], v[48:51], a[32:39], v6
    v_smfmac_f32_16x16x64_bf16 v[76:79], v[48:51], a[96:103], v6
    s_branch L_gd_a_23
L_q_a_69:
    buffer_load_dwordx4 v[60:63], v5, s[8:11], s38 offen sc1
    s_waitcnt vmcnt(1)
    v_max3_u32 v7, v48, v49, v50
    v_max_u32 v7, v7, v51
    v_cmp_eq_u32 vcc, s34, v7
    s_cbranch_vccnz L_q_a_74
L_v_a_75:
    v_smfmac_f32_16x16x64_bf16 v[64:67], v[48:51], a[0:7], v6
    s_waitcnt vmcnt(0)
    v_max3_u32 v7, v60, v61, v62
    v_max_u32 v7, v7, v63
    v_smfmac_f32_16x16x64_bf16 v[68:71], v[48:51], a[64:71], v6
    v_cmp_eq_u32 vcc, s34, v7
    v_smfmac_f32_16x16x64_bf16 v[72:75], v[48:51], a[32:39], v6
    v_smfmac_f32_16x16x64_bf16 v[76:79], v[48:51], a[96:103], v6
    s_cbranch_vccnz L_q_a_32
    s_branch L_v_a_31
L_q_a_74:
    buffer_load_dwordx4 v[48:51], v2, s[8:11], s38 offen sc1
    s_waitcnt vmcnt(2)
    v_max3_u32 v7, v60, v61, v62
    v_max_u32 v7, v7, v63
    v_cmp_eq_u32 vcc, s34, v7
    s_cbranch_vccz L_ok_a_76
    buffer_load_dwordx4 v[60:63], v5, s[8:11], s38 offen sc1
    s_waitcnt vmcnt(2)
    v_max3_u32 v7, v48, v49, v50
    v_max_u32 v7, v7, v51
    v_cmp_eq_u32 vcc, s34, v7
    s_cbranch_vccz L_ok_a_77
    s_add_u32 s33, s33, 1
    s_cmp_gt_u32 s33, 0x100000
    s_cbranch_scc0 L_q_a_74
    s_branch chain_kernel_abort
L_ok_a_76:
    v_smfmac_f32_16x16x64_bf16 v[64:67], v[60:63], a[24:31], v6
    v_smfmac_f32_16x16x64_bf16 v[68:71], v[60:63], a[88:95], v6
    v_smfmac_f32_16x16x64_bf16 v[72:75], v[60:63], a[56:63], v6
    v_smfmac_f32_16x16x64_bf16 v[76:79], v[60:63], a[120:127], v6
    s_branch L_q_a_71
L_ok_a_77:
    v_smfmac_f32_16x16x64_bf16 v[64:67], v[48:51], a[0:7], v6
    v_smfmac_f32_16x16x64_bf16 v[68:71], v[48:51], a[64:71], v6
    v_smfmac_f32_16x16x64_bf16 v[72:75], v[48:51], a[32:39], v6
    v_smfmac_f32_16x16x64_bf16 v[76:79], v[48:51], a[96:103], v6
    s_branch L_q_a_32
L_q_a_67:
    buffer_load_dwordx4 v[56:59], v4, s[8:11], s38 offen sc1
    s_waitcnt vmcnt(2)
    v_max3_u32 v7, v60, v61, v62
    v_max_u32 v7, v7, v63
    v_cmp_eq_u32 vcc, s34, v7
    s_cbranch_vccnz L_q_a_78
L_v_a_79:
    v_smfmac_f32_16x16x64_bf16 v[64:67], v[60:63], a[24:31], v6
    s_waitcnt vmcnt(1)
    v_max3_u32 v7, v48, v49, v50
    v_max_u32 v7, v7, v51
    v_smfmac_f32_16x16x64_bf16 v[68:71], v[60:63], a[88:95], v6
    v_cmp_eq_u32 vcc, s34, v7
    v_smfmac_f32_16x16x64_bf16 v[72:75], v[60:63], a[56:63], v6
    v_smfmac_f32_16x16x64_bf16 v[76:79], v[60:63], a[120:127], v6
    s_cbranch_vccnz L_q_a_80
L_v_a_81:
    v_smfmac_f32_16x16x64_bf16 v[64:67], v[48:51], a[0:7], v6
    s_waitcnt vmcnt(0)
    v_max3_u32 v7, v56, v57, v58
    v_max_u32 v7, v7, v59
    v_smfmac_f32_16x16x64_bf16 v[68:71], v[48:51], a[64:71], v6
    v_cmp_eq_u32 vcc, s34, v7
    v_smfmac_f32_16x16x64_bf16 v[72:75], v[48:51], a[32:39], v6
    v_smfmac_f32_16x16x64_bf16 v[76:79], v[48:51], a[96:103], v6
    s_cbranch_vccnz L_q_a_36
    s_branch L_v_a_37
L_q_a_80:
    buffer_load_dwordx4 v[48:51], v2, s[8:11], s38 offen sc1
    s_waitcnt vmcnt(2)
    v_max3_u32 v7, v56, v57, v58
    v_max_u32 v7, v7, v59
    v_cmp_eq_u32 vcc, s34, v7
    s_cbranch_vccz L_ok_a_82
    buffer_load_dwordx4 v[56:59], v4, s[8:11], s38 offen sc1
    s_waitcnt vmcnt(2)
    v_max3_u32 v7, v48, v49, v50
    v_max_u32 v7, v7, v51
    v_cmp_eq_u32 vcc, s34, v7
    s_cbranch_vccz L_ok_a_83
    s_add_u32 s33, s33, 1
    s_cmp_gt_u32 s33, 0x100000
    s_cbranch_scc0 L_q_a_80
    s_branch chain_kernel_abort
L_ok_a_82:
    v_smfmac_f32_16x16x64_bf16 v[64:67], v[56:59], a[16:23], v6
    v_smfmac_f32_16x16x64_bf16 v[68:71], v[56:59], a[80:87], v6
    v_smfmac_f32_16x16x64_bf16 v[72:75], v[56:59], a[48:55], v6
    v_smfmac_f32_16x16x64_bf16 v[76:79], v[56:59], a[112:119], v6
    s_branch L_q_a_71
L_ok_a_83:
    v_smfmac_f32_16x16x64_bf16 v[64:67], v[48:51], a[0:7], v6
    v_smfmac_f32_16x16x64_bf16 v[68:71], v[48:51], a[64:71], v6
    v_smfmac_f32_16x16x64_bf16 v[72:75], v[48:51], a[32:39], v6
    v_smfmac_f32_16x16x64_bf16 v[76:79], v[48:51], a[96:103], v6
    s_branch L_q_a_36
L_q_a_78:
    buffer_load_dwordx4 v[60:63], v5, s[8:11], s38 offen sc1
    s_waitcnt vmcnt(2)
    v_max3_u32 v7, v48, v49, v50
    v_max_u32 v7, v7, v51
    v_cmp_eq_u32 vcc, s34, v7
    s_cbranch_vccnz L_q_a_84
L_v_a_85:
    v_smfmac_f32_16x16x64_bf16 v[64:67], v[48:51], a[0:7], v6
    s_waitcnt vmcnt(1)
    v_max3_u32 v7, v56, v57, v58
    v_max_u32 v7, v7, v59
    v_smfmac_f32_16x16x64_bf16 v[68:71], v[48:51], a[64:71], v6
    v_cmp_eq_u32 vcc, s34, v7
    v_smfmac_f32_16x16x64_bf16 v[72:75], v[48:51], a[32:39], v6
    v_smfmac_f32_16x16x64_bf16 v[76:79], v[48:51], a[96:103], v6
    s_cbranch_vccnz L_q_a_39
    s_branch L_v_a_40
L_q_a_84:
    buffer_load_dwordx4 v[48:51], v2, s[8:11], s38 offen sc1
    s_waitcnt vmcnt(2)
    v_max3_u32 v7, v56, v57, v58
    v_max_u32 v7, v7, v59
    v_cmp_eq_u32 vcc, s34, v7
    s_cbranch_vccz L_ok_a_86
    buffer_load_dwordx4 v[56:59], v4, s[8:11], s38 offen sc1
    s_waitcnt vmcnt(2)
    v_max3_u32 v7, v60, v61, v62
    v_max_u32 v7, v7, v63
    v_cmp_eq_u32 vcc, s34, v7
    s_cbranch_vccz L_ok_a_87
    buffer_load_dwordx4 v[60:63], v5, s[8:11], s38 offen sc1
    s_waitcnt vmcnt(2)
    v_max3_u32 v7, v48, v49, v50
    v_max_u32 v7, v7, v51
    v_cmp_eq_u32 vcc, s34, v7
    s_cbranch_vccz L_ok_a_88
    s_add_u32 s33, s33, 1
    s_cmp_gt_u32 s33, 0x100000
    s_cbranch_scc0 L_q_a_84
    s_branch chain_kernel_abort
L_ok_a_86:
    v_smfmac_f32_16x16x64_bf16 v[64:67], v[56:59], a[16:23], v6
    v_smfmac_f32_16x16x64_bf16 v[68:71], v[56:59], a[80:87], v6
    v_smfmac_f32_16x16x64_bf16 v[72:75], v[56:59], a[48:55], v6
    v_smfmac_f32_16x16x64_bf16 v[76:79], v[56:59], a[112:119], v6
    s_branch L_q_a_74
L_ok_a_87:
    v_smfmac_f32_16x16x64_bf16 v[64:67], v[60:63], a[24:31], v6
    v_smfmac_f32_16x16x64_bf16 v[68:71], v[60:63], a[88:95], v6
    v_smfmac_f32_16x16x64_bf16 v[72:75], v[60:63], a[56:63], v6
    v_smfmac_f32_16x16x64_bf16 v[76:79], v[60:63], a[120:127], v6
    s_branch L_q_a_80
L_ok_a_88:
    v_smfmac_f32_16x16x64_bf16 v[64:67], v[48:51], a[0:7], v6
    v_smfmac_f32_16x16x64_bf16 v[68:71], v[48:51], a[64:71], v6
    v_smfmac_f32_16x16x64_bf16 v[72:75], v[48:51], a[32:39], v6
    v_smfmac_f32_16x16x64_bf16 v[76:79], v[48:51], a[96:103], v6
    s_branch L_q_a_39
L_q_a_65:
    buffer_load_dwordx4 v[52:55], v3, s[8:11], s38 offen sc1
    s_waitcnt vmcnt(3)
    v_max3_u32 v7, v56, v57, v58
    v_max_u32 v7, v7, v59
    v_cmp_eq_u32 vcc, s34, v7
    s_cbranch_vccnz L_q_a_89
L_v_a_90:
    v_smfmac_f32_16x16x64_bf16 v[64:67], v[56:59], a[16:23], v6
    s_waitcnt vmcnt(2)
    v_max3_u32 v7, v60, v61, v62
    v_max_u32 v7, v7, v63
    v_smfmac_f32_16x16x64_bf16 v[68:71], v[56:59], a[80:87], v6
    v_cmp_eq_u32 vcc, s34, v7
    v_smfmac_f32_16x16x64_bf16 v[72:75], v[56:59], a[48:55], v6
    v_smfmac_f32_16x16x64_bf16 v[76:79], v[56:59], a[112:119], v6
    s_cbranch_vccnz L_q_a_91
L_v_a_92:
    v_smfmac_f32_16x16x64_bf16 v[64:67], v[60:63], a[24:31], v6
    s_waitcnt vmcnt(1)
    v_max3_u32 v7, v48, v49, v50
    v_max_u32 v7, v7, v51
    v_smfmac_f32_16x16x64_bf16 v[68:71], v[60:63], a[88:95], v6
    v_cmp_eq_u32 vcc, s34, v7
    v_smfmac_f32_16x16x64_bf16 v[72:75], v[60:63], a[56:63], v6
    v_smfmac_f32_16x16x64_bf16 v[76:79], v[60:63], a[120:127], v6
    s_cbranch_vccnz L_q_a_93
L_v_a_94:
    v_smfmac_f32_16x16x64_bf16 v[64:67], v[48:51], a[0:7], v6
    s_waitcnt vmcnt(0)
    v_max3_u32 v7, v52, v53, v54
    v_max_u32 v7, v7, v55
    v_smfmac_f32_16x16x64_bf16 v[68:71], v[48:51], a[64:71], v6
    v_cmp_eq_u32 vcc, s34, v7
    v_smfmac_f32_16x16x64_bf16 v[72:75], v[48:51], a[32:39], v6
    v_smfmac_f32_16x16x64_bf16 v[76:79], v[48:51], a[96:103], v6
    s_cbranch_vccnz L_q_a_47
    s_branch L_v_a_48
L_q_a_93:
    buffer_load_dwordx4 v[48:51], v2, s[8:11], s38 offen sc1
    s_waitcnt vmcnt(2)
    v_max3_u32 v7, v52, v53, v54
    v_max_u32 v7, v7, v55
    v_cmp_eq_u32 vcc, s34, v7
    s_cbranch_vccz L_ok_a_95
    buffer_load_dwordx4 v[52:55], v3, s[8:11], s38 offen sc1
    s_waitcnt vmcnt(2)
    v_max3_u32 v7, v48, v49, v50
    v_max_u32 v7, v7, v51
    v_cmp_eq_u32 vcc, s34, v7
    s_cbranch_vccz L_ok_a_96
    s_add_u32 s33, s33, 1
    s_cmp_gt_u32 s33, 0x100000
    s_cbranch_scc0 L_q_a_93
    s_branch chain_kernel_abort
L_ok_a_95:
    v_smfmac_f32_16x16x64_bf16 v[64:67], v[52:55], a[8:15], v6
    v_smfmac_f32_16x16x64_bf16 v[68:71], v[52:55], a[72:79], v6
    v_smfmac_f32_16x16x64_bf16 v[72:75], v[52:55], a[40:47], v6
    v_smfmac_f32_16x16x64_bf16 v[76:79], v[52:55], a[104:111], v6
    s_branch L_q_a_71
L_ok_a_96:
    v_smfmac_f32_16x16x64_bf16 v[64:67], v[48:51], a[0:7], v6
    v_smfmac_f32_16x16x64_bf16 v[68:71], v[48:51], a[64:71], v6
    v_smfmac_f32_16x16x64_bf16 v[72:75], v[48:51], a[32:39], v6
    v_smfmac_f32_16x16x64_bf16 v[76:79], v[48:51], a[96:103], v6
    s_branch L_q_a_47
L_q_a_91:
    buffer_load_dwordx4 v[60:63], v5, s[8:11], s38 offen sc1
    s_waitcnt vmcnt(2)
    v_max3_u32 v7, v48, v49, v50
    v_max_u32 v7, v7, v51
    v_cmp_eq_u32 vcc, s34, v7
    s_cbranch_vccnz L_q_a_97
L_v_a_98:
    v_smfmac_f32_16x16x64_bf16 v[64:67], v[48:51], a[0:7], v6
    s_waitcnt vmcnt(1)
    v_max3_u32 v7, v52, v53, v54
    v_max_u32 v7, v7, v55
    v_smfmac_f32_16x16x64_bf16 v[68:71], v[48:51], a[64:71], v6
    v_cmp_eq_u32 vcc, s34, v7
    v_smfmac_f32_16x16x64_bf16 v[72:75], v[48:51], a[32:39], v6
    v_smfmac_f32_16x16x64_bf16 v[76:79], v[48:51], a[96:103], v6
    s_cbranch_vccnz L_q_a_50
    s_branch L_v_a_51
L_q_a_97:
    buffer_load_dwordx4 v[48:51], v2, s[8:11], s38 offen sc1
    s_waitcnt vmcnt(2)
    v_max3_u32 v7, v52, v53, v54
    v_max_u32 v7, v7, v55
    v_cmp_eq_u32 vcc, s34, v7
    s_cbranch_vccz L_ok_a_99
    buffer_load_dwordx4 v[52:55], v3, s[8:11], s38 offen sc1
    s_waitcnt vmcnt(2)
    v_max3_u32 v7, v60, v61, v62
    v_max_u32 v7, v7, v63
    v_cmp_eq_u32 vcc, s34, v7
    s_cbranch_vccz L_ok_a_100
    buffer_load_dwordx4 v[60:63], v5, s[8:11], s38 offen sc1
    s_waitcnt vmcnt(2)
    v_max3_u32 v7, v48, v49, v50
    v_max_u32 v7, v7, v51
    v_cmp_eq_u32 vcc, s34, v7
    s_cbranch_vccz L_ok_a_101
    s_add_u32 s33, s33, 1
    s_cmp_gt_u32 s33, 0x100000
    s_cbranch_scc0 L_q_a_97
    s_branch chain_kernel_abort
L_ok_a_99:
    v_smfmac_f32_16x16x64_bf16 v[64:67], v[52:55], a[8:15], v6
    v_smfmac_f32_16x16x64_bf16 v[68:71], v[52:55], a[72:79], v6
    v_smfmac_f32_16x16x64_bf16 v[72:75], v[52:55], a[40:47], v6
    v_smfmac_f32_16x16x64_bf16 v[76:79], v[52:55], a[104:111], v6
    s_branch L_q_a_74
L_ok_a_100:
    v_smfmac_f32_16x16x64_bf16 v[64:67], v[60:63], a[24:31], v6
    v_smfmac_f32_16x16x64_bf16 v[68:71], v[60:63], a[88:95], v6
    v_smfmac_f32_16x16x64_bf16 v[72:75], v[60:63], a[56:63], v6
    v_smfmac_f32_16x16x64_bf16 v[76:79], v[60:63], a[120:127], v6
    s_branch L_q_a_93
L_ok_a_101:
    v_smfmac_f32_16x16x64_bf16 v[64:67], v[48:51], a[0:7], v6
    v_smfmac_f32_16x16x64_bf16 v[68:71], v[48:51], a[64:71], v6
    v_smfmac_f32_16x16x64_bf16 v[72:75], v[48:51], a[32:39], v6
    v_smfmac_f32_16x16x64_bf16 v[76:79], v[48:51], a[96:103], v6
    s_branch L_q_a_50
L_q_a_89:
    buffer_load_dwordx4 v[56:59], v4, s[8:11], s38 offen sc1
    s_waitcnt vmcnt(3)
    v_max3_u32 v7, v60, v61, v62
    v_max_u32 v7, v7, v63
    v_cmp_eq_u32 vcc, s34, v7
    s_cbranch_vccnz L_q_a_102
L_v_a_103:
    v_smfmac_f32_16x16x64_bf16 v[64:67], v[60:63], a[24:31], v6
    s_waitcnt vmcnt(2)
    v_max3_u32 v7, v48, v49, v50
    v_max_u32 v7, v7, v51
    v_smfmac_f32_16x16x64_bf16 v[68:71], v[60:63], a[88:95], v6
    v_cmp_eq_u32 vcc, s34, v7
    v_smfmac_f32_16x16x64_bf16 v[72:75], v[60:63], a[56:63], v6
    v_smfmac_f32_16x16x64_bf16 v[76:79], v[60:63], a[120:127], v6
    s_cbranch_vccnz L_q_a_104
L_v_a_105:
    v_smfmac_f32_16x16x64_bf16 v[64:67], v[48:51], a[0:7], v6
    s_waitcnt vmcnt(1)
    v_max3_u32 v7, v52, v53, v54
    v_max_u32 v7, v7, v55
    v_smfmac_f32_16x16x64_bf16 v[68:71], v[48:51], a[64:71], v6
    v_cmp_eq_u32 vcc, s34, v7
    v_smfmac_f32_16x16x64_bf16 v[72:75], v[48:51], a[32:39], v6
    v_smfmac_f32_16x16x64_bf16 v[76:79], v[48:51], a[96:103], v6
    s_cbranch_vccnz L_q_a_56
    s_branch L_v_a_57
L_q_a_104:
    buffer_load_dwordx4 v[48:51], v2, s[8:11], s38 offen sc1
    s_waitcnt vmcnt(2)
    v_max3_u32 v7, v52, v53, v54
    v_max_u32 v7, v7, v55
    v_cmp_eq_u32 vcc, s34, v7
    s_cbranch_vccz L_ok_a_106
    buffer_load_dwordx4 v[52:55], v3, s[8:11], s38 offen sc1
    s_waitcnt vmcnt(2)
    v_max3_u32 v7, v56, v57, v58
    v_max_u32 v7, v7, v59
    v_cmp_eq_u32 vcc, s34, v7
    s_cbranch_vccz L_ok_a_107
    buffer_load_dwordx4 v[56:59], v4, s[8:11], s38 offen sc1
    s_waitcnt vmcnt(2)
    v_max3_u32 v7, v48, v49, v50
    v_max_u32 v7, v7, v51
    v_cmp_eq_u32 vcc, s34, v7
    s_cbranch_vccz L_ok_a_108
    s_add_u32 s33, s33, 1
    s_cmp_gt_u32 s33, 0x100000
    s_cbranch_scc0 L_q_a_104
    s_branch chain_kernel_abort
L_ok_a_106:
    v_smfmac_f32_16x16x64_bf16 v[64:67], v[52:55], a[8:15], v6
    v_smfmac_f32_16x16x64_bf16 v[68:71], v[52:55], a[72:79], v6
    v_smfmac_f32_16x16x64_bf16 v[72:75], v[52:55], a[40:47], v6
    v_smfmac_f32_16x16x64_bf16 v[76:79], v[52:55], a[104:111], v6
    s_branch L_q_a_80
L_ok_a_107:
    v_smfmac_f32_16x16x64_bf16 v[64:67], v[56:59], a[16:23], v6
    v_smfmac_f32_16x16x64_bf16 v[68:71], v[56:59], a[80:87], v6
    v_smfmac_f32_16x16x64_bf16 v[72:75], v[56:59], a[48:55], v6
    v_smfmac_f32_16x16x64_bf16 v[76:79], v[56:59], a[112:119], v6
    s_branch L_q_a_93
L_ok_a_108:
    v_smfmac_f32_16x16x64_bf16 v[64:67], v[48:51], a[0:7], v6
    v_smfmac_f32_16x16x64_bf16 v[68:71], v[48:51], a[64:71], v6
    v_smfmac_f32_16x16x64_bf16 v[72:75], v[48:51], a[32:39], v6
    v_smfmac_f32_16x16x64_bf16 v[76:79], v[48:51], a[96:103], v6
    s_branch L_q_a_56
L_q_a_102:
    buffer_load_dwordx4 v[60:63], v5, s[8:11], s38 offen sc1
    s_waitcnt vmcnt(3)
    v_max3_u32 v7, v48, v49, v50
    v_max_u32 v7, v7, v51
    v_cmp_eq_u32 vcc, s34, v7
    s_cbranch_vccnz L_q_a_109
L_v_a_110:
    v_smfmac_f32_16x16x64_bf16 v[64:67], v[48:51], a[0:7], v6
    s_waitcnt vmcnt(2)
    v_max3_u32 v7, v52, v53, v54
    v_max_u32 v7, v7, v55
    v_smfmac_f32_16x16x64_bf16 v[68:71], v[48:51], a[64:71], v6
    v_cmp_eq_u32 vcc, s34, v7
    v_smfmac_f32_16x16x64_bf16 v[72:75], v[48:51], a[32:39], v6
    v_smfmac_f32_16x16x64_bf16 v[76:79], v[48:51], a[96:103], v6
    s_cbranch_vccnz L_q_a_60
    s_branch L_v_a_61
L_q_a_109:
    buffer_load_dwordx4 v[48:51], v2, s[8:11], s38 offen sc1
    s_waitcnt vmcnt(2)
    v_max3_u32 v7, v52, v53, v54
    v_max_u32 v7, v7, v55
    v_cmp_eq_u32 vcc, s34, v7
    s_cbranch_vccz L_ok_a_111
    buffer_load_dwordx4 v[52:55], v3, s[8:11], s38 offen sc1
    s_waitcnt vmcnt(2)
    v_max3_u32 v7, v56, v57, v58
    v_max_u32 v7, v7, v59
    v_cmp_eq_u32 vcc, s34, v7
    s_cbranch_vccz L_ok_a_112
    buffer_load_dwordx4 v[56:59], v4, s[8:11], s38 offen sc1
    s_waitcnt vmcnt(2)
    v_max3_u32 v7, v60, v61, v62
    v_max_u32 v7, v7, v63
    v_cmp_eq_u32 vcc, s34, v7
    s_cbranch_vccz L_ok_a_113
    buffer_load_dwordx4 v[60:63], v5, s[8:11], s38 offen sc1
    s_waitcnt vmcnt(2)
    v_max3_u32 v7, v48, v49, v50
    v_max_u32 v7, v7, v51
    v_cmp_eq_u32 vcc, s34, v7
    s_cbranch_vccz L_ok_a_114
    s_add_u32 s33, s33, 1
    s_cmp_gt_u32 s33, 0x100000
    s_cbranch_scc0 L_q_a_109
    s_branch chain_kernel_abort
L_ok_a_111:
    v_smfmac_f32_16x16x64_bf16 v[64:67], v[52:55], a[8:15], v6
    v_smfmac_f32_16x16x64_bf16 v[68:71], v[52:55], a[72:79], v6
    v_smfmac_f32_16x16x64_bf16 v[72:75], v[52:55], a[40:47], v6
    v_smfmac_f32_16x16x64_bf16 v[76:79], v[52:55], a[104:111], v6
    s_branch L_q_a_84
L_ok_a_112:
    v_smfmac_f32_16x16x64_bf16 v[64:67], v[56:59], a[16:23], v6
    v_smfmac_f32_16x16x64_bf16 v[68:71], v[56:59], a[80:87], v6
    v_smfmac_f32_16x16x64_bf16 v[72:75], v[56:59], a[48:55], v6
    v_smfmac_f32_16x16x64_bf16 v[76:79], v[56:59], a[112:119], v6
    s_branch L_q_a_97
L_ok_a_113:
    v_smfmac_f32_16x16x64_bf16 v[64:67], v[60:63], a[24:31], v6
    v_smfmac_f32_16x16x64_bf16 v[68:71], v[60:63], a[88:95], v6
    v_smfmac_f32_16x16x64_bf16 v[72:75], v[60:63], a[56:63], v6
    v_smfmac_f32_16x16x64_bf16 v[76:79], v[60:63], a[120:127], v6
    s_branch L_q_a_104
L_ok_a_114:
    v_smfmac_f32_16x16x64_bf16 v[64:67], v[48:51], a[0:7], v6
    v_smfmac_f32_16x16x64_bf16 v[68:71], v[48:51], a[64:71], v6
    v_smfmac_f32_16x16x64_bf16 v[72:75], v[48:51], a[32:39], v6
    v_smfmac_f32_16x16x64_bf16 v[76:79], v[48:51], a[96:103], v6
    s_branch L_q_a_60
L_cf_122:
L_rt_123:
    buffer_load_dwordx4 v[200:203], v16, s[8:11], s40 offen sc1
    buffer_load_dwordx4 v[204:207], v13, s[8:11], s40 offen sc1
    buffer_load_dwordx4 v[208:211], v14, s[8:11], s40 offen sc1
    buffer_load_dwordx4 v[212:215], v15, s[8:11], s40 offen sc1
    s_waitcnt vmcnt(7)
    v_permlane32_swap_b32 v216, v218
    v_permlane32_swap_b32 v217, v219
    s_waitcnt vmcnt(6)
    v_pk_add_f32 v[154:155], v[216:217], v[218:219]
    v_pk_add_f32 v[148:149], v[124:125], v[220:221]
    v_pk_add_f32 v[150:151], v[126:127], v[222:223]
    v_permlane16_swap_b32 v154, v155
    s_waitcnt vmcnt(5)
    v_pk_add_f32 v[148:149], v[148:149], v[224:225]
    v_pk_add_f32 v[150:151], v[150:151], v[226:227]
    v_add_f32 v152, v154, v155
    s_waitcnt vmcnt(4)
    v_pk_add_f32 v[148:149], v[148:149], v[228:229]
    v_pk_add_f32 v[150:151], v[150:151], v[230:231]
    v_pk_add_f32 v[154:155], v[148:149], v[150:151]
    v_add_f32 v154, v154, v152
    v_cmp_u_f32 vcc, v154, v155
    s_cbranch_vccz L_cok_121
    buffer_load_dwordx4 v[216:219], v16, s[8:11], s40 offen sc1
    buffer_load_dwordx4 v[220:223], v13, s[8:11], s40 offen sc1
    buffer_load_dwordx4 v[224:227], v14, s[8:11], s40 offen sc1
    buffer_load_dwordx4 v[228:231], v15, s[8:11], s40 offen sc1
    s_waitcnt vmcnt(7)
    v_permlane32_swap_b32 v200, v202
    v_permlane32_swap_b32 v201, v203
    s_waitcnt vmcnt(6)
    v_pk_add_f32 v[154:155], v[200:201], v[202:203]
    v_pk_add_f32 v[148:149], v[124:125], v[204:205]
    v_pk_add_f32 v[150:151], v[126:127], v[206:207]
    v_permlane16_swap_b32 v154, v155
    s_waitcnt vmcnt(5)
    v_pk_add_f32 v[148:149], v[148:149], v[208:209]
    v_pk_add_f32 v[150:151], v[150:151], v[210:211]
    v_add_f32 v152, v154, v155
    s_waitcnt vmcnt(4)
    v_pk_add_f32 v[148:149], v[148:149], v[212:213]
    v_pk_add_f32 v[150:151], v[150:151], v[214:215]
    v_pk_add_f32 v[154:155], v[148:149], v[150:151]
    v_add_f32 v154, v154, v152
    v_cmp_u_f32 vcc, v154, v155
    s_cbranch_vccz L_cok_121
    s_add_u32 s33, s33, 1
    s_cmp_gt_u32 s33, 0x100000
    s_cbranch_scc1 chain_kernel_abort
    s_and_b32 s20, s33, 63
    s_cbranch_scc1 L_rt_123
    v_cmp_eq_u32 vcc, s34, v200
    v_cmp_eq_u32 s[20:21], s34, v201
    s_or_b64 vcc, vcc, s[20:21]
    v_cmp_eq_u32 s[20:21], s34, v202
    s_or_b64 vcc, vcc, s[20:21]
    v_cmp_eq_u32 s[20:21], s34, v203
    s_or_b64 vcc, vcc, s[20:21]
    v_cmp_eq_u32 s[20:21], s34, v204
    s_or_b64 vcc, vcc, s[20:21]
    v_cmp_eq_u32 s[20:21], s34, v205
    s_or_b64 vcc, vcc, s[20:21]
    v_cmp_eq_u32 s[20:21], s34, v206
    s_or_b64 vcc, vcc, s[20:21]
    v_cmp_eq_u32 s[20:21], s34, v207
    s_or_b64 vcc, vcc, s[20:21]
    v_cmp_eq_u32 s[20:21], s34, v208
    s_or_b64 vcc, vcc, s[20:21]
    v_cmp_eq_u32 s[20:21], s34, v209
    s_or_b64 vcc, vcc, s[20:21]
    v_cmp_eq_u32 s[20:21], s34, v210
    s_or_b64 vcc, vcc, s[20:21]
    v_cmp_eq_u32 s[20:21], s34, v211
    s_or_b64 vcc, vcc, s[20:21]
    v_cmp_eq_u32 s[20:21], s34, v212
    s_or_b64 vcc, vcc, s[20:21]
    v_cmp_eq_u32 s[20:21], s34, v213
    s_or_b64 vcc, vcc, s[20:21]
    v_cmp_eq_u32 s[20:21], s34, v214
    s_or_b64 vcc, vcc, s[20:21]
    v_cmp_eq_u32 s[20:21], s34, v215
    s_or_b64 vcc, vcc, s[20:21]
    s_cbranch_vccnz L_rt_123
    s_branch L_cok_121
L_cok_121:
    v_max3_f32 v154, v148, v149, v150
    v_max3_f32 v154, v154, v151, v152
    s_nop 1
    v_max_f32_dpp v154, v154, v154 row_ror:8 row_mask:0xf bank_mask:0xf
    s_branch L_chead_124
L_q_e_132:
    buffer_load_dwordx4 v[60:63], v5, s[8:11], s41 offen sc1
    s_waitcnt vmcnt(0)
    v_max3_u32 v7, v60, v61, v62
    v_max_u32 v7, v7, v63
    v_cmp_eq_u32 vcc, s34, v7
    s_cbranch_vccnz L_q_e_134
    s_branch L_v_e_133
L_q_e_134:
    buffer_load_dwordx4 v[60:63], v5, s[8:11], s41 offen sc1
    s_waitcnt vmcnt(2)
    v_max3_u32 v7, v60, v61, v62
    v_max_u32 v7, v7, v63
    v_cmp_eq_u32 vcc, s34, v7
    s_cbranch_vccz L_ok_e_135
    s_add_u32 s33, s33, 1
    s_cmp_gt_u32 s33, 0x100000
    s_cbranch_scc0 L_q_e_134
    s_branch chain_kernel_abort
L_ok_e_135:
    v_smfmac_f32_16x16x64_bf16 v[88:91], v[60:63], a[216:223], v6
    v_smfmac_f32_16x16x64_bf16 v[92:95], v[60:63], a[248:255], v6
    s_branch L_gd_e_125
L_q_e_130:
    buffer_load_dwordx4 v[56:59], v4, s[8:11], s41 offen sc1
    s_waitcnt vmcnt(1)
    v_max3_u32 v7, v60, v61, v62
    v_max_u32 v7, v7, v63
    v_cmp_eq_u32 vcc, s34, v7
    s_cbranch_vccnz L_q_e_136
L_v_e_137:
    v_smfmac_f32_16x16x64_bf16 v[88:91], v[60:63], a[216:223], v6
    s_waitcnt vmcnt(0)
    v_max3_u32 v7, v56, v57, v58
    v_max_u32 v7, v7, v59
    v_cmp_eq_u32 vcc, s34, v7
    v_smfmac_f32_16x16x64_bf16 v[92:95], v[60:63], a[248:255], v6
    s_cbranch_vccnz L_q_e_138
L_v_e_139:
    v_smfmac_f32_16x16x64_bf16 v[88:91], v[56:59], a[208:215], v6
    v_smfmac_f32_16x16x64_bf16 v[92:95], v[56:59], a[240:247], v6
    s_branch L_gd_e_125
L_q_e_138:
    buffer_load_dwordx4 v[56:59], v4, s[8:11], s41 offen sc1
    s_waitcnt vmcnt(2)
    v_max3_u32 v7, v56, v57, v58
    v_max_u32 v7, v7, v59
    v_cmp_eq_u32 vcc, s34, v7
    s_cbranch_vccz L_ok_e_140
    s_add_u32 s33, s33, 1
    s_cmp_gt_u32 s33, 0x100000
    s_cbranch_scc0 L_q_e_138
    s_branch chain_kernel_abort
L_ok_e_140:
    v_smfmac_f32_16x16x64_bf16 v[88:91], v[56:59], a[208:215], v6
    v_smfmac_f32_16x16x64_bf16 v[92:95], v[56:59], a[240:247], v6
    s_branch L_gd_e_125
L_q_e_136:
    buffer_load_dwordx4 v[60:63], v5, s[8:11], s41 offen sc1
    s_waitcnt vmcnt(1)
    v_max3_u32 v7, v56, v57, v58
    v_max_u32 v7, v7, v59
    v_cmp_eq_u32 vcc, s34, v7
    s_cbranch_vccnz L_q_e_141
L_v_e_142:
    v_smfmac_f32_16x16x64_bf16 v[88:91], v[56:59], a[208:215], v6
    s_waitcnt vmcnt(0)
    v_max3_u32 v7, v60, v61, v62
    v_max_u32 v7, v7, v63
    v_cmp_eq_u32 vcc, s34, v7
    v_smfmac_f32_16x16x64_bf16 v[92:95], v[56:59], a[240:247], v6
    s_cbranch_vccnz L_q_e_134
    s_branch L_v_e_133
L_q_e_141:
    buffer_load_dwordx4 v[56:59], v4, s[8:11], s41 offen sc1
    s_waitcnt vmcnt(2)
    v_max3_u32 v7, v60, v61, v62
    v_max_u32 v7, v7, v63
    v_cmp_eq_u32 vcc, s34, v7
    s_cbranch_vccz L_ok_e_143
    buffer_load_dwordx4 v[60:63], v5, s[8:11], s41 offen sc1
    s_waitcnt vmcnt(2)
    v_max3_u32 v7, v56, v57, v58
    v_max_u32 v7, v7, v59
    v_cmp_eq_u32 vcc, s34, v7
    s_cbranch_vccz L_ok_e_144
    s_add_u32 s33, s33, 1
    s_cmp_gt_u32 s33, 0x100000
    s_cbranch_scc0 L_q_e_141
    s_branch chain_kernel_abort
L_ok_e_143:
    v_smfmac_f32_16x16x64_bf16 v[88:91], v[60:63], a[216:223], v6
    v_smfmac_f32_16x16x64_bf16 v[92:95], v[60:63], a[248:255], v6
    s_branch L_q_e_138
L_ok_e_144:
    v_smfmac_f32_16x16x64_bf16 v[88:91], v[56:59], a[208:215], v6
    v_smfmac_f32_16x16x64_bf16 v[92:95], v[56:59], a[240:247], v6
    s_branch L_q_e_134
L_q_e_128:
    buffer_load_dwordx4 v[52:55], v3, s[8:11], s41 offen sc1
    s_waitcnt vmcnt(2)
    v_max3_u32 v7, v56, v57, v58
    v_max_u32 v7, v7, v59
    v_cmp_eq_u32 vcc, s34, v7
    s_cbranch_vccnz L_q_e_145
L_v_e_146:
    v_smfmac_f32_16x16x64_bf16 v[88:91], v[56:59], a[208:215], v6
    s_waitcnt vmcnt(1)
    v_max3_u32 v7, v60, v61, v62
    v_max_u32 v7, v7, v63
    v_cmp_eq_u32 vcc, s34, v7
    v_smfmac_f32_16x16x64_bf16 v[92:95], v[56:59], a[240:247], v6
    s_cbranch_vccnz L_q_e_147
L_v_e_148:
    v_smfmac_f32_16x16x64_bf16 v[88:91], v[60:63], a[216:223], v6
    s_waitcnt vmcnt(0)
    v_max3_u32 v7, v52, v53, v54
    v_max_u32 v7, v7, v55
    v_cmp_eq_u32 vcc, s34, v7
    v_smfmac_f32_16x16x64_bf16 v[92:95], v[60:63], a[248:255], v6
    s_cbranch_vccnz L_q_e_149
L_v_e_150:
    v_smfmac_f32_16x16x64_bf16 v[88:91], v[52:55], a[200:207], v6
    v_smfmac_f32_16x16x64_bf16 v[92:95], v[52:55], a[232:239], v6
    s_branch L_gd_e_125
L_q_e_149:
    buffer_load_dwordx4 v[52:55], v3, s[8:11], s41 offen sc1
    s_waitcnt vmcnt(2)
    v_max3_u32 v7, v52, v53, v54
    v_max_u32 v7, v7, v55
    v_cmp_eq_u32 vcc, s34, v7
    s_cbranch_vccz L_ok_e_151
    s_add_u32 s33, s33, 1
    s_cmp_gt_u32 s33, 0x100000
    s_cbranch_scc0 L_q_e_149
    s_branch chain_kernel_abort
L_ok_e_151:
    v_smfmac_f32_16x16x64_bf16 v[88:91], v[52:55], a[200:207], v6
    v_smfmac_f32_16x16x64_bf16 v[92:95], v[52:55], a[232:239], v6
    s_branch L_gd_e_125
L_q_e_147:
    buffer_load_dwordx4 v[60:63], v5, s[8:11], s41 offen sc1
    s_waitcnt vmcnt(1)
    v_max3_u32 v7, v52, v53, v54
    v_max_u32 v7, v7, v55
    v_cmp_eq_u32 vcc, s34, v7
    s_cbranch_vccnz L_q_e_152
L_v_e_153:
    v_smfmac_f32_16x16x64_bf16 v[88:91], v[52:55], a[200:207], v6
    s_waitcnt vmcnt(0)
    v_max3_u32 v7, v60, v61, v62
    v_max_u32 v7, v7, v63
    v_cmp_eq_u32 vcc, s34, v7
    v_smfmac_f32_16x16x64_bf16 v[92:95], v[52:55], a[232:239], v6
    s_cbranch_vccnz L_q_e_134
    s_branch L_v_e_133
L_q_e_152:
    buffer_load_dwordx4 v[52:55], v3, s[8:11], s41 offen sc1
    s_waitcnt vmcnt(2)
    v_max3_u32 v7, v60, v61, v62
    v_max_u32 v7, v7, v63
    v_cmp_eq_u32 vcc, s34, v7
    s_cbranch_vccz L_ok_e_154
    buffer_load_dwordx4 v[60:63], v5, s[8:11], s41 offen sc1
    s_waitcnt vmcnt(2)
    v_max3_u32 v7, v52, v53, v54
    v_max_u32 v7, v7, v55
    v_cmp_eq_u32 vcc, s34, v7
    s_cbranch_vccz L_ok_e_155
    s_add_u32 s33, s33, 1
    s_cmp_gt_u32 s33, 0x100000
    s_cbranch_scc0 L_q_e_152
    s_branch chain_kernel_abort
L_ok_e_154:
    v_smfmac_f32_16x16x64_bf16 v[88:91], v[60:63], a[216:223], v6
    v_smfmac_f32_16x16x64_bf16 v[92:95], v[60:63], a[248:255], v6
    s_branch L_q_e_149
L_ok_e_155:
    v_smfmac_f32_16x16x64_bf16 v[88:91], v[52:55], a[200:207], v6
    v_smfmac_f32_16x16x64_bf16 v[92:95], v[52:55], a[232:239], v6
    s_branch L_q_e_134
L_q_e_145:
    buffer_load_dwordx4 v[56:59], v4, s[8:11], s41 offen sc1
    s_waitcnt vmcnt(2)
    v_max3_u32 v7, v60, v61, v62
    v_max_u32 v7, v7, v63
    v_cmp_eq_u32 vcc, s34, v7
    s_cbranch_vccnz L_q_e_156
L_v_e_157:
    v_smfmac_f32_16x16x64_bf16 v[88:91], v[60:63], a[216:223], v6
    s_waitcnt vmcnt(1)
    v_max3_u32 v7, v52, v53, v54
    v_max_u32 v7, v7, v55
    v_cmp_eq_u32 vcc, s34, v7
    v_smfmac_f32_16x16x64_bf16 v[92:95], v[60:63], a[248:255], v6
    s_cbranch_vccnz L_q_e_158
L_v_e_159:
    v_smfmac_f32_16x16x64_bf16 v[88:91], v[52:55], a[200:207], v6
    s_waitcnt vmcnt(0)
    v_max3_u32 v7, v56, v57, v58
    v_max_u32 v7, v7, v59
    v_cmp_eq_u32 vcc, s34, v7
    v_smfmac_f32_16x16x64_bf16 v[92:95], v[52:55], a[232:239], v6
    s_cbranch_vccnz L_q_e_138
    s_branch L_v_e_139
L_q_e_158:
    buffer_load_dwordx4 v[52:55], v3, s[8:11], s41 offen sc1
    s_waitcnt vmcnt(2)
    v_max3_u32 v7, v56, v57, v58
    v_max_u32 v7, v7, v59
    v_cmp_eq_u32 vcc, s34, v7
    s_cbranch_vccz L_ok_e_160
    buffer_load_dwordx4 v[56:59], v4, s[8:11], s41 offen sc1
    s_waitcnt vmcnt(2)
    v_max3_u32 v7, v52, v53, v54
    v_max_u32 v7, v7, v55
    v_cmp_eq_u32 vcc, s34, v7
    s_cbranch_vccz L_ok_e_161
    s_add_u32 s33, s33, 1
    s_cmp_gt_u32 s33, 0x100000
    s_cbranch_scc0 L_q_e_158
    s_branch chain_kernel_abort
L_ok_e_160:
    v_smfmac_f32_16x16x64_bf16 v[88:91], v[56:59], a[208:215], v6
    v_smfmac_f32_16x16x64_bf16 v[92:95], v[56:59], a[240:247], v6
    s_branch L_q_e_149
L_ok_e_161:
    v_smfmac_f32_16x16x64_bf16 v[88:91], v[52:55], a[200:207], v6
    v_smfmac_f32_16x16x64_bf16 v[92:95], v[52:55], a[232:239], v6
    s_branch L_q_e_138
L_q_e_156:
    buffer_load_dwordx4 v[60:63], v5, s[8:11], s41 offen sc1
    s_waitcnt vmcnt(2)
    v_max3_u32 v7, v52, v53, v54
    v_max_u32 v7, v7, v55
    v_cmp_eq_u32 vcc, s34, v7
    s_cbranch_vccnz L_q_e_162
L_v_e_163:
    v_smfmac_f32_16x16x64_bf16 v[88:91], v[52:55], a[200:207], v6
    s_waitcnt vmcnt(1)
    v_max3_u32 v7, v56, v57, v58
    v_max_u32 v7, v7, v59
    v_cmp_eq_u32 vcc, s34, v7
    v_smfmac_f32_16x16x64_bf16 v[92:95], v[52:55], a[232:239], v6
    s_cbranch_vccnz L_q_e_141
    s_branch L_v_e_142
L_q_e_162:
    buffer_load_dwordx4 v[52:55], v3, s[8:11], s41 offen sc1
    s_waitcnt vmcnt(2)
    v_max3_u32 v7, v56, v57, v58
    v_max_u32 v7, v7, v59
    v_cmp_eq_u32 vcc, s34, v7
    s_cbranch_vccz L_ok_e_164
    buffer_load_dwordx4 v[56:59], v4, s[8:11], s41 offen sc1
    s_waitcnt vmcnt(2)
    v_max3_u32 v7, v60, v61, v62
    v_max_u32 v7, v7, v63
    v_cmp_eq_u32 vcc, s34, v7
    s_cbranch_vccz L_ok_e_165
    buffer_load_dwordx4 v[60:63], v5, s[8:11], s41 offen sc1
    s_waitcnt vmcnt(2)
    v_max3_u32 v7, v52, v53, v54
    v_max_u32 v7, v7, v55
    v_cmp_eq_u32 vcc, s34, v7
    s_cbranch_vccz L_ok_e_166
    s_add_u32 s33, s33, 1
    s_cmp_gt_u32 s33, 0x100000
    s_cbranch_scc0 L_q_e_162
    s_branch chain_kernel_abort
L_ok_e_164:
    v_smfmac_f32_16x16x64_bf16 v[88:91], v[56:59], a[208:215], v6
    v_smfmac_f32_16x16x64_bf16 v[92:95], v[56:59], a[240:247], v6
    s_branch L_q_e_152
L_ok_e_165:
    v_smfmac_f32_16x16x64_bf16 v[88:91], v[60:63], a[216:223], v6
    v_smfmac_f32_16x16x64_bf16 v[92:95], v[60:63], a[248:255], v6
    s_branch L_q_e_158
L_ok_e_166:
    v_smfmac_f32_16x16x64_bf16 v[88:91], v[52:55], a[200:207], v6
    v_smfmac_f32_16x16x64_bf16 v[92:95], v[52:55], a[232:239], v6
    s_branch L_q_e_141
L_q_e_126:
    buffer_load_dwordx4 v[48:51], v2, s[8:11], s41 offen sc1
    s_waitcnt vmcnt(3)
    v_max3_u32 v7, v52, v53, v54
    v_max_u32 v7, v7, v55
    v_cmp_eq_u32 vcc, s34, v7
    s_cbranch_vccnz L_q_e_167
L_v_e_168:
    v_smfmac_f32_16x16x64_bf16 v[88:91], v[52:55], a[200:207], v6
    s_waitcnt vmcnt(2)
    v_max3_u32 v7, v56, v57, v58
    v_max_u32 v7, v7, v59
    v_cmp_eq_u32 vcc, s34, v7
    v_smfmac_f32_16x16x64_bf16 v[92:95], v[52:55], a[232:239], v6
    s_cbranch_vccnz L_q_e_169
L_v_e_170:
    v_smfmac_f32_16x16x64_bf16 v[88:91], v[56:59], a[208:215], v6
    s_waitcnt vmcnt(1)
    v_max3_u32 v7, v60, v61, v62
    v_max_u32 v7, v7, v63
    v_cmp_eq_u32 vcc, s34, v7
    v_smfmac_f32_16x16x64_bf16 v[92:95], v[56:59], a[240:247], v6
    s_cbranch_vccnz L_q_e_171
L_v_e_172:
    v_smfmac_f32_16x16x64_bf16 v[88:91], v[60:63], a[216:223], v6
    s_waitcnt vmcnt(0)
    v_max3_u32 v7, v48, v49, v50
    v_max_u32 v7, v7, v51
    v_cmp_eq_u32 vcc, s34, v7
    v_smfmac_f32_16x16x64_bf16 v[92:95], v[60:63], a[248:255], v6
    s_cbranch_vccnz L_q_e_173
L_v_e_174:
    v_smfmac_f32_16x16x64_bf16 v[88:91], v[48:51], a[192:199], v6
    v_smfmac_f32_16x16x64_bf16 v[92:95], v[48:51], a[224:231], v6
    s_branch L_gd_e_125
L_q_e_173:
    buffer_load_dwordx4 v[48:51], v2, s[8:11], s41 offen sc1
    s_waitcnt vmcnt(2)
    v_max3_u32 v7, v48, v49, v50
    v_max_u32 v7, v7, v51
    v_cmp_eq_u32 vcc, s34, v7
    s_cbranch_vccz L_ok_e_175
    s_add_u32 s33, s33, 1
    s_cmp_gt_u32 s33, 0x100000
    s_cbranch_scc0 L_q_e_173
    s_branch chain_kernel_abort
L_ok_e_175:
    v_smfmac_f32_16x16x64_bf16 v[88:91], v[48:51], a[192:199], v6
    v_smfmac_f32_16x16x64_bf16 v[92:95], v[48:51], a[224:231], v6
    s_branch L_gd_e_125
L_q_e_171:
    buffer_load_dwordx4 v[60:63], v5, s[8:11], s41 offen sc1
    s_waitcnt vmcnt(1)
    v_max3_u32 v7, v48, v49, v50
    v_max_u32 v7, v7, v51
    v_cmp_eq_u32 vcc, s34, v7
    s_cbranch_vccnz L_q_e_176
L_v_e_177:
    v_smfmac_f32_16x16x64_bf16 v[88:91], v[48:51], a[192:199], v6
    s_waitcnt vmcnt(0)
    v_max3_u32 v7, v60, v61, v62
    v_max_u32 v7, v7, v63
    v_cmp_eq_u32 vcc, s34, v7
    v_smfmac_f32_16x16x64_bf16 v[92:95], v[48:51], a[224:231], v6
    s_cbranch_vccnz L_q_e_134
    s_branch L_v_e_133
L_q_e_176:
    buffer_load_dwordx4 v[48:51], v2, s[8:11], s41 offen sc1
    s_waitcnt vmcnt(2)
    v_max3_u32 v7, v60, v61, v62
    v_max_u32 v7, v7, v63
    v_cmp_eq_u32 vcc, s34, v7
    s_cbranch_vccz L_ok_e_178
    buffer_load_dwordx4 v[60:63], v5, s[8:11], s41 offen sc1
    s_waitcnt vmcnt(2)
    v_max3_u32 v7, v48, v49, v50
    v_max_u32 v7, v7, v51
    v_cmp_eq_u32 vcc, s34, v7
    s_cbranch_vccz L_ok_e_179
    s_add_u32 s33, s33, 1
    s_cmp_gt_u32 s33, 0x100000
    s_cbranch_scc0 L_q_e_176
    s_branch chain_kernel_abort
L_ok_e_178:
    v_smfmac_f32_16x16x64_bf16 v[88:91], v[60:63], a[216:223], v6
    v_smfmac_f32_16x16x64_bf16 v[92:95], v[60:63], a[248:255], v6
    s_branch L_q_e_173
L_ok_e_179:
    v_smfmac_f32_16x16x64_bf16 v[88:91], v[48:51], a[192:199], v6
    v_smfmac_f32_16x16x64_bf16 v[92:95], v[48:51], a[224:231], v6
    s_branch L_q_e_134
L_q_e_169:
    buffer_load_dwordx4 v[56:59], v4, s[8:11], s41 offen sc1
    s_waitcnt vmcnt(2)
    v_max3_u32 v7, v60, v61, v62
    v_max_u32 v7, v7, v63
    v_cmp_eq_u32 vcc, s34, v7
    s_cbranch_vccnz L_q_e_180
L_v_e_181:
    v_smfmac_f32_16x16x64_bf16 v[88:91], v[60:63], a[216:223], v6
    s_waitcnt vmcnt(1)
    v_max3_u32 v7, v48, v49, v50
    v_max_u32 v7, v7, v51
    v_cmp_eq_u32 vcc, s34, v7
    v_smfmac_f32_16x16x64_bf16 v[92:95], v[60:63], a[248:255], v6
    s_cbranch_vccnz L_q_e_182
L_v_e_183:
    v_smfmac_f32_16x16x64_bf16 v[88:91], v[48:51], a[192:199], v6
    s_waitcnt vmcnt(0)
    v_max3_u32 v7, v56, v57, v58
    v_max_u32 v7, v7, v59
    v_cmp_eq_u32 vcc, s34, v7
    v_smfmac_f32_16x16x64_bf16 v[92:95], v[48:51], a[224:231], v6
    s_cbranch_vccnz L_q_e_138
    s_branch L_v_e_139
L_q_e_182:
    buffer_load_dwordx4 v[48:51], v2, s[8:11], s41 offen sc1
    s_waitcnt vmcnt(2)
    v_max3_u32 v7, v56, v57, v58
    v_max_u32 v7, v7, v59
    v_cmp_eq_u32 vcc, s34, v7
    s_cbranch_vccz L_ok_e_184
    buffer_load_dwordx4 v[56:59], v4, s[8:11], s41 offen sc1
    s_waitcnt vmcnt(2)
    v_max3_u32 v7, v48, v49, v50
    v_max_u32 v7, v7, v51
    v_cmp_eq_u32 vcc, s34, v7
    s_cbranch_vccz L_ok_e_185
    s_add_u32 s33, s33, 1
    s_cmp_gt_u32 s33, 0x100000
    s_cbranch_scc0 L_q_e_182
    s_branch chain_kernel_abort
L_ok_e_184:
    v_smfmac_f32_16x16x64_bf16 v[88:91], v[56:59], a[208:215], v6
    v_smfmac_f32_16x16x64_bf16 v[92:95], v[56:59], a[240:247], v6
    s_branch L_q_e_173
L_ok_e_185:
    v_smfmac_f32_16x16x64_bf16 v[88:91], v[48:51], a[192:199], v6
    v_smfmac_f32_16x16x64_bf16 v[92:95], v[48:51], a[224:231], v6
    s_branch L_q_e_138
L_q_e_180:
    buffer_load_dwordx4 v[60:63], v5, s[8:11], s41 offen sc1
    s_waitcnt vmcnt(2)
    v_max3_u32 v7, v48, v49, v50
    v_max_u32 v7, v7, v51
    v_cmp_eq_u32 vcc, s34, v7
    s_cbranch_vccnz L_q_e_186
L_v_e_187:
    v_smfmac_f32_16x16x64_bf16 v[88:91], v[48:51], a[192:199], v6
    s_waitcnt vmcnt(1)
    v_max3_u32 v7, v56, v57, v58
    v_max_u32 v7, v7, v59
    v_cmp_eq_u32 vcc, s34, v7
    v_smfmac_f32_16x16x64_bf16 v[92:95], v[48:51], a[224:231], v6
    s_cbranch_vccnz L_q_e_141
    s_branch L_v_e_142
L_q_e_186:
    buffer_load_dwordx4 v[48:51], v2, s[8:11], s41 offen sc1
    s_waitcnt vmcnt(2)
    v_max3_u32 v7, v56, v57, v58
    v_max_u32 v7, v7, v59
    v_cmp_eq_u32 vcc, s34, v7
    s_cbranch_vccz L_ok_e_188
    buffer_load_dwordx4 v[56:59], v4, s[8:11], s41 offen sc1
    s_waitcnt vmcnt(2)
    v_max3_u32 v7, v60, v61, v62
    v_max_u32 v7, v7, v63
    v_cmp_eq_u32 vcc, s34, v7
    s_cbranch_vccz L_ok_e_189
    buffer_load_dwordx4 v[60:63], v5, s[8:11], s41 offen sc1
    s_waitcnt vmcnt(2)
    v_max3_u32 v7, v48, v49, v50
    v_max_u32 v7, v7, v51
    v_cmp_eq_u32 vcc, s34, v7
    s_cbranch_vccz L_ok_e_190
    s_add_u32 s33, s33, 1
    s_cmp_gt_u32 s33, 0x100000
    s_cbranch_scc0 L_q_e_186
    s_branch chain_kernel_abort
L_ok_e_188:
    v_smfmac_f32_16x16x64_bf16 v[88:91], v[56:59], a[208:215], v6
    v_smfmac_f32_16x16x64_bf16 v[92:95], v[56:59], a[240:247], v6
    s_branch L_q_e_176
L_ok_e_189:
    v_smfmac_f32_16x16x64_bf16 v[88:91], v[60:63], a[216:223], v6
    v_smfmac_f32_16x16x64_bf16 v[92:95], v[60:63], a[248:255], v6
    s_branch L_q_e_182
L_ok_e_190:
    v_smfmac_f32_16x16x64_bf16 v[88:91], v[48:51], a[192:199], v6
    v_smfmac_f32_16x16x64_bf16 v[92:95], v[48:51], a[224:231], v6
    s_branch L_q_e_141
L_q_e_167:
    buffer_load_dwordx4 v[52:55], v3, s[8:11], s41 offen sc1
    s_waitcnt vmcnt(3)
    v_max3_u32 v7, v56, v57, v58
    v_max_u32 v7, v7, v59
    v_cmp_eq_u32 vcc, s34, v7
    s_cbranch_vccnz L_q_e_191
L_v_e_192:
    v_smfmac_f32_16x16x64_bf16 v[88:91], v[56:59], a[208:215], v6
    s_waitcnt vmcnt(2)
    v_max3_u32 v7, v60, v61, v62
    v_max_u32 v7, v7, v63
    v_cmp_eq_u32 vcc, s34, v7
    v_smfmac_f32_16x16x64_bf16 v[92:95], v[56:59], a[240:247], v6
    s_cbranch_vccnz L_q_e_193
L_v_e_194:
    v_smfmac_f32_16x16x64_bf16 v[88:91], v[60:63], a[216:223], v6
    s_waitcnt vmcnt(1)
    v_max3_u32 v7, v48, v49, v50
    v_max_u32 v7, v7, v51
    v_cmp_eq_u32 vcc, s34, v7
    v_smfmac_f32_16x16x64_bf16 v[92:95], v[60:63], a[248:255], v6
    s_cbranch_vccnz L_q_e_195
L_v_e_196:
    v_smfmac_f32_16x16x64_bf16 v[88:91], v[48:51], a[192:199], v6
    s_waitcnt vmcnt(0)
    v_max3_u32 v7, v52, v53, v54
    v_max_u32 v7, v7, v55
    v_cmp_eq_u32 vcc, s34, v7
    v_smfmac_f32_16x16x64_bf16 v[92:95], v[48:51], a[224:231], v6
    s_cbranch_vccnz L_q_e_149
    s_branch L_v_e_150
L_q_e_195:
    buffer_load_dwordx4 v[48:51], v2, s[8:11], s41 offen sc1
    s_waitcnt vmcnt(2)
    v_max3_u32 v7, v52, v53, v54
    v_max_u32 v7, v7, v55
    v_cmp_eq_u32 vcc, s34, v7
    s_cbranch_vccz L_ok_e_197
    buffer_load_dwordx4 v[52:55], v3, s[8:11], s41 offen sc1
    s_waitcnt vmcnt(2)
    v_max3_u32 v7, v48, v49, v50
    v_max_u32 v7, v7, v51
    v_cmp_eq_u32 vcc, s34, v7
    s_cbranch_vccz L_ok_e_198
    s_add_u32 s33, s33, 1
    s_cmp_gt_u32 s33, 0x100000
    s_cbranch_scc0 L_q_e_195
    s_branch chain_kernel_abort
L_ok_e_197:
    v_smfmac_f32_16x16x64_bf16 v[88:91], v[52:55], a[200:207], v6
    v_smfmac_f32_16x16x64_bf16 v[92:95], v[52:55], a[232:239], v6
    s_branch L_q_e_173
L_ok_e_198:
    v_smfmac_f32_16x16x64_bf16 v[88:91], v[48:51], a[192:199], v6
    v_smfmac_f32_16x16x64_bf16 v[92:95], v[48:51], a[224:231], v6
    s_branch L_q_e_149
L_q_e_193:
    buffer_load_dwordx4 v[60:63], v5, s[8:11], s41 offen sc1
    s_waitcnt vmcnt(2)
    v_max3_u32 v7, v48, v49, v50
    v_max_u32 v7, v7, v51
    v_cmp_eq_u32 vcc, s34, v7
    s_cbranch_vccnz L_q_e_199
L_v_e_200:
    v_smfmac_f32_16x16x64_bf16 v[88:91], v[48:51], a[192:199], v6
    s_waitcnt vmcnt(1)
    v_max3_u32 v7, v52, v53, v54
    v_max_u32 v7, v7, v55
    v_cmp_eq_u32 vcc, s34, v7
    v_smfmac_f32_16x16x64_bf16 v[92:95], v[48:51], a[224:231], v6
    s_cbranch_vccnz L_q_e_152
    s_branch L_v_e_153
L_q_e_199:
    buffer_load_dwordx4 v[48:51], v2, s[8:11], s41 offen sc1
    s_waitcnt vmcnt(2)
    v_max3_u32 v7, v52, v53, v54
    v_max_u32 v7, v7, v55
    v_cmp_eq_u32 vcc, s34, v7
    s_cbranch_vccz L_ok_e_201
    buffer_load_dwordx4 v[52:55], v3, s[8:11], s41 offen sc1
    s_waitcnt vmcnt(2)
    v_max3_u32 v7, v60, v61, v62
    v_max_u32 v7, v7, v63
    v_cmp_eq_u32 vcc, s34, v7
    s_cbranch_vccz L_ok_e_202
    buffer_load_dwordx4 v[60:63], v5, s[8:11], s41 offen sc1
    s_waitcnt vmcnt(2)
    v_max3_u32 v7, v48, v49, v50
    v_max_u32 v7, v7, v51
    v_cmp_eq_u32 vcc, s34, v7
    s_cbranch_vccz L_ok_e_203
    s_add_u32 s33, s33, 1
    s_cmp_gt_u32 s33, 0x100000
    s_cbranch_scc0 L_q_e_199
    s_branch chain_kernel_abort
L_ok_e_201:
    v_smfmac_f32_16x16x64_bf16 v[88:91], v[52:55], a[200:207], v6
    v_smfmac_f32_16x16x64_bf16 v[92:95], v[52:55], a[232:239], v6
    s_branch L_q_e_176
L_ok_e_202:
    v_smfmac_f32_16x16x64_bf16 v[88:91], v[60:63], a[216:223], v6
    v_smfmac_f32_16x16x64_bf16 v[92:95], v[60:63], a[248:255], v6
    s_branch L_q_e_195
L_ok_e_203:
    v_smfmac_f32_16x16x64_bf16 v[88:91], v[48:51], a[192:199], v6
    v_smfmac_f32_16x16x64_bf16 v[92:95], v[48:51], a[224:231], v6
    s_branch L_q_e_152
L_q_e_191:
    buffer_load_dwordx4 v[56:59], v4, s[8:11], s41 offen sc1
    s_waitcnt vmcnt(3)
    v_max3_u32 v7, v60, v61, v62
    v_max_u32 v7, v7, v63
    v_cmp_eq_u32 vcc, s34, v7
    s_cbranch_vccnz L_q_e_204
L_v_e_205:
    v_smfmac_f32_16x16x64_bf16 v[88:91], v[60:63], a[216:223], v6
    s_waitcnt vmcnt(2)
    v_max3_u32 v7, v48, v49, v50
    v_max_u32 v7, v7, v51
    v_cmp_eq_u32 vcc, s34, v7
    v_smfmac_f32_16x16x64_bf16 v[92:95], v[60:63], a[248:255], v6
    s_cbranch_vccnz L_q_e_206
L_v_e_207:
    v_smfmac_f32_16x16x64_bf16 v[88:91], v[48:51], a[192:199], v6
    s_waitcnt vmcnt(1)
    v_max3_u32 v7, v52, v53, v54
    v_max_u32 v7, v7, v55
    v_cmp_eq_u32 vcc, s34, v7
    v_smfmac_f32_16x16x64_bf16 v[92:95], v[48:51], a[224:231], v6
    s_cbranch_vccnz L_q_e_158
    s_branch L_v_e_159
L_q_e_206:
    buffer_load_dwordx4 v[48:51], v2, s[8:11], s41 offen sc1
    s_waitcnt vmcnt(2)
    v_max3_u32 v7, v52, v53, v54
    v_max_u32 v7, v7, v55
    v_cmp_eq_u32 vcc, s34, v7
    s_cbranch_vccz L_ok_e_208
    buffer_load_dwordx4 v[52:55], v3, s[8:11], s41 offen sc1
    s_waitcnt vmcnt(2)
    v_max3_u32 v7, v56, v57, v58
    v_max_u32 v7, v7, v59
    v_cmp_eq_u32 vcc, s34, v7
    s_cbranch_vccz L_ok_e_209
    buffer_load_dwordx4 v[56:59], v4, s[8:11], s41 offen sc1
    s_waitcnt vmcnt(2)
    v_max3_u32 v7, v48, v49, v50
    v_max_u32 v7, v7, v51
    v_cmp_eq_u32 vcc, s34, v7
    s_cbranch_vccz L_ok_e_210
    s_add_u32 s33, s33, 1
    s_cmp_gt_u32 s33, 0x100000
    s_cbranch_scc0 L_q_e_206
    s_branch chain_kernel_abort
L_ok_e_208:
    v_smfmac_f32_16x16x64_bf16 v[88:91], v[52:55], a[200:207], v6
    v_smfmac_f32_16x16x64_bf16 v[92:95], v[52:55], a[232:239], v6
    s_branch L_q_e_182
L_ok_e_209:
    v_smfmac_f32_16x16x64_bf16 v[88:91], v[56:59], a[208:215], v6
    v_smfmac_f32_16x16x64_bf16 v[92:95], v[56:59], a[240:247], v6
    s_branch L_q_e_195
L_ok_e_210:
    v_smfmac_f32_16x16x64_bf16 v[88:91], v[48:51], a[192:199], v6
    v_smfmac_f32_16x16x64_bf16 v[92:95], v[48:51], a[224:231], v6
    s_branch L_q_e_158
L_q_e_204:
    buffer_load_dwordx4 v[60:63], v5, s[8:11], s41 offen sc1
    s_waitcnt vmcnt(3)
    v_max3_u32 v7, v48, v49, v50
    v_max_u32 v7, v7, v51
    v_cmp_eq_u32 vcc, s34, v7
    s_cbranch_vccnz L_q_e_211
L_v_e_212:
    v_smfmac_f32_16x16x64_bf16 v[88:91], v[48:51], a[192:199], v6
    s_waitcnt vmcnt(2)
    v_max3_u32 v7, v52, v53, v54
    v_max_u32 v7, v7, v55
    v_cmp_eq_u32 vcc, s34, v7
    v_smfmac_f32_16x16x64_bf16 v[92:95], v[48:51], a[224:231], v6
    s_cbranch_vccnz L_q_e_162
    s_branch L_v_e_163
L_q_e_211:
    buffer_load_dwordx4 v[48:51], v2, s[8:11], s41 offen sc1
    s_waitcnt vmcnt(2)
    v_max3_u32 v7, v52, v53, v54
    v_max_u32 v7, v7, v55
    v_cmp_eq_u32 vcc, s34, v7
    s_cbranch_vccz L_ok_e_213
    buffer_load_dwordx4 v[52:55], v3, s[8:11], s41 offen sc1
    s_waitcnt vmcnt(2)
    v_max3_u32 v7, v56, v57, v58
    v_max_u32 v7, v7, v59
    v_cmp_eq_u32 vcc, s34, v7
    s_cbranch_vccz L_ok_e_214
    buffer_load_dwordx4 v[56:59], v4, s[8:11], s41 offen sc1
    s_waitcnt vmcnt(2)
    v_max3_u32 v7, v60, v61, v62
    v_max_u32 v7, v7, v63
    v_cmp_eq_u32 vcc, s34, v7
    s_cbranch_vccz L_ok_e_215
    buffer_load_dwordx4 v[60:63], v5, s[8:11], s41 offen sc1
    s_waitcnt vmcnt(2)
    v_max3_u32 v7, v48, v49, v50
    v_max_u32 v7, v7, v51
    v_cmp_eq_u32 vcc, s34, v7
    s_cbranch_vccz L_ok_e_216
    s_add_u32 s33, s33, 1
    s_cmp_gt_u32 s33, 0x100000
    s_cbranch_scc0 L_q_e_211
    s_branch chain_kernel_abort
L_ok_e_213:
    v_smfmac_f32_16x16x64_bf16 v[88:91], v[52:55], a[200:207], v6
    v_smfmac_f32_16x16x64_bf16 v[92:95], v[52:55], a[232:239], v6
    s_branch L_q_e_186
L_ok_e_214:
    v_smfmac_f32_16x16x64_bf16 v[88:91], v[56:59], a[208:215], v6
    v_smfmac_f32_16x16x64_bf16 v[92:95], v[56:59], a[240:247], v6
    s_branch L_q_e_199
L_ok_e_215:
    v_smfmac_f32_16x16x64_bf16 v[88:91], v[60:63], a[216:223], v6
    v_smfmac_f32_16x16x64_bf16 v[92:95], v[60:63], a[248:255], v6
    s_branch L_q_e_206
L_ok_e_216:
    v_smfmac_f32_16x16x64_bf16 v[88:91], v[48:51], a[192:199], v6
    v_smfmac_f32_16x16x64_bf16 v[92:95], v[48:51], a[224:231], v6
    s_branch L_q_e_162
L_gf_217:
    s_waitcnt vmcnt(4)
    v_lshlrev_b32 v100, 16, v212
    v_and_b32 v101, 0xffff0000, v212
    v_lshlrev_b32 v102, 16, v213
    v_and_b32 v103, 0xffff0000, v213
    v_pk_add_f32 v[148:149], v[168:169], v[100:101]
    v_pk_add_f32 v[150:151], v[170:171], v[102:103]
    s_waitcnt vmcnt(3)
    v_lshlrev_b32 v100, 16, v214
    v_and_b32 v101, 0xffff0000, v214
    v_lshlrev_b32 v102, 16, v215
    v_and_b32 v103, 0xffff0000, v215
    v_pk_add_f32 v[148:149], v[148:149], v[100:101]
    v_pk_add_f32 v[150:151], v[150:151], v[102:103]
    s_waitcnt vmcnt(2)
    v_lshlrev_b32 v100, 16, v216
    v_and_b32 v101, 0xffff0000, v216
    v_lshlrev_b32 v102, 16, v217
    v_and_b32 v103, 0xffff0000, v217
    v_pk_add_f32 v[148:149], v[148:149], v[100:101]
    v_pk_add_f32 v[150:151], v[150:151], v[102:103]
    v_cmp_u_f32 vcc, v148, v150
    v_cvt_pk_bf16_f32 v180, v148, v149
    v_cvt_pk_bf16_f32 v181, v150, v151
    s_cbranch_vccz L_gok_218
    buffer_load_dwordx2 v[212:213], v17, s[8:11], s22 offen offset:512 sc1
    buffer_load_dwordx2 v[214:215], v18, s[8:11], s22 offen offset:512 sc1
    buffer_load_dwordx2 v[216:217], v19, s[8:11], s22 offen offset:512 sc1
    s_nop 11
L_rt_220:
    buffer_load_dwordx2 v[200:201], v17, s[8:11], s22 offen offset:0 sc1
    buffer_load_dwordx2 v[202:203], v18, s[8:11], s22 offen offset:0 sc1
    buffer_load_dwordx2 v[204:205], v19, s[8:11], s22 offen offset:0 sc1
    s_waitcnt vmcnt(5)
    v_lshlrev_b32 v100, 16, v212
    v_and_b32 v101, 0xffff0000, v212
    v_lshlrev_b32 v102, 16, v213
    v_and_b32 v103, 0xffff0000, v213
    v_pk_add_f32 v[148:149], v[168:169], v[100:101]
    v_pk_add_f32 v[150:151], v[170:171], v[102:103]
    s_waitcnt vmcnt(4)
    v_lshlrev_b32 v100, 16, v214
    v_and_b32 v101, 0xffff0000, v214
    v_lshlrev_b32 v102, 16, v215
    v_and_b32 v103, 0xffff0000, v215
    v_pk_add_f32 v[148:149], v[148:149], v[100:101]
    v_pk_add_f32 v[150:151], v[150:151], v[102:103]
    s_waitcnt vmcnt(3)
    v_lshlrev_b32 v100, 16, v216
    v_and_b32 v101, 0xffff0000, v216
    v_lshlrev_b32 v102, 16, v217
    v_and_b32 v103, 0xffff0000, v217
    v_pk_add_f32 v[148:149], v[148:149], v[100:101]
    v_pk_add_f32 v[150:151], v[150:151], v[102:103]
    v_cmp_u_f32 vcc, v148, v150
    v_cvt_pk_bf16_f32 v180, v148, v149
    v_cvt_pk_bf16_f32 v181, v150, v151
    s_cbranch_vccz L_gok_218
    buffer_load_dwordx2 v[212:213], v17, s[8:11], s22 offen offset:512 sc1
    buffer_load_dwordx2 v[214:215], v18, s[8:11], s22 offen offset:512 sc1
    buffer_load_dwordx2 v[216:217], v19, s[8:11], s22 offen offset:512 sc1
    s_waitcnt vmcnt(5)
    v_lshlrev_b32 v100, 16, v200
    v_and_b32 v101, 0xffff0000, v200
    v_lshlrev_b32 v102, 16, v201
    v_and_b32 v103, 0xffff0000, v201
    v_pk_add_f32 v[148:149], v[168:169], v[100:101]
    v_pk_add_f32 v[150:151], v[170:171], v[102:103]
    s_waitcnt vmcnt(4)
    v_lshlrev_b32 v100, 16, v202
    v_and_b32 v101, 0xffff0000, v202
    v_lshlrev_b32 v102, 16, v203
    v_and_b32 v103, 0xffff0000, v203
    v_pk_add_f32 v[148:149], v[148:149], v[100:101]
    v_pk_add_f32 v[150:151], v[150:151], v[102:103]
    s_waitcnt vmcnt(3)
    v_lshlrev_b32 v100, 16, v204
    v_and_b32 v101, 0xffff0000, v204
    v_lshlrev_b32 v102, 16, v205
    v_and_b32 v103, 0xffff0000, v205
    v_pk_add_f32 v[148:149], v[148:149], v[100:101]
    v_pk_add_f32 v[150:151], v[150:151], v[102:103]
    v_cmp_u_f32 vcc, v148, v150
    v_cvt_pk_bf16_f32 v180, v148, v149
    v_cvt_pk_bf16_f32 v181, v150, v151
    s_cbranch_vccz L_gok_218
    s_add_u32 s33, s33, 1
    s_cmp_gt_u32 s33, 0x100000
    s_cbranch_scc1 chain_kernel_abort
    s_and_b32 s20, s33, 63
    s_cbranch_scc1 L_rt_220
    v_cmp_eq_u32 vcc, s34, v200
    v_cmp_eq_u32 s[20:21], s34, v201
    s_or_b64 vcc, vcc, s[20:21]
    v_cmp_eq_u32 s[20:21], s34, v202
    s_or_b64 vcc, vcc, s[20:21]
    v_cmp_eq_u32 s[20:21], s34, v203
    s_or_b64 vcc, vcc, s[20:21]
    v_cmp_eq_u32 s[20:21], s34, v204
    s_or_b64 vcc, vcc, s[20:21]
    v_cmp_eq_u32 s[20:21], s34, v205
    s_or_b64 vcc, vcc, s[20:21]
    s_cbranch_vccnz L_rt_220
    s_branch L_gok_218
L_slow_16:
L_step_224:
    s_nop 15
    s_nop 7
L_step_224_nd:
    buffer_load_dwordx4 v[48:51], v2, s[8:11], s38 offen sc1
    v_mov_b32 v88, 0
    v_mov_b32 v89, 0
    v_mov_b32 v90, 0
    v_mov_b32 v91, 0
    v_mov_b32 v92, 0
    v_mov_b32 v93, 0
    v_mov_b32 v94, 0
    v_mov_b32 v95, 0
    ds_read_b128 v[116:119], v25
    ds_read_b128 v[120:123], v25 offset:1024
    v_xor_b32 v25, 0x1000, v25
    s_nop 0
    buffer_load_dwordx4 v[52:55], v3, s[8:11], s38 offen sc1
    s_nop 11
    buffer_load_dwordx4 v[56:59], v4, s[8:11], s38 offen sc1
    s_nop 11
    buffer_load_dwordx4 v[60:63], v5, s[8:11], s38 offen sc1
    s_waitcnt vmcnt(3)
    v_max3_u32 v7, v48, v49, v50
    v_max_u32 v7, v7, v51
    v_cmp_eq_u32 vcc, s34, v7
    s_cbranch_vccnz L_q_a_231
L_v_a_232:
    v_smfmac_f32_16x16x64_bf16 v[64:67], v[48:51], a[0:7], v6
    s_waitcnt vmcnt(2)
    v_max3_u32 v7, v52, v53, v54
    v_max_u32 v7, v7, v55
    v_smfmac_f32_16x16x64_bf16 v[68:71], v[48:51], a[64:71], v6
    v_cmp_eq_u32 vcc, s34, v7
    v_smfmac_f32_16x16x64_bf16 v[72:75], v[48:51], a[32:39], v6
    v_smfmac_f32_16x16x64_bf16 v[76:79], v[48:51], a[96:103], v6
    s_cbranch_vccnz L_q_a_233
L_v_a_234:
    v_smfmac_f32_16x16x64_bf16 v[64:67], v[52:55], a[8:15], v6
    s_waitcnt vmcnt(1)
    v_max3_u32 v7, v56, v57, v58
    v_max_u32 v7, v7, v59
    v_smfmac_f32_16x16x64_bf16 v[68:71], v[52:55], a[72:79], v6
    v_cmp_eq_u32 vcc, s34, v7
    v_smfmac_f32_16x16x64_bf16 v[72:75], v[52:55], a[40:47], v6
    v_smfmac_f32_16x16x64_bf16 v[76:79], v[52:55], a[104:111], v6
    s_cbranch_vccnz L_q_a_235
L_v_a_236:
    v_smfmac_f32_16x16x64_bf16 v[64:67], v[56:59], a[16:23], v6
    s_waitcnt vmcnt(0)
    v_max3_u32 v7, v60, v61, v62
    v_max_u32 v7, v7, v63
    v_smfmac_f32_16x16x64_bf16 v[68:71], v[56:59], a[80:87], v6
    v_cmp_eq_u32 vcc, s34, v7
    v_smfmac_f32_16x16x64_bf16 v[72:75], v[56:59], a[48:55], v6
    v_smfmac_f32_16x16x64_bf16 v[76:79], v[56:59], a[112:119], v6
    s_cbranch_vccnz L_q_a_237
L_v_a_238:
    v_smfmac_f32_16x16x64_bf16 v[64:67], v[60:63], a[24:31], v6
    v_smfmac_f32_16x16x64_bf16 v[68:71], v[60:63], a[88:95], v6
    v_smfmac_f32_16x16x64_bf16 v[72:75], v[60:63], a[56:63], v6
    v_smfmac_f32_16x16x64_bf16 v[76:79], v[60:63], a[120:127], v6
L_gd_a_230:
    v_cvt_pk_bf16_f32 v96, v64, v65
    v_cvt_pk_bf16_f32 v97, v66, v67
    v_cvt_pk_bf16_f32 v98, v68, v69
    v_cvt_pk_bf16_f32 v99, v70, v71
    s_cmp_lg_u32 s18, 0
    v_cvt_pk_bf16_f32 v100, v72, v73
    v_mfma_f32_16x16x32_bf16 v[104:107], v[96:99], v[40:43], 0
    v_cvt_pk_bf16_f32 v101, v74, v75
    v_cvt_pk_bf16_f32 v102, v76, v77
    v_cvt_pk_bf16_f32 v103, v78, v79
    s_nop 1
    v_mfma_f32_16x16x32_bf16 v[108:111], v[100:103], v[40:43], 0
    s_cbranch_scc0 L_help1_225_w0
    s_nop 0
    ds_write_b128 v20, v[104:107]
    s_nop 4
    ds_write_b128 v20, v[108:111] offset:1024
    s_waitcnt lgkmcnt(0)
    s_barrier
    v_smfmac_f32_16x16x64_bf16 v[80:83], v[48:51], a[128:135], v6
    v_smfmac_f32_16x16x64_bf16 v[84:87], v[48:51], a[160:167], v6
    v_smfmac_f32_16x16x64_bf16 v[80:83], v[52:55], a[136:143], v6
    v_smfmac_f32_16x16x64_bf16 v[84:87], v[52:55], a[168:175], v6
    v_smfmac_f32_16x16x64_bf16 v[80:83], v[56:59], a[144:151], v6
    v_smfmac_f32_16x16x64_bf16 v[84:87], v[56:59], a[176:183], v6
    v_smfmac_f32_16x16x64_bf16 v[80:83], v[60:63], a[152:159], v6
    v_smfmac_f32_16x16x64_bf16 v[84:87], v[60:63], a[184:191], v6
    s_nop 4
    ds_write_b128 v21, v[80:83]
    s_nop 1
    ds_write_b128 v21, v[84:87] offset:512
    s_waitcnt lgkmcnt(0)
L_bar2b_323_2:
    s_barrier
    s_cmp_eq_u32 s18, 1
    s_cbranch_scc1 L_vred_322
L_bar2b_323:
    s_waitcnt lgkmcnt(0)
    s_barrier
    s_cmp_eq_u32 s19, 63
    s_cbranch_scc1 L_fin_229
    s_cmp_lg_u32 s18, 2
    s_cbranch_scc1 L_poe_324
    s_sub_u32 s20, s19, 1
    s_and_b32 s20, s20, 3
    s_lshl_b32 s21, s20, 16
    s_add_u32 s21, s21, s36
    s_add_u32 s22, s21, 0x140000
    s_lshl_b32 s23, s20, 18
    s_add_u32 s23, s23, s37
    buffer_store_dwordx2 v[36:37], v8, s[8:11], s21 offen sc1
    buffer_store_dwordx2 v[36:37], v28, s[8:11], s22 offen sc1
    buffer_store_dwordx4 v[36:39], v9, s[8:11], s23 offen sc1
    s_mov_b64 exec, s[28:29]
    buffer_store_dwordx4 v[36:39], v10, s[8:11], s23 offen sc1
    s_mov_b64 exec, -1
L_poe_324:
    s_cmp_lg_u32 s18, 3
    s_cbranch_scc1 L_bar3_226
    s_cmp_ge_u32 s19, 2
    s_cbranch_scc1 L_gated_325
    s_add_u32 s23, s19, 1
    s_lshl_b32 s21, s23, 7
    s_add_u32 s21, s21, 0x5900000
    v_mov_b32 v34, 0
L_dw_326:
    buffer_load_dword v35, v34, s[8:11], s21 offen sc1
    s_add_u32 s33, s33, 1
    s_cmp_gt_u32 s33, 0x100000
    s_waitcnt vmcnt(0)
    s_cbranch_scc1 chain_kernel_abort
    v_readfirstlane_b32 s20, v35
    s_cmp_ge_u32 s20, 64
    s_cbranch_scc1 L_dwok_327
    s_sleep 2
    s_branch L_dw_326
L_dwok_327:
L_gated_325:
    s_add_u32 m0, s43, 0
    s_nop 0
    buffer_load_dwordx4 v27, s[8:11], s31 offen offset:0 lds
    s_add_u32 m0, s43, 896
    s_nop 0
    buffer_load_dwordx4 v27, s[8:11], s31 offen offset:128 lds
    s_add_u32 m0, s43, 0
    s_nop 0
    buffer_load_dwordx4 v29, s[8:11], s31 offen offset:2048 lds
    s_add_u32 m0, s43, 960
    s_nop 0
    buffer_load_dwordx4 v29, s[8:11], s31 offen offset:2112 lds
    s_xor_b32 s43, s43, 4096
    s_branch L_bar3_226
L_vred_322:
    ds_read_b64 v[168:169], v22 offset:0
    ds_read_b64 v[170:171], v22 offset:512
    ds_read_b64 v[172:173], v22 offset:1024
    ds_read_b64 v[174:175], v22 offset:1536
    ds_read_b64 v[176:177], v22 offset:2048
    ds_read_b64 v[178:179], v22 offset:2560
    ds_read_b64 v[180:181], v22 offset:3072
    ds_read_b64 v[182:183], v22 offset:3584
    ds_read_b64 v[184:185], v22 offset:4096
    ds_read_b64 v[186:187], v22 offset:4608
    ds_read_b64 v[188:189], v22 offset:5120
    ds_read_b64 v[190:191], v22 offset:5632
    ds_read_b64 v[192:193], v22 offset:6144
    ds_read_b64 v[194:195], v22 offset:6656
    ds_read_b64 v[196:197], v22 offset:7168
    s_waitcnt lgkmcnt(11)
    ds_read_b64 v[198:199], v22 offset:7680
    s_waitcnt lgkmcnt(8)
    v_pk_add_f32 v[168:169], v[168:169], v[172:173]
    v_pk_add_f32 v[170:171], v[170:171], v[174:175]
    v_pk_add_f32 v[176:177], v[176:177], v[180:181]
    v_pk_add_f32 v[178:179], v[178:179], v[182:183]
    v_pk_add_f32 v[168:169], v[168:169], v[176:177]
    v_pk_add_f32 v[170:171], v[170:171], v[178:179]
    s_waitcnt lgkmcnt(0)
    v_pk_add_f32 v[184:185], v[184:185], v[188:189]
    v_pk_add_f32 v[186:187], v[186:187], v[190:191]
    v_pk_add_f32 v[192:193], v[192:193], v[196:197]
    v_pk_add_f32 v[194:195], v[194:195], v[198:199]
    v_pk_add_f32 v[168:169], v[168:169], v[184:185]
    v_pk_add_f32 v[170:171], v[170:171], v[186:187]
    v_pk_add_f32 v[168:169], v[168:169], v[192:193]
    v_pk_add_f32 v[170:171], v[170:171], v[194:195]
    v_cvt_pk_bf16_f32 v144, v168, v169
    v_cvt_pk_bf16_f32 v146, v170, v171
    ds_write2_b32 v32, v144, v146 offset0:0 offset1:16
    s_branch L_bar2b_323
L_help1_225_w0:
    v_smfmac_f32_16x16x64_bf16 v[80:83], v[48:51], a[128:135], v6
    v_smfmac_f32_16x16x64_bf16 v[84:87], v[48:51], a[160:167], v6
    v_smfmac_f32_16x16x64_bf16 v[80:83], v[52:55], a[136:143], v6
    v_smfmac_f32_16x16x64_bf16 v[84:87], v[52:55], a[168:175], v6
    v_smfmac_f32_16x16x64_bf16 v[80:83], v[56:59], a[144:151], v6
    v_smfmac_f32_16x16x64_bf16 v[84:87], v[56:59], a[176:183], v6
    v_smfmac_f32_16x16x64_bf16 v[80:83], v[60:63], a[152:159], v6
    v_smfmac_f32_16x16x64_bf16 v[84:87], v[60:63], a[184:191], v6
    s_nop 4
    ds_write_b128 v21, v[80:83]
    s_nop 1
    ds_write_b128 v21, v[84:87] offset:512
    s_barrier
    ds_read_b128 v[168:171], v1 offset:2048
    ds_read_b128 v[172:175], v1 offset:3072
    ds_read_b128 v[176:179], v1 offset:4096
    ds_read_b128 v[180:183], v1 offset:5120
    ds_read_b128 v[184:187], v1 offset:6144
    ds_read_b128 v[188:191], v1 offset:7168
    s_waitcnt lgkmcnt(4)
    v_pk_add_f32 v[104:105], v[104:105], v[168:169]
    v_pk_add_f32 v[106:107], v[106:107], v[170:171]
    v_pk_add_f32 v[108:109], v[108:109], v[172:173]
    v_pk_add_f32 v[110:111], v[110:111], v[174:175]
    s_waitcnt lgkmcnt(2)
    v_pk_add_f32 v[104:105], v[104:105], v[176:177]
    v_pk_add_f32 v[106:107], v[106:107], v[178:179]
    v_pk_add_f32 v[108:109], v[108:109], v[180:181]
    v_pk_add_f32 v[110:111], v[110:111], v[182:183]
    s_waitcnt lgkmcnt(0)
    v_pk_add_f32 v[104:105], v[104:105], v[184:185]
    v_pk_add_f32 v[106:107], v[106:107], v[186:187]
    v_pk_add_f32 v[108:109], v[108:109], v[188:189]
    v_pk_add_f32 v[110:111], v[110:111], v[190:191]
    v_cvt_pk_bf16_f32 v112, v104, v105
    v_cvt_pk_bf16_f32 v113, v106, v107
    v_cvt_pk_bf16_f32 v114, v108, v109
    v_cvt_pk_bf16_f32 v115, v110, v111
    s_mov_b64 exec, s[28:29]
    s_nop 0
    v_mfma_f32_16x16x32_bf16 v[132:135], v[112:115], v[112:115], 0
    v_mfma_f32_16x16x32_bf16 v[124:127], v[116:119], v[112:115], 0
    v_mfma_f32_16x16x32_bf16 v[128:131], v[120:123], v[112:115], 0
    s_nop 3
    buffer_store_dwordx4 v[132:135], v10, s[8:11], s40 offen sc1
    s_mov_b64 exec, s[24:25]
    buffer_store_dwordx4 v[124:127], v9, s[8:11], s40 offen sc1
    s_nop 0
    buffer_store_dwordx4 v[128:131], v9, s[8:11], s40 offen offset:128 sc1
    s_mov_b64 exec, -1
    ds_write_b128 v1, v[112:115] offset:32768
    ds_read_b128 v[136:139], v26 offset:0
    ds_read_b128 v[140:143], v26 offset:1024
    v_mov_b32_dpp v124, v128 row_shr:8 row_mask:0xf bank_mask:0xc
    v_mov_b32_dpp v125, v129 row_shr:8 row_mask:0xf bank_mask:0xc
    v_mov_b32_dpp v126, v130 row_shr:8 row_mask:0xf bank_mask:0xc
    v_mov_b32_dpp v127, v131 row_shr:8 row_mask:0xf bank_mask:0xc
    v_xor_b32 v26, 0x1000, v26
    s_cmp_eq_u32 s19, 63
    s_cbranch_scc1 L_bar2b_323_2
    s_nop 11
    buffer_load_dwordx4 v[200:203], v16, s[8:11], s40 offen sc1
    buffer_load_dwordx4 v[204:207], v13, s[8:11], s40 offen sc1
    buffer_load_dwordx4 v[208:211], v14, s[8:11], s40 offen sc1
    buffer_load_dwordx4 v[212:215], v15, s[8:11], s40 offen sc1
    s_barrier
    s_nop 15
    s_nop 13
    buffer_load_dwordx4 v[216:219], v16, s[8:11], s40 offen sc1
    buffer_load_dwordx4 v[220:223], v13, s[8:11], s40 offen sc1
    buffer_load_dwordx4 v[224:227], v14, s[8:11], s40 offen sc1
    buffer_load_dwordx4 v[228:231], v15, s[8:11], s40 offen sc1
    s_waitcnt vmcnt(7)
    v_permlane32_swap_b32 v200, v202
    v_permlane32_swap_b32 v201, v203
    s_waitcnt vmcnt(6)
    v_pk_add_f32 v[154:155], v[200:201], v[202:203]
    v_pk_add_f32 v[148:149], v[124:125], v[204:205]
    v_pk_add_f32 v[150:151], v[126:127], v[206:207]
    v_permlane16_swap_b32 v154, v155
    s_waitcnt vmcnt(5)
    v_pk_add_f32 v[148:149], v[148:149], v[208:209]
    v_pk_add_f32 v[150:151], v[150:151], v[210:211]
    v_add_f32 v152, v154, v155
    s_waitcnt vmcnt(4)
    v_pk_add_f32 v[148:149], v[148:149], v[212:213]
    v_pk_add_f32 v[150:151], v[150:151], v[214:215]
    v_pk_add_f32 v[154:155], v[148:149], v[150:151]
    v_add_f32 v154, v154, v152
    v_cmp_u_f32 vcc, v154, v155
    v_max3_f32 v154, v148, v149, v150
    v_max3_f32 v154, v154, v151, v152
    s_nop 1
    v_max_f32_dpp v154, v154, v154 row_ror:8 row_mask:0xf bank_mask:0xf
    s_cbranch_vccnz L_cf_329
L_chead_331:
    v_mov_b32 v156, v154
    s_waitcnt lgkmcnt(0)
    s_barrier
    v_permlane16_swap_b32 v154, v156
    v_max_f32 v154, v154, v156
    v_mov_b32 v156, v154
    ds_read_b32 v144, v32
    ds_read_b32 v146, v32 offset:64
    v_permlane32_swap_b32 v154, v156
    v_max_f32 v154, v154, v156
    v_mul_f32 v154, s44, v154
    v_fma_f32 v152, v152, s44, -v154
    v_exp_f32 v152, v152
    v_pk_fma_f32 v[148:149], v[148:149], s[44:45], v[154:155] op_sel_hi:[1,1,0] neg_lo:[0,0,1] neg_hi:[0,0,1]
    v_pk_fma_f32 v[150:151], v[150:151], s[44:45], v[154:155] op_sel_hi:[1,1,0] neg_lo:[0,0,1] neg_hi:[0,0,1]
    v_mov_b32_dpp v156, v152 row_ror:8 row_mask:0xf bank_mask:0xf
    v_exp_f32 v148, v148
    v_cvt_pk_bf16_f32 v164, v152, v156
    v_exp_f32 v149, v149
    v_exp_f32 v150, v150
    v_mfma_f32_16x16x16_bf16 v[176:179], v[44:45], v[164:165], 0
    v_exp_f32 v151, v151
    s_waitcnt lgkmcnt(0)
    v_cvt_pk_bf16_f32 v160, v148, v149
    v_mfma_f32_16x16x16_bf16 v[168:171], v[144:145], v[164:165], 0
    v_cvt_pk_bf16_f32 v161, v150, v151
    v_mov_b32_dpp v162, v160 row_ror:8 row_mask:0xf bank_mask:0xf
    v_mfma_f32_16x16x16_bf16 v[172:175], v[146:147], v[164:165], 0
    v_mov_b32_dpp v163, v161 row_ror:8 row_mask:0xf bank_mask:0xf
    s_nop 0
    s_mov_b64 exec, s[24:25]
    v_mfma_f32_16x16x32_bf16 v[176:179], v[44:47], v[160:163], v[176:179]
    v_mfma_f32_16x16x32_bf16 v[168:171], v[136:139], v[160:163], v[168:171]
    v_mfma_f32_16x16x32_bf16 v[172:175], v[140:143], v[160:163], v[172:175]
    s_nop 3
    v_rcp_f32 v176, v176
    s_nop 0
    v_pk_mul_f32 v[168:169], v[168:169], v[176:177] op_sel_hi:[1,0]
    v_pk_mul_f32 v[170:171], v[170:171], v[176:177] op_sel_hi:[1,0]
    v_pk_mul_f32 v[172:173], v[172:173], v[176:177] op_sel_hi:[1,0]
    v_pk_mul_f32 v[174:175], v[174:175], v[176:177] op_sel_hi:[1,0]
    v_cvt_pk_bf16_f32 v180, v168, v169
    v_cvt_pk_bf16_f32 v181, v170, v171
    v_cvt_pk_bf16_f32 v182, v172, v173
    v_cvt_pk_bf16_f32 v183, v174, v175
    buffer_store_dwordx4 v[180:183], v11, s[8:11], s41 offen sc1
    s_mov_b64 exec, -1
    s_barrier
    s_nop 15
    s_nop 3
    s_branch L_bar3_226_e
L_bar3_226:
    s_waitcnt lgkmcnt(0)
    s_barrier
    s_nop 15
    s_nop 7
L_bar3_226_e:
    buffer_load_dwordx4 v[48:51], v2, s[8:11], s41 offen sc1
    v_mov_b32 v64, 0
    v_mov_b32 v65, 0
    v_mov_b32 v66, 0
    v_mov_b32 v67, 0
    v_mov_b32 v68, 0
    v_mov_b32 v69, 0
    v_mov_b32 v70, 0
    v_mov_b32 v71, 0
    v_mov_b32 v72, 0
    v_mov_b32 v73, 0
    v_mov_b32 v74, 0
    v_mov_b32 v75, 0
    buffer_load_dwordx4 v[52:55], v3, s[8:11], s41 offen sc1
    v_mov_b32 v76, 0
    v_mov_b32 v77, 0
    v_mov_b32 v78, 0
    v_mov_b32 v79, 0
    v_mov_b32 v80, 0
    v_mov_b32 v81, 0
    v_mov_b32 v82, 0
    v_mov_b32 v83, 0
    v_mov_b32 v84, 0
    v_mov_b32 v85, 0
    v_mov_b32 v86, 0
    v_mov_b32 v87, 0
    buffer_load_dwordx4 v[56:59], v4, s[8:11], s41 offen sc1
    s_nop 11
    buffer_load_dwordx4 v[60:63], v5, s[8:11], s41 offen sc1
    s_waitcnt vmcnt(3)
    v_max3_u32 v7, v48, v49, v50
    v_max_u32 v7, v7, v51
    v_cmp_eq_u32 vcc, s34, v7
    s_cbranch_vccnz L_q_e_333
L_v_e_334:
    v_smfmac_f32_16x16x64_bf16 v[88:91], v[48:51], a[192:199], v6
    s_waitcnt vmcnt(2)
    v_max3_u32 v7, v52, v53, v54
    v_max_u32 v7, v7, v55
    v_cmp_eq_u32 vcc, s34, v7
    v_smfmac_f32_16x16x64_bf16 v[92:95], v[48:51], a[224:231], v6
    s_cbranch_vccnz L_q_e_335
L_v_e_336:
    v_smfmac_f32_16x16x64_bf16 v[88:91], v[52:55], a[200:207], v6
    s_waitcnt vmcnt(1)
    v_max3_u32 v7, v56, v57, v58
    v_max_u32 v7, v7, v59
    v_cmp_eq_u32 vcc, s34, v7
    v_smfmac_f32_16x16x64_bf16 v[92:95], v[52:55], a[232:239], v6
    s_cbranch_vccnz L_q_e_337
L_v_e_338:
    v_smfmac_f32_16x16x64_bf16 v[88:91], v[56:59], a[208:215], v6
    s_waitcnt vmcnt(0)
    v_max3_u32 v7, v60, v61, v62
    v_max_u32 v7, v7, v63
    v_cmp_eq_u32 vcc, s34, v7
    v_smfmac_f32_16x16x64_bf16 v[92:95], v[56:59], a[240:247], v6
    s_cbranch_vccnz L_q_e_339
L_v_e_340:
    v_smfmac_f32_16x16x64_bf16 v[88:91], v[60:63], a[216:223], v6
    v_smfmac_f32_16x16x64_bf16 v[92:95], v[60:63], a[248:255], v6
L_gd_e_332:
    s_add_u32 s19, s19, 1
    s_cmp_lg_u32 s18, 0
    s_nop 2
    v_cvt_pk_bf16_f32 v96, v88, v89
    v_cvt_pk_bf16_f32 v97, v90, v91
    s_nop 0
    v_cvt_pk_bf16_f32 v98, v92, v93
    v_cvt_pk_bf16_f32 v99, v94, v95
    s_nop 1
    v_mfma_f32_16x16x32_bf16 v[104:107], v[96:99], v[252:255], 0
    s_cbranch_scc1 L_help2_227
    s_barrier
    ds_read_b128 v[172:175], v1 offset:18432
    ds_read_b128 v[176:179], v1 offset:20480
    ds_read_b128 v[180:183], v1 offset:22528
    s_waitcnt lgkmcnt(2)
    v_pk_add_f32 v[168:169], v[104:105], v[172:173]
    v_pk_add_f32 v[170:171], v[106:107], v[174:175]
    s_waitcnt lgkmcnt(1)
    v_pk_add_f32 v[168:169], v[168:169], v[176:177]
    v_pk_add_f32 v[170:171], v[170:171], v[178:179]
    s_waitcnt lgkmcnt(0)
    v_pk_add_f32 v[168:169], v[168:169], v[180:181]
    v_pk_add_f32 v[170:171], v[170:171], v[182:183]
    v_cvt_pk_bf16_f32 v96, v168, v169
    v_cvt_pk_bf16_f32 v97, v170, v171
    buffer_store_dwordx2 v[96:97], v12, s[8:11], s42 offen offset:0 sc1
    buffer_store_dwordx2 v[96:97], v12, s[8:11], s42 offen offset:512 sc1
    s_mov_b32 s22, s42
    s_mov_b32 s23, s39
    s_and_b32 s20, s19, 3
    s_lshl_b32 s21, s20, 16
    s_add_u32 s38, s36, s21
    s_add_u32 s41, s38, 0x140000
    s_lshl_b32 s21, s20, 18
    s_add_u32 s40, s37, s21
    s_add_u32 s42, s31, 0x8000000
    s_add_u32 s21, s19, 1
    s_bitcmp1_b32 s21, 1
    s_cselect_b32 s31, s52, s35
    s_lshl_b32 s21, s21, 20
    s_add_u32 s31, s31, s21
    s_add_u32 s20, s20, 1
    s_and_b32 s20, s20, 3
    s_lshl_b32 s20, s20, 16
    s_add_u32 s39, s36, s20
    s_nop 15
    s_nop 15
    s_nop 15
    buffer_load_dwordx2 v[200:201], v17, s[8:11], s22 offen offset:0 sc1
    buffer_load_dwordx2 v[202:203], v18, s[8:11], s22 offen offset:0 sc1
    buffer_load_dwordx2 v[204:205], v19, s[8:11], s22 offen offset:0 sc1
    s_nop 15
    s_nop 15
    s_nop 15
    s_nop 11
    buffer_load_dwordx2 v[212:213], v17, s[8:11], s22 offen offset:512 sc1
    buffer_load_dwordx2 v[214:215], v18, s[8:11], s22 offen offset:512 sc1
    buffer_load_dwordx2 v[216:217], v19, s[8:11], s22 offen offset:512 sc1
    ds_read_b128 v[172:175], v1 offset:33792
    s_mov_b64 exec, s[26:27]
    s_waitcnt lgkmcnt(1)
    buffer_store_dwordx4 v[112:115], v30, s[8:11], s22 offen offset:3072 sc1
    s_mov_b64 exec, s[48:49]
    s_waitcnt lgkmcnt(0)
    buffer_store_dwordx4 v[172:175], v31, s[8:11], s22 offen offset:3584 sc1
    s_mov_b64 exec, -1
    s_waitcnt vmcnt(7)
    v_lshlrev_b32 v100, 16, v200
    v_and_b32 v101, 0xffff0000, v200
    v_lshlrev_b32 v102, 16, v201
    v_and_b32 v103, 0xffff0000, v201
    v_pk_add_f32 v[148:149], v[168:169], v[100:101]
    v_pk_add_f32 v[150:151], v[170:171], v[102:103]
    s_waitcnt vmcnt(6)
    v_lshlrev_b32 v100, 16, v202
    v_and_b32 v101, 0xffff0000, v202
    v_lshlrev_b32 v102, 16, v203
    v_and_b32 v103, 0xffff0000, v203
    v_pk_add_f32 v[148:149], v[148:149], v[100:101]
    v_pk_add_f32 v[150:151], v[150:151], v[102:103]
    s_waitcnt vmcnt(5)
    v_lshlrev_b32 v100, 16, v204
    v_and_b32 v101, 0xffff0000, v204
    v_lshlrev_b32 v102, 16, v205
    v_and_b32 v103, 0xffff0000, v205
    v_pk_add_f32 v[148:149], v[148:149], v[100:101]
    v_pk_add_f32 v[150:151], v[150:151], v[102:103]
    v_cmp_u_f32 vcc, v148, v150
    v_cvt_pk_bf16_f32 v180, v148, v149
    v_cvt_pk_bf16_f32 v181, v150, v151
    s_cbranch_vccnz L_gf_424
L_gok_425:
    buffer_store_dwordx2 v[180:181], v8, s[8:11], s23 offen sc1
    s_barrier
    s_branch L_step_224
L_help2_227:
    s_nop 2
    ds_write_b128 v20, v[104:107] offset:16384
    s_waitcnt lgkmcnt(0)
    s_barrier
    s_and_b32 s20, s19, 3
    s_lshl_b32 s21, s20, 16
    s_add_u32 s38, s36, s21
    s_add_u32 s41, s38, 0x140000
    s_lshl_b32 s21, s20, 18
    s_add_u32 s40, s37, s21
    s_add_u32 s42, s31, 0x8000000
    s_add_u32 s21, s19, 1
    s_bitcmp1_b32 s21, 1
    s_cselect_b32 s31, s52, s35
    s_lshl_b32 s21, s21, 20
    s_add_u32 s31, s31, s21
    s_add_u32 s20, s20, 1
    s_and_b32 s20, s20, 3
    s_lshl_b32 s20, s20, 16
    s_add_u32 s39, s36, s20
    s_cmp_eq_u32 s18, 3
    s_cbranch_scc1 L_w3_428
    s_xor_b32 s20, s18, 2
    s_or_b32 s20, s20, s16
    s_or_b32 s20, s20, s17
    s_cbranch_scc1 L_bar4_228
    s_cmp_lt_u32 s19, 3
    s_cbranch_scc1 L_bar4_228
    s_atomic_add s53, s[98:99], 0x4
    s_branch L_bar4_228
L_w3_428:
    s_or_b32 s20, s16, s17
    s_cbranch_scc1 L_bar4_228
    s_add_u32 s23, s19, 2
    s_min_u32 s23, s23, 63
    s_lshl_b32 s21, s23, 7
    v_mov_b32 v34, 0
L_dw_429:
    s_load_dword s20, s[54:55], s21 glc
    s_add_u32 s33, s33, 1
    s_cmp_gt_u32 s33, 0x100000
    s_waitcnt lgkmcnt(0)
    s_cbranch_scc1 chain_kernel_abort
    s_cmp_ge_u32 s20, 64
    s_cbranch_scc1 L_dwok_430
    s_sleep 2
    s_branch L_dw_429
L_dwok_430:
L_bar4_228:
    s_barrier
    s_branch L_step_224
L_fin_229:
    s_cmp_lg_u32 s18, 2
    s_cbranch_scc1 chain_kernel_done
    ds_read_b128 v[168:171], v1 offset:32768
    ds_read_b128 v[172:175], v1 offset:33792
    s_mov_b64 exec, s[26:27]
    s_waitcnt lgkmcnt(1)
    buffer_store_dwordx4 v[168:171], v30, s[8:11], s42 offen offset:3072 sc1
    s_mov_b64 exec, s[48:49]
    s_waitcnt lgkmcnt(0)
    buffer_store_dwordx4 v[172:175], v31, s[8:11], s42 offen offset:3584 sc1
    s_mov_b64 exec, -1
    s_branch chain_kernel_done
L_q_a_237:
    buffer_load_dwordx4 v[60:63], v5, s[8:11], s38 offen sc1
    s_waitcnt vmcnt(0)
    v_max3_u32 v7, v60, v61, v62
    v_max_u32 v7, v7, v63
    v_cmp_eq_u32 vcc, s34, v7
    s_cbranch_vccnz L_q_a_239
    s_branch L_v_a_238
L_q_a_239:
    buffer_load_dwordx4 v[60:63], v5, s[8:11], s38 offen sc1
    s_waitcnt vmcnt(2)
    v_max3_u32 v7, v60, v61, v62
    v_max_u32 v7, v7, v63
    v_cmp_eq_u32 vcc, s34, v7
    s_cbranch_vccz L_ok_a_240
    s_add_u32 s33, s33, 1
    s_cmp_gt_u32 s33, 0x100000
    s_cbranch_scc0 L_q_a_239
    s_branch chain_kernel_abort
L_ok_a_240:
    v_smfmac_f32_16x16x64_bf16 v[64:67], v[60:63], a[24:31], v6
    v_smfmac_f32_16x16x64_bf16 v[68:71], v[60:63], a[88:95], v6
    v_smfmac_f32_16x16x64_bf16 v[72:75], v[60:63], a[56:63], v6
    v_smfmac_f32_16x16x64_bf16 v[76:79], v[60:63], a[120:127], v6
    s_branch L_gd_a_230
L_q_a_235:
    buffer_load_dwordx4 v[56:59], v4, s[8:11], s38 offen sc1
    s_waitcnt vmcnt(1)
    v_max3_u32 v7, v60, v61, v62
    v_max_u32 v7, v7, v63
    v_cmp_eq_u32 vcc, s34, v7
    s_cbranch_vccnz L_q_a_241
L_v_a_242:
    v_smfmac_f32_16x16x64_bf16 v[64:67], v[60:63], a[24:31], v6
    s_waitcnt vmcnt(0)
    v_max3_u32 v7, v56, v57, v58
    v_max_u32 v7, v7, v59
    v_smfmac_f32_16x16x64_bf16 v[68:71], v[60:63], a[88:95], v6
    v_cmp_eq_u32 vcc, s34, v7
    v_smfmac_f32_16x16x64_bf16 v[72:75], v[60:63], a[56:63], v6
    v_smfmac_f32_16x16x64_bf16 v[76:79], v[60:63], a[120:127], v6
    s_cbranch_vccnz L_q_a_243
L_v_a_244:
    v_smfmac_f32_16x16x64_bf16 v[64:67], v[56:59], a[16:23], v6
    v_smfmac_f32_16x16x64_bf16 v[68:71], v[56:59], a[80:87], v6
    v_smfmac_f32_16x16x64_bf16 v[72:75], v[56:59], a[48:55], v6
    v_smfmac_f32_16x16x64_bf16 v[76:79], v[56:59], a[112:119], v6
    s_branch L_gd_a_230
L_q_a_243:
    buffer_load_dwordx4 v[56:59], v4, s[8:11], s38 offen sc1
    s_waitcnt vmcnt(2)
    v_max3_u32 v7, v56, v57, v58
    v_max_u32 v7, v7, v59
    v_cmp_eq_u32 vcc, s34, v7
    s_cbranch_vccz L_ok_a_245
    s_add_u32 s33, s33, 1
    s_cmp_gt_u32 s33, 0x100000
    s_cbranch_scc0 L_q_a_243
    s_branch chain_kernel_abort
L_ok_a_245:
    v_smfmac_f32_16x16x64_bf16 v[64:67], v[56:59], a[16:23], v6
    v_smfmac_f32_16x16x64_bf16 v[68:71], v[56:59], a[80:87], v6
    v_smfmac_f32_16x16x64_bf16 v[72:75], v[56:59], a[48:55], v6
    v_smfmac_f32_16x16x64_bf16 v[76:79], v[56:59], a[112:119], v6
    s_branch L_gd_a_230
L_q_a_241:
    buffer_load_dwordx4 v[60:63], v5, s[8:11], s38 offen sc1
    s_waitcnt vmcnt(1)
    v_max3_u32 v7, v56, v57, v58
    v_max_u32 v7, v7, v59
    v_cmp_eq_u32 vcc, s34, v7
    s_cbranch_vccnz L_q_a_246
L_v_a_247:
    v_smfmac_f32_16x16x64_bf16 v[64:67], v[56:59], a[16:23], v6
    s_waitcnt vmcnt(0)
    v_max3_u32 v7, v60, v61, v62
    v_max_u32 v7, v7, v63
    v_smfmac_f32_16x16x64_bf16 v[68:71], v[56:59], a[80:87], v6
    v_cmp_eq_u32 vcc, s34, v7
    v_smfmac_f32_16x16x64_bf16 v[72:75], v[56:59], a[48:55], v6
    v_smfmac_f32_16x16x64_bf16 v[76:79], v[56:59], a[112:119], v6
    s_cbranch_vccnz L_q_a_239
    s_branch L_v_a_238
L_q_a_246:
    buffer_load_dwordx4 v[56:59], v4, s[8:11], s38 offen sc1
    s_waitcnt vmcnt(2)
    v_max3_u32 v7, v60, v61, v62
    v_max_u32 v7, v7, v63
    v_cmp_eq_u32 vcc, s34, v7
    s_cbranch_vccz L_ok_a_248
    buffer_load_dwordx4 v[60:63], v5, s[8:11], s38 offen sc1
    s_waitcnt vmcnt(2)
    v_max3_u32 v7, v56, v57, v58
    v_max_u32 v7, v7, v59
    v_cmp_eq_u32 vcc, s34, v7
    s_cbranch_vccz L_ok_a_249
    s_add_u32 s33, s33, 1
    s_cmp_gt_u32 s33, 0x100000
    s_cbranch_scc0 L_q_a_246
    s_branch chain_kernel_abort
L_ok_a_248:
    v_smfmac_f32_16x16x64_bf16 v[64:67], v[60:63], a[24:31], v6
    v_smfmac_f32_16x16x64_bf16 v[68:71], v[60:63], a[88:95], v6
    v_smfmac_f32_16x16x64_bf16 v[72:75], v[60:63], a[56:63], v6
    v_smfmac_f32_16x16x64_bf16 v[76:79], v[60:63], a[120:127], v6
    s_branch L_q_a_243
L_ok_a_249:
    v_smfmac_f32_16x16x64_bf16 v[64:67], v[56:59], a[16:23], v6
    v_smfmac_f32_16x16x64_bf16 v[68:71], v[56:59], a[80:87], v6
    v_smfmac_f32_16x16x64_bf16 v[72:75], v[56:59], a[48:55], v6
    v_smfmac_f32_16x16x64_bf16 v[76:79], v[56:59], a[112:119], v6
    s_branch L_q_a_239
L_q_a_233:
    buffer_load_dwordx4 v[52:55], v3, s[8:11], s38 offen sc1
    s_waitcnt vmcnt(2)
    v_max3_u32 v7, v56, v57, v58
    v_max_u32 v7, v7, v59
    v_cmp_eq_u32 vcc, s34, v7
    s_cbranch_vccnz L_q_a_250
L_v_a_251:
    v_smfmac_f32_16x16x64_bf16 v[64:67], v[56:59], a[16:23], v6
    s_waitcnt vmcnt(1)
    v_max3_u32 v7, v60, v61, v62
    v_max_u32 v7, v7, v63
    v_smfmac_f32_16x16x64_bf16 v[68:71], v[56:59], a[80:87], v6
    v_cmp_eq_u32 vcc, s34, v7
    v_smfmac_f32_16x16x64_bf16 v[72:75], v[56:59], a[48:55], v6
    v_smfmac_f32_16x16x64_bf16 v[76:79], v[56:59], a[112:119], v6
    s_cbranch_vccnz L_q_a_252
L_v_a_253:
    v_smfmac_f32_16x16x64_bf16 v[64:67], v[60:63], a[24:31], v6
    s_waitcnt vmcnt(0)
    v_max3_u32 v7, v52, v53, v54
    v_max_u32 v7, v7, v55
    v_smfmac_f32_16x16x64_bf16 v[68:71], v[60:63], a[88:95], v6
    v_cmp_eq_u32 vcc, s34, v7
    v_smfmac_f32_16x16x64_bf16 v[72:75], v[60:63], a[56:63], v6
    v_smfmac_f32_16x16x64_bf16 v[76:79], v[60:63], a[120:127], v6
    s_cbranch_vccnz L_q_a_254
L_v_a_255:
    v_smfmac_f32_16x16x64_bf16 v[64:67], v[52:55], a[8:15], v6
    v_smfmac_f32_16x16x64_bf16 v[68:71], v[52:55], a[72:79], v6
    v_smfmac_f32_16x16x64_bf16 v[72:75], v[52:55], a[40:47], v6
    v_smfmac_f32_16x16x64_bf16 v[76:79], v[52:55], a[104:111], v6
    s_branch L_gd_a_230
L_q_a_254:
    buffer_load_dwordx4 v[52:55], v3, s[8:11], s38 offen sc1
    s_waitcnt vmcnt(2)
    v_max3_u32 v7, v52, v53, v54
    v_max_u32 v7, v7, v55
    v_cmp_eq_u32 vcc, s34, v7
    s_cbranch_vccz L_ok_a_256
    s_add_u32 s33, s33, 1
    s_cmp_gt_u32 s33, 0x100000
    s_cbranch_scc0 L_q_a_254
    s_branch chain_kernel_abort
L_ok_a_256:
    v_smfmac_f32_16x16x64_bf16 v[64:67], v[52:55], a[8:15], v6
    v_smfmac_f32_16x16x64_bf16 v[68:71], v[52:55], a[72:79], v6
    v_smfmac_f32_16x16x64_bf16 v[72:75], v[52:55], a[40:47], v6
    v_smfmac_f32_16x16x64_bf16 v[76:79], v[52:55], a[104:111], v6
    s_branch L_gd_a_230
L_q_a_252:
    buffer_load_dwordx4 v[60:63], v5, s[8:11], s38 offen sc1
    s_waitcnt vmcnt(1)
    v_max3_u32 v7, v52, v53, v54
    v_max_u32 v7, v7, v55
    v_cmp_eq_u32 vcc, s34, v7
    s_cbranch_vccnz L_q_a_257
L_v_a_258:
    v_smfmac_f32_16x16x64_bf16 v[64:67], v[52:55], a[8:15], v6
    s_waitcnt vmcnt(0)
    v_max3_u32 v7, v60, v61, v62
    v_max_u32 v7, v7, v63
    v_smfmac_f32_16x16x64_bf16 v[68:71], v[52:55], a[72:79], v6
    v_cmp_eq_u32 vcc, s34, v7
    v_smfmac_f32_16x16x64_bf16 v[72:75], v[52:55], a[40:47], v6
    v_smfmac_f32_16x16x64_bf16 v[76:79], v[52:55], a[104:111], v6
    s_cbranch_vccnz L_q_a_239
    s_branch L_v_a_238
L_q_a_257:
    buffer_load_dwordx4 v[52:55], v3, s[8:11], s38 offen sc1
    s_waitcnt vmcnt(2)
    v_max3_u32 v7, v60, v61, v62
    v_max_u32 v7, v7, v63
    v_cmp_eq_u32 vcc, s34, v7
    s_cbranch_vccz L_ok_a_259
    buffer_load_dwordx4 v[60:63], v5, s[8:11], s38 offen sc1
    s_waitcnt vmcnt(2)
    v_max3_u32 v7, v52, v53, v54
    v_max_u32 v7, v7, v55
    v_cmp_eq_u32 vcc, s34, v7
    s_cbranch_vccz L_ok_a_260
    s_add_u32 s33, s33, 1
    s_cmp_gt_u32 s33, 0x100000
    s_cbranch_scc0 L_q_a_257
    s_branch chain_kernel_abort
L_ok_a_259:
    v_smfmac_f32_16x16x64_bf16 v[64:67], v[60:63], a[24:31], v6
    v_smfmac_f32_16x16x64_bf16 v[68:71], v[60:63], a[88:95], v6
    v_smfmac_f32_16x16x64_bf16 v[72:75], v[60:63], a[56:63], v6
    v_smfmac_f32_16x16x64_bf16 v[76:79], v[60:63], a[120:127], v6
    s_branch L_q_a_254
L_ok_a_260:
    v_smfmac_f32_16x16x64_bf16 v[64:67], v[52:55], a[8:15], v6
    v_smfmac_f32_16x16x64_bf16 v[68:71], v[52:55], a[72:79], v6
    v_smfmac_f32_16x16x64_bf16 v[72:75], v[52:55], a[40:47], v6
    v_smfmac_f32_16x16x64_bf16 v[76:79], v[52:55], a[104:111], v6
    s_branch L_q_a_239
L_q_a_250:
    buffer_load_dwordx4 v[56:59], v4, s[8:11], s38 offen sc1
    s_waitcnt vmcnt(2)
    v_max3_u32 v7, v60, v61, v62
    v_max_u32 v7, v7, v63
    v_cmp_eq_u32 vcc, s34, v7
    s_cbranch_vccnz L_q_a_261
L_v_a_262:
    v_smfmac_f32_16x16x64_bf16 v[64:67], v[60:63], a[24:31], v6
    s_waitcnt vmcnt(1)
    v_max3_u32 v7, v52, v53, v54
    v_max_u32 v7, v7, v55
    v_smfmac_f32_16x16x64_bf16 v[68:71], v[60:63], a[88:95], v6
    v_cmp_eq_u32 vcc, s34, v7
    v_smfmac_f32_16x16x64_bf16 v[72:75], v[60:63], a[56:63], v6
    v_smfmac_f32_16x16x64_bf16 v[76:79], v[60:63], a[120:127], v6
    s_cbranch_vccnz L_q_a_263
L_v_a_264:
    v_smfmac_f32_16x16x64_bf16 v[64:67], v[52:55], a[8:15], v6
    s_waitcnt vmcnt(0)
    v_max3_u32 v7, v56, v57, v58
    v_max_u32 v7, v7, v59
    v_smfmac_f32_16x16x64_bf16 v[68:71], v[52:55], a[72:79], v6
    v_cmp_eq_u32 vcc, s34, v7
    v_smfmac_f32_16x16x64_bf16 v[72:75], v[52:55], a[40:47], v6
    v_smfmac_f32_16x16x64_bf16 v[76:79], v[52:55], a[104:111], v6
    s_cbranch_vccnz L_q_a_243
    s_branch L_v_a_244
L_q_a_263:
    buffer_load_dwordx4 v[52:55], v3, s[8:11], s38 offen sc1
    s_waitcnt vmcnt(2)
    v_max3_u32 v7, v56, v57, v58
    v_max_u32 v7, v7, v59
    v_cmp_eq_u32 vcc, s34, v7
    s_cbranch_vccz L_ok_a_265
    buffer_load_dwordx4 v[56:59], v4, s[8:11], s38 offen sc1
    s_waitcnt vmcnt(2)
    v_max3_u32 v7, v52, v53, v54
    v_max_u32 v7, v7, v55
    v_cmp_eq_u32 vcc, s34, v7
    s_cbranch_vccz L_ok_a_266
    s_add_u32 s33, s33, 1
    s_cmp_gt_u32 s33, 0x100000
    s_cbranch_scc0 L_q_a_263
    s_branch chain_kernel_abort
L_ok_a_265:
    v_smfmac_f32_16x16x64_bf16 v[64:67], v[56:59], a[16:23], v6
    v_smfmac_f32_16x16x64_bf16 v[68:71], v[56:59], a[80:87], v6
    v_smfmac_f32_16x16x64_bf16 v[72:75], v[56:59], a[48:55], v6
    v_smfmac_f32_16x16x64_bf16 v[76:79], v[56:59], a[112:119], v6
    s_branch L_q_a_254
L_ok_a_266:
    v_smfmac_f32_16x16x64_bf16 v[64:67], v[52:55], a[8:15], v6
    v_smfmac_f32_16x16x64_bf16 v[68:71], v[52:55], a[72:79], v6
    v_smfmac_f32_16x16x64_bf16 v[72:75], v[52:55], a[40:47], v6
    v_smfmac_f32_16x16x64_bf16 v[76:79], v[52:55], a[104:111], v6
    s_branch L_q_a_243
L_q_a_261:
    buffer_load_dwordx4 v[60:63], v5, s[8:11], s38 offen sc1
    s_waitcnt vmcnt(2)
    v_max3_u32 v7, v52, v53, v54
    v_max_u32 v7, v7, v55
    v_cmp_eq_u32 vcc, s34, v7
    s_cbranch_vccnz L_q_a_267
L_v_a_268:
    v_smfmac_f32_16x16x64_bf16 v[64:67], v[52:55], a[8:15], v6
    s_waitcnt vmcnt(1)
    v_max3_u32 v7, v56, v57, v58
    v_max_u32 v7, v7, v59
    v_smfmac_f32_16x16x64_bf16 v[68:71], v[52:55], a[72:79], v6
    v_cmp_eq_u32 vcc, s34, v7
    v_smfmac_f32_16x16x64_bf16 v[72:75], v[52:55], a[40:47], v6
    v_smfmac_f32_16x16x64_bf16 v[76:79], v[52:55], a[104:111], v6
    s_cbranch_vccnz L_q_a_246
    s_branch L_v_a_247
L_q_a_267:
    buffer_load_dwordx4 v[52:55], v3, s[8:11], s38 offen sc1
    s_waitcnt vmcnt(2)
    v_max3_u32 v7, v56, v57, v58
    v_max_u32 v7, v7, v59
    v_cmp_eq_u32 vcc, s34, v7
    s_cbranch_vccz L_ok_a_269
    buffer_load_dwordx4 v[56:59], v4, s[8:11], s38 offen sc1
    s_waitcnt vmcnt(2)
    v_max3_u32 v7, v60, v61, v62
    v_max_u32 v7, v7, v63
    v_cmp_eq_u32 vcc, s34, v7
    s_cbranch_vccz L_ok_a_270
    buffer_load_dwordx4 v[60:63], v5, s[8:11], s38 offen sc1
    s_waitcnt vmcnt(2)
    v_max3_u32 v7, v52, v53, v54
    v_max_u32 v7, v7, v55
    v_cmp_eq_u32 vcc, s34, v7
    s_cbranch_vccz L_ok_a_271
    s_add_u32 s33, s33, 1
    s_cmp_gt_u32 s33, 0x100000
    s_cbranch_scc0 L_q_a_267
    s_branch chain_kernel_abort
L_ok_a_269:
    v_smfmac_f32_16x16x64_bf16 v[64:67], v[56:59], a[16:23], v6
    v_smfmac_f32_16x16x64_bf16 v[68:71], v[56:59], a[80:87], v6
    v_smfmac_f32_16x16x64_bf16 v[72:75], v[56:59], a[48:55], v6
    v_smfmac_f32_16x16x64_bf16 v[76:79], v[56:59], a[112:119], v6
    s_branch L_q_a_257
L_ok_a_270:
    v_smfmac_f32_16x16x64_bf16 v[64:67], v[60:63], a[24:31], v6
    v_smfmac_f32_16x16x64_bf16 v[68:71], v[60:63], a[88:95], v6
    v_smfmac_f32_16x16x64_bf16 v[72:75], v[60:63], a[56:63], v6
    v_smfmac_f32_16x16x64_bf16 v[76:79], v[60:63], a[120:127], v6
    s_branch L_q_a_263
L_ok_a_271:
    v_smfmac_f32_16x16x64_bf16 v[64:67], v[52:55], a[8:15], v6
    v_smfmac_f32_16x16x64_bf16 v[68:71], v[52:55], a[72:79], v6
    v_smfmac_f32_16x16x64_bf16 v[72:75], v[52:55], a[40:47], v6
    v_smfmac_f32_16x16x64_bf16 v[76:79], v[52:55], a[104:111], v6
    s_branch L_q_a_246
L_q_a_231:
    buffer_load_dwordx4 v[48:51], v2, s[8:11], s38 offen sc1
    s_waitcnt vmcnt(3)
    v_max3_u32 v7, v52, v53, v54
    v_max_u32 v7, v7, v55
    v_cmp_eq_u32 vcc, s34, v7
    s_cbranch_vccnz L_q_a_272
L_v_a_273:
    v_smfmac_f32_16x16x64_bf16 v[64:67], v[52:55], a[8:15], v6
    s_waitcnt vmcnt(2)
    v_max3_u32 v7, v56, v57, v58
    v_max_u32 v7, v7, v59
    v_smfmac_f32_16x16x64_bf16 v[68:71], v[52:55], a[72:79], v6
    v_cmp_eq_u32 vcc, s34, v7
    v_smfmac_f32_16x16x64_bf16 v[72:75], v[52:55], a[40:47], v6
    v_smfmac_f32_16x16x64_bf16 v[76:79], v[52:55], a[104:111], v6
    s_cbranch_vccnz L_q_a_274
L_v_a_275:
    v_smfmac_f32_16x16x64_bf16 v[64:67], v[56:59], a[16:23], v6
    s_waitcnt vmcnt(1)
    v_max3_u32 v7, v60, v61, v62
    v_max_u32 v7, v7, v63
    v_smfmac_f32_16x16x64_bf16 v[68:71], v[56:59], a[80:87], v6
    v_cmp_eq_u32 vcc, s34, v7
    v_smfmac_f32_16x16x64_bf16 v[72:75], v[56:59], a[48:55], v6
    v_smfmac_f32_16x16x64_bf16 v[76:79], v[56:59], a[112:119], v6
    s_cbranch_vccnz L_q_a_276
L_v_a_277:
    v_smfmac_f32_16x16x64_bf16 v[64:67], v[60:63], a[24:31], v6
    s_waitcnt vmcnt(0)
    v_max3_u32 v7, v48, v49, v50
    v_max_u32 v7, v7, v51
    v_smfmac_f32_16x16x64_bf16 v[68:71], v[60:63], a[88:95], v6
    v_cmp_eq_u32 vcc, s34, v7
    v_smfmac_f32_16x16x64_bf16 v[72:75], v[60:63], a[56:63], v6
    v_smfmac_f32_16x16x64_bf16 v[76:79], v[60:63], a[120:127], v6
    s_cbranch_vccnz L_q_a_278
L_v_a_279:
    v_smfmac_f32_16x16x64_bf16 v[64:67], v[48:51], a[0:7], v6
    v_smfmac_f32_16x16x64_bf16 v[68:71], v[48:51], a[64:71], v6
    v_smfmac_f32_16x16x64_bf16 v[72:75], v[48:51], a[32:39], v6
    v_smfmac_f32_16x16x64_bf16 v[76:79], v[48:51], a[96:103], v6
    s_branch L_gd_a_230
L_q_a_278:
    buffer_load_dwordx4 v[48:51], v2, s[8:11], s38 offen sc1
    s_waitcnt vmcnt(2)
    v_max3_u32 v7, v48, v49, v50
    v_max_u32 v7, v7, v51
    v_cmp_eq_u32 vcc, s34, v7
    s_cbranch_vccz L_ok_a_280
    s_add_u32 s33, s33, 1
    s_cmp_gt_u32 s33, 0x100000
    s_cbranch_scc0 L_q_a_278
    s_branch chain_kernel_abort
L_ok_a_280:
    v_smfmac_f32_16x16x64_bf16 v[64:67], v[48:51], a[0:7], v6
    v_smfmac_f32_16x16x64_bf16 v[68:71], v[48:51], a[64:71], v6
    v_smfmac_f32_16x16x64_bf16 v[72:75], v[48:51], a[32:39], v6
    v_smfmac_f32_16x16x64_bf16 v[76:79], v[48:51], a[96:103], v6
    s_branch L_gd_a_230
L_q_a_276:
    buffer_load_dwordx4 v[60:63], v5, s[8:11], s38 offen sc1
    s_waitcnt vmcnt(1)
    v_max3_u32 v7, v48, v49, v50
    v_max_u32 v7, v7, v51
    v_cmp_eq_u32 vcc, s34, v7
    s_cbranch_vccnz L_q_a_281
L_v_a_282:
    v_smfmac_f32_16x16x64_bf16 v[64:67], v[48:51], a[0:7], v6
    s_waitcnt vmcnt(0)
    v_max3_u32 v7, v60, v61, v62
    v_max_u32 v7, v7, v63
    v_smfmac_f32_16x16x64_bf16 v[68:71], v[48:51], a[64:71], v6
    v_cmp_eq_u32 vcc, s34, v7
    v_smfmac_f32_16x16x64_bf16 v[72:75], v[48:51], a[32:39], v6
    v_smfmac_f32_16x16x64_bf16 v[76:79], v[48:51], a[96:103], v6
    s_cbranch_vccnz L_q_a_239
    s_branch L_v_a_238
L_q_a_281:
    buffer_load_dwordx4 v[48:51], v2, s[8:11], s38 offen sc1
    s_waitcnt vmcnt(2)
    v_max3_u32 v7, v60, v61, v62
    v_max_u32 v7, v7, v63
    v_cmp_eq_u32 vcc, s34, v7
    s_cbranch_vccz L_ok_a_283
    buffer_load_dwordx4 v[60:63], v5, s[8:11], s38 offen sc1
    s_waitcnt vmcnt(2)
    v_max3_u32 v7, v48, v49, v50
    v_max_u32 v7, v7, v51
    v_cmp_eq_u32 vcc, s34, v7
    s_cbranch_vccz L_ok_a_284
    s_add_u32 s33, s33, 1
    s_cmp_gt_u32 s33, 0x100000
    s_cbranch_scc0 L_q_a_281
    s_branch chain_kernel_abort
L_ok_a_283:
    v_smfmac_f32_16x16x64_bf16 v[64:67], v[60:63], a[24:31], v6
    v_smfmac_f32_16x16x64_bf16 v[68:71], v[60:63], a[88:95], v6
    v_smfmac_f32_16x16x64_bf16 v[72:75], v[60:63], a[56:63], v6
    v_smfmac_f32_16x16x64_bf16 v[76:79], v[60:63], a[120:127], v6
    s_branch L_q_a_278
L_ok_a_284:
    v_smfmac_f32_16x16x64_bf16 v[64:67], v[48:51], a[0:7], v6
    v_smfmac_f32_16x16x64_bf16 v[68:71], v[48:51], a[64:71], v6
    v_smfmac_f32_16x16x64_bf16 v[72:75], v[48:51], a[32:39], v6
    v_smfmac_f32_16x16x64_bf16 v[76:79], v[48:51], a[96:103], v6
    s_branch L_q_a_239
L_q_a_274:
    buffer_load_dwordx4 v[56:59], v4, s[8:11], s38 offen sc1
    s_waitcnt vmcnt(2)
    v_max3_u32 v7, v60, v61, v62
    v_max_u32 v7, v7, v63
    v_cmp_eq_u32 vcc, s34, v7
    s_cbranch_vccnz L_q_a_285
L_v_a_286:
    v_smfmac_f32_16x16x64_bf16 v[64:67], v[60:63], a[24:31], v6
    s_waitcnt vmcnt(1)
    v_max3_u32 v7, v48, v49, v50
    v_max_u32 v7, v7, v51
    v_smfmac_f32_16x16x64_bf16 v[68:71], v[60:63], a[88:95], v6
    v_cmp_eq_u32 vcc, s34, v7
    v_smfmac_f32_16x16x64_bf16 v[72:75], v[60:63], a[56:63], v6
    v_smfmac_f32_16x16x64_bf16 v[76:79], v[60:63], a[120:127], v6
    s_cbranch_vccnz L_q_a_287
L_v_a_288:
    v_smfmac_f32_16x16x64_bf16 v[64:67], v[48:51], a[0:7], v6
    s_waitcnt vmcnt(0)
    v_max3_u32 v7, v56, v57, v58
    v_max_u32 v7, v7, v59
    v_smfmac_f32_16x16x64_bf16 v[68:71], v[48:51], a[64:71], v6
    v_cmp_eq_u32 vcc, s34, v7
    v_smfmac_f32_16x16x64_bf16 v[72:75], v[48:51], a[32:39], v6
    v_smfmac_f32_16x16x64_bf16 v[76:79], v[48:51], a[96:103], v6
    s_cbranch_vccnz L_q_a_243
    s_branch L_v_a_244
L_q_a_287:
    buffer_load_dwordx4 v[48:51], v2, s[8:11], s38 offen sc1
    s_waitcnt vmcnt(2)
    v_max3_u32 v7, v56, v57, v58
    v_max_u32 v7, v7, v59
    v_cmp_eq_u32 vcc, s34, v7
    s_cbranch_vccz L_ok_a_289
    buffer_load_dwordx4 v[56:59], v4, s[8:11], s38 offen sc1
    s_waitcnt vmcnt(2)
    v_max3_u32 v7, v48, v49, v50
    v_max_u32 v7, v7, v51
    v_cmp_eq_u32 vcc, s34, v7
    s_cbranch_vccz L_ok_a_290
    s_add_u32 s33, s33, 1
    s_cmp_gt_u32 s33, 0x100000
    s_cbranch_scc0 L_q_a_287
    s_branch chain_kernel_abort
L_ok_a_289:
    v_smfmac_f32_16x16x64_bf16 v[64:67], v[56:59], a[16:23], v6
    v_smfmac_f32_16x16x64_bf16 v[68:71], v[56:59], a[80:87], v6
    v_smfmac_f32_16x16x64_bf16 v[72:75], v[56:59], a[48:55], v6
    v_smfmac_f32_16x16x64_bf16 v[76:79], v[56:59], a[112:119], v6
    s_branch L_q_a_278
L_ok_a_290:
    v_smfmac_f32_16x16x64_bf16 v[64:67], v[48:51], a[0:7], v6
    v_smfmac_f32_16x16x64_bf16 v[68:71], v[48:51], a[64:71], v6
    v_smfmac_f32_16x16x64_bf16 v[72:75], v[48:51], a[32:39], v6
    v_smfmac_f32_16x16x64_bf16 v[76:79], v[48:51], a[96:103], v6
    s_branch L_q_a_243
L_q_a_285:
    buffer_load_dwordx4 v[60:63], v5, s[8:11], s38 offen sc1
    s_waitcnt vmcnt(2)
    v_max3_u32 v7, v48, v49, v50
    v_max_u32 v7, v7, v51
    v_cmp_eq_u32 vcc, s34, v7
    s_cbranch_vccnz L_q_a_291
L_v_a_292:
    v_smfmac_f32_16x16x64_bf16 v[64:67], v[48:51], a[0:7], v6
    s_waitcnt vmcnt(1)
    v_max3_u32 v7, v56, v57, v58
    v_max_u32 v7, v7, v59
    v_smfmac_f32_16x16x64_bf16 v[68:71], v[48:51], a[64:71], v6
    v_cmp_eq_u32 vcc, s34, v7
    v_smfmac_f32_16x16x64_bf16 v[72:75], v[48:51], a[32:39], v6
    v_smfmac_f32_16x16x64_bf16 v[76:79], v[48:51], a[96:103], v6
    s_cbranch_vccnz L_q_a_246
    s_branch L_v_a_247
L_q_a_291:
    buffer_load_dwordx4 v[48:51], v2, s[8:11], s38 offen sc1
    s_waitcnt vmcnt(2)
    v_max3_u32 v7, v56, v57, v58
    v_max_u32 v7, v7, v59
    v_cmp_eq_u32 vcc, s34, v7
    s_cbranch_vccz L_ok_a_293
    buffer_load_dwordx4 v[56:59], v4, s[8:11], s38 offen sc1
    s_waitcnt vmcnt(2)
    v_max3_u32 v7, v60, v61, v62
    v_max_u32 v7, v7, v63
    v_cmp_eq_u32 vcc, s34, v7
    s_cbranch_vccz L_ok_a_294
    buffer_load_dwordx4 v[60:63], v5, s[8:11], s38 offen sc1
    s_waitcnt vmcnt(2)
    v_max3_u32 v7, v48, v49, v50
    v_max_u32 v7, v7, v51
    v_cmp_eq_u32 vcc, s34, v7
    s_cbranch_vccz L_ok_a_295
    s_add_u32 s33, s33, 1
    s_cmp_gt_u32 s33, 0x100000
    s_cbranch_scc0 L_q_a_291
    s_branch chain_kernel_abort
L_ok_a_293:
    v_smfmac_f32_16x16x64_bf16 v[64:67], v[56:59], a[16:23], v6
    v_smfmac_f32_16x16x64_bf16 v[68:71], v[56:59], a[80:87], v6
    v_smfmac_f32_16x16x64_bf16 v[72:75], v[56:59], a[48:55], v6
    v_smfmac_f32_16x16x64_bf16 v[76:79], v[56:59], a[112:119], v6
    s_branch L_q_a_281
L_ok_a_294:
    v_smfmac_f32_16x16x64_bf16 v[64:67], v[60:63], a[24:31], v6
    v_smfmac_f32_16x16x64_bf16 v[68:71], v[60:63], a[88:95], v6
    v_smfmac_f32_16x16x64_bf16 v[72:75], v[60:63], a[56:63], v6
    v_smfmac_f32_16x16x64_bf16 v[76:79], v[60:63], a[120:127], v6
    s_branch L_q_a_287
L_ok_a_295:
    v_smfmac_f32_16x16x64_bf16 v[64:67], v[48:51], a[0:7], v6
    v_smfmac_f32_16x16x64_bf16 v[68:71], v[48:51], a[64:71], v6
    v_smfmac_f32_16x16x64_bf16 v[72:75], v[48:51], a[32:39], v6
    v_smfmac_f32_16x16x64_bf16 v[76:79], v[48:51], a[96:103], v6
    s_branch L_q_a_246
L_q_a_272:
    buffer_load_dwordx4 v[52:55], v3, s[8:11], s38 offen sc1
    s_waitcnt vmcnt(3)
    v_max3_u32 v7, v56, v57, v58
    v_max_u32 v7, v7, v59
    v_cmp_eq_u32 vcc, s34, v7
    s_cbranch_vccnz L_q_a_296
L_v_a_297:
    v_smfmac_f32_16x16x64_bf16 v[64:67], v[56:59], a[16:23], v6
    s_waitcnt vmcnt(2)
    v_max3_u32 v7, v60, v61, v62
    v_max_u32 v7, v7, v63
    v_smfmac_f32_16x16x64_bf16 v[68:71], v[56:59], a[80:87], v6
    v_cmp_eq_u32 vcc, s34, v7
    v_smfmac_f32_16x16x64_bf16 v[72:75], v[56:59], a[48:55], v6
    v_smfmac_f32_16x16x64_bf16 v[76:79], v[56:59], a[112:119], v6
    s_cbranch_vccnz L_q_a_298
L_v_a_299:
    v_smfmac_f32_16x16x64_bf16 v[64:67], v[60:63], a[24:31], v6
    s_waitcnt vmcnt(1)
    v_max3_u32 v7, v48, v49, v50
    v_max_u32 v7, v7, v51
    v_smfmac_f32_16x16x64_bf16 v[68:71], v[60:63], a[88:95], v6
    v_cmp_eq_u32 vcc, s34, v7
    v_smfmac_f32_16x16x64_bf16 v[72:75], v[60:63], a[56:63], v6
    v_smfmac_f32_16x16x64_bf16 v[76:79], v[60:63], a[120:127], v6
    s_cbranch_vccnz L_q_a_300
L_v_a_301:
    v_smfmac_f32_16x16x64_bf16 v[64:67], v[48:51], a[0:7], v6
    s_waitcnt vmcnt(0)
    v_max3_u32 v7, v52, v53, v54
    v_max_u32 v7, v7, v55
    v_smfmac_f32_16x16x64_bf16 v[68:71], v[48:51], a[64:71], v6
    v_cmp_eq_u32 vcc, s34, v7
    v_smfmac_f32_16x16x64_bf16 v[72:75], v[48:51], a[32:39], v6
    v_smfmac_f32_16x16x64_bf16 v[76:79], v[48:51], a[96:103], v6
    s_cbranch_vccnz L_q_a_254
    s_branch L_v_a_255
L_q_a_300:
    buffer_load_dwordx4 v[48:51], v2, s[8:11], s38 offen sc1
    s_waitcnt vmcnt(2)
    v_max3_u32 v7, v52, v53, v54
    v_max_u32 v7, v7, v55
    v_cmp_eq_u32 vcc, s34, v7
    s_cbranch_vccz L_ok_a_302
    buffer_load_dwordx4 v[52:55], v3, s[8:11], s38 offen sc1
    s_waitcnt vmcnt(2)
    v_max3_u32 v7, v48, v49, v50
    v_max_u32 v7, v7, v51
    v_cmp_eq_u32 vcc, s34, v7
    s_cbranch_vccz L_ok_a_303
    s_add_u32 s33, s33, 1
    s_cmp_gt_u32 s33, 0x100000
    s_cbranch_scc0 L_q_a_300
    s_branch chain_kernel_abort
L_ok_a_302:
    v_smfmac_f32_16x16x64_bf16 v[64:67], v[52:55], a[8:15], v6
    v_smfmac_f32_16x16x64_bf16 v[68:71], v[52:55], a[72:79], v6
    v_smfmac_f32_16x16x64_bf16 v[72:75], v[52:55], a[40:47], v6
    v_smfmac_f32_16x16x64_bf16 v[76:79], v[52:55], a[104:111], v6
    s_branch L_q_a_278
L_ok_a_303:
    v_smfmac_f32_16x16x64_bf16 v[64:67], v[48:51], a[0:7], v6
    v_smfmac_f32_16x16x64_bf16 v[68:71], v[48:51], a[64:71], v6
    v_smfmac_f32_16x16x64_bf16 v[72:75], v[48:51], a[32:39], v6
    v_smfmac_f32_16x16x64_bf16 v[76:79], v[48:51], a[96:103], v6
    s_branch L_q_a_254
L_q_a_298:
    buffer_load_dwordx4 v[60:63], v5, s[8:11], s38 offen sc1
    s_waitcnt vmcnt(2)
    v_max3_u32 v7, v48, v49, v50
    v_max_u32 v7, v7, v51
    v_cmp_eq_u32 vcc, s34, v7
    s_cbranch_vccnz L_q_a_304
L_v_a_305:
    v_smfmac_f32_16x16x64_bf16 v[64:67], v[48:51], a[0:7], v6
    s_waitcnt vmcnt(1)
    v_max3_u32 v7, v52, v53, v54
    v_max_u32 v7, v7, v55
    v_smfmac_f32_16x16x64_bf16 v[68:71], v[48:51], a[64:71], v6
    v_cmp_eq_u32 vcc, s34, v7
    v_smfmac_f32_16x16x64_bf16 v[72:75], v[48:51], a[32:39], v6
    v_smfmac_f32_16x16x64_bf16 v[76:79], v[48:51], a[96:103], v6
    s_cbranch_vccnz L_q_a_257
    s_branch L_v_a_258
L_q_a_304:
    buffer_load_dwordx4 v[48:51], v2, s[8:11], s38 offen sc1
    s_waitcnt vmcnt(2)
    v_max3_u32 v7, v52, v53, v54
    v_max_u32 v7, v7, v55
    v_cmp_eq_u32 vcc, s34, v7
    s_cbranch_vccz L_ok_a_306
    buffer_load_dwordx4 v[52:55], v3, s[8:11], s38 offen sc1
    s_waitcnt vmcnt(2)
    v_max3_u32 v7, v60, v61, v62
    v_max_u32 v7, v7, v63
    v_cmp_eq_u32 vcc, s34, v7
    s_cbranch_vccz L_ok_a_307
    buffer_load_dwordx4 v[60:63], v5, s[8:11], s38 offen sc1
    s_waitcnt vmcnt(2)
    v_max3_u32 v7, v48, v49, v50
    v_max_u32 v7, v7, v51
    v_cmp_eq_u32 vcc, s34, v7
    s_cbranch_vccz L_ok_a_308
    s_add_u32 s33, s33, 1
    s_cmp_gt_u32 s33, 0x100000
    s_cbranch_scc0 L_q_a_304
    s_branch chain_kernel_abort
L_ok_a_306:
    v_smfmac_f32_16x16x64_bf16 v[64:67], v[52:55], a[8:15], v6
    v_smfmac_f32_16x16x64_bf16 v[68:71], v[52:55], a[72:79], v6
    v_smfmac_f32_16x16x64_bf16 v[72:75], v[52:55], a[40:47], v6
    v_smfmac_f32_16x16x64_bf16 v[76:79], v[52:55], a[104:111], v6
    s_branch L_q_a_281
L_ok_a_307:
    v_smfmac_f32_16x16x64_bf16 v[64:67], v[60:63], a[24:31], v6
    v_smfmac_f32_16x16x64_bf16 v[68:71], v[60:63], a[88:95], v6
    v_smfmac_f32_16x16x64_bf16 v[72:75], v[60:63], a[56:63], v6
    v_smfmac_f32_16x16x64_bf16 v[76:79], v[60:63], a[120:127], v6
    s_branch L_q_a_300
L_ok_a_308:
    v_smfmac_f32_16x16x64_bf16 v[64:67], v[48:51], a[0:7], v6
    v_smfmac_f32_16x16x64_bf16 v[68:71], v[48:51], a[64:71], v6
    v_smfmac_f32_16x16x64_bf16 v[72:75], v[48:51], a[32:39], v6
    v_smfmac_f32_16x16x64_bf16 v[76:79], v[48:51], a[96:103], v6
    s_branch L_q_a_257
L_q_a_296:
    buffer_load_dwordx4 v[56:59], v4, s[8:11], s38 offen sc1
    s_waitcnt vmcnt(3)
    v_max3_u32 v7, v60, v61, v62
    v_max_u32 v7, v7, v63
    v_cmp_eq_u32 vcc, s34, v7
    s_cbranch_vccnz L_q_a_309
L_v_a_310:
    v_smfmac_f32_16x16x64_bf16 v[64:67], v[60:63], a[24:31], v6
    s_waitcnt vmcnt(2)
    v_max3_u32 v7, v48, v49, v50
    v_max_u32 v7, v7, v51
    v_smfmac_f32_16x16x64_bf16 v[68:71], v[60:63], a[88:95], v6
    v_cmp_eq_u32 vcc, s34, v7
    v_smfmac_f32_16x16x64_bf16 v[72:75], v[60:63], a[56:63], v6
    v_smfmac_f32_16x16x64_bf16 v[76:79], v[60:63], a[120:127], v6
    s_cbranch_vccnz L_q_a_311
L_v_a_312:
    v_smfmac_f32_16x16x64_bf16 v[64:67], v[48:51], a[0:7], v6
    s_waitcnt vmcnt(1)
    v_max3_u32 v7, v52, v53, v54
    v_max_u32 v7, v7, v55
    v_smfmac_f32_16x16x64_bf16 v[68:71], v[48:51], a[64:71], v6
    v_cmp_eq_u32 vcc, s34, v7
    v_smfmac_f32_16x16x64_bf16 v[72:75], v[48:51], a[32:39], v6
    v_smfmac_f32_16x16x64_bf16 v[76:79], v[48:51], a[96:103], v6
    s_cbranch_vccnz L_q_a_263
    s_branch L_v_a_264
L_q_a_311:
    buffer_load_dwordx4 v[48:51], v2, s[8:11], s38 offen sc1
    s_waitcnt vmcnt(2)
    v_max3_u32 v7, v52, v53, v54
    v_max_u32 v7, v7, v55
    v_cmp_eq_u32 vcc, s34, v7
    s_cbranch_vccz L_ok_a_313
    buffer_load_dwordx4 v[52:55], v3, s[8:11], s38 offen sc1
    s_waitcnt vmcnt(2)
    v_max3_u32 v7, v56, v57, v58
    v_max_u32 v7, v7, v59
    v_cmp_eq_u32 vcc, s34, v7
    s_cbranch_vccz L_ok_a_314
    buffer_load_dwordx4 v[56:59], v4, s[8:11], s38 offen sc1
    s_waitcnt vmcnt(2)
    v_max3_u32 v7, v48, v49, v50
    v_max_u32 v7, v7, v51
    v_cmp_eq_u32 vcc, s34, v7
    s_cbranch_vccz L_ok_a_315
    s_add_u32 s33, s33, 1
    s_cmp_gt_u32 s33, 0x100000
    s_cbranch_scc0 L_q_a_311
    s_branch chain_kernel_abort
L_ok_a_313:
    v_smfmac_f32_16x16x64_bf16 v[64:67], v[52:55], a[8:15], v6
    v_smfmac_f32_16x16x64_bf16 v[68:71], v[52:55], a[72:79], v6
    v_smfmac_f32_16x16x64_bf16 v[72:75], v[52:55], a[40:47], v6
    v_smfmac_f32_16x16x64_bf16 v[76:79], v[52:55], a[104:111], v6
    s_branch L_q_a_287
L_ok_a_314:
    v_smfmac_f32_16x16x64_bf16 v[64:67], v[56:59], a[16:23], v6
    v_smfmac_f32_16x16x64_bf16 v[68:71], v[56:59], a[80:87], v6
    v_smfmac_f32_16x16x64_bf16 v[72:75], v[56:59], a[48:55], v6
    v_smfmac_f32_16x16x64_bf16 v[76:79], v[56:59], a[112:119], v6
    s_branch L_q_a_300
L_ok_a_315:
    v_smfmac_f32_16x16x64_bf16 v[64:67], v[48:51], a[0:7], v6
    v_smfmac_f32_16x16x64_bf16 v[68:71], v[48:51], a[64:71], v6
    v_smfmac_f32_16x16x64_bf16 v[72:75], v[48:51], a[32:39], v6
    v_smfmac_f32_16x16x64_bf16 v[76:79], v[48:51], a[96:103], v6
    s_branch L_q_a_263
L_q_a_309:
    buffer_load_dwordx4 v[60:63], v5, s[8:11], s38 offen sc1
    s_waitcnt vmcnt(3)
    v_max3_u32 v7, v48, v49, v50
    v_max_u32 v7, v7, v51
    v_cmp_eq_u32 vcc, s34, v7
    s_cbranch_vccnz L_q_a_316
L_v_a_317:
    v_smfmac_f32_16x16x64_bf16 v[64:67], v[48:51], a[0:7], v6
    s_waitcnt vmcnt(2)
    v_max3_u32 v7, v52, v53, v54
    v_max_u32 v7, v7, v55
    v_smfmac_f32_16x16x64_bf16 v[68:71], v[48:51], a[64:71], v6
    v_cmp_eq_u32 vcc, s34, v7
    v_smfmac_f32_16x16x64_bf16 v[72:75], v[48:51], a[32:39], v6
    v_smfmac_f32_16x16x64_bf16 v[76:79], v[48:51], a[96:103], v6
    s_cbranch_vccnz L_q_a_267
    s_branch L_v_a_268
L_q_a_316:
    buffer_load_dwordx4 v[48:51], v2, s[8:11], s38 offen sc1
    s_waitcnt vmcnt(2)
    v_max3_u32 v7, v52, v53, v54
    v_max_u32 v7, v7, v55
    v_cmp_eq_u32 vcc, s34, v7
    s_cbranch_vccz L_ok_a_318
    buffer_load_dwordx4 v[52:55], v3, s[8:11], s38 offen sc1
    s_waitcnt vmcnt(2)
    v_max3_u32 v7, v56, v57, v58
    v_max_u32 v7, v7, v59
    v_cmp_eq_u32 vcc, s34, v7
    s_cbranch_vccz L_ok_a_319
    buffer_load_dwordx4 v[56:59], v4, s[8:11], s38 offen sc1
    s_waitcnt vmcnt(2)
    v_max3_u32 v7, v60, v61, v62
    v_max_u32 v7, v7, v63
    v_cmp_eq_u32 vcc, s34, v7
    s_cbranch_vccz L_ok_a_320
    buffer_load_dwordx4 v[60:63], v5, s[8:11], s38 offen sc1
    s_waitcnt vmcnt(2)
    v_max3_u32 v7, v48, v49, v50
    v_max_u32 v7, v7, v51
    v_cmp_eq_u32 vcc, s34, v7
    s_cbranch_vccz L_ok_a_321
    s_add_u32 s33, s33, 1
    s_cmp_gt_u32 s33, 0x100000
    s_cbranch_scc0 L_q_a_316
    s_branch chain_kernel_abort
L_ok_a_318:
    v_smfmac_f32_16x16x64_bf16 v[64:67], v[52:55], a[8:15], v6
    v_smfmac_f32_16x16x64_bf16 v[68:71], v[52:55], a[72:79], v6
    v_smfmac_f32_16x16x64_bf16 v[72:75], v[52:55], a[40:47], v6
    v_smfmac_f32_16x16x64_bf16 v[76:79], v[52:55], a[104:111], v6
    s_branch L_q_a_291
L_ok_a_319:
    v_smfmac_f32_16x16x64_bf16 v[64:67], v[56:59], a[16:23], v6
    v_smfmac_f32_16x16x64_bf16 v[68:71], v[56:59], a[80:87], v6
    v_smfmac_f32_16x16x64_bf16 v[72:75], v[56:59], a[48:55], v6
    v_smfmac_f32_16x16x64_bf16 v[76:79], v[56:59], a[112:119], v6
    s_branch L_q_a_304
L_ok_a_320:
    v_smfmac_f32_16x16x64_bf16 v[64:67], v[60:63], a[24:31], v6
    v_smfmac_f32_16x16x64_bf16 v[68:71], v[60:63], a[88:95], v6
    v_smfmac_f32_16x16x64_bf16 v[72:75], v[60:63], a[56:63], v6
    v_smfmac_f32_16x16x64_bf16 v[76:79], v[60:63], a[120:127], v6
    s_branch L_q_a_311
L_ok_a_321:
    v_smfmac_f32_16x16x64_bf16 v[64:67], v[48:51], a[0:7], v6
    v_smfmac_f32_16x16x64_bf16 v[68:71], v[48:51], a[64:71], v6
    v_smfmac_f32_16x16x64_bf16 v[72:75], v[48:51], a[32:39], v6
    v_smfmac_f32_16x16x64_bf16 v[76:79], v[48:51], a[96:103], v6
    s_branch L_q_a_267
L_cf_329:
L_rt_330:
    buffer_load_dwordx4 v[200:203], v16, s[8:11], s40 offen sc1
    buffer_load_dwordx4 v[204:207], v13, s[8:11], s40 offen sc1
    buffer_load_dwordx4 v[208:211], v14, s[8:11], s40 offen sc1
    buffer_load_dwordx4 v[212:215], v15, s[8:11], s40 offen sc1
    s_waitcnt vmcnt(7)
    v_permlane32_swap_b32 v216, v218
    v_permlane32_swap_b32 v217, v219
    s_waitcnt vmcnt(6)
    v_pk_add_f32 v[154:155], v[216:217], v[218:219]
    v_pk_add_f32 v[148:149], v[124:125], v[220:221]
    v_pk_add_f32 v[150:151], v[126:127], v[222:223]
    v_permlane16_swap_b32 v154, v155
    s_waitcnt vmcnt(5)
    v_pk_add_f32 v[148:149], v[148:149], v[224:225]
    v_pk_add_f32 v[150:151], v[150:151], v[226:227]
    v_add_f32 v152, v154, v155
    s_waitcnt vmcnt(4)
    v_pk_add_f32 v[148:149], v[148:149], v[228:229]
    v_pk_add_f32 v[150:151], v[150:151], v[230:231]
    v_pk_add_f32 v[154:155], v[148:149], v[150:151]
    v_add_f32 v154, v154, v152
    v_cmp_u_f32 vcc, v154, v155
    s_cbranch_vccz L_cok_328
    buffer_load_dwordx4 v[216:219], v16, s[8:11], s40 offen sc1
    buffer_load_dwordx4 v[220:223], v13, s[8:11], s40 offen sc1
    buffer_load_dwordx4 v[224:227], v14, s[8:11], s40 offen sc1
    buffer_load_dwordx4 v[228:231], v15, s[8:11], s40 offen sc1
    s_waitcnt vmcnt(7)
    v_permlane32_swap_b32 v200, v202
    v_permlane32_swap_b32 v201, v203
    s_waitcnt vmcnt(6)
    v_pk_add_f32 v[154:155], v[200:201], v[202:203]
    v_pk_add_f32 v[148:149], v[124:125], v[204:205]
    v_pk_add_f32 v[150:151], v[126:127], v[206:207]
    v_permlane16_swap_b32 v154, v155
    s_waitcnt vmcnt(5)
    v_pk_add_f32 v[148:149], v[148:149], v[208:209]
    v_pk_add_f32 v[150:151], v[150:151], v[210:211]
    v_add_f32 v152, v154, v155
    s_waitcnt vmcnt(4)
    v_pk_add_f32 v[148:149], v[148:149], v[212:213]
    v_pk_add_f32 v[150:151], v[150:151], v[214:215]
    v_pk_add_f32 v[154:155], v[148:149], v[150:151]
    v_add_f32 v154, v154, v152
    v_cmp_u_f32 vcc, v154, v155
    s_cbranch_vccz L_cok_328
    s_add_u32 s33, s33, 1
    s_cmp_gt_u32 s33, 0x100000
    s_cbranch_scc1 chain_kernel_abort
    s_and_b32 s20, s33, 63
    s_cbranch_scc1 L_rt_330
    v_cmp_eq_u32 vcc, s34, v200
    v_cmp_eq_u32 s[20:21], s34, v201
    s_or_b64 vcc, vcc, s[20:21]
    v_cmp_eq_u32 s[20:21], s34, v202
    s_or_b64 vcc, vcc, s[20:21]
    v_cmp_eq_u32 s[20:21], s34, v203
    s_or_b64 vcc, vcc, s[20:21]
    v_cmp_eq_u32 s[20:21], s34, v204
    s_or_b64 vcc, vcc, s[20:21]
    v_cmp_eq_u32 s[20:21], s34, v205
    s_or_b64 vcc, vcc, s[20:21]
    v_cmp_eq_u32 s[20:21], s34, v206
    s_or_b64 vcc, vcc, s[20:21]
    v_cmp_eq_u32 s[20:21], s34, v207
    s_or_b64 vcc, vcc, s[20:21]
    v_cmp_eq_u32 s[20:21], s34, v208
    s_or_b64 vcc, vcc, s[20:21]
    v_cmp_eq_u32 s[20:21], s34, v209
    s_or_b64 vcc, vcc, s[20:21]
    v_cmp_eq_u32 s[20:21], s34, v210
    s_or_b64 vcc, vcc, s[20:21]
    v_cmp_eq_u32 s[20:21], s34, v211
    s_or_b64 vcc, vcc, s[20:21]
    v_cmp_eq_u32 s[20:21], s34, v212
    s_or_b64 vcc, vcc, s[20:21]
    v_cmp_eq_u32 s[20:21], s34, v213
    s_or_b64 vcc, vcc, s[20:21]
    v_cmp_eq_u32 s[20:21], s34, v214
    s_or_b64 vcc, vcc, s[20:21]
    v_cmp_eq_u32 s[20:21], s34, v215
    s_or_b64 vcc, vcc, s[20:21]
    s_cbranch_vccnz L_rt_330
    s_branch L_cok_328
L_cok_328:
    v_max3_f32 v154, v148, v149, v150
    v_max3_f32 v154, v154, v151, v152
    s_nop 1
    v_max_f32_dpp v154, v154, v154 row_ror:8 row_mask:0xf bank_mask:0xf
    s_branch L_chead_331
L_q_e_339:
    buffer_load_dwordx4 v[60:63], v5, s[8:11], s41 offen sc1
    s_waitcnt vmcnt(0)
    v_max3_u32 v7, v60, v61, v62
    v_max_u32 v7, v7, v63
    v_cmp_eq_u32 vcc, s34, v7
    s_cbranch_vccnz L_q_e_341
    s_branch L_v_e_340
L_q_e_341:
    buffer_load_dwordx4 v[60:63], v5, s[8:11], s41 offen sc1
    s_waitcnt vmcnt(2)
    v_max3_u32 v7, v60, v61, v62
    v_max_u32 v7, v7, v63
    v_cmp_eq_u32 vcc, s34, v7
    s_cbranch_vccz L_ok_e_342
    s_add_u32 s33, s33, 1
    s_cmp_gt_u32 s33, 0x100000
    s_cbranch_scc0 L_q_e_341
    s_branch chain_kernel_abort
L_ok_e_342:
    v_smfmac_f32_16x16x64_bf16 v[88:91], v[60:63], a[216:223], v6
    v_smfmac_f32_16x16x64_bf16 v[92:95], v[60:63], a[248:255], v6
    s_branch L_gd_e_332
L_q_e_337:
    buffer_load_dwordx4 v[56:59], v4, s[8:11], s41 offen sc1
    s_waitcnt vmcnt(1)
    v_max3_u32 v7, v60, v61, v62
    v_max_u32 v7, v7, v63
    v_cmp_eq_u32 vcc, s34, v7
    s_cbranch_vccnz L_q_e_343
L_v_e_344:
    v_smfmac_f32_16x16x64_bf16 v[88:91], v[60:63], a[216:223], v6
    s_waitcnt vmcnt(0)
    v_max3_u32 v7, v56, v57, v58
    v_max_u32 v7, v7, v59
    v_cmp_eq_u32 vcc, s34, v7
    v_smfmac_f32_16x16x64_bf16 v[92:95], v[60:63], a[248:255], v6
    s_cbranch_vccnz L_q_e_345
L_v_e_346:
    v_smfmac_f32_16x16x64_bf16 v[88:91], v[56:59], a[208:215], v6
    v_smfmac_f32_16x16x64_bf16 v[92:95], v[56:59], a[240:247], v6
    s_branch L_gd_e_332
L_q_e_345:
    buffer_load_dwordx4 v[56:59], v4, s[8:11], s41 offen sc1
    s_waitcnt vmcnt(2)
    v_max3_u32 v7, v56, v57, v58
    v_max_u32 v7, v7, v59
    v_cmp_eq_u32 vcc, s34, v7
    s_cbranch_vccz L_ok_e_347
    s_add_u32 s33, s33, 1
    s_cmp_gt_u32 s33, 0x100000
    s_cbranch_scc0 L_q_e_345
    s_branch chain_kernel_abort
L_ok_e_347:
    v_smfmac_f32_16x16x64_bf16 v[88:91], v[56:59], a[208:215], v6
    v_smfmac_f32_16x16x64_bf16 v[92:95], v[56:59], a[240:247], v6
    s_branch L_gd_e_332
L_q_e_343:
    buffer_load_dwordx4 v[60:63], v5, s[8:11], s41 offen sc1
    s_waitcnt vmcnt(1)
    v_max3_u32 v7, v56, v57, v58
    v_max_u32 v7, v7, v59
    v_cmp_eq_u32 vcc, s34, v7
    s_cbranch_vccnz L_q_e_348
L_v_e_349:
    v_smfmac_f32_16x16x64_bf16 v[88:91], v[56:59], a[208:215], v6
    s_waitcnt vmcnt(0)
    v_max3_u32 v7, v60, v61, v62
    v_max_u32 v7, v7, v63
    v_cmp_eq_u32 vcc, s34, v7
    v_smfmac_f32_16x16x64_bf16 v[92:95], v[56:59], a[240:247], v6
    s_cbranch_vccnz L_q_e_341
    s_branch L_v_e_340
L_q_e_348:
    buffer_load_dwordx4 v[56:59], v4, s[8:11], s41 offen sc1
    s_waitcnt vmcnt(2)
    v_max3_u32 v7, v60, v61, v62
    v_max_u32 v7, v7, v63
    v_cmp_eq_u32 vcc, s34, v7
    s_cbranch_vccz L_ok_e_350
    buffer_load_dwordx4 v[60:63], v5, s[8:11], s41 offen sc1
    s_waitcnt vmcnt(2)
    v_max3_u32 v7, v56, v57, v58
    v_max_u32 v7, v7, v59
    v_cmp_eq_u32 vcc, s34, v7
    s_cbranch_vccz L_ok_e_351
    s_add_u32 s33, s33, 1
    s_cmp_gt_u32 s33, 0x100000
    s_cbranch_scc0 L_q_e_348
    s_branch chain_kernel_abort
L_ok_e_350:
    v_smfmac_f32_16x16x64_bf16 v[88:91], v[60:63], a[216:223], v6
    v_smfmac_f32_16x16x64_bf16 v[92:95], v[60:63], a[248:255], v6
    s_branch L_q_e_345
L_ok_e_351:
    v_smfmac_f32_16x16x64_bf16 v[88:91], v[56:59], a[208:215], v6
    v_smfmac_f32_16x16x64_bf16 v[92:95], v[56:59], a[240:247], v6
    s_branch L_q_e_341
L_q_e_335:
    buffer_load_dwordx4 v[52:55], v3, s[8:11], s41 offen sc1
    s_waitcnt vmcnt(2)
    v_max3_u32 v7, v56, v57, v58
    v_max_u32 v7, v7, v59
    v_cmp_eq_u32 vcc, s34, v7
    s_cbranch_vccnz L_q_e_352
L_v_e_353:
    v_smfmac_f32_16x16x64_bf16 v[88:91], v[56:59], a[208:215], v6
    s_waitcnt vmcnt(1)
    v_max3_u32 v7, v60, v61, v62
    v_max_u32 v7, v7, v63
    v_cmp_eq_u32 vcc, s34, v7
    v_smfmac_f32_16x16x64_bf16 v[92:95], v[56:59], a[240:247], v6
    s_cbranch_vccnz L_q_e_354
L_v_e_355:
    v_smfmac_f32_16x16x64_bf16 v[88:91], v[60:63], a[216:223], v6
    s_waitcnt vmcnt(0)
    v_max3_u32 v7, v52, v53, v54
    v_max_u32 v7, v7, v55
    v_cmp_eq_u32 vcc, s34, v7
    v_smfmac_f32_16x16x64_bf16 v[92:95], v[60:63], a[248:255], v6
    s_cbranch_vccnz L_q_e_356
L_v_e_357:
    v_smfmac_f32_16x16x64_bf16 v[88:91], v[52:55], a[200:207], v6
    v_smfmac_f32_16x16x64_bf16 v[92:95], v[52:55], a[232:239], v6
    s_branch L_gd_e_332
L_q_e_356:
    buffer_load_dwordx4 v[52:55], v3, s[8:11], s41 offen sc1
    s_waitcnt vmcnt(2)
    v_max3_u32 v7, v52, v53, v54
    v_max_u32 v7, v7, v55
    v_cmp_eq_u32 vcc, s34, v7
    s_cbranch_vccz L_ok_e_358
    s_add_u32 s33, s33, 1
    s_cmp_gt_u32 s33, 0x100000
    s_cbranch_scc0 L_q_e_356
    s_branch chain_kernel_abort
L_ok_e_358:
    v_smfmac_f32_16x16x64_bf16 v[88:91], v[52:55], a[200:207], v6
    v_smfmac_f32_16x16x64_bf16 v[92:95], v[52:55], a[232:239], v6
    s_branch L_gd_e_332
L_q_e_354:
    buffer_load_dwordx4 v[60:63], v5, s[8:11], s41 offen sc1
    s_waitcnt vmcnt(1)
    v_max3_u32 v7, v52, v53, v54
    v_max_u32 v7, v7, v55
    v_cmp_eq_u32 vcc, s34, v7
    s_cbranch_vccnz L_q_e_359
L_v_e_360:
    v_smfmac_f32_16x16x64_bf16 v[88:91], v[52:55], a[200:207], v6
    s_waitcnt vmcnt(0)
    v_max3_u32 v7, v60, v61, v62
    v_max_u32 v7, v7, v63
    v_cmp_eq_u32 vcc, s34, v7
    v_smfmac_f32_16x16x64_bf16 v[92:95], v[52:55], a[232:239], v6
    s_cbranch_vccnz L_q_e_341
    s_branch L_v_e_340
L_q_e_359:
    buffer_load_dwordx4 v[52:55], v3, s[8:11], s41 offen sc1
    s_waitcnt vmcnt(2)
    v_max3_u32 v7, v60, v61, v62
    v_max_u32 v7, v7, v63
    v_cmp_eq_u32 vcc, s34, v7
    s_cbranch_vccz L_ok_e_361
    buffer_load_dwordx4 v[60:63], v5, s[8:11], s41 offen sc1
    s_waitcnt vmcnt(2)
    v_max3_u32 v7, v52, v53, v54
    v_max_u32 v7, v7, v55
    v_cmp_eq_u32 vcc, s34, v7
    s_cbranch_vccz L_ok_e_362
    s_add_u32 s33, s33, 1
    s_cmp_gt_u32 s33, 0x100000
    s_cbranch_scc0 L_q_e_359
    s_branch chain_kernel_abort
L_ok_e_361:
    v_smfmac_f32_16x16x64_bf16 v[88:91], v[60:63], a[216:223], v6
    v_smfmac_f32_16x16x64_bf16 v[92:95], v[60:63], a[248:255], v6
    s_branch L_q_e_356
L_ok_e_362:
    v_smfmac_f32_16x16x64_bf16 v[88:91], v[52:55], a[200:207], v6
    v_smfmac_f32_16x16x64_bf16 v[92:95], v[52:55], a[232:239], v6
    s_branch L_q_e_341
L_q_e_352:
    buffer_load_dwordx4 v[56:59], v4, s[8:11], s41 offen sc1
    s_waitcnt vmcnt(2)
    v_max3_u32 v7, v60, v61, v62
    v_max_u32 v7, v7, v63
    v_cmp_eq_u32 vcc, s34, v7
    s_cbranch_vccnz L_q_e_363
L_v_e_364:
    v_smfmac_f32_16x16x64_bf16 v[88:91], v[60:63], a[216:223], v6
    s_waitcnt vmcnt(1)
    v_max3_u32 v7, v52, v53, v54
    v_max_u32 v7, v7, v55
    v_cmp_eq_u32 vcc, s34, v7
    v_smfmac_f32_16x16x64_bf16 v[92:95], v[60:63], a[248:255], v6
    s_cbranch_vccnz L_q_e_365
L_v_e_366:
    v_smfmac_f32_16x16x64_bf16 v[88:91], v[52:55], a[200:207], v6
    s_waitcnt vmcnt(0)
    v_max3_u32 v7, v56, v57, v58
    v_max_u32 v7, v7, v59
    v_cmp_eq_u32 vcc, s34, v7
    v_smfmac_f32_16x16x64_bf16 v[92:95], v[52:55], a[232:239], v6
    s_cbranch_vccnz L_q_e_345
    s_branch L_v_e_346
L_q_e_365:
    buffer_load_dwordx4 v[52:55], v3, s[8:11], s41 offen sc1
    s_waitcnt vmcnt(2)
    v_max3_u32 v7, v56, v57, v58
    v_max_u32 v7, v7, v59
    v_cmp_eq_u32 vcc, s34, v7
    s_cbranch_vccz L_ok_e_367
    buffer_load_dwordx4 v[56:59], v4, s[8:11], s41 offen sc1
    s_waitcnt vmcnt(2)
    v_max3_u32 v7, v52, v53, v54
    v_max_u32 v7, v7, v55
    v_cmp_eq_u32 vcc, s34, v7
    s_cbranch_vccz L_ok_e_368
    s_add_u32 s33, s33, 1
    s_cmp_gt_u32 s33, 0x100000
    s_cbranch_scc0 L_q_e_365
    s_branch chain_kernel_abort
L_ok_e_367:
    v_smfmac_f32_16x16x64_bf16 v[88:91], v[56:59], a[208:215], v6
    v_smfmac_f32_16x16x64_bf16 v[92:95], v[56:59], a[240:247], v6
    s_branch L_q_e_356
L_ok_e_368:
    v_smfmac_f32_16x16x64_bf16 v[88:91], v[52:55], a[200:207], v6
    v_smfmac_f32_16x16x64_bf16 v[92:95], v[52:55], a[232:239], v6
    s_branch L_q_e_345
L_q_e_363:
    buffer_load_dwordx4 v[60:63], v5, s[8:11], s41 offen sc1
    s_waitcnt vmcnt(2)
    v_max3_u32 v7, v52, v53, v54
    v_max_u32 v7, v7, v55
    v_cmp_eq_u32 vcc, s34, v7
    s_cbranch_vccnz L_q_e_369
L_v_e_370:
    v_smfmac_f32_16x16x64_bf16 v[88:91], v[52:55], a[200:207], v6
    s_waitcnt vmcnt(1)
    v_max3_u32 v7, v56, v57, v58
    v_max_u32 v7, v7, v59
    v_cmp_eq_u32 vcc, s34, v7
    v_smfmac_f32_16x16x64_bf16 v[92:95], v[52:55], a[232:239], v6
    s_cbranch_vccnz L_q_e_348
    s_branch L_v_e_349
L_q_e_369:
    buffer_load_dwordx4 v[52:55], v3, s[8:11], s41 offen sc1
    s_waitcnt vmcnt(2)
    v_max3_u32 v7, v56, v57, v58
    v_max_u32 v7, v7, v59
    v_cmp_eq_u32 vcc, s34, v7
    s_cbranch_vccz L_ok_e_371
    buffer_load_dwordx4 v[56:59], v4, s[8:11], s41 offen sc1
    s_waitcnt vmcnt(2)
    v_max3_u32 v7, v60, v61, v62
    v_max_u32 v7, v7, v63
    v_cmp_eq_u32 vcc, s34, v7
    s_cbranch_vccz L_ok_e_372
    buffer_load_dwordx4 v[60:63], v5, s[8:11], s41 offen sc1
    s_waitcnt vmcnt(2)
    v_max3_u32 v7, v52, v53, v54
    v_max_u32 v7, v7, v55
    v_cmp_eq_u32 vcc, s34, v7
    s_cbranch_vccz L_ok_e_373
    s_add_u32 s33, s33, 1
    s_cmp_gt_u32 s33, 0x100000
    s_cbranch_scc0 L_q_e_369
    s_branch chain_kernel_abort
L_ok_e_371:
    v_smfmac_f32_16x16x64_bf16 v[88:91], v[56:59], a[208:215], v6
    v_smfmac_f32_16x16x64_bf16 v[92:95], v[56:59], a[240:247], v6
    s_branch L_q_e_359
L_ok_e_372:
    v_smfmac_f32_16x16x64_bf16 v[88:91], v[60:63], a[216:223], v6
    v_smfmac_f32_16x16x64_bf16 v[92:95], v[60:63], a[248:255], v6
    s_branch L_q_e_365
L_ok_e_373:
    v_smfmac_f32_16x16x64_bf16 v[88:91], v[52:55], a[200:207], v6
    v_smfmac_f32_16x16x64_bf16 v[92:95], v[52:55], a[232:239], v6
    s_branch L_q_e_348
L_q_e_333:
    buffer_load_dwordx4 v[48:51], v2, s[8:11], s41 offen sc1
    s_waitcnt vmcnt(3)
    v_max3_u32 v7, v52, v53, v54
    v_max_u32 v7, v7, v55
    v_cmp_eq_u32 vcc, s34, v7
    s_cbranch_vccnz L_q_e_374
L_v_e_375:
    v_smfmac_f32_16x16x64_bf16 v[88:91], v[52:55], a[200:207], v6
    s_waitcnt vmcnt(2)
    v_max3_u32 v7, v56, v57, v58
    v_max_u32 v7, v7, v59
    v_cmp_eq_u32 vcc, s34, v7
    v_smfmac_f32_16x16x64_bf16 v[92:95], v[52:55], a[232:239], v6
    s_cbranch_vccnz L_q_e_376
L_v_e_377:
    v_smfmac_f32_16x16x64_bf16 v[88:91], v[56:59], a[208:215], v6
    s_waitcnt vmcnt(1)
    v_max3_u32 v7, v60, v61, v62
    v_max_u32 v7, v7, v63
    v_cmp_eq_u32 vcc, s34, v7
    v_smfmac_f32_16x16x64_bf16 v[92:95], v[56:59], a[240:247], v6
    s_cbranch_vccnz L_q_e_378
L_v_e_379:
    v_smfmac_f32_16x16x64_bf16 v[88:91], v[60:63], a[216:223], v6
    s_waitcnt vmcnt(0)
    v_max3_u32 v7, v48, v49, v50
    v_max_u32 v7, v7, v51
    v_cmp_eq_u32 vcc, s34, v7
    v_smfmac_f32_16x16x64_bf16 v[92:95], v[60:63], a[248:255], v6
    s_cbranch_vccnz L_q_e_380
L_v_e_381:
    v_smfmac_f32_16x16x64_bf16 v[88:91], v[48:51], a[192:199], v6
    v_smfmac_f32_16x16x64_bf16 v[92:95], v[48:51], a[224:231], v6
    s_branch L_gd_e_332
L_q_e_380:
    buffer_load_dwordx4 v[48:51], v2, s[8:11], s41 offen sc1
    s_waitcnt vmcnt(2)
    v_max3_u32 v7, v48, v49, v50
    v_max_u32 v7, v7, v51
    v_cmp_eq_u32 vcc, s34, v7
    s_cbranch_vccz L_ok_e_382
    s_add_u32 s33, s33, 1
    s_cmp_gt_u32 s33, 0x100000
    s_cbranch_scc0 L_q_e_380
    s_branch chain_kernel_abort
L_ok_e_382:
    v_smfmac_f32_16x16x64_bf16 v[88:91], v[48:51], a[192:199], v6
    v_smfmac_f32_16x16x64_bf16 v[92:95], v[48:51], a[224:231], v6
    s_branch L_gd_e_332
L_q_e_378:
    buffer_load_dwordx4 v[60:63], v5, s[8:11], s41 offen sc1
    s_waitcnt vmcnt(1)
    v_max3_u32 v7, v48, v49, v50
    v_max_u32 v7, v7, v51
    v_cmp_eq_u32 vcc, s34, v7
    s_cbranch_vccnz L_q_e_383
L_v_e_384:
    v_smfmac_f32_16x16x64_bf16 v[88:91], v[48:51], a[192:199], v6
    s_waitcnt vmcnt(0)
    v_max3_u32 v7, v60, v61, v62
    v_max_u32 v7, v7, v63
    v_cmp_eq_u32 vcc, s34, v7
    v_smfmac_f32_16x16x64_bf16 v[92:95], v[48:51], a[224:231], v6
    s_cbranch_vccnz L_q_e_341
    s_branch L_v_e_340
L_q_e_383:
    buffer_load_dwordx4 v[48:51], v2, s[8:11], s41 offen sc1
    s_waitcnt vmcnt(2)
    v_max3_u32 v7, v60, v61, v62
    v_max_u32 v7, v7, v63
    v_cmp_eq_u32 vcc, s34, v7
    s_cbranch_vccz L_ok_e_385
    buffer_load_dwordx4 v[60:63], v5, s[8:11], s41 offen sc1
    s_waitcnt vmcnt(2)
    v_max3_u32 v7, v48, v49, v50
    v_max_u32 v7, v7, v51
    v_cmp_eq_u32 vcc, s34, v7
    s_cbranch_vccz L_ok_e_386
    s_add_u32 s33, s33, 1
    s_cmp_gt_u32 s33, 0x100000
    s_cbranch_scc0 L_q_e_383
    s_branch chain_kernel_abort
L_ok_e_385:
    v_smfmac_f32_16x16x64_bf16 v[88:91], v[60:63], a[216:223], v6
    v_smfmac_f32_16x16x64_bf16 v[92:95], v[60:63], a[248:255], v6
    s_branch L_q_e_380
L_ok_e_386:
    v_smfmac_f32_16x16x64_bf16 v[88:91], v[48:51], a[192:199], v6
    v_smfmac_f32_16x16x64_bf16 v[92:95], v[48:51], a[224:231], v6
    s_branch L_q_e_341
L_q_e_376:
    buffer_load_dwordx4 v[56:59], v4, s[8:11], s41 offen sc1
    s_waitcnt vmcnt(2)
    v_max3_u32 v7, v60, v61, v62
    v_max_u32 v7, v7, v63
    v_cmp_eq_u32 vcc, s34, v7
    s_cbranch_vccnz L_q_e_387
L_v_e_388:
    v_smfmac_f32_16x16x64_bf16 v[88:91], v[60:63], a[216:223], v6
    s_waitcnt vmcnt(1)
    v_max3_u32 v7, v48, v49, v50
    v_max_u32 v7, v7, v51
    v_cmp_eq_u32 vcc, s34, v7
    v_smfmac_f32_16x16x64_bf16 v[92:95], v[60:63], a[248:255], v6
    s_cbranch_vccnz L_q_e_389
L_v_e_390:
    v_smfmac_f32_16x16x64_bf16 v[88:91], v[48:51], a[192:199], v6
    s_waitcnt vmcnt(0)
    v_max3_u32 v7, v56, v57, v58
    v_max_u32 v7, v7, v59
    v_cmp_eq_u32 vcc, s34, v7
    v_smfmac_f32_16x16x64_bf16 v[92:95], v[48:51], a[224:231], v6
    s_cbranch_vccnz L_q_e_345
    s_branch L_v_e_346
L_q_e_389:
    buffer_load_dwordx4 v[48:51], v2, s[8:11], s41 offen sc1
    s_waitcnt vmcnt(2)
    v_max3_u32 v7, v56, v57, v58
    v_max_u32 v7, v7, v59
    v_cmp_eq_u32 vcc, s34, v7
    s_cbranch_vccz L_ok_e_391
    buffer_load_dwordx4 v[56:59], v4, s[8:11], s41 offen sc1
    s_waitcnt vmcnt(2)
    v_max3_u32 v7, v48, v49, v50
    v_max_u32 v7, v7, v51
    v_cmp_eq_u32 vcc, s34, v7
    s_cbranch_vccz L_ok_e_392
    s_add_u32 s33, s33, 1
    s_cmp_gt_u32 s33, 0x100000
    s_cbranch_scc0 L_q_e_389
    s_branch chain_kernel_abort
L_ok_e_391:
    v_smfmac_f32_16x16x64_bf16 v[88:91], v[56:59], a[208:215], v6
    v_smfmac_f32_16x16x64_bf16 v[92:95], v[56:59], a[240:247], v6
    s_branch L_q_e_380
L_ok_e_392:
    v_smfmac_f32_16x16x64_bf16 v[88:91], v[48:51], a[192:199], v6
    v_smfmac_f32_16x16x64_bf16 v[92:95], v[48:51], a[224:231], v6
    s_branch L_q_e_345
L_q_e_387:
    buffer_load_dwordx4 v[60:63], v5, s[8:11], s41 offen sc1
    s_waitcnt vmcnt(2)
    v_max3_u32 v7, v48, v49, v50
    v_max_u32 v7, v7, v51
    v_cmp_eq_u32 vcc, s34, v7
    s_cbranch_vccnz L_q_e_393
L_v_e_394:
    v_smfmac_f32_16x16x64_bf16 v[88:91], v[48:51], a[192:199], v6
    s_waitcnt vmcnt(1)
    v_max3_u32 v7, v56, v57, v58
    v_max_u32 v7, v7, v59
    v_cmp_eq_u32 vcc, s34, v7
    v_smfmac_f32_16x16x64_bf16 v[92:95], v[48:51], a[224:231], v6
    s_cbranch_vccnz L_q_e_348
    s_branch L_v_e_349
L_q_e_393:
    buffer_load_dwordx4 v[48:51], v2, s[8:11], s41 offen sc1
    s_waitcnt vmcnt(2)
    v_max3_u32 v7, v56, v57, v58
    v_max_u32 v7, v7, v59
    v_cmp_eq_u32 vcc, s34, v7
    s_cbranch_vccz L_ok_e_395
    buffer_load_dwordx4 v[56:59], v4, s[8:11], s41 offen sc1
    s_waitcnt vmcnt(2)
    v_max3_u32 v7, v60, v61, v62
    v_max_u32 v7, v7, v63
    v_cmp_eq_u32 vcc, s34, v7
    s_cbranch_vccz L_ok_e_396
    buffer_load_dwordx4 v[60:63], v5, s[8:11], s41 offen sc1
    s_waitcnt vmcnt(2)
    v_max3_u32 v7, v48, v49, v50
    v_max_u32 v7, v7, v51
    v_cmp_eq_u32 vcc, s34, v7
    s_cbranch_vccz L_ok_e_397
    s_add_u32 s33, s33, 1
    s_cmp_gt_u32 s33, 0x100000
    s_cbranch_scc0 L_q_e_393
    s_branch chain_kernel_abort
L_ok_e_395:
    v_smfmac_f32_16x16x64_bf16 v[88:91], v[56:59], a[208:215], v6
    v_smfmac_f32_16x16x64_bf16 v[92:95], v[56:59], a[240:247], v6
    s_branch L_q_e_383
L_ok_e_396:
    v_smfmac_f32_16x16x64_bf16 v[88:91], v[60:63], a[216:223], v6
    v_smfmac_f32_16x16x64_bf16 v[92:95], v[60:63], a[248:255], v6
    s_branch L_q_e_389
L_ok_e_397:
    v_smfmac_f32_16x16x64_bf16 v[88:91], v[48:51], a[192:199], v6
    v_smfmac_f32_16x16x64_bf16 v[92:95], v[48:51], a[224:231], v6
    s_branch L_q_e_348
L_q_e_374:
    buffer_load_dwordx4 v[52:55], v3, s[8:11], s41 offen sc1
    s_waitcnt vmcnt(3)
    v_max3_u32 v7, v56, v57, v58
    v_max_u32 v7, v7, v59
    v_cmp_eq_u32 vcc, s34, v7
    s_cbranch_vccnz L_q_e_398
L_v_e_399:
    v_smfmac_f32_16x16x64_bf16 v[88:91], v[56:59], a[208:215], v6
    s_waitcnt vmcnt(2)
    v_max3_u32 v7, v60, v61, v62
    v_max_u32 v7, v7, v63
    v_cmp_eq_u32 vcc, s34, v7
    v_smfmac_f32_16x16x64_bf16 v[92:95], v[56:59], a[240:247], v6
    s_cbranch_vccnz L_q_e_400
L_v_e_401:
    v_smfmac_f32_16x16x64_bf16 v[88:91], v[60:63], a[216:223], v6
    s_waitcnt vmcnt(1)
    v_max3_u32 v7, v48, v49, v50
    v_max_u32 v7, v7, v51
    v_cmp_eq_u32 vcc, s34, v7
    v_smfmac_f32_16x16x64_bf16 v[92:95], v[60:63], a[248:255], v6
    s_cbranch_vccnz L_q_e_402
L_v_e_403:
    v_smfmac_f32_16x16x64_bf16 v[88:91], v[48:51], a[192:199], v6
    s_waitcnt vmcnt(0)
    v_max3_u32 v7, v52, v53, v54
    v_max_u32 v7, v7, v55
    v_cmp_eq_u32 vcc, s34, v7
    v_smfmac_f32_16x16x64_bf16 v[92:95], v[48:51], a[224:231], v6
    s_cbranch_vccnz L_q_e_356
    s_branch L_v_e_357
L_q_e_402:
    buffer_load_dwordx4 v[48:51], v2, s[8:11], s41 offen sc1
    s_waitcnt vmcnt(2)
    v_max3_u32 v7, v52, v53, v54
    v_max_u32 v7, v7, v55
    v_cmp_eq_u32 vcc, s34, v7
    s_cbranch_vccz L_ok_e_404
    buffer_load_dwordx4 v[52:55], v3, s[8:11], s41 offen sc1
    s_waitcnt vmcnt(2)
    v_max3_u32 v7, v48, v49, v50
    v_max_u32 v7, v7, v51
    v_cmp_eq_u32 vcc, s34, v7
    s_cbranch_vccz L_ok_e_405
    s_add_u32 s33, s33, 1
    s_cmp_gt_u32 s33, 0x100000
    s_cbranch_scc0 L_q_e_402
    s_branch chain_kernel_abort
L_ok_e_404:
    v_smfmac_f32_16x16x64_bf16 v[88:91], v[52:55], a[200:207], v6
    v_smfmac_f32_16x16x64_bf16 v[92:95], v[52:55], a[232:239], v6
    s_branch L_q_e_380
L_ok_e_405:
    v_smfmac_f32_16x16x64_bf16 v[88:91], v[48:51], a[192:199], v6
    v_smfmac_f32_16x16x64_bf16 v[92:95], v[48:51], a[224:231], v6
    s_branch L_q_e_356
L_q_e_400:
    buffer_load_dwordx4 v[60:63], v5, s[8:11], s41 offen sc1
    s_waitcnt vmcnt(2)
    v_max3_u32 v7, v48, v49, v50
    v_max_u32 v7, v7, v51
    v_cmp_eq_u32 vcc, s34, v7
    s_cbranch_vccnz L_q_e_406
L_v_e_407:
    v_smfmac_f32_16x16x64_bf16 v[88:91], v[48:51], a[192:199], v6
    s_waitcnt vmcnt(1)
    v_max3_u32 v7, v52, v53, v54
    v_max_u32 v7, v7, v55
    v_cmp_eq_u32 vcc, s34, v7
    v_smfmac_f32_16x16x64_bf16 v[92:95], v[48:51], a[224:231], v6
    s_cbranch_vccnz L_q_e_359
    s_branch L_v_e_360
L_q_e_406:
    buffer_load_dwordx4 v[48:51], v2, s[8:11], s41 offen sc1
    s_waitcnt vmcnt(2)
    v_max3_u32 v7, v52, v53, v54
    v_max_u32 v7, v7, v55
    v_cmp_eq_u32 vcc, s34, v7
    s_cbranch_vccz L_ok_e_408
    buffer_load_dwordx4 v[52:55], v3, s[8:11], s41 offen sc1
    s_waitcnt vmcnt(2)
    v_max3_u32 v7, v60, v61, v62
    v_max_u32 v7, v7, v63
    v_cmp_eq_u32 vcc, s34, v7
    s_cbranch_vccz L_ok_e_409
    buffer_load_dwordx4 v[60:63], v5, s[8:11], s41 offen sc1
    s_waitcnt vmcnt(2)
    v_max3_u32 v7, v48, v49, v50
    v_max_u32 v7, v7, v51
    v_cmp_eq_u32 vcc, s34, v7
    s_cbranch_vccz L_ok_e_410
    s_add_u32 s33, s33, 1
    s_cmp_gt_u32 s33, 0x100000
    s_cbranch_scc0 L_q_e_406
    s_branch chain_kernel_abort
L_ok_e_408:
    v_smfmac_f32_16x16x64_bf16 v[88:91], v[52:55], a[200:207], v6
    v_smfmac_f32_16x16x64_bf16 v[92:95], v[52:55], a[232:239], v6
    s_branch L_q_e_383
L_ok_e_409:
    v_smfmac_f32_16x16x64_bf16 v[88:91], v[60:63], a[216:223], v6
    v_smfmac_f32_16x16x64_bf16 v[92:95], v[60:63], a[248:255], v6
    s_branch L_q_e_402
L_ok_e_410:
    v_smfmac_f32_16x16x64_bf16 v[88:91], v[48:51], a[192:199], v6
    v_smfmac_f32_16x16x64_bf16 v[92:95], v[48:51], a[224:231], v6
    s_branch L_q_e_359
L_q_e_398:
    buffer_load_dwordx4 v[56:59], v4, s[8:11], s41 offen sc1
    s_waitcnt vmcnt(3)
    v_max3_u32 v7, v60, v61, v62
    v_max_u32 v7, v7, v63
    v_cmp_eq_u32 vcc, s34, v7
    s_cbranch_vccnz L_q_e_411
L_v_e_412:
    v_smfmac_f32_16x16x64_bf16 v[88:91], v[60:63], a[216:223], v6
    s_waitcnt vmcnt(2)
    v_max3_u32 v7, v48, v49, v50
    v_max_u32 v7, v7, v51
    v_cmp_eq_u32 vcc, s34, v7
    v_smfmac_f32_16x16x64_bf16 v[92:95], v[60:63], a[248:255], v6
    s_cbranch_vccnz L_q_e_413
L_v_e_414:
    v_smfmac_f32_16x16x64_bf16 v[88:91], v[48:51], a[192:199], v6
    s_waitcnt vmcnt(1)
    v_max3_u32 v7, v52, v53, v54
    v_max_u32 v7, v7, v55
    v_cmp_eq_u32 vcc, s34, v7
    v_smfmac_f32_16x16x64_bf16 v[92:95], v[48:51], a[224:231], v6
    s_cbranch_vccnz L_q_e_365
    s_branch L_v_e_366
L_q_e_413:
    buffer_load_dwordx4 v[48:51], v2, s[8:11], s41 offen sc1
    s_waitcnt vmcnt(2)
    v_max3_u32 v7, v52, v53, v54
    v_max_u32 v7, v7, v55
    v_cmp_eq_u32 vcc, s34, v7
    s_cbranch_vccz L_ok_e_415
    buffer_load_dwordx4 v[52:55], v3, s[8:11], s41 offen sc1
    s_waitcnt vmcnt(2)
    v_max3_u32 v7, v56, v57, v58
    v_max_u32 v7, v7, v59
    v_cmp_eq_u32 vcc, s34, v7
    s_cbranch_vccz L_ok_e_416
    buffer_load_dwordx4 v[56:59], v4, s[8:11], s41 offen sc1
    s_waitcnt vmcnt(2)
    v_max3_u32 v7, v48, v49, v50
    v_max_u32 v7, v7, v51
    v_cmp_eq_u32 vcc, s34, v7
    s_cbranch_vccz L_ok_e_417
    s_add_u32 s33, s33, 1
    s_cmp_gt_u32 s33, 0x100000
    s_cbranch_scc0 L_q_e_413
    s_branch chain_kernel_abort
L_ok_e_415:
    v_smfmac_f32_16x16x64_bf16 v[88:91], v[52:55], a[200:207], v6
    v_smfmac_f32_16x16x64_bf16 v[92:95], v[52:55], a[232:239], v6
    s_branch L_q_e_389
L_ok_e_416:
    v_smfmac_f32_16x16x64_bf16 v[88:91], v[56:59], a[208:215], v6
    v_smfmac_f32_16x16x64_bf16 v[92:95], v[56:59], a[240:247], v6
    s_branch L_q_e_402
L_ok_e_417:
    v_smfmac_f32_16x16x64_bf16 v[88:91], v[48:51], a[192:199], v6
    v_smfmac_f32_16x16x64_bf16 v[92:95], v[48:51], a[224:231], v6
    s_branch L_q_e_365
L_q_e_411:
    buffer_load_dwordx4 v[60:63], v5, s[8:11], s41 offen sc1
    s_waitcnt vmcnt(3)
    v_max3_u32 v7, v48, v49, v50
    v_max_u32 v7, v7, v51
    v_cmp_eq_u32 vcc, s34, v7
    s_cbranch_vccnz L_q_e_418
L_v_e_419:
    v_smfmac_f32_16x16x64_bf16 v[88:91], v[48:51], a[192:199], v6
    s_waitcnt vmcnt(2)
    v_max3_u32 v7, v52, v53, v54
    v_max_u32 v7, v7, v55
    v_cmp_eq_u32 vcc, s34, v7
    v_smfmac_f32_16x16x64_bf16 v[92:95], v[48:51], a[224:231], v6
    s_cbranch_vccnz L_q_e_369
    s_branch L_v_e_370
L_q_e_418:
    buffer_load_dwordx4 v[48:51], v2, s[8:11], s41 offen sc1
    s_waitcnt vmcnt(2)
    v_max3_u32 v7, v52, v53, v54
    v_max_u32 v7, v7, v55
    v_cmp_eq_u32 vcc, s34, v7
    s_cbranch_vccz L_ok_e_420
    buffer_load_dwordx4 v[52:55], v3, s[8:11], s41 offen sc1
    s_waitcnt vmcnt(2)
    v_max3_u32 v7, v56, v57, v58
    v_max_u32 v7, v7, v59
    v_cmp_eq_u32 vcc, s34, v7
    s_cbranch_vccz L_ok_e_421
    buffer_load_dwordx4 v[56:59], v4, s[8:11], s41 offen sc1
    s_waitcnt vmcnt(2)
    v_max3_u32 v7, v60, v61, v62
    v_max_u32 v7, v7, v63
    v_cmp_eq_u32 vcc, s34, v7
    s_cbranch_vccz L_ok_e_422
    buffer_load_dwordx4 v[60:63], v5, s[8:11], s41 offen sc1
    s_waitcnt vmcnt(2)
    v_max3_u32 v7, v48, v49, v50
    v_max_u32 v7, v7, v51
    v_cmp_eq_u32 vcc, s34, v7
    s_cbranch_vccz L_ok_e_423
    s_add_u32 s33, s33, 1
    s_cmp_gt_u32 s33, 0x100000
    s_cbranch_scc0 L_q_e_418
    s_branch chain_kernel_abort
L_ok_e_420:
    v_smfmac_f32_16x16x64_bf16 v[88:91], v[52:55], a[200:207], v6
    v_smfmac_f32_16x16x64_bf16 v[92:95], v[52:55], a[232:239], v6
    s_branch L_q_e_393
L_ok_e_421:
    v_smfmac_f32_16x16x64_bf16 v[88:91], v[56:59], a[208:215], v6
    v_smfmac_f32_16x16x64_bf16 v[92:95], v[56:59], a[240:247], v6
    s_branch L_q_e_406
L_ok_e_422:
    v_smfmac_f32_16x16x64_bf16 v[88:91], v[60:63], a[216:223], v6
    v_smfmac_f32_16x16x64_bf16 v[92:95], v[60:63], a[248:255], v6
    s_branch L_q_e_413
L_ok_e_423:
    v_smfmac_f32_16x16x64_bf16 v[88:91], v[48:51], a[192:199], v6
    v_smfmac_f32_16x16x64_bf16 v[92:95], v[48:51], a[224:231], v6
    s_branch L_q_e_369
L_gf_424:
    s_waitcnt vmcnt(4)
    v_lshlrev_b32 v100, 16, v212
    v_and_b32 v101, 0xffff0000, v212
    v_lshlrev_b32 v102, 16, v213
    v_and_b32 v103, 0xffff0000, v213
    v_pk_add_f32 v[148:149], v[168:169], v[100:101]
    v_pk_add_f32 v[150:151], v[170:171], v[102:103]
    s_waitcnt vmcnt(3)
    v_lshlrev_b32 v100, 16, v214
    v_and_b32 v101, 0xffff0000, v214
    v_lshlrev_b32 v102, 16, v215
    v_and_b32 v103, 0xffff0000, v215
    v_pk_add_f32 v[148:149], v[148:149], v[100:101]
    v_pk_add_f32 v[150:151], v[150:151], v[102:103]
    s_waitcnt vmcnt(2)
    v_lshlrev_b32 v100, 16, v216
    v_and_b32 v101, 0xffff0000, v216
    v_lshlrev_b32 v102, 16, v217
    v_and_b32 v103, 0xffff0000, v217
    v_pk_add_f32 v[148:149], v[148:149], v[100:101]
    v_pk_add_f32 v[150:151], v[150:151], v[102:103]
    v_cmp_u_f32 vcc, v148, v150
    v_cvt_pk_bf16_f32 v180, v148, v149
    v_cvt_pk_bf16_f32 v181, v150, v151
    s_cbranch_vccz L_gok_425
    buffer_load_dwordx2 v[212:213], v17, s[8:11], s22 offen offset:512 sc1
    buffer_load_dwordx2 v[214:215], v18, s[8:11], s22 offen offset:512 sc1
    buffer_load_dwordx2 v[216:217], v19, s[8:11], s22 offen offset:512 sc1
    s_nop 11
L_rt_427:
    buffer_load_dwordx2 v[200:201], v17, s[8:11], s22 offen offset:0 sc1
    buffer_load_dwordx2 v[202:203], v18, s[8:11], s22 offen offset:0 sc1
    buffer_load_dwordx2 v[204:205], v19, s[8:11], s22 offen offset:0 sc1
    s_waitcnt vmcnt(5)
    v_lshlrev_b32 v100, 16, v212
    v_and_b32 v101, 0xffff0000, v212
    v_lshlrev_b32 v102, 16, v213
    v_and_b32 v103, 0xffff0000, v213
    v_pk_add_f32 v[148:149], v[168:169], v[100:101]
    v_pk_add_f32 v[150:151], v[170:171], v[102:103]
    s_waitcnt vmcnt(4)
    v_lshlrev_b32 v100, 16, v214
    v_and_b32 v101, 0xffff0000, v214
    v_lshlrev_b32 v102, 16, v215
    v_and_b32 v103, 0xffff0000, v215
    v_pk_add_f32 v[148:149], v[148:149], v[100:101]
    v_pk_add_f32 v[150:151], v[150:151], v[102:103]
    s_waitcnt vmcnt(3)
    v_lshlrev_b32 v100, 16, v216
    v_and_b32 v101, 0xffff0000, v216
    v_lshlrev_b32 v102, 16, v217
    v_and_b32 v103, 0xffff0000, v217
    v_pk_add_f32 v[148:149], v[148:149], v[100:101]
    v_pk_add_f32 v[150:151], v[150:151], v[102:103]
    v_cmp_u_f32 vcc, v148, v150
    v_cvt_pk_bf16_f32 v180, v148, v149
    v_cvt_pk_bf16_f32 v181, v150, v151
    s_cbranch_vccz L_gok_425
    buffer_load_dwordx2 v[212:213], v17, s[8:11], s22 offen offset:512 sc1
    buffer_load_dwordx2 v[214:215], v18, s[8:11], s22 offen offset:512 sc1
    buffer_load_dwordx2 v[216:217], v19, s[8:11], s22 offen offset:512 sc1
    s_waitcnt vmcnt(5)
    v_lshlrev_b32 v100, 16, v200
    v_and_b32 v101, 0xffff0000, v200
    v_lshlrev_b32 v102, 16, v201
    v_and_b32 v103, 0xffff0000, v201
    v_pk_add_f32 v[148:149], v[168:169], v[100:101]
    v_pk_add_f32 v[150:151], v[170:171], v[102:103]
    s_waitcnt vmcnt(4)
    v_lshlrev_b32 v100, 16, v202
    v_and_b32 v101, 0xffff0000, v202
    v_lshlrev_b32 v102, 16, v203
    v_and_b32 v103, 0xffff0000, v203
    v_pk_add_f32 v[148:149], v[148:149], v[100:101]
    v_pk_add_f32 v[150:151], v[150:151], v[102:103]
    s_waitcnt vmcnt(3)
    v_lshlrev_b32 v100, 16, v204
    v_and_b32 v101, 0xffff0000, v204
    v_lshlrev_b32 v102, 16, v205
    v_and_b32 v103, 0xffff0000, v205
    v_pk_add_f32 v[148:149], v[148:149], v[100:101]
    v_pk_add_f32 v[150:151], v[150:151], v[102:103]
    v_cmp_u_f32 vcc, v148, v150
    v_cvt_pk_bf16_f32 v180, v148, v149
    v_cvt_pk_bf16_f32 v181, v150, v151
    s_cbranch_vccz L_gok_425
    s_add_u32 s33, s33, 1
    s_cmp_gt_u32 s33, 0x100000
    s_cbranch_scc1 chain_kernel_abort
    s_and_b32 s20, s33, 63
    s_cbranch_scc1 L_rt_427
    v_cmp_eq_u32 vcc, s34, v200
    v_cmp_eq_u32 s[20:21], s34, v201
    s_or_b64 vcc, vcc, s[20:21]
    v_cmp_eq_u32 s[20:21], s34, v202
    s_or_b64 vcc, vcc, s[20:21]
    v_cmp_eq_u32 s[20:21], s34, v203
    s_or_b64 vcc, vcc, s[20:21]
    v_cmp_eq_u32 s[20:21], s34, v204
    s_or_b64 vcc, vcc, s[20:21]
    v_cmp_eq_u32 s[20:21], s34, v205
    s_or_b64 vcc, vcc, s[20:21]
    s_cbranch_vccnz L_rt_427
    s_branch L_gok_425
chain_kernel_abort:
    s_mov_b64 exec, 1
    v_mov_b32 v1, s19
    v_or_b32 v1, 0xdead0000, v1
    v_mov_b32 v2, 124
    buffer_store_dword v1, v2, s[12:15], 0 offen
chain_kernel_done:
    s_endpgm
chain_kernel_worker:
    s_sub_u32 s40, s16, 4
    s_lshl_b32 s40, s40, 2
    s_lshr_b32 s40, 0x3210, s40
    s_and_b32 s40, s40, 3
    s_mov_b32 s41, s17
    s_mov_b32 s49, s18
    s_mov_b32 s12, s100
    s_and_b32 s13, s101, 0xffff
    s_mov_b32 s14, 0x10000000
    s_mov_b32 s15, 0x00020000
    s_mov_b32 s36, 0
    v_mov_b32 v84, 1
    v_min_u32 v85, 1, v0
    v_lshlrev_b32 v85, 30, v85
    s_cmp_eq_u32 s40, 3
    s_cbranch_scc1 L_g1_433
    s_mov_b32 s25, s40
    s_cmp_eq_u32 s25, 1
    s_cselect_b32 s16, s90, s88
    s_cselect_b32 s17, s91, s89
    s_cmp_eq_u32 s25, 2
    s_cselect_b32 s16, s86, s16
    s_cselect_b32 s17, s87, s17
    s_and_b32 s17, s17, 0xffff
    s_mov_b32 s18, 0x800000
    s_mov_b32 s19, 0x00020000
    s_mov_b32 s46, s41
    s_lshl_b32 s44, s46, 8
    s_mov_b32 s8, s82
    s_and_b32 s9, s83, 0xffff
    s_mov_b32 s10, 0x400000
    s_mov_b32 s11, 0x00020000
    v_lshlrev_b32 v1, 4, v0
    s_lshl_b32 s25, s41, 12
    buffer_load_dwordx4 v[52:55], v1, s[8:11], s25 offen
    s_add_u32 s25, s25, 131072
    buffer_load_dwordx4 v[52:55], v1, s[8:11], s25 offen
    s_add_u32 s25, s25, 131072
    v_and_b32 v1, 15, v0
    v_bfe_u32 v2, v0, 4, 2
    v_lshrrev_b32 v3, 6, v0
    v_lshlrev_b32 v4, 2, v2
    v_xor_b32 v4, v4, v1
    v_lshlrev_b32 v4, 4, v4
    v_lshl_add_u32 v5, v3, 5, v2
    s_mov_b32 s25, 8192
    v_mul_lo_u32 v5, v5, s25
    v_add_u32 v20, v5, v4
    v_bfe_u32 v4, v0, 2, 2
    v_lshl_add_u32 v5, v2, 3, v4
    v_lshlrev_b32 v5, 8, v5
    v_xor_b32 v4, v4, v3
    v_lshl_add_u32 v5, v4, 6, v5
    v_and_b32 v4, 3, v0
    v_lshl_add_u32 v5, v4, 3, v5
    v_and_b32 v4, 2, v4
    v_lshl_add_u32 v21, v4, 3, v5
    v_add_u32 v22, 16, v21
    v_add_u32 v23, 0x10000, v21
    v_add_u32 v24, 0x10000, v22
    s_lshl_b32 s26, s49, 13
    s_mov_b32 s25, s44
    s_barrier
    s_add_u32 m0, s26, 0
    s_add_u32 s27, s25, 0
    buffer_load_dwordx4 v20, s[16:19], s27 offen lds
    s_add_u32 m0, s26, 1024
    s_add_u32 s27, s25, 32768
    buffer_load_dwordx4 v20, s[16:19], s27 offen lds
    s_add_u32 m0, s26, 2048
    s_add_u32 s27, s25, 65536
    buffer_load_dwordx4 v20, s[16:19], s27 offen lds
    s_add_u32 m0, s26, 3072
    s_add_u32 s27, s25, 98304
    buffer_load_dwordx4 v20, s[16:19], s27 offen lds
    s_add_u32 m0, s26, 4096
    s_add_u32 s27, s25, 131072
    buffer_load_dwordx4 v20, s[16:19], s27 offen lds
    s_add_u32 m0, s26, 5120
    s_add_u32 s27, s25, 163840
    buffer_load_dwordx4 v20, s[16:19], s27 offen lds
    s_add_u32 m0, s26, 6144
    s_add_u32 s27, s25, 196608
    buffer_load_dwordx4 v20, s[16:19], s27 offen lds
    s_add_u32 m0, s26, 7168
    s_add_u32 s27, s25, 229376
    buffer_load_dwordx4 v20, s[16:19], s27 offen lds
    s_add_u32 m0, s26, 32768
    s_add_u32 s27, s25, 1048576
    buffer_load_dwordx4 v20, s[16:19], s27 offen lds
    s_add_u32 m0, s26, 33792
    s_add_u32 s27, s25, 1081344
    buffer_load_dwordx4 v20, s[16:19], s27 offen lds
    s_add_u32 m0, s26, 34816
    s_add_u32 s27, s25, 1114112
    buffer_load_dwordx4 v20, s[16:19], s27 offen lds
    s_add_u32 m0, s26, 35840
    s_add_u32 s27, s25, 1146880
    buffer_load_dwordx4 v20, s[16:19], s27 offen lds
    s_add_u32 m0, s26, 36864
    s_add_u32 s27, s25, 1179648
    buffer_load_dwordx4 v20, s[16:19], s27 offen lds
    s_add_u32 m0, s26, 37888
    s_add_u32 s27, s25, 1212416
    buffer_load_dwordx4 v20, s[16:19], s27 offen lds
    s_add_u32 m0, s26, 38912
    s_add_u32 s27, s25, 1245184
    buffer_load_dwordx4 v20, s[16:19], s27 offen lds
    s_add_u32 m0, s26, 39936
    s_add_u32 s27, s25, 1277952
    buffer_load_dwordx4 v20, s[16:19], s27 offen lds
    s_add_u32 m0, s26, 65536
    s_add_u32 s27, s25, 2097152
    buffer_load_dwordx4 v20, s[16:19], s27 offen lds
    s_add_u32 m0, s26, 66560
    s_add_u32 s27, s25, 2129920
    buffer_load_dwordx4 v20, s[16:19], s27 offen lds
    s_add_u32 m0, s26, 67584
    s_add_u32 s27, s25, 2162688
    buffer_load_dwordx4 v20, s[16:19], s27 offen lds
    s_add_u32 m0, s26, 68608
    s_add_u32 s27, s25, 2195456
    buffer_load_dwordx4 v20, s[16:19], s27 offen lds
    s_add_u32 m0, s26, 69632
    s_add_u32 s27, s25, 2228224
    buffer_load_dwordx4 v20, s[16:19], s27 offen lds
    s_add_u32 m0, s26, 70656
    s_add_u32 s27, s25, 2260992
    buffer_load_dwordx4 v20, s[16:19], s27 offen lds
    s_add_u32 m0, s26, 71680
    s_add_u32 s27, s25, 2293760
    buffer_load_dwordx4 v20, s[16:19], s27 offen lds
    s_add_u32 m0, s26, 72704
    s_add_u32 s27, s25, 2326528
    buffer_load_dwordx4 v20, s[16:19], s27 offen lds
    s_add_u32 m0, s26, 98304
    s_add_u32 s27, s25, 3145728
    buffer_load_dwordx4 v20, s[16:19], s27 offen lds
    s_add_u32 m0, s26, 99328
    s_add_u32 s27, s25, 3178496
    buffer_load_dwordx4 v20, s[16:19], s27 offen lds
    s_add_u32 m0, s26, 100352
    s_add_u32 s27, s25, 3211264
    buffer_load_dwordx4 v20, s[16:19], s27 offen lds
    s_add_u32 m0, s26, 101376
    s_add_u32 s27, s25, 3244032
    buffer_load_dwordx4 v20, s[16:19], s27 offen lds
    s_add_u32 m0, s26, 102400
    s_add_u32 s27, s25, 3276800
    buffer_load_dwordx4 v20, s[16:19], s27 offen lds
    s_add_u32 m0, s26, 103424
    s_add_u32 s27, s25, 3309568
    buffer_load_dwordx4 v20, s[16:19], s27 offen lds
    s_add_u32 m0, s26, 104448
    s_add_u32 s27, s25, 3342336
    buffer_load_dwordx4 v20, s[16:19], s27 offen lds
    s_add_u32 m0, s26, 105472
    s_add_u32 s27, s25, 3375104
    buffer_load_dwordx4 v20, s[16:19], s27 offen lds
    s_waitcnt vmcnt(24)
    s_barrier
    ds_read_b64_tr_b16 a[0:1], v21 offset:0
    ds_read_b64_tr_b16 a[2:3], v21 offset:1024
    ds_read_b64_tr_b16 a[4:5], v22 offset:0
    ds_read_b64_tr_b16 a[6:7], v22 offset:1024
    ds_read_b64_tr_b16 a[8:9], v21 offset:8192
    ds_read_b64_tr_b16 a[10:11], v21 offset:9216
    ds_read_b64_tr_b16 a[12:13], v22 offset:8192
    ds_read_b64_tr_b16 a[14:15], v22 offset:9216
    s_waitcnt lgkmcnt(0)
    ds_read_b64_tr_b16 a[16:17], v21 offset:16384
    ds_read_b64_tr_b16 a[18:19], v21 offset:17408
    ds_read_b64_tr_b16 a[20:21], v22 offset:16384
    ds_read_b64_tr_b16 a[22:23], v22 offset:17408
    ds_read_b64_tr_b16 a[24:25], v21 offset:24576
    ds_read_b64_tr_b16 a[26:27], v21 offset:25600
    ds_read_b64_tr_b16 a[28:29], v22 offset:24576
    ds_read_b64_tr_b16 a[30:31], v22 offset:25600
    s_waitcnt lgkmcnt(0)
    s_barrier
    s_add_u32 m0, s26, 0
    s_add_u32 s27, s25, 4194304
    buffer_load_dwordx4 v20, s[16:19], s27 offen lds
    s_add_u32 m0, s26, 1024
    s_add_u32 s27, s25, 4227072
    buffer_load_dwordx4 v20, s[16:19], s27 offen lds
    s_add_u32 m0, s26, 2048
    s_add_u32 s27, s25, 4259840
    buffer_load_dwordx4 v20, s[16:19], s27 offen lds
    s_add_u32 m0, s26, 3072
    s_add_u32 s27, s25, 4292608
    buffer_load_dwordx4 v20, s[16:19], s27 offen lds
    s_add_u32 m0, s26, 4096
    s_add_u32 s27, s25, 4325376
    buffer_load_dwordx4 v20, s[16:19], s27 offen lds
    s_add_u32 m0, s26, 5120
    s_add_u32 s27, s25, 4358144
    buffer_load_dwordx4 v20, s[16:19], s27 offen lds
    s_add_u32 m0, s26, 6144
    s_add_u32 s27, s25, 4390912
    buffer_load_dwordx4 v20, s[16:19], s27 offen lds
    s_add_u32 m0, s26, 7168
    s_add_u32 s27, s25, 4423680
    buffer_load_dwordx4 v20, s[16:19], s27 offen lds
    s_waitcnt vmcnt(24)
    s_barrier
    ds_read_b64_tr_b16 a[32:33], v21 offset:32768
    ds_read_b64_tr_b16 a[34:35], v21 offset:33792
    ds_read_b64_tr_b16 a[36:37], v22 offset:32768
    ds_read_b64_tr_b16 a[38:39], v22 offset:33792
    ds_read_b64_tr_b16 a[40:41], v21 offset:40960
    ds_read_b64_tr_b16 a[42:43], v21 offset:41984
    ds_read_b64_tr_b16 a[44:45], v22 offset:40960
    ds_read_b64_tr_b16 a[46:47], v22 offset:41984
    s_waitcnt lgkmcnt(0)
    ds_read_b64_tr_b16 a[48:49], v21 offset:49152
    ds_read_b64_tr_b16 a[50:51], v21 offset:50176
    ds_read_b64_tr_b16 a[52:53], v22 offset:49152
    ds_read_b64_tr_b16 a[54:55], v22 offset:50176
    ds_read_b64_tr_b16 a[56:57], v21 offset:57344
    ds_read_b64_tr_b16 a[58:59], v21 offset:58368
    ds_read_b64_tr_b16 a[60:61], v22 offset:57344
    ds_read_b64_tr_b16 a[62:63], v22 offset:58368
    s_waitcnt lgkmcnt(0)
    s_barrier
    s_add_u32 m0, s26, 32768
    s_add_u32 s27, s25, 5242880
    buffer_load_dwordx4 v20, s[16:19], s27 offen lds
    s_add_u32 m0, s26, 33792
    s_add_u32 s27, s25, 5275648
    buffer_load_dwordx4 v20, s[16:19], s27 offen lds
    s_add_u32 m0, s26, 34816
    s_add_u32 s27, s25, 5308416
    buffer_load_dwordx4 v20, s[16:19], s27 offen lds
    s_add_u32 m0, s26, 35840
    s_add_u32 s27, s25, 5341184
    buffer_load_dwordx4 v20, s[16:19], s27 offen lds
    s_add_u32 m0, s26, 36864
    s_add_u32 s27, s25, 5373952
    buffer_load_dwordx4 v20, s[16:19], s27 offen lds
    s_add_u32 m0, s26, 37888
    s_add_u32 s27, s25, 5406720
    buffer_load_dwordx4 v20, s[16:19], s27 offen lds
    s_add_u32 m0, s26, 38912
    s_add_u32 s27, s25, 5439488
    buffer_load_dwordx4 v20, s[16:19], s27 offen lds
    s_add_u32 m0, s26, 39936
    s_add_u32 s27, s25, 5472256
    buffer_load_dwordx4 v20, s[16:19], s27 offen lds
    s_waitcnt vmcnt(24)
    s_barrier
    ds_read_b64_tr_b16 a[64:65], v23 offset:0
    ds_read_b64_tr_b16 a[66:67], v23 offset:1024
    ds_read_b64_tr_b16 a[68:69], v24 offset:0
    ds_read_b64_tr_b16 a[70:71], v24 offset:1024
    ds_read_b64_tr_b16 a[72:73], v23 offset:8192
    ds_read_b64_tr_b16 a[74:75], v23 offset:9216
    ds_read_b64_tr_b16 a[76:77], v24 offset:8192
    ds_read_b64_tr_b16 a[78:79], v24 offset:9216
    s_waitcnt lgkmcnt(0)
    ds_read_b64_tr_b16 a[80:81], v23 offset:16384
    ds_read_b64_tr_b16 a[82:83], v23 offset:17408
    ds_read_b64_tr_b16 a[84:85], v24 offset:16384
    ds_read_b64_tr_b16 a[86:87], v24 offset:17408
    ds_read_b64_tr_b16 a[88:89], v23 offset:24576
    ds_read_b64_tr_b16 a[90:91], v23 offset:25600
    ds_read_b64_tr_b16 a[92:93], v24 offset:24576
    ds_read_b64_tr_b16 a[94:95], v24 offset:25600
    s_waitcnt lgkmcnt(0)
    s_barrier
    s_add_u32 m0, s26, 65536
    s_add_u32 s27, s25, 6291456
    buffer_load_dwordx4 v20, s[16:19], s27 offen lds
    s_add_u32 m0, s26, 66560
    s_add_u32 s27, s25, 6324224
    buffer_load_dwordx4 v20, s[16:19], s27 offen lds
    s_add_u32 m0, s26, 67584
    s_add_u32 s27, s25, 6356992
    buffer_load_dwordx4 v20, s[16:19], s27 offen lds
    s_add_u32 m0, s26, 68608
    s_add_u32 s27, s25, 6389760
    buffer_load_dwordx4 v20, s[16:19], s27 offen lds
    s_add_u32 m0, s26, 69632
    s_add_u32 s27, s25, 6422528
    buffer_load_dwordx4 v20, s[16:19], s27 offen lds
    s_add_u32 m0, s26, 70656
    s_add_u32 s27, s25, 6455296
    buffer_load_dwordx4 v20, s[16:19], s27 offen lds
    s_add_u32 m0, s26, 71680
    s_add_u32 s27, s25, 6488064
    buffer_load_dwordx4 v20, s[16:19], s27 offen lds
    s_add_u32 m0, s26, 72704
    s_add_u32 s27, s25, 6520832
    buffer_load_dwordx4 v20, s[16:19], s27 offen lds
    s_waitcnt vmcnt(24)
    s_barrier
    ds_read_b64_tr_b16 a[96:97], v23 offset:32768
    ds_read_b64_tr_b16 a[98:99], v23 offset:33792
    ds_read_b64_tr_b16 a[100:101], v24 offset:32768
    ds_read_b64_tr_b16 a[102:103], v24 offset:33792
    ds_read_b64_tr_b16 a[104:105], v23 offset:40960
    ds_read_b64_tr_b16 a[106:107], v23 offset:41984
    ds_read_b64_tr_b16 a[108:109], v24 offset:40960
    ds_read_b64_tr_b16 a[110:111], v24 offset:41984
    s_waitcnt lgkmcnt(0)
    ds_read_b64_tr_b16 a[112:113], v23 offset:49152
    ds_read_b64_tr_b16 a[114:115], v23 offset:50176
    ds_read_b64_tr_b16 a[116:117], v24 offset:49152
    ds_read_b64_tr_b16 a[118:119], v24 offset:50176
    ds_read_b64_tr_b16 a[120:121], v23 offset:57344
    ds_read_b64_tr_b16 a[122:123], v23 offset:58368
    ds_read_b64_tr_b16 a[124:125], v24 offset:57344
    ds_read_b64_tr_b16 a[126:127], v24 offset:58368
    s_waitcnt lgkmcnt(0)
    s_barrier
    s_add_u32 m0, s26, 98304
    s_add_u32 s27, s25, 7340032
    buffer_load_dwordx4 v20, s[16:19], s27 offen lds
    s_add_u32 m0, s26, 99328
    s_add_u32 s27, s25, 7372800
    buffer_load_dwordx4 v20, s[16:19], s27 offen lds
    s_add_u32 m0, s26, 100352
    s_add_u32 s27, s25, 7405568
    buffer_load_dwordx4 v20, s[16:19], s27 offen lds
    s_add_u32 m0, s26, 101376
    s_add_u32 s27, s25, 7438336
    buffer_load_dwordx4 v20, s[16:19], s27 offen lds
    s_add_u32 m0, s26, 102400
    s_add_u32 s27, s25, 7471104
    buffer_load_dwordx4 v20, s[16:19], s27 offen lds
    s_add_u32 m0, s26, 103424
    s_add_u32 s27, s25, 7503872
    buffer_load_dwordx4 v20, s[16:19], s27 offen lds
    s_add_u32 m0, s26, 104448
    s_add_u32 s27, s25, 7536640
    buffer_load_dwordx4 v20, s[16:19], s27 offen lds
    s_add_u32 m0, s26, 105472
    s_add_u32 s27, s25, 7569408
    buffer_load_dwordx4 v20, s[16:19], s27 offen lds
    s_waitcnt vmcnt(24)
    s_barrier
    ds_read_b64_tr_b16 a[128:129], v21 offset:0
    ds_read_b64_tr_b16 a[130:131], v21 offset:1024
    ds_read_b64_tr_b16 a[132:133], v22 offset:0
    ds_read_b64_tr_b16 a[134:135], v22 offset:1024
    ds_read_b64_tr_b16 a[136:137], v21 offset:8192
    ds_read_b64_tr_b16 a[138:139], v21 offset:9216
    ds_read_b64_tr_b16 a[140:141], v22 offset:8192
    ds_read_b64_tr_b16 a[142:143], v22 offset:9216
    s_waitcnt lgkmcnt(0)
    ds_read_b64_tr_b16 a[144:145], v21 offset:16384
    ds_read_b64_tr_b16 a[146:147], v21 offset:17408
    ds_read_b64_tr_b16 a[148:149], v22 offset:16384
    ds_read_b64_tr_b16 a[150:151], v22 offset:17408
    ds_read_b64_tr_b16 a[152:153], v21 offset:24576
    ds_read_b64_tr_b16 a[154:155], v21 offset:25600
    ds_read_b64_tr_b16 a[156:157], v22 offset:24576
    ds_read_b64_tr_b16 a[158:159], v22 offset:25600
    s_waitcnt lgkmcnt(0)
    s_waitcnt vmcnt(16)
    s_barrier
    ds_read_b64_tr_b16 a[160:161], v21 offset:32768
    ds_read_b64_tr_b16 a[162:163], v21 offset:33792
    ds_read_b64_tr_b16 a[164:165], v22 offset:32768
    ds_read_b64_tr_b16 a[166:167], v22 offset:33792
    ds_read_b64_tr_b16 a[168:169], v21 offset:40960
    ds_read_b64_tr_b16 a[170:171], v21 offset:41984
    ds_read_b64_tr_b16 a[172:173], v22 offset:40960
    ds_read_b64_tr_b16 a[174:175], v22 offset:41984
    s_waitcnt lgkmcnt(0)
    ds_read_b64_tr_b16 a[176:177], v21 offset:49152
    ds_read_b64_tr_b16 a[178:179], v21 offset:50176
    ds_read_b64_tr_b16 a[180:181], v22 offset:49152
    ds_read_b64_tr_b16 a[182:183], v22 offset:50176
    ds_read_b64_tr_b16 a[184:185], v21 offset:57344
    ds_read_b64_tr_b16 a[186:187], v21 offset:58368
    ds_read_b64_tr_b16 a[188:189], v22 offset:57344
    ds_read_b64_tr_b16 a[190:191], v22 offset:58368
    s_waitcnt lgkmcnt(0)
    s_waitcnt vmcnt(8)
    s_barrier
    ds_read_b64_tr_b16 a[192:193], v23 offset:0
    ds_read_b64_tr_b16 a[194:195], v23 offset:1024
    ds_read_b64_tr_b16 a[196:197], v24 offset:0
    ds_read_b64_tr_b16 a[198:199], v24 offset:1024
    ds_read_b64_tr_b16 a[200:201], v23 offset:8192
    ds_read_b64_tr_b16 a[202:203], v23 offset:9216
    ds_read_b64_tr_b16 a[204:205], v24 offset:8192
    ds_read_b64_tr_b16 a[206:207], v24 offset:9216
    s_waitcnt lgkmcnt(0)
    ds_read_b64_tr_b16 a[208:209], v23 offset:16384
    ds_read_b64_tr_b16 a[210:211], v23 offset:17408
    ds_read_b64_tr_b16 a[212:213], v24 offset:16384
    ds_read_b64_tr_b16 a[214:215], v24 offset:17408
    ds_read_b64_tr_b16 a[216:217], v23 offset:24576
    ds_read_b64_tr_b16 a[218:219], v23 offset:25600
    ds_read_b64_tr_b16 a[220:221], v24 offset:24576
    ds_read_b64_tr_b16 a[222:223], v24 offset:25600
    s_waitcnt lgkmcnt(0)
    s_waitcnt vmcnt(0)
    s_barrier
    ds_read_b64_tr_b16 a[224:225], v23 offset:32768
    ds_read_b64_tr_b16 a[226:227], v23 offset:33792
    ds_read_b64_tr_b16 a[228:229], v24 offset:32768
    ds_read_b64_tr_b16 a[230:231], v24 offset:33792
    ds_read_b64_tr_b16 a[232:233], v23 offset:40960
    ds_read_b64_tr_b16 a[234:235], v23 offset:41984
    ds_read_b64_tr_b16 a[236:237], v24 offset:40960
    ds_read_b64_tr_b16 a[238:239], v24 offset:41984
    s_waitcnt lgkmcnt(0)
    ds_read_b64_tr_b16 a[240:241], v23 offset:49152
    ds_read_b64_tr_b16 a[242:243], v23 offset:50176
    ds_read_b64_tr_b16 a[244:245], v24 offset:49152
    ds_read_b64_tr_b16 a[246:247], v24 offset:50176
    ds_read_b64_tr_b16 a[248:249], v23 offset:57344
    ds_read_b64_tr_b16 a[250:251], v23 offset:58368
    ds_read_b64_tr_b16 a[252:253], v24 offset:57344
    ds_read_b64_tr_b16 a[254:255], v24 offset:58368
    s_waitcnt lgkmcnt(0)
    s_lshl_b32 s21, s49, 12
    v_and_b32 v1, 63, v0
    v_and_b32 v2, 15, v0
    v_bfe_u32 v3, v0, 4, 2
    v_lshrrev_b32 v4, 6, v0
    v_lshrrev_b32 v5, 5, v1
    v_lshl_add_u32 v5, v4, 3, v5
    v_add_u32 v5, 0, v5
    v_and_b32 v6, 7, v5
    v_lshrrev_b32 v7, 4, v5
    v_lshl_add_u32 v6, v7, 3, v6
    v_and_b32 v7, 31, v1
    v_xor_b32 v6, v6, v7
    v_lshlrev_b32 v6, 4, v6
    v_lshl_add_u32 v8, v5, 11, v6
    v_lshrrev_b32 v5, 5, v1
    v_lshl_add_u32 v5, v4, 3, v5
    v_add_u32 v5, 2, v5
    v_and_b32 v6, 7, v5
    v_lshrrev_b32 v7, 4, v5
    v_lshl_add_u32 v6, v7, 3, v6
    v_and_b32 v7, 31, v1
    v_xor_b32 v6, v6, v7
    v_lshlrev_b32 v6, 4, v6
    v_lshl_add_u32 v9, v5, 11, v6
    v_lshrrev_b32 v5, 5, v1
    v_lshl_add_u32 v5, v4, 3, v5
    v_add_u32 v5, 4, v5
    v_and_b32 v6, 7, v5
    v_lshrrev_b32 v7, 4, v5
    v_lshl_add_u32 v6, v7, 3, v6
    v_and_b32 v7, 31, v1
    v_xor_b32 v6, v6, v7
    v_lshlrev_b32 v6, 4, v6
    v_lshl_add_u32 v10, v5, 11, v6
    v_lshrrev_b32 v5, 5, v1
    v_lshl_add_u32 v5, v4, 3, v5
    v_add_u32 v5, 6, v5
    v_and_b32 v6, 7, v5
    v_lshrrev_b32 v7, 4, v5
    v_lshl_add_u32 v6, v7, 3, v6
    v_and_b32 v7, 31, v1
    v_xor_b32 v6, v6, v7
    v_lshlrev_b32 v6, 4, v6
    v_lshl_add_u32 v11, v5, 11, v6
    v_and_b32 v5, 8, v2
    v_add_u32 v5, v5, v2
    v_add_u32 v6, 0, v3
    v_xor_b32 v6, v6, v2
    v_lshlrev_b32 v6, 4, v6
    v_lshl_add_u32 v12, v5, 9, v6
    v_add_u32 v6, 4, v3
    v_xor_b32 v6, v6, v2
    v_lshlrev_b32 v6, 4, v6
    v_lshl_add_u32 v13, v5, 9, v6
    v_add_u32 v6, 8, v3
    v_xor_b32 v6, v6, v2
    v_lshlrev_b32 v6, 4, v6
    v_lshl_add_u32 v14, v5, 9, v6
    v_add_u32 v6, 12, v3
    v_xor_b32 v6, v6, v2
    v_lshlrev_b32 v6, 4, v6
    v_lshl_add_u32 v15, v5, 9, v6
    v_add_u32 v16, 0x10000, v12
    v_add_u32 v17, 0x10000, v13
    v_add_u32 v18, 0x10000, v14
    v_add_u32 v19, 0x10000, v15
    v_lshlrev_b32 v86, 4, v5
    v_lshl_add_u32 v86, v3, 9, v86
    s_lshl_b32 s44, s46, 15
    s_lshr_b32 s25, s49, 1
    s_lshl_b32 s25, s25, 14
    s_add_u32 s44, s44, s25
    s_and_b32 s25, s49, 1
    s_lshl_b32 s25, s25, 12
    s_add_u32 s44, s44, s25
    s_mov_b32 s22, 0
    s_mov_b32 s24, 0
    s_mov_b32 s20, 0
    s_mov_b32 s37, 0
    s_mov_b32 s23, 64
    s_mov_b32 s32, s98
    s_and_b32 s33, s99, 0xffff
    s_mov_b32 s34, 0x100
    s_mov_b32 s35, 0x00020000
    s_mov_b32 s25, 0
    v_mov_b32 v2, 0
L_pl_436:
    buffer_load_dword v1, v2, s[32:35], s25 offen sc1
    s_add_u32 s36, s36, 1
    s_cmp_gt_u32 s36, 0x100000
    s_cbranch_scc1 chain_kernel_wend
    s_waitcnt vmcnt(0)
    v_readfirstlane_b32 s26, v1
    s_and_b32 s27, s26, 0xffff
    s_cmp_ge_u32 s27, 256
    s_cbranch_scc1 L_plok_437
    s_sleep 4
    s_branch L_pl_436
L_plok_437:
    s_lshr_b32 s25, s26, 16
    s_cmp_gt_u32 s25, 16
    s_cselect_b32 s25, 0x2000, 0x0
    s_add_u32 s54, s100, 0x1fffff
    s_and_b32 s54, s54, 0xffe00000
    s_sub_u32 s55, s54, s100
    s_add_u32 s54, s55, s25
    s_xor_b32 s25, s25, 0x2000
    s_add_u32 s55, s55, s25
    s_cmp_eq_u32 s40, 2
    s_cbranch_scc1 L_q_432
    s_cmp_eq_u32 s40, 1
    s_cbranch_scc1 L_v_431
    v_mov_b32 v96, 0xff81ff81
    v_mov_b32 v97, 0xff81ff81
    v_mov_b32 v98, 0xff81ff81
    v_mov_b32 v99, 0xff81ff81
    v_and_b32 v100, 63, v0
    v_lshlrev_b32 v101, 3, v100
    v_lshlrev_b32 v100, 4, v100
    s_barrier
    s_add_u32 m0, s21, 0
    s_nop 0
    buffer_load_dwordx4 v8, s[8:11], s20 offen lds
    s_add_u32 m0, s21, 1024
    s_nop 0
    buffer_load_dwordx4 v9, s[8:11], s20 offen lds
    s_add_u32 m0, s21, 2048
    s_nop 0
    buffer_load_dwordx4 v10, s[8:11], s20 offen lds
    s_add_u32 m0, s21, 3072
    s_nop 0
    buffer_load_dwordx4 v11, s[8:11], s20 offen lds
    s_add_u32 s20, s20, 512
    s_add_u32 m0, s21, 16384
    s_nop 0
    buffer_load_dwordx4 v8, s[8:11], s20 offen lds
    s_add_u32 m0, s21, 17408
    s_nop 0
    buffer_load_dwordx4 v9, s[8:11], s20 offen lds
    s_add_u32 m0, s21, 18432
    s_nop 0
    buffer_load_dwordx4 v10, s[8:11], s20 offen lds
    s_add_u32 m0, s21, 19456
    s_nop 0
    buffer_load_dwordx4 v11, s[8:11], s20 offen lds
    s_add_u32 s20, s20, 512
    s_add_u32 m0, s21, 32768
    s_nop 0
    buffer_load_dwordx4 v8, s[8:11], s20 offen lds
    s_add_u32 m0, s21, 33792
    s_nop 0
    buffer_load_dwordx4 v9, s[8:11], s20 offen lds
    s_add_u32 m0, s21, 34816
    s_nop 0
    buffer_load_dwordx4 v10, s[8:11], s20 offen lds
    s_add_u32 m0, s21, 35840
    s_nop 0
    buffer_load_dwordx4 v11, s[8:11], s20 offen lds
    s_add_u32 s20, s20, 512
    s_add_u32 m0, s21, 49152
    s_nop 0
    buffer_load_dwordx4 v8, s[8:11], s20 offen lds
    s_add_u32 m0, s21, 50176
    s_nop 0
    buffer_load_dwordx4 v9, s[8:11], s20 offen lds
    s_add_u32 m0, s21, 51200
    s_nop 0
    buffer_load_dwordx4 v10, s[8:11], s20 offen lds
    s_add_u32 m0, s21, 52224
    s_nop 0
    buffer_load_dwordx4 v11, s[8:11], s20 offen lds
    s_add_u32 s24, s24, 1
    s_min_u32 s24, s24, 63
    s_lshl_b32 s53, s24, 16
    s_mov_b32 s20, s53
    s_add_u32 m0, s21, 65536
    s_nop 0
    buffer_load_dwordx4 v8, s[8:11], s20 offen lds
    s_add_u32 m0, s21, 66560
    s_nop 0
    buffer_load_dwordx4 v9, s[8:11], s20 offen lds
    s_add_u32 m0, s21, 67584
    s_nop 0
    buffer_load_dwordx4 v10, s[8:11], s20 offen lds
    s_add_u32 m0, s21, 68608
    s_nop 0
    buffer_load_dwordx4 v11, s[8:11], s20 offen lds
    s_add_u32 s20, s20, 512
    s_add_u32 m0, s21, 81920
    s_nop 0
    buffer_load_dwordx4 v8, s[8:11], s20 offen lds
    s_add_u32 m0, s21, 82944
    s_nop 0
    buffer_load_dwordx4 v9, s[8:11], s20 offen lds
    s_add_u32 m0, s21, 83968
    s_nop 0
    buffer_load_dwordx4 v10, s[8:11], s20 offen lds
    s_add_u32 m0, s21, 84992
    s_nop 0
    buffer_load_dwordx4 v11, s[8:11], s20 offen lds
    s_add_u32 s20, s20, 512
    s_add_u32 m0, s21, 98304
    s_nop 0
    buffer_load_dwordx4 v8, s[8:11], s20 offen lds
    s_waitcnt vmcnt(21)
    s_barrier
    ds_read_b128 v[20:23], v12 offset:0
    ds_read_b128 v[24:27], v12 offset:4096
    ds_read_b128 v[28:31], v13 offset:0
    ds_read_b128 v[32:35], v13 offset:4096
    ds_read_b128 v[36:39], v14 offset:0
    ds_read_b128 v[40:43], v14 offset:4096
    s_waitcnt lgkmcnt(4)
L_st_441:
    v_mfma_f32_16x16x32_bf16 v[52:55], a[0:3], v[20:23], 0
    ds_read_b128 v[44:47], v15 offset:0
    s_add_u32 m0, s21, 99328
    s_sub_u32 s39, s22, 1
    v_mfma_f32_16x16x32_bf16 v[56:59], a[4:7], v[20:23], 0
    buffer_load_dwordx4 v9, s[8:11], s20 offen lds
    s_bitcmp1_b32 s39, 1
    s_cselect_b32 s38, s55, s54
    v_mfma_f32_16x16x32_bf16 v[60:63], a[0:3], v[24:27], 0
    ds_read_b128 v[48:51], v15 offset:4096
    v_mfma_f32_16x16x32_bf16 v[64:67], a[4:7], v[24:27], 0
    s_waitcnt lgkmcnt(4)
    s_add_u32 s38, s38, s44
    v_mfma_f32_16x16x32_bf16 v[52:55], a[8:11], v[28:31], v[52:55]
    ds_read_b128 v[20:23], v12 offset:256
    s_lshl_b32 s42, s39, 20
    v_mfma_f32_16x16x32_bf16 v[56:59], a[12:15], v[28:31], v[56:59]
    s_add_u32 s38, s38, s42
    s_lshl_b32 s39, s39, 7
    v_mfma_f32_16x16x32_bf16 v[60:63], a[8:11], v[32:35], v[60:63]
    ds_read_b128 v[24:27], v12 offset:4352
    s_add_u32 s39, s39, 0x5900000
    s_cmp_eq_u32 s37, 0
    s_cselect_b32 s38, 0x7ff00000, s38
    s_cselect_b32 s39, 0x7ff00000, s39
    v_mfma_f32_16x16x32_bf16 v[64:67], a[12:15], v[32:35], v[64:67]
    s_waitcnt lgkmcnt(4)
    v_mfma_f32_16x16x32_bf16 v[52:55], a[16:19], v[36:39], v[52:55]
    ds_read_b128 v[28:31], v13 offset:256
    s_add_u32 m0, s21, 100352
    v_mfma_f32_16x16x32_bf16 v[56:59], a[20:23], v[36:39], v[56:59]
    buffer_load_dwordx4 v10, s[8:11], s20 offen lds
    v_mfma_f32_16x16x32_bf16 v[60:63], a[16:19], v[40:43], v[60:63]
    ds_read_b128 v[32:35], v13 offset:4352
    v_cvt_pk_bf16_f32 v88, v68, v69
    v_mfma_f32_16x16x32_bf16 v[64:67], a[20:23], v[40:43], v[64:67]
    s_waitcnt lgkmcnt(4)
    v_cvt_pk_bf16_f32 v89, v70, v71
    v_cvt_pk_bf16_f32 v90, v72, v73
    v_mfma_f32_16x16x32_bf16 v[52:55], a[24:27], v[44:47], v[52:55]
    ds_read_b128 v[36:39], v14 offset:256
    v_cvt_pk_bf16_f32 v91, v74, v75
    v_mfma_f32_16x16x32_bf16 v[56:59], a[28:31], v[44:47], v[56:59]
    buffer_store_dwordx4 v[88:91], v86, s[12:15], s38 offen offset:0 sc1
    v_mfma_f32_16x16x32_bf16 v[60:63], a[24:27], v[48:51], v[60:63]
    ds_read_b128 v[40:43], v14 offset:4352
    v_cvt_pk_bf16_f32 v92, v76, v77
    v_mfma_f32_16x16x32_bf16 v[64:67], a[28:31], v[48:51], v[64:67]
    s_waitcnt lgkmcnt(4)
    v_cvt_pk_bf16_f32 v93, v78, v79
    v_mfma_f32_16x16x32_bf16 v[52:55], a[32:35], v[20:23], v[52:55]
    ds_read_b128 v[44:47], v15 offset:256
    s_add_u32 m0, s21, 101376
    v_mfma_f32_16x16x32_bf16 v[56:59], a[36:39], v[20:23], v[56:59]
    buffer_load_dwordx4 v11, s[8:11], s20 offen lds
    v_mfma_f32_16x16x32_bf16 v[60:63], a[32:35], v[24:27], v[60:63]
    ds_read_b128 v[48:51], v15 offset:4352
    v_cvt_pk_bf16_f32 v94, v80, v81
    v_mfma_f32_16x16x32_bf16 v[64:67], a[36:39], v[24:27], v[64:67]
    s_waitcnt lgkmcnt(4)
    v_cvt_pk_bf16_f32 v95, v82, v83
    v_mfma_f32_16x16x32_bf16 v[52:55], a[40:43], v[28:31], v[52:55]
    s_waitcnt vmcnt(20)
    s_barrier
    ds_read_b128 v[20:23], v12 offset:16384
    v_mfma_f32_16x16x32_bf16 v[56:59], a[44:47], v[28:31], v[56:59]
    s_add_u32 s20, s20, 512
    buffer_store_dwordx4 v[92:95], v86, s[12:15], s38 offen offset:128 sc1
    v_mfma_f32_16x16x32_bf16 v[60:63], a[40:43], v[32:35], v[60:63]
    ds_read_b128 v[24:27], v12 offset:20480
    s_add_u32 s42, s38, 0x8000000
    v_mfma_f32_16x16x32_bf16 v[64:67], a[44:47], v[32:35], v[64:67]
    s_waitcnt lgkmcnt(4)
    s_cmp_le_u32 s22, 52
    s_cbranch_scc1 L_nokm_442
    buffer_store_dwordx4 v[96:99], v100, s[12:15], s42 offen offset:3072 sc1
L_nokm_442:
    v_mfma_f32_16x16x32_bf16 v[52:55], a[48:51], v[36:39], v[52:55]
    ds_read_b128 v[28:31], v13 offset:16384
    s_add_u32 m0, s21, 114688
    v_mfma_f32_16x16x32_bf16 v[56:59], a[52:55], v[36:39], v[56:59]
    buffer_load_dwordx4 v8, s[8:11], s20 offen lds
    v_mfma_f32_16x16x32_bf16 v[60:63], a[48:51], v[40:43], v[60:63]
    ds_read_b128 v[32:35], v13 offset:20480
    v_mfma_f32_16x16x32_bf16 v[64:67], a[52:55], v[40:43], v[64:67]
    s_waitcnt lgkmcnt(4)
    v_mfma_f32_16x16x32_bf16 v[52:55], a[56:59], v[44:47], v[52:55]
    ds_read_b128 v[36:39], v14 offset:16384
    v_mfma_f32_16x16x32_bf16 v[56:59], a[60:63], v[44:47], v[56:59]
    buffer_store_dwordx2 v[96:97], v101, s[12:15], s42 offen offset:0 sc1
    v_mfma_f32_16x16x32_bf16 v[60:63], a[56:59], v[48:51], v[60:63]
    ds_read_b128 v[40:43], v14 offset:20480
    v_mfma_f32_16x16x32_bf16 v[64:67], a[60:63], v[48:51], v[64:67]
    s_waitcnt lgkmcnt(4)
    v_mfma_f32_16x16x32_bf16 v[52:55], a[64:67], v[20:23], v[52:55]
    ds_read_b128 v[44:47], v15 offset:16384
    s_add_u32 m0, s21, 115712
    v_mfma_f32_16x16x32_bf16 v[56:59], a[68:71], v[20:23], v[56:59]
    buffer_load_dwordx4 v9, s[8:11], s20 offen lds
    v_mfma_f32_16x16x32_bf16 v[60:63], a[64:67], v[24:27], v[60:63]
    ds_read_b128 v[48:51], v15 offset:20480
    v_mfma_f32_16x16x32_bf16 v[64:67], a[68:71], v[24:27], v[64:67]
    s_waitcnt lgkmcnt(4)
    v_mfma_f32_16x16x32_bf16 v[52:55], a[72:75], v[28:31], v[52:55]
    ds_read_b128 v[20:23], v12 offset:16640
    v_mfma_f32_16x16x32_bf16 v[56:59], a[76:79], v[28:31], v[56:59]
    v_mfma_f32_16x16x32_bf16 v[60:63], a[72:75], v[32:35], v[60:63]
    ds_read_b128 v[24:27], v12 offset:20736
    s_add_u32 s24, s24, 1
    v_mfma_f32_16x16x32_bf16 v[64:67], a[76:79], v[32:35], v[64:67]
    s_waitcnt lgkmcnt(4)
    v_mfma_f32_16x16x32_bf16 v[52:55], a[80:83], v[36:39], v[52:55]
    ds_read_b128 v[28:31], v13 offset:16640
    s_add_u32 m0, s21, 116736
    v_mfma_f32_16x16x32_bf16 v[56:59], a[84:87], v[36:39], v[56:59]
    buffer_load_dwordx4 v10, s[8:11], s20 offen lds
    v_mfma_f32_16x16x32_bf16 v[60:63], a[80:83], v[40:43], v[60:63]
    ds_read_b128 v[32:35], v13 offset:20736
    v_mfma_f32_16x16x32_bf16 v[64:67], a[84:87], v[40:43], v[64:67]
    s_waitcnt lgkmcnt(4)
    s_min_u32 s24, s24, 63
    v_mfma_f32_16x16x32_bf16 v[52:55], a[88:91], v[44:47], v[52:55]
    ds_read_b128 v[36:39], v14 offset:16640
    v_mfma_f32_16x16x32_bf16 v[56:59], a[92:95], v[44:47], v[56:59]
    v_mfma_f32_16x16x32_bf16 v[60:63], a[88:91], v[48:51], v[60:63]
    ds_read_b128 v[40:43], v14 offset:20736
    s_lshl_b32 s53, s24, 16
    v_mfma_f32_16x16x32_bf16 v[64:67], a[92:95], v[48:51], v[64:67]
    s_waitcnt lgkmcnt(4)
    v_mfma_f32_16x16x32_bf16 v[52:55], a[96:99], v[20:23], v[52:55]
    ds_read_b128 v[44:47], v15 offset:16640
    s_add_u32 m0, s21, 117760
    v_mfma_f32_16x16x32_bf16 v[56:59], a[100:103], v[20:23], v[56:59]
    buffer_load_dwordx4 v11, s[8:11], s20 offen lds
    v_mfma_f32_16x16x32_bf16 v[60:63], a[96:99], v[24:27], v[60:63]
    ds_read_b128 v[48:51], v15 offset:20736
    v_mfma_f32_16x16x32_bf16 v[64:67], a[100:103], v[24:27], v[64:67]
    s_waitcnt lgkmcnt(4)
    v_mfma_f32_16x16x32_bf16 v[52:55], a[104:107], v[28:31], v[52:55]
    s_waitcnt vmcnt(20)
    s_barrier
    ds_read_b128 v[20:23], v12 offset:32768
    v_mfma_f32_16x16x32_bf16 v[56:59], a[108:111], v[28:31], v[56:59]
    s_mov_b32 s20, s53
    v_mfma_f32_16x16x32_bf16 v[60:63], a[104:107], v[32:35], v[60:63]
    ds_read_b128 v[24:27], v12 offset:36864
    v_mfma_f32_16x16x32_bf16 v[64:67], a[108:111], v[32:35], v[64:67]
    s_waitcnt lgkmcnt(4)
    v_mfma_f32_16x16x32_bf16 v[52:55], a[112:115], v[36:39], v[52:55]
    ds_read_b128 v[28:31], v13 offset:32768
    s_add_u32 m0, s21, 0
    v_mfma_f32_16x16x32_bf16 v[56:59], a[116:119], v[36:39], v[56:59]
    buffer_load_dwordx4 v8, s[8:11], s20 offen lds
    v_mfma_f32_16x16x32_bf16 v[60:63], a[112:115], v[40:43], v[60:63]
    ds_read_b128 v[32:35], v13 offset:36864
    v_mfma_f32_16x16x32_bf16 v[64:67], a[116:119], v[40:43], v[64:67]
    s_waitcnt lgkmcnt(4)
    v_mfma_f32_16x16x32_bf16 v[52:55], a[120:123], v[44:47], v[52:55]
    ds_read_b128 v[36:39], v14 offset:32768
    v_mfma_f32_16x16x32_bf16 v[56:59], a[124:127], v[44:47], v[56:59]
    v_mfma_f32_16x16x32_bf16 v[60:63], a[120:123], v[48:51], v[60:63]
    ds_read_b128 v[40:43], v14 offset:36864
    v_mfma_f32_16x16x32_bf16 v[64:67], a[124:127], v[48:51], v[64:67]
    s_waitcnt lgkmcnt(4)
    v_mfma_f32_16x16x32_bf16 v[52:55], a[128:131], v[20:23], v[52:55]
    ds_read_b128 v[44:47], v15 offset:32768
    s_add_u32 m0, s21, 1024
    v_mfma_f32_16x16x32_bf16 v[56:59], a[132:135], v[20:23], v[56:59]
    buffer_load_dwordx4 v9, s[8:11], s20 offen lds
    v_mfma_f32_16x16x32_bf16 v[60:63], a[128:131], v[24:27], v[60:63]
    ds_read_b128 v[48:51], v15 offset:36864
    v_mfma_f32_16x16x32_bf16 v[64:67], a[132:135], v[24:27], v[64:67]
    s_waitcnt lgkmcnt(4)
    v_mfma_f32_16x16x32_bf16 v[52:55], a[136:139], v[28:31], v[52:55]
    ds_read_b128 v[20:23], v12 offset:33024
    v_mfma_f32_16x16x32_bf16 v[56:59], a[140:143], v[28:31], v[56:59]
    v_mfma_f32_16x16x32_bf16 v[60:63], a[136:139], v[32:35], v[60:63]
    ds_read_b128 v[24:27], v12 offset:37120
    v_mfma_f32_16x16x32_bf16 v[64:67], a[140:143], v[32:35], v[64:67]
    s_waitcnt lgkmcnt(4)
    v_mfma_f32_16x16x32_bf16 v[52:55], a[144:147], v[36:39], v[52:55]
    ds_read_b128 v[28:31], v13 offset:33024
    s_add_u32 m0, s21, 2048
    v_mfma_f32_16x16x32_bf16 v[56:59], a[148:151], v[36:39], v[56:59]
    buffer_load_dwordx4 v10, s[8:11], s20 offen lds
    v_mfma_f32_16x16x32_bf16 v[60:63], a[144:147], v[40:43], v[60:63]
    ds_read_b128 v[32:35], v13 offset:37120
    v_mfma_f32_16x16x32_bf16 v[64:67], a[148:151], v[40:43], v[64:67]
    s_waitcnt lgkmcnt(4)
    v_mfma_f32_16x16x32_bf16 v[52:55], a[152:155], v[44:47], v[52:55]
    ds_read_b128 v[36:39], v14 offset:33024
    v_mfma_f32_16x16x32_bf16 v[56:59], a[156:159], v[44:47], v[56:59]
    v_mfma_f32_16x16x32_bf16 v[60:63], a[152:155], v[48:51], v[60:63]
    ds_read_b128 v[40:43], v14 offset:37120
    v_mfma_f32_16x16x32_bf16 v[64:67], a[156:159], v[48:51], v[64:67]
    s_waitcnt lgkmcnt(4)
    v_mfma_f32_16x16x32_bf16 v[52:55], a[160:163], v[20:23], v[52:55]
    ds_read_b128 v[44:47], v15 offset:33024
    s_add_u32 m0, s21, 3072
    v_mfma_f32_16x16x32_bf16 v[56:59], a[164:167], v[20:23], v[56:59]
    buffer_load_dwordx4 v11, s[8:11], s20 offen lds
    v_mfma_f32_16x16x32_bf16 v[60:63], a[160:163], v[24:27], v[60:63]
    ds_read_b128 v[48:51], v15 offset:37120
    v_mfma_f32_16x16x32_bf16 v[64:67], a[164:167], v[24:27], v[64:67]
    s_waitcnt lgkmcnt(4)
    v_mfma_f32_16x16x32_bf16 v[52:55], a[168:171], v[28:31], v[52:55]
    s_waitcnt vmcnt(7)
    s_barrier
    ds_read_b128 v[20:23], v12 offset:49152
    v_mfma_f32_16x16x32_bf16 v[56:59], a[172:175], v[28:31], v[56:59]
    s_add_u32 s20, s20, 512
    buffer_atomic_add v84, v85, s[12:15], s39 offen sc1
    v_mfma_f32_16x16x32_bf16 v[60:63], a[168:171], v[32:35], v[60:63]
    ds_read_b128 v[24:27], v12 offset:53248
    s_mov_b32 s37, 1
    v_mfma_f32_16x16x32_bf16 v[64:67], a[172:175], v[32:35], v[64:67]
    s_waitcnt lgkmcnt(4)
    v_mfma_f32_16x16x32_bf16 v[52:55], a[176:179], v[36:39], v[52:55]
    ds_read_b128 v[28:31], v13 offset:49152
    s_add_u32 m0, s21, 16384
    v_mfma_f32_16x16x32_bf16 v[56:59], a[180:183], v[36:39], v[56:59]
    buffer_load_dwordx4 v8, s[8:11], s20 offen lds
    v_mfma_f32_16x16x32_bf16 v[60:63], a[176:179], v[40:43], v[60:63]
    ds_read_b128 v[32:35], v13 offset:53248
    v_mfma_f32_16x16x32_bf16 v[64:67], a[180:183], v[40:43], v[64:67]
    s_waitcnt lgkmcnt(4)
    v_mfma_f32_16x16x32_bf16 v[52:55], a[184:187], v[44:47], v[52:55]
    ds_read_b128 v[36:39], v14 offset:49152
    v_mfma_f32_16x16x32_bf16 v[56:59], a[188:191], v[44:47], v[56:59]
    v_mfma_f32_16x16x32_bf16 v[60:63], a[184:187], v[48:51], v[60:63]
    ds_read_b128 v[40:43], v14 offset:53248
    v_mfma_f32_16x16x32_bf16 v[64:67], a[188:191], v[48:51], v[64:67]
    s_waitcnt lgkmcnt(4)
    v_mfma_f32_16x16x32_bf16 v[52:55], a[192:195], v[20:23], v[52:55]
    ds_read_b128 v[44:47], v15 offset:49152
    s_add_u32 m0, s21, 17408
    v_mfma_f32_16x16x32_bf16 v[56:59], a[196:199], v[20:23], v[56:59]
    buffer_load_dwordx4 v9, s[8:11], s20 offen lds
    v_mfma_f32_16x16x32_bf16 v[60:63], a[192:195], v[24:27], v[60:63]
    ds_read_b128 v[48:51], v15 offset:53248
    v_mfma_f32_16x16x32_bf16 v[64:67], a[196:199], v[24:27], v[64:67]
    s_waitcnt lgkmcnt(4)
    v_mfma_f32_16x16x32_bf16 v[52:55], a[200:203], v[28:31], v[52:55]
    ds_read_b128 v[20:23], v12 offset:49408
    v_mfma_f32_16x16x32_bf16 v[56:59], a[204:207], v[28:31], v[56:59]
    v_mfma_f32_16x16x32_bf16 v[60:63], a[200:203], v[32:35], v[60:63]
    ds_read_b128 v[24:27], v12 offset:53504
    v_mfma_f32_16x16x32_bf16 v[64:67], a[204:207], v[32:35], v[64:67]
    s_waitcnt lgkmcnt(4)
    v_mfma_f32_16x16x32_bf16 v[52:55], a[208:211], v[36:39], v[52:55]
    ds_read_b128 v[28:31], v13 offset:49408
    s_add_u32 m0, s21, 18432
    v_mfma_f32_16x16x32_bf16 v[56:59], a[212:215], v[36:39], v[56:59]
    buffer_load_dwordx4 v10, s[8:11], s20 offen lds
    v_mfma_f32_16x16x32_bf16 v[60:63], a[208:211], v[40:43], v[60:63]
    ds_read_b128 v[32:35], v13 offset:53504
    v_mfma_f32_16x16x32_bf16 v[64:67], a[212:215], v[40:43], v[64:67]
    s_waitcnt lgkmcnt(4)
    v_mfma_f32_16x16x32_bf16 v[52:55], a[216:219], v[44:47], v[52:55]
    ds_read_b128 v[36:39], v14 offset:49408
    v_mfma_f32_16x16x32_bf16 v[56:59], a[220:223], v[44:47], v[56:59]
    v_mfma_f32_16x16x32_bf16 v[60:63], a[216:219], v[48:51], v[60:63]
    ds_read_b128 v[40:43], v14 offset:53504
    v_mfma_f32_16x16x32_bf16 v[64:67], a[220:223], v[48:51], v[64:67]
    s_waitcnt lgkmcnt(4)
    v_mfma_f32_16x16x32_bf16 v[52:55], a[224:227], v[20:23], v[52:55]
    ds_read_b128 v[44:47], v15 offset:49408
    s_add_u32 m0, s21, 19456
    v_mfma_f32_16x16x32_bf16 v[56:59], a[228:231], v[20:23], v[56:59]
    buffer_load_dwordx4 v11, s[8:11], s20 offen lds
    v_mfma_f32_16x16x32_bf16 v[60:63], a[224:227], v[24:27], v[60:63]
    ds_read_b128 v[48:51], v15 offset:53504
    v_mfma_f32_16x16x32_bf16 v[64:67], a[228:231], v[24:27], v[64:67]
    s_waitcnt lgkmcnt(4)
    v_mfma_f32_16x16x32_bf16 v[52:55], a[232:235], v[28:31], v[52:55]
    s_waitcnt vmcnt(20)
    s_barrier
    ds_read_b128 v[20:23], v16 offset:0
    v_mfma_f32_16x16x32_bf16 v[56:59], a[236:239], v[28:31], v[56:59]
    s_add_u32 s20, s20, 512
    v_mfma_f32_16x16x32_bf16 v[60:63], a[232:235], v[32:35], v[60:63]
    ds_read_b128 v[24:27], v16 offset:4096
    v_mfma_f32_16x16x32_bf16 v[64:67], a[236:239], v[32:35], v[64:67]
    s_waitcnt lgkmcnt(4)
    v_mfma_f32_16x16x32_bf16 v[52:55], a[240:243], v[36:39], v[52:55]
    ds_read_b128 v[28:31], v17 offset:0
    s_add_u32 m0, s21, 32768
    v_mfma_f32_16x16x32_bf16 v[56:59], a[244:247], v[36:39], v[56:59]
    buffer_load_dwordx4 v8, s[8:11], s20 offen lds
    v_mfma_f32_16x16x32_bf16 v[60:63], a[240:243], v[40:43], v[60:63]
    ds_read_b128 v[32:35], v17 offset:4096
    v_mfma_f32_16x16x32_bf16 v[64:67], a[244:247], v[40:43], v[64:67]
    s_waitcnt lgkmcnt(4)
    v_mfma_f32_16x16x32_bf16 v[52:55], a[248:251], v[44:47], v[52:55]
    ds_read_b128 v[36:39], v18 offset:0
    v_mfma_f32_16x16x32_bf16 v[56:59], a[252:255], v[44:47], v[56:59]
    v_mfma_f32_16x16x32_bf16 v[60:63], a[248:251], v[48:51], v[60:63]
    ds_read_b128 v[40:43], v18 offset:4096
    v_mfma_f32_16x16x32_bf16 v[64:67], a[252:255], v[48:51], v[64:67]
    s_waitcnt lgkmcnt(4)
    s_add_u32 s22, s22, 1
    s_cmp_ge_u32 s22, s23
    s_cbranch_scc1 L_fl0_438
    v_mfma_f32_16x16x32_bf16 v[68:71], a[0:3], v[20:23], 0
    ds_read_b128 v[44:47], v19 offset:0
    s_add_u32 m0, s21, 33792
    s_sub_u32 s39, s22, 1
    v_mfma_f32_16x16x32_bf16 v[72:75], a[4:7], v[20:23], 0
    buffer_load_dwordx4 v9, s[8:11], s20 offen lds
    s_bitcmp1_b32 s39, 1
    s_cselect_b32 s38, s55, s54
    v_mfma_f32_16x16x32_bf16 v[76:79], a[0:3], v[24:27], 0
    ds_read_b128 v[48:51], v19 offset:4096
    v_mfma_f32_16x16x32_bf16 v[80:83], a[4:7], v[24:27], 0
    s_waitcnt lgkmcnt(4)
    s_add_u32 s38, s38, s44
    v_mfma_f32_16x16x32_bf16 v[68:71], a[8:11], v[28:31], v[68:71]
    ds_read_b128 v[20:23], v16 offset:256
    s_lshl_b32 s42, s39, 20
    v_mfma_f32_16x16x32_bf16 v[72:75], a[12:15], v[28:31], v[72:75]
    s_add_u32 s38, s38, s42
    s_lshl_b32 s39, s39, 7
    v_mfma_f32_16x16x32_bf16 v[76:79], a[8:11], v[32:35], v[76:79]
    ds_read_b128 v[24:27], v16 offset:4352
    s_add_u32 s39, s39, 0x5900000
    s_cmp_eq_u32 s37, 0
    s_cselect_b32 s38, 0x7ff00000, s38
    s_cselect_b32 s39, 0x7ff00000, s39
    v_mfma_f32_16x16x32_bf16 v[80:83], a[12:15], v[32:35], v[80:83]
    s_waitcnt lgkmcnt(4)
    v_mfma_f32_16x16x32_bf16 v[68:71], a[16:19], v[36:39], v[68:71]
    ds_read_b128 v[28:31], v17 offset:256
    s_add_u32 m0, s21, 34816
    v_mfma_f32_16x16x32_bf16 v[72:75], a[20:23], v[36:39], v[72:75]
    buffer_load_dwordx4 v10, s[8:11], s20 offen lds
    v_mfma_f32_16x16x32_bf16 v[76:79], a[16:19], v[40:43], v[76:79]
    ds_read_b128 v[32:35], v17 offset:4352
    v_cvt_pk_bf16_f32 v88, v52, v53
    v_mfma_f32_16x16x32_bf16 v[80:83], a[20:23], v[40:43], v[80:83]
    s_waitcnt lgkmcnt(4)
    v_cvt_pk_bf16_f32 v89, v54, v55
    v_cvt_pk_bf16_f32 v90, v56, v57
    v_mfma_f32_16x16x32_bf16 v[68:71], a[24:27], v[44:47], v[68:71]
    ds_read_b128 v[36:39], v18 offset:256
    v_cvt_pk_bf16_f32 v91, v58, v59
    v_mfma_f32_16x16x32_bf16 v[72:75], a[28:31], v[44:47], v[72:75]
    buffer_store_dwordx4 v[88:91], v86, s[12:15], s38 offen offset:0 sc1
    v_mfma_f32_16x16x32_bf16 v[76:79], a[24:27], v[48:51], v[76:79]
    ds_read_b128 v[40:43], v18 offset:4352
    v_cvt_pk_bf16_f32 v92, v60, v61
    v_mfma_f32_16x16x32_bf16 v[80:83], a[28:31], v[48:51], v[80:83]
    s_waitcnt lgkmcnt(4)
    v_cvt_pk_bf16_f32 v93, v62, v63
    v_mfma_f32_16x16x32_bf16 v[68:71], a[32:35], v[20:23], v[68:71]
    ds_read_b128 v[44:47], v19 offset:256
    s_add_u32 m0, s21, 35840
    v_mfma_f32_16x16x32_bf16 v[72:75], a[36:39], v[20:23], v[72:75]
    buffer_load_dwordx4 v11, s[8:11], s20 offen lds
    v_mfma_f32_16x16x32_bf16 v[76:79], a[32:35], v[24:27], v[76:79]
    ds_read_b128 v[48:51], v19 offset:4352
    v_cvt_pk_bf16_f32 v94, v64, v65
    v_mfma_f32_16x16x32_bf16 v[80:83], a[36:39], v[24:27], v[80:83]
    s_waitcnt lgkmcnt(4)
    v_cvt_pk_bf16_f32 v95, v66, v67
    v_mfma_f32_16x16x32_bf16 v[68:71], a[40:43], v[28:31], v[68:71]
    s_waitcnt vmcnt(20)
    s_barrier
    ds_read_b128 v[20:23], v16 offset:16384
    v_mfma_f32_16x16x32_bf16 v[72:75], a[44:47], v[28:31], v[72:75]
    s_add_u32 s20, s20, 512
    buffer_store_dwordx4 v[92:95], v86, s[12:15], s38 offen offset:128 sc1
    v_mfma_f32_16x16x32_bf16 v[76:79], a[40:43], v[32:35], v[76:79]
    ds_read_b128 v[24:27], v16 offset:20480
    s_add_u32 s42, s38, 0x8000000
    v_mfma_f32_16x16x32_bf16 v[80:83], a[44:47], v[32:35], v[80:83]
    s_waitcnt lgkmcnt(4)
    s_cmp_le_u32 s22, 52
    s_cbranch_scc1 L_nokm_443
    buffer_store_dwordx4 v[96:99], v100, s[12:15], s42 offen offset:3072 sc1
L_nokm_443:
    v_mfma_f32_16x16x32_bf16 v[68:71], a[48:51], v[36:39], v[68:71]
    ds_read_b128 v[28:31], v17 offset:16384
    s_add_u32 m0, s21, 49152
    v_mfma_f32_16x16x32_bf16 v[72:75], a[52:55], v[36:39], v[72:75]
    buffer_load_dwordx4 v8, s[8:11], s20 offen lds
    v_mfma_f32_16x16x32_bf16 v[76:79], a[48:51], v[40:43], v[76:79]
    ds_read_b128 v[32:35], v17 offset:20480
    v_mfma_f32_16x16x32_bf16 v[80:83], a[52:55], v[40:43], v[80:83]
    s_waitcnt lgkmcnt(4)
    v_mfma_f32_16x16x32_bf16 v[68:71], a[56:59], v[44:47], v[68:71]
    ds_read_b128 v[36:39], v18 offset:16384
    v_mfma_f32_16x16x32_bf16 v[72:75], a[60:63], v[44:47], v[72:75]
    buffer_store_dwordx2 v[96:97], v101, s[12:15], s42 offen offset:0 sc1
    v_mfma_f32_16x16x32_bf16 v[76:79], a[56:59], v[48:51], v[76:79]
    ds_read_b128 v[40:43], v18 offset:20480
    v_mfma_f32_16x16x32_bf16 v[80:83], a[60:63], v[48:51], v[80:83]
    s_waitcnt lgkmcnt(4)
    v_mfma_f32_16x16x32_bf16 v[68:71], a[64:67], v[20:23], v[68:71]
    ds_read_b128 v[44:47], v19 offset:16384
    s_add_u32 m0, s21, 50176
    v_mfma_f32_16x16x32_bf16 v[72:75], a[68:71], v[20:23], v[72:75]
    buffer_load_dwordx4 v9, s[8:11], s20 offen lds
    v_mfma_f32_16x16x32_bf16 v[76:79], a[64:67], v[24:27], v[76:79]
    ds_read_b128 v[48:51], v19 offset:20480
    v_mfma_f32_16x16x32_bf16 v[80:83], a[68:71], v[24:27], v[80:83]
    s_waitcnt lgkmcnt(4)
    v_mfma_f32_16x16x32_bf16 v[68:71], a[72:75], v[28:31], v[68:71]
    ds_read_b128 v[20:23], v16 offset:16640
    v_mfma_f32_16x16x32_bf16 v[72:75], a[76:79], v[28:31], v[72:75]
    v_mfma_f32_16x16x32_bf16 v[76:79], a[72:75], v[32:35], v[76:79]
    ds_read_b128 v[24:27], v16 offset:20736
    s_add_u32 s24, s24, 1
    v_mfma_f32_16x16x32_bf16 v[80:83], a[76:79], v[32:35], v[80:83]
    s_waitcnt lgkmcnt(4)
    v_mfma_f32_16x16x32_bf16 v[68:71], a[80:83], v[36:39], v[68:71]
    ds_read_b128 v[28:31], v17 offset:16640
    s_add_u32 m0, s21, 51200
    v_mfma_f32_16x16x32_bf16 v[72:75], a[84:87], v[36:39], v[72:75]
    buffer_load_dwordx4 v10, s[8:11], s20 offen lds
    v_mfma_f32_16x16x32_bf16 v[76:79], a[80:83], v[40:43], v[76:79]
    ds_read_b128 v[32:35], v17 offset:20736
    v_mfma_f32_16x16x32_bf16 v[80:83], a[84:87], v[40:43], v[80:83]
    s_waitcnt lgkmcnt(4)
    s_min_u32 s24, s24, 63
    v_mfma_f32_16x16x32_bf16 v[68:71], a[88:91], v[44:47], v[68:71]
    ds_read_b128 v[36:39], v18 offset:16640
    v_mfma_f32_16x16x32_bf16 v[72:75], a[92:95], v[44:47], v[72:75]
    v_mfma_f32_16x16x32_bf16 v[76:79], a[88:91], v[48:51], v[76:79]
    ds_read_b128 v[40:43], v18 offset:20736
    s_lshl_b32 s53, s24, 16
    v_mfma_f32_16x16x32_bf16 v[80:83], a[92:95], v[48:51], v[80:83]
    s_waitcnt lgkmcnt(4)
    v_mfma_f32_16x16x32_bf16 v[68:71], a[96:99], v[20:23], v[68:71]
    ds_read_b128 v[44:47], v19 offset:16640
    s_add_u32 m0, s21, 52224
    v_mfma_f32_16x16x32_bf16 v[72:75], a[100:103], v[20:23], v[72:75]
    buffer_load_dwordx4 v11, s[8:11], s20 offen lds
    v_mfma_f32_16x16x32_bf16 v[76:79], a[96:99], v[24:27], v[76:79]
    ds_read_b128 v[48:51], v19 offset:20736
    v_mfma_f32_16x16x32_bf16 v[80:83], a[100:103], v[24:27], v[80:83]
    s_waitcnt lgkmcnt(4)
    v_mfma_f32_16x16x32_bf16 v[68:71], a[104:107], v[28:31], v[68:71]
    s_waitcnt vmcnt(20)
    s_barrier
    ds_read_b128 v[20:23], v16 offset:32768
    v_mfma_f32_16x16x32_bf16 v[72:75], a[108:111], v[28:31], v[72:75]
    s_mov_b32 s20, s53
    v_mfma_f32_16x16x32_bf16 v[76:79], a[104:107], v[32:35], v[76:79]
    ds_read_b128 v[24:27], v16 offset:36864
    v_mfma_f32_16x16x32_bf16 v[80:83], a[108:111], v[32:35], v[80:83]
    s_waitcnt lgkmcnt(4)
    v_mfma_f32_16x16x32_bf16 v[68:71], a[112:115], v[36:39], v[68:71]
    ds_read_b128 v[28:31], v17 offset:32768
    s_add_u32 m0, s21, 65536
    v_mfma_f32_16x16x32_bf16 v[72:75], a[116:119], v[36:39], v[72:75]
    buffer_load_dwordx4 v8, s[8:11], s20 offen lds
    v_mfma_f32_16x16x32_bf16 v[76:79], a[112:115], v[40:43], v[76:79]
    ds_read_b128 v[32:35], v17 offset:36864
    v_mfma_f32_16x16x32_bf16 v[80:83], a[116:119], v[40:43], v[80:83]
    s_waitcnt lgkmcnt(4)
    v_mfma_f32_16x16x32_bf16 v[68:71], a[120:123], v[44:47], v[68:71]
    ds_read_b128 v[36:39], v18 offset:32768
    v_mfma_f32_16x16x32_bf16 v[72:75], a[124:127], v[44:47], v[72:75]
    v_mfma_f32_16x16x32_bf16 v[76:79], a[120:123], v[48:51], v[76:79]
    ds_read_b128 v[40:43], v18 offset:36864
    v_mfma_f32_16x16x32_bf16 v[80:83], a[124:127], v[48:51], v[80:83]
    s_waitcnt lgkmcnt(4)
    v_mfma_f32_16x16x32_bf16 v[68:71], a[128:131], v[20:23], v[68:71]
    ds_read_b128 v[44:47], v19 offset:32768
    s_add_u32 m0, s21, 66560
    v_mfma_f32_16x16x32_bf16 v[72:75], a[132:135], v[20:23], v[72:75]
    buffer_load_dwordx4 v9, s[8:11], s20 offen lds
    v_mfma_f32_16x16x32_bf16 v[76:79], a[128:131], v[24:27], v[76:79]
    ds_read_b128 v[48:51], v19 offset:36864
    v_mfma_f32_16x16x32_bf16 v[80:83], a[132:135], v[24:27], v[80:83]
    s_waitcnt lgkmcnt(4)
    v_mfma_f32_16x16x32_bf16 v[68:71], a[136:139], v[28:31], v[68:71]
    ds_read_b128 v[20:23], v16 offset:33024
    v_mfma_f32_16x16x32_bf16 v[72:75], a[140:143], v[28:31], v[72:75]
    v_mfma_f32_16x16x32_bf16 v[76:79], a[136:139], v[32:35], v[76:79]
    ds_read_b128 v[24:27], v16 offset:37120
    v_mfma_f32_16x16x32_bf16 v[80:83], a[140:143], v[32:35], v[80:83]
    s_waitcnt lgkmcnt(4)
    v_mfma_f32_16x16x32_bf16 v[68:71], a[144:147], v[36:39], v[68:71]
    ds_read_b128 v[28:31], v17 offset:33024
    s_add_u32 m0, s21, 67584
    v_mfma_f32_16x16x32_bf16 v[72:75], a[148:151], v[36:39], v[72:75]
    buffer_load_dwordx4 v10, s[8:11], s20 offen lds
    v_mfma_f32_16x16x32_bf16 v[76:79], a[144:147], v[40:43], v[76:79]
    ds_read_b128 v[32:35], v17 offset:37120
    v_mfma_f32_16x16x32_bf16 v[80:83], a[148:151], v[40:43], v[80:83]
    s_waitcnt lgkmcnt(4)
    v_mfma_f32_16x16x32_bf16 v[68:71], a[152:155], v[44:47], v[68:71]
    ds_read_b128 v[36:39], v18 offset:33024
    v_mfma_f32_16x16x32_bf16 v[72:75], a[156:159], v[44:47], v[72:75]
    v_mfma_f32_16x16x32_bf16 v[76:79], a[152:155], v[48:51], v[76:79]
    ds_read_b128 v[40:43], v18 offset:37120
    v_mfma_f32_16x16x32_bf16 v[80:83], a[156:159], v[48:51], v[80:83]
    s_waitcnt lgkmcnt(4)
    v_mfma_f32_16x16x32_bf16 v[68:71], a[160:163], v[20:23], v[68:71]
    ds_read_b128 v[44:47], v19 offset:33024
    s_add_u32 m0, s21, 68608
    v_mfma_f32_16x16x32_bf16 v[72:75], a[164:167], v[20:23], v[72:75]
    buffer_load_dwordx4 v11, s[8:11], s20 offen lds
    v_mfma_f32_16x16x32_bf16 v[76:79], a[160:163], v[24:27], v[76:79]
    ds_read_b128 v[48:51], v19 offset:37120
    v_mfma_f32_16x16x32_bf16 v[80:83], a[164:167], v[24:27], v[80:83]
    s_waitcnt lgkmcnt(4)
    v_mfma_f32_16x16x32_bf16 v[68:71], a[168:171], v[28:31], v[68:71]
    s_waitcnt vmcnt(7)
    s_barrier
    ds_read_b128 v[20:23], v16 offset:49152
    v_mfma_f32_16x16x32_bf16 v[72:75], a[172:175], v[28:31], v[72:75]
    s_add_u32 s20, s20, 512
    buffer_atomic_add v84, v85, s[12:15], s39 offen sc1
    v_mfma_f32_16x16x32_bf16 v[76:79], a[168:171], v[32:35], v[76:79]
    ds_read_b128 v[24:27], v16 offset:53248
    s_mov_b32 s37, 1
    v_mfma_f32_16x16x32_bf16 v[80:83], a[172:175], v[32:35], v[80:83]
    s_waitcnt lgkmcnt(4)
    v_mfma_f32_16x16x32_bf16 v[68:71], a[176:179], v[36:39], v[68:71]
    ds_read_b128 v[28:31], v17 offset:49152
    s_add_u32 m0, s21, 81920
    v_mfma_f32_16x16x32_bf16 v[72:75], a[180:183], v[36:39], v[72:75]
    buffer_load_dwordx4 v8, s[8:11], s20 offen lds
    v_mfma_f32_16x16x32_bf16 v[76:79], a[176:179], v[40:43], v[76:79]
    ds_read_b128 v[32:35], v17 offset:53248
    v_mfma_f32_16x16x32_bf16 v[80:83], a[180:183], v[40:43], v[80:83]
    s_waitcnt lgkmcnt(4)
    v_mfma_f32_16x16x32_bf16 v[68:71], a[184:187], v[44:47], v[68:71]
    ds_read_b128 v[36:39], v18 offset:49152
    v_mfma_f32_16x16x32_bf16 v[72:75], a[188:191], v[44:47], v[72:75]
    v_mfma_f32_16x16x32_bf16 v[76:79], a[184:187], v[48:51], v[76:79]
    ds_read_b128 v[40:43], v18 offset:53248
    v_mfma_f32_16x16x32_bf16 v[80:83], a[188:191], v[48:51], v[80:83]
    s_waitcnt lgkmcnt(4)
    v_mfma_f32_16x16x32_bf16 v[68:71], a[192:195], v[20:23], v[68:71]
    ds_read_b128 v[44:47], v19 offset:49152
    s_add_u32 m0, s21, 82944
    v_mfma_f32_16x16x32_bf16 v[72:75], a[196:199], v[20:23], v[72:75]
    buffer_load_dwordx4 v9, s[8:11], s20 offen lds
    v_mfma_f32_16x16x32_bf16 v[76:79], a[192:195], v[24:27], v[76:79]
    ds_read_b128 v[48:51], v19 offset:53248
    v_mfma_f32_16x16x32_bf16 v[80:83], a[196:199], v[24:27], v[80:83]
    s_waitcnt lgkmcnt(4)
    v_mfma_f32_16x16x32_bf16 v[68:71], a[200:203], v[28:31], v[68:71]
    ds_read_b128 v[20:23], v16 offset:49408
    v_mfma_f32_16x16x32_bf16 v[72:75], a[204:207], v[28:31], v[72:75]
    v_mfma_f32_16x16x32_bf16 v[76:79], a[200:203], v[32:35], v[76:79]
    ds_read_b128 v[24:27], v16 offset:53504
    v_mfma_f32_16x16x32_bf16 v[80:83], a[204:207], v[32:35], v[80:83]
    s_waitcnt lgkmcnt(4)
    v_mfma_f32_16x16x32_bf16 v[68:71], a[208:211], v[36:39], v[68:71]
    ds_read_b128 v[28:31], v17 offset:49408
    s_add_u32 m0, s21, 83968
    v_mfma_f32_16x16x32_bf16 v[72:75], a[212:215], v[36:39], v[72:75]
    buffer_load_dwordx4 v10, s[8:11], s20 offen lds
    v_mfma_f32_16x16x32_bf16 v[76:79], a[208:211], v[40:43], v[76:79]
    ds_read_b128 v[32:35], v17 offset:53504
    v_mfma_f32_16x16x32_bf16 v[80:83], a[212:215], v[40:43], v[80:83]
    s_waitcnt lgkmcnt(4)
    v_mfma_f32_16x16x32_bf16 v[68:71], a[216:219], v[44:47], v[68:71]
    ds_read_b128 v[36:39], v18 offset:49408
    v_mfma_f32_16x16x32_bf16 v[72:75], a[220:223], v[44:47], v[72:75]
    v_mfma_f32_16x16x32_bf16 v[76:79], a[216:219], v[48:51], v[76:79]
    ds_read_b128 v[40:43], v18 offset:53504
    v_mfma_f32_16x16x32_bf16 v[80:83], a[220:223], v[48:51], v[80:83]
    s_waitcnt lgkmcnt(4)
    v_mfma_f32_16x16x32_bf16 v[68:71], a[224:227], v[20:23], v[68:71]
    ds_read_b128 v[44:47], v19 offset:49408
    s_add_u32 m0, s21, 84992
    v_mfma_f32_16x16x32_bf16 v[72:75], a[228:231], v[20:23], v[72:75]
    buffer_load_dwordx4 v11, s[8:11], s20 offen lds
    v_mfma_f32_16x16x32_bf16 v[76:79], a[224:227], v[24:27], v[76:79]
    ds_read_b128 v[48:51], v19 offset:53504
    v_mfma_f32_16x16x32_bf16 v[80:83], a[228:231], v[24:27], v[80:83]
    s_waitcnt lgkmcnt(4)
    v_mfma_f32_16x16x32_bf16 v[68:71], a[232:235], v[28:31], v[68:71]
    s_waitcnt vmcnt(20)
    s_barrier
    ds_read_b128 v[20:23], v12 offset:0
    v_mfma_f32_16x16x32_bf16 v[72:75], a[236:239], v[28:31], v[72:75]
    s_add_u32 s20, s20, 512
    v_mfma_f32_16x16x32_bf16 v[76:79], a[232:235], v[32:35], v[76:79]
    ds_read_b128 v[24:27], v12 offset:4096
    v_mfma_f32_16x16x32_bf16 v[80:83], a[236:239], v[32:35], v[80:83]
    s_waitcnt lgkmcnt(4)
    v_mfma_f32_16x16x32_bf16 v[68:71], a[240:243], v[36:39], v[68:71]
    ds_read_b128 v[28:31], v13 offset:0
    s_add_u32 m0, s21, 98304
    v_mfma_f32_16x16x32_bf16 v[72:75], a[244:247], v[36:39], v[72:75]
    buffer_load_dwordx4 v8, s[8:11], s20 offen lds
    v_mfma_f32_16x16x32_bf16 v[76:79], a[240:243], v[40:43], v[76:79]
    ds_read_b128 v[32:35], v13 offset:4096
    v_mfma_f32_16x16x32_bf16 v[80:83], a[244:247], v[40:43], v[80:83]
    s_waitcnt lgkmcnt(4)
    v_mfma_f32_16x16x32_bf16 v[68:71], a[248:251], v[44:47], v[68:71]
    ds_read_b128 v[36:39], v14 offset:0
    v_mfma_f32_16x16x32_bf16 v[72:75], a[252:255], v[44:47], v[72:75]
    v_mfma_f32_16x16x32_bf16 v[76:79], a[248:251], v[48:51], v[76:79]
    ds_read_b128 v[40:43], v14 offset:4096
    v_mfma_f32_16x16x32_bf16 v[80:83], a[252:255], v[48:51], v[80:83]
    s_waitcnt lgkmcnt(4)
    s_add_u32 s22, s22, 1
    s_cmp_ge_u32 s22, s23
    s_cbranch_scc0 L_st_441
L_fl1_439:
    s_waitcnt lgkmcnt(0)
    s_nop 7
    s_sub_u32 s39, s22, 1
    s_bitcmp1_b32 s39, 1
    s_cselect_b32 s38, s55, s54
    s_add_u32 s38, s38, s44
    s_lshl_b32 s42, s39, 20
    s_add_u32 s38, s38, s42
    s_lshl_b32 s39, s39, 7
    s_add_u32 s39, s39, 0x5900000
    s_cmp_eq_u32 s37, 0
    s_cselect_b32 s38, 0x7ff00000, s38
    s_cselect_b32 s39, 0x7ff00000, s39
    v_cvt_pk_bf16_f32 v88, v68, v69
    v_cvt_pk_bf16_f32 v89, v70, v71
    v_cvt_pk_bf16_f32 v90, v72, v73
    v_cvt_pk_bf16_f32 v91, v74, v75
    buffer_store_dwordx4 v[88:91], v86, s[12:15], s38 offen offset:0 sc1
    v_cvt_pk_bf16_f32 v92, v76, v77
    v_cvt_pk_bf16_f32 v93, v78, v79
    v_cvt_pk_bf16_f32 v94, v80, v81
    v_cvt_pk_bf16_f32 v95, v82, v83
    buffer_store_dwordx4 v[92:95], v86, s[12:15], s38 offen offset:128 sc1
    s_add_u32 s42, s38, 0x8000000
    s_cmp_le_u32 s22, 52
    s_cbranch_scc1 L_nokm_444
    buffer_store_dwordx4 v[96:99], v100, s[12:15], s42 offen offset:3072 sc1
L_nokm_444:
    buffer_store_dwordx2 v[96:97], v101, s[12:15], s42 offen offset:0 sc1
    s_waitcnt vmcnt(0)
    s_barrier
    buffer_atomic_add v84, v85, s[12:15], s39 offen sc1
    s_mov_b32 s37, 1
    s_branch L_ste_440
L_fl0_438:
    s_waitcnt lgkmcnt(0)
    s_nop 7
    s_sub_u32 s39, s22, 1
    s_bitcmp1_b32 s39, 1
    s_cselect_b32 s38, s55, s54
    s_add_u32 s38, s38, s44
    s_lshl_b32 s42, s39, 20
    s_add_u32 s38, s38, s42
    s_lshl_b32 s39, s39, 7
    s_add_u32 s39, s39, 0x5900000
    s_cmp_eq_u32 s37, 0
    s_cselect_b32 s38, 0x7ff00000, s38
    s_cselect_b32 s39, 0x7ff00000, s39
    v_cvt_pk_bf16_f32 v88, v52, v53
    v_cvt_pk_bf16_f32 v89, v54, v55
    v_cvt_pk_bf16_f32 v90, v56, v57
    v_cvt_pk_bf16_f32 v91, v58, v59
    buffer_store_dwordx4 v[88:91], v86, s[12:15], s38 offen offset:0 sc1
    v_cvt_pk_bf16_f32 v92, v60, v61
    v_cvt_pk_bf16_f32 v93, v62, v63
    v_cvt_pk_bf16_f32 v94, v64, v65
    v_cvt_pk_bf16_f32 v95, v66, v67
    buffer_store_dwordx4 v[92:95], v86, s[12:15], s38 offen offset:128 sc1
    s_add_u32 s42, s38, 0x8000000
    s_cmp_le_u32 s22, 52
    s_cbranch_scc1 L_nokm_445
    buffer_store_dwordx4 v[96:99], v100, s[12:15], s42 offen offset:3072 sc1
L_nokm_445:
    buffer_store_dwordx2 v[96:97], v101, s[12:15], s42 offen offset:0 sc1
    s_waitcnt vmcnt(0)
    s_barrier
    buffer_atomic_add v84, v85, s[12:15], s39 offen sc1
    s_mov_b32 s37, 1
L_ste_440:
    s_branch L_op_435
L_v_431:
    v_mov_b32 v96, 0xff81ff81
    v_mov_b32 v97, 0xff81ff81
    v_mov_b32 v98, 0xff81ff81
    v_mov_b32 v99, 0xff81ff81
    v_and_b32 v100, 63, v0
    v_lshlrev_b32 v101, 3, v100
    v_lshlrev_b32 v100, 4, v100
    s_barrier
    s_add_u32 m0, s21, 0
    s_nop 0
    buffer_load_dwordx4 v8, s[8:11], s20 offen lds
    s_add_u32 m0, s21, 1024
    s_nop 0
    buffer_load_dwordx4 v9, s[8:11], s20 offen lds
    s_add_u32 m0, s21, 2048
    s_nop 0
    buffer_load_dwordx4 v10, s[8:11], s20 offen lds
    s_add_u32 m0, s21, 3072
    s_nop 0
    buffer_load_dwordx4 v11, s[8:11], s20 offen lds
    s_add_u32 s20, s20, 512
    s_add_u32 m0, s21, 16384
    s_nop 0
    buffer_load_dwordx4 v8, s[8:11], s20 offen lds
    s_add_u32 m0, s21, 17408
    s_nop 0
    buffer_load_dwordx4 v9, s[8:11], s20 offen lds
    s_add_u32 m0, s21, 18432
    s_nop 0
    buffer_load_dwordx4 v10, s[8:11], s20 offen lds
    s_add_u32 m0, s21, 19456
    s_nop 0
    buffer_load_dwordx4 v11, s[8:11], s20 offen lds
    s_add_u32 s20, s20, 512
    s_add_u32 m0, s21, 32768
    s_nop 0
    buffer_load_dwordx4 v8, s[8:11], s20 offen lds
    s_add_u32 m0, s21, 33792
    s_nop 0
    buffer_load_dwordx4 v9, s[8:11], s20 offen lds
    s_add_u32 m0, s21, 34816
    s_nop 0
    buffer_load_dwordx4 v10, s[8:11], s20 offen lds
    s_add_u32 m0, s21, 35840
    s_nop 0
    buffer_load_dwordx4 v11, s[8:11], s20 offen lds
    s_add_u32 s20, s20, 512
    s_add_u32 m0, s21, 49152
    s_nop 0
    buffer_load_dwordx4 v8, s[8:11], s20 offen lds
    s_add_u32 m0, s21, 50176
    s_nop 0
    buffer_load_dwordx4 v9, s[8:11], s20 offen lds
    s_add_u32 m0, s21, 51200
    s_nop 0
    buffer_load_dwordx4 v10, s[8:11], s20 offen lds
    s_add_u32 m0, s21, 52224
    s_nop 0
    buffer_load_dwordx4 v11, s[8:11], s20 offen lds
    s_add_u32 s24, s24, 1
    s_min_u32 s24, s24, 63
    s_lshl_b32 s53, s24, 16
    s_mov_b32 s20, s53
    s_add_u32 m0, s21, 65536
    s_nop 0
    buffer_load_dwordx4 v8, s[8:11], s20 offen lds
    s_add_u32 m0, s21, 66560
    s_nop 0
    buffer_load_dwordx4 v9, s[8:11], s20 offen lds
    s_add_u32 m0, s21, 67584
    s_nop 0
    buffer_load_dwordx4 v10, s[8:11], s20 offen lds
    s_add_u32 m0, s21, 68608
    s_nop 0
    buffer_load_dwordx4 v11, s[8:11], s20 offen lds
    s_add_u32 s20, s20, 512
    s_add_u32 m0, s21, 81920
    s_nop 0
    buffer_load_dwordx4 v8, s[8:11], s20 offen lds
    s_add_u32 m0, s21, 82944
    s_nop 0
    buffer_load_dwordx4 v9, s[8:11], s20 offen lds
    s_add_u32 m0, s21, 83968
    s_nop 0
    buffer_load_dwordx4 v10, s[8:11], s20 offen lds
    s_add_u32 m0, s21, 84992
    s_nop 0
    buffer_load_dwordx4 v11, s[8:11], s20 offen lds
    s_add_u32 s20, s20, 512
    s_add_u32 m0, s21, 98304
    s_nop 0
    buffer_load_dwordx4 v8, s[8:11], s20 offen lds
    s_waitcnt vmcnt(21)
    s_barrier
    ds_read_b128 v[20:23], v12 offset:0
    ds_read_b128 v[24:27], v12 offset:4096
    ds_read_b128 v[28:31], v13 offset:0
    ds_read_b128 v[32:35], v13 offset:4096
    ds_read_b128 v[36:39], v14 offset:0
    ds_read_b128 v[40:43], v14 offset:4096
    s_waitcnt lgkmcnt(4)
L_st_449:
    v_mfma_f32_16x16x32_bf16 v[52:55], v[20:23], a[0:3], 0
    ds_read_b128 v[44:47], v15 offset:0
    s_add_u32 m0, s21, 99328
    s_sub_u32 s39, s22, 1
    v_mfma_f32_16x16x32_bf16 v[56:59], v[20:23], a[4:7], 0
    buffer_load_dwordx4 v9, s[8:11], s20 offen lds
    s_bitcmp1_b32 s39, 1
    s_cselect_b32 s38, s55, s54
    v_mfma_f32_16x16x32_bf16 v[60:63], v[24:27], a[0:3], 0
    ds_read_b128 v[48:51], v15 offset:4096
    v_mfma_f32_16x16x32_bf16 v[64:67], v[24:27], a[4:7], 0
    s_waitcnt lgkmcnt(4)
    s_add_u32 s38, s38, s44
    v_mfma_f32_16x16x32_bf16 v[52:55], v[28:31], a[8:11], v[52:55]
    ds_read_b128 v[20:23], v12 offset:256
    s_lshl_b32 s42, s39, 20
    v_mfma_f32_16x16x32_bf16 v[56:59], v[28:31], a[12:15], v[56:59]
    s_add_u32 s38, s38, s42
    s_lshl_b32 s39, s39, 7
    v_mfma_f32_16x16x32_bf16 v[60:63], v[32:35], a[8:11], v[60:63]
    ds_read_b128 v[24:27], v12 offset:4352
    s_add_u32 s39, s39, 0x5900000
    s_cmp_eq_u32 s37, 0
    s_cselect_b32 s38, 0x7ff00000, s38
    s_cselect_b32 s39, 0x7ff00000, s39
    v_mfma_f32_16x16x32_bf16 v[64:67], v[32:35], a[12:15], v[64:67]
    s_waitcnt lgkmcnt(4)
    v_mfma_f32_16x16x32_bf16 v[52:55], v[36:39], a[16:19], v[52:55]
    ds_read_b128 v[28:31], v13 offset:256
    s_add_u32 m0, s21, 100352
    v_mfma_f32_16x16x32_bf16 v[56:59], v[36:39], a[20:23], v[56:59]
    buffer_load_dwordx4 v10, s[8:11], s20 offen lds
    v_mfma_f32_16x16x32_bf16 v[60:63], v[40:43], a[16:19], v[60:63]
    ds_read_b128 v[32:35], v13 offset:4352
    v_cvt_pk_bf16_f32 v88, v68, v69
    v_mfma_f32_16x16x32_bf16 v[64:67], v[40:43], a[20:23], v[64:67]
    s_waitcnt lgkmcnt(4)
    v_cvt_pk_bf16_f32 v89, v70, v71
    v_cvt_pk_bf16_f32 v90, v76, v77
    v_mfma_f32_16x16x32_bf16 v[52:55], v[44:47], a[24:27], v[52:55]
    ds_read_b128 v[36:39], v14 offset:256
    v_cvt_pk_bf16_f32 v91, v78, v79
    v_mfma_f32_16x16x32_bf16 v[56:59], v[44:47], a[28:31], v[56:59]
    buffer_store_dwordx4 v[88:91], v86, s[12:15], s38 offen offset:2048 sc1
    v_mfma_f32_16x16x32_bf16 v[60:63], v[48:51], a[24:27], v[60:63]
    ds_read_b128 v[40:43], v14 offset:4352
    v_cvt_pk_bf16_f32 v92, v72, v73
    v_mfma_f32_16x16x32_bf16 v[64:67], v[48:51], a[28:31], v[64:67]
    s_waitcnt lgkmcnt(4)
    v_cvt_pk_bf16_f32 v93, v74, v75
    v_mfma_f32_16x16x32_bf16 v[52:55], v[20:23], a[32:35], v[52:55]
    ds_read_b128 v[44:47], v15 offset:256
    s_add_u32 m0, s21, 101376
    v_mfma_f32_16x16x32_bf16 v[56:59], v[20:23], a[36:39], v[56:59]
    buffer_load_dwordx4 v11, s[8:11], s20 offen lds
    v_mfma_f32_16x16x32_bf16 v[60:63], v[24:27], a[32:35], v[60:63]
    ds_read_b128 v[48:51], v15 offset:4352
    v_cvt_pk_bf16_f32 v94, v80, v81
    v_mfma_f32_16x16x32_bf16 v[64:67], v[24:27], a[36:39], v[64:67]
    s_waitcnt lgkmcnt(4)
    v_cvt_pk_bf16_f32 v95, v82, v83
    v_mfma_f32_16x16x32_bf16 v[52:55], v[28:31], a[40:43], v[52:55]
    s_waitcnt vmcnt(20)
    s_barrier
    ds_read_b128 v[20:23], v12 offset:16384
    v_mfma_f32_16x16x32_bf16 v[56:59], v[28:31], a[44:47], v[56:59]
    s_add_u32 s20, s20, 512
    buffer_store_dwordx4 v[92:95], v86, s[12:15], s38 offen offset:2176 sc1
    v_mfma_f32_16x16x32_bf16 v[60:63], v[32:35], a[40:43], v[60:63]
    ds_read_b128 v[24:27], v12 offset:20480
    s_add_u32 s42, s38, 0x8000000
    v_mfma_f32_16x16x32_bf16 v[64:67], v[32:35], a[44:47], v[64:67]
    s_waitcnt lgkmcnt(4)
    v_mfma_f32_16x16x32_bf16 v[52:55], v[36:39], a[48:51], v[52:55]
    ds_read_b128 v[28:31], v13 offset:16384
    s_add_u32 m0, s21, 114688
    v_mfma_f32_16x16x32_bf16 v[56:59], v[36:39], a[52:55], v[56:59]
    buffer_load_dwordx4 v8, s[8:11], s20 offen lds
    v_mfma_f32_16x16x32_bf16 v[60:63], v[40:43], a[48:51], v[60:63]
    ds_read_b128 v[32:35], v13 offset:20480
    v_mfma_f32_16x16x32_bf16 v[64:67], v[40:43], a[52:55], v[64:67]
    s_waitcnt lgkmcnt(4)
    v_mfma_f32_16x16x32_bf16 v[52:55], v[44:47], a[56:59], v[52:55]
    ds_read_b128 v[36:39], v14 offset:16384
    v_mfma_f32_16x16x32_bf16 v[56:59], v[44:47], a[60:63], v[56:59]
    buffer_store_dwordx2 v[96:97], v101, s[12:15], s42 offen offset:512 sc1
    v_mfma_f32_16x16x32_bf16 v[60:63], v[48:51], a[56:59], v[60:63]
    ds_read_b128 v[40:43], v14 offset:20480
    v_mfma_f32_16x16x32_bf16 v[64:67], v[48:51], a[60:63], v[64:67]
    s_waitcnt lgkmcnt(4)
    v_mfma_f32_16x16x32_bf16 v[52:55], v[20:23], a[64:67], v[52:55]
    ds_read_b128 v[44:47], v15 offset:16384
    s_add_u32 m0, s21, 115712
    v_mfma_f32_16x16x32_bf16 v[56:59], v[20:23], a[68:71], v[56:59]
    buffer_load_dwordx4 v9, s[8:11], s20 offen lds
    v_mfma_f32_16x16x32_bf16 v[60:63], v[24:27], a[64:67], v[60:63]
    ds_read_b128 v[48:51], v15 offset:20480
    v_mfma_f32_16x16x32_bf16 v[64:67], v[24:27], a[68:71], v[64:67]
    s_waitcnt lgkmcnt(4)
    v_mfma_f32_16x16x32_bf16 v[52:55], v[28:31], a[72:75], v[52:55]
    ds_read_b128 v[20:23], v12 offset:16640
    v_mfma_f32_16x16x32_bf16 v[56:59], v[28:31], a[76:79], v[56:59]
    v_mfma_f32_16x16x32_bf16 v[60:63], v[32:35], a[72:75], v[60:63]
    ds_read_b128 v[24:27], v12 offset:20736
    s_add_u32 s24, s24, 1
    v_mfma_f32_16x16x32_bf16 v[64:67], v[32:35], a[76:79], v[64:67]
    s_waitcnt lgkmcnt(4)
    v_mfma_f32_16x16x32_bf16 v[52:55], v[36:39], a[80:83], v[52:55]
    ds_read_b128 v[28:31], v13 offset:16640
    s_add_u32 m0, s21, 116736
    v_mfma_f32_16x16x32_bf16 v[56:59], v[36:39], a[84:87], v[56:59]
    buffer_load_dwordx4 v10, s[8:11], s20 offen lds
    v_mfma_f32_16x16x32_bf16 v[60:63], v[40:43], a[80:83], v[60:63]
    ds_read_b128 v[32:35], v13 offset:20736
    v_mfma_f32_16x16x32_bf16 v[64:67], v[40:43], a[84:87], v[64:67]
    s_waitcnt lgkmcnt(4)
    s_min_u32 s24, s24, 63
    v_mfma_f32_16x16x32_bf16 v[52:55], v[44:47], a[88:91], v[52:55]
    ds_read_b128 v[36:39], v14 offset:16640
    v_mfma_f32_16x16x32_bf16 v[56:59], v[44:47], a[92:95], v[56:59]
    v_mfma_f32_16x16x32_bf16 v[60:63], v[48:51], a[88:91], v[60:63]
    ds_read_b128 v[40:43], v14 offset:20736
    s_lshl_b32 s53, s24, 16
    v_mfma_f32_16x16x32_bf16 v[64:67], v[48:51], a[92:95], v[64:67]
    s_waitcnt lgkmcnt(4)
    v_mfma_f32_16x16x32_bf16 v[52:55], v[20:23], a[96:99], v[52:55]
    ds_read_b128 v[44:47], v15 offset:16640
    s_add_u32 m0, s21, 117760
    v_mfma_f32_16x16x32_bf16 v[56:59], v[20:23], a[100:103], v[56:59]
    buffer_load_dwordx4 v11, s[8:11], s20 offen lds
    v_mfma_f32_16x16x32_bf16 v[60:63], v[24:27], a[96:99], v[60:63]
    ds_read_b128 v[48:51], v15 offset:20736
    v_mfma_f32_16x16x32_bf16 v[64:67], v[24:27], a[100:103], v[64:67]
    s_waitcnt lgkmcnt(4)
    v_mfma_f32_16x16x32_bf16 v[52:55], v[28:31], a[104:107], v[52:55]
    s_waitcnt vmcnt(20)
    s_barrier
    ds_read_b128 v[20:23], v12 offset:32768
    v_mfma_f32_16x16x32_bf16 v[56:59], v[28:31], a[108:111], v[56:59]
    s_mov_b32 s20, s53
    v_mfma_f32_16x16x32_bf16 v[60:63], v[32:35], a[104:107], v[60:63]
    ds_read_b128 v[24:27], v12 offset:36864
    v_mfma_f32_16x16x32_bf16 v[64:67], v[32:35], a[108:111], v[64:67]
    s_waitcnt lgkmcnt(4)
    v_mfma_f32_16x16x32_bf16 v[52:55], v[36:39], a[112:115], v[52:55]
    ds_read_b128 v[28:31], v13 offset:32768
    s_add_u32 m0, s21, 0
    v_mfma_f32_16x16x32_bf16 v[56:59], v[36:39], a[116:119], v[56:59]
    buffer_load_dwordx4 v8, s[8:11], s20 offen lds
    v_mfma_f32_16x16x32_bf16 v[60:63], v[40:43], a[112:115], v[60:63]
    ds_read_b128 v[32:35], v13 offset:36864
    v_mfma_f32_16x16x32_bf16 v[64:67], v[40:43], a[116:119], v[64:67]
    s_waitcnt lgkmcnt(4)
    v_mfma_f32_16x16x32_bf16 v[52:55], v[44:47], a[120:123], v[52:55]
    ds_read_b128 v[36:39], v14 offset:32768
    v_mfma_f32_16x16x32_bf16 v[56:59], v[44:47], a[124:127], v[56:59]
    v_mfma_f32_16x16x32_bf16 v[60:63], v[48:51], a[120:123], v[60:63]
    ds_read_b128 v[40:43], v14 offset:36864
    v_mfma_f32_16x16x32_bf16 v[64:67], v[48:51], a[124:127], v[64:67]
    s_waitcnt lgkmcnt(4)
    v_mfma_f32_16x16x32_bf16 v[52:55], v[20:23], a[128:131], v[52:55]
    ds_read_b128 v[44:47], v15 offset:32768
    s_add_u32 m0, s21, 1024
    v_mfma_f32_16x16x32_bf16 v[56:59], v[20:23], a[132:135], v[56:59]
    buffer_load_dwordx4 v9, s[8:11], s20 offen lds
    v_mfma_f32_16x16x32_bf16 v[60:63], v[24:27], a[128:131], v[60:63]
    ds_read_b128 v[48:51], v15 offset:36864
    v_mfma_f32_16x16x32_bf16 v[64:67], v[24:27], a[132:135], v[64:67]
    s_waitcnt lgkmcnt(4)
    v_mfma_f32_16x16x32_bf16 v[52:55], v[28:31], a[136:139], v[52:55]
    ds_read_b128 v[20:23], v12 offset:33024
    v_mfma_f32_16x16x32_bf16 v[56:59], v[28:31], a[140:143], v[56:59]
    v_mfma_f32_16x16x32_bf16 v[60:63], v[32:35], a[136:139], v[60:63]
    ds_read_b128 v[24:27], v12 offset:37120
    v_mfma_f32_16x16x32_bf16 v[64:67], v[32:35], a[140:143], v[64:67]
    s_waitcnt lgkmcnt(4)
    v_mfma_f32_16x16x32_bf16 v[52:55], v[36:39], a[144:147], v[52:55]
    ds_read_b128 v[28:31], v13 offset:33024
    s_add_u32 m0, s21, 2048
    v_mfma_f32_16x16x32_bf16 v[56:59], v[36:39], a[148:151], v[56:59]
    buffer_load_dwordx4 v10, s[8:11], s20 offen lds
    v_mfma_f32_16x16x32_bf16 v[60:63], v[40:43], a[144:147], v[60:63]
    ds_read_b128 v[32:35], v13 offset:37120
    v_mfma_f32_16x16x32_bf16 v[64:67], v[40:43], a[148:151], v[64:67]
    s_waitcnt lgkmcnt(4)
    v_mfma_f32_16x16x32_bf16 v[52:55], v[44:47], a[152:155], v[52:55]
    ds_read_b128 v[36:39], v14 offset:33024
    v_mfma_f32_16x16x32_bf16 v[56:59], v[44:47], a[156:159], v[56:59]
    v_mfma_f32_16x16x32_bf16 v[60:63], v[48:51], a[152:155], v[60:63]
    ds_read_b128 v[40:43], v14 offset:37120
    v_mfma_f32_16x16x32_bf16 v[64:67], v[48:51], a[156:159], v[64:67]
    s_waitcnt lgkmcnt(4)
    v_mfma_f32_16x16x32_bf16 v[52:55], v[20:23], a[160:163], v[52:55]
    ds_read_b128 v[44:47], v15 offset:33024
    s_add_u32 m0, s21, 3072
    v_mfma_f32_16x16x32_bf16 v[56:59], v[20:23], a[164:167], v[56:59]
    buffer_load_dwordx4 v11, s[8:11], s20 offen lds
    v_mfma_f32_16x16x32_bf16 v[60:63], v[24:27], a[160:163], v[60:63]
    ds_read_b128 v[48:51], v15 offset:37120
    v_mfma_f32_16x16x32_bf16 v[64:67], v[24:27], a[164:167], v[64:67]
    s_waitcnt lgkmcnt(4)
    v_mfma_f32_16x16x32_bf16 v[52:55], v[28:31], a[168:171], v[52:55]
    s_waitcnt vmcnt(7)
    s_barrier
    ds_read_b128 v[20:23], v12 offset:49152
    v_mfma_f32_16x16x32_bf16 v[56:59], v[28:31], a[172:175], v[56:59]
    s_add_u32 s20, s20, 512
    buffer_atomic_add v84, v85, s[12:15], s39 offen sc1
    v_mfma_f32_16x16x32_bf16 v[60:63], v[32:35], a[168:171], v[60:63]
    ds_read_b128 v[24:27], v12 offset:53248
    s_mov_b32 s37, 1
    v_mfma_f32_16x16x32_bf16 v[64:67], v[32:35], a[172:175], v[64:67]
    s_waitcnt lgkmcnt(4)
    v_mfma_f32_16x16x32_bf16 v[52:55], v[36:39], a[176:179], v[52:55]
    ds_read_b128 v[28:31], v13 offset:49152
    s_add_u32 m0, s21, 16384
    v_mfma_f32_16x16x32_bf16 v[56:59], v[36:39], a[180:183], v[56:59]
    buffer_load_dwordx4 v8, s[8:11], s20 offen lds
    v_mfma_f32_16x16x32_bf16 v[60:63], v[40:43], a[176:179], v[60:63]
    ds_read_b128 v[32:35], v13 offset:53248
    v_mfma_f32_16x16x32_bf16 v[64:67], v[40:43], a[180:183], v[64:67]
    s_waitcnt lgkmcnt(4)
    v_mfma_f32_16x16x32_bf16 v[52:55], v[44:47], a[184:187], v[52:55]
    ds_read_b128 v[36:39], v14 offset:49152
    v_mfma_f32_16x16x32_bf16 v[56:59], v[44:47], a[188:191], v[56:59]
    v_mfma_f32_16x16x32_bf16 v[60:63], v[48:51], a[184:187], v[60:63]
    ds_read_b128 v[40:43], v14 offset:53248
    v_mfma_f32_16x16x32_bf16 v[64:67], v[48:51], a[188:191], v[64:67]
    s_waitcnt lgkmcnt(4)
    v_mfma_f32_16x16x32_bf16 v[52:55], v[20:23], a[192:195], v[52:55]
    ds_read_b128 v[44:47], v15 offset:49152
    s_add_u32 m0, s21, 17408
    v_mfma_f32_16x16x32_bf16 v[56:59], v[20:23], a[196:199], v[56:59]
    buffer_load_dwordx4 v9, s[8:11], s20 offen lds
    v_mfma_f32_16x16x32_bf16 v[60:63], v[24:27], a[192:195], v[60:63]
    ds_read_b128 v[48:51], v15 offset:53248
    v_mfma_f32_16x16x32_bf16 v[64:67], v[24:27], a[196:199], v[64:67]
    s_waitcnt lgkmcnt(4)
    v_mfma_f32_16x16x32_bf16 v[52:55], v[28:31], a[200:203], v[52:55]
    ds_read_b128 v[20:23], v12 offset:49408
    v_mfma_f32_16x16x32_bf16 v[56:59], v[28:31], a[204:207], v[56:59]
    v_mfma_f32_16x16x32_bf16 v[60:63], v[32:35], a[200:203], v[60:63]
    ds_read_b128 v[24:27], v12 offset:53504
    v_mfma_f32_16x16x32_bf16 v[64:67], v[32:35], a[204:207], v[64:67]
    s_waitcnt lgkmcnt(4)
    v_mfma_f32_16x16x32_bf16 v[52:55], v[36:39], a[208:211], v[52:55]
    ds_read_b128 v[28:31], v13 offset:49408
    s_add_u32 m0, s21, 18432
    v_mfma_f32_16x16x32_bf16 v[56:59], v[36:39], a[212:215], v[56:59]
    buffer_load_dwordx4 v10, s[8:11], s20 offen lds
    v_mfma_f32_16x16x32_bf16 v[60:63], v[40:43], a[208:211], v[60:63]
    ds_read_b128 v[32:35], v13 offset:53504
    v_mfma_f32_16x16x32_bf16 v[64:67], v[40:43], a[212:215], v[64:67]
    s_waitcnt lgkmcnt(4)
    v_mfma_f32_16x16x32_bf16 v[52:55], v[44:47], a[216:219], v[52:55]
    ds_read_b128 v[36:39], v14 offset:49408
    v_mfma_f32_16x16x32_bf16 v[56:59], v[44:47], a[220:223], v[56:59]
    v_mfma_f32_16x16x32_bf16 v[60:63], v[48:51], a[216:219], v[60:63]
    ds_read_b128 v[40:43], v14 offset:53504
    v_mfma_f32_16x16x32_bf16 v[64:67], v[48:51], a[220:223], v[64:67]
    s_waitcnt lgkmcnt(4)
    v_mfma_f32_16x16x32_bf16 v[52:55], v[20:23], a[224:227], v[52:55]
    ds_read_b128 v[44:47], v15 offset:49408
    s_add_u32 m0, s21, 19456
    v_mfma_f32_16x16x32_bf16 v[56:59], v[20:23], a[228:231], v[56:59]
    buffer_load_dwordx4 v11, s[8:11], s20 offen lds
    v_mfma_f32_16x16x32_bf16 v[60:63], v[24:27], a[224:227], v[60:63]
    ds_read_b128 v[48:51], v15 offset:53504
    v_mfma_f32_16x16x32_bf16 v[64:67], v[24:27], a[228:231], v[64:67]
    s_waitcnt lgkmcnt(4)
    v_mfma_f32_16x16x32_bf16 v[52:55], v[28:31], a[232:235], v[52:55]
    s_waitcnt vmcnt(20)
    s_barrier
    ds_read_b128 v[20:23], v16 offset:0
    v_mfma_f32_16x16x32_bf16 v[56:59], v[28:31], a[236:239], v[56:59]
    s_add_u32 s20, s20, 512
    v_mfma_f32_16x16x32_bf16 v[60:63], v[32:35], a[232:235], v[60:63]
    ds_read_b128 v[24:27], v16 offset:4096
    v_mfma_f32_16x16x32_bf16 v[64:67], v[32:35], a[236:239], v[64:67]
    s_waitcnt lgkmcnt(4)
    v_mfma_f32_16x16x32_bf16 v[52:55], v[36:39], a[240:243], v[52:55]
    ds_read_b128 v[28:31], v17 offset:0
    s_add_u32 m0, s21, 32768
    v_mfma_f32_16x16x32_bf16 v[56:59], v[36:39], a[244:247], v[56:59]
    buffer_load_dwordx4 v8, s[8:11], s20 offen lds
    v_mfma_f32_16x16x32_bf16 v[60:63], v[40:43], a[240:243], v[60:63]
    ds_read_b128 v[32:35], v17 offset:4096
    v_mfma_f32_16x16x32_bf16 v[64:67], v[40:43], a[244:247], v[64:67]
    s_waitcnt lgkmcnt(4)
    v_mfma_f32_16x16x32_bf16 v[52:55], v[44:47], a[248:251], v[52:55]
    ds_read_b128 v[36:39], v18 offset:0
    v_mfma_f32_16x16x32_bf16 v[56:59], v[44:47], a[252:255], v[56:59]
    v_mfma_f32_16x16x32_bf16 v[60:63], v[48:51], a[248:251], v[60:63]
    ds_read_b128 v[40:43], v18 offset:4096
    v_mfma_f32_16x16x32_bf16 v[64:67], v[48:51], a[252:255], v[64:67]
    s_waitcnt lgkmcnt(4)
    s_add_u32 s22, s22, 1
    s_cmp_ge_u32 s22, s23
    s_cbranch_scc1 L_fl0_446
    v_mfma_f32_16x16x32_bf16 v[68:71], v[20:23], a[0:3], 0
    ds_read_b128 v[44:47], v19 offset:0
    s_add_u32 m0, s21, 33792
    s_sub_u32 s39, s22, 1
    v_mfma_f32_16x16x32_bf16 v[72:75], v[20:23], a[4:7], 0
    buffer_load_dwordx4 v9, s[8:11], s20 offen lds
    s_bitcmp1_b32 s39, 1
    s_cselect_b32 s38, s55, s54
    v_mfma_f32_16x16x32_bf16 v[76:79], v[24:27], a[0:3], 0
    ds_read_b128 v[48:51], v19 offset:4096
    v_mfma_f32_16x16x32_bf16 v[80:83], v[24:27], a[4:7], 0
    s_waitcnt lgkmcnt(4)
    s_add_u32 s38, s38, s44
    v_mfma_f32_16x16x32_bf16 v[68:71], v[28:31], a[8:11], v[68:71]
    ds_read_b128 v[20:23], v16 offset:256
    s_lshl_b32 s42, s39, 20
    v_mfma_f32_16x16x32_bf16 v[72:75], v[28:31], a[12:15], v[72:75]
    s_add_u32 s38, s38, s42
    s_lshl_b32 s39, s39, 7
    v_mfma_f32_16x16x32_bf16 v[76:79], v[32:35], a[8:11], v[76:79]
    ds_read_b128 v[24:27], v16 offset:4352
    s_add_u32 s39, s39, 0x5900000
    s_cmp_eq_u32 s37, 0
    s_cselect_b32 s38, 0x7ff00000, s38
    s_cselect_b32 s39, 0x7ff00000, s39
    v_mfma_f32_16x16x32_bf16 v[80:83], v[32:35], a[12:15], v[80:83]
    s_waitcnt lgkmcnt(4)
    v_mfma_f32_16x16x32_bf16 v[68:71], v[36:39], a[16:19], v[68:71]
    ds_read_b128 v[28:31], v17 offset:256
    s_add_u32 m0, s21, 34816
    v_mfma_f32_16x16x32_bf16 v[72:75], v[36:39], a[20:23], v[72:75]
    buffer_load_dwordx4 v10, s[8:11], s20 offen lds
    v_mfma_f32_16x16x32_bf16 v[76:79], v[40:43], a[16:19], v[76:79]
    ds_read_b128 v[32:35], v17 offset:4352
    v_cvt_pk_bf16_f32 v88, v52, v53
    v_mfma_f32_16x16x32_bf16 v[80:83], v[40:43], a[20:23], v[80:83]
    s_waitcnt lgkmcnt(4)
    v_cvt_pk_bf16_f32 v89, v54, v55
    v_cvt_pk_bf16_f32 v90, v60, v61
    v_mfma_f32_16x16x32_bf16 v[68:71], v[44:47], a[24:27], v[68:71]
    ds_read_b128 v[36:39], v18 offset:256
    v_cvt_pk_bf16_f32 v91, v62, v63
    v_mfma_f32_16x16x32_bf16 v[72:75], v[44:47], a[28:31], v[72:75]
    buffer_store_dwordx4 v[88:91], v86, s[12:15], s38 offen offset:2048 sc1
    v_mfma_f32_16x16x32_bf16 v[76:79], v[48:51], a[24:27], v[76:79]
    ds_read_b128 v[40:43], v18 offset:4352
    v_cvt_pk_bf16_f32 v92, v56, v57
    v_mfma_f32_16x16x32_bf16 v[80:83], v[48:51], a[28:31], v[80:83]
    s_waitcnt lgkmcnt(4)
    v_cvt_pk_bf16_f32 v93, v58, v59
    v_mfma_f32_16x16x32_bf16 v[68:71], v[20:23], a[32:35], v[68:71]
    ds_read_b128 v[44:47], v19 offset:256
    s_add_u32 m0, s21, 35840
    v_mfma_f32_16x16x32_bf16 v[72:75], v[20:23], a[36:39], v[72:75]
    buffer_load_dwordx4 v11, s[8:11], s20 offen lds
    v_mfma_f32_16x16x32_bf16 v[76:79], v[24:27], a[32:35], v[76:79]
    ds_read_b128 v[48:51], v19 offset:4352
    v_cvt_pk_bf16_f32 v94, v64, v65
    v_mfma_f32_16x16x32_bf16 v[80:83], v[24:27], a[36:39], v[80:83]
    s_waitcnt lgkmcnt(4)
    v_cvt_pk_bf16_f32 v95, v66, v67
    v_mfma_f32_16x16x32_bf16 v[68:71], v[28:31], a[40:43], v[68:71]
    s_waitcnt vmcnt(20)
    s_barrier
    ds_read_b128 v[20:23], v16 offset:16384
    v_mfma_f32_16x16x32_bf16 v[72:75], v[28:31], a[44:47], v[72:75]
    s_add_u32 s20, s20, 512
    buffer_store_dwordx4 v[92:95], v86, s[12:15], s38 offen offset:2176 sc1
    v_mfma_f32_16x16x32_bf16 v[76:79], v[32:35], a[40:43], v[76:79]
    ds_read_b128 v[24:27], v16 offset:20480
    s_add_u32 s42, s38, 0x8000000
    v_mfma_f32_16x16x32_bf16 v[80:83], v[32:35], a[44:47], v[80:83]
    s_waitcnt lgkmcnt(4)
    v_mfma_f32_16x16x32_bf16 v[68:71], v[36:39], a[48:51], v[68:71]
    ds_read_b128 v[28:31], v17 offset:16384
    s_add_u32 m0, s21, 49152
    v_mfma_f32_16x16x32_bf16 v[72:75], v[36:39], a[52:55], v[72:75]
    buffer_load_dwordx4 v8, s[8:11], s20 offen lds
    v_mfma_f32_16x16x32_bf16 v[76:79], v[40:43], a[48:51], v[76:79]
    ds_read_b128 v[32:35], v17 offset:20480
    v_mfma_f32_16x16x32_bf16 v[80:83], v[40:43], a[52:55], v[80:83]
    s_waitcnt lgkmcnt(4)
    v_mfma_f32_16x16x32_bf16 v[68:71], v[44:47], a[56:59], v[68:71]
    ds_read_b128 v[36:39], v18 offset:16384
    v_mfma_f32_16x16x32_bf16 v[72:75], v[44:47], a[60:63], v[72:75]
    buffer_store_dwordx2 v[96:97], v101, s[12:15], s42 offen offset:512 sc1
    v_mfma_f32_16x16x32_bf16 v[76:79], v[48:51], a[56:59], v[76:79]
    ds_read_b128 v[40:43], v18 offset:20480
    v_mfma_f32_16x16x32_bf16 v[80:83], v[48:51], a[60:63], v[80:83]
    s_waitcnt lgkmcnt(4)
    v_mfma_f32_16x16x32_bf16 v[68:71], v[20:23], a[64:67], v[68:71]
    ds_read_b128 v[44:47], v19 offset:16384
    s_add_u32 m0, s21, 50176
    v_mfma_f32_16x16x32_bf16 v[72:75], v[20:23], a[68:71], v[72:75]
    buffer_load_dwordx4 v9, s[8:11], s20 offen lds
    v_mfma_f32_16x16x32_bf16 v[76:79], v[24:27], a[64:67], v[76:79]
    ds_read_b128 v[48:51], v19 offset:20480
    v_mfma_f32_16x16x32_bf16 v[80:83], v[24:27], a[68:71], v[80:83]
    s_waitcnt lgkmcnt(4)
    v_mfma_f32_16x16x32_bf16 v[68:71], v[28:31], a[72:75], v[68:71]
    ds_read_b128 v[20:23], v16 offset:16640
    v_mfma_f32_16x16x32_bf16 v[72:75], v[28:31], a[76:79], v[72:75]
    v_mfma_f32_16x16x32_bf16 v[76:79], v[32:35], a[72:75], v[76:79]
    ds_read_b128 v[24:27], v16 offset:20736
    s_add_u32 s24, s24, 1
    v_mfma_f32_16x16x32_bf16 v[80:83], v[32:35], a[76:79], v[80:83]
    s_waitcnt lgkmcnt(4)
    v_mfma_f32_16x16x32_bf16 v[68:71], v[36:39], a[80:83], v[68:71]
    ds_read_b128 v[28:31], v17 offset:16640
    s_add_u32 m0, s21, 51200
    v_mfma_f32_16x16x32_bf16 v[72:75], v[36:39], a[84:87], v[72:75]
    buffer_load_dwordx4 v10, s[8:11], s20 offen lds
    v_mfma_f32_16x16x32_bf16 v[76:79], v[40:43], a[80:83], v[76:79]
    ds_read_b128 v[32:35], v17 offset:20736
    v_mfma_f32_16x16x32_bf16 v[80:83], v[40:43], a[84:87], v[80:83]
    s_waitcnt lgkmcnt(4)
    s_min_u32 s24, s24, 63
    v_mfma_f32_16x16x32_bf16 v[68:71], v[44:47], a[88:91], v[68:71]
    ds_read_b128 v[36:39], v18 offset:16640
    v_mfma_f32_16x16x32_bf16 v[72:75], v[44:47], a[92:95], v[72:75]
    v_mfma_f32_16x16x32_bf16 v[76:79], v[48:51], a[88:91], v[76:79]
    ds_read_b128 v[40:43], v18 offset:20736
    s_lshl_b32 s53, s24, 16
    v_mfma_f32_16x16x32_bf16 v[80:83], v[48:51], a[92:95], v[80:83]
    s_waitcnt lgkmcnt(4)
    v_mfma_f32_16x16x32_bf16 v[68:71], v[20:23], a[96:99], v[68:71]
    ds_read_b128 v[44:47], v19 offset:16640
    s_add_u32 m0, s21, 52224
    v_mfma_f32_16x16x32_bf16 v[72:75], v[20:23], a[100:103], v[72:75]
    buffer_load_dwordx4 v11, s[8:11], s20 offen lds
    v_mfma_f32_16x16x32_bf16 v[76:79], v[24:27], a[96:99], v[76:79]
    ds_read_b128 v[48:51], v19 offset:20736
    v_mfma_f32_16x16x32_bf16 v[80:83], v[24:27], a[100:103], v[80:83]
    s_waitcnt lgkmcnt(4)
    v_mfma_f32_16x16x32_bf16 v[68:71], v[28:31], a[104:107], v[68:71]
    s_waitcnt vmcnt(20)
    s_barrier
    ds_read_b128 v[20:23], v16 offset:32768
    v_mfma_f32_16x16x32_bf16 v[72:75], v[28:31], a[108:111], v[72:75]
    s_mov_b32 s20, s53
    v_mfma_f32_16x16x32_bf16 v[76:79], v[32:35], a[104:107], v[76:79]
    ds_read_b128 v[24:27], v16 offset:36864
    v_mfma_f32_16x16x32_bf16 v[80:83], v[32:35], a[108:111], v[80:83]
    s_waitcnt lgkmcnt(4)
    v_mfma_f32_16x16x32_bf16 v[68:71], v[36:39], a[112:115], v[68:71]
    ds_read_b128 v[28:31], v17 offset:32768
    s_add_u32 m0, s21, 65536
    v_mfma_f32_16x16x32_bf16 v[72:75], v[36:39], a[116:119], v[72:75]
    buffer_load_dwordx4 v8, s[8:11], s20 offen lds
    v_mfma_f32_16x16x32_bf16 v[76:79], v[40:43], a[112:115], v[76:79]
    ds_read_b128 v[32:35], v17 offset:36864
    v_mfma_f32_16x16x32_bf16 v[80:83], v[40:43], a[116:119], v[80:83]
    s_waitcnt lgkmcnt(4)
    v_mfma_f32_16x16x32_bf16 v[68:71], v[44:47], a[120:123], v[68:71]
    ds_read_b128 v[36:39], v18 offset:32768
    v_mfma_f32_16x16x32_bf16 v[72:75], v[44:47], a[124:127], v[72:75]
    v_mfma_f32_16x16x32_bf16 v[76:79], v[48:51], a[120:123], v[76:79]
    ds_read_b128 v[40:43], v18 offset:36864
    v_mfma_f32_16x16x32_bf16 v[80:83], v[48:51], a[124:127], v[80:83]
    s_waitcnt lgkmcnt(4)
    v_mfma_f32_16x16x32_bf16 v[68:71], v[20:23], a[128:131], v[68:71]
    ds_read_b128 v[44:47], v19 offset:32768
    s_add_u32 m0, s21, 66560
    v_mfma_f32_16x16x32_bf16 v[72:75], v[20:23], a[132:135], v[72:75]
    buffer_load_dwordx4 v9, s[8:11], s20 offen lds
    v_mfma_f32_16x16x32_bf16 v[76:79], v[24:27], a[128:131], v[76:79]
    ds_read_b128 v[48:51], v19 offset:36864
    v_mfma_f32_16x16x32_bf16 v[80:83], v[24:27], a[132:135], v[80:83]
    s_waitcnt lgkmcnt(4)
    v_mfma_f32_16x16x32_bf16 v[68:71], v[28:31], a[136:139], v[68:71]
    ds_read_b128 v[20:23], v16 offset:33024
    v_mfma_f32_16x16x32_bf16 v[72:75], v[28:31], a[140:143], v[72:75]
    v_mfma_f32_16x16x32_bf16 v[76:79], v[32:35], a[136:139], v[76:79]
    ds_read_b128 v[24:27], v16 offset:37120
    v_mfma_f32_16x16x32_bf16 v[80:83], v[32:35], a[140:143], v[80:83]
    s_waitcnt lgkmcnt(4)
    v_mfma_f32_16x16x32_bf16 v[68:71], v[36:39], a[144:147], v[68:71]
    ds_read_b128 v[28:31], v17 offset:33024
    s_add_u32 m0, s21, 67584
    v_mfma_f32_16x16x32_bf16 v[72:75], v[36:39], a[148:151], v[72:75]
    buffer_load_dwordx4 v10, s[8:11], s20 offen lds
    v_mfma_f32_16x16x32_bf16 v[76:79], v[40:43], a[144:147], v[76:79]
    ds_read_b128 v[32:35], v17 offset:37120
    v_mfma_f32_16x16x32_bf16 v[80:83], v[40:43], a[148:151], v[80:83]
    s_waitcnt lgkmcnt(4)
    v_mfma_f32_16x16x32_bf16 v[68:71], v[44:47], a[152:155], v[68:71]
    ds_read_b128 v[36:39], v18 offset:33024
    v_mfma_f32_16x16x32_bf16 v[72:75], v[44:47], a[156:159], v[72:75]
    v_mfma_f32_16x16x32_bf16 v[76:79], v[48:51], a[152:155], v[76:79]
    ds_read_b128 v[40:43], v18 offset:37120
    v_mfma_f32_16x16x32_bf16 v[80:83], v[48:51], a[156:159], v[80:83]
    s_waitcnt lgkmcnt(4)
    v_mfma_f32_16x16x32_bf16 v[68:71], v[20:23], a[160:163], v[68:71]
    ds_read_b128 v[44:47], v19 offset:33024
    s_add_u32 m0, s21, 68608
    v_mfma_f32_16x16x32_bf16 v[72:75], v[20:23], a[164:167], v[72:75]
    buffer_load_dwordx4 v11, s[8:11], s20 offen lds
    v_mfma_f32_16x16x32_bf16 v[76:79], v[24:27], a[160:163], v[76:79]
    ds_read_b128 v[48:51], v19 offset:37120
    v_mfma_f32_16x16x32_bf16 v[80:83], v[24:27], a[164:167], v[80:83]
    s_waitcnt lgkmcnt(4)
    v_mfma_f32_16x16x32_bf16 v[68:71], v[28:31], a[168:171], v[68:71]
    s_waitcnt vmcnt(7)
    s_barrier
    ds_read_b128 v[20:23], v16 offset:49152
    v_mfma_f32_16x16x32_bf16 v[72:75], v[28:31], a[172:175], v[72:75]
    s_add_u32 s20, s20, 512
    buffer_atomic_add v84, v85, s[12:15], s39 offen sc1
    v_mfma_f32_16x16x32_bf16 v[76:79], v[32:35], a[168:171], v[76:79]
    ds_read_b128 v[24:27], v16 offset:53248
    s_mov_b32 s37, 1
    v_mfma_f32_16x16x32_bf16 v[80:83], v[32:35], a[172:175], v[80:83]
    s_waitcnt lgkmcnt(4)
    v_mfma_f32_16x16x32_bf16 v[68:71], v[36:39], a[176:179], v[68:71]
    ds_read_b128 v[28:31], v17 offset:49152
    s_add_u32 m0, s21, 81920
    v_mfma_f32_16x16x32_bf16 v[72:75], v[36:39], a[180:183], v[72:75]
    buffer_load_dwordx4 v8, s[8:11], s20 offen lds
    v_mfma_f32_16x16x32_bf16 v[76:79], v[40:43], a[176:179], v[76:79]
    ds_read_b128 v[32:35], v17 offset:53248
    v_mfma_f32_16x16x32_bf16 v[80:83], v[40:43], a[180:183], v[80:83]
    s_waitcnt lgkmcnt(4)
    v_mfma_f32_16x16x32_bf16 v[68:71], v[44:47], a[184:187], v[68:71]
    ds_read_b128 v[36:39], v18 offset:49152
    v_mfma_f32_16x16x32_bf16 v[72:75], v[44:47], a[188:191], v[72:75]
    v_mfma_f32_16x16x32_bf16 v[76:79], v[48:51], a[184:187], v[76:79]
    ds_read_b128 v[40:43], v18 offset:53248
    v_mfma_f32_16x16x32_bf16 v[80:83], v[48:51], a[188:191], v[80:83]
    s_waitcnt lgkmcnt(4)
    v_mfma_f32_16x16x32_bf16 v[68:71], v[20:23], a[192:195], v[68:71]
    ds_read_b128 v[44:47], v19 offset:49152
    s_add_u32 m0, s21, 82944
    v_mfma_f32_16x16x32_bf16 v[72:75], v[20:23], a[196:199], v[72:75]
    buffer_load_dwordx4 v9, s[8:11], s20 offen lds
    v_mfma_f32_16x16x32_bf16 v[76:79], v[24:27], a[192:195], v[76:79]
    ds_read_b128 v[48:51], v19 offset:53248
    v_mfma_f32_16x16x32_bf16 v[80:83], v[24:27], a[196:199], v[80:83]
    s_waitcnt lgkmcnt(4)
    v_mfma_f32_16x16x32_bf16 v[68:71], v[28:31], a[200:203], v[68:71]
    ds_read_b128 v[20:23], v16 offset:49408
    v_mfma_f32_16x16x32_bf16 v[72:75], v[28:31], a[204:207], v[72:75]
    v_mfma_f32_16x16x32_bf16 v[76:79], v[32:35], a[200:203], v[76:79]
    ds_read_b128 v[24:27], v16 offset:53504
    v_mfma_f32_16x16x32_bf16 v[80:83], v[32:35], a[204:207], v[80:83]
    s_waitcnt lgkmcnt(4)
    v_mfma_f32_16x16x32_bf16 v[68:71], v[36:39], a[208:211], v[68:71]
    ds_read_b128 v[28:31], v17 offset:49408
    s_add_u32 m0, s21, 83968
    v_mfma_f32_16x16x32_bf16 v[72:75], v[36:39], a[212:215], v[72:75]
    buffer_load_dwordx4 v10, s[8:11], s20 offen lds
    v_mfma_f32_16x16x32_bf16 v[76:79], v[40:43], a[208:211], v[76:79]
    ds_read_b128 v[32:35], v17 offset:53504
    v_mfma_f32_16x16x32_bf16 v[80:83], v[40:43], a[212:215], v[80:83]
    s_waitcnt lgkmcnt(4)
    v_mfma_f32_16x16x32_bf16 v[68:71], v[44:47], a[216:219], v[68:71]
    ds_read_b128 v[36:39], v18 offset:49408
    v_mfma_f32_16x16x32_bf16 v[72:75], v[44:47], a[220:223], v[72:75]
    v_mfma_f32_16x16x32_bf16 v[76:79], v[48:51], a[216:219], v[76:79]
    ds_read_b128 v[40:43], v18 offset:53504
    v_mfma_f32_16x16x32_bf16 v[80:83], v[48:51], a[220:223], v[80:83]
    s_waitcnt lgkmcnt(4)
    v_mfma_f32_16x16x32_bf16 v[68:71], v[20:23], a[224:227], v[68:71]
    ds_read_b128 v[44:47], v19 offset:49408
    s_add_u32 m0, s21, 84992
    v_mfma_f32_16x16x32_bf16 v[72:75], v[20:23], a[228:231], v[72:75]
    buffer_load_dwordx4 v11, s[8:11], s20 offen lds
    v_mfma_f32_16x16x32_bf16 v[76:79], v[24:27], a[224:227], v[76:79]
    ds_read_b128 v[48:51], v19 offset:53504
    v_mfma_f32_16x16x32_bf16 v[80:83], v[24:27], a[228:231], v[80:83]
    s_waitcnt lgkmcnt(4)
    v_mfma_f32_16x16x32_bf16 v[68:71], v[28:31], a[232:235], v[68:71]
    s_waitcnt vmcnt(20)
    s_barrier
    ds_read_b128 v[20:23], v12 offset:0
    v_mfma_f32_16x16x32_bf16 v[72:75], v[28:31], a[236:239], v[72:75]
    s_add_u32 s20, s20, 512
    v_mfma_f32_16x16x32_bf16 v[76:79], v[32:35], a[232:235], v[76:79]
    ds_read_b128 v[24:27], v12 offset:4096
    v_mfma_f32_16x16x32_bf16 v[80:83], v[32:35], a[236:239], v[80:83]
    s_waitcnt lgkmcnt(4)
    v_mfma_f32_16x16x32_bf16 v[68:71], v[36:39], a[240:243], v[68:71]
    ds_read_b128 v[28:31], v13 offset:0
    s_add_u32 m0, s21, 98304
    v_mfma_f32_16x16x32_bf16 v[72:75], v[36:39], a[244:247], v[72:75]
    buffer_load_dwordx4 v8, s[8:11], s20 offen lds
    v_mfma_f32_16x16x32_bf16 v[76:79], v[40:43], a[240:243], v[76:79]
    ds_read_b128 v[32:35], v13 offset:4096
    v_mfma_f32_16x16x32_bf16 v[80:83], v[40:43], a[244:247], v[80:83]
    s_waitcnt lgkmcnt(4)
    v_mfma_f32_16x16x32_bf16 v[68:71], v[44:47], a[248:251], v[68:71]
    ds_read_b128 v[36:39], v14 offset:0
    v_mfma_f32_16x16x32_bf16 v[72:75], v[44:47], a[252:255], v[72:75]
    v_mfma_f32_16x16x32_bf16 v[76:79], v[48:51], a[248:251], v[76:79]
    ds_read_b128 v[40:43], v14 offset:4096
    v_mfma_f32_16x16x32_bf16 v[80:83], v[48:51], a[252:255], v[80:83]
    s_waitcnt lgkmcnt(4)
    s_add_u32 s22, s22, 1
    s_cmp_ge_u32 s22, s23
    s_cbranch_scc0 L_st_449
L_fl1_447:
    s_waitcnt lgkmcnt(0)
    s_nop 7
    s_sub_u32 s39, s22, 1
    s_bitcmp1_b32 s39, 1
    s_cselect_b32 s38, s55, s54
    s_add_u32 s38, s38, s44
    s_lshl_b32 s42, s39, 20
    s_add_u32 s38, s38, s42
    s_lshl_b32 s39, s39, 7
    s_add_u32 s39, s39, 0x5900000
    s_cmp_eq_u32 s37, 0
    s_cselect_b32 s38, 0x7ff00000, s38
    s_cselect_b32 s39, 0x7ff00000, s39
    v_cvt_pk_bf16_f32 v88, v68, v69
    v_cvt_pk_bf16_f32 v89, v70, v71
    v_cvt_pk_bf16_f32 v90, v76, v77
    v_cvt_pk_bf16_f32 v91, v78, v79
    buffer_store_dwordx4 v[88:91], v86, s[12:15], s38 offen offset:2048 sc1
    v_cvt_pk_bf16_f32 v92, v72, v73
    v_cvt_pk_bf16_f32 v93, v74, v75
    v_cvt_pk_bf16_f32 v94, v80, v81
    v_cvt_pk_bf16_f32 v95, v82, v83
    buffer_store_dwordx4 v[92:95], v86, s[12:15], s38 offen offset:2176 sc1
    s_add_u32 s42, s38, 0x8000000
    buffer_store_dwordx2 v[96:97], v101, s[12:15], s42 offen offset:512 sc1
    s_waitcnt vmcnt(0)
    s_barrier
    buffer_atomic_add v84, v85, s[12:15], s39 offen sc1
    s_mov_b32 s37, 1
    s_branch L_ste_448
L_fl0_446:
    s_waitcnt lgkmcnt(0)
    s_nop 7
    s_sub_u32 s39, s22, 1
    s_bitcmp1_b32 s39, 1
    s_cselect_b32 s38, s55, s54
    s_add_u32 s38, s38, s44
    s_lshl_b32 s42, s39, 20
    s_add_u32 s38, s38, s42
    s_lshl_b32 s39, s39, 7
    s_add_u32 s39, s39, 0x5900000
    s_cmp_eq_u32 s37, 0
    s_cselect_b32 s38, 0x7ff00000, s38
    s_cselect_b32 s39, 0x7ff00000, s39
    v_cvt_pk_bf16_f32 v88, v52, v53
    v_cvt_pk_bf16_f32 v89, v54, v55
    v_cvt_pk_bf16_f32 v90, v60, v61
    v_cvt_pk_bf16_f32 v91, v62, v63
    buffer_store_dwordx4 v[88:91], v86, s[12:15], s38 offen offset:2048 sc1
    v_cvt_pk_bf16_f32 v92, v56, v57
    v_cvt_pk_bf16_f32 v93, v58, v59
    v_cvt_pk_bf16_f32 v94, v64, v65
    v_cvt_pk_bf16_f32 v95, v66, v67
    buffer_store_dwordx4 v[92:95], v86, s[12:15], s38 offen offset:2176 sc1
    s_add_u32 s42, s38, 0x8000000
    buffer_store_dwordx2 v[96:97], v101, s[12:15], s42 offen offset:512 sc1
    s_waitcnt vmcnt(0)
    s_barrier
    buffer_atomic_add v84, v85, s[12:15], s39 offen sc1
    s_mov_b32 s37, 1
L_ste_448:
    s_branch L_op_435
L_q_432:
    v_and_b32 v1, 31, v0
    v_bfe_u32 v2, v0, 5, 1
    v_and_b32 v96, 63, v0
    v_lshlrev_b32 v96, 4, v96
    v_and_b32 v4, 7, v1
    v_lshlrev_b32 v4, 4, v4
    s_lshl_b32 s7, s49, 12
    s_add_u32 s7, s7, 0x21000
    v_lshl_add_u32 v97, v2, 7, v4
    v_add_u32 v97, s7, v97
    v_bfe_u32 v5, v1, 2, 1
    v_lshlrev_b32 v5, 4, v5
    v_lshrrev_b32 v6, 3, v1
    v_lshl_add_u32 v5, v6, 2, v5
    v_and_b32 v6, 3, v1
    v_add_u32 v5, v5, v6
    v_lshlrev_b32 v5, 4, v5
    v_lshl_add_u32 v98, v2, 9, v5
    v_lshl_add_u32 v99, v2, 3, v5
    v_add_u32 v99, s7, v99
    v_lshlrev_b32 v4, 4, v1
    v_lshl_add_u32 v100, v2, 10, v4
    v_and_b32 v85, 63, v0
    v_min_u32 v85, 1, v85
    v_lshlrev_b32 v85, 30, v85
    v_lshlrev_b32 v4, 2, v2
    v_sub_u32 v4, v1, v4
    v_mov_b32 v5, 0xff800000
    v_cmp_gt_i32 vcc, 0, v4
    s_nop 1
    v_cndmask_b32 v240, 0, v5, vcc
    v_cmp_gt_i32 vcc, 1, v4
    s_nop 1
    v_cndmask_b32 v241, 0, v5, vcc
    v_cmp_gt_i32 vcc, 2, v4
    s_nop 1
    v_cndmask_b32 v242, 0, v5, vcc
    v_cmp_gt_i32 vcc, 3, v4
    s_nop 1
    v_cndmask_b32 v243, 0, v5, vcc
    v_cmp_gt_i32 vcc, 8, v4
    s_nop 1
    v_cndmask_b32 v244, 0, v5, vcc
    v_cmp_gt_i32 vcc, 9, v4
    s_nop 1
    v_cndmask_b32 v245, 0, v5, vcc
    v_cmp_gt_i32 vcc, 10, v4
    s_nop 1
    v_cndmask_b32 v246, 0, v5, vcc
    v_cmp_gt_i32 vcc, 11, v4
    s_nop 1
    v_cndmask_b32 v247, 0, v5, vcc
    v_cmp_gt_i32 vcc, 16, v4
    s_nop 1
    v_cndmask_b32 v248, 0, v5, vcc
    v_cmp_gt_i32 vcc, 17, v4
    s_nop 1
    v_cndmask_b32 v249, 0, v5, vcc
    v_cmp_gt_i32 vcc, 18, v4
    s_nop 1
    v_cndmask_b32 v250, 0, v5, vcc
    v_cmp_gt_i32 vcc, 19, v4
    s_nop 1
    v_cndmask_b32 v251, 0, v5, vcc
    v_cmp_gt_i32 vcc, 24, v4
    s_nop 1
    v_cndmask_b32 v252, 0, v5, vcc
    v_cmp_gt_i32 vcc, 25, v4
    s_nop 1
    v_cndmask_b32 v253, 0, v5, vcc
    v_cmp_gt_i32 vcc, 26, v4
    s_nop 1
    v_cndmask_b32 v254, 0, v5, vcc
    v_cmp_gt_i32 vcc, 27, v4
    s_nop 1
    v_cndmask_b32 v255, 0, v5, vcc
    s_mov_b32 s47, 0
    v_mov_b32 v102, 0x20000
    v_lshl_add_u32 v101, v0, 2, v102
    v_mov_b32 v103, 4
    v_mov_b32 v87, 0
    s_mov_b32 s45, 0
    s_barrier
    s_add_u32 m0, s21, 0
    s_nop 0
    buffer_load_dwordx4 v8, s[8:11], s20 offen lds
    s_add_u32 m0, s21, 1024
    s_nop 0
    buffer_load_dwordx4 v9, s[8:11], s20 offen lds
    s_add_u32 m0, s21, 2048
    s_nop 0
    buffer_load_dwordx4 v10, s[8:11], s20 offen lds
    s_add_u32 m0, s21, 3072
    s_nop 0
    buffer_load_dwordx4 v11, s[8:11], s20 offen lds
    s_add_u32 s20, s20, 512
    s_add_u32 m0, s21, 16384
    s_nop 0
    buffer_load_dwordx4 v8, s[8:11], s20 offen lds
    s_add_u32 m0, s21, 17408
    s_nop 0
    buffer_load_dwordx4 v9, s[8:11], s20 offen lds
    s_add_u32 m0, s21, 18432
    s_nop 0
    buffer_load_dwordx4 v10, s[8:11], s20 offen lds
    s_add_u32 m0, s21, 19456
    s_nop 0
    buffer_load_dwordx4 v11, s[8:11], s20 offen lds
    s_add_u32 s20, s20, 512
    s_add_u32 m0, s21, 32768
    s_nop 0
    buffer_load_dwordx4 v8, s[8:11], s20 offen lds
    s_add_u32 m0, s21, 33792
    s_nop 0
    buffer_load_dwordx4 v9, s[8:11], s20 offen lds
    s_add_u32 m0, s21, 34816
    s_nop 0
    buffer_load_dwordx4 v10, s[8:11], s20 offen lds
    s_add_u32 m0, s21, 35840
    s_nop 0
    buffer_load_dwordx4 v11, s[8:11], s20 offen lds
    s_add_u32 s20, s20, 512
    s_add_u32 m0, s21, 49152
    s_nop 0
    buffer_load_dwordx4 v8, s[8:11], s20 offen lds
    s_add_u32 m0, s21, 50176
    s_nop 0
    buffer_load_dwordx4 v9, s[8:11], s20 offen lds
    s_add_u32 m0, s21, 51200
    s_nop 0
    buffer_load_dwordx4 v10, s[8:11], s20 offen lds
    s_add_u32 m0, s21, 52224
    s_nop 0
    buffer_load_dwordx4 v11, s[8:11], s20 offen lds
    s_add_u32 s24, s24, 1
    s_min_u32 s24, s24, 63
    s_lshl_b32 s53, s24, 16
    s_mov_b32 s20, s53
    s_add_u32 m0, s21, 65536
    s_nop 0
    buffer_load_dwordx4 v8, s[8:11], s20 offen lds
    s_add_u32 m0, s21, 66560
    s_nop 0
    buffer_load_dwordx4 v9, s[8:11], s20 offen lds
    s_add_u32 m0, s21, 67584
    s_nop 0
    buffer_load_dwordx4 v10, s[8:11], s20 offen lds
    s_add_u32 m0, s21, 68608
    s_nop 0
    buffer_load_dwordx4 v11, s[8:11], s20 offen lds
    s_add_u32 s20, s20, 512
    s_add_u32 m0, s21, 81920
    s_nop 0
    buffer_load_dwordx4 v8, s[8:11], s20 offen lds
    s_add_u32 m0, s21, 82944
    s_nop 0
    buffer_load_dwordx4 v9, s[8:11], s20 offen lds
    s_add_u32 m0, s21, 83968
    s_nop 0
    buffer_load_dwordx4 v10, s[8:11], s20 offen lds
    s_add_u32 m0, s21, 84992
    s_nop 0
    buffer_load_dwordx4 v11, s[8:11], s20 offen lds
    s_add_u32 s20, s20, 512
    s_add_u32 m0, s21, 98304
    s_nop 0
    buffer_load_dwordx4 v8, s[8:11], s20 offen lds
    s_waitcnt vmcnt(0)
    s_barrier
    ds_read_b128 v[20:23], v12 offset:0
    ds_read_b128 v[24:27], v12 offset:4096
    ds_read_b128 v[28:31], v13 offset:0
    ds_read_b128 v[32:35], v13 offset:4096
    ds_read_b128 v[36:39], v14 offset:0
    ds_read_b128 v[40:43], v14 offset:4096
    s_waitcnt lgkmcnt(4)
L_st_459:
    v_mfma_f32_16x16x32_bf16 v[52:55], a[0:3], v[20:23], 0
    ds_read_b128 v[44:47], v15 offset:0
    s_add_u32 m0, s21, 99328
    s_sub_u32 s39, s22, 1
    v_mfma_f32_16x16x32_bf16 v[56:59], a[4:7], v[20:23], 0
    buffer_load_dwordx4 v9, s[8:11], s20 offen lds
    v_mfma_f32_16x16x32_bf16 v[60:63], a[0:3], v[24:27], 0
    ds_read_b128 v[48:51], v15 offset:4096
    s_bitcmp1_b32 s39, 1
    s_cselect_b32 s38, s54, s55
    v_mfma_f32_16x16x32_bf16 v[64:67], a[4:7], v[24:27], 0
    s_waitcnt lgkmcnt(4)
    v_mfma_f32_16x16x32_bf16 v[52:55], a[8:11], v[28:31], v[52:55]
    ds_read_b128 v[20:23], v12 offset:256
    s_add_u32 s38, s38, s44
    s_waitcnt vmcnt(5)
    v_mfma_f32_16x16x32_bf16 v[56:59], a[12:15], v[28:31], v[56:59]
    s_lshl_b32 s42, s39, 20
    s_add_u32 s38, s38, s42
    ds_write_b32 v101, v87
    v_mfma_f32_16x16x32_bf16 v[60:63], a[8:11], v[32:35], v[60:63]
    ds_read_b128 v[24:27], v12 offset:4352
    s_cmp_eq_u32 s37, 0
    s_cselect_b32 s38, 0x7ff00000, s38
    v_mfma_f32_16x16x32_bf16 v[64:67], a[12:15], v[32:35], v[64:67]
    s_waitcnt lgkmcnt(4)
    v_mfma_f32_16x16x32_bf16 v[52:55], a[16:19], v[36:39], v[52:55]
    ds_read_b128 v[28:31], v13 offset:256
    s_add_u32 m0, s21, 100352
    v_mfma_f32_16x16x32_bf16 v[56:59], a[20:23], v[36:39], v[56:59]
    buffer_load_dwordx4 v10, s[8:11], s20 offen lds
    s_mov_b32 s37, 1
    v_mfma_f32_16x16x32_bf16 v[60:63], a[16:19], v[40:43], v[60:63]
    ds_read_b128 v[32:35], v13 offset:4352
    v_cvt_pk_bf16_f32 v88, v68, v69
    v_mfma_f32_16x16x32_bf16 v[64:67], a[20:23], v[40:43], v[64:67]
    s_waitcnt lgkmcnt(4)
    v_cvt_pk_bf16_f32 v89, v70, v71
    v_mfma_f32_16x16x32_bf16 v[52:55], a[24:27], v[44:47], v[52:55]
    ds_read_b128 v[36:39], v14 offset:256
    v_cvt_pk_bf16_f32 v90, v72, v73
    v_mfma_f32_16x16x32_bf16 v[56:59], a[28:31], v[44:47], v[56:59]
    v_cvt_pk_bf16_f32 v91, v74, v75
    v_mfma_f32_16x16x32_bf16 v[60:63], a[24:27], v[48:51], v[60:63]
    ds_read_b128 v[40:43], v14 offset:4352
    buffer_store_dwordx4 v[88:91], v86, s[12:15], s38 offen offset:0
    v_mfma_f32_16x16x32_bf16 v[64:67], a[28:31], v[48:51], v[64:67]
    s_waitcnt lgkmcnt(4)
    v_cvt_pk_bf16_f32 v92, v76, v77
    v_cvt_pk_bf16_f32 v93, v78, v79
    v_mfma_f32_16x16x32_bf16 v[52:55], a[32:35], v[20:23], v[52:55]
    ds_read_b128 v[44:47], v15 offset:256
    s_add_u32 m0, s21, 101376
    v_mfma_f32_16x16x32_bf16 v[56:59], a[36:39], v[20:23], v[56:59]
    buffer_load_dwordx4 v11, s[8:11], s20 offen lds
    v_cvt_pk_bf16_f32 v94, v80, v81
    v_mfma_f32_16x16x32_bf16 v[60:63], a[32:35], v[24:27], v[60:63]
    ds_read_b128 v[48:51], v15 offset:4352
    v_cvt_pk_bf16_f32 v95, v82, v83
    v_mfma_f32_16x16x32_bf16 v[64:67], a[36:39], v[24:27], v[64:67]
    s_waitcnt lgkmcnt(4)
    buffer_store_dwordx4 v[92:95], v86, s[12:15], s38 offen offset:128
    v_mfma_f32_16x16x32_bf16 v[52:55], a[40:43], v[28:31], v[52:55]
    s_waitcnt vmcnt(25)
    s_barrier
    ds_read_b128 v[20:23], v12 offset:16384
    v_mfma_f32_16x16x32_bf16 v[56:59], a[44:47], v[28:31], v[56:59]
    s_add_u32 s20, s20, 512
    v_mfma_f32_16x16x32_bf16 v[60:63], a[40:43], v[32:35], v[60:63]
    ds_read_b128 v[24:27], v12 offset:20480
    ds_read_b32 v87, v102
    v_mfma_f32_16x16x32_bf16 v[64:67], a[44:47], v[32:35], v[64:67]
    s_waitcnt lgkmcnt(4)
    v_mfma_f32_16x16x32_bf16 v[52:55], a[48:51], v[36:39], v[52:55]
    ds_read_b128 v[28:31], v13 offset:16384
    s_add_u32 m0, s21, 114688
    v_mfma_f32_16x16x32_bf16 v[56:59], a[52:55], v[36:39], v[56:59]
    buffer_load_dwordx4 v8, s[8:11], s20 offen lds
    v_mfma_f32_16x16x32_bf16 v[60:63], a[48:51], v[40:43], v[60:63]
    ds_read_b128 v[32:35], v13 offset:20480
    v_mfma_f32_16x16x32_bf16 v[64:67], a[52:55], v[40:43], v[64:67]
    s_waitcnt lgkmcnt(4)
    v_mfma_f32_16x16x32_bf16 v[52:55], a[56:59], v[44:47], v[52:55]
    ds_read_b128 v[36:39], v14 offset:16384
    v_mfma_f32_16x16x32_bf16 v[56:59], a[60:63], v[44:47], v[56:59]
    v_mfma_f32_16x16x32_bf16 v[60:63], a[56:59], v[48:51], v[60:63]
    ds_read_b128 v[40:43], v14 offset:20480
    v_mfma_f32_16x16x32_bf16 v[64:67], a[60:63], v[48:51], v[64:67]
    s_waitcnt lgkmcnt(4)
    v_mfma_f32_16x16x32_bf16 v[52:55], a[64:67], v[20:23], v[52:55]
    ds_read_b128 v[44:47], v15 offset:16384
    s_add_u32 m0, s21, 115712
    v_mfma_f32_16x16x32_bf16 v[56:59], a[68:71], v[20:23], v[56:59]
    buffer_load_dwordx4 v9, s[8:11], s20 offen lds
    v_mfma_f32_16x16x32_bf16 v[60:63], a[64:67], v[24:27], v[60:63]
    ds_read_b128 v[48:51], v15 offset:20480
    s_branch L_anext_451
L_attr_452:
    v_mfma_f32_16x16x32_bf16 v[64:67], a[68:71], v[24:27], v[64:67]
    s_waitcnt lgkmcnt(4)
    v_mfma_f32_16x16x32_bf16 v[52:55], a[72:75], v[28:31], v[52:55]
    ds_read_b128 v[20:23], v12 offset:16640
    v_mfma_f32_16x16x32_bf16 v[56:59], a[76:79], v[28:31], v[56:59]
    v_mfma_f32_16x16x32_bf16 v[60:63], a[72:75], v[32:35], v[60:63]
    ds_read_b128 v[24:27], v12 offset:20736
    s_add_u32 s24, s24, 1
    v_mfma_f32_16x16x32_bf16 v[64:67], a[76:79], v[32:35], v[64:67]
    s_waitcnt lgkmcnt(4)
    v_mfma_f32_16x16x32_bf16 v[52:55], a[80:83], v[36:39], v[52:55]
    ds_read_b128 v[28:31], v13 offset:16640
    s_add_u32 m0, s21, 116736
    v_mfma_f32_16x16x32_bf16 v[56:59], a[84:87], v[36:39], v[56:59]
    buffer_load_dwordx4 v10, s[8:11], s20 offen lds
    v_mfma_f32_16x16x32_bf16 v[60:63], a[80:83], v[40:43], v[60:63]
    ds_read_b128 v[32:35], v13 offset:20736
    v_mfma_f32_16x16x32_bf16 v[64:67], a[84:87], v[40:43], v[64:67]
    s_waitcnt lgkmcnt(4)
    s_min_u32 s24, s24, 63
    v_mfma_f32_16x16x32_bf16 v[52:55], a[88:91], v[44:47], v[52:55]
    ds_read_b128 v[36:39], v14 offset:16640
    v_mfma_f32_16x16x32_bf16 v[56:59], a[92:95], v[44:47], v[56:59]
    v_mfma_f32_16x16x32_bf16 v[60:63], a[88:91], v[48:51], v[60:63]
    ds_read_b128 v[40:43], v14 offset:20736
    s_lshl_b32 s53, s24, 16
    v_mfma_f32_16x16x32_bf16 v[64:67], a[92:95], v[48:51], v[64:67]
    s_waitcnt lgkmcnt(4)
    v_mfma_f32_16x16x32_bf16 v[52:55], a[96:99], v[20:23], v[52:55]
    ds_read_b128 v[44:47], v15 offset:16640
    s_add_u32 m0, s21, 117760
    v_mfma_f32_16x16x32_bf16 v[56:59], a[100:103], v[20:23], v[56:59]
    buffer_load_dwordx4 v11, s[8:11], s20 offen lds
    v_mfma_f32_16x16x32_bf16 v[60:63], a[96:99], v[24:27], v[60:63]
    ds_read_b128 v[48:51], v15 offset:20736
    v_mfma_f32_16x16x32_bf16 v[64:67], a[100:103], v[24:27], v[64:67]
    s_waitcnt lgkmcnt(4)
    v_mfma_f32_16x16x32_bf16 v[52:55], a[104:107], v[28:31], v[52:55]
    s_waitcnt vmcnt(24)
    s_barrier
    ds_read_b128 v[20:23], v12 offset:32768
    v_mfma_f32_16x16x32_bf16 v[56:59], a[108:111], v[28:31], v[56:59]
    s_mov_b32 s20, s53
    v_mfma_f32_16x16x32_bf16 v[60:63], a[104:107], v[32:35], v[60:63]
    ds_read_b128 v[24:27], v12 offset:36864
    v_mfma_f32_16x16x32_bf16 v[64:67], a[108:111], v[32:35], v[64:67]
    s_waitcnt lgkmcnt(4)
    v_mfma_f32_16x16x32_bf16 v[52:55], a[112:115], v[36:39], v[52:55]
    ds_read_b128 v[28:31], v13 offset:32768
    s_add_u32 m0, s21, 0
    v_mfma_f32_16x16x32_bf16 v[56:59], a[116:119], v[36:39], v[56:59]
    buffer_load_dwordx4 v8, s[8:11], s20 offen lds
    v_mfma_f32_16x16x32_bf16 v[60:63], a[112:115], v[40:43], v[60:63]
    ds_read_b128 v[32:35], v13 offset:36864
    v_mfma_f32_16x16x32_bf16 v[64:67], a[116:119], v[40:43], v[64:67]
    s_waitcnt lgkmcnt(4)
    v_mfma_f32_16x16x32_bf16 v[52:55], a[120:123], v[44:47], v[52:55]
    ds_read_b128 v[36:39], v14 offset:32768
    v_mfma_f32_16x16x32_bf16 v[56:59], a[124:127], v[44:47], v[56:59]
    v_mfma_f32_16x16x32_bf16 v[60:63], a[120:123], v[48:51], v[60:63]
    ds_read_b128 v[40:43], v14 offset:36864
    v_mfma_f32_16x16x32_bf16 v[64:67], a[124:127], v[48:51], v[64:67]
    s_waitcnt lgkmcnt(4)
    v_mfma_f32_16x16x32_bf16 v[52:55], a[128:131], v[20:23], v[52:55]
    ds_read_b128 v[44:47], v15 offset:32768
    s_add_u32 m0, s21, 1024
    v_mfma_f32_16x16x32_bf16 v[56:59], a[132:135], v[20:23], v[56:59]
    buffer_load_dwordx4 v9, s[8:11], s20 offen lds
    v_mfma_f32_16x16x32_bf16 v[60:63], a[128:131], v[24:27], v[60:63]
    ds_read_b128 v[48:51], v15 offset:36864
    v_mfma_f32_16x16x32_bf16 v[64:67], a[132:135], v[24:27], v[64:67]
    s_waitcnt lgkmcnt(4)
    v_mfma_f32_16x16x32_bf16 v[52:55], a[136:139], v[28:31], v[52:55]
    ds_read_b128 v[20:23], v12 offset:33024
    v_mfma_f32_16x16x32_bf16 v[56:59], a[140:143], v[28:31], v[56:59]
    v_mfma_f32_16x16x32_bf16 v[60:63], a[136:139], v[32:35], v[60:63]
    ds_read_b128 v[24:27], v12 offset:37120
    v_mfma_f32_16x16x32_bf16 v[64:67], a[140:143], v[32:35], v[64:67]
    s_waitcnt lgkmcnt(4)
    v_mfma_f32_16x16x32_bf16 v[52:55], a[144:147], v[36:39], v[52:55]
    ds_read_b128 v[28:31], v13 offset:33024
    s_add_u32 m0, s21, 2048
    v_mfma_f32_16x16x32_bf16 v[56:59], a[148:151], v[36:39], v[56:59]
    buffer_load_dwordx4 v10, s[8:11], s20 offen lds
    v_mfma_f32_16x16x32_bf16 v[60:63], a[144:147], v[40:43], v[60:63]
    ds_read_b128 v[32:35], v13 offset:37120
    v_mfma_f32_16x16x32_bf16 v[64:67], a[148:151], v[40:43], v[64:67]
    s_waitcnt lgkmcnt(4)
    v_mfma_f32_16x16x32_bf16 v[52:55], a[152:155], v[44:47], v[52:55]
    ds_read_b128 v[36:39], v14 offset:33024
    v_mfma_f32_16x16x32_bf16 v[56:59], a[156:159], v[44:47], v[56:59]
    v_mfma_f32_16x16x32_bf16 v[60:63], a[152:155], v[48:51], v[60:63]
    ds_read_b128 v[40:43], v14 offset:37120
    v_mfma_f32_16x16x32_bf16 v[64:67], a[156:159], v[48:51], v[64:67]
    s_waitcnt lgkmcnt(4)
    v_mfma_f32_16x16x32_bf16 v[52:55], a[160:163], v[20:23], v[52:55]
    ds_read_b128 v[44:47], v15 offset:33024
    s_add_u32 m0, s21, 3072
    v_mfma_f32_16x16x32_bf16 v[56:59], a[164:167], v[20:23], v[56:59]
    buffer_load_dwordx4 v11, s[8:11], s20 offen lds
    v_mfma_f32_16x16x32_bf16 v[60:63], a[160:163], v[24:27], v[60:63]
    ds_read_b128 v[48:51], v15 offset:37120
    v_mfma_f32_16x16x32_bf16 v[64:67], a[164:167], v[24:27], v[64:67]
    s_waitcnt lgkmcnt(4)
    v_mfma_f32_16x16x32_bf16 v[52:55], a[168:171], v[28:31], v[52:55]
    s_waitcnt vmcnt(23)
    s_barrier
    ds_read_b128 v[20:23], v12 offset:49152
    v_mfma_f32_16x16x32_bf16 v[56:59], a[172:175], v[28:31], v[56:59]
    s_add_u32 s20, s20, 512
    v_mfma_f32_16x16x32_bf16 v[60:63], a[168:171], v[32:35], v[60:63]
    ds_read_b128 v[24:27], v12 offset:53248
    v_mfma_f32_16x16x32_bf16 v[64:67], a[172:175], v[32:35], v[64:67]
    s_waitcnt lgkmcnt(4)
    v_mfma_f32_16x16x32_bf16 v[52:55], a[176:179], v[36:39], v[52:55]
    ds_read_b128 v[28:31], v13 offset:49152
    s_add_u32 m0, s21, 16384
    v_mfma_f32_16x16x32_bf16 v[56:59], a[180:183], v[36:39], v[56:59]
    buffer_load_dwordx4 v8, s[8:11], s20 offen lds
    v_mfma_f32_16x16x32_bf16 v[60:63], a[176:179], v[40:43], v[60:63]
    ds_read_b128 v[32:35], v13 offset:53248
    v_mfma_f32_16x16x32_bf16 v[64:67], a[180:183], v[40:43], v[64:67]
    s_waitcnt lgkmcnt(4)
    v_mfma_f32_16x16x32_bf16 v[52:55], a[184:187], v[44:47], v[52:55]
    ds_read_b128 v[36:39], v14 offset:49152
    v_mfma_f32_16x16x32_bf16 v[56:59], a[188:191], v[44:47], v[56:59]
    v_mfma_f32_16x16x32_bf16 v[60:63], a[184:187], v[48:51], v[60:63]
    ds_read_b128 v[40:43], v14 offset:53248
    v_mfma_f32_16x16x32_bf16 v[64:67], a[188:191], v[48:51], v[64:67]
    s_waitcnt lgkmcnt(4)
    v_mfma_f32_16x16x32_bf16 v[52:55], a[192:195], v[20:23], v[52:55]
    ds_read_b128 v[44:47], v15 offset:49152
    s_add_u32 m0, s21, 17408
    v_mfma_f32_16x16x32_bf16 v[56:59], a[196:199], v[20:23], v[56:59]
    buffer_load_dwordx4 v9, s[8:11], s20 offen lds
    v_mfma_f32_16x16x32_bf16 v[60:63], a[192:195], v[24:27], v[60:63]
    ds_read_b128 v[48:51], v15 offset:53248
    v_mfma_f32_16x16x32_bf16 v[64:67], a[196:199], v[24:27], v[64:67]
    s_waitcnt lgkmcnt(4)
    v_mfma_f32_16x16x32_bf16 v[52:55], a[200:203], v[28:31], v[52:55]
    ds_read_b128 v[20:23], v12 offset:49408
    v_mfma_f32_16x16x32_bf16 v[56:59], a[204:207], v[28:31], v[56:59]
    v_mfma_f32_16x16x32_bf16 v[60:63], a[200:203], v[32:35], v[60:63]
    ds_read_b128 v[24:27], v12 offset:53504
    v_mfma_f32_16x16x32_bf16 v[64:67], a[204:207], v[32:35], v[64:67]
    s_waitcnt lgkmcnt(4)
    v_mfma_f32_16x16x32_bf16 v[52:55], a[208:211], v[36:39], v[52:55]
    ds_read_b128 v[28:31], v13 offset:49408
    s_add_u32 m0, s21, 18432
    v_mfma_f32_16x16x32_bf16 v[56:59], a[212:215], v[36:39], v[56:59]
    buffer_load_dwordx4 v10, s[8:11], s20 offen lds
    v_mfma_f32_16x16x32_bf16 v[60:63], a[208:211], v[40:43], v[60:63]
    ds_read_b128 v[32:35], v13 offset:53504
    v_mfma_f32_16x16x32_bf16 v[64:67], a[212:215], v[40:43], v[64:67]
    s_waitcnt lgkmcnt(4)
    v_mfma_f32_16x16x32_bf16 v[52:55], a[216:219], v[44:47], v[52:55]
    ds_read_b128 v[36:39], v14 offset:49408
    v_mfma_f32_16x16x32_bf16 v[56:59], a[220:223], v[44:47], v[56:59]
    v_mfma_f32_16x16x32_bf16 v[60:63], a[216:219], v[48:51], v[60:63]
    ds_read_b128 v[40:43], v14 offset:53504
    v_mfma_f32_16x16x32_bf16 v[64:67], a[220:223], v[48:51], v[64:67]
    s_waitcnt lgkmcnt(4)
    v_mfma_f32_16x16x32_bf16 v[52:55], a[224:227], v[20:23], v[52:55]
    ds_read_b128 v[44:47], v15 offset:49408
    s_add_u32 m0, s21, 19456
    v_mfma_f32_16x16x32_bf16 v[56:59], a[228:231], v[20:23], v[56:59]
    buffer_load_dwordx4 v11, s[8:11], s20 offen lds
    v_mfma_f32_16x16x32_bf16 v[60:63], a[224:227], v[24:27], v[60:63]
    ds_read_b128 v[48:51], v15 offset:53504
    v_mfma_f32_16x16x32_bf16 v[64:67], a[228:231], v[24:27], v[64:67]
    s_waitcnt lgkmcnt(4)
    v_mfma_f32_16x16x32_bf16 v[52:55], a[232:235], v[28:31], v[52:55]
    s_waitcnt vmcnt(23)
    s_barrier
    ds_read_b128 v[20:23], v16 offset:0
    v_mfma_f32_16x16x32_bf16 v[56:59], a[236:239], v[28:31], v[56:59]
    s_add_u32 s20, s20, 512
    v_mfma_f32_16x16x32_bf16 v[60:63], a[232:235], v[32:35], v[60:63]
    ds_read_b128 v[24:27], v16 offset:4096
    v_mfma_f32_16x16x32_bf16 v[64:67], a[236:239], v[32:35], v[64:67]
    s_waitcnt lgkmcnt(4)
    v_mfma_f32_16x16x32_bf16 v[52:55], a[240:243], v[36:39], v[52:55]
    ds_read_b128 v[28:31], v17 offset:0
    s_add_u32 m0, s21, 32768
    v_mfma_f32_16x16x32_bf16 v[56:59], a[244:247], v[36:39], v[56:59]
    buffer_load_dwordx4 v8, s[8:11], s20 offen lds
    v_mfma_f32_16x16x32_bf16 v[60:63], a[240:243], v[40:43], v[60:63]
    ds_read_b128 v[32:35], v17 offset:4096
    v_mfma_f32_16x16x32_bf16 v[64:67], a[244:247], v[40:43], v[64:67]
    s_waitcnt lgkmcnt(4)
    v_mfma_f32_16x16x32_bf16 v[52:55], a[248:251], v[44:47], v[52:55]
    ds_read_b128 v[36:39], v18 offset:0
    v_mfma_f32_16x16x32_bf16 v[56:59], a[252:255], v[44:47], v[56:59]
    v_mfma_f32_16x16x32_bf16 v[60:63], a[248:251], v[48:51], v[60:63]
    ds_read_b128 v[40:43], v18 offset:4096
    v_mfma_f32_16x16x32_bf16 v[64:67], a[252:255], v[48:51], v[64:67]
    s_waitcnt lgkmcnt(4)
    s_add_u32 s22, s22, 1
    s_cmp_ge_u32 s22, s23
    s_cbranch_scc1 L_fl0_456
    v_mfma_f32_16x16x32_bf16 v[68:71], a[0:3], v[20:23], 0
    ds_read_b128 v[44:47], v19 offset:0
    s_add_u32 m0, s21, 33792
    s_sub_u32 s39, s22, 1
    v_mfma_f32_16x16x32_bf16 v[72:75], a[4:7], v[20:23], 0
    buffer_load_dwordx4 v9, s[8:11], s20 offen lds
    v_mfma_f32_16x16x32_bf16 v[76:79], a[0:3], v[24:27], 0
    ds_read_b128 v[48:51], v19 offset:4096
    s_bitcmp1_b32 s39, 1
    s_cselect_b32 s38, s54, s55
    v_mfma_f32_16x16x32_bf16 v[80:83], a[4:7], v[24:27], 0
    s_waitcnt lgkmcnt(4)
    v_mfma_f32_16x16x32_bf16 v[68:71], a[8:11], v[28:31], v[68:71]
    ds_read_b128 v[20:23], v16 offset:256
    s_add_u32 s38, s38, s44
    v_mfma_f32_16x16x32_bf16 v[72:75], a[12:15], v[28:31], v[72:75]
    s_lshl_b32 s42, s39, 20
    s_add_u32 s38, s38, s42
    v_mfma_f32_16x16x32_bf16 v[76:79], a[8:11], v[32:35], v[76:79]
    ds_read_b128 v[24:27], v16 offset:4352
    s_cmp_eq_u32 s37, 0
    s_cselect_b32 s38, 0x7ff00000, s38
    v_mfma_f32_16x16x32_bf16 v[80:83], a[12:15], v[32:35], v[80:83]
    s_waitcnt lgkmcnt(4)
    v_mfma_f32_16x16x32_bf16 v[68:71], a[16:19], v[36:39], v[68:71]
    ds_read_b128 v[28:31], v17 offset:256
    s_add_u32 m0, s21, 34816
    v_mfma_f32_16x16x32_bf16 v[72:75], a[20:23], v[36:39], v[72:75]
    buffer_load_dwordx4 v10, s[8:11], s20 offen lds
    s_mov_b32 s37, 1
    v_mfma_f32_16x16x32_bf16 v[76:79], a[16:19], v[40:43], v[76:79]
    ds_read_b128 v[32:35], v17 offset:4352
    v_cvt_pk_bf16_f32 v88, v52, v53
    v_mfma_f32_16x16x32_bf16 v[80:83], a[20:23], v[40:43], v[80:83]
    s_waitcnt lgkmcnt(4)
    v_cvt_pk_bf16_f32 v89, v54, v55
    v_mfma_f32_16x16x32_bf16 v[68:71], a[24:27], v[44:47], v[68:71]
    ds_read_b128 v[36:39], v18 offset:256
    v_cvt_pk_bf16_f32 v90, v56, v57
    v_mfma_f32_16x16x32_bf16 v[72:75], a[28:31], v[44:47], v[72:75]
    v_cvt_pk_bf16_f32 v91, v58, v59
    v_mfma_f32_16x16x32_bf16 v[76:79], a[24:27], v[48:51], v[76:79]
    ds_read_b128 v[40:43], v18 offset:4352
    buffer_store_dwordx4 v[88:91], v86, s[12:15], s38 offen offset:0
    v_mfma_f32_16x16x32_bf16 v[80:83], a[28:31], v[48:51], v[80:83]
    s_waitcnt lgkmcnt(4)
    v_cvt_pk_bf16_f32 v92, v60, v61
    v_cvt_pk_bf16_f32 v93, v62, v63
    v_mfma_f32_16x16x32_bf16 v[68:71], a[32:35], v[20:23], v[68:71]
    ds_read_b128 v[44:47], v19 offset:256
    s_add_u32 m0, s21, 35840
    v_mfma_f32_16x16x32_bf16 v[72:75], a[36:39], v[20:23], v[72:75]
    buffer_load_dwordx4 v11, s[8:11], s20 offen lds
    v_cvt_pk_bf16_f32 v94, v64, v65
    v_mfma_f32_16x16x32_bf16 v[76:79], a[32:35], v[24:27], v[76:79]
    ds_read_b128 v[48:51], v19 offset:4352
    v_cvt_pk_bf16_f32 v95, v66, v67
    v_mfma_f32_16x16x32_bf16 v[80:83], a[36:39], v[24:27], v[80:83]
    s_waitcnt lgkmcnt(4)
    buffer_store_dwordx4 v[92:95], v86, s[12:15], s38 offen offset:128
    v_mfma_f32_16x16x32_bf16 v[68:71], a[40:43], v[28:31], v[68:71]
    s_waitcnt vmcnt(24)
    s_barrier
    ds_read_b128 v[20:23], v16 offset:16384
    v_mfma_f32_16x16x32_bf16 v[72:75], a[44:47], v[28:31], v[72:75]
    s_add_u32 s20, s20, 512
    v_mfma_f32_16x16x32_bf16 v[76:79], a[40:43], v[32:35], v[76:79]
    ds_read_b128 v[24:27], v16 offset:20480
    v_mfma_f32_16x16x32_bf16 v[80:83], a[44:47], v[32:35], v[80:83]
    s_waitcnt lgkmcnt(4)
    v_mfma_f32_16x16x32_bf16 v[68:71], a[48:51], v[36:39], v[68:71]
    ds_read_b128 v[28:31], v17 offset:16384
    s_add_u32 m0, s21, 49152
    v_mfma_f32_16x16x32_bf16 v[72:75], a[52:55], v[36:39], v[72:75]
    buffer_load_dwordx4 v8, s[8:11], s20 offen lds
    v_mfma_f32_16x16x32_bf16 v[76:79], a[48:51], v[40:43], v[76:79]
    ds_read_b128 v[32:35], v17 offset:20480
    v_mfma_f32_16x16x32_bf16 v[80:83], a[52:55], v[40:43], v[80:83]
    s_waitcnt lgkmcnt(4)
    v_mfma_f32_16x16x32_bf16 v[68:71], a[56:59], v[44:47], v[68:71]
    ds_read_b128 v[36:39], v18 offset:16384
    v_mfma_f32_16x16x32_bf16 v[72:75], a[60:63], v[44:47], v[72:75]
    v_mfma_f32_16x16x32_bf16 v[76:79], a[56:59], v[48:51], v[76:79]
    ds_read_b128 v[40:43], v18 offset:20480
    v_mfma_f32_16x16x32_bf16 v[80:83], a[60:63], v[48:51], v[80:83]
    s_waitcnt lgkmcnt(4)
    v_mfma_f32_16x16x32_bf16 v[68:71], a[64:67], v[20:23], v[68:71]
    ds_read_b128 v[44:47], v19 offset:16384
    s_add_u32 m0, s21, 50176
    v_mfma_f32_16x16x32_bf16 v[72:75], a[68:71], v[20:23], v[72:75]
    buffer_load_dwordx4 v9, s[8:11], s20 offen lds
    v_mfma_f32_16x16x32_bf16 v[76:79], a[64:67], v[24:27], v[76:79]
    ds_read_b128 v[48:51], v19 offset:20480
    v_mfma_f32_16x16x32_bf16 v[80:83], a[68:71], v[24:27], v[80:83]
    s_waitcnt lgkmcnt(4)
    v_mfma_f32_16x16x32_bf16 v[68:71], a[72:75], v[28:31], v[68:71]
    ds_read_b128 v[20:23], v16 offset:16640
    v_mfma_f32_16x16x32_bf16 v[72:75], a[76:79], v[28:31], v[72:75]
    v_mfma_f32_16x16x32_bf16 v[76:79], a[72:75], v[32:35], v[76:79]
    ds_read_b128 v[24:27], v16 offset:20736
    s_add_u32 s24, s24, 1
    v_mfma_f32_16x16x32_bf16 v[80:83], a[76:79], v[32:35], v[80:83]
    s_waitcnt lgkmcnt(4)
    v_mfma_f32_16x16x32_bf16 v[68:71], a[80:83], v[36:39], v[68:71]
    ds_read_b128 v[28:31], v17 offset:16640
    s_add_u32 m0, s21, 51200
    v_mfma_f32_16x16x32_bf16 v[72:75], a[84:87], v[36:39], v[72:75]
    buffer_load_dwordx4 v10, s[8:11], s20 offen lds
    v_mfma_f32_16x16x32_bf16 v[76:79], a[80:83], v[40:43], v[76:79]
    ds_read_b128 v[32:35], v17 offset:20736
    v_mfma_f32_16x16x32_bf16 v[80:83], a[84:87], v[40:43], v[80:83]
    s_waitcnt lgkmcnt(4)
    s_min_u32 s24, s24, 63
    v_mfma_f32_16x16x32_bf16 v[68:71], a[88:91], v[44:47], v[68:71]
    ds_read_b128 v[36:39], v18 offset:16640
    v_mfma_f32_16x16x32_bf16 v[72:75], a[92:95], v[44:47], v[72:75]
    v_mfma_f32_16x16x32_bf16 v[76:79], a[88:91], v[48:51], v[76:79]
    ds_read_b128 v[40:43], v18 offset:20736
    s_lshl_b32 s53, s24, 16
    v_mfma_f32_16x16x32_bf16 v[80:83], a[92:95], v[48:51], v[80:83]
    s_waitcnt lgkmcnt(4)
    v_mfma_f32_16x16x32_bf16 v[68:71], a[96:99], v[20:23], v[68:71]
    ds_read_b128 v[44:47], v19 offset:16640
    s_add_u32 m0, s21, 52224
    v_mfma_f32_16x16x32_bf16 v[72:75], a[100:103], v[20:23], v[72:75]
    buffer_load_dwordx4 v11, s[8:11], s20 offen lds
    v_mfma_f32_16x16x32_bf16 v[76:79], a[96:99], v[24:27], v[76:79]
    ds_read_b128 v[48:51], v19 offset:20736
    v_mfma_f32_16x16x32_bf16 v[80:83], a[100:103], v[24:27], v[80:83]
    s_waitcnt lgkmcnt(4)
    v_mfma_f32_16x16x32_bf16 v[68:71], a[104:107], v[28:31], v[68:71]
    s_waitcnt vmcnt(23)
    s_barrier
    ds_read_b128 v[20:23], v16 offset:32768
    v_mfma_f32_16x16x32_bf16 v[72:75], a[108:111], v[28:31], v[72:75]
    s_mov_b32 s20, s53
    v_mfma_f32_16x16x32_bf16 v[76:79], a[104:107], v[32:35], v[76:79]
    ds_read_b128 v[24:27], v16 offset:36864
    v_mfma_f32_16x16x32_bf16 v[80:83], a[108:111], v[32:35], v[80:83]
    s_waitcnt lgkmcnt(4)
    v_mfma_f32_16x16x32_bf16 v[68:71], a[112:115], v[36:39], v[68:71]
    ds_read_b128 v[28:31], v17 offset:32768
    s_add_u32 m0, s21, 65536
    v_mfma_f32_16x16x32_bf16 v[72:75], a[116:119], v[36:39], v[72:75]
    buffer_load_dwordx4 v8, s[8:11], s20 offen lds
    v_mfma_f32_16x16x32_bf16 v[76:79], a[112:115], v[40:43], v[76:79]
    ds_read_b128 v[32:35], v17 offset:36864
    v_mfma_f32_16x16x32_bf16 v[80:83], a[116:119], v[40:43], v[80:83]
    s_waitcnt lgkmcnt(4)
    v_mfma_f32_16x16x32_bf16 v[68:71], a[120:123], v[44:47], v[68:71]
    ds_read_b128 v[36:39], v18 offset:32768
    v_mfma_f32_16x16x32_bf16 v[72:75], a[124:127], v[44:47], v[72:75]
    v_mfma_f32_16x16x32_bf16 v[76:79], a[120:123], v[48:51], v[76:79]
    ds_read_b128 v[40:43], v18 offset:36864
    v_mfma_f32_16x16x32_bf16 v[80:83], a[124:127], v[48:51], v[80:83]
    s_waitcnt lgkmcnt(4)
    v_mfma_f32_16x16x32_bf16 v[68:71], a[128:131], v[20:23], v[68:71]
    ds_read_b128 v[44:47], v19 offset:32768
    s_add_u32 m0, s21, 66560
    v_mfma_f32_16x16x32_bf16 v[72:75], a[132:135], v[20:23], v[72:75]
    buffer_load_dwordx4 v9, s[8:11], s20 offen lds
    v_mfma_f32_16x16x32_bf16 v[76:79], a[128:131], v[24:27], v[76:79]
    ds_read_b128 v[48:51], v19 offset:36864
    v_mfma_f32_16x16x32_bf16 v[80:83], a[132:135], v[24:27], v[80:83]
    s_waitcnt lgkmcnt(4)
    v_mfma_f32_16x16x32_bf16 v[68:71], a[136:139], v[28:31], v[68:71]
    ds_read_b128 v[20:23], v16 offset:33024
    v_mfma_f32_16x16x32_bf16 v[72:75], a[140:143], v[28:31], v[72:75]
    v_mfma_f32_16x16x32_bf16 v[76:79], a[136:139], v[32:35], v[76:79]
    ds_read_b128 v[24:27], v16 offset:37120
    v_mfma_f32_16x16x32_bf16 v[80:83], a[140:143], v[32:35], v[80:83]
    s_waitcnt lgkmcnt(4)
    v_mfma_f32_16x16x32_bf16 v[68:71], a[144:147], v[36:39], v[68:71]
    ds_read_b128 v[28:31], v17 offset:33024
    s_add_u32 m0, s21, 67584
    v_mfma_f32_16x16x32_bf16 v[72:75], a[148:151], v[36:39], v[72:75]
    buffer_load_dwordx4 v10, s[8:11], s20 offen lds
    v_mfma_f32_16x16x32_bf16 v[76:79], a[144:147], v[40:43], v[76:79]
    ds_read_b128 v[32:35], v17 offset:37120
    v_mfma_f32_16x16x32_bf16 v[80:83], a[148:151], v[40:43], v[80:83]
    s_waitcnt lgkmcnt(4)
    v_mfma_f32_16x16x32_bf16 v[68:71], a[152:155], v[44:47], v[68:71]
    ds_read_b128 v[36:39], v18 offset:33024
    v_mfma_f32_16x16x32_bf16 v[72:75], a[156:159], v[44:47], v[72:75]
    v_mfma_f32_16x16x32_bf16 v[76:79], a[152:155], v[48:51], v[76:79]
    ds_read_b128 v[40:43], v18 offset:37120
    v_mfma_f32_16x16x32_bf16 v[80:83], a[156:159], v[48:51], v[80:83]
    s_waitcnt lgkmcnt(4)
    v_mfma_f32_16x16x32_bf16 v[68:71], a[160:163], v[20:23], v[68:71]
    ds_read_b128 v[44:47], v19 offset:33024
    s_add_u32 m0, s21, 68608
    v_mfma_f32_16x16x32_bf16 v[72:75], a[164:167], v[20:23], v[72:75]
    buffer_load_dwordx4 v11, s[8:11], s20 offen lds
    v_mfma_f32_16x16x32_bf16 v[76:79], a[160:163], v[24:27], v[76:79]
    ds_read_b128 v[48:51], v19 offset:37120
    v_mfma_f32_16x16x32_bf16 v[80:83], a[164:167], v[24:27], v[80:83]
    s_waitcnt lgkmcnt(4)
    v_mfma_f32_16x16x32_bf16 v[68:71], a[168:171], v[28:31], v[68:71]
    s_waitcnt vmcnt(22)
    s_barrier
    ds_read_b128 v[20:23], v16 offset:49152
    v_mfma_f32_16x16x32_bf16 v[72:75], a[172:175], v[28:31], v[72:75]
    s_add_u32 s20, s20, 512
    v_mfma_f32_16x16x32_bf16 v[76:79], a[168:171], v[32:35], v[76:79]
    ds_read_b128 v[24:27], v16 offset:53248
    v_mfma_f32_16x16x32_bf16 v[80:83], a[172:175], v[32:35], v[80:83]
    s_waitcnt lgkmcnt(4)
    v_mfma_f32_16x16x32_bf16 v[68:71], a[176:179], v[36:39], v[68:71]
    ds_read_b128 v[28:31], v17 offset:49152
    s_add_u32 m0, s21, 81920
    v_mfma_f32_16x16x32_bf16 v[72:75], a[180:183], v[36:39], v[72:75]
    buffer_load_dwordx4 v8, s[8:11], s20 offen lds
    v_mfma_f32_16x16x32_bf16 v[76:79], a[176:179], v[40:43], v[76:79]
    ds_read_b128 v[32:35], v17 offset:53248
    v_mfma_f32_16x16x32_bf16 v[80:83], a[180:183], v[40:43], v[80:83]
    s_waitcnt lgkmcnt(4)
    buffer_load_dword v87, v103, s[32:35], 0 offen sc1
    v_mfma_f32_16x16x32_bf16 v[68:71], a[184:187], v[44:47], v[68:71]
    ds_read_b128 v[36:39], v18 offset:49152
    v_mfma_f32_16x16x32_bf16 v[72:75], a[188:191], v[44:47], v[72:75]
    v_mfma_f32_16x16x32_bf16 v[76:79], a[184:187], v[48:51], v[76:79]
    ds_read_b128 v[40:43], v18 offset:53248
    v_mfma_f32_16x16x32_bf16 v[80:83], a[188:191], v[48:51], v[80:83]
    s_waitcnt lgkmcnt(4)
    v_mfma_f32_16x16x32_bf16 v[68:71], a[192:195], v[20:23], v[68:71]
    ds_read_b128 v[44:47], v19 offset:49152
    s_add_u32 m0, s21, 82944
    v_mfma_f32_16x16x32_bf16 v[72:75], a[196:199], v[20:23], v[72:75]
    buffer_load_dwordx4 v9, s[8:11], s20 offen lds
    v_mfma_f32_16x16x32_bf16 v[76:79], a[192:195], v[24:27], v[76:79]
    ds_read_b128 v[48:51], v19 offset:53248
    v_mfma_f32_16x16x32_bf16 v[80:83], a[196:199], v[24:27], v[80:83]
    s_waitcnt lgkmcnt(4)
    v_mfma_f32_16x16x32_bf16 v[68:71], a[200:203], v[28:31], v[68:71]
    ds_read_b128 v[20:23], v16 offset:49408
    v_mfma_f32_16x16x32_bf16 v[72:75], a[204:207], v[28:31], v[72:75]
    v_mfma_f32_16x16x32_bf16 v[76:79], a[200:203], v[32:35], v[76:79]
    ds_read_b128 v[24:27], v16 offset:53504
    v_mfma_f32_16x16x32_bf16 v[80:83], a[204:207], v[32:35], v[80:83]
    s_waitcnt lgkmcnt(4)
    v_mfma_f32_16x16x32_bf16 v[68:71], a[208:211], v[36:39], v[68:71]
    ds_read_b128 v[28:31], v17 offset:49408
    s_add_u32 m0, s21, 83968
    v_mfma_f32_16x16x32_bf16 v[72:75], a[212:215], v[36:39], v[72:75]
    buffer_load_dwordx4 v10, s[8:11], s20 offen lds
    v_mfma_f32_16x16x32_bf16 v[76:79], a[208:211], v[40:43], v[76:79]
    ds_read_b128 v[32:35], v17 offset:53504
    v_mfma_f32_16x16x32_bf16 v[80:83], a[212:215], v[40:43], v[80:83]
    s_waitcnt lgkmcnt(4)
    v_mfma_f32_16x16x32_bf16 v[68:71], a[216:219], v[44:47], v[68:71]
    ds_read_b128 v[36:39], v18 offset:49408
    v_mfma_f32_16x16x32_bf16 v[72:75], a[220:223], v[44:47], v[72:75]
    v_mfma_f32_16x16x32_bf16 v[76:79], a[216:219], v[48:51], v[76:79]
    ds_read_b128 v[40:43], v18 offset:53504
    v_mfma_f32_16x16x32_bf16 v[80:83], a[220:223], v[48:51], v[80:83]
    s_waitcnt lgkmcnt(4)
    v_mfma_f32_16x16x32_bf16 v[68:71], a[224:227], v[20:23], v[68:71]
    ds_read_b128 v[44:47], v19 offset:49408
    s_add_u32 m0, s21, 84992
    v_mfma_f32_16x16x32_bf16 v[72:75], a[228:231], v[20:23], v[72:75]
    buffer_load_dwordx4 v11, s[8:11], s20 offen lds
    v_mfma_f32_16x16x32_bf16 v[76:79], a[224:227], v[24:27], v[76:79]
    ds_read_b128 v[48:51], v19 offset:53504
    v_mfma_f32_16x16x32_bf16 v[80:83], a[228:231], v[24:27], v[80:83]
    s_waitcnt lgkmcnt(4)
    v_mfma_f32_16x16x32_bf16 v[68:71], a[232:235], v[28:31], v[68:71]
    s_waitcnt vmcnt(23)
    s_barrier
    ds_read_b128 v[20:23], v12 offset:0
    v_mfma_f32_16x16x32_bf16 v[72:75], a[236:239], v[28:31], v[72:75]
    s_add_u32 s20, s20, 512
    v_mfma_f32_16x16x32_bf16 v[76:79], a[232:235], v[32:35], v[76:79]
    ds_read_b128 v[24:27], v12 offset:4096
    v_mfma_f32_16x16x32_bf16 v[80:83], a[236:239], v[32:35], v[80:83]
    s_waitcnt lgkmcnt(4)
    v_mfma_f32_16x16x32_bf16 v[68:71], a[240:243], v[36:39], v[68:71]
    ds_read_b128 v[28:31], v13 offset:0
    s_add_u32 m0, s21, 98304
    v_mfma_f32_16x16x32_bf16 v[72:75], a[244:247], v[36:39], v[72:75]
    buffer_load_dwordx4 v8, s[8:11], s20 offen lds
    v_mfma_f32_16x16x32_bf16 v[76:79], a[240:243], v[40:43], v[76:79]
    ds_read_b128 v[32:35], v13 offset:4096
    v_mfma_f32_16x16x32_bf16 v[80:83], a[244:247], v[40:43], v[80:83]
    s_waitcnt lgkmcnt(4)
    v_mfma_f32_16x16x32_bf16 v[68:71], a[248:251], v[44:47], v[68:71]
    ds_read_b128 v[36:39], v14 offset:0
    v_mfma_f32_16x16x32_bf16 v[72:75], a[252:255], v[44:47], v[72:75]
    v_mfma_f32_16x16x32_bf16 v[76:79], a[248:251], v[48:51], v[76:79]
    ds_read_b128 v[40:43], v14 offset:4096
    v_mfma_f32_16x16x32_bf16 v[80:83], a[252:255], v[48:51], v[80:83]
    s_waitcnt lgkmcnt(4)
    s_add_u32 s22, s22, 1
    s_cmp_ge_u32 s22, s23
    s_cbranch_scc0 L_st_459
    s_branch L_fl1_457
L_st_460:
    v_mfma_f32_16x16x32_bf16 v[52:55], a[0:3], v[20:23], 0
    ds_read_b128 v[44:47], v15 offset:0
    s_add_u32 m0, s21, 99328
    s_sub_u32 s39, s22, 1
    v_mfma_f32_16x16x32_bf16 v[56:59], a[4:7], v[20:23], 0
    buffer_load_dwordx4 v9, s[8:11], s20 offen lds
    v_mfma_f32_16x16x32_bf16 v[60:63], a[0:3], v[24:27], 0
    ds_read_b128 v[48:51], v15 offset:4096
    s_bitcmp1_b32 s39, 1
    s_cselect_b32 s38, s54, s55
    v_mfma_f32_16x16x32_bf16 v[64:67], a[4:7], v[24:27], 0
    s_waitcnt lgkmcnt(4)
    v_mfma_f32_16x16x32_bf16 v[52:55], a[8:11], v[28:31], v[52:55]
    ds_read_b128 v[20:23], v12 offset:256
    s_add_u32 s38, s38, s44
    s_waitcnt vmcnt(5)
    v_mfma_f32_16x16x32_bf16 v[56:59], a[12:15], v[28:31], v[56:59]
    s_lshl_b32 s42, s39, 20
    s_add_u32 s38, s38, s42
    ds_write_b32 v101, v87
    v_mfma_f32_16x16x32_bf16 v[60:63], a[8:11], v[32:35], v[60:63]
    ds_read_b128 v[24:27], v12 offset:4352
    s_cmp_eq_u32 s37, 0
    s_cselect_b32 s38, 0x7ff00000, s38
    v_mfma_f32_16x16x32_bf16 v[64:67], a[12:15], v[32:35], v[64:67]
    s_waitcnt lgkmcnt(4)
    v_mfma_f32_16x16x32_bf16 v[52:55], a[16:19], v[36:39], v[52:55]
    ds_read_b128 v[28:31], v13 offset:256
    s_add_u32 m0, s21, 100352
    v_mfma_f32_16x16x32_bf16 v[56:59], a[20:23], v[36:39], v[56:59]
    buffer_load_dwordx4 v10, s[8:11], s20 offen lds
    s_mov_b32 s37, 1
    v_mfma_f32_16x16x32_bf16 v[60:63], a[16:19], v[40:43], v[60:63]
    ds_read_b128 v[32:35], v13 offset:4352
    v_cvt_pk_bf16_f32 v88, v68, v69
    v_mfma_f32_16x16x32_bf16 v[64:67], a[20:23], v[40:43], v[64:67]
    s_waitcnt lgkmcnt(4)
    v_cvt_pk_bf16_f32 v89, v70, v71
    v_mfma_f32_16x16x32_bf16 v[52:55], a[24:27], v[44:47], v[52:55]
    ds_read_b128 v[36:39], v14 offset:256
    v_cvt_pk_bf16_f32 v90, v72, v73
    v_mfma_f32_16x16x32_bf16 v[56:59], a[28:31], v[44:47], v[56:59]
    v_cvt_pk_bf16_f32 v91, v74, v75
    v_mfma_f32_16x16x32_bf16 v[60:63], a[24:27], v[48:51], v[60:63]
    ds_read_b128 v[40:43], v14 offset:4352
    buffer_store_dwordx4 v[88:91], v86, s[12:15], s38 offen offset:0
    v_mfma_f32_16x16x32_bf16 v[64:67], a[28:31], v[48:51], v[64:67]
    s_waitcnt lgkmcnt(4)
    v_cvt_pk_bf16_f32 v92, v76, v77
    v_cvt_pk_bf16_f32 v93, v78, v79
    v_mfma_f32_16x16x32_bf16 v[52:55], a[32:35], v[20:23], v[52:55]
    ds_read_b128 v[44:47], v15 offset:256
    s_add_u32 m0, s21, 101376
    v_mfma_f32_16x16x32_bf16 v[56:59], a[36:39], v[20:23], v[56:59]
    buffer_load_dwordx4 v11, s[8:11], s20 offen lds
    v_cvt_pk_bf16_f32 v94, v80, v81
    v_mfma_f32_16x16x32_bf16 v[60:63], a[32:35], v[24:27], v[60:63]
    ds_read_b128 v[48:51], v15 offset:4352
    v_cvt_pk_bf16_f32 v95, v82, v83
    v_mfma_f32_16x16x32_bf16 v[64:67], a[36:39], v[24:27], v[64:67]
    s_waitcnt lgkmcnt(4)
    buffer_store_dwordx4 v[92:95], v86, s[12:15], s38 offen offset:128
    v_mfma_f32_16x16x32_bf16 v[52:55], a[40:43], v[28:31], v[52:55]
    s_waitcnt vmcnt(40)
    s_barrier
    ds_read_b128 v[20:23], v12 offset:16384
    v_mfma_f32_16x16x32_bf16 v[56:59], a[44:47], v[28:31], v[56:59]
    s_add_u32 s20, s20, 512
    v_mfma_f32_16x16x32_bf16 v[60:63], a[40:43], v[32:35], v[60:63]
    ds_read_b128 v[24:27], v12 offset:20480
    ds_read_b32 v87, v102
    v_mfma_f32_16x16x32_bf16 v[64:67], a[44:47], v[32:35], v[64:67]
    s_waitcnt lgkmcnt(4)
    v_mfma_f32_16x16x32_bf16 v[52:55], a[48:51], v[36:39], v[52:55]
    ds_read_b128 v[28:31], v13 offset:16384
    s_add_u32 m0, s21, 114688
    v_mfma_f32_16x16x32_bf16 v[56:59], a[52:55], v[36:39], v[56:59]
    buffer_load_dwordx4 v8, s[8:11], s20 offen lds
    v_mfma_f32_16x16x32_bf16 v[60:63], a[48:51], v[40:43], v[60:63]
    ds_read_b128 v[32:35], v13 offset:20480
    v_mfma_f32_16x16x32_bf16 v[64:67], a[52:55], v[40:43], v[64:67]
    s_waitcnt lgkmcnt(4)
    v_mfma_f32_16x16x32_bf16 v[52:55], a[56:59], v[44:47], v[52:55]
    ds_read_b128 v[36:39], v14 offset:16384
    v_mfma_f32_16x16x32_bf16 v[56:59], a[60:63], v[44:47], v[56:59]
    v_mfma_f32_16x16x32_bf16 v[60:63], a[56:59], v[48:51], v[60:63]
    ds_read_b128 v[40:43], v14 offset:20480
    v_mfma_f32_16x16x32_bf16 v[64:67], a[60:63], v[48:51], v[64:67]
    s_waitcnt lgkmcnt(4)
    v_mfma_f32_16x16x32_bf16 v[52:55], a[64:67], v[20:23], v[52:55]
    ds_read_b128 v[44:47], v15 offset:16384
    s_add_u32 m0, s21, 115712
    v_mfma_f32_16x16x32_bf16 v[56:59], a[68:71], v[20:23], v[56:59]
    buffer_load_dwordx4 v9, s[8:11], s20 offen lds
    v_mfma_f32_16x16x32_bf16 v[60:63], a[64:67], v[24:27], v[60:63]
    ds_read_b128 v[48:51], v15 offset:20480
    s_waitcnt vmcnt(13)
    s_branch L_att_450
L_attr_453:
    v_mfma_f32_16x16x32_bf16 v[64:67], a[68:71], v[24:27], v[64:67]
    s_waitcnt lgkmcnt(4)
    s_add_u32 s43, s50, 0
    buffer_load_dwordx4 v[136:139], v96, s[12:15], s43 offen offset:0
    v_mfma_f32_16x16x32_bf16 v[52:55], a[72:75], v[28:31], v[52:55]
    ds_read_b128 v[20:23], v12 offset:16640
    v_mfma_f32_16x16x32_bf16 v[56:59], a[76:79], v[28:31], v[56:59]
    v_mfma_f32_16x16x32_bf16 v[60:63], a[72:75], v[32:35], v[60:63]
    ds_read_b128 v[24:27], v12 offset:20736
    s_add_u32 s24, s24, 1
    v_mfma_f32_16x16x32_bf16 v[64:67], a[76:79], v[32:35], v[64:67]
    s_waitcnt lgkmcnt(4)
    v_mfma_f32_16x16x32_bf16 v[52:55], a[80:83], v[36:39], v[52:55]
    ds_read_b128 v[28:31], v13 offset:16640
    s_add_u32 m0, s21, 116736
    v_mfma_f32_16x16x32_bf16 v[56:59], a[84:87], v[36:39], v[56:59]
    buffer_load_dwordx4 v10, s[8:11], s20 offen lds
    v_mfma_f32_16x16x32_bf16 v[60:63], a[80:83], v[40:43], v[60:63]
    ds_read_b128 v[32:35], v13 offset:20736
    v_mfma_f32_16x16x32_bf16 v[64:67], a[84:87], v[40:43], v[64:67]
    s_waitcnt lgkmcnt(4)
    s_add_u32 s43, s50, 0
    buffer_load_dwordx4 v[140:143], v96, s[12:15], s43 offen offset:1024
    v_mfma_f32_16x16x32_bf16 v[52:55], a[88:91], v[44:47], v[52:55]
    ds_read_b128 v[36:39], v14 offset:16640
    s_min_u32 s24, s24, 63
    v_mfma_f32_16x16x32_bf16 v[56:59], a[92:95], v[44:47], v[56:59]
    v_mfma_f32_16x16x32_bf16 v[60:63], a[88:91], v[48:51], v[60:63]
    ds_read_b128 v[40:43], v14 offset:20736
    s_add_u32 s43, s48, 0
    buffer_load_dwordx4 v[104:107], v96, s[12:15], s43 offen offset:0
    v_mfma_f32_16x16x32_bf16 v[64:67], a[92:95], v[48:51], v[64:67]
    s_waitcnt lgkmcnt(4)
    s_lshl_b32 s53, s24, 16
    v_mfma_f32_16x16x32_bf16 v[52:55], a[96:99], v[20:23], v[52:55]
    ds_read_b128 v[44:47], v15 offset:16640
    s_add_u32 m0, s21, 117760
    v_mfma_f32_16x16x32_bf16 v[56:59], a[100:103], v[20:23], v[56:59]
    buffer_load_dwordx4 v11, s[8:11], s20 offen lds
    v_mfma_f32_16x16x32_bf16 v[60:63], a[96:99], v[24:27], v[60:63]
    ds_read_b128 v[48:51], v15 offset:20736
    v_mfma_f32_16x16x32_bf16 v[64:67], a[100:103], v[24:27], v[64:67]
    s_waitcnt lgkmcnt(4)
    v_mfma_f32_16x16x32_bf16 v[52:55], a[104:107], v[28:31], v[52:55]
    s_waitcnt vmcnt(27)
    s_barrier
    ds_read_b128 v[20:23], v12 offset:32768
    v_mfma_f32_16x16x32_bf16 v[56:59], a[108:111], v[28:31], v[56:59]
    s_mov_b32 s20, s53
    v_mfma_f32_16x16x32_bf16 v[60:63], a[104:107], v[32:35], v[60:63]
    ds_read_b128 v[24:27], v12 offset:36864
    s_add_u32 s43, s48, 0
    buffer_load_dwordx4 v[108:111], v96, s[12:15], s43 offen offset:1024
    v_mfma_f32_16x16x32_bf16 v[64:67], a[108:111], v[32:35], v[64:67]
    s_waitcnt lgkmcnt(4)
    v_mfma_f32_16x16x32_bf16 v[52:55], a[112:115], v[36:39], v[52:55]
    ds_read_b128 v[28:31], v13 offset:32768
    s_add_u32 m0, s21, 0
    v_mfma_f32_16x16x32_bf16 v[56:59], a[116:119], v[36:39], v[56:59]
    buffer_load_dwordx4 v8, s[8:11], s20 offen lds
    v_mfma_f32_16x16x32_bf16 v[60:63], a[112:115], v[40:43], v[60:63]
    ds_read_b128 v[32:35], v13 offset:36864
    v_mfma_f32_16x16x32_bf16 v[64:67], a[116:119], v[40:43], v[64:67]
    s_waitcnt lgkmcnt(4)
    s_add_u32 s43, s50, 4096
    buffer_load_dwordx4 v[144:147], v96, s[12:15], s43 offen offset:0
    v_mfma_f32_16x16x32_bf16 v[52:55], a[120:123], v[44:47], v[52:55]
    ds_read_b128 v[36:39], v14 offset:32768
    v_mfma_f32_16x16x32_bf16 v[56:59], a[124:127], v[44:47], v[56:59]
    v_mfma_f32_16x16x32_bf16 v[60:63], a[120:123], v[48:51], v[60:63]
    ds_read_b128 v[40:43], v14 offset:36864
    v_mfma_f32_16x16x32_bf16 v[64:67], a[124:127], v[48:51], v[64:67]
    s_waitcnt lgkmcnt(4)
    v_mfma_f32_16x16x32_bf16 v[52:55], a[128:131], v[20:23], v[52:55]
    ds_read_b128 v[44:47], v15 offset:32768
    s_add_u32 m0, s21, 1024
    v_mfma_f32_16x16x32_bf16 v[56:59], a[132:135], v[20:23], v[56:59]
    buffer_load_dwordx4 v9, s[8:11], s20 offen lds
    v_mfma_f32_16x16x32_bf16 v[60:63], a[128:131], v[24:27], v[60:63]
    ds_read_b128 v[48:51], v15 offset:36864
    v_mfma_f32_16x16x32_bf16 v[64:67], a[132:135], v[24:27], v[64:67]
    s_waitcnt lgkmcnt(4)
    s_add_u32 s43, s50, 4096
    buffer_load_dwordx4 v[148:151], v96, s[12:15], s43 offen offset:1024
    v_mfma_f32_16x16x32_bf16 v[52:55], a[136:139], v[28:31], v[52:55]
    ds_read_b128 v[20:23], v12 offset:33024
    v_mfma_f32_16x16x32_bf16 v[56:59], a[140:143], v[28:31], v[56:59]
    v_mfma_f32_16x16x32_bf16 v[60:63], a[136:139], v[32:35], v[60:63]
    ds_read_b128 v[24:27], v12 offset:37120
    s_add_u32 s43, s48, 4096
    buffer_load_dwordx4 v[112:115], v96, s[12:15], s43 offen offset:0
    v_mfma_f32_16x16x32_bf16 v[64:67], a[140:143], v[32:35], v[64:67]
    s_waitcnt lgkmcnt(4)
    v_mfma_f32_16x16x32_bf16 v[52:55], a[144:147], v[36:39], v[52:55]
    ds_read_b128 v[28:31], v13 offset:33024
    s_add_u32 m0, s21, 2048
    v_mfma_f32_16x16x32_bf16 v[56:59], a[148:151], v[36:39], v[56:59]
    buffer_load_dwordx4 v10, s[8:11], s20 offen lds
    v_mfma_f32_16x16x32_bf16 v[60:63], a[144:147], v[40:43], v[60:63]
    ds_read_b128 v[32:35], v13 offset:37120
    v_mfma_f32_16x16x32_bf16 v[64:67], a[148:151], v[40:43], v[64:67]
    s_waitcnt lgkmcnt(4)
    v_mfma_f32_16x16x32_bf16 v[52:55], a[152:155], v[44:47], v[52:55]
    ds_read_b128 v[36:39], v14 offset:33024
    v_mfma_f32_16x16x32_bf16 v[56:59], a[156:159], v[44:47], v[56:59]
    v_mfma_f32_16x16x32_bf16 v[60:63], a[152:155], v[48:51], v[60:63]
    ds_read_b128 v[40:43], v14 offset:37120
    s_add_u32 s43, s48, 4096
    buffer_load_dwordx4 v[116:119], v96, s[12:15], s43 offen offset:1024
    v_mfma_f32_16x16x32_bf16 v[64:67], a[156:159], v[48:51], v[64:67]
    s_waitcnt lgkmcnt(4)
    v_mfma_f32_16x16x32_bf16 v[52:55], a[160:163], v[20:23], v[52:55]
    ds_read_b128 v[44:47], v15 offset:33024
    s_add_u32 m0, s21, 3072
    v_mfma_f32_16x16x32_bf16 v[56:59], a[164:167], v[20:23], v[56:59]
    buffer_load_dwordx4 v11, s[8:11], s20 offen lds
    v_mfma_f32_16x16x32_bf16 v[60:63], a[160:163], v[24:27], v[60:63]
    ds_read_b128 v[48:51], v15 offset:37120
    v_mfma_f32_16x16x32_bf16 v[64:67], a[164:167], v[24:27], v[64:67]
    s_waitcnt lgkmcnt(4)
    s_add_u32 s43, s50, 16384
    buffer_load_dwordx4 v[152:155], v96, s[12:15], s43 offen offset:0
    v_mfma_f32_16x16x32_bf16 v[52:55], a[168:171], v[28:31], v[52:55]
    s_waitcnt vmcnt(32)
    s_barrier
    ds_read_b128 v[20:23], v12 offset:49152
    v_mfma_f32_16x16x32_bf16 v[56:59], a[172:175], v[28:31], v[56:59]
    s_add_u32 s20, s20, 512
    v_mfma_f32_16x16x32_bf16 v[60:63], a[168:171], v[32:35], v[60:63]
    ds_read_b128 v[24:27], v12 offset:53248
    v_mfma_f32_16x16x32_bf16 v[64:67], a[172:175], v[32:35], v[64:67]
    s_waitcnt lgkmcnt(4)
    v_mfma_f32_16x16x32_bf16 v[52:55], a[176:179], v[36:39], v[52:55]
    ds_read_b128 v[28:31], v13 offset:49152
    s_add_u32 m0, s21, 16384
    v_mfma_f32_16x16x32_bf16 v[56:59], a[180:183], v[36:39], v[56:59]
    buffer_load_dwordx4 v8, s[8:11], s20 offen lds
    v_mfma_f32_16x16x32_bf16 v[60:63], a[176:179], v[40:43], v[60:63]
    ds_read_b128 v[32:35], v13 offset:53248
    v_mfma_f32_16x16x32_bf16 v[64:67], a[180:183], v[40:43], v[64:67]
    s_waitcnt lgkmcnt(4)
    s_add_u32 s43, s50, 16384
    buffer_load_dwordx4 v[156:159], v96, s[12:15], s43 offen offset:1024
    v_mfma_f32_16x16x32_bf16 v[52:55], a[184:187], v[44:47], v[52:55]
    ds_read_b128 v[36:39], v14 offset:49152
    v_mfma_f32_16x16x32_bf16 v[56:59], a[188:191], v[44:47], v[56:59]
    v_mfma_f32_16x16x32_bf16 v[60:63], a[184:187], v[48:51], v[60:63]
    ds_read_b128 v[40:43], v14 offset:53248
    s_add_u32 s43, s48, 16384
    buffer_load_dwordx4 v[120:123], v96, s[12:15], s43 offen offset:0
    v_mfma_f32_16x16x32_bf16 v[64:67], a[188:191], v[48:51], v[64:67]
    s_waitcnt lgkmcnt(4)
    v_mfma_f32_16x16x32_bf16 v[52:55], a[192:195], v[20:23], v[52:55]
    ds_read_b128 v[44:47], v15 offset:49152
    s_add_u32 m0, s21, 17408
    v_mfma_f32_16x16x32_bf16 v[56:59], a[196:199], v[20:23], v[56:59]
    buffer_load_dwordx4 v9, s[8:11], s20 offen lds
    v_mfma_f32_16x16x32_bf16 v[60:63], a[192:195], v[24:27], v[60:63]
    ds_read_b128 v[48:51], v15 offset:53248
    v_mfma_f32_16x16x32_bf16 v[64:67], a[196:199], v[24:27], v[64:67]
    s_waitcnt lgkmcnt(4)
    v_mfma_f32_16x16x32_bf16 v[52:55], a[200:203], v[28:31], v[52:55]
    ds_read_b128 v[20:23], v12 offset:49408
    v_mfma_f32_16x16x32_bf16 v[56:59], a[204:207], v[28:31], v[56:59]
    v_mfma_f32_16x16x32_bf16 v[60:63], a[200:203], v[32:35], v[60:63]
    ds_read_b128 v[24:27], v12 offset:53504
    s_add_u32 s43, s48, 16384
    buffer_load_dwordx4 v[124:127], v96, s[12:15], s43 offen offset:1024
    v_mfma_f32_16x16x32_bf16 v[64:67], a[204:207], v[32:35], v[64:67]
    s_waitcnt lgkmcnt(4)
    v_mfma_f32_16x16x32_bf16 v[52:55], a[208:211], v[36:39], v[52:55]
    ds_read_b128 v[28:31], v13 offset:49408
    s_add_u32 m0, s21, 18432
    v_mfma_f32_16x16x32_bf16 v[56:59], a[212:215], v[36:39], v[56:59]
    buffer_load_dwordx4 v10, s[8:11], s20 offen lds
    v_mfma_f32_16x16x32_bf16 v[60:63], a[208:211], v[40:43], v[60:63]
    ds_read_b128 v[32:35], v13 offset:53504
    v_mfma_f32_16x16x32_bf16 v[64:67], a[212:215], v[40:43], v[64:67]
    s_waitcnt lgkmcnt(4)
    s_add_u32 s43, s50, 20480
    buffer_load_dwordx4 v[160:163], v96, s[12:15], s43 offen offset:0
    v_mfma_f32_16x16x32_bf16 v[52:55], a[216:219], v[44:47], v[52:55]
    ds_read_b128 v[36:39], v14 offset:49408
    v_mfma_f32_16x16x32_bf16 v[56:59], a[220:223], v[44:47], v[56:59]
    v_mfma_f32_16x16x32_bf16 v[60:63], a[216:219], v[48:51], v[60:63]
    ds_read_b128 v[40:43], v14 offset:53504
    v_mfma_f32_16x16x32_bf16 v[64:67], a[220:223], v[48:51], v[64:67]
    s_waitcnt lgkmcnt(4)
    v_mfma_f32_16x16x32_bf16 v[52:55], a[224:227], v[20:23], v[52:55]
    ds_read_b128 v[44:47], v15 offset:49408
    s_add_u32 m0, s21, 19456
    v_mfma_f32_16x16x32_bf16 v[56:59], a[228:231], v[20:23], v[56:59]
    buffer_load_dwordx4 v11, s[8:11], s20 offen lds
    v_mfma_f32_16x16x32_bf16 v[60:63], a[224:227], v[24:27], v[60:63]
    ds_read_b128 v[48:51], v15 offset:53504
    v_mfma_f32_16x16x32_bf16 v[64:67], a[228:231], v[24:27], v[64:67]
    s_waitcnt lgkmcnt(4)
    s_add_u32 s43, s50, 20480
    buffer_load_dwordx4 v[164:167], v96, s[12:15], s43 offen offset:1024
    v_mfma_f32_16x16x32_bf16 v[52:55], a[232:235], v[28:31], v[52:55]
    s_waitcnt vmcnt(37)
    s_barrier
    ds_read_b128 v[20:23], v16 offset:0
    v_mfma_f32_16x16x32_bf16 v[56:59], a[236:239], v[28:31], v[56:59]
    s_add_u32 s20, s20, 512
    v_mfma_f32_16x16x32_bf16 v[60:63], a[232:235], v[32:35], v[60:63]
    ds_read_b128 v[24:27], v16 offset:4096
    s_add_u32 s43, s48, 20480
    buffer_load_dwordx4 v[128:131], v96, s[12:15], s43 offen offset:0
    v_mfma_f32_16x16x32_bf16 v[64:67], a[236:239], v[32:35], v[64:67]
    s_waitcnt lgkmcnt(4)
    v_mfma_f32_16x16x32_bf16 v[52:55], a[240:243], v[36:39], v[52:55]
    ds_read_b128 v[28:31], v17 offset:0
    s_add_u32 m0, s21, 32768
    v_mfma_f32_16x16x32_bf16 v[56:59], a[244:247], v[36:39], v[56:59]
    buffer_load_dwordx4 v8, s[8:11], s20 offen lds
    v_mfma_f32_16x16x32_bf16 v[60:63], a[240:243], v[40:43], v[60:63]
    ds_read_b128 v[32:35], v17 offset:4096
    v_mfma_f32_16x16x32_bf16 v[64:67], a[244:247], v[40:43], v[64:67]
    s_waitcnt lgkmcnt(4)
    v_mfma_f32_16x16x32_bf16 v[52:55], a[248:251], v[44:47], v[52:55]
    ds_read_b128 v[36:39], v18 offset:0
    v_mfma_f32_16x16x32_bf16 v[56:59], a[252:255], v[44:47], v[56:59]
    v_mfma_f32_16x16x32_bf16 v[60:63], a[248:251], v[48:51], v[60:63]
    ds_read_b128 v[40:43], v18 offset:4096
    v_mfma_f32_16x16x32_bf16 v[64:67], a[252:255], v[48:51], v[64:67]
    s_waitcnt lgkmcnt(4)
    s_add_u32 s22, s22, 1
    s_cmp_ge_u32 s22, s23
    s_cbranch_scc1 L_fl0_456
    v_mfma_f32_16x16x32_bf16 v[68:71], a[0:3], v[20:23], 0
    ds_read_b128 v[44:47], v19 offset:0
    s_add_u32 m0, s21, 33792
    s_sub_u32 s39, s22, 1
    v_mfma_f32_16x16x32_bf16 v[72:75], a[4:7], v[20:23], 0
    buffer_load_dwordx4 v9, s[8:11], s20 offen lds
    s_bitcmp1_b32 s39, 1
    s_cselect_b32 s38, s54, s55
    v_mfma_f32_16x16x32_bf16 v[76:79], a[0:3], v[24:27], 0
    ds_read_b128 v[48:51], v19 offset:4096
    v_mfma_f32_16x16x32_bf16 v[80:83], a[4:7], v[24:27], 0
    s_waitcnt lgkmcnt(4)
    s_add_u32 s43, s48, 20480
    buffer_load_dwordx4 v[132:135], v96, s[12:15], s43 offen offset:1024
    v_mfma_f32_16x16x32_bf16 v[68:71], a[8:11], v[28:31], v[68:71]
    ds_read_b128 v[20:23], v16 offset:256
    s_add_u32 s38, s38, s44
    v_mfma_f32_16x16x32_bf16 v[72:75], a[12:15], v[28:31], v[72:75]
    s_lshl_b32 s42, s39, 20
    s_add_u32 s38, s38, s42
    v_mfma_f32_16x16x32_bf16 v[76:79], a[8:11], v[32:35], v[76:79]
    ds_read_b128 v[24:27], v16 offset:4352
    s_add_u32 s43, s48, 0
    buffer_load_dwordx4 v[168:171], v98, s[12:15], s43 offen offset:2048
    v_mfma_f32_16x16x32_bf16 v[80:83], a[12:15], v[32:35], v[80:83]
    s_waitcnt lgkmcnt(4)
    s_cmp_eq_u32 s37, 0
    s_cselect_b32 s38, 0x7ff00000, s38
    v_mfma_f32_16x16x32_bf16 v[68:71], a[16:19], v[36:39], v[68:71]
    ds_read_b128 v[28:31], v17 offset:256
    s_add_u32 m0, s21, 34816
    v_mfma_f32_16x16x32_bf16 v[72:75], a[20:23], v[36:39], v[72:75]
    buffer_load_dwordx4 v10, s[8:11], s20 offen lds
    s_mov_b32 s37, 1
    v_mfma_f32_16x16x32_bf16 v[76:79], a[16:19], v[40:43], v[76:79]
    ds_read_b128 v[32:35], v17 offset:4352
    v_cvt_pk_bf16_f32 v88, v52, v53
    v_mfma_f32_16x16x32_bf16 v[80:83], a[20:23], v[40:43], v[80:83]
    s_waitcnt lgkmcnt(4)
    s_add_u32 s43, s48, 0
    buffer_load_dwordx4 v[172:175], v98, s[12:15], s43 offen offset:3072
    v_mfma_f32_16x16x32_bf16 v[68:71], a[24:27], v[44:47], v[68:71]
    ds_read_b128 v[36:39], v18 offset:256
    v_cvt_pk_bf16_f32 v89, v54, v55
    v_cvt_pk_bf16_f32 v90, v56, v57
    v_mfma_f32_16x16x32_bf16 v[72:75], a[28:31], v[44:47], v[72:75]
    v_cvt_pk_bf16_f32 v91, v58, v59
    v_mfma_f32_16x16x32_bf16 v[76:79], a[24:27], v[48:51], v[76:79]
    ds_read_b128 v[40:43], v18 offset:4352
    buffer_store_dwordx4 v[88:91], v86, s[12:15], s38 offen offset:0
    v_mfma_f32_16x16x32_bf16 v[80:83], a[28:31], v[48:51], v[80:83]
    s_waitcnt lgkmcnt(4)
    v_cvt_pk_bf16_f32 v92, v60, v61
    v_cvt_pk_bf16_f32 v93, v62, v63
    v_mfma_f32_16x16x32_bf16 v[68:71], a[32:35], v[20:23], v[68:71]
    ds_read_b128 v[44:47], v19 offset:256
    s_add_u32 m0, s21, 35840
    v_mfma_f32_16x16x32_bf16 v[72:75], a[36:39], v[20:23], v[72:75]
    buffer_load_dwordx4 v11, s[8:11], s20 offen lds
    v_cvt_pk_bf16_f32 v94, v64, v65
    v_mfma_f32_16x16x32_bf16 v[76:79], a[32:35], v[24:27], v[76:79]
    ds_read_b128 v[48:51], v19 offset:4352
    v_cvt_pk_bf16_f32 v95, v66, v67
    v_mfma_f32_16x16x32_bf16 v[80:83], a[36:39], v[24:27], v[80:83]
    s_waitcnt lgkmcnt(4)
    buffer_store_dwordx4 v[92:95], v86, s[12:15], s38 offen offset:128
    v_mfma_f32_16x16x32_bf16 v[68:71], a[40:43], v[28:31], v[68:71]
    s_waitcnt vmcnt(42)
    s_barrier
    ds_read_b128 v[20:23], v16 offset:16384
    v_mfma_f32_16x16x32_bf16 v[72:75], a[44:47], v[28:31], v[72:75]
    s_add_u32 s20, s20, 512
    v_mfma_f32_16x16x32_bf16 v[76:79], a[40:43], v[32:35], v[76:79]
    ds_read_b128 v[24:27], v16 offset:20480
    s_add_u32 s43, s48, 4096
    buffer_load_dwordx4 v[176:179], v98, s[12:15], s43 offen offset:2048
    v_mfma_f32_16x16x32_bf16 v[80:83], a[44:47], v[32:35], v[80:83]
    s_waitcnt lgkmcnt(4)
    v_mfma_f32_16x16x32_bf16 v[68:71], a[48:51], v[36:39], v[68:71]
    ds_read_b128 v[28:31], v17 offset:16384
    s_add_u32 m0, s21, 49152
    v_mfma_f32_16x16x32_bf16 v[72:75], a[52:55], v[36:39], v[72:75]
    buffer_load_dwordx4 v8, s[8:11], s20 offen lds
    v_mfma_f32_16x16x32_bf16 v[76:79], a[48:51], v[40:43], v[76:79]
    ds_read_b128 v[32:35], v17 offset:20480
    v_mfma_f32_16x16x32_bf16 v[80:83], a[52:55], v[40:43], v[80:83]
    s_waitcnt lgkmcnt(4)
    s_add_u32 s43, s48, 4096
    buffer_load_dwordx4 v[180:183], v98, s[12:15], s43 offen offset:3072
    v_mfma_f32_16x16x32_bf16 v[68:71], a[56:59], v[44:47], v[68:71]
    ds_read_b128 v[36:39], v18 offset:16384
    v_mfma_f32_16x16x32_bf16 v[72:75], a[60:63], v[44:47], v[72:75]
    v_mfma_f32_16x16x32_bf16 v[76:79], a[56:59], v[48:51], v[76:79]
    ds_read_b128 v[40:43], v18 offset:20480
    s_add_u32 s43, s48, 16384
    buffer_load_dwordx4 v[184:187], v98, s[12:15], s43 offen offset:2048
    v_mfma_f32_16x16x32_bf16 v[80:83], a[60:63], v[48:51], v[80:83]
    s_waitcnt lgkmcnt(4)
    v_mfma_f32_16x16x32_bf16 v[68:71], a[64:67], v[20:23], v[68:71]
    ds_read_b128 v[44:47], v19 offset:16384
    s_add_u32 m0, s21, 50176
    v_mfma_f32_16x16x32_bf16 v[72:75], a[68:71], v[20:23], v[72:75]
    buffer_load_dwordx4 v9, s[8:11], s20 offen lds
    v_mfma_f32_16x16x32_bf16 v[76:79], a[64:67], v[24:27], v[76:79]
    ds_read_b128 v[48:51], v19 offset:20480
    v_mfma_f32_16x16x32_bf16 v[80:83], a[68:71], v[24:27], v[80:83]
    s_waitcnt lgkmcnt(4)
    s_add_u32 s43, s48, 16384
    buffer_load_dwordx4 v[188:191], v98, s[12:15], s43 offen offset:3072
    v_mfma_f32_16x16x32_bf16 v[68:71], a[72:75], v[28:31], v[68:71]
    ds_read_b128 v[20:23], v16 offset:16640
    v_mfma_f32_16x16x32_bf16 v[72:75], a[76:79], v[28:31], v[72:75]
    v_mfma_f32_16x16x32_bf16 v[76:79], a[72:75], v[32:35], v[76:79]
    ds_read_b128 v[24:27], v16 offset:20736
    s_add_u32 s24, s24, 1
    v_mfma_f32_16x16x32_bf16 v[80:83], a[76:79], v[32:35], v[80:83]
    s_waitcnt lgkmcnt(4)
    v_mfma_f32_16x16x32_bf16 v[68:71], a[80:83], v[36:39], v[68:71]
    ds_read_b128 v[28:31], v17 offset:16640
    s_add_u32 m0, s21, 51200
    v_mfma_f32_16x16x32_bf16 v[72:75], a[84:87], v[36:39], v[72:75]
    buffer_load_dwordx4 v10, s[8:11], s20 offen lds
    v_mfma_f32_16x16x32_bf16 v[76:79], a[80:83], v[40:43], v[76:79]
    ds_read_b128 v[32:35], v17 offset:20736
    v_mfma_f32_16x16x32_bf16 v[80:83], a[84:87], v[40:43], v[80:83]
    s_waitcnt lgkmcnt(4)
    s_add_u32 s43, s48, 20480
    buffer_load_dwordx4 v[192:195], v98, s[12:15], s43 offen offset:2048
    v_mfma_f32_16x16x32_bf16 v[68:71], a[88:91], v[44:47], v[68:71]
    ds_read_b128 v[36:39], v18 offset:16640
    s_min_u32 s24, s24, 63
    v_mfma_f32_16x16x32_bf16 v[72:75], a[92:95], v[44:47], v[72:75]
    v_mfma_f32_16x16x32_bf16 v[76:79], a[88:91], v[48:51], v[76:79]
    ds_read_b128 v[40:43], v18 offset:20736
    s_add_u32 s43, s48, 20480
    buffer_load_dwordx4 v[196:199], v98, s[12:15], s43 offen offset:3072
    v_mfma_f32_16x16x32_bf16 v[80:83], a[92:95], v[48:51], v[80:83]
    s_waitcnt lgkmcnt(4)
    s_lshl_b32 s53, s24, 16
    v_mfma_f32_16x16x32_bf16 v[68:71], a[96:99], v[20:23], v[68:71]
    ds_read_b128 v[44:47], v19 offset:16640
    s_add_u32 m0, s21, 52224
    v_mfma_f32_16x16x32_bf16 v[72:75], a[100:103], v[20:23], v[72:75]
    buffer_load_dwordx4 v11, s[8:11], s20 offen lds
    v_mfma_f32_16x16x32_bf16 v[76:79], a[96:99], v[24:27], v[76:79]
    ds_read_b128 v[48:51], v19 offset:20736
    v_mfma_f32_16x16x32_bf16 v[80:83], a[100:103], v[24:27], v[80:83]
    s_waitcnt lgkmcnt(4)
    v_mfma_f32_16x16x32_bf16 v[68:71], a[104:107], v[28:31], v[68:71]
    s_waitcnt vmcnt(47)
    s_barrier
    ds_read_b128 v[20:23], v16 offset:32768
    v_mfma_f32_16x16x32_bf16 v[72:75], a[108:111], v[28:31], v[72:75]
    s_mov_b32 s20, s53
    v_mfma_f32_16x16x32_bf16 v[76:79], a[104:107], v[32:35], v[76:79]
    ds_read_b128 v[24:27], v16 offset:36864
    s_add_u32 m0, s7, 0
    s_add_u32 s43, s48, 0x8000c00
    buffer_load_dwordx4 v96, s[12:15], s43 offen sc1 lds
    v_mfma_f32_16x16x32_bf16 v[80:83], a[108:111], v[32:35], v[80:83]
    s_waitcnt lgkmcnt(4)
    v_mfma_f32_16x16x32_bf16 v[68:71], a[112:115], v[36:39], v[68:71]
    ds_read_b128 v[28:31], v17 offset:32768
    s_add_u32 m0, s21, 65536
    v_mfma_f32_16x16x32_bf16 v[72:75], a[116:119], v[36:39], v[72:75]
    buffer_load_dwordx4 v8, s[8:11], s20 offen lds
    v_mfma_f32_16x16x32_bf16 v[76:79], a[112:115], v[40:43], v[76:79]
    ds_read_b128 v[32:35], v17 offset:36864
    v_mfma_f32_16x16x32_bf16 v[80:83], a[116:119], v[40:43], v[80:83]
    s_waitcnt lgkmcnt(4)
    v_mfma_f32_16x16x32_bf16 v[68:71], a[120:123], v[44:47], v[68:71]
    ds_read_b128 v[36:39], v18 offset:32768
    v_mfma_f32_16x16x32_bf16 v[72:75], a[124:127], v[44:47], v[72:75]
    v_mfma_f32_16x16x32_bf16 v[76:79], a[120:123], v[48:51], v[76:79]
    ds_read_b128 v[40:43], v18 offset:36864
    s_add_u32 m0, s7, 1024
    s_add_u32 s43, s48, 0x8001c00
    buffer_load_dwordx4 v96, s[12:15], s43 offen sc1 lds
    v_mfma_f32_16x16x32_bf16 v[80:83], a[124:127], v[48:51], v[80:83]
    s_waitcnt lgkmcnt(4)
    v_mfma_f32_16x16x32_bf16 v[68:71], a[128:131], v[20:23], v[68:71]
    ds_read_b128 v[44:47], v19 offset:32768
    s_add_u32 m0, s21, 66560
    v_mfma_f32_16x16x32_bf16 v[72:75], a[132:135], v[20:23], v[72:75]
    buffer_load_dwordx4 v9, s[8:11], s20 offen lds
    v_mfma_f32_16x16x32_bf16 v[76:79], a[128:131], v[24:27], v[76:79]
    ds_read_b128 v[48:51], v19 offset:36864
    v_mfma_f32_16x16x32_bf16 v[80:83], a[132:135], v[24:27], v[80:83]
    s_waitcnt lgkmcnt(4)
    v_mfma_f32_16x16x32_bf16 v[68:71], a[136:139], v[28:31], v[68:71]
    ds_read_b128 v[20:23], v16 offset:33024
    v_mfma_f32_16x16x32_bf16 v[72:75], a[140:143], v[28:31], v[72:75]
    v_mfma_f32_16x16x32_bf16 v[76:79], a[136:139], v[32:35], v[76:79]
    ds_read_b128 v[24:27], v16 offset:37120
    s_add_u32 m0, s7, 2048
    s_add_u32 s43, s48, 0x8004c00
    buffer_load_dwordx4 v96, s[12:15], s43 offen sc1 lds
    v_mfma_f32_16x16x32_bf16 v[80:83], a[140:143], v[32:35], v[80:83]
    s_waitcnt lgkmcnt(4)
    v_mfma_f32_16x16x32_bf16 v[68:71], a[144:147], v[36:39], v[68:71]
    ds_read_b128 v[28:31], v17 offset:33024
    s_add_u32 m0, s21, 67584
    v_mfma_f32_16x16x32_bf16 v[72:75], a[148:151], v[36:39], v[72:75]
    buffer_load_dwordx4 v10, s[8:11], s20 offen lds
    v_mfma_f32_16x16x32_bf16 v[76:79], a[144:147], v[40:43], v[76:79]
    ds_read_b128 v[32:35], v17 offset:37120
    v_mfma_f32_16x16x32_bf16 v[80:83], a[148:151], v[40:43], v[80:83]
    s_waitcnt lgkmcnt(4)
    v_mfma_f32_16x16x32_bf16 v[68:71], a[152:155], v[44:47], v[68:71]
    ds_read_b128 v[36:39], v18 offset:33024
    v_mfma_f32_16x16x32_bf16 v[72:75], a[156:159], v[44:47], v[72:75]
    v_mfma_f32_16x16x32_bf16 v[76:79], a[152:155], v[48:51], v[76:79]
    ds_read_b128 v[40:43], v18 offset:37120
    v_mfma_f32_16x16x32_bf16 v[80:83], a[156:159], v[48:51], v[80:83]
    s_waitcnt lgkmcnt(4)
    v_mfma_f32_16x16x32_bf16 v[68:71], a[160:163], v[20:23], v[68:71]
    ds_read_b128 v[44:47], v19 offset:33024
    s_add_u32 m0, s21, 68608
    v_mfma_f32_16x16x32_bf16 v[72:75], a[164:167], v[20:23], v[72:75]
    buffer_load_dwordx4 v11, s[8:11], s20 offen lds
    v_mfma_f32_16x16x32_bf16 v[76:79], a[160:163], v[24:27], v[76:79]
    ds_read_b128 v[48:51], v19 offset:37120
    v_mfma_f32_16x16x32_bf16 v[80:83], a[164:167], v[24:27], v[80:83]
    s_waitcnt lgkmcnt(4)
    s_add_u32 m0, s7, 3072
    s_add_u32 s43, s48, 0x8005c00
    buffer_load_dwordx4 v96, s[12:15], s43 offen sc1 lds
    v_mfma_f32_16x16x32_bf16 v[68:71], a[168:171], v[28:31], v[68:71]
    s_waitcnt vmcnt(47)
    s_barrier
    ds_read_b128 v[20:23], v16 offset:49152
    v_mfma_f32_16x16x32_bf16 v[72:75], a[172:175], v[28:31], v[72:75]
    s_add_u32 s20, s20, 512
    v_mfma_f32_16x16x32_bf16 v[76:79], a[168:171], v[32:35], v[76:79]
    ds_read_b128 v[24:27], v16 offset:53248
    v_mfma_f32_16x16x32_bf16 v[80:83], a[172:175], v[32:35], v[80:83]
    s_waitcnt lgkmcnt(4)
    v_mfma_f32_16x16x32_bf16 v[68:71], a[176:179], v[36:39], v[68:71]
    ds_read_b128 v[28:31], v17 offset:49152
    s_add_u32 m0, s21, 81920
    v_mfma_f32_16x16x32_bf16 v[72:75], a[180:183], v[36:39], v[72:75]
    buffer_load_dwordx4 v8, s[8:11], s20 offen lds
    v_mfma_f32_16x16x32_bf16 v[76:79], a[176:179], v[40:43], v[76:79]
    ds_read_b128 v[32:35], v17 offset:53248
    v_mfma_f32_16x16x32_bf16 v[80:83], a[180:183], v[40:43], v[80:83]
    s_waitcnt lgkmcnt(4)
    buffer_load_dword v87, v103, s[32:35], 0 offen sc1
    v_mfma_f32_16x16x32_bf16 v[68:71], a[184:187], v[44:47], v[68:71]
    ds_read_b128 v[36:39], v18 offset:49152
    v_mfma_f32_16x16x32_bf16 v[72:75], a[188:191], v[44:47], v[72:75]
    v_mfma_f32_16x16x32_bf16 v[76:79], a[184:187], v[48:51], v[76:79]
    ds_read_b128 v[40:43], v18 offset:53248
    v_mfma_f32_16x16x32_bf16 v[80:83], a[188:191], v[48:51], v[80:83]
    s_waitcnt lgkmcnt(4)
    v_mfma_f32_16x16x32_bf16 v[68:71], a[192:195], v[20:23], v[68:71]
    ds_read_b128 v[44:47], v19 offset:49152
    s_add_u32 m0, s21, 82944
    v_mfma_f32_16x16x32_bf16 v[72:75], a[196:199], v[20:23], v[72:75]
    buffer_load_dwordx4 v9, s[8:11], s20 offen lds
    v_mfma_f32_16x16x32_bf16 v[76:79], a[192:195], v[24:27], v[76:79]
    ds_read_b128 v[48:51], v19 offset:53248
    v_mfma_f32_16x16x32_bf16 v[80:83], a[196:199], v[24:27], v[80:83]
    s_waitcnt lgkmcnt(4)
    v_mfma_f32_16x16x32_bf16 v[68:71], a[200:203], v[28:31], v[68:71]
    ds_read_b128 v[20:23], v16 offset:49408
    v_mfma_f32_16x16x32_bf16 v[72:75], a[204:207], v[28:31], v[72:75]
    v_mfma_f32_16x16x32_bf16 v[76:79], a[200:203], v[32:35], v[76:79]
    ds_read_b128 v[24:27], v16 offset:53504
    v_mfma_f32_16x16x32_bf16 v[80:83], a[204:207], v[32:35], v[80:83]
    s_waitcnt lgkmcnt(4)
    v_mfma_f32_16x16x32_bf16 v[68:71], a[208:211], v[36:39], v[68:71]
    ds_read_b128 v[28:31], v17 offset:49408
    s_add_u32 m0, s21, 83968
    v_mfma_f32_16x16x32_bf16 v[72:75], a[212:215], v[36:39], v[72:75]
    buffer_load_dwordx4 v10, s[8:11], s20 offen lds
    v_mfma_f32_16x16x32_bf16 v[76:79], a[208:211], v[40:43], v[76:79]
    ds_read_b128 v[32:35], v17 offset:53504
    v_mfma_f32_16x16x32_bf16 v[80:83], a[212:215], v[40:43], v[80:83]
    s_waitcnt lgkmcnt(4)
    v_mfma_f32_16x16x32_bf16 v[68:71], a[216:219], v[44:47], v[68:71]
    ds_read_b128 v[36:39], v18 offset:49408
    v_mfma_f32_16x16x32_bf16 v[72:75], a[220:223], v[44:47], v[72:75]
    v_mfma_f32_16x16x32_bf16 v[76:79], a[216:219], v[48:51], v[76:79]
    ds_read_b128 v[40:43], v18 offset:53504
    v_mfma_f32_16x16x32_bf16 v[80:83], a[220:223], v[48:51], v[80:83]
    s_waitcnt lgkmcnt(4)
    v_mfma_f32_16x16x32_bf16 v[68:71], a[224:227], v[20:23], v[68:71]
    ds_read_b128 v[44:47], v19 offset:49408
    s_add_u32 m0, s21, 84992
    v_mfma_f32_16x16x32_bf16 v[72:75], a[228:231], v[20:23], v[72:75]
    buffer_load_dwordx4 v11, s[8:11], s20 offen lds
    v_mfma_f32_16x16x32_bf16 v[76:79], a[224:227], v[24:27], v[76:79]
    ds_read_b128 v[48:51], v19 offset:53504
    v_mfma_f32_16x16x32_bf16 v[80:83], a[228:231], v[24:27], v[80:83]
    s_waitcnt lgkmcnt(4)
    v_mfma_f32_16x16x32_bf16 v[68:71], a[232:235], v[28:31], v[68:71]
    s_waitcnt vmcnt(43)
    s_barrier
    ds_read_b128 v[20:23], v12 offset:0
    v_mfma_f32_16x16x32_bf16 v[72:75], a[236:239], v[28:31], v[72:75]
    s_add_u32 s20, s20, 512
    v_mfma_f32_16x16x32_bf16 v[76:79], a[232:235], v[32:35], v[76:79]
    ds_read_b128 v[24:27], v12 offset:4096
    v_mfma_f32_16x16x32_bf16 v[80:83], a[236:239], v[32:35], v[80:83]
    s_waitcnt lgkmcnt(4)
    v_mfma_f32_16x16x32_bf16 v[68:71], a[240:243], v[36:39], v[68:71]
    ds_read_b128 v[28:31], v13 offset:0
    s_add_u32 m0, s21, 98304
    v_mfma_f32_16x16x32_bf16 v[72:75], a[244:247], v[36:39], v[72:75]
    buffer_load_dwordx4 v8, s[8:11], s20 offen lds
    v_mfma_f32_16x16x32_bf16 v[76:79], a[240:243], v[40:43], v[76:79]
    ds_read_b128 v[32:35], v13 offset:4096
    v_mfma_f32_16x16x32_bf16 v[80:83], a[244:247], v[40:43], v[80:83]
    s_waitcnt lgkmcnt(4)
    v_mfma_f32_16x16x32_bf16 v[68:71], a[248:251], v[44:47], v[68:71]
    ds_read_b128 v[36:39], v14 offset:0
    v_mfma_f32_16x16x32_bf16 v[72:75], a[252:255], v[44:47], v[72:75]
    v_mfma_f32_16x16x32_bf16 v[76:79], a[248:251], v[48:51], v[76:79]
    ds_read_b128 v[40:43], v14 offset:4096
    v_mfma_f32_16x16x32_bf16 v[80:83], a[252:255], v[48:51], v[80:83]
    s_waitcnt lgkmcnt(4)
    s_add_u32 s22, s22, 1
    s_cmp_ge_u32 s22, s23
    s_cbranch_scc0 L_st_460
    s_branch L_fl1_457
L_st_461:
    v_mfma_f32_16x16x32_bf16 v[52:55], a[0:3], v[20:23], 0
    ds_read_b128 v[44:47], v15 offset:0
    s_add_u32 m0, s21, 99328
    s_sub_u32 s39, s22, 1
    v_mfma_f32_16x16x32_bf16 v[56:59], a[4:7], v[20:23], 0
    buffer_load_dwordx4 v9, s[8:11], s20 offen lds
    v_mfma_f32_16x16x32_bf16 v[60:63], a[0:3], v[24:27], 0
    ds_read_b128 v[48:51], v15 offset:4096
    s_bitcmp1_b32 s39, 1
    s_cselect_b32 s38, s54, s55
    v_mfma_f32_16x16x32_bf16 v[64:67], a[4:7], v[24:27], 0
    s_waitcnt lgkmcnt(4)
    v_mfma_f32_16x16x32_bf16 v[52:55], a[8:11], v[28:31], v[52:55]
    ds_read_b128 v[20:23], v12 offset:256
    s_add_u32 s38, s38, s44
    s_waitcnt vmcnt(5)
    v_mfma_f32_16x16x32_bf16 v[56:59], a[12:15], v[28:31], v[56:59]
    s_lshl_b32 s42, s39, 20
    s_add_u32 s38, s38, s42
    ds_write_b32 v101, v87
    v_mfma_f32_16x16x32_bf16 v[60:63], a[8:11], v[32:35], v[60:63]
    ds_read_b128 v[24:27], v12 offset:4352
    s_cmp_eq_u32 s37, 0
    s_cselect_b32 s38, 0x7ff00000, s38
    v_mfma_f32_16x16x32_bf16 v[64:67], a[12:15], v[32:35], v[64:67]
    s_waitcnt lgkmcnt(4)
    v_mfma_f32_16x16x32_bf16 v[52:55], a[16:19], v[36:39], v[52:55]
    ds_read_b128 v[28:31], v13 offset:256
    s_add_u32 m0, s21, 100352
    v_mfma_f32_16x16x32_bf16 v[56:59], a[20:23], v[36:39], v[56:59]
    buffer_load_dwordx4 v10, s[8:11], s20 offen lds
    s_mov_b32 s37, 1
    v_mfma_f32_16x16x32_bf16 v[60:63], a[16:19], v[40:43], v[60:63]
    ds_read_b128 v[32:35], v13 offset:4352
    v_cvt_pk_bf16_f32 v88, v68, v69
    v_mfma_f32_16x16x32_bf16 v[64:67], a[20:23], v[40:43], v[64:67]
    s_waitcnt lgkmcnt(4)
    v_cvt_pk_bf16_f32 v89, v70, v71
    v_mfma_f32_16x16x32_bf16 v[52:55], a[24:27], v[44:47], v[52:55]
    ds_read_b128 v[36:39], v14 offset:256
    v_cvt_pk_bf16_f32 v90, v72, v73
    v_mfma_f32_16x16x32_bf16 v[56:59], a[28:31], v[44:47], v[56:59]
    v_cvt_pk_bf16_f32 v91, v74, v75
    v_mfma_f32_16x16x32_bf16 v[60:63], a[24:27], v[48:51], v[60:63]
    ds_read_b128 v[40:43], v14 offset:4352
    buffer_store_dwordx4 v[88:91], v86, s[12:15], s38 offen offset:0
    v_mfma_f32_16x16x32_bf16 v[64:67], a[28:31], v[48:51], v[64:67]
    s_waitcnt lgkmcnt(4)
    v_cvt_pk_bf16_f32 v92, v76, v77
    v_cvt_pk_bf16_f32 v93, v78, v79
    v_mfma_f32_16x16x32_bf16 v[52:55], a[32:35], v[20:23], v[52:55]
    ds_read_b128 v[44:47], v15 offset:256
    s_add_u32 m0, s21, 101376
    v_mfma_f32_16x16x32_bf16 v[56:59], a[36:39], v[20:23], v[56:59]
    buffer_load_dwordx4 v11, s[8:11], s20 offen lds
    v_cvt_pk_bf16_f32 v94, v80, v81
    v_mfma_f32_16x16x32_bf16 v[60:63], a[32:35], v[24:27], v[60:63]
    ds_read_b128 v[48:51], v15 offset:4352
    v_cvt_pk_bf16_f32 v95, v82, v83
    v_mfma_f32_16x16x32_bf16 v[64:67], a[36:39], v[24:27], v[64:67]
    s_waitcnt lgkmcnt(4)
    buffer_store_dwordx4 v[92:95], v86, s[12:15], s38 offen offset:128
    v_mfma_f32_16x16x32_bf16 v[52:55], a[40:43], v[28:31], v[52:55]
    s_waitcnt vmcnt(27)
    s_barrier
    ds_read_b128 v[20:23], v12 offset:16384
    v_mfma_f32_16x16x32_bf16 v[56:59], a[44:47], v[28:31], v[56:59]
    s_add_u32 s20, s20, 512
    v_mfma_f32_16x16x32_bf16 v[60:63], a[40:43], v[32:35], v[60:63]
    ds_read_b128 v[24:27], v12 offset:20480
    ds_read_b32 v87, v102
    v_mfma_f32_16x16x32_bf16 v[64:67], a[44:47], v[32:35], v[64:67]
    s_waitcnt lgkmcnt(4)
    v_mfma_f32_16x16x32_bf16 v[52:55], a[48:51], v[36:39], v[52:55]
    ds_read_b128 v[28:31], v13 offset:16384
    s_add_u32 m0, s21, 114688
    v_mfma_f32_16x16x32_bf16 v[56:59], a[52:55], v[36:39], v[56:59]
    buffer_load_dwordx4 v8, s[8:11], s20 offen lds
    v_mfma_f32_16x16x32_bf16 v[60:63], a[48:51], v[40:43], v[60:63]
    ds_read_b128 v[32:35], v13 offset:20480
    v_mfma_f32_16x16x32_bf16 v[64:67], a[52:55], v[40:43], v[64:67]
    s_waitcnt lgkmcnt(4)
    v_mfma_f32_16x16x32_bf16 v[52:55], a[56:59], v[44:47], v[52:55]
    ds_read_b128 v[36:39], v14 offset:16384
    v_mfma_f32_16x16x32_bf16 v[56:59], a[60:63], v[44:47], v[56:59]
    v_mfma_f32_16x16x32_bf16 v[60:63], a[56:59], v[48:51], v[60:63]
    ds_read_b128 v[40:43], v14 offset:20480
    v_mfma_f32_16x16x32_bf16 v[64:67], a[60:63], v[48:51], v[64:67]
    s_waitcnt lgkmcnt(4)
    v_mfma_f32_16x16x32_bf16 v[52:55], a[64:67], v[20:23], v[52:55]
    ds_read_b128 v[44:47], v15 offset:16384
    s_add_u32 m0, s21, 115712
    v_mfma_f32_16x16x32_bf16 v[56:59], a[68:71], v[20:23], v[56:59]
    buffer_load_dwordx4 v9, s[8:11], s20 offen lds
    v_mfma_f32_16x16x32_bf16 v[60:63], a[64:67], v[24:27], v[60:63]
    ds_read_b128 v[48:51], v15 offset:20480
    s_branch L_anext_451
L_attr_454:
    v_mfma_f32_16x16x32_bf16 v[64:67], a[68:71], v[24:27], v[64:67]
    s_waitcnt lgkmcnt(4)
    s_add_u32 s43, s94, 0
    buffer_store_dwordx4 v[168:171], v100, s[12:15], s43 offen offset:2048 sc1
    v_mfma_f32_16x16x32_bf16 v[52:55], a[72:75], v[28:31], v[52:55]
    ds_read_b128 v[20:23], v12 offset:16640
    v_mfma_f32_16x16x32_bf16 v[56:59], a[76:79], v[28:31], v[56:59]
    v_mfma_f32_16x16x32_bf16 v[60:63], a[72:75], v[32:35], v[60:63]
    ds_read_b128 v[24:27], v12 offset:20736
    s_add_u32 s24, s24, 1
    v_mfma_f32_16x16x32_bf16 v[64:67], a[76:79], v[32:35], v[64:67]
    s_waitcnt lgkmcnt(4)
    v_mfma_f32_16x16x32_bf16 v[52:55], a[80:83], v[36:39], v[52:55]
    ds_read_b128 v[28:31], v13 offset:16640
    s_add_u32 m0, s21, 116736
    v_mfma_f32_16x16x32_bf16 v[56:59], a[84:87], v[36:39], v[56:59]
    buffer_load_dwordx4 v10, s[8:11], s20 offen lds
    v_mfma_f32_16x16x32_bf16 v[60:63], a[80:83], v[40:43], v[60:63]
    ds_read_b128 v[32:35], v13 offset:20736
    v_mfma_f32_16x16x32_bf16 v[64:67], a[84:87], v[40:43], v[64:67]
    s_waitcnt lgkmcnt(4)
    s_min_u32 s24, s24, 63
    v_mfma_f32_16x16x32_bf16 v[52:55], a[88:91], v[44:47], v[52:55]
    ds_read_b128 v[36:39], v14 offset:16640
    v_mfma_f32_16x16x32_bf16 v[56:59], a[92:95], v[44:47], v[56:59]
    s_lshl_b32 s53, s24, 16
    v_mfma_f32_16x16x32_bf16 v[60:63], a[88:91], v[48:51], v[60:63]
    ds_read_b128 v[40:43], v14 offset:20736
    s_add_u32 s43, s94, 0
    buffer_store_dwordx4 v[172:175], v100, s[12:15], s43 offen offset:2560 sc1
    v_mfma_f32_16x16x32_bf16 v[64:67], a[92:95], v[48:51], v[64:67]
    s_waitcnt lgkmcnt(4)
    v_mfma_f32_16x16x32_bf16 v[52:55], a[96:99], v[20:23], v[52:55]
    ds_read_b128 v[44:47], v15 offset:16640
    s_add_u32 m0, s21, 117760
    v_mfma_f32_16x16x32_bf16 v[56:59], a[100:103], v[20:23], v[56:59]
    buffer_load_dwordx4 v11, s[8:11], s20 offen lds
    v_mfma_f32_16x16x32_bf16 v[60:63], a[96:99], v[24:27], v[60:63]
    ds_read_b128 v[48:51], v15 offset:20736
    v_mfma_f32_16x16x32_bf16 v[64:67], a[100:103], v[24:27], v[64:67]
    s_waitcnt lgkmcnt(4)
    v_mfma_f32_16x16x32_bf16 v[52:55], a[104:107], v[28:31], v[52:55]
    s_waitcnt vmcnt(26)
    s_barrier
    ds_read_b128 v[20:23], v12 offset:32768
    v_mfma_f32_16x16x32_bf16 v[56:59], a[108:111], v[28:31], v[56:59]
    s_mov_b32 s20, s53
    v_mfma_f32_16x16x32_bf16 v[60:63], a[104:107], v[32:35], v[60:63]
    ds_read_b128 v[24:27], v12 offset:36864
    v_mfma_f32_16x16x32_bf16 v[64:67], a[108:111], v[32:35], v[64:67]
    s_waitcnt lgkmcnt(4)
    v_mfma_f32_16x16x32_bf16 v[52:55], a[112:115], v[36:39], v[52:55]
    ds_read_b128 v[28:31], v13 offset:32768
    s_add_u32 m0, s21, 0
    v_mfma_f32_16x16x32_bf16 v[56:59], a[116:119], v[36:39], v[56:59]
    buffer_load_dwordx4 v8, s[8:11], s20 offen lds
    v_mfma_f32_16x16x32_bf16 v[60:63], a[112:115], v[40:43], v[60:63]
    ds_read_b128 v[32:35], v13 offset:36864
    v_mfma_f32_16x16x32_bf16 v[64:67], a[116:119], v[40:43], v[64:67]
    s_waitcnt lgkmcnt(4)
    s_add_u32 s43, s94, 4096
    buffer_store_dwordx4 v[176:179], v100, s[12:15], s43 offen offset:2048 sc1
    v_mfma_f32_16x16x32_bf16 v[52:55], a[120:123], v[44:47], v[52:55]
    ds_read_b128 v[36:39], v14 offset:32768
    v_mfma_f32_16x16x32_bf16 v[56:59], a[124:127], v[44:47], v[56:59]
    v_mfma_f32_16x16x32_bf16 v[60:63], a[120:123], v[48:51], v[60:63]
    ds_read_b128 v[40:43], v14 offset:36864
    v_mfma_f32_16x16x32_bf16 v[64:67], a[124:127], v[48:51], v[64:67]
    s_waitcnt lgkmcnt(4)
    v_mfma_f32_16x16x32_bf16 v[52:55], a[128:131], v[20:23], v[52:55]
    ds_read_b128 v[44:47], v15 offset:32768
    s_add_u32 m0, s21, 1024
    v_mfma_f32_16x16x32_bf16 v[56:59], a[132:135], v[20:23], v[56:59]
    buffer_load_dwordx4 v9, s[8:11], s20 offen lds
    v_mfma_f32_16x16x32_bf16 v[60:63], a[128:131], v[24:27], v[60:63]
    ds_read_b128 v[48:51], v15 offset:36864
    v_mfma_f32_16x16x32_bf16 v[64:67], a[132:135], v[24:27], v[64:67]
    s_waitcnt lgkmcnt(4)
    v_mfma_f32_16x16x32_bf16 v[52:55], a[136:139], v[28:31], v[52:55]
    ds_read_b128 v[20:23], v12 offset:33024
    v_mfma_f32_16x16x32_bf16 v[56:59], a[140:143], v[28:31], v[56:59]
    v_mfma_f32_16x16x32_bf16 v[60:63], a[136:139], v[32:35], v[60:63]
    ds_read_b128 v[24:27], v12 offset:37120
    s_add_u32 s43, s94, 4096
    buffer_store_dwordx4 v[180:183], v100, s[12:15], s43 offen offset:2560 sc1
    v_mfma_f32_16x16x32_bf16 v[64:67], a[140:143], v[32:35], v[64:67]
    s_waitcnt lgkmcnt(4)
    v_mfma_f32_16x16x32_bf16 v[52:55], a[144:147], v[36:39], v[52:55]
    ds_read_b128 v[28:31], v13 offset:33024
    s_add_u32 m0, s21, 2048
    v_mfma_f32_16x16x32_bf16 v[56:59], a[148:151], v[36:39], v[56:59]
    buffer_load_dwordx4 v10, s[8:11], s20 offen lds
    v_mfma_f32_16x16x32_bf16 v[60:63], a[144:147], v[40:43], v[60:63]
    ds_read_b128 v[32:35], v13 offset:37120
    v_mfma_f32_16x16x32_bf16 v[64:67], a[148:151], v[40:43], v[64:67]
    s_waitcnt lgkmcnt(4)
    v_mfma_f32_16x16x32_bf16 v[52:55], a[152:155], v[44:47], v[52:55]
    ds_read_b128 v[36:39], v14 offset:33024
    v_mfma_f32_16x16x32_bf16 v[56:59], a[156:159], v[44:47], v[56:59]
    v_mfma_f32_16x16x32_bf16 v[60:63], a[152:155], v[48:51], v[60:63]
    ds_read_b128 v[40:43], v14 offset:37120
    v_mfma_f32_16x16x32_bf16 v[64:67], a[156:159], v[48:51], v[64:67]
    s_waitcnt lgkmcnt(4)
    v_mfma_f32_16x16x32_bf16 v[52:55], a[160:163], v[20:23], v[52:55]
    ds_read_b128 v[44:47], v15 offset:33024
    s_add_u32 m0, s21, 3072
    v_mfma_f32_16x16x32_bf16 v[56:59], a[164:167], v[20:23], v[56:59]
    buffer_load_dwordx4 v11, s[8:11], s20 offen lds
    v_mfma_f32_16x16x32_bf16 v[60:63], a[160:163], v[24:27], v[60:63]
    ds_read_b128 v[48:51], v15 offset:37120
    v_mfma_f32_16x16x32_bf16 v[64:67], a[164:167], v[24:27], v[64:67]
    s_waitcnt lgkmcnt(4)
    s_add_u32 s43, s94, 16384
    buffer_store_dwordx4 v[184:187], v100, s[12:15], s43 offen offset:2048 sc1
    v_mfma_f32_16x16x32_bf16 v[52:55], a[168:171], v[28:31], v[52:55]
    s_waitcnt vmcnt(28)
    s_barrier
    ds_read_b128 v[20:23], v12 offset:49152
    v_mfma_f32_16x16x32_bf16 v[56:59], a[172:175], v[28:31], v[56:59]
    s_add_u32 s20, s20, 512
    v_mfma_f32_16x16x32_bf16 v[60:63], a[168:171], v[32:35], v[60:63]
    ds_read_b128 v[24:27], v12 offset:53248
    v_mfma_f32_16x16x32_bf16 v[64:67], a[172:175], v[32:35], v[64:67]
    s_waitcnt lgkmcnt(4)
    v_mfma_f32_16x16x32_bf16 v[52:55], a[176:179], v[36:39], v[52:55]
    ds_read_b128 v[28:31], v13 offset:49152
    s_add_u32 m0, s21, 16384
    v_mfma_f32_16x16x32_bf16 v[56:59], a[180:183], v[36:39], v[56:59]
    buffer_load_dwordx4 v8, s[8:11], s20 offen lds
    v_mfma_f32_16x16x32_bf16 v[60:63], a[176:179], v[40:43], v[60:63]
    ds_read_b128 v[32:35], v13 offset:53248
    v_mfma_f32_16x16x32_bf16 v[64:67], a[180:183], v[40:43], v[64:67]
    s_waitcnt lgkmcnt(4)
    s_add_u32 s43, s94, 16384
    buffer_store_dwordx4 v[188:191], v100, s[12:15], s43 offen offset:2560 sc1
    v_mfma_f32_16x16x32_bf16 v[52:55], a[184:187], v[44:47], v[52:55]
    ds_read_b128 v[36:39], v14 offset:49152
    v_mfma_f32_16x16x32_bf16 v[56:59], a[188:191], v[44:47], v[56:59]
    v_mfma_f32_16x16x32_bf16 v[60:63], a[184:187], v[48:51], v[60:63]
    ds_read_b128 v[40:43], v14 offset:53248
    v_mfma_f32_16x16x32_bf16 v[64:67], a[188:191], v[48:51], v[64:67]
    s_waitcnt lgkmcnt(4)
    v_mfma_f32_16x16x32_bf16 v[52:55], a[192:195], v[20:23], v[52:55]
    ds_read_b128 v[44:47], v15 offset:49152
    s_add_u32 m0, s21, 17408
    v_mfma_f32_16x16x32_bf16 v[56:59], a[196:199], v[20:23], v[56:59]
    buffer_load_dwordx4 v9, s[8:11], s20 offen lds
    v_mfma_f32_16x16x32_bf16 v[60:63], a[192:195], v[24:27], v[60:63]
    ds_read_b128 v[48:51], v15 offset:53248
    v_mfma_f32_16x16x32_bf16 v[64:67], a[196:199], v[24:27], v[64:67]
    s_waitcnt lgkmcnt(4)
    v_mfma_f32_16x16x32_bf16 v[52:55], a[200:203], v[28:31], v[52:55]
    ds_read_b128 v[20:23], v12 offset:49408
    v_mfma_f32_16x16x32_bf16 v[56:59], a[204:207], v[28:31], v[56:59]
    v_mfma_f32_16x16x32_bf16 v[60:63], a[200:203], v[32:35], v[60:63]
    ds_read_b128 v[24:27], v12 offset:53504
    s_add_u32 s43, s94, 20480
    buffer_store_dwordx4 v[192:195], v100, s[12:15], s43 offen offset:2048 sc1
    v_mfma_f32_16x16x32_bf16 v[64:67], a[204:207], v[32:35], v[64:67]
    s_waitcnt lgkmcnt(4)
    v_mfma_f32_16x16x32_bf16 v[52:55], a[208:211], v[36:39], v[52:55]
    ds_read_b128 v[28:31], v13 offset:49408
    s_add_u32 m0, s21, 18432
    v_mfma_f32_16x16x32_bf16 v[56:59], a[212:215], v[36:39], v[56:59]
    buffer_load_dwordx4 v10, s[8:11], s20 offen lds
    v_mfma_f32_16x16x32_bf16 v[60:63], a[208:211], v[40:43], v[60:63]
    ds_read_b128 v[32:35], v13 offset:53504
    v_mfma_f32_16x16x32_bf16 v[64:67], a[212:215], v[40:43], v[64:67]
    s_waitcnt lgkmcnt(4)
    v_mfma_f32_16x16x32_bf16 v[52:55], a[216:219], v[44:47], v[52:55]
    ds_read_b128 v[36:39], v14 offset:49408
    v_mfma_f32_16x16x32_bf16 v[56:59], a[220:223], v[44:47], v[56:59]
    v_mfma_f32_16x16x32_bf16 v[60:63], a[216:219], v[48:51], v[60:63]
    ds_read_b128 v[40:43], v14 offset:53504
    v_mfma_f32_16x16x32_bf16 v[64:67], a[220:223], v[48:51], v[64:67]
    s_waitcnt lgkmcnt(4)
    v_mfma_f32_16x16x32_bf16 v[52:55], a[224:227], v[20:23], v[52:55]
    ds_read_b128 v[44:47], v15 offset:49408
    s_add_u32 m0, s21, 19456
    v_mfma_f32_16x16x32_bf16 v[56:59], a[228:231], v[20:23], v[56:59]
    buffer_load_dwordx4 v11, s[8:11], s20 offen lds
    v_mfma_f32_16x16x32_bf16 v[60:63], a[224:227], v[24:27], v[60:63]
    ds_read_b128 v[48:51], v15 offset:53504
    v_mfma_f32_16x16x32_bf16 v[64:67], a[228:231], v[24:27], v[64:67]
    s_waitcnt lgkmcnt(4)
    s_add_u32 s43, s94, 20480
    buffer_store_dwordx4 v[196:199], v100, s[12:15], s43 offen offset:2560 sc1
    v_mfma_f32_16x16x32_bf16 v[52:55], a[232:235], v[28:31], v[52:55]
    s_waitcnt vmcnt(31)
    s_barrier
    ds_read_b128 v[20:23], v16 offset:0
    v_mfma_f32_16x16x32_bf16 v[56:59], a[236:239], v[28:31], v[56:59]
    s_add_u32 s20, s20, 512
    v_mfma_f32_16x16x32_bf16 v[60:63], a[232:235], v[32:35], v[60:63]
    ds_read_b128 v[24:27], v16 offset:4096
    v_mfma_f32_16x16x32_bf16 v[64:67], a[236:239], v[32:35], v[64:67]
    s_waitcnt lgkmcnt(4)
    v_mfma_f32_16x16x32_bf16 v[52:55], a[240:243], v[36:39], v[52:55]
    ds_read_b128 v[28:31], v17 offset:0
    s_add_u32 m0, s21, 32768
    v_mfma_f32_16x16x32_bf16 v[56:59], a[244:247], v[36:39], v[56:59]
    buffer_load_dwordx4 v8, s[8:11], s20 offen lds
    v_mfma_f32_16x16x32_bf16 v[60:63], a[240:243], v[40:43], v[60:63]
    ds_read_b128 v[32:35], v17 offset:4096
    v_mfma_f32_16x16x32_bf16 v[64:67], a[244:247], v[40:43], v[64:67]
    s_waitcnt lgkmcnt(4)
    v_mfma_f32_16x16x32_bf16 v[52:55], a[248:251], v[44:47], v[52:55]
    ds_read_b128 v[36:39], v18 offset:0
    v_mfma_f32_16x16x32_bf16 v[56:59], a[252:255], v[44:47], v[56:59]
    v_mfma_f32_16x16x32_bf16 v[60:63], a[248:251], v[48:51], v[60:63]
    ds_read_b128 v[40:43], v18 offset:4096
    v_mfma_f32_16x16x32_bf16 v[64:67], a[252:255], v[48:51], v[64:67]
    s_waitcnt lgkmcnt(4)
    s_add_u32 s22, s22, 1
    s_cmp_ge_u32 s22, s23
    s_cbranch_scc1 L_fl0_456
    v_mfma_f32_16x16x32_bf16 v[68:71], a[0:3], v[20:23], 0
    ds_read_b128 v[44:47], v19 offset:0
    s_add_u32 m0, s21, 33792
    s_sub_u32 s39, s22, 1
    v_mfma_f32_16x16x32_bf16 v[72:75], a[4:7], v[20:23], 0
    buffer_load_dwordx4 v9, s[8:11], s20 offen lds
    v_mfma_f32_16x16x32_bf16 v[76:79], a[0:3], v[24:27], 0
    ds_read_b128 v[48:51], v19 offset:4096
    s_bitcmp1_b32 s39, 1
    s_cselect_b32 s38, s54, s55
    v_mfma_f32_16x16x32_bf16 v[80:83], a[4:7], v[24:27], 0
    s_waitcnt lgkmcnt(4)
    v_mfma_f32_16x16x32_bf16 v[68:71], a[8:11], v[28:31], v[68:71]
    ds_read_b128 v[20:23], v16 offset:256
    s_add_u32 s38, s38, s44
    v_mfma_f32_16x16x32_bf16 v[72:75], a[12:15], v[28:31], v[72:75]
    s_lshl_b32 s42, s39, 20
    s_add_u32 s38, s38, s42
    v_mfma_f32_16x16x32_bf16 v[76:79], a[8:11], v[32:35], v[76:79]
    ds_read_b128 v[24:27], v16 offset:4352
    s_cmp_eq_u32 s37, 0
    s_cselect_b32 s38, 0x7ff00000, s38
    v_mfma_f32_16x16x32_bf16 v[80:83], a[12:15], v[32:35], v[80:83]
    s_waitcnt lgkmcnt(4)
    v_mfma_f32_16x16x32_bf16 v[68:71], a[16:19], v[36:39], v[68:71]
    ds_read_b128 v[28:31], v17 offset:256
    s_add_u32 m0, s21, 34816
    v_mfma_f32_16x16x32_bf16 v[72:75], a[20:23], v[36:39], v[72:75]
    buffer_load_dwordx4 v10, s[8:11], s20 offen lds
    s_mov_b32 s37, 1
    v_mfma_f32_16x16x32_bf16 v[76:79], a[16:19], v[40:43], v[76:79]
    ds_read_b128 v[32:35], v17 offset:4352
    v_cvt_pk_bf16_f32 v88, v52, v53
    v_mfma_f32_16x16x32_bf16 v[80:83], a[20:23], v[40:43], v[80:83]
    s_waitcnt lgkmcnt(4)
    v_cvt_pk_bf16_f32 v89, v54, v55
    v_mfma_f32_16x16x32_bf16 v[68:71], a[24:27], v[44:47], v[68:71]
    ds_read_b128 v[36:39], v18 offset:256
    v_cvt_pk_bf16_f32 v90, v56, v57
    v_mfma_f32_16x16x32_bf16 v[72:75], a[28:31], v[44:47], v[72:75]
    v_cvt_pk_bf16_f32 v91, v58, v59
    v_mfma_f32_16x16x32_bf16 v[76:79], a[24:27], v[48:51], v[76:79]
    ds_read_b128 v[40:43], v18 offset:4352
    buffer_store_dwordx4 v[88:91], v86, s[12:15], s38 offen offset:0
    v_mfma_f32_16x16x32_bf16 v[80:83], a[28:31], v[48:51], v[80:83]
    s_waitcnt lgkmcnt(4)
    v_cvt_pk_bf16_f32 v92, v60, v61
    v_cvt_pk_bf16_f32 v93, v62, v63
    v_mfma_f32_16x16x32_bf16 v[68:71], a[32:35], v[20:23], v[68:71]
    ds_read_b128 v[44:47], v19 offset:256
    s_add_u32 m0, s21, 35840
    v_mfma_f32_16x16x32_bf16 v[72:75], a[36:39], v[20:23], v[72:75]
    buffer_load_dwordx4 v11, s[8:11], s20 offen lds
    v_cvt_pk_bf16_f32 v94, v64, v65
    v_mfma_f32_16x16x32_bf16 v[76:79], a[32:35], v[24:27], v[76:79]
    ds_read_b128 v[48:51], v19 offset:4352
    v_cvt_pk_bf16_f32 v95, v66, v67
    v_mfma_f32_16x16x32_bf16 v[80:83], a[36:39], v[24:27], v[80:83]
    s_waitcnt lgkmcnt(4)
    buffer_store_dwordx4 v[92:95], v86, s[12:15], s38 offen offset:128
    v_mfma_f32_16x16x32_bf16 v[68:71], a[40:43], v[28:31], v[68:71]
    s_waitcnt vmcnt(32)
    s_barrier
    ds_read_b128 v[20:23], v16 offset:16384
    v_mfma_f32_16x16x32_bf16 v[72:75], a[44:47], v[28:31], v[72:75]
    s_add_u32 s20, s20, 512
    v_mfma_f32_16x16x32_bf16 v[76:79], a[40:43], v[32:35], v[76:79]
    ds_read_b128 v[24:27], v16 offset:20480
    v_mfma_f32_16x16x32_bf16 v[80:83], a[44:47], v[32:35], v[80:83]
    s_waitcnt lgkmcnt(4)
    v_mfma_f32_16x16x32_bf16 v[68:71], a[48:51], v[36:39], v[68:71]
    ds_read_b128 v[28:31], v17 offset:16384
    s_add_u32 m0, s21, 49152
    v_mfma_f32_16x16x32_bf16 v[72:75], a[52:55], v[36:39], v[72:75]
    buffer_load_dwordx4 v8, s[8:11], s20 offen lds
    v_mfma_f32_16x16x32_bf16 v[76:79], a[48:51], v[40:43], v[76:79]
    ds_read_b128 v[32:35], v17 offset:20480
    v_mfma_f32_16x16x32_bf16 v[80:83], a[52:55], v[40:43], v[80:83]
    s_waitcnt lgkmcnt(4)
    v_mfma_f32_16x16x32_bf16 v[68:71], a[56:59], v[44:47], v[68:71]
    ds_read_b128 v[36:39], v18 offset:16384
    v_mfma_f32_16x16x32_bf16 v[72:75], a[60:63], v[44:47], v[72:75]
    v_mfma_f32_16x16x32_bf16 v[76:79], a[56:59], v[48:51], v[76:79]
    ds_read_b128 v[40:43], v18 offset:20480
    v_mfma_f32_16x16x32_bf16 v[80:83], a[60:63], v[48:51], v[80:83]
    s_waitcnt lgkmcnt(4)
    v_mfma_f32_16x16x32_bf16 v[68:71], a[64:67], v[20:23], v[68:71]
    ds_read_b128 v[44:47], v19 offset:16384
    s_add_u32 m0, s21, 50176
    v_mfma_f32_16x16x32_bf16 v[72:75], a[68:71], v[20:23], v[72:75]
    buffer_load_dwordx4 v9, s[8:11], s20 offen lds
    v_mfma_f32_16x16x32_bf16 v[76:79], a[64:67], v[24:27], v[76:79]
    ds_read_b128 v[48:51], v19 offset:20480
    v_mfma_f32_16x16x32_bf16 v[80:83], a[68:71], v[24:27], v[80:83]
    s_waitcnt lgkmcnt(4)
    v_mfma_f32_16x16x32_bf16 v[68:71], a[72:75], v[28:31], v[68:71]
    ds_read_b128 v[20:23], v16 offset:16640
    v_mfma_f32_16x16x32_bf16 v[72:75], a[76:79], v[28:31], v[72:75]
    v_mfma_f32_16x16x32_bf16 v[76:79], a[72:75], v[32:35], v[76:79]
    ds_read_b128 v[24:27], v16 offset:20736
    s_add_u32 s24, s24, 1
    v_mfma_f32_16x16x32_bf16 v[80:83], a[76:79], v[32:35], v[80:83]
    s_waitcnt lgkmcnt(4)
    v_mfma_f32_16x16x32_bf16 v[68:71], a[80:83], v[36:39], v[68:71]
    ds_read_b128 v[28:31], v17 offset:16640
    s_add_u32 m0, s21, 51200
    v_mfma_f32_16x16x32_bf16 v[72:75], a[84:87], v[36:39], v[72:75]
    buffer_load_dwordx4 v10, s[8:11], s20 offen lds
    v_mfma_f32_16x16x32_bf16 v[76:79], a[80:83], v[40:43], v[76:79]
    ds_read_b128 v[32:35], v17 offset:20736
    v_mfma_f32_16x16x32_bf16 v[80:83], a[84:87], v[40:43], v[80:83]
    s_waitcnt lgkmcnt(4)
    s_min_u32 s24, s24, 63
    v_mfma_f32_16x16x32_bf16 v[68:71], a[88:91], v[44:47], v[68:71]
    ds_read_b128 v[36:39], v18 offset:16640
    v_mfma_f32_16x16x32_bf16 v[72:75], a[92:95], v[44:47], v[72:75]
    v_mfma_f32_16x16x32_bf16 v[76:79], a[88:91], v[48:51], v[76:79]
    ds_read_b128 v[40:43], v18 offset:20736
    s_lshl_b32 s53, s24, 16
    v_mfma_f32_16x16x32_bf16 v[80:83], a[92:95], v[48:51], v[80:83]
    s_waitcnt lgkmcnt(4)
    v_mfma_f32_16x16x32_bf16 v[68:71], a[96:99], v[20:23], v[68:71]
    ds_read_b128 v[44:47], v19 offset:16640
    s_add_u32 m0, s21, 52224
    v_mfma_f32_16x16x32_bf16 v[72:75], a[100:103], v[20:23], v[72:75]
    buffer_load_dwordx4 v11, s[8:11], s20 offen lds
    v_mfma_f32_16x16x32_bf16 v[76:79], a[96:99], v[24:27], v[76:79]
    ds_read_b128 v[48:51], v19 offset:20736
    s_waitcnt vmcnt(10)
    v_mfma_f32_16x16x32_bf16 v[80:83], a[100:103], v[24:27], v[80:83]
    s_waitcnt lgkmcnt(4)
    v_mfma_f32_16x16x32_bf16 v[68:71], a[104:107], v[28:31], v[68:71]
    s_waitcnt vmcnt(31)
    s_barrier
    ds_read_b128 v[20:23], v16 offset:32768
    v_mfma_f32_16x16x32_bf16 v[72:75], a[108:111], v[28:31], v[72:75]
    s_mov_b32 s20, s53
    v_mfma_f32_16x16x32_bf16 v[76:79], a[104:107], v[32:35], v[76:79]
    ds_read_b128 v[24:27], v16 offset:36864
    buffer_atomic_add v84, v85, s[12:15], s51 offen sc1
    v_mfma_f32_16x16x32_bf16 v[80:83], a[108:111], v[32:35], v[80:83]
    s_waitcnt lgkmcnt(4)
    v_mfma_f32_16x16x32_bf16 v[68:71], a[112:115], v[36:39], v[68:71]
    ds_read_b128 v[28:31], v17 offset:32768
    s_add_u32 m0, s21, 65536
    v_mfma_f32_16x16x32_bf16 v[72:75], a[116:119], v[36:39], v[72:75]
    buffer_load_dwordx4 v8, s[8:11], s20 offen lds
    v_mfma_f32_16x16x32_bf16 v[76:79], a[112:115], v[40:43], v[76:79]
    ds_read_b128 v[32:35], v17 offset:36864
    v_mfma_f32_16x16x32_bf16 v[80:83], a[116:119], v[40:43], v[80:83]
    s_waitcnt lgkmcnt(4)
    v_mfma_f32_16x16x32_bf16 v[68:71], a[120:123], v[44:47], v[68:71]
    ds_read_b128 v[36:39], v18 offset:32768
    v_mfma_f32_16x16x32_bf16 v[72:75], a[124:127], v[44:47], v[72:75]
    v_mfma_f32_16x16x32_bf16 v[76:79], a[120:123], v[48:51], v[76:79]
    ds_read_b128 v[40:43], v18 offset:36864
    v_mfma_f32_16x16x32_bf16 v[80:83], a[124:127], v[48:51], v[80:83]
    s_waitcnt lgkmcnt(4)
    v_mfma_f32_16x16x32_bf16 v[68:71], a[128:131], v[20:23], v[68:71]
    ds_read_b128 v[44:47], v19 offset:32768
    s_add_u32 m0, s21, 66560
    v_mfma_f32_16x16x32_bf16 v[72:75], a[132:135], v[20:23], v[72:75]
    buffer_load_dwordx4 v9, s[8:11], s20 offen lds
    v_mfma_f32_16x16x32_bf16 v[76:79], a[128:131], v[24:27], v[76:79]
    ds_read_b128 v[48:51], v19 offset:36864
    v_mfma_f32_16x16x32_bf16 v[80:83], a[132:135], v[24:27], v[80:83]
    s_waitcnt lgkmcnt(4)
    v_mfma_f32_16x16x32_bf16 v[68:71], a[136:139], v[28:31], v[68:71]
    ds_read_b128 v[20:23], v16 offset:33024
    v_mfma_f32_16x16x32_bf16 v[72:75], a[140:143], v[28:31], v[72:75]
    v_mfma_f32_16x16x32_bf16 v[76:79], a[136:139], v[32:35], v[76:79]
    ds_read_b128 v[24:27], v16 offset:37120
    v_mfma_f32_16x16x32_bf16 v[80:83], a[140:143], v[32:35], v[80:83]
    s_waitcnt lgkmcnt(4)
    v_mfma_f32_16x16x32_bf16 v[68:71], a[144:147], v[36:39], v[68:71]
    ds_read_b128 v[28:31], v17 offset:33024
    s_add_u32 m0, s21, 67584
    v_mfma_f32_16x16x32_bf16 v[72:75], a[148:151], v[36:39], v[72:75]
    buffer_load_dwordx4 v10, s[8:11], s20 offen lds
    v_mfma_f32_16x16x32_bf16 v[76:79], a[144:147], v[40:43], v[76:79]
    ds_read_b128 v[32:35], v17 offset:37120
    v_mfma_f32_16x16x32_bf16 v[80:83], a[148:151], v[40:43], v[80:83]
    s_waitcnt lgkmcnt(4)
    v_mfma_f32_16x16x32_bf16 v[68:71], a[152:155], v[44:47], v[68:71]
    ds_read_b128 v[36:39], v18 offset:33024
    v_mfma_f32_16x16x32_bf16 v[72:75], a[156:159], v[44:47], v[72:75]
    v_mfma_f32_16x16x32_bf16 v[76:79], a[152:155], v[48:51], v[76:79]
    ds_read_b128 v[40:43], v18 offset:37120
    v_mfma_f32_16x16x32_bf16 v[80:83], a[156:159], v[48:51], v[80:83]
    s_waitcnt lgkmcnt(4)
    v_mfma_f32_16x16x32_bf16 v[68:71], a[160:163], v[20:23], v[68:71]
    ds_read_b128 v[44:47], v19 offset:33024
    s_add_u32 m0, s21, 68608
    v_mfma_f32_16x16x32_bf16 v[72:75], a[164:167], v[20:23], v[72:75]
    buffer_load_dwordx4 v11, s[8:11], s20 offen lds
    v_mfma_f32_16x16x32_bf16 v[76:79], a[160:163], v[24:27], v[76:79]
    ds_read_b128 v[48:51], v19 offset:37120
    v_mfma_f32_16x16x32_bf16 v[80:83], a[164:167], v[24:27], v[80:83]
    s_waitcnt lgkmcnt(4)
    v_mfma_f32_16x16x32_bf16 v[68:71], a[168:171], v[28:31], v[68:71]
    s_waitcnt vmcnt(29)
    s_barrier
    ds_read_b128 v[20:23], v16 offset:49152
    v_mfma_f32_16x16x32_bf16 v[72:75], a[172:175], v[28:31], v[72:75]
    s_add_u32 s20, s20, 512
    v_mfma_f32_16x16x32_bf16 v[76:79], a[168:171], v[32:35], v[76:79]
    ds_read_b128 v[24:27], v16 offset:53248
    v_mfma_f32_16x16x32_bf16 v[80:83], a[172:175], v[32:35], v[80:83]
    s_waitcnt lgkmcnt(4)
    v_mfma_f32_16x16x32_bf16 v[68:71], a[176:179], v[36:39], v[68:71]
    ds_read_b128 v[28:31], v17 offset:49152
    s_add_u32 m0, s21, 81920
    v_mfma_f32_16x16x32_bf16 v[72:75], a[180:183], v[36:39], v[72:75]
    buffer_load_dwordx4 v8, s[8:11], s20 offen lds
    v_mfma_f32_16x16x32_bf16 v[76:79], a[176:179], v[40:43], v[76:79]
    ds_read_b128 v[32:35], v17 offset:53248
    v_mfma_f32_16x16x32_bf16 v[80:83], a[180:183], v[40:43], v[80:83]
    s_waitcnt lgkmcnt(4)
    buffer_load_dword v87, v103, s[32:35], 0 offen sc1
    v_mfma_f32_16x16x32_bf16 v[68:71], a[184:187], v[44:47], v[68:71]
    ds_read_b128 v[36:39], v18 offset:49152
    v_mfma_f32_16x16x32_bf16 v[72:75], a[188:191], v[44:47], v[72:75]
    v_mfma_f32_16x16x32_bf16 v[76:79], a[184:187], v[48:51], v[76:79]
    ds_read_b128 v[40:43], v18 offset:53248
    v_mfma_f32_16x16x32_bf16 v[80:83], a[188:191], v[48:51], v[80:83]
    s_waitcnt lgkmcnt(4)
    v_mfma_f32_16x16x32_bf16 v[68:71], a[192:195], v[20:23], v[68:71]
    ds_read_b128 v[44:47], v19 offset:49152
    s_add_u32 m0, s21, 82944
    v_mfma_f32_16x16x32_bf16 v[72:75], a[196:199], v[20:23], v[72:75]
    buffer_load_dwordx4 v9, s[8:11], s20 offen lds
    v_mfma_f32_16x16x32_bf16 v[76:79], a[192:195], v[24:27], v[76:79]
    ds_read_b128 v[48:51], v19 offset:53248
    v_mfma_f32_16x16x32_bf16 v[80:83], a[196:199], v[24:27], v[80:83]
    s_waitcnt lgkmcnt(4)
    v_mfma_f32_16x16x32_bf16 v[68:71], a[200:203], v[28:31], v[68:71]
    ds_read_b128 v[20:23], v16 offset:49408
    v_mfma_f32_16x16x32_bf16 v[72:75], a[204:207], v[28:31], v[72:75]
    v_mfma_f32_16x16x32_bf16 v[76:79], a[200:203], v[32:35], v[76:79]
    ds_read_b128 v[24:27], v16 offset:53504
    v_mfma_f32_16x16x32_bf16 v[80:83], a[204:207], v[32:35], v[80:83]
    s_waitcnt lgkmcnt(4)
    v_mfma_f32_16x16x32_bf16 v[68:71], a[208:211], v[36:39], v[68:71]
    ds_read_b128 v[28:31], v17 offset:49408
    s_add_u32 m0, s21, 83968
    v_mfma_f32_16x16x32_bf16 v[72:75], a[212:215], v[36:39], v[72:75]
    buffer_load_dwordx4 v10, s[8:11], s20 offen lds
    v_mfma_f32_16x16x32_bf16 v[76:79], a[208:211], v[40:43], v[76:79]
    ds_read_b128 v[32:35], v17 offset:53504
    v_mfma_f32_16x16x32_bf16 v[80:83], a[212:215], v[40:43], v[80:83]
    s_waitcnt lgkmcnt(4)
    v_mfma_f32_16x16x32_bf16 v[68:71], a[216:219], v[44:47], v[68:71]
    ds_read_b128 v[36:39], v18 offset:49408
    v_mfma_f32_16x16x32_bf16 v[72:75], a[220:223], v[44:47], v[72:75]
    v_mfma_f32_16x16x32_bf16 v[76:79], a[216:219], v[48:51], v[76:79]
    ds_read_b128 v[40:43], v18 offset:53504
    v_mfma_f32_16x16x32_bf16 v[80:83], a[220:223], v[48:51], v[80:83]
    s_waitcnt lgkmcnt(4)
    v_mfma_f32_16x16x32_bf16 v[68:71], a[224:227], v[20:23], v[68:71]
    ds_read_b128 v[44:47], v19 offset:49408
    s_add_u32 m0, s21, 84992
    v_mfma_f32_16x16x32_bf16 v[72:75], a[228:231], v[20:23], v[72:75]
    buffer_load_dwordx4 v11, s[8:11], s20 offen lds
    v_mfma_f32_16x16x32_bf16 v[76:79], a[224:227], v[24:27], v[76:79]
    ds_read_b128 v[48:51], v19 offset:53504
    v_mfma_f32_16x16x32_bf16 v[80:83], a[228:231], v[24:27], v[80:83]
    s_waitcnt lgkmcnt(4)
    v_mfma_f32_16x16x32_bf16 v[68:71], a[232:235], v[28:31], v[68:71]
    s_waitcnt vmcnt(28)
    s_barrier
    ds_read_b128 v[20:23], v12 offset:0
    v_mfma_f32_16x16x32_bf16 v[72:75], a[236:239], v[28:31], v[72:75]
    s_add_u32 s20, s20, 512
    v_mfma_f32_16x16x32_bf16 v[76:79], a[232:235], v[32:35], v[76:79]
    ds_read_b128 v[24:27], v12 offset:4096
    v_mfma_f32_16x16x32_bf16 v[80:83], a[236:239], v[32:35], v[80:83]
    s_waitcnt lgkmcnt(4)
    v_mfma_f32_16x16x32_bf16 v[68:71], a[240:243], v[36:39], v[68:71]
    ds_read_b128 v[28:31], v13 offset:0
    s_add_u32 m0, s21, 98304
    v_mfma_f32_16x16x32_bf16 v[72:75], a[244:247], v[36:39], v[72:75]
    buffer_load_dwordx4 v8, s[8:11], s20 offen lds
    v_mfma_f32_16x16x32_bf16 v[76:79], a[240:243], v[40:43], v[76:79]
    ds_read_b128 v[32:35], v13 offset:4096
    v_mfma_f32_16x16x32_bf16 v[80:83], a[244:247], v[40:43], v[80:83]
    s_waitcnt lgkmcnt(4)
    v_mfma_f32_16x16x32_bf16 v[68:71], a[248:251], v[44:47], v[68:71]
    ds_read_b128 v[36:39], v14 offset:0
    v_mfma_f32_16x16x32_bf16 v[72:75], a[252:255], v[44:47], v[72:75]
    v_mfma_f32_16x16x32_bf16 v[76:79], a[248:251], v[48:51], v[76:79]
    ds_read_b128 v[40:43], v14 offset:4096
    v_mfma_f32_16x16x32_bf16 v[80:83], a[252:255], v[48:51], v[80:83]
    s_waitcnt lgkmcnt(4)
    s_add_u32 s22, s22, 1
    s_cmp_ge_u32 s22, s23
    s_cbranch_scc0 L_st_461
    s_branch L_fl1_457
L_st_462:
    v_mfma_f32_16x16x32_bf16 v[52:55], a[0:3], v[20:23], 0
    ds_read_b128 v[44:47], v15 offset:0
    s_add_u32 m0, s21, 99328
    s_sub_u32 s39, s22, 1
    v_mfma_f32_16x16x32_bf16 v[56:59], a[4:7], v[20:23], 0
    buffer_load_dwordx4 v9, s[8:11], s20 offen lds
    v_mfma_f32_16x16x32_bf16 v[60:63], a[0:3], v[24:27], 0
    ds_read_b128 v[48:51], v15 offset:4096
    s_bitcmp1_b32 s39, 1
    s_cselect_b32 s38, s54, s55
    v_mfma_f32_16x16x32_bf16 v[64:67], a[4:7], v[24:27], 0
    s_waitcnt lgkmcnt(4)
    v_mfma_f32_16x16x32_bf16 v[52:55], a[8:11], v[28:31], v[52:55]
    ds_read_b128 v[20:23], v12 offset:256
    s_add_u32 s38, s38, s44
    s_waitcnt vmcnt(5)
    v_mfma_f32_16x16x32_bf16 v[56:59], a[12:15], v[28:31], v[56:59]
    s_lshl_b32 s42, s39, 20
    s_add_u32 s38, s38, s42
    ds_write_b32 v101, v87
    v_mfma_f32_16x16x32_bf16 v[60:63], a[8:11], v[32:35], v[60:63]
    ds_read_b128 v[24:27], v12 offset:4352
    s_cmp_eq_u32 s37, 0
    s_cselect_b32 s38, 0x7ff00000, s38
    v_mfma_f32_16x16x32_bf16 v[64:67], a[12:15], v[32:35], v[64:67]
    s_waitcnt lgkmcnt(4)
    v_mfma_f32_16x16x32_bf16 v[52:55], a[16:19], v[36:39], v[52:55]
    ds_read_b128 v[28:31], v13 offset:256
    s_add_u32 m0, s21, 100352
    v_mfma_f32_16x16x32_bf16 v[56:59], a[20:23], v[36:39], v[56:59]
    buffer_load_dwordx4 v10, s[8:11], s20 offen lds
    s_mov_b32 s37, 1
    v_mfma_f32_16x16x32_bf16 v[60:63], a[16:19], v[40:43], v[60:63]
    ds_read_b128 v[32:35], v13 offset:4352
    v_cvt_pk_bf16_f32 v88, v68, v69
    v_mfma_f32_16x16x32_bf16 v[64:67], a[20:23], v[40:43], v[64:67]
    s_waitcnt lgkmcnt(4)
    v_cvt_pk_bf16_f32 v89, v70, v71
    v_mfma_f32_16x16x32_bf16 v[52:55], a[24:27], v[44:47], v[52:55]
    ds_read_b128 v[36:39], v14 offset:256
    v_cvt_pk_bf16_f32 v90, v72, v73
    v_mfma_f32_16x16x32_bf16 v[56:59], a[28:31], v[44:47], v[56:59]
    v_cvt_pk_bf16_f32 v91, v74, v75
    v_mfma_f32_16x16x32_bf16 v[60:63], a[24:27], v[48:51], v[60:63]
    ds_read_b128 v[40:43], v14 offset:4352
    buffer_store_dwordx4 v[88:91], v86, s[12:15], s38 offen offset:0
    v_mfma_f32_16x16x32_bf16 v[64:67], a[28:31], v[48:51], v[64:67]
    s_waitcnt lgkmcnt(4)
    v_cvt_pk_bf16_f32 v92, v76, v77
    v_cvt_pk_bf16_f32 v93, v78, v79
    v_mfma_f32_16x16x32_bf16 v[52:55], a[32:35], v[20:23], v[52:55]
    ds_read_b128 v[44:47], v15 offset:256
    s_add_u32 m0, s21, 101376
    v_mfma_f32_16x16x32_bf16 v[56:59], a[36:39], v[20:23], v[56:59]
    buffer_load_dwordx4 v11, s[8:11], s20 offen lds
    v_cvt_pk_bf16_f32 v94, v80, v81
    v_mfma_f32_16x16x32_bf16 v[60:63], a[32:35], v[24:27], v[60:63]
    ds_read_b128 v[48:51], v15 offset:4352
    v_cvt_pk_bf16_f32 v95, v82, v83
    v_mfma_f32_16x16x32_bf16 v[64:67], a[36:39], v[24:27], v[64:67]
    s_waitcnt lgkmcnt(4)
    buffer_store_dwordx4 v[92:95], v86, s[12:15], s38 offen offset:128
    v_mfma_f32_16x16x32_bf16 v[52:55], a[40:43], v[28:31], v[52:55]
    s_waitcnt vmcnt(44)
    s_barrier
    ds_read_b128 v[20:23], v12 offset:16384
    v_mfma_f32_16x16x32_bf16 v[56:59], a[44:47], v[28:31], v[56:59]
    s_add_u32 s20, s20, 512
    v_mfma_f32_16x16x32_bf16 v[60:63], a[40:43], v[32:35], v[60:63]
    ds_read_b128 v[24:27], v12 offset:20480
    ds_read_b32 v87, v102
    v_mfma_f32_16x16x32_bf16 v[64:67], a[44:47], v[32:35], v[64:67]
    s_waitcnt lgkmcnt(4)
    v_mfma_f32_16x16x32_bf16 v[52:55], a[48:51], v[36:39], v[52:55]
    ds_read_b128 v[28:31], v13 offset:16384
    s_add_u32 m0, s21, 114688
    v_mfma_f32_16x16x32_bf16 v[56:59], a[52:55], v[36:39], v[56:59]
    buffer_load_dwordx4 v8, s[8:11], s20 offen lds
    v_mfma_f32_16x16x32_bf16 v[60:63], a[48:51], v[40:43], v[60:63]
    ds_read_b128 v[32:35], v13 offset:20480
    v_mfma_f32_16x16x32_bf16 v[64:67], a[52:55], v[40:43], v[64:67]
    s_waitcnt lgkmcnt(4)
    v_mfma_f32_16x16x32_bf16 v[52:55], a[56:59], v[44:47], v[52:55]
    ds_read_b128 v[36:39], v14 offset:16384
    v_mfma_f32_16x16x32_bf16 v[56:59], a[60:63], v[44:47], v[56:59]
    v_mfma_f32_16x16x32_bf16 v[60:63], a[56:59], v[48:51], v[60:63]
    ds_read_b128 v[40:43], v14 offset:20480
    v_mfma_f32_16x16x32_bf16 v[64:67], a[60:63], v[48:51], v[64:67]
    s_waitcnt lgkmcnt(4)
    v_mfma_f32_16x16x32_bf16 v[52:55], a[64:67], v[20:23], v[52:55]
    ds_read_b128 v[44:47], v15 offset:16384
    s_add_u32 m0, s21, 115712
    v_mfma_f32_16x16x32_bf16 v[56:59], a[68:71], v[20:23], v[56:59]
    buffer_load_dwordx4 v9, s[8:11], s20 offen lds
    v_mfma_f32_16x16x32_bf16 v[60:63], a[64:67], v[24:27], v[60:63]
    ds_read_b128 v[48:51], v15 offset:20480
    s_waitcnt vmcnt(13)
    s_branch L_att_450
L_attr_455:
    v_mfma_f32_16x16x32_bf16 v[64:67], a[68:71], v[24:27], v[64:67]
    s_waitcnt lgkmcnt(4)
    s_add_u32 s43, s94, 0
    buffer_store_dwordx4 v[168:171], v100, s[12:15], s43 offen offset:2048 sc1
    v_mfma_f32_16x16x32_bf16 v[52:55], a[72:75], v[28:31], v[52:55]
    ds_read_b128 v[20:23], v12 offset:16640
    v_mfma_f32_16x16x32_bf16 v[56:59], a[76:79], v[28:31], v[56:59]
    v_mfma_f32_16x16x32_bf16 v[60:63], a[72:75], v[32:35], v[60:63]
    ds_read_b128 v[24:27], v12 offset:20736
    s_add_u32 s43, s50, 0
    buffer_load_dwordx4 v[136:139], v96, s[12:15], s43 offen offset:0
    v_mfma_f32_16x16x32_bf16 v[64:67], a[76:79], v[32:35], v[64:67]
    s_waitcnt lgkmcnt(4)
    s_add_u32 s24, s24, 1
    v_mfma_f32_16x16x32_bf16 v[52:55], a[80:83], v[36:39], v[52:55]
    ds_read_b128 v[28:31], v13 offset:16640
    s_add_u32 m0, s21, 116736
    v_mfma_f32_16x16x32_bf16 v[56:59], a[84:87], v[36:39], v[56:59]
    buffer_load_dwordx4 v10, s[8:11], s20 offen lds
    v_mfma_f32_16x16x32_bf16 v[60:63], a[80:83], v[40:43], v[60:63]
    ds_read_b128 v[32:35], v13 offset:20736
    v_mfma_f32_16x16x32_bf16 v[64:67], a[84:87], v[40:43], v[64:67]
    s_waitcnt lgkmcnt(4)
    s_add_u32 s43, s50, 0
    buffer_load_dwordx4 v[140:143], v96, s[12:15], s43 offen offset:1024
    v_mfma_f32_16x16x32_bf16 v[52:55], a[88:91], v[44:47], v[52:55]
    ds_read_b128 v[36:39], v14 offset:16640
    s_min_u32 s24, s24, 63
    v_mfma_f32_16x16x32_bf16 v[56:59], a[92:95], v[44:47], v[56:59]
    s_lshl_b32 s53, s24, 16
    v_mfma_f32_16x16x32_bf16 v[60:63], a[88:91], v[48:51], v[60:63]
    ds_read_b128 v[40:43], v14 offset:20736
    s_add_u32 s43, s94, 0
    buffer_store_dwordx4 v[172:175], v100, s[12:15], s43 offen offset:2560 sc1
    v_mfma_f32_16x16x32_bf16 v[64:67], a[92:95], v[48:51], v[64:67]
    s_waitcnt lgkmcnt(4)
    v_mfma_f32_16x16x32_bf16 v[52:55], a[96:99], v[20:23], v[52:55]
    ds_read_b128 v[44:47], v15 offset:16640
    s_add_u32 m0, s21, 117760
    v_mfma_f32_16x16x32_bf16 v[56:59], a[100:103], v[20:23], v[56:59]
    buffer_load_dwordx4 v11, s[8:11], s20 offen lds
    v_mfma_f32_16x16x32_bf16 v[60:63], a[96:99], v[24:27], v[60:63]
    ds_read_b128 v[48:51], v15 offset:20736
    v_mfma_f32_16x16x32_bf16 v[64:67], a[100:103], v[24:27], v[64:67]
    s_waitcnt lgkmcnt(4)
    s_add_u32 s43, s48, 0
    buffer_load_dwordx4 v[104:107], v96, s[12:15], s43 offen offset:0
    v_mfma_f32_16x16x32_bf16 v[52:55], a[104:107], v[28:31], v[52:55]
    s_waitcnt vmcnt(29)
    s_barrier
    ds_read_b128 v[20:23], v12 offset:32768
    v_mfma_f32_16x16x32_bf16 v[56:59], a[108:111], v[28:31], v[56:59]
    s_mov_b32 s20, s53
    v_mfma_f32_16x16x32_bf16 v[60:63], a[104:107], v[32:35], v[60:63]
    ds_read_b128 v[24:27], v12 offset:36864
    s_add_u32 s43, s48, 0
    buffer_load_dwordx4 v[108:111], v96, s[12:15], s43 offen offset:1024
    v_mfma_f32_16x16x32_bf16 v[64:67], a[108:111], v[32:35], v[64:67]
    s_waitcnt lgkmcnt(4)
    v_mfma_f32_16x16x32_bf16 v[52:55], a[112:115], v[36:39], v[52:55]
    ds_read_b128 v[28:31], v13 offset:32768
    s_add_u32 m0, s21, 0
    v_mfma_f32_16x16x32_bf16 v[56:59], a[116:119], v[36:39], v[56:59]
    buffer_load_dwordx4 v8, s[8:11], s20 offen lds
    v_mfma_f32_16x16x32_bf16 v[60:63], a[112:115], v[40:43], v[60:63]
    ds_read_b128 v[32:35], v13 offset:36864
    v_mfma_f32_16x16x32_bf16 v[64:67], a[116:119], v[40:43], v[64:67]
    s_waitcnt lgkmcnt(4)
    s_add_u32 s43, s94, 4096
    buffer_store_dwordx4 v[176:179], v100, s[12:15], s43 offen offset:2048 sc1
    v_mfma_f32_16x16x32_bf16 v[52:55], a[120:123], v[44:47], v[52:55]
    ds_read_b128 v[36:39], v14 offset:32768
    v_mfma_f32_16x16x32_bf16 v[56:59], a[124:127], v[44:47], v[56:59]
    v_mfma_f32_16x16x32_bf16 v[60:63], a[120:123], v[48:51], v[60:63]
    ds_read_b128 v[40:43], v14 offset:36864
    v_mfma_f32_16x16x32_bf16 v[64:67], a[124:127], v[48:51], v[64:67]
    s_waitcnt lgkmcnt(4)
    v_mfma_f32_16x16x32_bf16 v[52:55], a[128:131], v[20:23], v[52:55]
    ds_read_b128 v[44:47], v15 offset:32768
    s_add_u32 m0, s21, 1024
    v_mfma_f32_16x16x32_bf16 v[56:59], a[132:135], v[20:23], v[56:59]
    buffer_load_dwordx4 v9, s[8:11], s20 offen lds
    v_mfma_f32_16x16x32_bf16 v[60:63], a[128:131], v[24:27], v[60:63]
    ds_read_b128 v[48:51], v15 offset:36864
    v_mfma_f32_16x16x32_bf16 v[64:67], a[132:135], v[24:27], v[64:67]
    s_waitcnt lgkmcnt(4)
    s_add_u32 s43, s50, 4096
    buffer_load_dwordx4 v[144:147], v96, s[12:15], s43 offen offset:0
    v_mfma_f32_16x16x32_bf16 v[52:55], a[136:139], v[28:31], v[52:55]
    ds_read_b128 v[20:23], v12 offset:33024
    v_mfma_f32_16x16x32_bf16 v[56:59], a[140:143], v[28:31], v[56:59]
    v_mfma_f32_16x16x32_bf16 v[60:63], a[136:139], v[32:35], v[60:63]
    ds_read_b128 v[24:27], v12 offset:37120
    s_add_u32 s43, s94, 4096
    buffer_store_dwordx4 v[180:183], v100, s[12:15], s43 offen offset:2560 sc1
    v_mfma_f32_16x16x32_bf16 v[64:67], a[140:143], v[32:35], v[64:67]
    s_waitcnt lgkmcnt(4)
    v_mfma_f32_16x16x32_bf16 v[52:55], a[144:147], v[36:39], v[52:55]
    ds_read_b128 v[28:31], v13 offset:33024
    s_add_u32 m0, s21, 2048
    v_mfma_f32_16x16x32_bf16 v[56:59], a[148:151], v[36:39], v[56:59]
    buffer_load_dwordx4 v10, s[8:11], s20 offen lds
    v_mfma_f32_16x16x32_bf16 v[60:63], a[144:147], v[40:43], v[60:63]
    ds_read_b128 v[32:35], v13 offset:37120
    v_mfma_f32_16x16x32_bf16 v[64:67], a[148:151], v[40:43], v[64:67]
    s_waitcnt lgkmcnt(4)
    s_add_u32 s43, s50, 4096
    buffer_load_dwordx4 v[148:151], v96, s[12:15], s43 offen offset:1024
    v_mfma_f32_16x16x32_bf16 v[52:55], a[152:155], v[44:47], v[52:55]
    ds_read_b128 v[36:39], v14 offset:33024
    v_mfma_f32_16x16x32_bf16 v[56:59], a[156:159], v[44:47], v[56:59]
    v_mfma_f32_16x16x32_bf16 v[60:63], a[152:155], v[48:51], v[60:63]
    ds_read_b128 v[40:43], v14 offset:37120
    s_add_u32 s43, s48, 4096
    buffer_load_dwordx4 v[112:115], v96, s[12:15], s43 offen offset:0
    v_mfma_f32_16x16x32_bf16 v[64:67], a[156:159], v[48:51], v[64:67]
    s_waitcnt lgkmcnt(4)
    v_mfma_f32_16x16x32_bf16 v[52:55], a[160:163], v[20:23], v[52:55]
    ds_read_b128 v[44:47], v15 offset:33024
    s_add_u32 m0, s21, 3072
    v_mfma_f32_16x16x32_bf16 v[56:59], a[164:167], v[20:23], v[56:59]
    buffer_load_dwordx4 v11, s[8:11], s20 offen lds
    v_mfma_f32_16x16x32_bf16 v[60:63], a[160:163], v[24:27], v[60:63]
    ds_read_b128 v[48:51], v15 offset:37120
    v_mfma_f32_16x16x32_bf16 v[64:67], a[164:167], v[24:27], v[64:67]
    s_waitcnt lgkmcnt(4)
    s_add_u32 s43, s94, 16384
    buffer_store_dwordx4 v[184:187], v100, s[12:15], s43 offen offset:2048 sc1
    v_mfma_f32_16x16x32_bf16 v[52:55], a[168:171], v[28:31], v[52:55]
    s_waitcnt vmcnt(35)
    s_barrier
    ds_read_b128 v[20:23], v12 offset:49152
    v_mfma_f32_16x16x32_bf16 v[56:59], a[172:175], v[28:31], v[56:59]
    s_add_u32 s20, s20, 512
    v_mfma_f32_16x16x32_bf16 v[60:63], a[168:171], v[32:35], v[60:63]
    ds_read_b128 v[24:27], v12 offset:53248
    s_add_u32 s43, s48, 4096
    buffer_load_dwordx4 v[116:119], v96, s[12:15], s43 offen offset:1024
    v_mfma_f32_16x16x32_bf16 v[64:67], a[172:175], v[32:35], v[64:67]
    s_waitcnt lgkmcnt(4)
    v_mfma_f32_16x16x32_bf16 v[52:55], a[176:179], v[36:39], v[52:55]
    ds_read_b128 v[28:31], v13 offset:49152
    s_add_u32 m0, s21, 16384
    v_mfma_f32_16x16x32_bf16 v[56:59], a[180:183], v[36:39], v[56:59]
    buffer_load_dwordx4 v8, s[8:11], s20 offen lds
    v_mfma_f32_16x16x32_bf16 v[60:63], a[176:179], v[40:43], v[60:63]
    ds_read_b128 v[32:35], v13 offset:53248
    v_mfma_f32_16x16x32_bf16 v[64:67], a[180:183], v[40:43], v[64:67]
    s_waitcnt lgkmcnt(4)
    s_add_u32 s43, s94, 16384
    buffer_store_dwordx4 v[188:191], v100, s[12:15], s43 offen offset:2560 sc1
    v_mfma_f32_16x16x32_bf16 v[52:55], a[184:187], v[44:47], v[52:55]
    ds_read_b128 v[36:39], v14 offset:49152
    v_mfma_f32_16x16x32_bf16 v[56:59], a[188:191], v[44:47], v[56:59]
    v_mfma_f32_16x16x32_bf16 v[60:63], a[184:187], v[48:51], v[60:63]
    ds_read_b128 v[40:43], v14 offset:53248
    s_add_u32 s43, s50, 16384
    buffer_load_dwordx4 v[152:155], v96, s[12:15], s43 offen offset:0
    v_mfma_f32_16x16x32_bf16 v[64:67], a[188:191], v[48:51], v[64:67]
    s_waitcnt lgkmcnt(4)
    v_mfma_f32_16x16x32_bf16 v[52:55], a[192:195], v[20:23], v[52:55]
    ds_read_b128 v[44:47], v15 offset:49152
    s_add_u32 m0, s21, 17408
    v_mfma_f32_16x16x32_bf16 v[56:59], a[196:199], v[20:23], v[56:59]
    buffer_load_dwordx4 v9, s[8:11], s20 offen lds
    v_mfma_f32_16x16x32_bf16 v[60:63], a[192:195], v[24:27], v[60:63]
    ds_read_b128 v[48:51], v15 offset:53248
    v_mfma_f32_16x16x32_bf16 v[64:67], a[196:199], v[24:27], v[64:67]
    s_waitcnt lgkmcnt(4)
    v_mfma_f32_16x16x32_bf16 v[52:55], a[200:203], v[28:31], v[52:55]
    ds_read_b128 v[20:23], v12 offset:49408
    v_mfma_f32_16x16x32_bf16 v[56:59], a[204:207], v[28:31], v[56:59]
    v_mfma_f32_16x16x32_bf16 v[60:63], a[200:203], v[32:35], v[60:63]
    ds_read_b128 v[24:27], v12 offset:53504
    s_add_u32 s43, s94, 20480
    buffer_store_dwordx4 v[192:195], v100, s[12:15], s43 offen offset:2048 sc1
    v_mfma_f32_16x16x32_bf16 v[64:67], a[204:207], v[32:35], v[64:67]
    s_waitcnt lgkmcnt(4)
    v_mfma_f32_16x16x32_bf16 v[52:55], a[208:211], v[36:39], v[52:55]
    ds_read_b128 v[28:31], v13 offset:49408
    s_add_u32 m0, s21, 18432
    v_mfma_f32_16x16x32_bf16 v[56:59], a[212:215], v[36:39], v[56:59]
    buffer_load_dwordx4 v10, s[8:11], s20 offen lds
    v_mfma_f32_16x16x32_bf16 v[60:63], a[208:211], v[40:43], v[60:63]
    ds_read_b128 v[32:35], v13 offset:53504
    v_mfma_f32_16x16x32_bf16 v[64:67], a[212:215], v[40:43], v[64:67]
    s_waitcnt lgkmcnt(4)
    s_add_u32 s43, s50, 16384
    buffer_load_dwordx4 v[156:159], v96, s[12:15], s43 offen offset:1024
    v_mfma_f32_16x16x32_bf16 v[52:55], a[216:219], v[44:47], v[52:55]
    ds_read_b128 v[36:39], v14 offset:49408
    v_mfma_f32_16x16x32_bf16 v[56:59], a[220:223], v[44:47], v[56:59]
    v_mfma_f32_16x16x32_bf16 v[60:63], a[216:219], v[48:51], v[60:63]
    ds_read_b128 v[40:43], v14 offset:53504
    s_add_u32 s43, s48, 16384
    buffer_load_dwordx4 v[120:123], v96, s[12:15], s43 offen offset:0
    v_mfma_f32_16x16x32_bf16 v[64:67], a[220:223], v[48:51], v[64:67]
    s_waitcnt lgkmcnt(4)
    v_mfma_f32_16x16x32_bf16 v[52:55], a[224:227], v[20:23], v[52:55]
    ds_read_b128 v[44:47], v15 offset:49408
    s_add_u32 m0, s21, 19456
    v_mfma_f32_16x16x32_bf16 v[56:59], a[228:231], v[20:23], v[56:59]
    buffer_load_dwordx4 v11, s[8:11], s20 offen lds
    v_mfma_f32_16x16x32_bf16 v[60:63], a[224:227], v[24:27], v[60:63]
    ds_read_b128 v[48:51], v15 offset:53504
    v_mfma_f32_16x16x32_bf16 v[64:67], a[228:231], v[24:27], v[64:67]
    s_waitcnt lgkmcnt(4)
    s_add_u32 s43, s94, 20480
    buffer_store_dwordx4 v[196:199], v100, s[12:15], s43 offen offset:2560 sc1
    v_mfma_f32_16x16x32_bf16 v[52:55], a[232:235], v[28:31], v[52:55]
    s_waitcnt vmcnt(42)
    s_barrier
    ds_read_b128 v[20:23], v16 offset:0
    v_mfma_f32_16x16x32_bf16 v[56:59], a[236:239], v[28:31], v[56:59]
    s_add_u32 s20, s20, 512
    v_mfma_f32_16x16x32_bf16 v[60:63], a[232:235], v[32:35], v[60:63]
    ds_read_b128 v[24:27], v16 offset:4096
    s_add_u32 s43, s48, 16384
    buffer_load_dwordx4 v[124:127], v96, s[12:15], s43 offen offset:1024
    v_mfma_f32_16x16x32_bf16 v[64:67], a[236:239], v[32:35], v[64:67]
    s_waitcnt lgkmcnt(4)
    v_mfma_f32_16x16x32_bf16 v[52:55], a[240:243], v[36:39], v[52:55]
    ds_read_b128 v[28:31], v17 offset:0
    s_add_u32 m0, s21, 32768
    v_mfma_f32_16x16x32_bf16 v[56:59], a[244:247], v[36:39], v[56:59]
    buffer_load_dwordx4 v8, s[8:11], s20 offen lds
    v_mfma_f32_16x16x32_bf16 v[60:63], a[240:243], v[40:43], v[60:63]
    ds_read_b128 v[32:35], v17 offset:4096
    v_mfma_f32_16x16x32_bf16 v[64:67], a[244:247], v[40:43], v[64:67]
    s_waitcnt lgkmcnt(4)
    v_mfma_f32_16x16x32_bf16 v[52:55], a[248:251], v[44:47], v[52:55]
    ds_read_b128 v[36:39], v18 offset:0
    v_mfma_f32_16x16x32_bf16 v[56:59], a[252:255], v[44:47], v[56:59]
    v_mfma_f32_16x16x32_bf16 v[60:63], a[248:251], v[48:51], v[60:63]
    ds_read_b128 v[40:43], v18 offset:4096
    v_mfma_f32_16x16x32_bf16 v[64:67], a[252:255], v[48:51], v[64:67]
    s_waitcnt lgkmcnt(4)
    s_add_u32 s22, s22, 1
    s_cmp_ge_u32 s22, s23
    s_cbranch_scc1 L_fl0_456
    v_mfma_f32_16x16x32_bf16 v[68:71], a[0:3], v[20:23], 0
    ds_read_b128 v[44:47], v19 offset:0
    s_add_u32 m0, s21, 33792
    s_sub_u32 s39, s22, 1
    v_mfma_f32_16x16x32_bf16 v[72:75], a[4:7], v[20:23], 0
    buffer_load_dwordx4 v9, s[8:11], s20 offen lds
    s_bitcmp1_b32 s39, 1
    s_cselect_b32 s38, s54, s55
    v_mfma_f32_16x16x32_bf16 v[76:79], a[0:3], v[24:27], 0
    ds_read_b128 v[48:51], v19 offset:4096
    v_mfma_f32_16x16x32_bf16 v[80:83], a[4:7], v[24:27], 0
    s_waitcnt lgkmcnt(4)
    s_add_u32 s43, s50, 20480
    buffer_load_dwordx4 v[160:163], v96, s[12:15], s43 offen offset:0
    v_mfma_f32_16x16x32_bf16 v[68:71], a[8:11], v[28:31], v[68:71]
    ds_read_b128 v[20:23], v16 offset:256
    s_add_u32 s38, s38, s44
    v_mfma_f32_16x16x32_bf16 v[72:75], a[12:15], v[28:31], v[72:75]
    s_lshl_b32 s42, s39, 20
    s_add_u32 s38, s38, s42
    v_mfma_f32_16x16x32_bf16 v[76:79], a[8:11], v[32:35], v[76:79]
    ds_read_b128 v[24:27], v16 offset:4352
    s_add_u32 s43, s50, 20480
    buffer_load_dwordx4 v[164:167], v96, s[12:15], s43 offen offset:1024
    v_mfma_f32_16x16x32_bf16 v[80:83], a[12:15], v[32:35], v[80:83]
    s_waitcnt lgkmcnt(4)
    s_cmp_eq_u32 s37, 0
    s_cselect_b32 s38, 0x7ff00000, s38
    v_mfma_f32_16x16x32_bf16 v[68:71], a[16:19], v[36:39], v[68:71]
    ds_read_b128 v[28:31], v17 offset:256
    s_add_u32 m0, s21, 34816
    v_mfma_f32_16x16x32_bf16 v[72:75], a[20:23], v[36:39], v[72:75]
    buffer_load_dwordx4 v10, s[8:11], s20 offen lds
    s_mov_b32 s37, 1
    v_mfma_f32_16x16x32_bf16 v[76:79], a[16:19], v[40:43], v[76:79]
    ds_read_b128 v[32:35], v17 offset:4352
    v_cvt_pk_bf16_f32 v88, v52, v53
    v_mfma_f32_16x16x32_bf16 v[80:83], a[20:23], v[40:43], v[80:83]
    s_waitcnt lgkmcnt(4)
    s_add_u32 s43, s48, 20480
    buffer_load_dwordx4 v[128:131], v96, s[12:15], s43 offen offset:0
    v_mfma_f32_16x16x32_bf16 v[68:71], a[24:27], v[44:47], v[68:71]
    ds_read_b128 v[36:39], v18 offset:256
    v_cvt_pk_bf16_f32 v89, v54, v55
    v_cvt_pk_bf16_f32 v90, v56, v57
    v_mfma_f32_16x16x32_bf16 v[72:75], a[28:31], v[44:47], v[72:75]
    v_cvt_pk_bf16_f32 v91, v58, v59
    v_mfma_f32_16x16x32_bf16 v[76:79], a[24:27], v[48:51], v[76:79]
    ds_read_b128 v[40:43], v18 offset:4352
    buffer_store_dwordx4 v[88:91], v86, s[12:15], s38 offen offset:0
    v_mfma_f32_16x16x32_bf16 v[80:83], a[28:31], v[48:51], v[80:83]
    s_waitcnt lgkmcnt(4)
    v_cvt_pk_bf16_f32 v92, v60, v61
    v_cvt_pk_bf16_f32 v93, v62, v63
    v_mfma_f32_16x16x32_bf16 v[68:71], a[32:35], v[20:23], v[68:71]
    ds_read_b128 v[44:47], v19 offset:256
    s_add_u32 m0, s21, 35840
    v_mfma_f32_16x16x32_bf16 v[72:75], a[36:39], v[20:23], v[72:75]
    buffer_load_dwordx4 v11, s[8:11], s20 offen lds
    v_cvt_pk_bf16_f32 v94, v64, v65
    v_mfma_f32_16x16x32_bf16 v[76:79], a[32:35], v[24:27], v[76:79]
    ds_read_b128 v[48:51], v19 offset:4352
    v_cvt_pk_bf16_f32 v95, v66, v67
    v_mfma_f32_16x16x32_bf16 v[80:83], a[36:39], v[24:27], v[80:83]
    s_waitcnt lgkmcnt(4)
    buffer_store_dwordx4 v[92:95], v86, s[12:15], s38 offen offset:128
    v_mfma_f32_16x16x32_bf16 v[68:71], a[40:43], v[28:31], v[68:71]
    s_waitcnt vmcnt(47)
    s_barrier
    ds_read_b128 v[20:23], v16 offset:16384
    v_mfma_f32_16x16x32_bf16 v[72:75], a[44:47], v[28:31], v[72:75]
    s_add_u32 s20, s20, 512
    v_mfma_f32_16x16x32_bf16 v[76:79], a[40:43], v[32:35], v[76:79]
    ds_read_b128 v[24:27], v16 offset:20480
    s_add_u32 s43, s48, 20480
    buffer_load_dwordx4 v[132:135], v96, s[12:15], s43 offen offset:1024
    v_mfma_f32_16x16x32_bf16 v[80:83], a[44:47], v[32:35], v[80:83]
    s_waitcnt lgkmcnt(4)
    v_mfma_f32_16x16x32_bf16 v[68:71], a[48:51], v[36:39], v[68:71]
    ds_read_b128 v[28:31], v17 offset:16384
    s_add_u32 m0, s21, 49152
    v_mfma_f32_16x16x32_bf16 v[72:75], a[52:55], v[36:39], v[72:75]
    buffer_load_dwordx4 v8, s[8:11], s20 offen lds
    v_mfma_f32_16x16x32_bf16 v[76:79], a[48:51], v[40:43], v[76:79]
    ds_read_b128 v[32:35], v17 offset:20480
    v_mfma_f32_16x16x32_bf16 v[80:83], a[52:55], v[40:43], v[80:83]
    s_waitcnt lgkmcnt(4)
    s_add_u32 s43, s48, 0
    buffer_load_dwordx4 v[168:171], v98, s[12:15], s43 offen offset:2048
    v_mfma_f32_16x16x32_bf16 v[68:71], a[56:59], v[44:47], v[68:71]
    ds_read_b128 v[36:39], v18 offset:16384
    v_mfma_f32_16x16x32_bf16 v[72:75], a[60:63], v[44:47], v[72:75]
    v_mfma_f32_16x16x32_bf16 v[76:79], a[56:59], v[48:51], v[76:79]
    ds_read_b128 v[40:43], v18 offset:20480
    s_add_u32 s43, s48, 0
    buffer_load_dwordx4 v[172:175], v98, s[12:15], s43 offen offset:3072
    v_mfma_f32_16x16x32_bf16 v[80:83], a[60:63], v[48:51], v[80:83]
    s_waitcnt lgkmcnt(4)
    v_mfma_f32_16x16x32_bf16 v[68:71], a[64:67], v[20:23], v[68:71]
    ds_read_b128 v[44:47], v19 offset:16384
    s_add_u32 m0, s21, 50176
    v_mfma_f32_16x16x32_bf16 v[72:75], a[68:71], v[20:23], v[72:75]
    buffer_load_dwordx4 v9, s[8:11], s20 offen lds
    v_mfma_f32_16x16x32_bf16 v[76:79], a[64:67], v[24:27], v[76:79]
    ds_read_b128 v[48:51], v19 offset:20480
    v_mfma_f32_16x16x32_bf16 v[80:83], a[68:71], v[24:27], v[80:83]
    s_waitcnt lgkmcnt(4)
    s_add_u32 s43, s48, 4096
    buffer_load_dwordx4 v[176:179], v98, s[12:15], s43 offen offset:2048
    v_mfma_f32_16x16x32_bf16 v[68:71], a[72:75], v[28:31], v[68:71]
    ds_read_b128 v[20:23], v16 offset:16640
    v_mfma_f32_16x16x32_bf16 v[72:75], a[76:79], v[28:31], v[72:75]
    v_mfma_f32_16x16x32_bf16 v[76:79], a[72:75], v[32:35], v[76:79]
    ds_read_b128 v[24:27], v16 offset:20736
    s_add_u32 s43, s48, 4096
    buffer_load_dwordx4 v[180:183], v98, s[12:15], s43 offen offset:3072
    v_mfma_f32_16x16x32_bf16 v[80:83], a[76:79], v[32:35], v[80:83]
    s_waitcnt lgkmcnt(4)
    s_add_u32 s24, s24, 1
    v_mfma_f32_16x16x32_bf16 v[68:71], a[80:83], v[36:39], v[68:71]
    ds_read_b128 v[28:31], v17 offset:16640
    s_add_u32 m0, s21, 51200
    v_mfma_f32_16x16x32_bf16 v[72:75], a[84:87], v[36:39], v[72:75]
    buffer_load_dwordx4 v10, s[8:11], s20 offen lds
    v_mfma_f32_16x16x32_bf16 v[76:79], a[80:83], v[40:43], v[76:79]
    ds_read_b128 v[32:35], v17 offset:20736
    v_mfma_f32_16x16x32_bf16 v[80:83], a[84:87], v[40:43], v[80:83]
    s_waitcnt lgkmcnt(4)
    s_add_u32 s43, s48, 16384
    buffer_load_dwordx4 v[184:187], v98, s[12:15], s43 offen offset:2048
    v_mfma_f32_16x16x32_bf16 v[68:71], a[88:91], v[44:47], v[68:71]
    ds_read_b128 v[36:39], v18 offset:16640
    s_min_u32 s24, s24, 63
    v_mfma_f32_16x16x32_bf16 v[72:75], a[92:95], v[44:47], v[72:75]
    s_lshl_b32 s53, s24, 16
    v_mfma_f32_16x16x32_bf16 v[76:79], a[88:91], v[48:51], v[76:79]
    ds_read_b128 v[40:43], v18 offset:20736
    s_add_u32 s43, s48, 16384
    buffer_load_dwordx4 v[188:191], v98, s[12:15], s43 offen offset:3072
    v_mfma_f32_16x16x32_bf16 v[80:83], a[92:95], v[48:51], v[80:83]
    s_waitcnt lgkmcnt(4)
    v_mfma_f32_16x16x32_bf16 v[68:71], a[96:99], v[20:23], v[68:71]
    ds_read_b128 v[44:47], v19 offset:16640
    s_add_u32 m0, s21, 52224
    v_mfma_f32_16x16x32_bf16 v[72:75], a[100:103], v[20:23], v[72:75]
    buffer_load_dwordx4 v11, s[8:11], s20 offen lds
    v_mfma_f32_16x16x32_bf16 v[76:79], a[96:99], v[24:27], v[76:79]
    ds_read_b128 v[48:51], v19 offset:20736
    s_waitcnt vmcnt(21)
    v_mfma_f32_16x16x32_bf16 v[80:83], a[100:103], v[24:27], v[80:83]
    s_waitcnt lgkmcnt(4)
    s_add_u32 s43, s48, 20480
    buffer_load_dwordx4 v[192:195], v98, s[12:15], s43 offen offset:2048
    v_mfma_f32_16x16x32_bf16 v[68:71], a[104:107], v[28:31], v[68:71]
    s_waitcnt vmcnt(54)
    s_barrier
    ds_read_b128 v[20:23], v16 offset:32768
    v_mfma_f32_16x16x32_bf16 v[72:75], a[108:111], v[28:31], v[72:75]
    s_mov_b32 s20, s53
    v_mfma_f32_16x16x32_bf16 v[76:79], a[104:107], v[32:35], v[76:79]
    ds_read_b128 v[24:27], v16 offset:36864
    buffer_atomic_add v84, v85, s[12:15], s51 offen sc1
    v_mfma_f32_16x16x32_bf16 v[80:83], a[108:111], v[32:35], v[80:83]
    s_waitcnt lgkmcnt(4)
    v_mfma_f32_16x16x32_bf16 v[68:71], a[112:115], v[36:39], v[68:71]
    ds_read_b128 v[28:31], v17 offset:32768
    s_add_u32 m0, s21, 65536
    v_mfma_f32_16x16x32_bf16 v[72:75], a[116:119], v[36:39], v[72:75]
    buffer_load_dwordx4 v8, s[8:11], s20 offen lds
    v_mfma_f32_16x16x32_bf16 v[76:79], a[112:115], v[40:43], v[76:79]
    ds_read_b128 v[32:35], v17 offset:36864
    v_mfma_f32_16x16x32_bf16 v[80:83], a[116:119], v[40:43], v[80:83]
    s_waitcnt lgkmcnt(4)
    s_add_u32 s43, s48, 20480
    buffer_load_dwordx4 v[196:199], v98, s[12:15], s43 offen offset:3072
    v_mfma_f32_16x16x32_bf16 v[68:71], a[120:123], v[44:47], v[68:71]
    ds_read_b128 v[36:39], v18 offset:32768
    v_mfma_f32_16x16x32_bf16 v[72:75], a[124:127], v[44:47], v[72:75]
    v_mfma_f32_16x16x32_bf16 v[76:79], a[120:123], v[48:51], v[76:79]
    ds_read_b128 v[40:43], v18 offset:36864
    s_add_u32 m0, s7, 0
    s_add_u32 s43, s48, 0x8000c00
    buffer_load_dwordx4 v96, s[12:15], s43 offen sc1 lds
    v_mfma_f32_16x16x32_bf16 v[80:83], a[124:127], v[48:51], v[80:83]
    s_waitcnt lgkmcnt(4)
    v_mfma_f32_16x16x32_bf16 v[68:71], a[128:131], v[20:23], v[68:71]
    ds_read_b128 v[44:47], v19 offset:32768
    s_add_u32 m0, s21, 66560
    v_mfma_f32_16x16x32_bf16 v[72:75], a[132:135], v[20:23], v[72:75]
    buffer_load_dwordx4 v9, s[8:11], s20 offen lds
    v_mfma_f32_16x16x32_bf16 v[76:79], a[128:131], v[24:27], v[76:79]
    ds_read_b128 v[48:51], v19 offset:36864
    v_mfma_f32_16x16x32_bf16 v[80:83], a[132:135], v[24:27], v[80:83]
    s_waitcnt lgkmcnt(4)
    s_add_u32 m0, s7, 1024
    s_add_u32 s43, s48, 0x8001c00
    buffer_load_dwordx4 v96, s[12:15], s43 offen sc1 lds
    v_mfma_f32_16x16x32_bf16 v[68:71], a[136:139], v[28:31], v[68:71]
    ds_read_b128 v[20:23], v16 offset:33024
    v_mfma_f32_16x16x32_bf16 v[72:75], a[140:143], v[28:31], v[72:75]
    v_mfma_f32_16x16x32_bf16 v[76:79], a[136:139], v[32:35], v[76:79]
    ds_read_b128 v[24:27], v16 offset:37120
    v_mfma_f32_16x16x32_bf16 v[80:83], a[140:143], v[32:35], v[80:83]
    s_waitcnt lgkmcnt(4)
    v_mfma_f32_16x16x32_bf16 v[68:71], a[144:147], v[36:39], v[68:71]
    ds_read_b128 v[28:31], v17 offset:33024
    s_add_u32 m0, s21, 67584
    v_mfma_f32_16x16x32_bf16 v[72:75], a[148:151], v[36:39], v[72:75]
    buffer_load_dwordx4 v10, s[8:11], s20 offen lds
    v_mfma_f32_16x16x32_bf16 v[76:79], a[144:147], v[40:43], v[76:79]
    ds_read_b128 v[32:35], v17 offset:37120
    v_mfma_f32_16x16x32_bf16 v[80:83], a[148:151], v[40:43], v[80:83]
    s_waitcnt lgkmcnt(4)
    s_add_u32 m0, s7, 2048
    s_add_u32 s43, s48, 0x8004c00
    buffer_load_dwordx4 v96, s[12:15], s43 offen sc1 lds
    v_mfma_f32_16x16x32_bf16 v[68:71], a[152:155], v[44:47], v[68:71]
    ds_read_b128 v[36:39], v18 offset:33024
    v_mfma_f32_16x16x32_bf16 v[72:75], a[156:159], v[44:47], v[72:75]
    v_mfma_f32_16x16x32_bf16 v[76:79], a[152:155], v[48:51], v[76:79]
    ds_read_b128 v[40:43], v18 offset:37120
    v_mfma_f32_16x16x32_bf16 v[80:83], a[156:159], v[48:51], v[80:83]
    s_waitcnt lgkmcnt(4)
    v_mfma_f32_16x16x32_bf16 v[68:71], a[160:163], v[20:23], v[68:71]
    ds_read_b128 v[44:47], v19 offset:33024
    s_add_u32 m0, s21, 68608
    v_mfma_f32_16x16x32_bf16 v[72:75], a[164:167], v[20:23], v[72:75]
    buffer_load_dwordx4 v11, s[8:11], s20 offen lds
    v_mfma_f32_16x16x32_bf16 v[76:79], a[160:163], v[24:27], v[76:79]
    ds_read_b128 v[48:51], v19 offset:37120
    v_mfma_f32_16x16x32_bf16 v[80:83], a[164:167], v[24:27], v[80:83]
    s_waitcnt lgkmcnt(4)
    s_add_u32 m0, s7, 3072
    s_add_u32 s43, s48, 0x8005c00
    buffer_load_dwordx4 v96, s[12:15], s43 offen sc1 lds
    v_mfma_f32_16x16x32_bf16 v[68:71], a[168:171], v[28:31], v[68:71]
    s_waitcnt vmcnt(55)
    s_barrier
    ds_read_b128 v[20:23], v16 offset:49152
    v_mfma_f32_16x16x32_bf16 v[72:75], a[172:175], v[28:31], v[72:75]
    s_add_u32 s20, s20, 512
    v_mfma_f32_16x16x32_bf16 v[76:79], a[168:171], v[32:35], v[76:79]
    ds_read_b128 v[24:27], v16 offset:53248
    v_mfma_f32_16x16x32_bf16 v[80:83], a[172:175], v[32:35], v[80:83]
    s_waitcnt lgkmcnt(4)
    v_mfma_f32_16x16x32_bf16 v[68:71], a[176:179], v[36:39], v[68:71]
    ds_read_b128 v[28:31], v17 offset:49152
    s_add_u32 m0, s21, 81920
    v_mfma_f32_16x16x32_bf16 v[72:75], a[180:183], v[36:39], v[72:75]
    buffer_load_dwordx4 v8, s[8:11], s20 offen lds
    v_mfma_f32_16x16x32_bf16 v[76:79], a[176:179], v[40:43], v[76:79]
    ds_read_b128 v[32:35], v17 offset:53248
    v_mfma_f32_16x16x32_bf16 v[80:83], a[180:183], v[40:43], v[80:83]
    s_waitcnt lgkmcnt(4)
    buffer_load_dword v87, v103, s[32:35], 0 offen sc1
    v_mfma_f32_16x16x32_bf16 v[68:71], a[184:187], v[44:47], v[68:71]
    ds_read_b128 v[36:39], v18 offset:49152
    v_mfma_f32_16x16x32_bf16 v[72:75], a[188:191], v[44:47], v[72:75]
    v_mfma_f32_16x16x32_bf16 v[76:79], a[184:187], v[48:51], v[76:79]
    ds_read_b128 v[40:43], v18 offset:53248
    v_mfma_f32_16x16x32_bf16 v[80:83], a[188:191], v[48:51], v[80:83]
    s_waitcnt lgkmcnt(4)
    v_mfma_f32_16x16x32_bf16 v[68:71], a[192:195], v[20:23], v[68:71]
    ds_read_b128 v[44:47], v19 offset:49152
    s_add_u32 m0, s21, 82944
    v_mfma_f32_16x16x32_bf16 v[72:75], a[196:199], v[20:23], v[72:75]
    buffer_load_dwordx4 v9, s[8:11], s20 offen lds
    v_mfma_f32_16x16x32_bf16 v[76:79], a[192:195], v[24:27], v[76:79]
    ds_read_b128 v[48:51], v19 offset:53248
    v_mfma_f32_16x16x32_bf16 v[80:83], a[196:199], v[24:27], v[80:83]
    s_waitcnt lgkmcnt(4)
    v_mfma_f32_16x16x32_bf16 v[68:71], a[200:203], v[28:31], v[68:71]
    ds_read_b128 v[20:23], v16 offset:49408
    v_mfma_f32_16x16x32_bf16 v[72:75], a[204:207], v[28:31], v[72:75]
    v_mfma_f32_16x16x32_bf16 v[76:79], a[200:203], v[32:35], v[76:79]
    ds_read_b128 v[24:27], v16 offset:53504
    v_mfma_f32_16x16x32_bf16 v[80:83], a[204:207], v[32:35], v[80:83]
    s_waitcnt lgkmcnt(4)
    v_mfma_f32_16x16x32_bf16 v[68:71], a[208:211], v[36:39], v[68:71]
    ds_read_b128 v[28:31], v17 offset:49408
    s_add_u32 m0, s21, 83968
    v_mfma_f32_16x16x32_bf16 v[72:75], a[212:215], v[36:39], v[72:75]
    buffer_load_dwordx4 v10, s[8:11], s20 offen lds
    v_mfma_f32_16x16x32_bf16 v[76:79], a[208:211], v[40:43], v[76:79]
    ds_read_b128 v[32:35], v17 offset:53504
    v_mfma_f32_16x16x32_bf16 v[80:83], a[212:215], v[40:43], v[80:83]
    s_waitcnt lgkmcnt(4)
    v_mfma_f32_16x16x32_bf16 v[68:71], a[216:219], v[44:47], v[68:71]
    ds_read_b128 v[36:39], v18 offset:49408
    v_mfma_f32_16x16x32_bf16 v[72:75], a[220:223], v[44:47], v[72:75]
    v_mfma_f32_16x16x32_bf16 v[76:79], a[216:219], v[48:51], v[76:79]
    ds_read_b128 v[40:43], v18 offset:53504
    v_mfma_f32_16x16x32_bf16 v[80:83], a[220:223], v[48:51], v[80:83]
    s_waitcnt lgkmcnt(4)
    v_mfma_f32_16x16x32_bf16 v[68:71], a[224:227], v[20:23], v[68:71]
    ds_read_b128 v[44:47], v19 offset:49408
    s_add_u32 m0, s21, 84992
    v_mfma_f32_16x16x32_bf16 v[72:75], a[228:231], v[20:23], v[72:75]
    buffer_load_dwordx4 v11, s[8:11], s20 offen lds
    v_mfma_f32_16x16x32_bf16 v[76:79], a[224:227], v[24:27], v[76:79]
    ds_read_b128 v[48:51], v19 offset:53504
    v_mfma_f32_16x16x32_bf16 v[80:83], a[228:231], v[24:27], v[80:83]
    s_waitcnt lgkmcnt(4)
    v_mfma_f32_16x16x32_bf16 v[68:71], a[232:235], v[28:31], v[68:71]
    s_waitcnt vmcnt(49)
    s_barrier
    ds_read_b128 v[20:23], v12 offset:0
    v_mfma_f32_16x16x32_bf16 v[72:75], a[236:239], v[28:31], v[72:75]
    s_add_u32 s20, s20, 512
    v_mfma_f32_16x16x32_bf16 v[76:79], a[232:235], v[32:35], v[76:79]
    ds_read_b128 v[24:27], v12 offset:4096
    v_mfma_f32_16x16x32_bf16 v[80:83], a[236:239], v[32:35], v[80:83]
    s_waitcnt lgkmcnt(4)
    v_mfma_f32_16x16x32_bf16 v[68:71], a[240:243], v[36:39], v[68:71]
    ds_read_b128 v[28:31], v13 offset:0
    s_add_u32 m0, s21, 98304
    v_mfma_f32_16x16x32_bf16 v[72:75], a[244:247], v[36:39], v[72:75]
    buffer_load_dwordx4 v8, s[8:11], s20 offen lds
    v_mfma_f32_16x16x32_bf16 v[76:79], a[240:243], v[40:43], v[76:79]
    ds_read_b128 v[32:35], v13 offset:4096
    v_mfma_f32_16x16x32_bf16 v[80:83], a[244:247], v[40:43], v[80:83]
    s_waitcnt lgkmcnt(4)
    v_mfma_f32_16x16x32_bf16 v[68:71], a[248:251], v[44:47], v[68:71]
    ds_read_b128 v[36:39], v14 offset:0
    v_mfma_f32_16x16x32_bf16 v[72:75], a[252:255], v[44:47], v[72:75]
    v_mfma_f32_16x16x32_bf16 v[76:79], a[248:251], v[48:51], v[76:79]
    ds_read_b128 v[40:43], v14 offset:4096
    v_mfma_f32_16x16x32_bf16 v[80:83], a[252:255], v[48:51], v[80:83]
    s_waitcnt lgkmcnt(4)
    s_add_u32 s22, s22, 1
    s_cmp_ge_u32 s22, s23
    s_cbranch_scc0 L_st_462
L_fl1_457:
    s_waitcnt lgkmcnt(0)
    s_nop 7
    s_sub_u32 s39, s22, 1
    s_bitcmp1_b32 s39, 1
    s_cselect_b32 s38, s54, s55
    s_add_u32 s38, s38, s44
    s_lshl_b32 s42, s39, 20
    s_add_u32 s38, s38, s42
    s_cmp_eq_u32 s37, 0
    s_cselect_b32 s38, 0x7ff00000, s38
    s_mov_b32 s37, 1
    v_cvt_pk_bf16_f32 v88, v68, v69
    v_cvt_pk_bf16_f32 v89, v70, v71
    v_cvt_pk_bf16_f32 v90, v72, v73
    v_cvt_pk_bf16_f32 v91, v74, v75
    buffer_store_dwordx4 v[88:91], v86, s[12:15], s38 offen offset:0
    v_cvt_pk_bf16_f32 v92, v76, v77
    v_cvt_pk_bf16_f32 v93, v78, v79
    v_cvt_pk_bf16_f32 v94, v80, v81
    v_cvt_pk_bf16_f32 v95, v82, v83
    buffer_store_dwordx4 v[92:95], v86, s[12:15], s38 offen offset:128
    s_waitcnt vmcnt(0)
    s_barrier
    s_mov_b32 s25, 0x5901f80
    v_mov_b32 v2, 0
L_pl_465:
    buffer_load_dword v1, v2, s[12:15], s25 offen sc1
    s_add_u32 s36, s36, 1
    s_cmp_gt_u32 s36, 0x100000
    s_cbranch_scc1 chain_kernel_wend
    s_waitcnt vmcnt(0)
    v_readfirstlane_b32 s26, v1
    s_cmp_ge_u32 s26, 64
    s_cbranch_scc1 L_plok_466
    s_sleep 4
    s_branch L_pl_465
L_plok_466:
    s_cmp_eq_u32 s45, 0
    s_cbranch_scc1 L_anext_451
L_att_450:
    s_waitcnt lgkmcnt(0)
    s_add_u32 s38, s47, s49
    s_mov_b32 s28, 0x3e0293ee
    s_mov_b32 s29, 0x3db504f3
    s_cmp_ge_u32 s22, 64
    s_cbranch_scc1 L_asrv_467
    ds_read_b64 v[216:217], v99 offset:512
    ds_read_b64 v[218:219], v99 offset:1536
    ds_read_b64 v[220:221], v99 offset:2560
    ds_read_b64 v[222:223], v99 offset:3584
    v_mfma_f32_32x32x16_bf16 v[200:215], v[104:107], v[136:139], v[240:255]
    v_mfma_f32_32x32x16_bf16 v[200:215], v[108:111], v[140:143], v[200:215]
    ds_read_b128 v[104:107], v97 offset:0
    v_mfma_f32_32x32x16_bf16 v[200:215], v[112:115], v[144:147], v[200:215]
    ds_read_b128 v[108:111], v97 offset:256
    v_mfma_f32_32x32x16_bf16 v[200:215], v[116:119], v[148:151], v[200:215]
    ds_read_b128 v[112:115], v97 offset:1024
    v_mfma_f32_32x32x16_bf16 v[200:215], v[120:123], v[152:155], v[200:215]
    ds_read_b128 v[116:119], v97 offset:1280
    v_mfma_f32_32x32x16_bf16 v[200:215], v[124:127], v[156:159], v[200:215]
    ds_read_b128 v[120:123], v97 offset:2048
    v_mfma_f32_32x32x16_bf16 v[200:215], v[128:131], v[160:163], v[200:215]
    ds_read_b128 v[124:127], v97 offset:2304
    v_mfma_f32_32x32x16_bf16 v[200:215], v[132:135], v[164:167], v[200:215]
    ds_read_b128 v[128:131], v97 offset:3072
    ds_read_b128 v[132:135], v97 offset:3328
    s_waitcnt lgkmcnt(2)
    v_mfma_f32_32x32x16_bf16 v[68:83], v[104:107], v[136:139], 0
    s_nop 0
    v_mfma_f32_32x32x16_bf16 v[68:83], v[108:111], v[140:143], v[68:83]
    v_max3_f32 v234, v200, v201, v202
    s_nop 0
    v_mfma_f32_32x32x16_bf16 v[68:83], v[112:115], v[144:147], v[68:83]
    v_max3_f32 v235, v203, v204, v205
    s_nop 0
    v_mfma_f32_32x32x16_bf16 v[68:83], v[116:119], v[148:151], v[68:83]
    v_max3_f32 v234, v234, v206, v207
    s_nop 0
    v_mfma_f32_32x32x16_bf16 v[68:83], v[120:123], v[152:155], v[68:83]
    v_max3_f32 v235, v235, v208, v209
    s_nop 0
    v_mfma_f32_32x32x16_bf16 v[68:83], v[124:127], v[156:159], v[68:83]
    v_max3_f32 v234, v234, v210, v211
    s_waitcnt lgkmcnt(1)
    v_mfma_f32_32x32x16_bf16 v[68:83], v[128:131], v[160:163], v[68:83]
    v_max3_f32 v235, v235, v212, v213
    s_waitcnt lgkmcnt(0)
    v_mfma_f32_32x32x16_bf16 v[68:83], v[132:135], v[164:167], v[68:83]
    v_max3_f32 v234, v234, v214, v215
    s_nop 10
    s_branch L_atail_468
L_asrv_467:
    v_mfma_f32_32x32x16_bf16 v[200:215], v[104:107], v[136:139], v[240:255]
    v_mfma_f32_32x32x16_bf16 v[200:215], v[108:111], v[140:143], v[200:215]
    v_mfma_f32_32x32x16_bf16 v[200:215], v[112:115], v[144:147], v[200:215]
    v_mfma_f32_32x32x16_bf16 v[200:215], v[116:119], v[148:151], v[200:215]
    v_mfma_f32_32x32x16_bf16 v[200:215], v[120:123], v[152:155], v[200:215]
    v_mfma_f32_32x32x16_bf16 v[200:215], v[124:127], v[156:159], v[200:215]
    v_mfma_f32_32x32x16_bf16 v[200:215], v[128:131], v[160:163], v[200:215]
    v_mfma_f32_32x32x16_bf16 v[200:215], v[132:135], v[164:167], v[200:215]
    s_nop 11
    v_max3_f32 v234, v200, v201, v202
    v_max3_f32 v235, v203, v204, v205
    v_max3_f32 v234, v234, v206, v207
    v_max3_f32 v235, v235, v208, v209
    v_max3_f32 v234, v234, v210, v211
    v_max3_f32 v235, v235, v212, v213
    v_max3_f32 v234, v234, v214, v215
    s_add_u32 s27, s38, 1
    s_sub_u32 s26, s38, 1
    s_min_u32 s26, s26, 61
    s_cmp_ge_u32 s38, 52
    s_cselect_b32 s27, s26, s27
    v_mov_b32 v2, 4
L_cw_469:
    buffer_load_dword v1, v2, s[32:35], 0 offen sc1
    s_add_u32 s36, s36, 1
    s_cmp_gt_u32 s36, 0x100000
    s_cbranch_scc1 chain_kernel_wend
    s_waitcnt vmcnt(0)
    v_readfirstlane_b32 s25, v1
    s_cmp_ge_u32 s25, s27
    s_cbranch_scc1 L_cwok_470
    s_sleep 4
    s_branch L_cw_469
L_cwok_470:
    s_add_u32 m0, s7, 0
    s_add_u32 s43, s48, 0x8000c00
    buffer_load_dwordx4 v96, s[12:15], s43 offen sc1 lds
    s_add_u32 m0, s7, 1024
    s_add_u32 s43, s48, 0x8001c00
    buffer_load_dwordx4 v96, s[12:15], s43 offen sc1 lds
    s_add_u32 m0, s7, 2048
    s_add_u32 s43, s48, 0x8004c00
    buffer_load_dwordx4 v96, s[12:15], s43 offen sc1 lds
    s_add_u32 m0, s7, 3072
    s_add_u32 s43, s48, 0x8005c00
    buffer_load_dwordx4 v96, s[12:15], s43 offen sc1 lds
    s_add_u32 s36, s36, 1
    s_cmp_gt_u32 s36, 0x100000
    s_cbranch_scc1 chain_kernel_wend
    s_waitcnt vmcnt(0)
    ds_read_b128 v[104:107], v97 offset:0
    ds_read_b128 v[108:111], v97 offset:256
    ds_read_b64 v[216:217], v99 offset:512
    ds_read_b128 v[112:115], v97 offset:1024
    ds_read_b128 v[116:119], v97 offset:1280
    ds_read_b64 v[218:219], v99 offset:1536
    ds_read_b128 v[120:123], v97 offset:2048
    ds_read_b128 v[124:127], v97 offset:2304
    ds_read_b64 v[220:221], v99 offset:2560
    ds_read_b128 v[128:131], v97 offset:3072
    ds_read_b128 v[132:135], v97 offset:3328
    ds_read_b64 v[222:223], v99 offset:3584
    v_mov_b32 v1, 0
    s_waitcnt lgkmcnt(11)
    v_mfma_f32_32x32x16_bf16 v[68:83], v[104:107], v[136:139], 0
    v_max3_u32 v1, v1, v104, v105
    v_max3_u32 v1, v1, v106, v107
    s_waitcnt lgkmcnt(9)
    v_mfma_f32_32x32x16_bf16 v[68:83], v[108:111], v[140:143], v[68:83]
    v_max3_u32 v1, v1, v108, v109
    v_max3_u32 v1, v1, v110, v111
    v_max3_u32 v1, v1, v216, v217
    s_waitcnt lgkmcnt(8)
    v_mfma_f32_32x32x16_bf16 v[68:83], v[112:115], v[144:147], v[68:83]
    v_max3_u32 v1, v1, v112, v113
    v_max3_u32 v1, v1, v114, v115
    s_waitcnt lgkmcnt(6)
    v_mfma_f32_32x32x16_bf16 v[68:83], v[116:119], v[148:151], v[68:83]
    v_max3_u32 v1, v1, v116, v117
    v_max3_u32 v1, v1, v118, v119
    v_max3_u32 v1, v1, v218, v219
    s_waitcnt lgkmcnt(5)
    v_mfma_f32_32x32x16_bf16 v[68:83], v[120:123], v[152:155], v[68:83]
    v_max3_u32 v1, v1, v120, v121
    v_max3_u32 v1, v1, v122, v123
    s_waitcnt lgkmcnt(3)
    v_mfma_f32_32x32x16_bf16 v[68:83], v[124:127], v[156:159], v[68:83]
    v_max3_u32 v1, v1, v124, v125
    v_max3_u32 v1, v1, v126, v127
    v_max3_u32 v1, v1, v220, v221
    s_waitcnt lgkmcnt(2)
    v_mfma_f32_32x32x16_bf16 v[68:83], v[128:131], v[160:163], v[68:83]
    v_max3_u32 v1, v1, v128, v129
    v_max3_u32 v1, v1, v130, v131
    s_waitcnt lgkmcnt(0)
    v_mfma_f32_32x32x16_bf16 v[68:83], v[132:135], v[164:167], v[68:83]
    v_max3_u32 v1, v1, v132, v133
    v_max3_u32 v1, v1, v134, v135
    v_max3_u32 v1, v1, v222, v223
    v_cmp_eq_u32 vcc, 0xff81ff81, v1
    s_cbranch_vccnz L_cwok_470
    s_nop 4
    s_cmp_ge_u32 s47, 60
    s_cbranch_scc1 L_atail_468
    s_add_u32 s43, s50, 4194304
    buffer_load_dwordx4 a[32:35], v96, s[12:15], s43 offen offset:0
    s_add_u32 s43, s50, 4194304
    buffer_load_dwordx4 a[36:39], v96, s[12:15], s43 offen offset:1024
    s_add_u32 s43, s48, 4194304
    buffer_load_dwordx4 a[0:3], v96, s[12:15], s43 offen offset:0
    s_add_u32 s43, s48, 4194304
    buffer_load_dwordx4 a[4:7], v96, s[12:15], s43 offen offset:1024
    s_add_u32 s43, s50, 4198400
    buffer_load_dwordx4 a[40:43], v96, s[12:15], s43 offen offset:0
    s_add_u32 s43, s50, 4198400
    buffer_load_dwordx4 a[44:47], v96, s[12:15], s43 offen offset:1024
    s_add_u32 s43, s48, 4198400
    buffer_load_dwordx4 a[8:11], v96, s[12:15], s43 offen offset:0
    s_add_u32 s43, s48, 4198400
    buffer_load_dwordx4 a[12:15], v96, s[12:15], s43 offen offset:1024
    s_add_u32 s43, s50, 4210688
    buffer_load_dwordx4 a[48:51], v96, s[12:15], s43 offen offset:0
    s_add_u32 s43, s50, 4210688
    buffer_load_dwordx4 a[52:55], v96, s[12:15], s43 offen offset:1024
    s_add_u32 s43, s48, 4210688
    buffer_load_dwordx4 a[16:19], v96, s[12:15], s43 offen offset:0
    s_add_u32 s43, s48, 4210688
    buffer_load_dwordx4 a[20:23], v96, s[12:15], s43 offen offset:1024
    s_add_u32 s43, s50, 4214784
    buffer_load_dwordx4 a[56:59], v96, s[12:15], s43 offen offset:0
    s_add_u32 s43, s50, 4214784
    buffer_load_dwordx4 a[60:63], v96, s[12:15], s43 offen offset:1024
    s_add_u32 s43, s48, 4214784
    buffer_load_dwordx4 a[24:27], v96, s[12:15], s43 offen offset:0
    s_add_u32 s43, s48, 4214784
    buffer_load_dwordx4 a[28:31], v96, s[12:15], s43 offen offset:1024
    s_add_u32 s43, s48, 4194304
    buffer_load_dwordx4 a[64:67], v98, s[12:15], s43 offen offset:2048
    s_add_u32 s43, s48, 4194304
    buffer_load_dwordx4 a[68:71], v98, s[12:15], s43 offen offset:3072
    s_add_u32 s43, s48, 4198400
    buffer_load_dwordx4 a[72:75], v98, s[12:15], s43 offen offset:2048
    s_add_u32 s43, s48, 4198400
    buffer_load_dwordx4 a[76:79], v98, s[12:15], s43 offen offset:3072
    s_add_u32 s43, s48, 4210688
    buffer_load_dwordx4 a[80:83], v98, s[12:15], s43 offen offset:2048
    s_add_u32 s43, s48, 4210688
    buffer_load_dwordx4 a[84:87], v98, s[12:15], s43 offen offset:3072
    s_add_u32 s43, s48, 4214784
    buffer_load_dwordx4 a[88:91], v98, s[12:15], s43 offen offset:2048
    s_add_u32 s43, s48, 4214784
    buffer_load_dwordx4 a[92:95], v98, s[12:15], s43 offen offset:3072
L_atail_468:
    v_max3_f32 v235, v235, v68, v69
    v_max3_f32 v234, v234, v70, v71
    v_max_f32 v234, v234, v235
    v_mov_b32 v235, v234
    s_nop 1
    v_permlane32_swap_b32 v234, v235
    s_nop 0
    v_max_f32 v234, v234, v235
    v_mul_f32 v234, s28, v234
    v_fma_f32 v200, v200, s28, -v234
    v_fma_f32 v201, v201, s28, -v234
    v_fma_f32 v202, v202, s28, -v234
    v_fma_f32 v203, v203, s28, -v234
    v_fma_f32 v204, v204, s28, -v234
    v_fma_f32 v205, v205, s28, -v234
    v_fma_f32 v206, v206, s28, -v234
    v_fma_f32 v207, v207, s28, -v234
    v_fma_f32 v208, v208, s28, -v234
    v_fma_f32 v209, v209, s28, -v234
    v_fma_f32 v210, v210, s28, -v234
    v_fma_f32 v211, v211, s28, -v234
    v_fma_f32 v212, v212, s28, -v234
    v_fma_f32 v213, v213, s28, -v234
    v_fma_f32 v214, v214, s28, -v234
    v_fma_f32 v215, v215, s28, -v234
    v_fma_f32 v68, v68, s28, -v234
    v_fma_f32 v69, v69, s28, -v234
    v_fma_f32 v70, v70, s28, -v234
    v_fma_f32 v71, v71, s28, -v234
    v_exp_f32 v200, v200
    v_exp_f32 v201, v201
    v_exp_f32 v202, v202
    v_exp_f32 v203, v203
    v_exp_f32 v204, v204
    v_exp_f32 v205, v205
    v_exp_f32 v206, v206
    v_exp_f32 v207, v207
    v_exp_f32 v208, v208
    v_exp_f32 v209, v209
    v_exp_f32 v210, v210
    v_exp_f32 v211, v211
    v_exp_f32 v212, v212
    v_exp_f32 v213, v213
    v_exp_f32 v214, v214
    v_exp_f32 v215, v215
    v_exp_f32 v68, v68
    v_exp_f32 v69, v69
    v_exp_f32 v70, v70
    v_exp_f32 v71, v71
    v_pk_add_f32 v[236:237], v[200:201], v[202:203]
    v_pk_add_f32 v[236:237], v[236:237], v[204:205]
    v_pk_add_f32 v[236:237], v[236:237], v[206:207]
    v_pk_add_f32 v[236:237], v[236:237], v[208:209]
    v_pk_add_f32 v[236:237], v[236:237], v[210:211]
    v_pk_add_f32 v[236:237], v[236:237], v[212:213]
    v_pk_add_f32 v[236:237], v[236:237], v[214:215]
    v_pk_add_f32 v[236:237], v[236:237], v[68:69]
    v_pk_add_f32 v[236:237], v[236:237], v[70:71]
    v_add_f32 v236, v236, v237
    v_mov_b32 v235, v236
    s_nop 1
    v_permlane32_swap_b32 v236, v235
    s_nop 0
    v_add_f32 v236, v236, v235
    v_rcp_f32 v236, v236
    s_nop 0
    v_pk_mul_f32 v[200:201], v[200:201], v[236:237] op_sel_hi:[1,0]
    v_pk_mul_f32 v[202:203], v[202:203], v[236:237] op_sel_hi:[1,0]
    v_pk_mul_f32 v[204:205], v[204:205], v[236:237] op_sel_hi:[1,0]
    v_pk_mul_f32 v[206:207], v[206:207], v[236:237] op_sel_hi:[1,0]
    v_pk_mul_f32 v[208:209], v[208:209], v[236:237] op_sel_hi:[1,0]
    v_pk_mul_f32 v[210:211], v[210:211], v[236:237] op_sel_hi:[1,0]
    v_pk_mul_f32 v[212:213], v[212:213], v[236:237] op_sel_hi:[1,0]
    v_pk_mul_f32 v[214:215], v[214:215], v[236:237] op_sel_hi:[1,0]
    v_pk_mul_f32 v[68:69], v[68:69], v[236:237] op_sel_hi:[1,0]
    v_pk_mul_f32 v[70:71], v[70:71], v[236:237] op_sel_hi:[1,0]
    v_cvt_pk_bf16_f32 v224, v200, v201
    v_cvt_pk_bf16_f32 v225, v202, v203
    v_cvt_pk_bf16_f32 v226, v204, v205
    v_cvt_pk_bf16_f32 v227, v206, v207
    v_cvt_pk_bf16_f32 v228, v208, v209
    v_cvt_pk_bf16_f32 v229, v210, v211
    v_cvt_pk_bf16_f32 v230, v212, v213
    v_cvt_pk_bf16_f32 v231, v214, v215
    v_cvt_pk_bf16_f32 v232, v68, v69
    v_cvt_pk_bf16_f32 v233, v70, v71
    s_nop 1
    v_mfma_f32_32x32x16_bf16 v[104:119], v[168:171], v[224:227], 0
    v_mfma_f32_32x32x16_bf16 v[104:119], v[172:175], v[228:231], v[104:119]
    s_lshl_b32 s25, s38, 9
    s_lshr_b32 s26, s46, 3
    s_lshl_b32 s26, s26, 7
    s_add_u32 s25, s25, s26
    v_mfma_f32_32x32x8_bf16 v[104:119], v[216:217], v[232:233], v[104:119]
    s_add_u32 s51, s25, 0x5904000
    s_mov_b32 s94, s50
    s_add_u32 s47, s47, 4
    v_mfma_f32_32x32x16_bf16 v[120:135], v[176:179], v[224:227], 0
    v_mfma_f32_32x32x16_bf16 v[120:135], v[180:183], v[228:231], v[120:135]
    v_cvt_pk_bf16_f32 v168, v104, v105
    v_cvt_pk_bf16_f32 v169, v106, v107
    v_cvt_pk_bf16_f32 v170, v108, v109
    v_cvt_pk_bf16_f32 v171, v110, v111
    v_mfma_f32_32x32x8_bf16 v[120:135], v[218:219], v[232:233], v[120:135]
    v_cvt_pk_bf16_f32 v172, v112, v113
    v_cvt_pk_bf16_f32 v173, v114, v115
    v_cvt_pk_bf16_f32 v174, v116, v117
    v_cvt_pk_bf16_f32 v175, v118, v119
    v_mfma_f32_32x32x16_bf16 v[136:151], v[184:187], v[224:227], 0
    v_mfma_f32_32x32x16_bf16 v[136:151], v[188:191], v[228:231], v[136:151]
    v_cvt_pk_bf16_f32 v176, v120, v121
    v_cvt_pk_bf16_f32 v177, v122, v123
    v_cvt_pk_bf16_f32 v178, v124, v125
    v_cvt_pk_bf16_f32 v179, v126, v127
    v_mfma_f32_32x32x8_bf16 v[136:151], v[220:221], v[232:233], v[136:151]
    v_cvt_pk_bf16_f32 v180, v128, v129
    v_cvt_pk_bf16_f32 v181, v130, v131
    v_cvt_pk_bf16_f32 v182, v132, v133
    v_cvt_pk_bf16_f32 v183, v134, v135
    v_mfma_f32_32x32x16_bf16 v[152:167], v[192:195], v[224:227], 0
    v_mfma_f32_32x32x16_bf16 v[152:167], v[196:199], v[228:231], v[152:167]
    v_cvt_pk_bf16_f32 v184, v136, v137
    v_cvt_pk_bf16_f32 v185, v138, v139
    v_cvt_pk_bf16_f32 v186, v140, v141
    v_cvt_pk_bf16_f32 v187, v142, v143
    v_mfma_f32_32x32x8_bf16 v[152:167], v[222:223], v[232:233], v[152:167]
    v_cvt_pk_bf16_f32 v188, v144, v145
    v_cvt_pk_bf16_f32 v189, v146, v147
    v_cvt_pk_bf16_f32 v190, v148, v149
    v_cvt_pk_bf16_f32 v191, v150, v151
    s_nop 7
    v_cvt_pk_bf16_f32 v192, v152, v153
    v_cvt_pk_bf16_f32 v193, v154, v155
    v_cvt_pk_bf16_f32 v194, v156, v157
    v_cvt_pk_bf16_f32 v195, v158, v159
    v_cvt_pk_bf16_f32 v196, v160, v161
    v_cvt_pk_bf16_f32 v197, v162, v163
    v_cvt_pk_bf16_f32 v198, v164, v165
    v_cvt_pk_bf16_f32 v199, v166, v167
L_anext_451:
    s_add_u32 s27, s47, s49
    s_lshl_b32 s25, s27, 20
    s_lshl_b32 s26, s46, 15
    s_add_u32 s25, s25, s26
    s_bitcmp1_b32 s27, 1
    s_cselect_b32 s48, s55, s54
    s_cselect_b32 s50, s54, s55
    s_add_u32 s48, s48, s25
    s_add_u32 s50, s50, s25
    s_waitcnt lgkmcnt(4)
    s_cmp_ge_u32 s22, 64
    s_cbranch_scc1 L_aserve_463
    v_readfirstlane_b32 s25, v87
    s_and_b32 s26, s46, 1
    s_mul_i32 s26, s26, 2
    s_sub_u32 s25, s25, s26
    s_sub_u32 s26, s22, 3
    s_min_i32 s25, s25, s26
    s_add_u32 s26, s47, 4
    s_cmp_ge_i32 s25, s26
    s_cbranch_scc1 L_ago_471
    s_cmp_eq_u32 s45, 0
    s_mov_b32 s45, 0
    s_cbranch_scc1 L_attr_452
    s_branch L_attr_454
L_ago_471:
    s_cmp_eq_u32 s45, 0
    s_mov_b32 s45, 1
    s_cbranch_scc1 L_attr_453
    s_branch L_attr_455
L_aserve_463:
    s_cmp_eq_u32 s45, 0
    s_cbranch_scc1 L_afirst_472
    s_add_u32 s43, s94, 0
    buffer_store_dwordx4 v[168:171], v100, s[12:15], s43 offen offset:2048 sc1
    s_add_u32 s43, s94, 0
    buffer_store_dwordx4 v[172:175], v100, s[12:15], s43 offen offset:2560 sc1
    s_add_u32 s43, s94, 4096
    buffer_store_dwordx4 v[176:179], v100, s[12:15], s43 offen offset:2048 sc1
    s_add_u32 s43, s94, 4096
    buffer_store_dwordx4 v[180:183], v100, s[12:15], s43 offen offset:2560 sc1
    s_add_u32 s43, s94, 16384
    buffer_store_dwordx4 v[184:187], v100, s[12:15], s43 offen offset:2048 sc1
    s_add_u32 s43, s94, 16384
    buffer_store_dwordx4 v[188:191], v100, s[12:15], s43 offen offset:2560 sc1
    s_add_u32 s43, s94, 20480
    buffer_store_dwordx4 v[192:195], v100, s[12:15], s43 offen offset:2048 sc1
    s_add_u32 s43, s94, 20480
    buffer_store_dwordx4 v[196:199], v100, s[12:15], s43 offen offset:2560 sc1
    s_waitcnt vmcnt(0)
    buffer_atomic_add v84, v85, s[12:15], s51 offen sc1
    s_cmp_ge_u32 s47, 64
    s_cbranch_scc1 L_afin_464
    v_accvgpr_read_b32 v104, a0
    v_accvgpr_read_b32 v105, a1
    v_accvgpr_read_b32 v106, a2
    v_accvgpr_read_b32 v107, a3
    v_accvgpr_read_b32 v108, a4
    v_accvgpr_read_b32 v109, a5
    v_accvgpr_read_b32 v110, a6
    v_accvgpr_read_b32 v111, a7
    v_accvgpr_read_b32 v112, a8
    v_accvgpr_read_b32 v113, a9
    v_accvgpr_read_b32 v114, a10
    v_accvgpr_read_b32 v115, a11
    v_accvgpr_read_b32 v116, a12
    v_accvgpr_read_b32 v117, a13
    v_accvgpr_read_b32 v118, a14
    v_accvgpr_read_b32 v119, a15
    v_accvgpr_read_b32 v120, a16
    v_accvgpr_read_b32 v121, a17
    v_accvgpr_read_b32 v122, a18
    v_accvgpr_read_b32 v123, a19
    v_accvgpr_read_b32 v124, a20
    v_accvgpr_read_b32 v125, a21
    v_accvgpr_read_b32 v126, a22
    v_accvgpr_read_b32 v127, a23
    v_accvgpr_read_b32 v128, a24
    v_accvgpr_read_b32 v129, a25
    v_accvgpr_read_b32 v130, a26
    v_accvgpr_read_b32 v131, a27
    v_accvgpr_read_b32 v132, a28
    v_accvgpr_read_b32 v133, a29
    v_accvgpr_read_b32 v134, a30
    v_accvgpr_read_b32 v135, a31
    v_accvgpr_read_b32 v136, a32
    v_accvgpr_read_b32 v137, a33
    v_accvgpr_read_b32 v138, a34
    v_accvgpr_read_b32 v139, a35
    v_accvgpr_read_b32 v140, a36
    v_accvgpr_read_b32 v141, a37
    v_accvgpr_read_b32 v142, a38
    v_accvgpr_read_b32 v143, a39
    v_accvgpr_read_b32 v144, a40
    v_accvgpr_read_b32 v145, a41
    v_accvgpr_read_b32 v146, a42
    v_accvgpr_read_b32 v147, a43
    v_accvgpr_read_b32 v148, a44
    v_accvgpr_read_b32 v149, a45
    v_accvgpr_read_b32 v150, a46
    v_accvgpr_read_b32 v151, a47
    v_accvgpr_read_b32 v152, a48
    v_accvgpr_read_b32 v153, a49
    v_accvgpr_read_b32 v154, a50
    v_accvgpr_read_b32 v155, a51
    v_accvgpr_read_b32 v156, a52
    v_accvgpr_read_b32 v157, a53
    v_accvgpr_read_b32 v158, a54
    v_accvgpr_read_b32 v159, a55
    v_accvgpr_read_b32 v160, a56
    v_accvgpr_read_b32 v161, a57
    v_accvgpr_read_b32 v162, a58
    v_accvgpr_read_b32 v163, a59
    v_accvgpr_read_b32 v164, a60
    v_accvgpr_read_b32 v165, a61
    v_accvgpr_read_b32 v166, a62
    v_accvgpr_read_b32 v167, a63
    v_accvgpr_read_b32 v168, a64
    v_accvgpr_read_b32 v169, a65
    v_accvgpr_read_b32 v170, a66
    v_accvgpr_read_b32 v171, a67
    v_accvgpr_read_b32 v172, a68
    v_accvgpr_read_b32 v173, a69
    v_accvgpr_read_b32 v174, a70
    v_accvgpr_read_b32 v175, a71
    v_accvgpr_read_b32 v176, a72
    v_accvgpr_read_b32 v177, a73
    v_accvgpr_read_b32 v178, a74
    v_accvgpr_read_b32 v179, a75
    v_accvgpr_read_b32 v180, a76
    v_accvgpr_read_b32 v181, a77
    v_accvgpr_read_b32 v182, a78
    v_accvgpr_read_b32 v183, a79
    v_accvgpr_read_b32 v184, a80
    v_accvgpr_read_b32 v185, a81
    v_accvgpr_read_b32 v186, a82
    v_accvgpr_read_b32 v187, a83
    v_accvgpr_read_b32 v188, a84
    v_accvgpr_read_b32 v189, a85
    v_accvgpr_read_b32 v190, a86
    v_accvgpr_read_b32 v191, a87
    v_accvgpr_read_b32 v192, a88
    v_accvgpr_read_b32 v193, a89
    v_accvgpr_read_b32 v194, a90
    v_accvgpr_read_b32 v195, a91
    v_accvgpr_read_b32 v196, a92
    v_accvgpr_read_b32 v197, a93
    v_accvgpr_read_b32 v198, a94
    v_accvgpr_read_b32 v199, a95
    s_branch L_att_450
L_afirst_472:
    s_add_u32 s43, s50, 0
    buffer_load_dwordx4 v[136:139], v96, s[12:15], s43 offen offset:0
    s_add_u32 s43, s50, 0
    buffer_load_dwordx4 v[140:143], v96, s[12:15], s43 offen offset:1024
    s_add_u32 s43, s48, 0
    buffer_load_dwordx4 v[104:107], v96, s[12:15], s43 offen offset:0
    s_add_u32 s43, s48, 0
    buffer_load_dwordx4 v[108:111], v96, s[12:15], s43 offen offset:1024
    s_add_u32 s43, s50, 4096
    buffer_load_dwordx4 v[144:147], v96, s[12:15], s43 offen offset:0
    s_add_u32 s43, s50, 4096
    buffer_load_dwordx4 v[148:151], v96, s[12:15], s43 offen offset:1024
    s_add_u32 s43, s48, 4096
    buffer_load_dwordx4 v[112:115], v96, s[12:15], s43 offen offset:0
    s_add_u32 s43, s48, 4096
    buffer_load_dwordx4 v[116:119], v96, s[12:15], s43 offen offset:1024
    s_add_u32 s43, s50, 16384
    buffer_load_dwordx4 v[152:155], v96, s[12:15], s43 offen offset:0
    s_add_u32 s43, s50, 16384
    buffer_load_dwordx4 v[156:159], v96, s[12:15], s43 offen offset:1024
    s_add_u32 s43, s48, 16384
    buffer_load_dwordx4 v[120:123], v96, s[12:15], s43 offen offset:0
    s_add_u32 s43, s48, 16384
    buffer_load_dwordx4 v[124:127], v96, s[12:15], s43 offen offset:1024
    s_add_u32 s43, s50, 20480
    buffer_load_dwordx4 v[160:163], v96, s[12:15], s43 offen offset:0
    s_add_u32 s43, s50, 20480
    buffer_load_dwordx4 v[164:167], v96, s[12:15], s43 offen offset:1024
    s_add_u32 s43, s48, 20480
    buffer_load_dwordx4 v[128:131], v96, s[12:15], s43 offen offset:0
    s_add_u32 s43, s48, 20480
    buffer_load_dwordx4 v[132:135], v96, s[12:15], s43 offen offset:1024
    s_add_u32 s43, s48, 0
    buffer_load_dwordx4 v[168:171], v98, s[12:15], s43 offen offset:2048
    s_add_u32 s43, s48, 0
    buffer_load_dwordx4 v[172:175], v98, s[12:15], s43 offen offset:3072
    s_add_u32 s43, s48, 4096
    buffer_load_dwordx4 v[176:179], v98, s[12:15], s43 offen offset:2048
    s_add_u32 s43, s48, 4096
    buffer_load_dwordx4 v[180:183], v98, s[12:15], s43 offen offset:3072
    s_add_u32 s43, s48, 16384
    buffer_load_dwordx4 v[184:187], v98, s[12:15], s43 offen offset:2048
    s_add_u32 s43, s48, 16384
    buffer_load_dwordx4 v[188:191], v98, s[12:15], s43 offen offset:3072
    s_add_u32 s43, s48, 20480
    buffer_load_dwordx4 v[192:195], v98, s[12:15], s43 offen offset:2048
    s_add_u32 s43, s48, 20480
    buffer_load_dwordx4 v[196:199], v98, s[12:15], s43 offen offset:3072
    s_mov_b32 s45, 1
    s_waitcnt vmcnt(0)
    s_branch L_att_450
L_afin_464:
    s_branch L_ste_458
L_fl0_456:
    s_waitcnt lgkmcnt(0)
    s_nop 7
L_ste_458:
    s_branch chain_kernel_wend
L_g1_433:
    s_cmp_ge_u32 s41, 16
    s_cbranch_scc1 L_g2_434
    s_mov_b32 s8, s64
    s_and_b32 s9, s65, 0xffff
    s_mov_b32 s10, 0x400000
    s_mov_b32 s11, 0x00020000
    v_lshlrev_b32 v1, 4, v0
    s_lshl_b32 s25, s41, 12
    buffer_load_dwordx4 v[52:55], v1, s[8:11], s25 offen
    s_add_u32 s25, s25, 65536
    buffer_load_dwordx4 v[52:55], v1, s[8:11], s25 offen
    s_add_u32 s25, s25, 65536
    buffer_load_dwordx4 v[52:55], v1, s[8:11], s25 offen
    s_add_u32 s25, s25, 65536
    buffer_load_dwordx4 v[52:55], v1, s[8:11], s25 offen
    s_add_u32 s25, s25, 65536
    s_lshl_b32 s46, s41, 6
    s_lshl_b32 s25, s49, 4
    s_add_u32 s46, s46, s25
    v_and_b32 v1, 15, v0
    v_add_u32 v1, s46, v1
    v_bfe_u32 v2, v0, 4, 2
    v_lshlrev_b32 v3, 1, v1
    s_mov_b32 s16, s66
    s_and_b32 s17, s67, 0xffff
    s_mov_b32 s18, 0x800
    s_mov_b32 s19, 0x00020000
    buffer_load_ushort v128, v3, s[16:19], 0 offen
    s_mov_b32 s16, s68
    s_and_b32 s17, s69, 0xffff
    s_mov_b32 s18, 0x800
    s_mov_b32 s19, 0x00020000
    buffer_load_ushort v129, v3, s[16:19], 0 offen
    s_mov_b32 s16, s78
    s_and_b32 s17, s79, 0xffff
    s_mov_b32 s18, 0x800
    s_mov_b32 s19, 0x00020000
    buffer_load_ushort v130, v3, s[16:19], 0 offen
    s_mov_b32 s16, s70
    s_and_b32 s17, s71, 0xffff
    s_mov_b32 s18, 0x200000
    s_mov_b32 s19, 0x00020000
    s_mov_b32 s32, s72
    s_and_b32 s33, s73, 0xffff
    s_mov_b32 s34, 0x200000
    s_mov_b32 s35, 0x00020000
    v_and_b32 v5, 3, v0
    v_cmp_eq_u32 vcc, v5, v2
    v_and_b32 v5, 1, v0
    v_lshlrev_b32 v5, 4, v5
    v_cndmask_b32 v116, 0, 1.0, vcc
    v_mov_b32 v6, 0x3f80
    v_lshlrev_b32 v6, v5, v6
    v_bfe_u32 v5, v0, 1, 3
    v_lshlrev_b32 v7, 2, v2
    v_sub_u32 v5, v5, v7
    v_cmp_eq_i32 vcc, 0, v5
    s_nop 1
    v_cndmask_b32 v172, 0, v6, vcc
    v_cmp_eq_i32 vcc, 1, v5
    s_nop 1
    v_cndmask_b32 v173, 0, v6, vcc
    v_cmp_eq_i32 vcc, 2, v5
    s_nop 1
    v_cndmask_b32 v174, 0, v6, vcc
    v_cmp_eq_i32 vcc, 3, v5
    s_nop 1
    v_cndmask_b32 v175, 0, v6, vcc
    v_cmp_eq_i32 vcc, -8, v5
    s_nop 1
    v_cndmask_b32 v176, 0, v6, vcc
    v_cmp_eq_i32 vcc, -7, v5
    s_nop 1
    v_cndmask_b32 v177, 0, v6, vcc
    v_cmp_eq_i32 vcc, -6, v5
    s_nop 1
    v_cndmask_b32 v178, 0, v6, vcc
    v_cmp_eq_i32 vcc, -5, v5
    s_nop 1
    v_cndmask_b32 v179, 0, v6, vcc
    s_lshl_b32 s25, s46, 6
    v_and_b32 v5, 15, v0
    v_lshlrev_b32 v5, 4, v5
    v_bfe_u32 v6, v0, 5, 1
    v_lshl_add_u32 v5, v6, 9, v5
    v_bfe_u32 v6, v0, 4, 1
    v_lshl_add_u32 v5, v6, 3, v5
    v_add_u32 v86, s25, v5
    v_and_b32 v1, 31, v0
    v_bfe_u32 v2, v0, 5, 1
    v_add_u32 v3, 0, v2
    v_xor_b32 v4, v3, v1
    v_lshlrev_b32 v4, 4, v4
    v_add_u32 v3, s46, v3
    v_lshl_add_u32 v20, v3, 11, v4
    v_add_u32 v3, 2, v2
    v_xor_b32 v4, v3, v1
    v_lshlrev_b32 v4, 4, v4
    v_add_u32 v3, s46, v3
    v_lshl_add_u32 v21, v3, 11, v4
    v_add_u32 v3, 4, v2
    v_xor_b32 v4, v3, v1
    v_lshlrev_b32 v4, 4, v4
    v_add_u32 v3, s46, v3
    v_lshl_add_u32 v22, v3, 11, v4
    v_add_u32 v3, 6, v2
    v_xor_b32 v4, v3, v1
    v_lshlrev_b32 v4, 4, v4
    v_add_u32 v3, s46, v3
    v_lshl_add_u32 v23, v3, 11, v4
    v_add_u32 v3, 8, v2
    v_xor_b32 v4, v3, v1
    v_lshlrev_b32 v4, 4, v4
    v_add_u32 v3, s46, v3
    v_lshl_add_u32 v24, v3, 11, v4
    v_add_u32 v3, 10, v2
    v_xor_b32 v4, v3, v1
    v_lshlrev_b32 v4, 4, v4
    v_add_u32 v3, s46, v3
    v_lshl_add_u32 v25, v3, 11, v4
    v_add_u32 v3, 12, v2
    v_xor_b32 v4, v3, v1
    v_lshlrev_b32 v4, 4, v4
    v_add_u32 v3, s46, v3
    v_lshl_add_u32 v26, v3, 11, v4
    v_add_u32 v3, 14, v2
    v_xor_b32 v4, v3, v1
    v_lshlrev_b32 v4, 4, v4
    v_add_u32 v3, s46, v3
    v_lshl_add_u32 v27, v3, 11, v4
    v_and_b32 v1, 15, v0
    v_bfe_u32 v2, v0, 4, 2
    v_lshrrev_b32 v3, 6, v0
    v_lshlrev_b32 v3, 15, v3
    v_lshl_add_u32 v3, v1, 9, v3
    v_add_u32 v4, 0, v2
    v_xor_b32 v4, v4, v1
    v_lshl_add_u32 v28, v4, 4, v3
    v_add_u32 v4, 4, v2
    v_xor_b32 v4, v4, v1
    v_lshl_add_u32 v29, v4, 4, v3
    v_add_u32 v4, 8, v2
    v_xor_b32 v4, v4, v1
    v_lshl_add_u32 v30, v4, 4, v3
    v_add_u32 v4, 12, v2
    v_xor_b32 v4, v4, v1
    v_lshl_add_u32 v31, v4, 4, v3
    s_lshl_b32 s26, s49, 15
    s_barrier
    s_mov_b32 s27, 0
    s_add_u32 m0, s26, 0
    s_nop 0
    buffer_load_dwordx4 v20, s[16:19], s27 offen nt lds
    s_add_u32 m0, s26, 1024
    s_nop 0
    buffer_load_dwordx4 v21, s[16:19], s27 offen nt lds
    s_add_u32 m0, s26, 2048
    s_nop 0
    buffer_load_dwordx4 v22, s[16:19], s27 offen nt lds
    s_add_u32 m0, s26, 3072
    s_nop 0
    buffer_load_dwordx4 v23, s[16:19], s27 offen nt lds
    s_add_u32 m0, s26, 4096
    s_nop 0
    buffer_load_dwordx4 v24, s[16:19], s27 offen nt lds
    s_add_u32 m0, s26, 5120
    s_nop 0
    buffer_load_dwordx4 v25, s[16:19], s27 offen nt lds
    s_add_u32 m0, s26, 6144
    s_nop 0
    buffer_load_dwordx4 v26, s[16:19], s27 offen nt lds
    s_add_u32 m0, s26, 7168
    s_nop 0
    buffer_load_dwordx4 v27, s[16:19], s27 offen nt lds
    s_mov_b32 s27, 0
    s_add_u32 m0, s26, 8192
    s_nop 0
    buffer_load_dwordx4 v20, s[32:35], s27 offen nt lds
    s_add_u32 m0, s26, 9216
    s_nop 0
    buffer_load_dwordx4 v21, s[32:35], s27 offen nt lds
    s_add_u32 m0, s26, 10240
    s_nop 0
    buffer_load_dwordx4 v22, s[32:35], s27 offen nt lds
    s_add_u32 m0, s26, 11264
    s_nop 0
    buffer_load_dwordx4 v23, s[32:35], s27 offen nt lds
    s_add_u32 m0, s26, 12288
    s_nop 0
    buffer_load_dwordx4 v24, s[32:35], s27 offen nt lds
    s_add_u32 m0, s26, 13312
    s_nop 0
    buffer_load_dwordx4 v25, s[32:35], s27 offen nt lds
    s_add_u32 m0, s26, 14336
    s_nop 0
    buffer_load_dwordx4 v26, s[32:35], s27 offen nt lds
    s_add_u32 m0, s26, 15360
    s_nop 0
    buffer_load_dwordx4 v27, s[32:35], s27 offen nt lds
    s_mov_b32 s27, 512
    s_add_u32 m0, s26, 16384
    s_nop 0
    buffer_load_dwordx4 v20, s[16:19], s27 offen nt lds
    s_add_u32 m0, s26, 17408
    s_nop 0
    buffer_load_dwordx4 v21, s[16:19], s27 offen nt lds
    s_add_u32 m0, s26, 18432
    s_nop 0
    buffer_load_dwordx4 v22, s[16:19], s27 offen nt lds
    s_add_u32 m0, s26, 19456
    s_nop 0
    buffer_load_dwordx4 v23, s[16:19], s27 offen nt lds
    s_add_u32 m0, s26, 20480
    s_nop 0
    buffer_load_dwordx4 v24, s[16:19], s27 offen nt lds
    s_add_u32 m0, s26, 21504
    s_nop 0
    buffer_load_dwordx4 v25, s[16:19], s27 offen nt lds
    s_add_u32 m0, s26, 22528
    s_nop 0
    buffer_load_dwordx4 v26, s[16:19], s27 offen nt lds
    s_add_u32 m0, s26, 23552
    s_nop 0
    buffer_load_dwordx4 v27, s[16:19], s27 offen nt lds
    s_mov_b32 s27, 512
    s_add_u32 m0, s26, 24576
    s_nop 0
    buffer_load_dwordx4 v20, s[32:35], s27 offen nt lds
    s_add_u32 m0, s26, 25600
    s_nop 0
    buffer_load_dwordx4 v21, s[32:35], s27 offen nt lds
    s_add_u32 m0, s26, 26624
    s_nop 0
    buffer_load_dwordx4 v22, s[32:35], s27 offen nt lds
    s_add_u32 m0, s26, 27648
    s_nop 0
    buffer_load_dwordx4 v23, s[32:35], s27 offen nt lds
    s_add_u32 m0, s26, 28672
    s_nop 0
    buffer_load_dwordx4 v24, s[32:35], s27 offen nt lds
    s_add_u32 m0, s26, 29696
    s_nop 0
    buffer_load_dwordx4 v25, s[32:35], s27 offen nt lds
    s_add_u32 m0, s26, 30720
    s_nop 0
    buffer_load_dwordx4 v26, s[32:35], s27 offen nt lds
    s_add_u32 m0, s26, 31744
    s_nop 0
    buffer_load_dwordx4 v27, s[32:35], s27 offen nt lds
    s_waitcnt vmcnt(16)
    ds_read_b128 a[0:3], v28 offset:0
    ds_read_b128 a[4:7], v28 offset:8192
    ds_read_b128 a[8:11], v29 offset:0
    ds_read_b128 a[12:15], v29 offset:8192
    ds_read_b128 a[16:19], v30 offset:0
    ds_read_b128 a[20:23], v30 offset:8192
    ds_read_b128 a[24:27], v31 offset:0
    ds_read_b128 a[28:31], v31 offset:8192
    s_waitcnt lgkmcnt(0)
    ds_read_b128 a[32:35], v28 offset:256
    ds_read_b128 a[36:39], v28 offset:8448
    ds_read_b128 a[40:43], v29 offset:256
    ds_read_b128 a[44:47], v29 offset:8448
    ds_read_b128 a[48:51], v30 offset:256
    ds_read_b128 a[52:55], v30 offset:8448
    ds_read_b128 a[56:59], v31 offset:256
    ds_read_b128 a[60:63], v31 offset:8448
    s_waitcnt lgkmcnt(0)
    s_mov_b32 s27, 1024
    s_add_u32 m0, s26, 0
    s_nop 0
    buffer_load_dwordx4 v20, s[16:19], s27 offen nt lds
    s_add_u32 m0, s26, 1024
    s_nop 0
    buffer_load_dwordx4 v21, s[16:19], s27 offen nt lds
    s_add_u32 m0, s26, 2048
    s_nop 0
    buffer_load_dwordx4 v22, s[16:19], s27 offen nt lds
    s_add_u32 m0, s26, 3072
    s_nop 0
    buffer_load_dwordx4 v23, s[16:19], s27 offen nt lds
    s_add_u32 m0, s26, 4096
    s_nop 0
    buffer_load_dwordx4 v24, s[16:19], s27 offen nt lds
    s_add_u32 m0, s26, 5120
    s_nop 0
    buffer_load_dwordx4 v25, s[16:19], s27 offen nt lds
    s_add_u32 m0, s26, 6144
    s_nop 0
    buffer_load_dwordx4 v26, s[16:19], s27 offen nt lds
    s_add_u32 m0, s26, 7168
    s_nop 0
    buffer_load_dwordx4 v27, s[16:19], s27 offen nt lds
    s_mov_b32 s27, 1024
    s_add_u32 m0, s26, 8192
    s_nop 0
    buffer_load_dwordx4 v20, s[32:35], s27 offen nt lds
    s_add_u32 m0, s26, 9216
    s_nop 0
    buffer_load_dwordx4 v21, s[32:35], s27 offen nt lds
    s_add_u32 m0, s26, 10240
    s_nop 0
    buffer_load_dwordx4 v22, s[32:35], s27 offen nt lds
    s_add_u32 m0, s26, 11264
    s_nop 0
    buffer_load_dwordx4 v23, s[32:35], s27 offen nt lds
    s_add_u32 m0, s26, 12288
    s_nop 0
    buffer_load_dwordx4 v24, s[32:35], s27 offen nt lds
    s_add_u32 m0, s26, 13312
    s_nop 0
    buffer_load_dwordx4 v25, s[32:35], s27 offen nt lds
    s_add_u32 m0, s26, 14336
    s_nop 0
    buffer_load_dwordx4 v26, s[32:35], s27 offen nt lds
    s_add_u32 m0, s26, 15360
    s_nop 0
    buffer_load_dwordx4 v27, s[32:35], s27 offen nt lds
    s_waitcnt vmcnt(16)
    ds_read_b128 a[64:67], v28 offset:16384
    ds_read_b128 a[68:71], v28 offset:24576
    ds_read_b128 a[72:75], v29 offset:16384
    ds_read_b128 a[76:79], v29 offset:24576
    ds_read_b128 a[80:83], v30 offset:16384
    ds_read_b128 a[84:87], v30 offset:24576
    ds_read_b128 a[88:91], v31 offset:16384
    ds_read_b128 a[92:95], v31 offset:24576
    s_waitcnt lgkmcnt(0)
    ds_read_b128 a[96:99], v28 offset:16640
    ds_read_b128 a[100:103], v28 offset:24832
    ds_read_b128 a[104:107], v29 offset:16640
    ds_read_b128 a[108:111], v29 offset:24832
    ds_read_b128 a[112:115], v30 offset:16640
    ds_read_b128 a[116:119], v30 offset:24832
    ds_read_b128 a[120:123], v31 offset:16640
    ds_read_b128 a[124:127], v31 offset:24832
    s_waitcnt lgkmcnt(0)
    s_mov_b32 s27, 1536
    s_add_u32 m0, s26, 16384
    s_nop 0
    buffer_load_dwordx4 v20, s[16:19], s27 offen nt lds
    s_add_u32 m0, s26, 17408
    s_nop 0
    buffer_load_dwordx4 v21, s[16:19], s27 offen nt lds
    s_add_u32 m0, s26, 18432
    s_nop 0
    buffer_load_dwordx4 v22, s[16:19], s27 offen nt lds
    s_add_u32 m0, s26, 19456
    s_nop 0
    buffer_load_dwordx4 v23, s[16:19], s27 offen nt lds
    s_add_u32 m0, s26, 20480
    s_nop 0
    buffer_load_dwordx4 v24, s[16:19], s27 offen nt lds
    s_add_u32 m0, s26, 21504
    s_nop 0
    buffer_load_dwordx4 v25, s[16:19], s27 offen nt lds
    s_add_u32 m0, s26, 22528
    s_nop 0
    buffer_load_dwordx4 v26, s[16:19], s27 offen nt lds
    s_add_u32 m0, s26, 23552
    s_nop 0
    buffer_load_dwordx4 v27, s[16:19], s27 offen nt lds
    s_mov_b32 s27, 1536
    s_add_u32 m0, s26, 24576
    s_nop 0
    buffer_load_dwordx4 v20, s[32:35], s27 offen nt lds
    s_add_u32 m0, s26, 25600
    s_nop 0
    buffer_load_dwordx4 v21, s[32:35], s27 offen nt lds
    s_add_u32 m0, s26, 26624
    s_nop 0
    buffer_load_dwordx4 v22, s[32:35], s27 offen nt lds
    s_add_u32 m0, s26, 27648
    s_nop 0
    buffer_load_dwordx4 v23, s[32:35], s27 offen nt lds
    s_add_u32 m0, s26, 28672
    s_nop 0
    buffer_load_dwordx4 v24, s[32:35], s27 offen nt lds
    s_add_u32 m0, s26, 29696
    s_nop 0
    buffer_load_dwordx4 v25, s[32:35], s27 offen nt lds
    s_add_u32 m0, s26, 30720
    s_nop 0
    buffer_load_dwordx4 v26, s[32:35], s27 offen nt lds
    s_add_u32 m0, s26, 31744
    s_nop 0
    buffer_load_dwordx4 v27, s[32:35], s27 offen nt lds
    s_waitcnt vmcnt(16)
    ds_read_b128 a[128:131], v28 offset:0
    ds_read_b128 a[132:135], v28 offset:8192
    ds_read_b128 a[136:139], v29 offset:0
    ds_read_b128 a[140:143], v29 offset:8192
    ds_read_b128 a[144:147], v30 offset:0
    ds_read_b128 a[148:151], v30 offset:8192
    ds_read_b128 a[152:155], v31 offset:0
    ds_read_b128 a[156:159], v31 offset:8192
    s_waitcnt lgkmcnt(0)
    ds_read_b128 a[160:163], v28 offset:256
    ds_read_b128 a[164:167], v28 offset:8448
    ds_read_b128 a[168:171], v29 offset:256
    ds_read_b128 a[172:175], v29 offset:8448
    ds_read_b128 a[176:179], v30 offset:256
    ds_read_b128 a[180:183], v30 offset:8448
    ds_read_b128 a[184:187], v31 offset:256
    ds_read_b128 a[188:191], v31 offset:8448
    s_waitcnt lgkmcnt(0)
    s_waitcnt vmcnt(0)
    ds_read_b128 a[192:195], v28 offset:16384
    ds_read_b128 a[196:199], v28 offset:24576
    ds_read_b128 a[200:203], v29 offset:16384
    ds_read_b128 a[204:207], v29 offset:24576
    ds_read_b128 a[208:211], v30 offset:16384
    ds_read_b128 a[212:215], v30 offset:24576
    ds_read_b128 a[216:219], v31 offset:16384
    ds_read_b128 a[220:223], v31 offset:24576
    s_waitcnt lgkmcnt(0)
    ds_read_b128 a[224:227], v28 offset:16640
    ds_read_b128 a[228:231], v28 offset:24832
    ds_read_b128 a[232:235], v29 offset:16640
    ds_read_b128 a[236:239], v29 offset:24832
    ds_read_b128 a[240:243], v30 offset:16640
    ds_read_b128 a[244:247], v30 offset:24832
    ds_read_b128 a[248:251], v31 offset:16640
    ds_read_b128 a[252:255], v31 offset:24832
    s_waitcnt lgkmcnt(0)
    v_lshlrev_b32 v128, 16, v128
    v_lshlrev_b32 v129, 16, v129
    v_lshlrev_b32 v130, 16, v130
    v_mul_f32 v131, 0x3fb8aa3b, v130
    v_exp_f32 v131, v131
    s_nop 0
    v_cvt_pk_bf16_f32 v131, 0, v131
    v_mul_f32 v132, v131, v128
    v_mul_f32 v133, v131, v129
    v_mul_f32 v132, 0x3fb8aa3b, v132
    v_exp_f32 v132, v132
    v_mul_f32 v133, 0x3e22f983, v133
    v_fract_f32 v133, v133
    v_cos_f32 v134, v133
    v_sin_f32 v133, v133
    s_nop 0
    v_mul_f32 v88, v132, v134
    v_mul_f32 v89, v132, v133
    v_add_f32 v131, -1.0, v88
    v_mul_f32 v132, v131, v128
    v_fma_f32 v132, v89, v129, v132
    v_mul_f32 v133, v89, v128
    v_fma_f32 v133, -v131, v129, v133
    v_mul_f32 v134, v128, v128
    v_fma_f32 v134, v129, v129, v134
    v_rcp_f32 v134, v134
    s_nop 0
    v_add_f32 v134, v134, v134
    v_mul_f32 v90, v132, v134
    v_mul_f32 v91, v133, v134
    v_mov_b32 v92, v88
    v_mov_b32 v93, v89
    v_mul_f32 v131, v93, v93
    v_mul_f32 v93, v92, v93
    v_fma_f32 v92, v92, v92, -v131
    v_add_f32 v93, v93, v93
    v_mul_f32 v131, v93, v93
    v_mul_f32 v93, v92, v93
    v_fma_f32 v92, v92, v92, -v131
    v_add_f32 v93, v93, v93
    v_mul_f32 v131, v93, v93
    v_mul_f32 v93, v92, v93
    v_fma_f32 v92, v92, v92, -v131
    v_add_f32 v93, v93, v93
    v_xor_b32 v152, 0x80000000, v89
    v_xor_b32 v153, 0x80000000, v93
    v_xor_b32 v154, 0x80000000, v90
    v_xor_b32 v155, 0x80000000, v91
    v_mul_f32 v156, v88, v90
    v_mul_f32 v157, v88, v91
    v_fmac_f32 v156, v152, v91
    v_fmac_f32 v157, v89, v90
    v_mul_f32 v158, v88, v156
    v_mul_f32 v159, v88, v157
    v_fmac_f32 v158, v152, v157
    v_fmac_f32 v159, v89, v156
    v_mul_f32 v160, v88, v158
    v_mul_f32 v161, v88, v159
    v_fmac_f32 v160, v152, v159
    v_fmac_f32 v161, v89, v158
    v_mul_f32 v162, v88, v160
    v_mul_f32 v163, v88, v161
    v_fmac_f32 v162, v152, v161
    v_fmac_f32 v163, v89, v160
    v_mul_f32 v164, v88, v162
    v_mul_f32 v165, v88, v163
    v_fmac_f32 v164, v152, v163
    v_fmac_f32 v165, v89, v162
    v_mul_f32 v166, v88, v164
    v_mul_f32 v167, v88, v165
    v_fmac_f32 v166, v152, v165
    v_fmac_f32 v167, v89, v164
    v_mul_f32 v168, v88, v166
    v_mul_f32 v169, v88, v167
    v_fmac_f32 v168, v152, v167
    v_fmac_f32 v169, v89, v166
    v_mul_f32 v170, v88, v168
    v_mul_f32 v171, v88, v169
    v_fmac_f32 v170, v152, v169
    v_fmac_f32 v171, v89, v168
    v_mov_b32 v94, 0
    v_mov_b32 v95, 0
    v_mov_b32 v68, 0
    v_mov_b32 v69, 0
    v_mov_b32 v70, 0
    v_mov_b32 v71, 0
    v_mov_b32 v72, 0
    v_mov_b32 v73, 0
    v_mov_b32 v74, 0
    v_mov_b32 v75, 0
    v_mov_b32 v76, 0
    v_mov_b32 v77, 0
    v_mov_b32 v78, 0
    v_mov_b32 v79, 0
    v_mov_b32 v80, 0
    v_mov_b32 v81, 0
    v_mov_b32 v82, 0
    v_mov_b32 v83, 0
    s_lshl_b32 s21, s49, 12
    v_and_b32 v1, 63, v0
    v_and_b32 v2, 15, v0
    v_bfe_u32 v3, v0, 4, 2
    v_lshrrev_b32 v4, 6, v0
    v_lshrrev_b32 v5, 5, v1
    v_lshl_add_u32 v5, v4, 3, v5
    v_add_u32 v5, 0, v5
    v_and_b32 v6, 3, v5
    v_lshrrev_b32 v7, 3, v5
    v_lshl_add_u32 v6, v7, 2, v6
    v_and_b32 v7, 31, v1
    v_xor_b32 v6, v6, v7
    v_lshlrev_b32 v6, 4, v6
    v_lshl_add_u32 v8, v5, 11, v6
    v_lshrrev_b32 v5, 5, v1
    v_lshl_add_u32 v5, v4, 3, v5
    v_add_u32 v5, 2, v5
    v_and_b32 v6, 3, v5
    v_lshrrev_b32 v7, 3, v5
    v_lshl_add_u32 v6, v7, 2, v6
    v_and_b32 v7, 31, v1
    v_xor_b32 v6, v6, v7
    v_lshlrev_b32 v6, 4, v6
    v_lshl_add_u32 v9, v5, 11, v6
    v_lshrrev_b32 v5, 5, v1
    v_lshl_add_u32 v5, v4, 3, v5
    v_add_u32 v5, 4, v5
    v_and_b32 v6, 3, v5
    v_lshrrev_b32 v7, 3, v5
    v_lshl_add_u32 v6, v7, 2, v6
    v_and_b32 v7, 31, v1
    v_xor_b32 v6, v6, v7
    v_lshlrev_b32 v6, 4, v6
    v_lshl_add_u32 v10, v5, 11, v6
    v_lshrrev_b32 v5, 5, v1
    v_lshl_add_u32 v5, v4, 3, v5
    v_add_u32 v5, 6, v5
    v_and_b32 v6, 3, v5
    v_lshrrev_b32 v7, 3, v5
    v_lshl_add_u32 v6, v7, 2, v6
    v_and_b32 v7, 31, v1
    v_xor_b32 v6, v6, v7
    v_lshlrev_b32 v6, 4, v6
    v_lshl_add_u32 v11, v5, 11, v6
    v_and_b32 v5, 12, v2
    v_add_u32 v5, v5, v2
    v_add_u32 v6, 0, v3
    v_xor_b32 v6, v6, v2
    v_lshlrev_b32 v6, 4, v6
    v_lshl_add_u32 v12, v5, 9, v6
    v_add_u32 v6, 4, v3
    v_xor_b32 v6, v6, v2
    v_lshlrev_b32 v6, 4, v6
    v_lshl_add_u32 v13, v5, 9, v6
    v_add_u32 v6, 8, v3
    v_xor_b32 v6, v6, v2
    v_lshlrev_b32 v6, 4, v6
    v_lshl_add_u32 v14, v5, 9, v6
    v_add_u32 v6, 12, v3
    v_xor_b32 v6, v6, v2
    v_lshlrev_b32 v6, 4, v6
    v_lshl_add_u32 v15, v5, 9, v6
    v_add_u32 v16, 0x10000, v12
    v_add_u32 v17, 0x10000, v13
    v_add_u32 v18, 0x10000, v14
    v_add_u32 v19, 0x10000, v15
    s_mov_b32 s32, s98
    s_and_b32 s33, s99, 0xffff
    s_mov_b32 s34, 0x100
    s_mov_b32 s35, 0x00020000
    s_mov_b32 s25, 0
    v_mov_b32 v2, 0
L_pl_473:
    buffer_load_dword v1, v2, s[32:35], s25 offen sc1
    s_add_u32 s36, s36, 1
    s_cmp_gt_u32 s36, 0x100000
    s_cbranch_scc1 chain_kernel_wend
    s_waitcnt vmcnt(0)
    v_readfirstlane_b32 s26, v1
    s_and_b32 s27, s26, 0xffff
    s_cmp_ge_u32 s27, 256
    s_cbranch_scc1 L_plok_474
    s_sleep 4
    s_branch L_pl_473
L_plok_474:
    s_lshr_b32 s25, s26, 16
    s_cmp_gt_u32 s25, 16
    s_cselect_b32 s25, 0x2000, 0x0
    s_add_u32 s54, s100, 0x1fffff
    s_and_b32 s54, s54, 0xffe00000
    s_sub_u32 s55, s54, s100
    s_add_u32 s54, s55, s25
    s_xor_b32 s25, s25, 0x2000
    s_add_u32 s55, s55, s25
    s_mov_b32 s56, 0xffff0000
    s_mov_b32 s57, 0xffffffff
    s_mov_b32 s58, 0x0
    s_mov_b32 s59, 0xffffffff
    s_mov_b32 s60, 0x0
    s_mov_b32 s61, 0xffff0000
    s_mov_b32 s22, 0
    s_mov_b32 s24, 0
    s_mov_b32 s20, 0
    s_mov_b32 s37, 0
    s_mov_b32 s23, 64
    s_mov_b32 s38, 0x7ff00000
    s_mov_b32 s39, 0x7ff00000
    s_mov_b32 s43, 0x7ff00000
    s_barrier
    s_add_u32 m0, s21, 0
    s_nop 0
    buffer_load_dwordx4 v8, s[8:11], s20 offen lds
    s_add_u32 m0, s21, 1024
    s_nop 0
    buffer_load_dwordx4 v9, s[8:11], s20 offen lds
    s_add_u32 m0, s21, 2048
    s_nop 0
    buffer_load_dwordx4 v10, s[8:11], s20 offen lds
    s_add_u32 m0, s21, 3072
    s_nop 0
    buffer_load_dwordx4 v11, s[8:11], s20 offen lds
    s_add_u32 s20, s20, 512
    s_add_u32 m0, s21, 16384
    s_nop 0
    buffer_load_dwordx4 v8, s[8:11], s20 offen lds
    s_add_u32 m0, s21, 17408
    s_nop 0
    buffer_load_dwordx4 v9, s[8:11], s20 offen lds
    s_add_u32 m0, s21, 18432
    s_nop 0
    buffer_load_dwordx4 v10, s[8:11], s20 offen lds
    s_add_u32 m0, s21, 19456
    s_nop 0
    buffer_load_dwordx4 v11, s[8:11], s20 offen lds
    s_add_u32 s20, s20, 512
    s_add_u32 m0, s21, 32768
    s_nop 0
    buffer_load_dwordx4 v8, s[8:11], s20 offen lds
    s_add_u32 m0, s21, 33792
    s_nop 0
    buffer_load_dwordx4 v9, s[8:11], s20 offen lds
    s_add_u32 m0, s21, 34816
    s_nop 0
    buffer_load_dwordx4 v10, s[8:11], s20 offen lds
    s_add_u32 m0, s21, 35840
    s_nop 0
    buffer_load_dwordx4 v11, s[8:11], s20 offen lds
    s_add_u32 s20, s20, 512
    s_add_u32 m0, s21, 49152
    s_nop 0
    buffer_load_dwordx4 v8, s[8:11], s20 offen lds
    s_add_u32 m0, s21, 50176
    s_nop 0
    buffer_load_dwordx4 v9, s[8:11], s20 offen lds
    s_add_u32 m0, s21, 51200
    s_nop 0
    buffer_load_dwordx4 v10, s[8:11], s20 offen lds
    s_add_u32 m0, s21, 52224
    s_nop 0
    buffer_load_dwordx4 v11, s[8:11], s20 offen lds
    s_add_u32 s24, s24, 1
    s_min_u32 s24, s24, 63
    s_lshl_b32 s53, s24, 16
    s_mov_b32 s20, s53
    s_add_u32 m0, s21, 65536
    s_nop 0
    buffer_load_dwordx4 v8, s[8:11], s20 offen lds
    s_add_u32 m0, s21, 66560
    s_nop 0
    buffer_load_dwordx4 v9, s[8:11], s20 offen lds
    s_add_u32 m0, s21, 67584
    s_nop 0
    buffer_load_dwordx4 v10, s[8:11], s20 offen lds
    s_add_u32 m0, s21, 68608
    s_nop 0
    buffer_load_dwordx4 v11, s[8:11], s20 offen lds
    s_add_u32 s20, s20, 512
    s_add_u32 m0, s21, 81920
    s_nop 0
    buffer_load_dwordx4 v8, s[8:11], s20 offen lds
    s_add_u32 m0, s21, 82944
    s_nop 0
    buffer_load_dwordx4 v9, s[8:11], s20 offen lds
    s_add_u32 m0, s21, 83968
    s_nop 0
    buffer_load_dwordx4 v10, s[8:11], s20 offen lds
    s_add_u32 m0, s21, 84992
    s_nop 0
    buffer_load_dwordx4 v11, s[8:11], s20 offen lds
    s_add_u32 s20, s20, 512
    s_add_u32 m0, s21, 98304
    s_nop 0
    buffer_load_dwordx4 v8, s[8:11], s20 offen lds
    s_waitcnt vmcnt(21)
    s_barrier
    ds_read_b128 v[20:23], v12 offset:0
    ds_read_b128 v[24:27], v12 offset:2048
    ds_read_b128 v[28:31], v13 offset:0
    ds_read_b128 v[32:35], v13 offset:2048
    ds_read_b128 v[36:39], v14 offset:0
    ds_read_b128 v[40:43], v14 offset:2048
    s_waitcnt lgkmcnt(4)
L_st_478:
    v_mfma_f32_16x16x32_bf16 v[52:55], v[20:23], a[0:3], 0
    ds_read_b128 v[44:47], v15 offset:0
    s_add_u32 m0, s21, 99328
    v_mfma_f32_16x16x32_bf16 v[56:59], v[20:23], a[4:7], 0
    buffer_load_dwordx4 v9, s[8:11], s20 offen lds
    v_mfma_f32_16x16x32_bf16 v[60:63], v[24:27], a[0:3], 0
    ds_read_b128 v[48:51], v15 offset:2048
    v_cvt_pk_bf16_f32 v144, v180, v181
    v_mfma_f32_16x16x32_bf16 v[64:67], v[24:27], a[4:7], 0
    s_waitcnt lgkmcnt(4)
    v_cvt_pk_bf16_f32 v145, v182, v183
    v_fmac_f32 v69, v88, v68
    v_mfma_f32_16x16x32_bf16 v[52:55], v[28:31], a[8:11], v[52:55]
    ds_read_b128 v[20:23], v12 offset:256
    v_fmac_f32 v73, v88, v72
    v_mul_f32 v128, v90, v68
    v_mfma_f32_16x16x32_bf16 v[56:59], v[28:31], a[12:15], v[56:59]
    buffer_store_dwordx2 v[144:145], v86, s[12:15], s38 offen offset:0 sc1
    v_mfma_f32_16x16x32_bf16 v[60:63], v[32:35], a[8:11], v[60:63]
    ds_read_b128 v[24:27], v12 offset:2304
    v_cvt_pk_bf16_f32 v146, v184, v185
    v_mul_f32 v136, v154, v72
    v_mfma_f32_16x16x32_bf16 v[64:67], v[32:35], a[12:15], v[64:67]
    s_waitcnt lgkmcnt(4)
    v_fmac_f32 v69, v152, v72
    v_fmac_f32 v73, v89, v68
    v_mfma_f32_16x16x32_bf16 v[52:55], v[36:39], a[16:19], v[52:55]
    ds_read_b128 v[28:31], v13 offset:256
    s_add_u32 m0, s21, 100352
    v_mfma_f32_16x16x32_bf16 v[56:59], v[36:39], a[20:23], v[56:59]
    buffer_load_dwordx4 v10, s[8:11], s20 offen lds
    v_fmac_f32 v128, v155, v72
    v_mfma_f32_16x16x32_bf16 v[60:63], v[40:43], a[16:19], v[60:63]
    ds_read_b128 v[32:35], v13 offset:2304
    v_cvt_pk_bf16_f32 v147, v186, v187
    v_fmac_f32 v136, v155, v68
    v_mfma_f32_16x16x32_bf16 v[64:67], v[40:43], a[20:23], v[64:67]
    s_waitcnt lgkmcnt(4)
    v_fmac_f32 v70, v88, v69
    v_mfma_f32_16x16x32_bf16 v[52:55], v[44:47], a[24:27], v[52:55]
    ds_read_b128 v[36:39], v14 offset:256
    v_fmac_f32 v74, v88, v73
    v_mul_f32 v129, v90, v69
    v_mfma_f32_16x16x32_bf16 v[56:59], v[44:47], a[28:31], v[56:59]
    buffer_store_dwordx2 v[146:147], v86, s[12:15], s38 offen offset:256 sc1
    v_mul_f32 v137, v154, v73
    v_mfma_f32_16x16x32_bf16 v[60:63], v[48:51], a[24:27], v[60:63]
    ds_read_b128 v[40:43], v14 offset:2304
    v_cvt_pk_bf16_f32 v148, v188, v189
    v_mfma_f32_16x16x32_bf16 v[64:67], v[48:51], a[28:31], v[64:67]
    s_waitcnt lgkmcnt(4)
    v_fmac_f32 v70, v152, v73
    v_fmac_f32 v74, v89, v69
    v_mfma_f32_16x16x32_bf16 v[52:55], v[20:23], a[32:35], v[52:55]
    ds_read_b128 v[44:47], v15 offset:256
    s_add_u32 m0, s21, 101376
    v_fmac_f32 v129, v155, v73
    v_mfma_f32_16x16x32_bf16 v[56:59], v[20:23], a[36:39], v[56:59]
    buffer_load_dwordx4 v11, s[8:11], s20 offen lds
    v_mfma_f32_16x16x32_bf16 v[60:63], v[24:27], a[32:35], v[60:63]
    ds_read_b128 v[48:51], v15 offset:2304
    v_cvt_pk_bf16_f32 v149, v190, v191
    v_fmac_f32 v137, v155, v69
    v_mfma_f32_16x16x32_bf16 v[64:67], v[24:27], a[36:39], v[64:67]
    s_waitcnt lgkmcnt(4)
    v_fmac_f32 v71, v88, v70
    v_fmac_f32 v75, v88, v74
    v_mfma_f32_16x16x32_bf16 v[52:55], v[28:31], a[40:43], v[52:55]
    s_waitcnt vmcnt(20)
    s_barrier
    ds_read_b128 v[20:23], v12 offset:16384
    v_mfma_f32_16x16x32_bf16 v[56:59], v[28:31], a[44:47], v[56:59]
    s_add_u32 s20, s20, 512
    buffer_store_dwordx2 v[148:149], v86, s[12:15], s43 offen offset:0 sc1
    v_mfma_f32_16x16x32_bf16 v[60:63], v[32:35], a[40:43], v[60:63]
    ds_read_b128 v[24:27], v12 offset:18432
    v_cvt_pk_bf16_f32 v150, v192, v193
    v_mfma_f32_16x16x32_bf16 v[64:67], v[32:35], a[44:47], v[64:67]
    s_waitcnt lgkmcnt(4)
    v_mul_f32 v130, v90, v70
    v_mul_f32 v138, v154, v74
    v_mfma_f32_16x16x32_bf16 v[52:55], v[36:39], a[48:51], v[52:55]
    ds_read_b128 v[28:31], v13 offset:16384
    s_add_u32 m0, s21, 114688
    v_fmac_f32 v71, v152, v74
    v_mfma_f32_16x16x32_bf16 v[56:59], v[36:39], a[52:55], v[56:59]
    buffer_load_dwordx4 v8, s[8:11], s20 offen lds
    v_mfma_f32_16x16x32_bf16 v[60:63], v[40:43], a[48:51], v[60:63]
    ds_read_b128 v[32:35], v13 offset:18432
    v_cvt_pk_bf16_f32 v151, v194, v195
    v_fmac_f32 v75, v89, v70
    v_mfma_f32_16x16x32_bf16 v[64:67], v[40:43], a[52:55], v[64:67]
    s_waitcnt lgkmcnt(4)
    v_fmac_f32 v130, v155, v74
    v_fmac_f32 v138, v155, v70
    v_mfma_f32_16x16x32_bf16 v[52:55], v[44:47], a[56:59], v[52:55]
    ds_read_b128 v[36:39], v14 offset:16384
    v_fmac_f32 v76, v88, v71
    v_mfma_f32_16x16x32_bf16 v[56:59], v[44:47], a[60:63], v[56:59]
    buffer_store_dwordx2 v[150:151], v86, s[12:15], s43 offen offset:256 sc1
    v_fmac_f32 v80, v88, v75
    v_mfma_f32_16x16x32_bf16 v[60:63], v[48:51], a[56:59], v[60:63]
    ds_read_b128 v[40:43], v14 offset:18432
    v_mul_f32 v131, v90, v71
    v_mfma_f32_16x16x32_bf16 v[64:67], v[48:51], a[60:63], v[64:67]
    s_waitcnt lgkmcnt(4)
    v_mul_f32 v139, v154, v75
    v_fmac_f32 v76, v152, v75
    v_mfma_f32_16x16x32_bf16 v[52:55], v[20:23], a[64:67], v[52:55]
    ds_read_b128 v[44:47], v15 offset:16384
    s_add_u32 m0, s21, 115712
    v_fmac_f32 v80, v89, v71
    v_mfma_f32_16x16x32_bf16 v[56:59], v[20:23], a[68:71], v[56:59]
    buffer_load_dwordx4 v9, s[8:11], s20 offen lds
    v_mfma_f32_16x16x32_bf16 v[60:63], v[24:27], a[64:67], v[60:63]
    ds_read_b128 v[48:51], v15 offset:18432
    v_fmac_f32 v131, v155, v75
    v_fmac_f32 v139, v155, v71
    v_mfma_f32_16x16x32_bf16 v[64:67], v[24:27], a[68:71], v[64:67]
    s_waitcnt lgkmcnt(4)
    v_fmac_f32 v77, v88, v76
    v_mfma_f32_16x16x32_bf16 v[52:55], v[28:31], a[72:75], v[52:55]
    ds_read_b128 v[20:23], v12 offset:16640
    v_fmac_f32 v81, v88, v80
    v_mul_f32 v132, v90, v76
    v_mfma_f32_16x16x32_bf16 v[56:59], v[28:31], a[76:79], v[56:59]
    v_mul_f32 v140, v154, v80
    v_fmac_f32 v77, v152, v80
    v_mfma_f32_16x16x32_bf16 v[60:63], v[32:35], a[72:75], v[60:63]
    ds_read_b128 v[24:27], v12 offset:18688
    s_add_u32 s24, s24, 1
    v_fmac_f32 v81, v89, v76
    v_mfma_f32_16x16x32_bf16 v[64:67], v[32:35], a[76:79], v[64:67]
    s_waitcnt lgkmcnt(4)
    v_fmac_f32 v132, v155, v80
    v_mfma_f32_16x16x32_bf16 v[52:55], v[36:39], a[80:83], v[52:55]
    ds_read_b128 v[28:31], v13 offset:16640
    s_add_u32 m0, s21, 116736
    v_fmac_f32 v140, v155, v76
    v_mfma_f32_16x16x32_bf16 v[56:59], v[36:39], a[84:87], v[56:59]
    buffer_load_dwordx4 v10, s[8:11], s20 offen lds
    v_fmac_f32 v78, v88, v77
    v_mfma_f32_16x16x32_bf16 v[60:63], v[40:43], a[80:83], v[60:63]
    ds_read_b128 v[32:35], v13 offset:18688
    v_fmac_f32 v82, v88, v81
    v_mfma_f32_16x16x32_bf16 v[64:67], v[40:43], a[84:87], v[64:67]
    s_waitcnt lgkmcnt(4)
    s_min_u32 s24, s24, 63
    v_mul_f32 v133, v90, v77
    v_mfma_f32_16x16x32_bf16 v[52:55], v[44:47], a[88:91], v[52:55]
    ds_read_b128 v[36:39], v14 offset:16640
    v_mul_f32 v141, v154, v81
    v_mfma_f32_16x16x32_bf16 v[56:59], v[44:47], a[92:95], v[56:59]
    v_fmac_f32 v78, v152, v81
    v_fmac_f32 v82, v89, v77
    v_fmac_f32 v133, v155, v81
    v_mfma_f32_16x16x32_bf16 v[60:63], v[48:51], a[88:91], v[60:63]
    ds_read_b128 v[40:43], v14 offset:18688
    s_lshl_b32 s53, s24, 16
    v_mfma_f32_16x16x32_bf16 v[64:67], v[48:51], a[92:95], v[64:67]
    s_waitcnt lgkmcnt(4)
    v_fmac_f32 v141, v155, v77
    v_fmac_f32 v79, v88, v78
    v_mfma_f32_16x16x32_bf16 v[52:55], v[20:23], a[96:99], v[52:55]
    ds_read_b128 v[44:47], v15 offset:16640
    s_add_u32 m0, s21, 117760
    v_fmac_f32 v83, v88, v82
    v_mfma_f32_16x16x32_bf16 v[56:59], v[20:23], a[100:103], v[56:59]
    buffer_load_dwordx4 v11, s[8:11], s20 offen lds
    v_mfma_f32_16x16x32_bf16 v[60:63], v[24:27], a[96:99], v[60:63]
    ds_read_b128 v[48:51], v15 offset:18688
    v_mul_f32 v134, v90, v78
    v_mul_f32 v142, v154, v82
    v_mfma_f32_16x16x32_bf16 v[64:67], v[24:27], a[100:103], v[64:67]
    s_waitcnt lgkmcnt(4)
    v_fmac_f32 v79, v152, v82
    v_mfma_f32_16x16x32_bf16 v[52:55], v[28:31], a[104:107], v[52:55]
    s_waitcnt vmcnt(20)
    s_barrier
    ds_read_b128 v[20:23], v12 offset:32768
    v_mfma_f32_16x16x32_bf16 v[56:59], v[28:31], a[108:111], v[56:59]
    s_mov_b32 s20, s53
    v_fmac_f32 v83, v89, v78
    v_fmac_f32 v134, v155, v82
    v_mfma_f32_16x16x32_bf16 v[60:63], v[32:35], a[104:107], v[60:63]
    ds_read_b128 v[24:27], v12 offset:34816
    v_fmac_f32 v142, v155, v78
    v_mfma_f32_16x16x32_bf16 v[64:67], v[32:35], a[108:111], v[64:67]
    s_waitcnt lgkmcnt(4)
    v_mfma_f32_16x16x4_f32 v[104:107], v116, v79, 0
    v_mfma_f32_16x16x4_f32 v[108:111], v116, v83, 0
    v_mfma_f32_16x16x32_bf16 v[52:55], v[36:39], a[112:115], v[52:55]
    ds_read_b128 v[28:31], v13 offset:32768
    s_add_u32 m0, s21, 0
    v_mul_f32 v135, v90, v79
    v_mfma_f32_16x16x32_bf16 v[56:59], v[36:39], a[116:119], v[56:59]
    buffer_load_dwordx4 v8, s[8:11], s20 offen lds
    v_mfma_f32_16x16x32_bf16 v[60:63], v[40:43], a[112:115], v[60:63]
    ds_read_b128 v[32:35], v13 offset:34816
    v_mul_f32 v143, v154, v83
    v_fmac_f32 v135, v155, v83
    v_mfma_f32_16x16x32_bf16 v[64:67], v[40:43], a[116:119], v[64:67]
    s_waitcnt lgkmcnt(4)
    v_fmac_f32 v143, v155, v79
    v_mfma_f32_16x16x32_bf16 v[52:55], v[44:47], a[120:123], v[52:55]
    ds_read_b128 v[36:39], v14 offset:32768
    s_nop 0
    s_nop 0
    v_mfma_f32_16x16x32_bf16 v[56:59], v[44:47], a[124:127], v[56:59]
    s_nop 0
    s_nop 0
    v_mfma_f32_16x16x32_bf16 v[60:63], v[48:51], a[120:123], v[60:63]
    ds_read_b128 v[40:43], v14 offset:34816
    s_nop 0
    s_nop 0
    v_mfma_f32_16x16x32_bf16 v[64:67], v[48:51], a[124:127], v[64:67]
    s_waitcnt lgkmcnt(4)
    s_nop 0
    v_mfma_f32_16x16x32_bf16 v[52:55], v[20:23], a[128:131], v[52:55]
    ds_read_b128 v[44:47], v15 offset:32768
    s_add_u32 m0, s21, 1024
    v_fmac_f32 v104, v92, v94
    v_mfma_f32_16x16x32_bf16 v[56:59], v[20:23], a[132:135], v[56:59]
    buffer_load_dwordx4 v9, s[8:11], s20 offen lds
    v_fmac_f32 v108, v92, v95
    v_mfma_f32_16x16x32_bf16 v[60:63], v[24:27], a[128:131], v[60:63]
    ds_read_b128 v[48:51], v15 offset:34816
    v_fmac_f32 v104, v153, v95
    v_mfma_f32_16x16x32_bf16 v[64:67], v[24:27], a[132:135], v[64:67]
    s_waitcnt lgkmcnt(4)
    v_fmac_f32 v108, v93, v94
    v_cndmask_b32 v96, v94, v104, s[56:57]
    v_mfma_f32_16x16x32_bf16 v[52:55], v[28:31], a[136:139], v[52:55]
    ds_read_b128 v[20:23], v12 offset:33024
    v_cndmask_b32 v97, v95, v108, s[56:57]
    v_mfma_f32_16x16x32_bf16 v[56:59], v[28:31], a[140:143], v[56:59]
    v_fmac_f32 v105, v92, v104
    v_fmac_f32 v109, v92, v108
    v_mfma_f32_16x16x32_bf16 v[60:63], v[32:35], a[136:139], v[60:63]
    ds_read_b128 v[24:27], v12 offset:35072
    v_fmac_f32 v105, v153, v108
    v_fmac_f32 v109, v93, v104
    v_mfma_f32_16x16x32_bf16 v[64:67], v[32:35], a[140:143], v[64:67]
    s_waitcnt lgkmcnt(4)
    v_cndmask_b32 v96, v96, v105, s[58:59]
    v_mfma_f32_16x16x32_bf16 v[52:55], v[36:39], a[144:147], v[52:55]
    ds_read_b128 v[28:31], v13 offset:33024
    s_add_u32 m0, s21, 2048
    v_cndmask_b32 v97, v97, v109, s[58:59]
    v_mfma_f32_16x16x32_bf16 v[56:59], v[36:39], a[148:151], v[56:59]
    buffer_load_dwordx4 v10, s[8:11], s20 offen lds
    v_fmac_f32 v106, v92, v105
    v_mfma_f32_16x16x32_bf16 v[60:63], v[40:43], a[144:147], v[60:63]
    ds_read_b128 v[32:35], v13 offset:35072
    v_fmac_f32 v110, v92, v109
    v_mfma_f32_16x16x32_bf16 v[64:67], v[40:43], a[148:151], v[64:67]
    s_waitcnt lgkmcnt(4)
    v_fmac_f32 v106, v153, v109
    v_fmac_f32 v110, v93, v105
    v_mfma_f32_16x16x32_bf16 v[52:55], v[44:47], a[152:155], v[52:55]
    ds_read_b128 v[36:39], v14 offset:33024
    v_cndmask_b32 v96, v96, v106, s[60:61]
    v_mfma_f32_16x16x32_bf16 v[56:59], v[44:47], a[156:159], v[56:59]
    v_cndmask_b32 v97, v97, v110, s[60:61]
    v_fmac_f32 v107, v92, v106
    v_mfma_f32_16x16x32_bf16 v[60:63], v[48:51], a[152:155], v[60:63]
    ds_read_b128 v[40:43], v14 offset:35072
    v_fmac_f32 v111, v92, v110
    v_fmac_f32 v107, v153, v110
    v_mfma_f32_16x16x32_bf16 v[64:67], v[48:51], a[156:159], v[64:67]
    s_waitcnt lgkmcnt(4)
    v_fmac_f32 v111, v93, v106
    v_mfma_f32_16x16x32_bf16 v[52:55], v[20:23], a[160:163], v[52:55]
    ds_read_b128 v[44:47], v15 offset:33024
    s_add_u32 m0, s21, 3072
    v_xor_b32 v98, 0x80000000, v96
    v_mfma_f32_16x16x32_bf16 v[56:59], v[20:23], a[164:167], v[56:59]
    buffer_load_dwordx4 v11, s[8:11], s20 offen lds
    v_xor_b32 v99, 0x80000000, v97
    v_mfma_f32_16x16x32_bf16 v[60:63], v[24:27], a[160:163], v[60:63]
    ds_read_b128 v[48:51], v15 offset:35072
    v_mov_b32 v94, v107
    v_mfma_f32_16x16x32_bf16 v[64:67], v[24:27], a[164:167], v[64:67]
    s_waitcnt lgkmcnt(4)
    v_mov_b32 v95, v111
    v_fmac_f32 v128, v156, v96
    v_mfma_f32_16x16x32_bf16 v[52:55], v[28:31], a[168:171], v[52:55]
    s_waitcnt vmcnt(7)
    s_barrier
    ds_read_b128 v[20:23], v12 offset:49152
    v_mfma_f32_16x16x32_bf16 v[56:59], v[28:31], a[172:175], v[56:59]
    s_add_u32 s20, s20, 512
    buffer_atomic_add v84, v85, s[12:15], s39 offen sc1
    v_mfma_f32_16x16x32_bf16 v[60:63], v[32:35], a[168:171], v[60:63]
    ds_read_b128 v[24:27], v12 offset:51200
    v_fmac_f32 v136, v156, v99
    v_mfma_f32_16x16x32_bf16 v[64:67], v[32:35], a[172:175], v[64:67]
    s_waitcnt lgkmcnt(4)
    v_fmac_f32 v128, v157, v99
    v_fmac_f32 v136, v157, v98
    v_mfma_f32_16x16x32_bf16 v[52:55], v[36:39], a[176:179], v[52:55]
    ds_read_b128 v[28:31], v13 offset:49152
    s_add_u32 m0, s21, 16384
    v_fmac_f32 v129, v158, v96
    v_mfma_f32_16x16x32_bf16 v[56:59], v[36:39], a[180:183], v[56:59]
    buffer_load_dwordx4 v8, s[8:11], s20 offen lds
    v_mfma_f32_16x16x32_bf16 v[60:63], v[40:43], a[176:179], v[60:63]
    ds_read_b128 v[32:35], v13 offset:51200
    v_fmac_f32 v137, v158, v99
    v_fmac_f32 v129, v159, v99
    v_mfma_f32_16x16x32_bf16 v[64:67], v[40:43], a[180:183], v[64:67]
    s_waitcnt lgkmcnt(4)
    v_fmac_f32 v137, v159, v98
    v_mfma_f32_16x16x32_bf16 v[52:55], v[44:47], a[184:187], v[52:55]
    ds_read_b128 v[36:39], v14 offset:49152
    v_cvt_pk_bf16_f32 v120, v128, v129
    v_cvt_pk_bf16_f32 v124, v136, v137
    v_mfma_f32_16x16x32_bf16 v[56:59], v[44:47], a[188:191], v[56:59]
    v_fmac_f32 v130, v160, v96
    v_fmac_f32 v138, v160, v99
    v_mfma_f32_16x16x32_bf16 v[60:63], v[48:51], a[184:187], v[60:63]
    ds_read_b128 v[40:43], v14 offset:51200
    v_fmac_f32 v130, v161, v99
    v_fmac_f32 v138, v161, v98
    v_mfma_f32_16x16x32_bf16 v[64:67], v[48:51], a[188:191], v[64:67]
    s_waitcnt lgkmcnt(4)
    v_fmac_f32 v131, v162, v96
    v_mfma_f32_16x16x32_bf16 v[52:55], v[20:23], a[192:195], v[52:55]
    ds_read_b128 v[44:47], v15 offset:49152
    s_add_u32 m0, s21, 17408
    v_fmac_f32 v139, v162, v99
    v_mfma_f32_16x16x32_bf16 v[56:59], v[20:23], a[196:199], v[56:59]
    buffer_load_dwordx4 v9, s[8:11], s20 offen lds
    v_fmac_f32 v131, v163, v99
    v_mfma_f32_16x16x32_bf16 v[60:63], v[24:27], a[192:195], v[60:63]
    ds_read_b128 v[48:51], v15 offset:51200
    v_fmac_f32 v139, v163, v98
    v_mfma_f32_16x16x32_bf16 v[64:67], v[24:27], a[196:199], v[64:67]
    s_waitcnt lgkmcnt(4)
    v_cvt_pk_bf16_f32 v121, v130, v131
    v_mfma_f32_16x16x32_bf16 v[52:55], v[28:31], a[200:203], v[52:55]
    ds_read_b128 v[20:23], v12 offset:49408
    v_cvt_pk_bf16_f32 v125, v138, v139
    v_fmac_f32 v132, v164, v96
    v_mfma_f32_16x16x32_bf16 v[56:59], v[28:31], a[204:207], v[56:59]
    v_fmac_f32 v140, v164, v99
    v_fmac_f32 v132, v165, v99
    v_mfma_f32_16x16x32_bf16 v[60:63], v[32:35], a[200:203], v[60:63]
    ds_read_b128 v[24:27], v12 offset:51456
    v_fmac_f32 v140, v165, v98
    v_fmac_f32 v133, v166, v96
    v_mfma_f32_16x16x32_bf16 v[64:67], v[32:35], a[204:207], v[64:67]
    s_waitcnt lgkmcnt(4)
    v_fmac_f32 v141, v166, v99
    v_mfma_f32_16x16x32_bf16 v[52:55], v[36:39], a[208:211], v[52:55]
    ds_read_b128 v[28:31], v13 offset:49408
    s_add_u32 m0, s21, 18432
    v_fmac_f32 v133, v167, v99
    v_mfma_f32_16x16x32_bf16 v[56:59], v[36:39], a[212:215], v[56:59]
    buffer_load_dwordx4 v10, s[8:11], s20 offen lds
    v_fmac_f32 v141, v167, v98
    v_mfma_f32_16x16x32_bf16 v[60:63], v[40:43], a[208:211], v[60:63]
    ds_read_b128 v[32:35], v13 offset:51456
    v_cvt_pk_bf16_f32 v122, v132, v133
    v_mfma_f32_16x16x32_bf16 v[64:67], v[40:43], a[212:215], v[64:67]
    s_waitcnt lgkmcnt(4)
    v_cvt_pk_bf16_f32 v126, v140, v141
    v_fmac_f32 v134, v168, v96
    v_mfma_f32_16x16x32_bf16 v[52:55], v[44:47], a[216:219], v[52:55]
    ds_read_b128 v[36:39], v14 offset:49408
    v_fmac_f32 v142, v168, v99
    v_mfma_f32_16x16x32_bf16 v[56:59], v[44:47], a[220:223], v[56:59]
    v_fmac_f32 v134, v169, v99
    v_fmac_f32 v142, v169, v98
    v_mfma_f32_16x16x32_bf16 v[60:63], v[48:51], a[216:219], v[60:63]
    ds_read_b128 v[40:43], v14 offset:51456
    v_fmac_f32 v135, v170, v96
    v_fmac_f32 v143, v170, v99
    v_mfma_f32_16x16x32_bf16 v[64:67], v[48:51], a[220:223], v[64:67]
    s_waitcnt lgkmcnt(4)
    v_fmac_f32 v135, v171, v99
    v_mfma_f32_16x16x32_bf16 v[52:55], v[20:23], a[224:227], v[52:55]
    ds_read_b128 v[44:47], v15 offset:49408
    s_add_u32 m0, s21, 19456
    v_fmac_f32 v143, v171, v98
    v_mfma_f32_16x16x32_bf16 v[56:59], v[20:23], a[228:231], v[56:59]
    buffer_load_dwordx4 v11, s[8:11], s20 offen lds
    v_cvt_pk_bf16_f32 v123, v134, v135
    v_mfma_f32_16x16x32_bf16 v[60:63], v[24:27], a[224:227], v[60:63]
    ds_read_b128 v[48:51], v15 offset:51456
    v_cvt_pk_bf16_f32 v127, v142, v143
    v_mfma_f32_16x16x32_bf16 v[64:67], v[24:27], a[228:231], v[64:67]
    s_waitcnt lgkmcnt(4)
    s_nop 0
    s_nop 0
    v_mfma_f32_16x16x32_bf16 v[52:55], v[28:31], a[232:235], v[52:55]
    s_waitcnt vmcnt(20)
    s_barrier
    ds_read_b128 v[20:23], v16 offset:0
    v_mfma_f32_16x16x32_bf16 v[56:59], v[28:31], a[236:239], v[56:59]
    s_add_u32 s20, s20, 512
    v_mfma_f32_16x16x32_bf16 v[180:183], v[120:123], v[172:175], 0
    v_mfma_f32_16x16x32_bf16 v[60:63], v[32:35], a[232:235], v[60:63]
    ds_read_b128 v[24:27], v16 offset:2048
    v_mfma_f32_16x16x32_bf16 v[184:187], v[120:123], v[176:179], 0
    v_mfma_f32_16x16x32_bf16 v[188:191], v[124:127], v[172:175], 0
    v_mfma_f32_16x16x32_bf16 v[64:67], v[32:35], a[236:239], v[64:67]
    s_waitcnt lgkmcnt(4)
    v_mfma_f32_16x16x32_bf16 v[192:195], v[124:127], v[176:179], 0
    v_mfma_f32_16x16x32_bf16 v[52:55], v[36:39], a[240:243], v[52:55]
    ds_read_b128 v[28:31], v17 offset:0
    s_add_u32 m0, s21, 32768
    s_sub_u32 s39, s22, 1
    v_mfma_f32_16x16x32_bf16 v[56:59], v[36:39], a[244:247], v[56:59]
    buffer_load_dwordx4 v8, s[8:11], s20 offen lds
    s_lshl_b32 s38, s39, 17
    v_mfma_f32_16x16x32_bf16 v[60:63], v[40:43], a[240:243], v[60:63]
    ds_read_b128 v[32:35], v17 offset:2048
    s_add_u32 s38, s38, 0x4400000
    v_mfma_f32_16x16x32_bf16 v[64:67], v[40:43], a[244:247], v[64:67]
    s_waitcnt lgkmcnt(4)
    s_add_u32 s43, s38, 0x10000
    s_lshl_b32 s39, s39, 7
    v_mfma_f32_16x16x32_bf16 v[52:55], v[44:47], a[248:251], v[52:55]
    ds_read_b128 v[36:39], v18 offset:0
    s_add_u32 s39, s39, 0x5902000
    v_mfma_f32_16x16x32_bf16 v[56:59], v[44:47], a[252:255], v[56:59]
    s_cmp_eq_u32 s37, 0
    s_cselect_b32 s38, 0x7ff00000, s38
    s_cselect_b32 s39, 0x7ff00000, s39
    s_cselect_b32 s43, 0x7ff00000, s43
    v_mfma_f32_16x16x32_bf16 v[60:63], v[48:51], a[248:251], v[60:63]
    ds_read_b128 v[40:43], v18 offset:2048
    v_mfma_f32_16x16x32_bf16 v[64:67], v[48:51], a[252:255], v[64:67]
    s_waitcnt lgkmcnt(4)
    s_mov_b32 s37, 1
    s_add_u32 s22, s22, 1
    s_cmp_ge_u32 s22, s23
    s_cbranch_scc1 L_fl0_475
    v_mfma_f32_16x16x32_bf16 v[68:71], v[20:23], a[0:3], 0
    ds_read_b128 v[44:47], v19 offset:0
    s_add_u32 m0, s21, 33792
    v_mfma_f32_16x16x32_bf16 v[72:75], v[20:23], a[4:7], 0
    buffer_load_dwordx4 v9, s[8:11], s20 offen lds
    v_mfma_f32_16x16x32_bf16 v[76:79], v[24:27], a[0:3], 0
    ds_read_b128 v[48:51], v19 offset:2048
    v_cvt_pk_bf16_f32 v144, v180, v181
    v_mfma_f32_16x16x32_bf16 v[80:83], v[24:27], a[4:7], 0
    s_waitcnt lgkmcnt(4)
    v_cvt_pk_bf16_f32 v145, v182, v183
    v_fmac_f32 v53, v88, v52
    v_mfma_f32_16x16x32_bf16 v[68:71], v[28:31], a[8:11], v[68:71]
    ds_read_b128 v[20:23], v16 offset:256
    v_fmac_f32 v57, v88, v56
    v_mul_f32 v128, v90, v52
    v_mfma_f32_16x16x32_bf16 v[72:75], v[28:31], a[12:15], v[72:75]
    buffer_store_dwordx2 v[144:145], v86, s[12:15], s38 offen offset:0 sc1
    v_mfma_f32_16x16x32_bf16 v[76:79], v[32:35], a[8:11], v[76:79]
    ds_read_b128 v[24:27], v16 offset:2304
    v_cvt_pk_bf16_f32 v146, v184, v185
    v_mul_f32 v136, v154, v56
    v_mfma_f32_16x16x32_bf16 v[80:83], v[32:35], a[12:15], v[80:83]
    s_waitcnt lgkmcnt(4)
    v_fmac_f32 v53, v152, v56
    v_fmac_f32 v57, v89, v52
    v_mfma_f32_16x16x32_bf16 v[68:71], v[36:39], a[16:19], v[68:71]
    ds_read_b128 v[28:31], v17 offset:256
    s_add_u32 m0, s21, 34816
    v_mfma_f32_16x16x32_bf16 v[72:75], v[36:39], a[20:23], v[72:75]
    buffer_load_dwordx4 v10, s[8:11], s20 offen lds
    v_fmac_f32 v128, v155, v56
    v_mfma_f32_16x16x32_bf16 v[76:79], v[40:43], a[16:19], v[76:79]
    ds_read_b128 v[32:35], v17 offset:2304
    v_cvt_pk_bf16_f32 v147, v186, v187
    v_fmac_f32 v136, v155, v52
    v_mfma_f32_16x16x32_bf16 v[80:83], v[40:43], a[20:23], v[80:83]
    s_waitcnt lgkmcnt(4)
    v_fmac_f32 v54, v88, v53
    v_mfma_f32_16x16x32_bf16 v[68:71], v[44:47], a[24:27], v[68:71]
    ds_read_b128 v[36:39], v18 offset:256
    v_fmac_f32 v58, v88, v57
    v_mul_f32 v129, v90, v53
    v_mfma_f32_16x16x32_bf16 v[72:75], v[44:47], a[28:31], v[72:75]
    buffer_store_dwordx2 v[146:147], v86, s[12:15], s38 offen offset:256 sc1
    v_mul_f32 v137, v154, v57
    v_mfma_f32_16x16x32_bf16 v[76:79], v[48:51], a[24:27], v[76:79]
    ds_read_b128 v[40:43], v18 offset:2304
    v_cvt_pk_bf16_f32 v148, v188, v189
    v_mfma_f32_16x16x32_bf16 v[80:83], v[48:51], a[28:31], v[80:83]
    s_waitcnt lgkmcnt(4)
    v_fmac_f32 v54, v152, v57
    v_fmac_f32 v58, v89, v53
    v_mfma_f32_16x16x32_bf16 v[68:71], v[20:23], a[32:35], v[68:71]
    ds_read_b128 v[44:47], v19 offset:256
    s_add_u32 m0, s21, 35840
    v_fmac_f32 v129, v155, v57
    v_mfma_f32_16x16x32_bf16 v[72:75], v[20:23], a[36:39], v[72:75]
    buffer_load_dwordx4 v11, s[8:11], s20 offen lds
    v_mfma_f32_16x16x32_bf16 v[76:79], v[24:27], a[32:35], v[76:79]
    ds_read_b128 v[48:51], v19 offset:2304
    v_cvt_pk_bf16_f32 v149, v190, v191
    v_fmac_f32 v137, v155, v53
    v_mfma_f32_16x16x32_bf16 v[80:83], v[24:27], a[36:39], v[80:83]
    s_waitcnt lgkmcnt(4)
    v_fmac_f32 v55, v88, v54
    v_fmac_f32 v59, v88, v58
    v_mfma_f32_16x16x32_bf16 v[68:71], v[28:31], a[40:43], v[68:71]
    s_waitcnt vmcnt(20)
    s_barrier
    ds_read_b128 v[20:23], v16 offset:16384
    v_mfma_f32_16x16x32_bf16 v[72:75], v[28:31], a[44:47], v[72:75]
    s_add_u32 s20, s20, 512
    buffer_store_dwordx2 v[148:149], v86, s[12:15], s43 offen offset:0 sc1
    v_mfma_f32_16x16x32_bf16 v[76:79], v[32:35], a[40:43], v[76:79]
    ds_read_b128 v[24:27], v16 offset:18432
    v_cvt_pk_bf16_f32 v150, v192, v193
    v_mfma_f32_16x16x32_bf16 v[80:83], v[32:35], a[44:47], v[80:83]
    s_waitcnt lgkmcnt(4)
    v_mul_f32 v130, v90, v54
    v_mul_f32 v138, v154, v58
    v_mfma_f32_16x16x32_bf16 v[68:71], v[36:39], a[48:51], v[68:71]
    ds_read_b128 v[28:31], v17 offset:16384
    s_add_u32 m0, s21, 49152
    v_fmac_f32 v55, v152, v58
    v_mfma_f32_16x16x32_bf16 v[72:75], v[36:39], a[52:55], v[72:75]
    buffer_load_dwordx4 v8, s[8:11], s20 offen lds
    v_mfma_f32_16x16x32_bf16 v[76:79], v[40:43], a[48:51], v[76:79]
    ds_read_b128 v[32:35], v17 offset:18432
    v_cvt_pk_bf16_f32 v151, v194, v195
    v_fmac_f32 v59, v89, v54
    v_mfma_f32_16x16x32_bf16 v[80:83], v[40:43], a[52:55], v[80:83]
    s_waitcnt lgkmcnt(4)
    v_fmac_f32 v130, v155, v58
    v_fmac_f32 v138, v155, v54
    v_mfma_f32_16x16x32_bf16 v[68:71], v[44:47], a[56:59], v[68:71]
    ds_read_b128 v[36:39], v18 offset:16384
    v_fmac_f32 v60, v88, v55
    v_mfma_f32_16x16x32_bf16 v[72:75], v[44:47], a[60:63], v[72:75]
    buffer_store_dwordx2 v[150:151], v86, s[12:15], s43 offen offset:256 sc1
    v_fmac_f32 v64, v88, v59
    v_mfma_f32_16x16x32_bf16 v[76:79], v[48:51], a[56:59], v[76:79]
    ds_read_b128 v[40:43], v18 offset:18432
    v_mul_f32 v131, v90, v55
    v_mfma_f32_16x16x32_bf16 v[80:83], v[48:51], a[60:63], v[80:83]
    s_waitcnt lgkmcnt(4)
    v_mul_f32 v139, v154, v59
    v_fmac_f32 v60, v152, v59
    v_mfma_f32_16x16x32_bf16 v[68:71], v[20:23], a[64:67], v[68:71]
    ds_read_b128 v[44:47], v19 offset:16384
    s_add_u32 m0, s21, 50176
    v_fmac_f32 v64, v89, v55
    v_mfma_f32_16x16x32_bf16 v[72:75], v[20:23], a[68:71], v[72:75]
    buffer_load_dwordx4 v9, s[8:11], s20 offen lds
    v_mfma_f32_16x16x32_bf16 v[76:79], v[24:27], a[64:67], v[76:79]
    ds_read_b128 v[48:51], v19 offset:18432
    v_fmac_f32 v131, v155, v59
    v_fmac_f32 v139, v155, v55
    v_mfma_f32_16x16x32_bf16 v[80:83], v[24:27], a[68:71], v[80:83]
    s_waitcnt lgkmcnt(4)
    v_fmac_f32 v61, v88, v60
    v_mfma_f32_16x16x32_bf16 v[68:71], v[28:31], a[72:75], v[68:71]
    ds_read_b128 v[20:23], v16 offset:16640
    v_fmac_f32 v65, v88, v64
    v_mul_f32 v132, v90, v60
    v_mfma_f32_16x16x32_bf16 v[72:75], v[28:31], a[76:79], v[72:75]
    v_mul_f32 v140, v154, v64
    v_fmac_f32 v61, v152, v64
    v_mfma_f32_16x16x32_bf16 v[76:79], v[32:35], a[72:75], v[76:79]
    ds_read_b128 v[24:27], v16 offset:18688
    s_add_u32 s24, s24, 1
    v_fmac_f32 v65, v89, v60
    v_mfma_f32_16x16x32_bf16 v[80:83], v[32:35], a[76:79], v[80:83]
    s_waitcnt lgkmcnt(4)
    v_fmac_f32 v132, v155, v64
    v_mfma_f32_16x16x32_bf16 v[68:71], v[36:39], a[80:83], v[68:71]
    ds_read_b128 v[28:31], v17 offset:16640
    s_add_u32 m0, s21, 51200
    v_fmac_f32 v140, v155, v60
    v_mfma_f32_16x16x32_bf16 v[72:75], v[36:39], a[84:87], v[72:75]
    buffer_load_dwordx4 v10, s[8:11], s20 offen lds
    v_fmac_f32 v62, v88, v61
    v_mfma_f32_16x16x32_bf16 v[76:79], v[40:43], a[80:83], v[76:79]
    ds_read_b128 v[32:35], v17 offset:18688
    v_fmac_f32 v66, v88, v65
    v_mfma_f32_16x16x32_bf16 v[80:83], v[40:43], a[84:87], v[80:83]
    s_waitcnt lgkmcnt(4)
    s_min_u32 s24, s24, 63
    v_mul_f32 v133, v90, v61
    v_mfma_f32_16x16x32_bf16 v[68:71], v[44:47], a[88:91], v[68:71]
    ds_read_b128 v[36:39], v18 offset:16640
    v_mul_f32 v141, v154, v65
    v_mfma_f32_16x16x32_bf16 v[72:75], v[44:47], a[92:95], v[72:75]
    v_fmac_f32 v62, v152, v65
    v_fmac_f32 v66, v89, v61
    v_fmac_f32 v133, v155, v65
    v_mfma_f32_16x16x32_bf16 v[76:79], v[48:51], a[88:91], v[76:79]
    ds_read_b128 v[40:43], v18 offset:18688
    s_lshl_b32 s53, s24, 16
    v_mfma_f32_16x16x32_bf16 v[80:83], v[48:51], a[92:95], v[80:83]
    s_waitcnt lgkmcnt(4)
    v_fmac_f32 v141, v155, v61
    v_fmac_f32 v63, v88, v62
    v_mfma_f32_16x16x32_bf16 v[68:71], v[20:23], a[96:99], v[68:71]
    ds_read_b128 v[44:47], v19 offset:16640
    s_add_u32 m0, s21, 52224
    v_fmac_f32 v67, v88, v66
    v_mfma_f32_16x16x32_bf16 v[72:75], v[20:23], a[100:103], v[72:75]
    buffer_load_dwordx4 v11, s[8:11], s20 offen lds
    v_mfma_f32_16x16x32_bf16 v[76:79], v[24:27], a[96:99], v[76:79]
    ds_read_b128 v[48:51], v19 offset:18688
    v_mul_f32 v134, v90, v62
    v_mul_f32 v142, v154, v66
    v_mfma_f32_16x16x32_bf16 v[80:83], v[24:27], a[100:103], v[80:83]
    s_waitcnt lgkmcnt(4)
    v_fmac_f32 v63, v152, v66
    v_mfma_f32_16x16x32_bf16 v[68:71], v[28:31], a[104:107], v[68:71]
    s_waitcnt vmcnt(20)
    s_barrier
    ds_read_b128 v[20:23], v16 offset:32768
    v_mfma_f32_16x16x32_bf16 v[72:75], v[28:31], a[108:111], v[72:75]
    s_mov_b32 s20, s53
    v_fmac_f32 v67, v89, v62
    v_fmac_f32 v134, v155, v66
    v_mfma_f32_16x16x32_bf16 v[76:79], v[32:35], a[104:107], v[76:79]
    ds_read_b128 v[24:27], v16 offset:34816
    v_fmac_f32 v142, v155, v62
    v_mfma_f32_16x16x32_bf16 v[80:83], v[32:35], a[108:111], v[80:83]
    s_waitcnt lgkmcnt(4)
    v_mfma_f32_16x16x4_f32 v[104:107], v116, v63, 0
    v_mfma_f32_16x16x4_f32 v[108:111], v116, v67, 0
    v_mfma_f32_16x16x32_bf16 v[68:71], v[36:39], a[112:115], v[68:71]
    ds_read_b128 v[28:31], v17 offset:32768
    s_add_u32 m0, s21, 65536
    v_mul_f32 v135, v90, v63
    v_mfma_f32_16x16x32_bf16 v[72:75], v[36:39], a[116:119], v[72:75]
    buffer_load_dwordx4 v8, s[8:11], s20 offen lds
    v_mfma_f32_16x16x32_bf16 v[76:79], v[40:43], a[112:115], v[76:79]
    ds_read_b128 v[32:35], v17 offset:34816
    v_mul_f32 v143, v154, v67
    v_fmac_f32 v135, v155, v67
    v_mfma_f32_16x16x32_bf16 v[80:83], v[40:43], a[116:119], v[80:83]
    s_waitcnt lgkmcnt(4)
    v_fmac_f32 v143, v155, v63
    v_mfma_f32_16x16x32_bf16 v[68:71], v[44:47], a[120:123], v[68:71]
    ds_read_b128 v[36:39], v18 offset:32768
    s_nop 0
    s_nop 0
    v_mfma_f32_16x16x32_bf16 v[72:75], v[44:47], a[124:127], v[72:75]
    s_nop 0
    s_nop 0
    v_mfma_f32_16x16x32_bf16 v[76:79], v[48:51], a[120:123], v[76:79]
    ds_read_b128 v[40:43], v18 offset:34816
    s_nop 0
    s_nop 0
    v_mfma_f32_16x16x32_bf16 v[80:83], v[48:51], a[124:127], v[80:83]
    s_waitcnt lgkmcnt(4)
    s_nop 0
    v_mfma_f32_16x16x32_bf16 v[68:71], v[20:23], a[128:131], v[68:71]
    ds_read_b128 v[44:47], v19 offset:32768
    s_add_u32 m0, s21, 66560
    v_fmac_f32 v104, v92, v94
    v_mfma_f32_16x16x32_bf16 v[72:75], v[20:23], a[132:135], v[72:75]
    buffer_load_dwordx4 v9, s[8:11], s20 offen lds
    v_fmac_f32 v108, v92, v95
    v_mfma_f32_16x16x32_bf16 v[76:79], v[24:27], a[128:131], v[76:79]
    ds_read_b128 v[48:51], v19 offset:34816
    v_fmac_f32 v104, v153, v95
    v_mfma_f32_16x16x32_bf16 v[80:83], v[24:27], a[132:135], v[80:83]
    s_waitcnt lgkmcnt(4)
    v_fmac_f32 v108, v93, v94
    v_cndmask_b32 v96, v94, v104, s[56:57]
    v_mfma_f32_16x16x32_bf16 v[68:71], v[28:31], a[136:139], v[68:71]
    ds_read_b128 v[20:23], v16 offset:33024
    v_cndmask_b32 v97, v95, v108, s[56:57]
    v_mfma_f32_16x16x32_bf16 v[72:75], v[28:31], a[140:143], v[72:75]
    v_fmac_f32 v105, v92, v104
    v_fmac_f32 v109, v92, v108
    v_mfma_f32_16x16x32_bf16 v[76:79], v[32:35], a[136:139], v[76:79]
    ds_read_b128 v[24:27], v16 offset:35072
    v_fmac_f32 v105, v153, v108
    v_fmac_f32 v109, v93, v104
    v_mfma_f32_16x16x32_bf16 v[80:83], v[32:35], a[140:143], v[80:83]
    s_waitcnt lgkmcnt(4)
    v_cndmask_b32 v96, v96, v105, s[58:59]
    v_mfma_f32_16x16x32_bf16 v[68:71], v[36:39], a[144:147], v[68:71]
    ds_read_b128 v[28:31], v17 offset:33024
    s_add_u32 m0, s21, 67584
    v_cndmask_b32 v97, v97, v109, s[58:59]
    v_mfma_f32_16x16x32_bf16 v[72:75], v[36:39], a[148:151], v[72:75]
    buffer_load_dwordx4 v10, s[8:11], s20 offen lds
    v_fmac_f32 v106, v92, v105
    v_mfma_f32_16x16x32_bf16 v[76:79], v[40:43], a[144:147], v[76:79]
    ds_read_b128 v[32:35], v17 offset:35072
    v_fmac_f32 v110, v92, v109
    v_mfma_f32_16x16x32_bf16 v[80:83], v[40:43], a[148:151], v[80:83]
    s_waitcnt lgkmcnt(4)
    v_fmac_f32 v106, v153, v109
    v_fmac_f32 v110, v93, v105
    v_mfma_f32_16x16x32_bf16 v[68:71], v[44:47], a[152:155], v[68:71]
    ds_read_b128 v[36:39], v18 offset:33024
    v_cndmask_b32 v96, v96, v106, s[60:61]
    v_mfma_f32_16x16x32_bf16 v[72:75], v[44:47], a[156:159], v[72:75]
    v_cndmask_b32 v97, v97, v110, s[60:61]
    v_fmac_f32 v107, v92, v106
    v_mfma_f32_16x16x32_bf16 v[76:79], v[48:51], a[152:155], v[76:79]
    ds_read_b128 v[40:43], v18 offset:35072
    v_fmac_f32 v111, v92, v110
    v_fmac_f32 v107, v153, v110
    v_mfma_f32_16x16x32_bf16 v[80:83], v[48:51], a[156:159], v[80:83]
    s_waitcnt lgkmcnt(4)
    v_fmac_f32 v111, v93, v106
    v_mfma_f32_16x16x32_bf16 v[68:71], v[20:23], a[160:163], v[68:71]
    ds_read_b128 v[44:47], v19 offset:33024
    s_add_u32 m0, s21, 68608
    v_xor_b32 v98, 0x80000000, v96
    v_mfma_f32_16x16x32_bf16 v[72:75], v[20:23], a[164:167], v[72:75]
    buffer_load_dwordx4 v11, s[8:11], s20 offen lds
    v_xor_b32 v99, 0x80000000, v97
    v_mfma_f32_16x16x32_bf16 v[76:79], v[24:27], a[160:163], v[76:79]
    ds_read_b128 v[48:51], v19 offset:35072
    v_mov_b32 v94, v107
    v_mfma_f32_16x16x32_bf16 v[80:83], v[24:27], a[164:167], v[80:83]
    s_waitcnt lgkmcnt(4)
    v_mov_b32 v95, v111
    v_fmac_f32 v128, v156, v96
    v_mfma_f32_16x16x32_bf16 v[68:71], v[28:31], a[168:171], v[68:71]
    s_waitcnt vmcnt(7)
    s_barrier
    ds_read_b128 v[20:23], v16 offset:49152
    v_mfma_f32_16x16x32_bf16 v[72:75], v[28:31], a[172:175], v[72:75]
    s_add_u32 s20, s20, 512
    buffer_atomic_add v84, v85, s[12:15], s39 offen sc1
    v_mfma_f32_16x16x32_bf16 v[76:79], v[32:35], a[168:171], v[76:79]
    ds_read_b128 v[24:27], v16 offset:51200
    v_fmac_f32 v136, v156, v99
    v_mfma_f32_16x16x32_bf16 v[80:83], v[32:35], a[172:175], v[80:83]
    s_waitcnt lgkmcnt(4)
    v_fmac_f32 v128, v157, v99
    v_fmac_f32 v136, v157, v98
    v_mfma_f32_16x16x32_bf16 v[68:71], v[36:39], a[176:179], v[68:71]
    ds_read_b128 v[28:31], v17 offset:49152
    s_add_u32 m0, s21, 81920
    v_fmac_f32 v129, v158, v96
    v_mfma_f32_16x16x32_bf16 v[72:75], v[36:39], a[180:183], v[72:75]
    buffer_load_dwordx4 v8, s[8:11], s20 offen lds
    v_mfma_f32_16x16x32_bf16 v[76:79], v[40:43], a[176:179], v[76:79]
    ds_read_b128 v[32:35], v17 offset:51200
    v_fmac_f32 v137, v158, v99
    v_fmac_f32 v129, v159, v99
    v_mfma_f32_16x16x32_bf16 v[80:83], v[40:43], a[180:183], v[80:83]
    s_waitcnt lgkmcnt(4)
    v_fmac_f32 v137, v159, v98
    v_mfma_f32_16x16x32_bf16 v[68:71], v[44:47], a[184:187], v[68:71]
    ds_read_b128 v[36:39], v18 offset:49152
    v_cvt_pk_bf16_f32 v120, v128, v129
    v_cvt_pk_bf16_f32 v124, v136, v137
    v_mfma_f32_16x16x32_bf16 v[72:75], v[44:47], a[188:191], v[72:75]
    v_fmac_f32 v130, v160, v96
    v_fmac_f32 v138, v160, v99
    v_mfma_f32_16x16x32_bf16 v[76:79], v[48:51], a[184:187], v[76:79]
    ds_read_b128 v[40:43], v18 offset:51200
    v_fmac_f32 v130, v161, v99
    v_fmac_f32 v138, v161, v98
    v_mfma_f32_16x16x32_bf16 v[80:83], v[48:51], a[188:191], v[80:83]
    s_waitcnt lgkmcnt(4)
    v_fmac_f32 v131, v162, v96
    v_mfma_f32_16x16x32_bf16 v[68:71], v[20:23], a[192:195], v[68:71]
    ds_read_b128 v[44:47], v19 offset:49152
    s_add_u32 m0, s21, 82944
    v_fmac_f32 v139, v162, v99
    v_mfma_f32_16x16x32_bf16 v[72:75], v[20:23], a[196:199], v[72:75]
    buffer_load_dwordx4 v9, s[8:11], s20 offen lds
    v_fmac_f32 v131, v163, v99
    v_mfma_f32_16x16x32_bf16 v[76:79], v[24:27], a[192:195], v[76:79]
    ds_read_b128 v[48:51], v19 offset:51200
    v_fmac_f32 v139, v163, v98
    v_mfma_f32_16x16x32_bf16 v[80:83], v[24:27], a[196:199], v[80:83]
    s_waitcnt lgkmcnt(4)
    v_cvt_pk_bf16_f32 v121, v130, v131
    v_mfma_f32_16x16x32_bf16 v[68:71], v[28:31], a[200:203], v[68:71]
    ds_read_b128 v[20:23], v16 offset:49408
    v_cvt_pk_bf16_f32 v125, v138, v139
    v_fmac_f32 v132, v164, v96
    v_mfma_f32_16x16x32_bf16 v[72:75], v[28:31], a[204:207], v[72:75]
    v_fmac_f32 v140, v164, v99
    v_fmac_f32 v132, v165, v99
    v_mfma_f32_16x16x32_bf16 v[76:79], v[32:35], a[200:203], v[76:79]
    ds_read_b128 v[24:27], v16 offset:51456
    v_fmac_f32 v140, v165, v98
    v_fmac_f32 v133, v166, v96
    v_mfma_f32_16x16x32_bf16 v[80:83], v[32:35], a[204:207], v[80:83]
    s_waitcnt lgkmcnt(4)
    v_fmac_f32 v141, v166, v99
    v_mfma_f32_16x16x32_bf16 v[68:71], v[36:39], a[208:211], v[68:71]
    ds_read_b128 v[28:31], v17 offset:49408
    s_add_u32 m0, s21, 83968
    v_fmac_f32 v133, v167, v99
    v_mfma_f32_16x16x32_bf16 v[72:75], v[36:39], a[212:215], v[72:75]
    buffer_load_dwordx4 v10, s[8:11], s20 offen lds
    v_fmac_f32 v141, v167, v98
    v_mfma_f32_16x16x32_bf16 v[76:79], v[40:43], a[208:211], v[76:79]
    ds_read_b128 v[32:35], v17 offset:51456
    v_cvt_pk_bf16_f32 v122, v132, v133
    v_mfma_f32_16x16x32_bf16 v[80:83], v[40:43], a[212:215], v[80:83]
    s_waitcnt lgkmcnt(4)
    v_cvt_pk_bf16_f32 v126, v140, v141
    v_fmac_f32 v134, v168, v96
    v_mfma_f32_16x16x32_bf16 v[68:71], v[44:47], a[216:219], v[68:71]
    ds_read_b128 v[36:39], v18 offset:49408
    v_fmac_f32 v142, v168, v99
    v_mfma_f32_16x16x32_bf16 v[72:75], v[44:47], a[220:223], v[72:75]
    v_fmac_f32 v134, v169, v99
    v_fmac_f32 v142, v169, v98
    v_mfma_f32_16x16x32_bf16 v[76:79], v[48:51], a[216:219], v[76:79]
    ds_read_b128 v[40:43], v18 offset:51456
    v_fmac_f32 v135, v170, v96
    v_fmac_f32 v143, v170, v99
    v_mfma_f32_16x16x32_bf16 v[80:83], v[48:51], a[220:223], v[80:83]
    s_waitcnt lgkmcnt(4)
    v_fmac_f32 v135, v171, v99
    v_mfma_f32_16x16x32_bf16 v[68:71], v[20:23], a[224:227], v[68:71]
    ds_read_b128 v[44:47], v19 offset:49408
    s_add_u32 m0, s21, 84992
    v_fmac_f32 v143, v171, v98
    v_mfma_f32_16x16x32_bf16 v[72:75], v[20:23], a[228:231], v[72:75]
    buffer_load_dwordx4 v11, s[8:11], s20 offen lds
    v_cvt_pk_bf16_f32 v123, v134, v135
    v_mfma_f32_16x16x32_bf16 v[76:79], v[24:27], a[224:227], v[76:79]
    ds_read_b128 v[48:51], v19 offset:51456
    v_cvt_pk_bf16_f32 v127, v142, v143
    v_mfma_f32_16x16x32_bf16 v[80:83], v[24:27], a[228:231], v[80:83]
    s_waitcnt lgkmcnt(4)
    s_nop 0
    s_nop 0
    v_mfma_f32_16x16x32_bf16 v[68:71], v[28:31], a[232:235], v[68:71]
    s_waitcnt vmcnt(20)
    s_barrier
    ds_read_b128 v[20:23], v12 offset:0
    v_mfma_f32_16x16x32_bf16 v[72:75], v[28:31], a[236:239], v[72:75]
    s_add_u32 s20, s20, 512
    v_mfma_f32_16x16x32_bf16 v[180:183], v[120:123], v[172:175], 0
    v_mfma_f32_16x16x32_bf16 v[76:79], v[32:35], a[232:235], v[76:79]
    ds_read_b128 v[24:27], v12 offset:2048
    v_mfma_f32_16x16x32_bf16 v[184:187], v[120:123], v[176:179], 0
    v_mfma_f32_16x16x32_bf16 v[188:191], v[124:127], v[172:175], 0
    v_mfma_f32_16x16x32_bf16 v[80:83], v[32:35], a[236:239], v[80:83]
    s_waitcnt lgkmcnt(4)
    v_mfma_f32_16x16x32_bf16 v[192:195], v[124:127], v[176:179], 0
    v_mfma_f32_16x16x32_bf16 v[68:71], v[36:39], a[240:243], v[68:71]
    ds_read_b128 v[28:31], v13 offset:0
    s_add_u32 m0, s21, 98304
    s_sub_u32 s39, s22, 1
    v_mfma_f32_16x16x32_bf16 v[72:75], v[36:39], a[244:247], v[72:75]
    buffer_load_dwordx4 v8, s[8:11], s20 offen lds
    s_lshl_b32 s38, s39, 17
    v_mfma_f32_16x16x32_bf16 v[76:79], v[40:43], a[240:243], v[76:79]
    ds_read_b128 v[32:35], v13 offset:2048
    s_add_u32 s38, s38, 0x4400000
    v_mfma_f32_16x16x32_bf16 v[80:83], v[40:43], a[244:247], v[80:83]
    s_waitcnt lgkmcnt(4)
    s_add_u32 s43, s38, 0x10000
    s_lshl_b32 s39, s39, 7
    v_mfma_f32_16x16x32_bf16 v[68:71], v[44:47], a[248:251], v[68:71]
    ds_read_b128 v[36:39], v14 offset:0
    s_add_u32 s39, s39, 0x5902000
    v_mfma_f32_16x16x32_bf16 v[72:75], v[44:47], a[252:255], v[72:75]
    s_cmp_eq_u32 s37, 0
    s_cselect_b32 s38, 0x7ff00000, s38
    s_cselect_b32 s39, 0x7ff00000, s39
    s_cselect_b32 s43, 0x7ff00000, s43
    v_mfma_f32_16x16x32_bf16 v[76:79], v[48:51], a[248:251], v[76:79]
    ds_read_b128 v[40:43], v14 offset:2048
    v_mfma_f32_16x16x32_bf16 v[80:83], v[48:51], a[252:255], v[80:83]
    s_waitcnt lgkmcnt(4)
    s_mov_b32 s37, 1
    s_add_u32 s22, s22, 1
    s_cmp_ge_u32 s22, s23
    s_cbranch_scc0 L_st_478
L_fl1_476:
    s_waitcnt lgkmcnt(0)
    s_nop 7
    v_cvt_pk_bf16_f32 v144, v180, v181
    v_cvt_pk_bf16_f32 v145, v182, v183
    buffer_store_dwordx2 v[144:145], v86, s[12:15], s38 offen offset:0 sc1
    v_cvt_pk_bf16_f32 v146, v184, v185
    v_cvt_pk_bf16_f32 v147, v186, v187
    buffer_store_dwordx2 v[146:147], v86, s[12:15], s38 offen offset:256 sc1
    v_cvt_pk_bf16_f32 v148, v188, v189
    v_cvt_pk_bf16_f32 v149, v190, v191
    buffer_store_dwordx2 v[148:149], v86, s[12:15], s43 offen offset:0 sc1
    v_cvt_pk_bf16_f32 v150, v192, v193
    v_cvt_pk_bf16_f32 v151, v194, v195
    buffer_store_dwordx2 v[150:151], v86, s[12:15], s43 offen offset:256 sc1
    s_waitcnt vmcnt(0)
    s_barrier
    buffer_atomic_add v84, v85, s[12:15], s39 offen sc1
    v_fmac_f32 v69, v88, v68
    v_fmac_f32 v73, v88, v72
    v_mul_f32 v128, v90, v68
    v_mul_f32 v136, v154, v72
    v_fmac_f32 v69, v152, v72
    v_fmac_f32 v73, v89, v68
    v_fmac_f32 v128, v155, v72
    v_fmac_f32 v136, v155, v68
    v_fmac_f32 v70, v88, v69
    v_fmac_f32 v74, v88, v73
    v_mul_f32 v129, v90, v69
    v_mul_f32 v137, v154, v73
    v_fmac_f32 v70, v152, v73
    v_fmac_f32 v74, v89, v69
    v_fmac_f32 v129, v155, v73
    v_fmac_f32 v137, v155, v69
    v_fmac_f32 v71, v88, v70
    v_fmac_f32 v75, v88, v74
    v_mul_f32 v130, v90, v70
    v_mul_f32 v138, v154, v74
    v_fmac_f32 v71, v152, v74
    v_fmac_f32 v75, v89, v70
    v_fmac_f32 v130, v155, v74
    v_fmac_f32 v138, v155, v70
    v_fmac_f32 v76, v88, v71
    v_fmac_f32 v80, v88, v75
    v_mul_f32 v131, v90, v71
    v_mul_f32 v139, v154, v75
    v_fmac_f32 v76, v152, v75
    v_fmac_f32 v80, v89, v71
    v_fmac_f32 v131, v155, v75
    v_fmac_f32 v139, v155, v71
    v_fmac_f32 v77, v88, v76
    v_fmac_f32 v81, v88, v80
    v_mul_f32 v132, v90, v76
    v_mul_f32 v140, v154, v80
    v_fmac_f32 v77, v152, v80
    v_fmac_f32 v81, v89, v76
    v_fmac_f32 v132, v155, v80
    v_fmac_f32 v140, v155, v76
    v_fmac_f32 v78, v88, v77
    v_fmac_f32 v82, v88, v81
    v_mul_f32 v133, v90, v77
    v_mul_f32 v141, v154, v81
    v_fmac_f32 v78, v152, v81
    v_fmac_f32 v82, v89, v77
    v_fmac_f32 v133, v155, v81
    v_fmac_f32 v141, v155, v77
    v_fmac_f32 v79, v88, v78
    v_fmac_f32 v83, v88, v82
    v_mul_f32 v134, v90, v78
    v_mul_f32 v142, v154, v82
    v_fmac_f32 v79, v152, v82
    v_fmac_f32 v83, v89, v78
    v_fmac_f32 v134, v155, v82
    v_fmac_f32 v142, v155, v78
    v_mfma_f32_16x16x4_f32 v[104:107], v116, v79, 0
    v_mfma_f32_16x16x4_f32 v[108:111], v116, v83, 0
    v_mul_f32 v135, v90, v79
    v_mul_f32 v143, v154, v83
    v_fmac_f32 v135, v155, v83
    v_fmac_f32 v143, v155, v79
    s_nop 0
    s_nop 0
    s_nop 0
    s_nop 0
    s_nop 0
    s_nop 0
    s_nop 0
    v_fmac_f32 v104, v92, v94
    v_fmac_f32 v108, v92, v95
    v_fmac_f32 v104, v153, v95
    v_fmac_f32 v108, v93, v94
    v_cndmask_b32 v96, v94, v104, s[56:57]
    v_cndmask_b32 v97, v95, v108, s[56:57]
    v_fmac_f32 v105, v92, v104
    v_fmac_f32 v109, v92, v108
    v_fmac_f32 v105, v153, v108
    v_fmac_f32 v109, v93, v104
    v_cndmask_b32 v96, v96, v105, s[58:59]
    v_cndmask_b32 v97, v97, v109, s[58:59]
    v_fmac_f32 v106, v92, v105
    v_fmac_f32 v110, v92, v109
    v_fmac_f32 v106, v153, v109
    v_fmac_f32 v110, v93, v105
    v_cndmask_b32 v96, v96, v106, s[60:61]
    v_cndmask_b32 v97, v97, v110, s[60:61]
    v_fmac_f32 v107, v92, v106
    v_fmac_f32 v111, v92, v110
    v_fmac_f32 v107, v153, v110
    v_fmac_f32 v111, v93, v106
    v_xor_b32 v98, 0x80000000, v96
    v_xor_b32 v99, 0x80000000, v97
    v_mov_b32 v94, v107
    v_mov_b32 v95, v111
    v_fmac_f32 v128, v156, v96
    v_fmac_f32 v136, v156, v99
    v_fmac_f32 v128, v157, v99
    v_fmac_f32 v136, v157, v98
    v_fmac_f32 v129, v158, v96
    v_fmac_f32 v137, v158, v99
    v_fmac_f32 v129, v159, v99
    v_fmac_f32 v137, v159, v98
    v_cvt_pk_bf16_f32 v120, v128, v129
    v_cvt_pk_bf16_f32 v124, v136, v137
    v_fmac_f32 v130, v160, v96
    v_fmac_f32 v138, v160, v99
    v_fmac_f32 v130, v161, v99
    v_fmac_f32 v138, v161, v98
    v_fmac_f32 v131, v162, v96
    v_fmac_f32 v139, v162, v99
    v_fmac_f32 v131, v163, v99
    v_fmac_f32 v139, v163, v98
    v_cvt_pk_bf16_f32 v121, v130, v131
    v_cvt_pk_bf16_f32 v125, v138, v139
    v_fmac_f32 v132, v164, v96
    v_fmac_f32 v140, v164, v99
    v_fmac_f32 v132, v165, v99
    v_fmac_f32 v140, v165, v98
    v_fmac_f32 v133, v166, v96
    v_fmac_f32 v141, v166, v99
    v_fmac_f32 v133, v167, v99
    v_fmac_f32 v141, v167, v98
    v_cvt_pk_bf16_f32 v122, v132, v133
    v_cvt_pk_bf16_f32 v126, v140, v141
    v_fmac_f32 v134, v168, v96
    v_fmac_f32 v142, v168, v99
    v_fmac_f32 v134, v169, v99
    v_fmac_f32 v142, v169, v98
    v_fmac_f32 v135, v170, v96
    v_fmac_f32 v143, v170, v99
    v_fmac_f32 v135, v171, v99
    v_fmac_f32 v143, v171, v98
    v_cvt_pk_bf16_f32 v123, v134, v135
    v_cvt_pk_bf16_f32 v127, v142, v143
    s_nop 0
    s_nop 0
    v_mfma_f32_16x16x32_bf16 v[180:183], v[120:123], v[172:175], 0
    v_mfma_f32_16x16x32_bf16 v[184:187], v[120:123], v[176:179], 0
    v_mfma_f32_16x16x32_bf16 v[188:191], v[124:127], v[172:175], 0
    v_mfma_f32_16x16x32_bf16 v[192:195], v[124:127], v[176:179], 0
    s_sub_u32 s39, s22, 1
    s_lshl_b32 s38, s39, 17
    s_add_u32 s38, s38, 0x4400000
    s_add_u32 s43, s38, 0x10000
    s_lshl_b32 s39, s39, 7
    s_add_u32 s39, s39, 0x5902000
    s_cmp_eq_u32 s37, 0
    s_cselect_b32 s38, 0x7ff00000, s38
    s_cselect_b32 s39, 0x7ff00000, s39
    s_cselect_b32 s43, 0x7ff00000, s43
    s_mov_b32 s37, 1
    v_cvt_pk_bf16_f32 v144, v180, v181
    v_cvt_pk_bf16_f32 v145, v182, v183
    buffer_store_dwordx2 v[144:145], v86, s[12:15], s38 offen offset:0 sc1
    v_cvt_pk_bf16_f32 v146, v184, v185
    v_cvt_pk_bf16_f32 v147, v186, v187
    buffer_store_dwordx2 v[146:147], v86, s[12:15], s38 offen offset:256 sc1
    v_cvt_pk_bf16_f32 v148, v188, v189
    v_cvt_pk_bf16_f32 v149, v190, v191
    buffer_store_dwordx2 v[148:149], v86, s[12:15], s43 offen offset:0 sc1
    v_cvt_pk_bf16_f32 v150, v192, v193
    v_cvt_pk_bf16_f32 v151, v194, v195
    buffer_store_dwordx2 v[150:151], v86, s[12:15], s43 offen offset:256 sc1
    s_waitcnt vmcnt(0)
    s_barrier
    buffer_atomic_add v84, v85, s[12:15], s39 offen sc1
    s_branch L_ste_477
L_fl0_475:
    s_waitcnt lgkmcnt(0)
    s_nop 7
    v_cvt_pk_bf16_f32 v144, v180, v181
    v_cvt_pk_bf16_f32 v145, v182, v183
    buffer_store_dwordx2 v[144:145], v86, s[12:15], s38 offen offset:0 sc1
    v_cvt_pk_bf16_f32 v146, v184, v185
    v_cvt_pk_bf16_f32 v147, v186, v187
    buffer_store_dwordx2 v[146:147], v86, s[12:15], s38 offen offset:256 sc1
    v_cvt_pk_bf16_f32 v148, v188, v189
    v_cvt_pk_bf16_f32 v149, v190, v191
    buffer_store_dwordx2 v[148:149], v86, s[12:15], s43 offen offset:0 sc1
    v_cvt_pk_bf16_f32 v150, v192, v193
    v_cvt_pk_bf16_f32 v151, v194, v195
    buffer_store_dwordx2 v[150:151], v86, s[12:15], s43 offen offset:256 sc1
    s_waitcnt vmcnt(0)
    s_barrier
    buffer_atomic_add v84, v85, s[12:15], s39 offen sc1
    v_fmac_f32 v53, v88, v52
    v_fmac_f32 v57, v88, v56
    v_mul_f32 v128, v90, v52
    v_mul_f32 v136, v154, v56
    v_fmac_f32 v53, v152, v56
    v_fmac_f32 v57, v89, v52
    v_fmac_f32 v128, v155, v56
    v_fmac_f32 v136, v155, v52
    v_fmac_f32 v54, v88, v53
    v_fmac_f32 v58, v88, v57
    v_mul_f32 v129, v90, v53
    v_mul_f32 v137, v154, v57
    v_fmac_f32 v54, v152, v57
    v_fmac_f32 v58, v89, v53
    v_fmac_f32 v129, v155, v57
    v_fmac_f32 v137, v155, v53
    v_fmac_f32 v55, v88, v54
    v_fmac_f32 v59, v88, v58
    v_mul_f32 v130, v90, v54
    v_mul_f32 v138, v154, v58
    v_fmac_f32 v55, v152, v58
    v_fmac_f32 v59, v89, v54
    v_fmac_f32 v130, v155, v58
    v_fmac_f32 v138, v155, v54
    v_fmac_f32 v60, v88, v55
    v_fmac_f32 v64, v88, v59
    v_mul_f32 v131, v90, v55
    v_mul_f32 v139, v154, v59
    v_fmac_f32 v60, v152, v59
    v_fmac_f32 v64, v89, v55
    v_fmac_f32 v131, v155, v59
    v_fmac_f32 v139, v155, v55
    v_fmac_f32 v61, v88, v60
    v_fmac_f32 v65, v88, v64
    v_mul_f32 v132, v90, v60
    v_mul_f32 v140, v154, v64
    v_fmac_f32 v61, v152, v64
    v_fmac_f32 v65, v89, v60
    v_fmac_f32 v132, v155, v64
    v_fmac_f32 v140, v155, v60
    v_fmac_f32 v62, v88, v61
    v_fmac_f32 v66, v88, v65
    v_mul_f32 v133, v90, v61
    v_mul_f32 v141, v154, v65
    v_fmac_f32 v62, v152, v65
    v_fmac_f32 v66, v89, v61
    v_fmac_f32 v133, v155, v65
    v_fmac_f32 v141, v155, v61
    v_fmac_f32 v63, v88, v62
    v_fmac_f32 v67, v88, v66
    v_mul_f32 v134, v90, v62
    v_mul_f32 v142, v154, v66
    v_fmac_f32 v63, v152, v66
    v_fmac_f32 v67, v89, v62
    v_fmac_f32 v134, v155, v66
    v_fmac_f32 v142, v155, v62
    v_mfma_f32_16x16x4_f32 v[104:107], v116, v63, 0
    v_mfma_f32_16x16x4_f32 v[108:111], v116, v67, 0
    v_mul_f32 v135, v90, v63
    v_mul_f32 v143, v154, v67
    v_fmac_f32 v135, v155, v67
    v_fmac_f32 v143, v155, v63
    s_nop 0
    s_nop 0
    s_nop 0
    s_nop 0
    s_nop 0
    s_nop 0
    s_nop 0
    v_fmac_f32 v104, v92, v94
    v_fmac_f32 v108, v92, v95
    v_fmac_f32 v104, v153, v95
    v_fmac_f32 v108, v93, v94
    v_cndmask_b32 v96, v94, v104, s[56:57]
    v_cndmask_b32 v97, v95, v108, s[56:57]
    v_fmac_f32 v105, v92, v104
    v_fmac_f32 v109, v92, v108
    v_fmac_f32 v105, v153, v108
    v_fmac_f32 v109, v93, v104
    v_cndmask_b32 v96, v96, v105, s[58:59]
    v_cndmask_b32 v97, v97, v109, s[58:59]
    v_fmac_f32 v106, v92, v105
    v_fmac_f32 v110, v92, v109
    v_fmac_f32 v106, v153, v109
    v_fmac_f32 v110, v93, v105
    v_cndmask_b32 v96, v96, v106, s[60:61]
    v_cndmask_b32 v97, v97, v110, s[60:61]
    v_fmac_f32 v107, v92, v106
    v_fmac_f32 v111, v92, v110
    v_fmac_f32 v107, v153, v110
    v_fmac_f32 v111, v93, v106
    v_xor_b32 v98, 0x80000000, v96
    v_xor_b32 v99, 0x80000000, v97
    v_mov_b32 v94, v107
    v_mov_b32 v95, v111
    v_fmac_f32 v128, v156, v96
    v_fmac_f32 v136, v156, v99
    v_fmac_f32 v128, v157, v99
    v_fmac_f32 v136, v157, v98
    v_fmac_f32 v129, v158, v96
    v_fmac_f32 v137, v158, v99
    v_fmac_f32 v129, v159, v99
    v_fmac_f32 v137, v159, v98
    v_cvt_pk_bf16_f32 v120, v128, v129
    v_cvt_pk_bf16_f32 v124, v136, v137
    v_fmac_f32 v130, v160, v96
    v_fmac_f32 v138, v160, v99
    v_fmac_f32 v130, v161, v99
    v_fmac_f32 v138, v161, v98
    v_fmac_f32 v131, v162, v96
    v_fmac_f32 v139, v162, v99
    v_fmac_f32 v131, v163, v99
    v_fmac_f32 v139, v163, v98
    v_cvt_pk_bf16_f32 v121, v130, v131
    v_cvt_pk_bf16_f32 v125, v138, v139
    v_fmac_f32 v132, v164, v96
    v_fmac_f32 v140, v164, v99
    v_fmac_f32 v132, v165, v99
    v_fmac_f32 v140, v165, v98
    v_fmac_f32 v133, v166, v96
    v_fmac_f32 v141, v166, v99
    v_fmac_f32 v133, v167, v99
    v_fmac_f32 v141, v167, v98
    v_cvt_pk_bf16_f32 v122, v132, v133
    v_cvt_pk_bf16_f32 v126, v140, v141
    v_fmac_f32 v134, v168, v96
    v_fmac_f32 v142, v168, v99
    v_fmac_f32 v134, v169, v99
    v_fmac_f32 v142, v169, v98
    v_fmac_f32 v135, v170, v96
    v_fmac_f32 v143, v170, v99
    v_fmac_f32 v135, v171, v99
    v_fmac_f32 v143, v171, v98
    v_cvt_pk_bf16_f32 v123, v134, v135
    v_cvt_pk_bf16_f32 v127, v142, v143
    s_nop 0
    s_nop 0
    v_mfma_f32_16x16x32_bf16 v[180:183], v[120:123], v[172:175], 0
    v_mfma_f32_16x16x32_bf16 v[184:187], v[120:123], v[176:179], 0
    v_mfma_f32_16x16x32_bf16 v[188:191], v[124:127], v[172:175], 0
    v_mfma_f32_16x16x32_bf16 v[192:195], v[124:127], v[176:179], 0
    s_sub_u32 s39, s22, 1
    s_lshl_b32 s38, s39, 17
    s_add_u32 s38, s38, 0x4400000
    s_add_u32 s43, s38, 0x10000
    s_lshl_b32 s39, s39, 7
    s_add_u32 s39, s39, 0x5902000
    s_cmp_eq_u32 s37, 0
    s_cselect_b32 s38, 0x7ff00000, s38
    s_cselect_b32 s39, 0x7ff00000, s39
    s_cselect_b32 s43, 0x7ff00000, s43
    s_mov_b32 s37, 1
    v_cvt_pk_bf16_f32 v144, v180, v181
    v_cvt_pk_bf16_f32 v145, v182, v183
    buffer_store_dwordx2 v[144:145], v86, s[12:15], s38 offen offset:0 sc1
    v_cvt_pk_bf16_f32 v146, v184, v185
    v_cvt_pk_bf16_f32 v147, v186, v187
    buffer_store_dwordx2 v[146:147], v86, s[12:15], s38 offen offset:256 sc1
    v_cvt_pk_bf16_f32 v148, v188, v189
    v_cvt_pk_bf16_f32 v149, v190, v191
    buffer_store_dwordx2 v[148:149], v86, s[12:15], s43 offen offset:0 sc1
    v_cvt_pk_bf16_f32 v150, v192, v193
    v_cvt_pk_bf16_f32 v151, v194, v195
    buffer_store_dwordx2 v[150:151], v86, s[12:15], s43 offen offset:256 sc1
    s_waitcnt vmcnt(0)
    s_barrier
    buffer_atomic_add v84, v85, s[12:15], s39 offen sc1
L_ste_477:
    s_branch L_op_435
L_g2_434:
    s_and_b32 s46, s41, 15
    s_mov_b32 s32, s64
    s_and_b32 s33, s65, 0xffff
    s_mov_b32 s34, 0x400000
    s_mov_b32 s35, 0x00020000
    v_lshlrev_b32 v1, 4, v0
    s_lshl_b32 s25, s46, 12
L_warm_479:
    buffer_load_dwordx4 v[20:23], v1, s[32:35], s25 offen
    s_add_u32 s25, s25, 0x10000
    buffer_load_dwordx4 v[24:27], v1, s[32:35], s25 offen
    s_add_u32 s25, s25, 0x10000
    buffer_load_dwordx4 v[28:31], v1, s[32:35], s25 offen
    s_add_u32 s25, s25, 0x10000
    buffer_load_dwordx4 v[32:35], v1, s[32:35], s25 offen
    s_add_u32 s25, s25, 0x10000
    buffer_load_dwordx4 v[36:39], v1, s[32:35], s25 offen
    s_add_u32 s25, s25, 0x10000
    buffer_load_dwordx4 v[40:43], v1, s[32:35], s25 offen
    s_add_u32 s25, s25, 0x10000
    buffer_load_dwordx4 v[44:47], v1, s[32:35], s25 offen
    s_add_u32 s25, s25, 0x10000
    buffer_load_dwordx4 v[48:51], v1, s[32:35], s25 offen
    s_add_u32 s25, s25, 0x10000
    buffer_load_dwordx4 v[52:55], v1, s[32:35], s25 offen
    s_add_u32 s25, s25, 0x10000
    buffer_load_dwordx4 v[56:59], v1, s[32:35], s25 offen
    s_add_u32 s25, s25, 0x10000
    buffer_load_dwordx4 v[60:63], v1, s[32:35], s25 offen
    s_add_u32 s25, s25, 0x10000
    buffer_load_dwordx4 v[64:67], v1, s[32:35], s25 offen
    s_add_u32 s25, s25, 0x10000
    buffer_load_dwordx4 v[68:71], v1, s[32:35], s25 offen
    s_add_u32 s25, s25, 0x10000
    buffer_load_dwordx4 v[72:75], v1, s[32:35], s25 offen
    s_add_u32 s25, s25, 0x10000
    buffer_load_dwordx4 v[76:79], v1, s[32:35], s25 offen
    s_add_u32 s25, s25, 0x10000
    buffer_load_dwordx4 v[80:83], v1, s[32:35], s25 offen
    s_add_u32 s25, s25, 0x10000
    s_waitcnt vmcnt(16)
    s_cmp_lt_u32 s25, 0x400000
    s_cbranch_scc1 L_warm_479
    s_waitcnt vmcnt(0)
    s_mov_b32 s32, s98
    s_and_b32 s33, s99, 0xffff
    s_mov_b32 s34, 0x100
    s_mov_b32 s35, 0x00020000
    s_mov_b32 s25, 0
    v_mov_b32 v2, 0
L_pl_480:
    buffer_load_dword v1, v2, s[32:35], s25 offen sc1
    s_add_u32 s36, s36, 1
    s_cmp_gt_u32 s36, 0x100000
    s_cbranch_scc1 chain_kernel_wend
    s_waitcnt vmcnt(0)
    v_readfirstlane_b32 s26, v1
    s_and_b32 s27, s26, 0xffff
    s_cmp_ge_u32 s27, 256
    s_cbranch_scc1 L_plok_481
    s_sleep 4
    s_branch L_pl_480
L_plok_481:
    s_lshr_b32 s25, s26, 16
    s_cmp_gt_u32 s25, 16
    s_cselect_b32 s25, 0x2000, 0x0
    s_add_u32 s54, s100, 0x1fffff
    s_and_b32 s54, s54, 0xffe00000
    s_sub_u32 s55, s54, s100
    s_add_u32 s54, s55, s25
    s_xor_b32 s25, s25, 0x2000
    s_add_u32 s55, s55, s25
    s_lshl_b32 s44, s46, 15
    s_lshl_b32 s25, s49, 13
    s_add_u32 s44, s44, s25
    s_xor_b32 s45, s44, 0x8000
    s_add_u32 s44, s44, 0x6800000
    s_add_u32 s45, s45, 0x6800000
    s_lshr_b32 s48, s46, 1
    s_lshl_b32 s48, s48, 7
    s_add_u32 s48, s48, 0x590d000
    v_mov_b32 v104, 0
    v_mov_b32 v105, 0
    v_mov_b32 v106, 0
    v_mov_b32 v107, 0
    v_and_b32 v2, 63, v0
    v_lshlrev_b32 v3, 4, v2
    v_lshlrev_b32 v112, 4, v2
    s_add_u32 s28, s44, 0
    buffer_store_dwordx4 v[104:107], v3, s[12:15], s28 offen sc1
    s_add_u32 s28, s44, 1024
    buffer_store_dwordx4 v[104:107], v3, s[12:15], s28 offen sc1
    s_add_u32 s28, s44, 2048
    buffer_store_dwordx4 v[104:107], v3, s[12:15], s28 offen sc1
    s_add_u32 s28, s44, 3072
    buffer_store_dwordx4 v[104:107], v3, s[12:15], s28 offen sc1
    s_add_u32 s28, s44, 4096
    buffer_store_dwordx4 v[104:107], v3, s[12:15], s28 offen sc1
    s_add_u32 s28, s44, 5120
    buffer_store_dwordx4 v[104:107], v3, s[12:15], s28 offen sc1
    s_add_u32 s28, s44, 6144
    buffer_store_dwordx4 v[104:107], v3, s[12:15], s28 offen sc1
    s_add_u32 s28, s44, 7168
    buffer_store_dwordx4 v[104:107], v3, s[12:15], s28 offen sc1
    v_lshrrev_b32 v1, 6, v0
    v_lshlrev_b32 v1, 11, v1
    v_add_u32 v1, 0x21000, v1
    s_waitcnt vmcnt(0)
    s_barrier
    buffer_atomic_add v84, v85, s[12:15], s48 offen sc1
    v_mov_b32 v2, 0
L_pl_482:
    buffer_load_dword v1, v2, s[12:15], s48 offen sc1
    s_add_u32 s36, s36, 1
    s_cmp_gt_u32 s36, 0x100000
    s_cbranch_scc1 chain_kernel_wend
    s_waitcnt vmcnt(0)
    v_readfirstlane_b32 s26, v1
    s_cmp_ge_u32 s26, 2
    s_cbranch_scc1 L_plok_483
    s_sleep 4
    s_branch L_pl_482
L_plok_483:
    s_and_b32 s47, s46, 1
    s_cmp_eq_u32 s47, 1
    s_cselect_b32 s16, s76, s74
    s_cselect_b32 s17, s77, s75
    s_and_b32 s17, s17, 0xffff
    s_mov_b32 s18, 0x200000
    s_mov_b32 s19, 0x00020000
    s_lshr_b32 s25, s46, 1
    s_lshl_b32 s25, s25, 7
    s_lshl_b32 s26, s49, 5
    s_add_u32 s25, s25, s26
    v_and_b32 v5, 15, v0
    v_lshl_add_u32 v5, v5, 1, s25
    s_lshl_b32 s26, s47, 4
    v_bfe_u32 v6, v0, 4, 2
    v_lshl_add_u32 v6, v6, 2, s26
    v_lshlrev_b32 v7, 1, v5
    v_lshl_add_u32 v136, v6, 11, v7
    v_add_u32 v137, 0x1000, v136
    v_lshlrev_b32 v5, 2, v5
    v_lshl_add_u32 v140, v6, 13, v5
    v_add_u32 v141, 0x2000, v140
    v_add_u32 v142, 0x4000, v140
    v_add_u32 v143, 0x6000, v140
    s_mov_b32 s32, s80
    s_and_b32 s33, s81, 0xffff
    s_mov_b32 s34, 0x800
    s_mov_b32 s35, 0x00020000
    buffer_load_dword v132, v7, s[32:35], 0 offen
    v_and_b32 v1, 31, v0
    v_bfe_u32 v2, v0, 5, 1
    v_add_u32 v3, 0, v2
    v_xor_b32 v4, v3, v1
    v_lshlrev_b32 v4, 4, v4
    v_lshlrev_b32 v3, 1, v3
    v_add_u32 v3, s25, v3
    v_lshl_add_u32 v20, v3, 11, v4
    v_add_u32 v3, 2, v2
    v_xor_b32 v4, v3, v1
    v_lshlrev_b32 v4, 4, v4
    v_lshlrev_b32 v3, 1, v3
    v_add_u32 v3, s25, v3
    v_lshl_add_u32 v21, v3, 11, v4
    v_add_u32 v3, 4, v2
    v_xor_b32 v4, v3, v1
    v_lshlrev_b32 v4, 4, v4
    v_lshlrev_b32 v3, 1, v3
    v_add_u32 v3, s25, v3
    v_lshl_add_u32 v22, v3, 11, v4
    v_add_u32 v3, 6, v2
    v_xor_b32 v4, v3, v1
    v_lshlrev_b32 v4, 4, v4
    v_lshlrev_b32 v3, 1, v3
    v_add_u32 v3, s25, v3
    v_lshl_add_u32 v23, v3, 11, v4
    v_add_u32 v3, 8, v2
    v_xor_b32 v4, v3, v1
    v_lshlrev_b32 v4, 4, v4
    v_lshlrev_b32 v3, 1, v3
    v_add_u32 v3, s25, v3
    v_lshl_add_u32 v24, v3, 11, v4
    v_add_u32 v3, 10, v2
    v_xor_b32 v4, v3, v1
    v_lshlrev_b32 v4, 4, v4
    v_lshlrev_b32 v3, 1, v3
    v_add_u32 v3, s25, v3
    v_lshl_add_u32 v25, v3, 11, v4
    v_add_u32 v3, 12, v2
    v_xor_b32 v4, v3, v1
    v_lshlrev_b32 v4, 4, v4
    v_lshlrev_b32 v3, 1, v3
    v_add_u32 v3, s25, v3
    v_lshl_add_u32 v26, v3, 11, v4
    v_add_u32 v3, 14, v2
    v_xor_b32 v4, v3, v1
    v_lshlrev_b32 v4, 4, v4
    v_lshlrev_b32 v3, 1, v3
    v_add_u32 v3, s25, v3
    v_lshl_add_u32 v27, v3, 11, v4
    v_and_b32 v1, 15, v0
    v_bfe_u32 v2, v0, 4, 2
    v_lshrrev_b32 v3, 6, v0
    v_lshlrev_b32 v3, 15, v3
    v_lshl_add_u32 v3, v1, 9, v3
    v_add_u32 v4, 0, v2
    v_xor_b32 v4, v4, v1
    v_lshl_add_u32 v28, v4, 4, v3
    v_add_u32 v4, 4, v2
    v_xor_b32 v4, v4, v1
    v_lshl_add_u32 v29, v4, 4, v3
    v_add_u32 v4, 8, v2
    v_xor_b32 v4, v4, v1
    v_lshl_add_u32 v30, v4, 4, v3
    v_add_u32 v4, 12, v2
    v_xor_b32 v4, v4, v1
    v_lshl_add_u32 v31, v4, 4, v3
    s_lshl_b32 s26, s49, 15
    s_barrier
    s_mov_b32 s27, 0
    s_add_u32 m0, s26, 0
    s_nop 0
    buffer_load_dwordx4 v20, s[16:19], s27 offen nt lds
    s_add_u32 m0, s26, 1024
    s_nop 0
    buffer_load_dwordx4 v21, s[16:19], s27 offen nt lds
    s_add_u32 m0, s26, 2048
    s_nop 0
    buffer_load_dwordx4 v22, s[16:19], s27 offen nt lds
    s_add_u32 m0, s26, 3072
    s_nop 0
    buffer_load_dwordx4 v23, s[16:19], s27 offen nt lds
    s_add_u32 m0, s26, 4096
    s_nop 0
    buffer_load_dwordx4 v24, s[16:19], s27 offen nt lds
    s_add_u32 m0, s26, 5120
    s_nop 0
    buffer_load_dwordx4 v25, s[16:19], s27 offen nt lds
    s_add_u32 m0, s26, 6144
    s_nop 0
    buffer_load_dwordx4 v26, s[16:19], s27 offen nt lds
    s_add_u32 m0, s26, 7168
    s_nop 0
    buffer_load_dwordx4 v27, s[16:19], s27 offen nt lds
    s_mov_b32 s27, 2048
    s_add_u32 m0, s26, 8192
    s_nop 0
    buffer_load_dwordx4 v20, s[16:19], s27 offen nt lds
    s_add_u32 m0, s26, 9216
    s_nop 0
    buffer_load_dwordx4 v21, s[16:19], s27 offen nt lds
    s_add_u32 m0, s26, 10240
    s_nop 0
    buffer_load_dwordx4 v22, s[16:19], s27 offen nt lds
    s_add_u32 m0, s26, 11264
    s_nop 0
    buffer_load_dwordx4 v23, s[16:19], s27 offen nt lds
    s_add_u32 m0, s26, 12288
    s_nop 0
    buffer_load_dwordx4 v24, s[16:19], s27 offen nt lds
    s_add_u32 m0, s26, 13312
    s_nop 0
    buffer_load_dwordx4 v25, s[16:19], s27 offen nt lds
    s_add_u32 m0, s26, 14336
    s_nop 0
    buffer_load_dwordx4 v26, s[16:19], s27 offen nt lds
    s_add_u32 m0, s26, 15360
    s_nop 0
    buffer_load_dwordx4 v27, s[16:19], s27 offen nt lds
    s_mov_b32 s27, 512
    s_add_u32 m0, s26, 16384
    s_nop 0
    buffer_load_dwordx4 v20, s[16:19], s27 offen nt lds
    s_add_u32 m0, s26, 17408
    s_nop 0
    buffer_load_dwordx4 v21, s[16:19], s27 offen nt lds
    s_add_u32 m0, s26, 18432
    s_nop 0
    buffer_load_dwordx4 v22, s[16:19], s27 offen nt lds
    s_add_u32 m0, s26, 19456
    s_nop 0
    buffer_load_dwordx4 v23, s[16:19], s27 offen nt lds
    s_add_u32 m0, s26, 20480
    s_nop 0
    buffer_load_dwordx4 v24, s[16:19], s27 offen nt lds
    s_add_u32 m0, s26, 21504
    s_nop 0
    buffer_load_dwordx4 v25, s[16:19], s27 offen nt lds
    s_add_u32 m0, s26, 22528
    s_nop 0
    buffer_load_dwordx4 v26, s[16:19], s27 offen nt lds
    s_add_u32 m0, s26, 23552
    s_nop 0
    buffer_load_dwordx4 v27, s[16:19], s27 offen nt lds
    s_mov_b32 s27, 2560
    s_add_u32 m0, s26, 24576
    s_nop 0
    buffer_load_dwordx4 v20, s[16:19], s27 offen nt lds
    s_add_u32 m0, s26, 25600
    s_nop 0
    buffer_load_dwordx4 v21, s[16:19], s27 offen nt lds
    s_add_u32 m0, s26, 26624
    s_nop 0
    buffer_load_dwordx4 v22, s[16:19], s27 offen nt lds
    s_add_u32 m0, s26, 27648
    s_nop 0
    buffer_load_dwordx4 v23, s[16:19], s27 offen nt lds
    s_add_u32 m0, s26, 28672
    s_nop 0
    buffer_load_dwordx4 v24, s[16:19], s27 offen nt lds
    s_add_u32 m0, s26, 29696
    s_nop 0
    buffer_load_dwordx4 v25, s[16:19], s27 offen nt lds
    s_add_u32 m0, s26, 30720
    s_nop 0
    buffer_load_dwordx4 v26, s[16:19], s27 offen nt lds
    s_add_u32 m0, s26, 31744
    s_nop 0
    buffer_load_dwordx4 v27, s[16:19], s27 offen nt lds
    s_waitcnt vmcnt(16)
    ds_read_b128 a[0:3], v28 offset:0
    ds_read_b128 a[4:7], v28 offset:8192
    ds_read_b128 a[8:11], v29 offset:0
    ds_read_b128 a[12:15], v29 offset:8192
    ds_read_b128 a[16:19], v30 offset:0
    ds_read_b128 a[20:23], v30 offset:8192
    ds_read_b128 a[24:27], v31 offset:0
    ds_read_b128 a[28:31], v31 offset:8192
    s_waitcnt lgkmcnt(0)
    ds_read_b128 a[32:35], v28 offset:256
    ds_read_b128 a[36:39], v28 offset:8448
    ds_read_b128 a[40:43], v29 offset:256
    ds_read_b128 a[44:47], v29 offset:8448
    ds_read_b128 a[48:51], v30 offset:256
    ds_read_b128 a[52:55], v30 offset:8448
    ds_read_b128 a[56:59], v31 offset:256
    ds_read_b128 a[60:63], v31 offset:8448
    s_waitcnt lgkmcnt(0)
    s_mov_b32 s27, 1024
    s_add_u32 m0, s26, 0
    s_nop 0
    buffer_load_dwordx4 v20, s[16:19], s27 offen nt lds
    s_add_u32 m0, s26, 1024
    s_nop 0
    buffer_load_dwordx4 v21, s[16:19], s27 offen nt lds
    s_add_u32 m0, s26, 2048
    s_nop 0
    buffer_load_dwordx4 v22, s[16:19], s27 offen nt lds
    s_add_u32 m0, s26, 3072
    s_nop 0
    buffer_load_dwordx4 v23, s[16:19], s27 offen nt lds
    s_add_u32 m0, s26, 4096
    s_nop 0
    buffer_load_dwordx4 v24, s[16:19], s27 offen nt lds
    s_add_u32 m0, s26, 5120
    s_nop 0
    buffer_load_dwordx4 v25, s[16:19], s27 offen nt lds
    s_add_u32 m0, s26, 6144
    s_nop 0
    buffer_load_dwordx4 v26, s[16:19], s27 offen nt lds
    s_add_u32 m0, s26, 7168
    s_nop 0
    buffer_load_dwordx4 v27, s[16:19], s27 offen nt lds
    s_mov_b32 s27, 3072
    s_add_u32 m0, s26, 8192
    s_nop 0
    buffer_load_dwordx4 v20, s[16:19], s27 offen nt lds
    s_add_u32 m0, s26, 9216
    s_nop 0
    buffer_load_dwordx4 v21, s[16:19], s27 offen nt lds
    s_add_u32 m0, s26, 10240
    s_nop 0
    buffer_load_dwordx4 v22, s[16:19], s27 offen nt lds
    s_add_u32 m0, s26, 11264
    s_nop 0
    buffer_load_dwordx4 v23, s[16:19], s27 offen nt lds
    s_add_u32 m0, s26, 12288
    s_nop 0
    buffer_load_dwordx4 v24, s[16:19], s27 offen nt lds
    s_add_u32 m0, s26, 13312
    s_nop 0
    buffer_load_dwordx4 v25, s[16:19], s27 offen nt lds
    s_add_u32 m0, s26, 14336
    s_nop 0
    buffer_load_dwordx4 v26, s[16:19], s27 offen nt lds
    s_add_u32 m0, s26, 15360
    s_nop 0
    buffer_load_dwordx4 v27, s[16:19], s27 offen nt lds
    s_waitcnt vmcnt(16)
    ds_read_b128 a[64:67], v28 offset:16384
    ds_read_b128 a[68:71], v28 offset:24576
    ds_read_b128 a[72:75], v29 offset:16384
    ds_read_b128 a[76:79], v29 offset:24576
    ds_read_b128 a[80:83], v30 offset:16384
    ds_read_b128 a[84:87], v30 offset:24576
    ds_read_b128 a[88:91], v31 offset:16384
    ds_read_b128 a[92:95], v31 offset:24576
    s_waitcnt lgkmcnt(0)
    ds_read_b128 a[96:99], v28 offset:16640
    ds_read_b128 a[100:103], v28 offset:24832
    ds_read_b128 a[104:107], v29 offset:16640
    ds_read_b128 a[108:111], v29 offset:24832
    ds_read_b128 a[112:115], v30 offset:16640
    ds_read_b128 a[116:119], v30 offset:24832
    ds_read_b128 a[120:123], v31 offset:16640
    ds_read_b128 a[124:127], v31 offset:24832
    s_waitcnt lgkmcnt(0)
    s_mov_b32 s27, 1536
    s_add_u32 m0, s26, 16384
    s_nop 0
    buffer_load_dwordx4 v20, s[16:19], s27 offen nt lds
    s_add_u32 m0, s26, 17408
    s_nop 0
    buffer_load_dwordx4 v21, s[16:19], s27 offen nt lds
    s_add_u32 m0, s26, 18432
    s_nop 0
    buffer_load_dwordx4 v22, s[16:19], s27 offen nt lds
    s_add_u32 m0, s26, 19456
    s_nop 0
    buffer_load_dwordx4 v23, s[16:19], s27 offen nt lds
    s_add_u32 m0, s26, 20480
    s_nop 0
    buffer_load_dwordx4 v24, s[16:19], s27 offen nt lds
    s_add_u32 m0, s26, 21504
    s_nop 0
    buffer_load_dwordx4 v25, s[16:19], s27 offen nt lds
    s_add_u32 m0, s26, 22528
    s_nop 0
    buffer_load_dwordx4 v26, s[16:19], s27 offen nt lds
    s_add_u32 m0, s26, 23552
    s_nop 0
    buffer_load_dwordx4 v27, s[16:19], s27 offen nt lds
    s_mov_b32 s27, 3584
    s_add_u32 m0, s26, 24576
    s_nop 0
    buffer_load_dwordx4 v20, s[16:19], s27 offen nt lds
    s_add_u32 m0, s26, 25600
    s_nop 0
    buffer_load_dwordx4 v21, s[16:19], s27 offen nt lds
    s_add_u32 m0, s26, 26624
    s_nop 0
    buffer_load_dwordx4 v22, s[16:19], s27 offen nt lds
    s_add_u32 m0, s26, 27648
    s_nop 0
    buffer_load_dwordx4 v23, s[16:19], s27 offen nt lds
    s_add_u32 m0, s26, 28672
    s_nop 0
    buffer_load_dwordx4 v24, s[16:19], s27 offen nt lds
    s_add_u32 m0, s26, 29696
    s_nop 0
    buffer_load_dwordx4 v25, s[16:19], s27 offen nt lds
    s_add_u32 m0, s26, 30720
    s_nop 0
    buffer_load_dwordx4 v26, s[16:19], s27 offen nt lds
    s_add_u32 m0, s26, 31744
    s_nop 0
    buffer_load_dwordx4 v27, s[16:19], s27 offen nt lds
    s_waitcnt vmcnt(16)
    ds_read_b128 a[128:131], v28 offset:0
    ds_read_b128 a[132:135], v28 offset:8192
    ds_read_b128 a[136:139], v29 offset:0
    ds_read_b128 a[140:143], v29 offset:8192
    ds_read_b128 a[144:147], v30 offset:0
    ds_read_b128 a[148:151], v30 offset:8192
    ds_read_b128 a[152:155], v31 offset:0
    ds_read_b128 a[156:159], v31 offset:8192
    s_waitcnt lgkmcnt(0)
    ds_read_b128 a[160:163], v28 offset:256
    ds_read_b128 a[164:167], v28 offset:8448
    ds_read_b128 a[168:171], v29 offset:256
    ds_read_b128 a[172:175], v29 offset:8448
    ds_read_b128 a[176:179], v30 offset:256
    ds_read_b128 a[180:183], v30 offset:8448
    ds_read_b128 a[184:187], v31 offset:256
    ds_read_b128 a[188:191], v31 offset:8448
    s_waitcnt lgkmcnt(0)
    s_waitcnt vmcnt(0)
    ds_read_b128 a[192:195], v28 offset:16384
    ds_read_b128 a[196:199], v28 offset:24576
    ds_read_b128 a[200:203], v29 offset:16384
    ds_read_b128 a[204:207], v29 offset:24576
    ds_read_b128 a[208:211], v30 offset:16384
    ds_read_b128 a[212:215], v30 offset:24576
    ds_read_b128 a[216:219], v31 offset:16384
    ds_read_b128 a[220:223], v31 offset:24576
    s_waitcnt lgkmcnt(0)
    ds_read_b128 a[224:227], v28 offset:16640
    ds_read_b128 a[228:231], v28 offset:24832
    ds_read_b128 a[232:235], v29 offset:16640
    ds_read_b128 a[236:239], v29 offset:24832
    ds_read_b128 a[240:243], v30 offset:16640
    ds_read_b128 a[244:247], v30 offset:24832
    ds_read_b128 a[248:251], v31 offset:16640
    ds_read_b128 a[252:255], v31 offset:24832
    s_waitcnt lgkmcnt(0)
    v_lshlrev_b32 v128, 16, v132
    v_and_b32 v129, 0xffff0000, v132
    s_mov_b32 s48, 0x5902000
    s_lshl_b32 s50, s47, 16
    s_add_u32 s50, s50, 0x4400000
    s_mov_b32 s8, s100
    s_and_b32 s9, s101, 0xffff
    s_mov_b32 s10, 0x10000000
    s_mov_b32 s11, 0x00020000
    s_mov_b32 s16, s96
    s_and_b32 s17, s97, 0xffff
    s_mov_b32 s18, 0x1000000
    s_mov_b32 s19, 0x00020000
    s_mov_b32 s32, s64
    s_and_b32 s33, s65, 0xffff
    s_mov_b32 s34, 0x400000
    s_mov_b32 s35, 0x00020000
    s_lshl_b32 s47, s47, 8
    s_lshl_b32 s21, s49, 12
    v_and_b32 v1, 63, v0
    v_and_b32 v2, 15, v0
    v_bfe_u32 v3, v0, 4, 2
    v_lshrrev_b32 v4, 6, v0
    v_lshlrev_b32 v5, 4, v1
    v_lshl_add_u32 v5, v4, 12, v5
    v_add_u32 v8, 0, v5
    v_add_u32 v9, 1024, v5
    v_add_u32 v10, 2048, v5
    v_add_u32 v11, 3072, v5
    v_lshlrev_b32 v5, 4, v2
    v_lshl_add_u32 v5, v3, 9, v5
    v_xor_b32 v12, s47, v5
    v_xor_b32 v13, 0x100, v12
    v_add_u32 v16, 0x10000, v12
    v_add_u32 v17, 0x10000, v13
    s_mov_b32 s23, 64
    s_mov_b32 s52, 0
    v_mov_b32 v4, 0
    s_mov_b32 s22, 0
    s_sub_u32 s61, s23, 1
    s_mov_b32 s24, s22
    s_add_u32 s51, s24, 1
    s_min_u32 s51, s51, s61
    s_lshl_b32 s51, s51, 7
    s_add_u32 s51, s51, s48
L_gw_485:
    buffer_load_dword v87, v4, s[12:15], s51 offen sc1
    s_add_u32 s36, s36, 1
    s_cmp_gt_u32 s36, 0x100000
    s_cbranch_scc1 chain_kernel_wend
    s_waitcnt vmcnt(0)
    v_readfirstlane_b32 s30, v87
    s_cmp_lt_u32 s30, 16
    s_cbranch_scc0 L_rgo_484
    s_sleep 1
    s_branch L_gw_485
L_rgo_484:
    s_add_u32 s51, s24, 1
    s_min_u32 s51, s51, s61
    s_lshl_b32 s51, s51, 7
    s_add_u32 s51, s51, s48
    buffer_load_dword v87, v4, s[12:15], s51 offen sc1
    s_mov_b32 s37, 0
    s_mov_b32 s7, 0
    v_mov_b32 v88, 0
    v_mov_b32 v89, 0
    v_mov_b32 v90, 0
    v_mov_b32 v91, 0
    v_mov_b32 v92, 0
    v_mov_b32 v93, 0
    v_mov_b32 v94, 0
    v_mov_b32 v95, 0
    s_lshl_b32 s53, s24, 17
    s_add_u32 s53, s53, s50
    s_mov_b32 s20, s53
    s_mov_b32 s39, 0x7ff00000
    s_mov_b32 s42, 0x7ff00000
    s_mov_b32 s43, 0x7ff00000
    s_barrier
    s_add_u32 m0, s21, 0
    s_nop 0
    buffer_load_dwordx4 v8, s[8:11], s20 offen lds
    s_add_u32 m0, s21, 1024
    s_nop 0
    buffer_load_dwordx4 v9, s[8:11], s20 offen lds
    s_add_u32 m0, s21, 2048
    s_nop 0
    buffer_load_dwordx4 v10, s[8:11], s20 offen lds
    s_add_u32 m0, s21, 3072
    s_nop 0
    buffer_load_dwordx4 v11, s[8:11], s20 offen lds
    s_add_u32 s20, s20, 16384
    s_add_u32 m0, s21, 16384
    s_nop 0
    buffer_load_dwordx4 v8, s[8:11], s20 offen lds
    s_add_u32 m0, s21, 17408
    s_nop 0
    buffer_load_dwordx4 v9, s[8:11], s20 offen lds
    s_add_u32 m0, s21, 18432
    s_nop 0
    buffer_load_dwordx4 v10, s[8:11], s20 offen lds
    s_add_u32 m0, s21, 19456
    s_nop 0
    buffer_load_dwordx4 v11, s[8:11], s20 offen lds
    s_add_u32 s20, s20, 16384
    s_add_u32 m0, s21, 32768
    s_nop 0
    buffer_load_dwordx4 v8, s[8:11], s20 offen lds
    s_add_u32 m0, s21, 33792
    s_nop 0
    buffer_load_dwordx4 v9, s[8:11], s20 offen lds
    s_add_u32 m0, s21, 34816
    s_nop 0
    buffer_load_dwordx4 v10, s[8:11], s20 offen lds
    s_add_u32 m0, s21, 35840
    s_nop 0
    buffer_load_dwordx4 v11, s[8:11], s20 offen lds
    s_add_u32 s20, s20, 16384
    s_add_u32 m0, s21, 49152
    s_nop 0
    buffer_load_dwordx4 v8, s[8:11], s20 offen lds
    s_add_u32 m0, s21, 50176
    s_nop 0
    buffer_load_dwordx4 v9, s[8:11], s20 offen lds
    s_add_u32 m0, s21, 51200
    s_nop 0
    buffer_load_dwordx4 v10, s[8:11], s20 offen lds
    s_add_u32 m0, s21, 52224
    s_nop 0
    buffer_load_dwordx4 v11, s[8:11], s20 offen lds
L_gw_487:
    buffer_load_dword v87, v4, s[12:15], s51 offen sc1
    s_add_u32 s36, s36, 1
    s_cmp_gt_u32 s36, 0x100000
    s_cbranch_scc1 chain_kernel_wend
    s_waitcnt vmcnt(0)
    v_readfirstlane_b32 s30, v87
    s_cmp_lt_u32 s30, 16
    s_cbranch_scc0 L_gok_486
    s_sleep 1
    s_branch L_gw_487
L_gok_486:
    s_add_u32 s24, s24, 1
    s_min_u32 s24, s24, s61
    s_lshl_b32 s53, s24, 17
    s_add_u32 s53, s53, s50
    s_add_u32 s51, s24, 1
    s_min_u32 s51, s51, s61
    s_lshl_b32 s51, s51, 7
    s_add_u32 s51, s51, s48
    buffer_load_dword v87, v4, s[12:15], s51 offen sc1
    s_mov_b32 s20, s53
    s_add_u32 m0, s21, 65536
    s_nop 0
    buffer_load_dwordx4 v8, s[8:11], s20 offen lds
    s_waitcnt vmcnt(0)
    s_barrier
    ds_read_b128 v[20:23], v12 offset:0
    ds_read_b128 v[24:27], v13 offset:0
    ds_read_b128 v[28:31], v12 offset:2048
    ds_read_b128 v[32:35], v13 offset:2048
    ds_read_b128 v[36:39], v12 offset:4096
    ds_read_b128 v[40:43], v13 offset:4096
    s_waitcnt lgkmcnt(4)
L_st_491:
    v_mfma_f32_16x16x32_bf16 v[52:55], v[20:23], a[0:3], 0
    ds_read_b128 v[44:47], v12 offset:6144
    s_add_u32 m0, s21, 66560
    v_mfma_f32_16x16x32_bf16 v[56:59], v[20:23], a[4:7], 0
    buffer_load_dwordx4 v9, s[8:11], s20 offen lds
    v_mfma_f32_16x16x32_bf16 v[60:63], v[24:27], a[0:3], 0
    ds_read_b128 v[48:51], v13 offset:6144
    s_sub_u32 s38, s22, 1
    v_mfma_f32_16x16x32_bf16 v[64:67], v[24:27], a[4:7], 0
    s_waitcnt lgkmcnt(4)
    s_and_b32 s31, s38, 3
    v_mfma_f32_16x16x32_bf16 v[52:55], v[28:31], a[8:11], v[52:55]
    ds_read_b128 v[20:23], v12 offset:8192
    s_lshl_b32 s31, s31, 11
    v_mfma_f32_16x16x32_bf16 v[56:59], v[28:31], a[12:15], v[56:59]
    buffer_load_dword v132, v136, s[32:35], s42 offen offset:0
    v_mfma_f32_16x16x32_bf16 v[60:63], v[32:35], a[8:11], v[60:63]
    ds_read_b128 v[24:27], v13 offset:8192
    v_mfma_f32_16x16x32_bf16 v[64:67], v[32:35], a[12:15], v[64:67]
    s_waitcnt lgkmcnt(4)
    s_bfe_u32 s38, s38, 0x10002
    v_mfma_f32_16x16x32_bf16 v[52:55], v[36:39], a[16:19], v[52:55]
    ds_read_b128 v[28:31], v12 offset:10240
    s_add_u32 m0, s21, 67584
    v_mfma_f32_16x16x32_bf16 v[56:59], v[36:39], a[20:23], v[56:59]
    buffer_load_dwordx4 v10, s[8:11], s20 offen lds
    v_mfma_f32_16x16x32_bf16 v[60:63], v[40:43], a[16:19], v[60:63]
    ds_read_b128 v[32:35], v13 offset:10240
    s_xor_b32 s38, s38, 1
    v_mfma_f32_16x16x32_bf16 v[64:67], v[40:43], a[20:23], v[64:67]
    s_waitcnt lgkmcnt(4)
    s_cmp_eq_u32 s37, 0
    s_cselect_b32 s31, 0x40000000, s31
    s_cselect_b32 s38, 0, s38
    v_mfma_f32_16x16x32_bf16 v[52:55], v[44:47], a[24:27], v[52:55]
    ds_read_b128 v[36:39], v12 offset:12288
    v_mfma_f32_16x16x32_bf16 v[56:59], v[44:47], a[28:31], v[56:59]
    buffer_load_dword v133, v136, s[32:35], s42 offen offset:2048
    v_mfma_f32_16x16x32_bf16 v[60:63], v[48:51], a[24:27], v[60:63]
    ds_read_b128 v[40:43], v13 offset:12288
    v_mfma_f32_16x16x32_bf16 v[64:67], v[48:51], a[28:31], v[64:67]
    s_waitcnt lgkmcnt(4)
    v_mfma_f32_16x16x32_bf16 v[52:55], v[20:23], a[32:35], v[52:55]
    ds_read_b128 v[44:47], v12 offset:14336
    s_add_u32 m0, s21, 68608
    v_mfma_f32_16x16x32_bf16 v[56:59], v[20:23], a[36:39], v[56:59]
    buffer_load_dwordx4 v11, s[8:11], s20 offen lds
    v_mfma_f32_16x16x32_bf16 v[60:63], v[24:27], a[32:35], v[60:63]
    ds_read_b128 v[48:51], v13 offset:14336
    v_cvt_pk_bf16_f32 v104, v76, v80
    v_mfma_f32_16x16x32_bf16 v[64:67], v[24:27], a[36:39], v[64:67]
    s_waitcnt lgkmcnt(4)
    v_mfma_f32_16x16x32_bf16 v[52:55], v[28:31], a[40:43], v[52:55]
    s_waitcnt vmcnt(20)
    s_barrier
    ds_read_b128 v[20:23], v12 offset:16384
    v_mfma_f32_16x16x32_bf16 v[56:59], v[28:31], a[44:47], v[56:59]
    s_add_u32 s20, s20, 16384
    v_cvt_pk_bf16_f32 v105, v77, v81
    v_mfma_f32_16x16x32_bf16 v[60:63], v[32:35], a[40:43], v[60:63]
    ds_read_b128 v[24:27], v13 offset:16384
    v_cvt_pk_bf16_f32 v106, v78, v82
    v_mfma_f32_16x16x32_bf16 v[64:67], v[32:35], a[44:47], v[64:67]
    s_waitcnt lgkmcnt(4)
    v_cvt_pk_bf16_f32 v107, v79, v83
    v_mfma_f32_16x16x32_bf16 v[52:55], v[36:39], a[48:51], v[52:55]
    ds_read_b128 v[28:31], v12 offset:18432
    s_add_u32 m0, s21, 81920
    v_mfma_f32_16x16x32_bf16 v[56:59], v[36:39], a[52:55], v[56:59]
    buffer_load_dwordx4 v8, s[8:11], s20 offen lds
    v_mfma_f32_16x16x32_bf16 v[60:63], v[40:43], a[48:51], v[60:63]
    ds_read_b128 v[32:35], v13 offset:18432
    v_mfma_f32_16x16x32_bf16 v[64:67], v[40:43], a[52:55], v[64:67]
    s_waitcnt lgkmcnt(4)
    v_and_or_b32 v104, v104, -2, s38
    v_mfma_f32_16x16x32_bf16 v[52:55], v[44:47], a[56:59], v[52:55]
    ds_read_b128 v[36:39], v12 offset:20480
    v_and_or_b32 v105, v105, -2, s38
    v_mfma_f32_16x16x32_bf16 v[56:59], v[44:47], a[60:63], v[56:59]
    buffer_load_dword v134, v137, s[32:35], s42 offen offset:0
    v_mfma_f32_16x16x32_bf16 v[60:63], v[48:51], a[56:59], v[60:63]
    ds_read_b128 v[40:43], v13 offset:20480
    v_and_or_b32 v106, v106, -2, s38
    v_mfma_f32_16x16x32_bf16 v[64:67], v[48:51], a[60:63], v[64:67]
    s_waitcnt lgkmcnt(4)
    v_mfma_f32_16x16x32_bf16 v[52:55], v[20:23], a[64:67], v[52:55]
    ds_read_b128 v[44:47], v12 offset:22528
    s_add_u32 m0, s21, 82944
    v_mfma_f32_16x16x32_bf16 v[56:59], v[20:23], a[68:71], v[56:59]
    buffer_load_dwordx4 v9, s[8:11], s20 offen lds
    v_mfma_f32_16x16x32_bf16 v[60:63], v[24:27], a[64:67], v[60:63]
    ds_read_b128 v[48:51], v13 offset:22528
    v_and_or_b32 v107, v107, -2, s38
    v_mfma_f32_16x16x32_bf16 v[64:67], v[24:27], a[68:71], v[64:67]
    s_waitcnt lgkmcnt(4)
    s_add_u32 s29, s45, s31
    v_mfma_f32_16x16x32_bf16 v[52:55], v[28:31], a[72:75], v[52:55]
    ds_read_b128 v[20:23], v12 offset:24576
    v_mfma_f32_16x16x32_bf16 v[56:59], v[28:31], a[76:79], v[56:59]
    buffer_store_dwordx4 v[104:107], v112, s[12:15], s29 offen offset:0 sc1
    v_mfma_f32_16x16x32_bf16 v[60:63], v[32:35], a[72:75], v[60:63]
    ds_read_b128 v[24:27], v13 offset:24576
    s_add_u32 s51, s24, 1
    v_mfma_f32_16x16x32_bf16 v[64:67], v[32:35], a[76:79], v[64:67]
    s_waitcnt lgkmcnt(4)
    v_mfma_f32_16x16x32_bf16 v[52:55], v[36:39], a[80:83], v[52:55]
    ds_read_b128 v[28:31], v12 offset:26624
    s_add_u32 m0, s21, 83968
    v_mfma_f32_16x16x32_bf16 v[56:59], v[36:39], a[84:87], v[56:59]
    buffer_load_dwordx4 v10, s[8:11], s20 offen lds
    v_mfma_f32_16x16x32_bf16 v[60:63], v[40:43], a[80:83], v[60:63]
    ds_read_b128 v[32:35], v13 offset:26624
    s_min_u32 s51, s51, s61
    v_mfma_f32_16x16x32_bf16 v[64:67], v[40:43], a[84:87], v[64:67]
    s_waitcnt lgkmcnt(4)
    v_mfma_f32_16x16x32_bf16 v[52:55], v[44:47], a[88:91], v[52:55]
    ds_read_b128 v[36:39], v12 offset:28672
    s_lshl_b32 s51, s51, 7
    v_mfma_f32_16x16x32_bf16 v[56:59], v[44:47], a[92:95], v[56:59]
    buffer_load_dword v135, v137, s[32:35], s42 offen offset:2048
    v_mfma_f32_16x16x32_bf16 v[60:63], v[48:51], a[88:91], v[60:63]
    ds_read_b128 v[40:43], v13 offset:28672
    v_mfma_f32_16x16x32_bf16 v[64:67], v[48:51], a[92:95], v[64:67]
    s_waitcnt lgkmcnt(4)
    s_add_u32 s51, s51, s48
    v_mfma_f32_16x16x32_bf16 v[52:55], v[20:23], a[96:99], v[52:55]
    ds_read_b128 v[44:47], v12 offset:30720
    s_add_u32 m0, s21, 84992
    v_mfma_f32_16x16x32_bf16 v[56:59], v[20:23], a[100:103], v[56:59]
    buffer_load_dwordx4 v11, s[8:11], s20 offen lds
    v_mfma_f32_16x16x32_bf16 v[60:63], v[24:27], a[96:99], v[60:63]
    ds_read_b128 v[48:51], v13 offset:30720
    s_waitcnt vmcnt(12)
    v_xor_b32 v124, s7, v88
    v_mfma_f32_16x16x32_bf16 v[64:67], v[24:27], a[100:103], v[64:67]
    s_waitcnt lgkmcnt(4)
    v_bitop3_b32 v124, v124, v89, s7 bitop3:0xf6
    v_mfma_f32_16x16x32_bf16 v[52:55], v[28:31], a[104:107], v[52:55]
    s_waitcnt vmcnt(22)
    s_barrier
    ds_read_b128 v[20:23], v12 offset:32768
    v_mfma_f32_16x16x32_bf16 v[56:59], v[28:31], a[108:111], v[56:59]
    s_add_u32 s20, s20, 16384
    buffer_load_dword v87, v4, s[12:15], s51 offen sc1
    v_mfma_f32_16x16x32_bf16 v[60:63], v[32:35], a[104:107], v[60:63]
    ds_read_b128 v[24:27], v13 offset:32768
    v_bitop3_b32 v124, v124, v90, s7 bitop3:0xf6
    v_bitop3_b32 v124, v124, v91, s7 bitop3:0xf6
    v_mfma_f32_16x16x32_bf16 v[64:67], v[32:35], a[108:111], v[64:67]
    s_waitcnt lgkmcnt(4)
    v_and_b32 v124, 1, v124
    v_mfma_f32_16x16x32_bf16 v[52:55], v[36:39], a[112:115], v[52:55]
    ds_read_b128 v[28:31], v12 offset:34816
    s_add_u32 m0, s21, 98304
    v_cmp_ne_u32 vcc, 0, v124
    v_mfma_f32_16x16x32_bf16 v[56:59], v[36:39], a[116:119], v[56:59]
    buffer_load_dwordx4 v8, s[8:11], s20 offen lds
    s_nop 0
    v_mfma_f32_16x16x32_bf16 v[60:63], v[40:43], a[112:115], v[60:63]
    ds_read_b128 v[32:35], v13 offset:34816
    s_nop 0
    v_mfma_f32_16x16x32_bf16 v[64:67], v[40:43], a[116:119], v[64:67]
    s_waitcnt lgkmcnt(4)
    s_nop 0
    s_cbranch_vccnz L_rbad_492
L_rok_493:
    v_mfma_f32_16x16x32_bf16 v[52:55], v[44:47], a[120:123], v[52:55]
    ds_read_b128 v[36:39], v12 offset:36864
    v_mfma_f32_16x16x32_bf16 v[56:59], v[44:47], a[124:127], v[56:59]
    v_lshlrev_b32 v124, 16, v88
    v_and_b32 v125, 0xffff0000, v88
    v_mfma_f32_16x16x32_bf16 v[60:63], v[48:51], a[120:123], v[60:63]
    ds_read_b128 v[40:43], v13 offset:36864
    v_add_f32 v96, v116, v124
    v_add_f32 v97, v117, v125
    v_mfma_f32_16x16x32_bf16 v[64:67], v[48:51], a[124:127], v[64:67]
    s_waitcnt lgkmcnt(4)
    v_lshlrev_b32 v124, 16, v89
    v_mfma_f32_16x16x32_bf16 v[52:55], v[20:23], a[128:131], v[52:55]
    ds_read_b128 v[44:47], v12 offset:38912
    s_add_u32 m0, s21, 99328
    v_and_b32 v125, 0xffff0000, v89
    v_mfma_f32_16x16x32_bf16 v[56:59], v[20:23], a[132:135], v[56:59]
    buffer_load_dwordx4 v9, s[8:11], s20 offen lds
    v_mfma_f32_16x16x32_bf16 v[60:63], v[24:27], a[128:131], v[60:63]
    ds_read_b128 v[48:51], v13 offset:38912
    v_add_f32 v98, v118, v124
    v_add_f32 v99, v119, v125
    v_mfma_f32_16x16x32_bf16 v[64:67], v[24:27], a[132:135], v[64:67]
    s_waitcnt lgkmcnt(4)
    v_lshlrev_b32 v124, 16, v90
    v_mfma_f32_16x16x32_bf16 v[52:55], v[28:31], a[136:139], v[52:55]
    ds_read_b128 v[20:23], v12 offset:40960
    v_and_b32 v125, 0xffff0000, v90
    v_add_f32 v100, v120, v124
    v_mfma_f32_16x16x32_bf16 v[56:59], v[28:31], a[140:143], v[56:59]
    v_add_f32 v101, v121, v125
    v_lshlrev_b32 v124, 16, v91
    v_mfma_f32_16x16x32_bf16 v[60:63], v[32:35], a[136:139], v[60:63]
    ds_read_b128 v[24:27], v13 offset:40960
    v_and_b32 v125, 0xffff0000, v91
    v_mfma_f32_16x16x32_bf16 v[64:67], v[32:35], a[140:143], v[64:67]
    s_waitcnt lgkmcnt(4)
    v_add_f32 v102, v122, v124
    v_add_f32 v103, v123, v125
    v_mfma_f32_16x16x32_bf16 v[52:55], v[36:39], a[144:147], v[52:55]
    ds_read_b128 v[28:31], v12 offset:43008
    s_add_u32 m0, s21, 100352
    v_mfma_f32_16x16x32_bf16 v[56:59], v[36:39], a[148:151], v[56:59]
    buffer_load_dwordx4 v10, s[8:11], s20 offen lds
    v_mfma_f32_16x16x32_bf16 v[60:63], v[40:43], a[144:147], v[60:63]
    ds_read_b128 v[32:35], v13 offset:43008
    v_mfma_f32_16x16x32_bf16 v[64:67], v[40:43], a[148:151], v[64:67]
    s_waitcnt lgkmcnt(4)
    v_mfma_f32_16x16x32_bf16 v[52:55], v[44:47], a[152:155], v[52:55]
    ds_read_b128 v[36:39], v12 offset:45056
    s_waitcnt vmcnt(5)
    v_lshlrev_b32 v130, 16, v132
    v_mfma_f32_16x16x32_bf16 v[56:59], v[44:47], a[156:159], v[56:59]
    v_and_b32 v131, 0xffff0000, v132
    v_mfma_f32_16x16x32_bf16 v[60:63], v[48:51], a[152:155], v[60:63]
    ds_read_b128 v[40:43], v13 offset:45056
    v_mul_f32 v130, v130, v128
    v_mul_f32 v131, v131, v129
    v_mfma_f32_16x16x32_bf16 v[64:67], v[48:51], a[156:159], v[64:67]
    s_waitcnt lgkmcnt(4)
    v_cvt_pk_bf16_f32 v130, 0, v130
    v_mfma_f32_16x16x32_bf16 v[52:55], v[20:23], a[160:163], v[52:55]
    ds_read_b128 v[44:47], v12 offset:47104
    s_add_u32 m0, s21, 101376
    v_mfma_f32_16x16x32_bf16 v[56:59], v[20:23], a[164:167], v[56:59]
    buffer_load_dwordx4 v11, s[8:11], s20 offen lds
    v_cvt_pk_bf16_f32 v131, 0, v131
    v_mfma_f32_16x16x32_bf16 v[60:63], v[24:27], a[160:163], v[60:63]
    ds_read_b128 v[48:51], v13 offset:47104
    v_add_f32 v96, v96, v130
    v_mfma_f32_16x16x32_bf16 v[64:67], v[24:27], a[164:167], v[64:67]
    s_waitcnt lgkmcnt(4)
    v_add_f32 v97, v97, v131
    v_mfma_f32_16x16x32_bf16 v[52:55], v[28:31], a[168:171], v[52:55]
    s_waitcnt vmcnt(19)
    s_barrier
    ds_read_b128 v[20:23], v12 offset:49152
    v_mfma_f32_16x16x32_bf16 v[56:59], v[28:31], a[172:175], v[56:59]
    s_add_u32 s20, s20, 16384
    buffer_store_dwordx2 v[96:97], v140, s[16:19], s43 offen
    v_mfma_f32_16x16x32_bf16 v[60:63], v[32:35], a[168:171], v[60:63]
    ds_read_b128 v[24:27], v13 offset:49152
    v_lshlrev_b32 v130, 16, v133
    v_and_b32 v131, 0xffff0000, v133
    v_mfma_f32_16x16x32_bf16 v[64:67], v[32:35], a[172:175], v[64:67]
    s_waitcnt lgkmcnt(4)
    v_mul_f32 v130, v130, v128
    v_mfma_f32_16x16x32_bf16 v[52:55], v[36:39], a[176:179], v[52:55]
    ds_read_b128 v[28:31], v12 offset:51200
    s_add_u32 m0, s21, 114688
    v_mul_f32 v131, v131, v129
    v_mfma_f32_16x16x32_bf16 v[56:59], v[36:39], a[180:183], v[56:59]
    buffer_load_dwordx4 v8, s[8:11], s20 offen lds
    v_mfma_f32_16x16x32_bf16 v[60:63], v[40:43], a[176:179], v[60:63]
    ds_read_b128 v[32:35], v13 offset:51200
    v_cvt_pk_bf16_f32 v130, 0, v130
    v_mfma_f32_16x16x32_bf16 v[64:67], v[40:43], a[180:183], v[64:67]
    s_waitcnt lgkmcnt(4)
    v_cvt_pk_bf16_f32 v131, 0, v131
    v_add_f32 v98, v98, v130
    v_mfma_f32_16x16x32_bf16 v[52:55], v[44:47], a[184:187], v[52:55]
    ds_read_b128 v[36:39], v12 offset:53248
    v_add_f32 v99, v99, v131
    v_mfma_f32_16x16x32_bf16 v[56:59], v[44:47], a[188:191], v[56:59]
    buffer_store_dwordx2 v[98:99], v141, s[16:19], s43 offen
    v_lshlrev_b32 v130, 16, v134
    v_mfma_f32_16x16x32_bf16 v[60:63], v[48:51], a[184:187], v[60:63]
    ds_read_b128 v[40:43], v13 offset:53248
    v_and_b32 v131, 0xffff0000, v134
    v_mfma_f32_16x16x32_bf16 v[64:67], v[48:51], a[188:191], v[64:67]
    s_waitcnt lgkmcnt(4)
    v_mul_f32 v130, v130, v128
    v_mfma_f32_16x16x32_bf16 v[52:55], v[20:23], a[192:195], v[52:55]
    ds_read_b128 v[44:47], v12 offset:55296
    s_add_u32 m0, s21, 115712
    v_mul_f32 v131, v131, v129
    v_mfma_f32_16x16x32_bf16 v[56:59], v[20:23], a[196:199], v[56:59]
    buffer_load_dwordx4 v9, s[8:11], s20 offen lds
    v_mfma_f32_16x16x32_bf16 v[60:63], v[24:27], a[192:195], v[60:63]
    ds_read_b128 v[48:51], v13 offset:55296
    v_cvt_pk_bf16_f32 v130, 0, v130
    v_cvt_pk_bf16_f32 v131, 0, v131
    v_mfma_f32_16x16x32_bf16 v[64:67], v[24:27], a[196:199], v[64:67]
    s_waitcnt lgkmcnt(4)
    v_add_f32 v100, v100, v130
    v_mfma_f32_16x16x32_bf16 v[52:55], v[28:31], a[200:203], v[52:55]
    ds_read_b128 v[20:23], v12 offset:57344
    v_add_f32 v101, v101, v131
    v_mfma_f32_16x16x32_bf16 v[56:59], v[28:31], a[204:207], v[56:59]
    buffer_store_dwordx2 v[100:101], v142, s[16:19], s43 offen
    v_lshlrev_b32 v130, 16, v135
    v_mfma_f32_16x16x32_bf16 v[60:63], v[32:35], a[200:203], v[60:63]
    ds_read_b128 v[24:27], v13 offset:57344
    s_add_u32 s24, s24, 1
    v_and_b32 v131, 0xffff0000, v135
    v_mfma_f32_16x16x32_bf16 v[64:67], v[32:35], a[204:207], v[64:67]
    s_waitcnt lgkmcnt(4)
    s_min_u32 s24, s24, s61
    v_mul_f32 v130, v130, v128
    v_mfma_f32_16x16x32_bf16 v[52:55], v[36:39], a[208:211], v[52:55]
    ds_read_b128 v[28:31], v12 offset:59392
    s_add_u32 m0, s21, 116736
    s_lshl_b32 s53, s24, 17
    v_mul_f32 v131, v131, v129
    v_mfma_f32_16x16x32_bf16 v[56:59], v[36:39], a[212:215], v[56:59]
    buffer_load_dwordx4 v10, s[8:11], s20 offen lds
    v_cvt_pk_bf16_f32 v130, 0, v130
    v_mfma_f32_16x16x32_bf16 v[60:63], v[40:43], a[208:211], v[60:63]
    ds_read_b128 v[32:35], v13 offset:59392
    s_add_u32 s53, s53, s50
    v_cvt_pk_bf16_f32 v131, 0, v131
    v_mfma_f32_16x16x32_bf16 v[64:67], v[40:43], a[212:215], v[64:67]
    s_waitcnt lgkmcnt(4)
    s_waitcnt vmcnt(10)
    v_add_f32 v102, v102, v130
    v_mfma_f32_16x16x32_bf16 v[52:55], v[44:47], a[216:219], v[52:55]
    ds_read_b128 v[36:39], v12 offset:61440
    v_readfirstlane_b32 s30, v87
    v_add_f32 v103, v103, v131
    v_mfma_f32_16x16x32_bf16 v[56:59], v[44:47], a[220:223], v[56:59]
    s_nop 0
    buffer_store_dwordx2 v[102:103], v143, s[16:19], s43 offen
    v_mfma_f32_16x16x32_bf16 v[60:63], v[48:51], a[216:219], v[60:63]
    ds_read_b128 v[40:43], v13 offset:61440
    s_nop 0
    v_mfma_f32_16x16x32_bf16 v[64:67], v[48:51], a[220:223], v[64:67]
    s_waitcnt lgkmcnt(4)
    s_cmp_lt_u32 s30, 16
    s_cbranch_scc1 L_gw_495
L_gok_494:
    v_mfma_f32_16x16x32_bf16 v[52:55], v[20:23], a[224:227], v[52:55]
    ds_read_b128 v[44:47], v12 offset:63488
    s_add_u32 m0, s21, 117760
    v_mfma_f32_16x16x32_bf16 v[56:59], v[20:23], a[228:231], v[56:59]
    buffer_load_dwordx4 v11, s[8:11], s20 offen lds
    v_mfma_f32_16x16x32_bf16 v[60:63], v[24:27], a[224:227], v[60:63]
    ds_read_b128 v[48:51], v13 offset:63488
    v_mov_b32 v116, v68
    v_mov_b32 v117, v72
    v_mfma_f32_16x16x32_bf16 v[64:67], v[24:27], a[228:231], v[64:67]
    s_waitcnt lgkmcnt(4)
    v_mov_b32 v118, v69
    v_mov_b32 v119, v73
    v_mfma_f32_16x16x32_bf16 v[52:55], v[28:31], a[232:235], v[52:55]
    s_waitcnt vmcnt(20)
    s_barrier
    ds_read_b128 v[20:23], v16 offset:0
    v_mfma_f32_16x16x32_bf16 v[56:59], v[28:31], a[236:239], v[56:59]
    s_mov_b32 s20, s53
    v_mov_b32 v120, v70
    v_mov_b32 v121, v74
    v_mfma_f32_16x16x32_bf16 v[60:63], v[32:35], a[232:235], v[60:63]
    ds_read_b128 v[24:27], v17 offset:0
    v_mov_b32 v122, v71
    v_mfma_f32_16x16x32_bf16 v[64:67], v[32:35], a[236:239], v[64:67]
    s_waitcnt lgkmcnt(4)
    v_mov_b32 v123, v75
    s_mov_b32 s7, s38
    v_mfma_f32_16x16x32_bf16 v[52:55], v[36:39], a[240:243], v[52:55]
    ds_read_b128 v[28:31], v16 offset:2048
    s_add_u32 m0, s21, 0
    s_add_u32 s39, s44, s31
    v_mfma_f32_16x16x32_bf16 v[56:59], v[36:39], a[244:247], v[56:59]
    buffer_load_dwordx4 v8, s[8:11], s20 offen lds
    s_sub_u32 s43, s22, 1
    v_mfma_f32_16x16x32_bf16 v[60:63], v[40:43], a[240:243], v[60:63]
    ds_read_b128 v[32:35], v17 offset:2048
    s_lshl_b32 s42, s43, 16
    v_mfma_f32_16x16x32_bf16 v[64:67], v[40:43], a[244:247], v[64:67]
    s_waitcnt lgkmcnt(4)
    s_lshl_b32 s43, s43, 18
    s_cmp_eq_u32 s37, 0
    s_cselect_b32 s42, 0x7ff00000, s42
    s_cselect_b32 s43, 0x7ff00000, s43
    v_mfma_f32_16x16x32_bf16 v[52:55], v[44:47], a[248:251], v[52:55]
    ds_read_b128 v[36:39], v16 offset:4096
    v_mfma_f32_16x16x32_bf16 v[56:59], v[44:47], a[252:255], v[56:59]
    buffer_load_dwordx4 v[88:91], v112, s[12:15], s39 offen offset:0 sc1
    v_mfma_f32_16x16x32_bf16 v[60:63], v[48:51], a[248:251], v[60:63]
    ds_read_b128 v[40:43], v17 offset:4096
    s_mov_b32 s37, 1
    v_mfma_f32_16x16x32_bf16 v[64:67], v[48:51], a[252:255], v[64:67]
    s_waitcnt lgkmcnt(4)
    s_add_u32 s22, s22, 1
    s_cmp_ge_u32 s22, s23
    s_cbranch_scc1 L_fl0_488
    v_mfma_f32_16x16x32_bf16 v[68:71], v[20:23], a[0:3], 0
    ds_read_b128 v[44:47], v16 offset:6144
    s_add_u32 m0, s21, 1024
    v_mfma_f32_16x16x32_bf16 v[72:75], v[20:23], a[4:7], 0
    buffer_load_dwordx4 v9, s[8:11], s20 offen lds
    v_mfma_f32_16x16x32_bf16 v[76:79], v[24:27], a[0:3], 0
    ds_read_b128 v[48:51], v17 offset:6144
    s_sub_u32 s38, s22, 1
    v_mfma_f32_16x16x32_bf16 v[80:83], v[24:27], a[4:7], 0
    s_waitcnt lgkmcnt(4)
    s_and_b32 s31, s38, 3
    v_mfma_f32_16x16x32_bf16 v[68:71], v[28:31], a[8:11], v[68:71]
    ds_read_b128 v[20:23], v16 offset:8192
    s_lshl_b32 s31, s31, 11
    v_mfma_f32_16x16x32_bf16 v[72:75], v[28:31], a[12:15], v[72:75]
    buffer_load_dword v132, v136, s[32:35], s42 offen offset:0
    v_mfma_f32_16x16x32_bf16 v[76:79], v[32:35], a[8:11], v[76:79]
    ds_read_b128 v[24:27], v17 offset:8192
    v_mfma_f32_16x16x32_bf16 v[80:83], v[32:35], a[12:15], v[80:83]
    s_waitcnt lgkmcnt(4)
    s_bfe_u32 s38, s38, 0x10002
    v_mfma_f32_16x16x32_bf16 v[68:71], v[36:39], a[16:19], v[68:71]
    ds_read_b128 v[28:31], v16 offset:10240
    s_add_u32 m0, s21, 2048
    v_mfma_f32_16x16x32_bf16 v[72:75], v[36:39], a[20:23], v[72:75]
    buffer_load_dwordx4 v10, s[8:11], s20 offen lds
    v_mfma_f32_16x16x32_bf16 v[76:79], v[40:43], a[16:19], v[76:79]
    ds_read_b128 v[32:35], v17 offset:10240
    s_xor_b32 s38, s38, 1
    v_mfma_f32_16x16x32_bf16 v[80:83], v[40:43], a[20:23], v[80:83]
    s_waitcnt lgkmcnt(4)
    s_cmp_eq_u32 s37, 0
    s_cselect_b32 s31, 0x40000000, s31
    s_cselect_b32 s38, 0, s38
    v_mfma_f32_16x16x32_bf16 v[68:71], v[44:47], a[24:27], v[68:71]
    ds_read_b128 v[36:39], v16 offset:12288
    v_mfma_f32_16x16x32_bf16 v[72:75], v[44:47], a[28:31], v[72:75]
    buffer_load_dword v133, v136, s[32:35], s42 offen offset:2048
    v_mfma_f32_16x16x32_bf16 v[76:79], v[48:51], a[24:27], v[76:79]
    ds_read_b128 v[40:43], v17 offset:12288
    v_mfma_f32_16x16x32_bf16 v[80:83], v[48:51], a[28:31], v[80:83]
    s_waitcnt lgkmcnt(4)
    v_mfma_f32_16x16x32_bf16 v[68:71], v[20:23], a[32:35], v[68:71]
    ds_read_b128 v[44:47], v16 offset:14336
    s_add_u32 m0, s21, 3072
    v_mfma_f32_16x16x32_bf16 v[72:75], v[20:23], a[36:39], v[72:75]
    buffer_load_dwordx4 v11, s[8:11], s20 offen lds
    v_mfma_f32_16x16x32_bf16 v[76:79], v[24:27], a[32:35], v[76:79]
    ds_read_b128 v[48:51], v17 offset:14336
    v_cvt_pk_bf16_f32 v104, v60, v64
    v_mfma_f32_16x16x32_bf16 v[80:83], v[24:27], a[36:39], v[80:83]
    s_waitcnt lgkmcnt(4)
    v_mfma_f32_16x16x32_bf16 v[68:71], v[28:31], a[40:43], v[68:71]
    s_waitcnt vmcnt(20)
    s_barrier
    ds_read_b128 v[20:23], v16 offset:16384
    v_mfma_f32_16x16x32_bf16 v[72:75], v[28:31], a[44:47], v[72:75]
    s_add_u32 s20, s20, 16384
    v_cvt_pk_bf16_f32 v105, v61, v65
    v_mfma_f32_16x16x32_bf16 v[76:79], v[32:35], a[40:43], v[76:79]
    ds_read_b128 v[24:27], v17 offset:16384
    v_cvt_pk_bf16_f32 v106, v62, v66
    v_mfma_f32_16x16x32_bf16 v[80:83], v[32:35], a[44:47], v[80:83]
    s_waitcnt lgkmcnt(4)
    v_cvt_pk_bf16_f32 v107, v63, v67
    v_mfma_f32_16x16x32_bf16 v[68:71], v[36:39], a[48:51], v[68:71]
    ds_read_b128 v[28:31], v16 offset:18432
    s_add_u32 m0, s21, 16384
    v_mfma_f32_16x16x32_bf16 v[72:75], v[36:39], a[52:55], v[72:75]
    buffer_load_dwordx4 v8, s[8:11], s20 offen lds
    v_mfma_f32_16x16x32_bf16 v[76:79], v[40:43], a[48:51], v[76:79]
    ds_read_b128 v[32:35], v17 offset:18432
    v_mfma_f32_16x16x32_bf16 v[80:83], v[40:43], a[52:55], v[80:83]
    s_waitcnt lgkmcnt(4)
    v_and_or_b32 v104, v104, -2, s38
    v_mfma_f32_16x16x32_bf16 v[68:71], v[44:47], a[56:59], v[68:71]
    ds_read_b128 v[36:39], v16 offset:20480
    v_and_or_b32 v105, v105, -2, s38
    v_mfma_f32_16x16x32_bf16 v[72:75], v[44:47], a[60:63], v[72:75]
    buffer_load_dword v134, v137, s[32:35], s42 offen offset:0
    v_mfma_f32_16x16x32_bf16 v[76:79], v[48:51], a[56:59], v[76:79]
    ds_read_b128 v[40:43], v17 offset:20480
    v_and_or_b32 v106, v106, -2, s38
    v_mfma_f32_16x16x32_bf16 v[80:83], v[48:51], a[60:63], v[80:83]
    s_waitcnt lgkmcnt(4)
    v_mfma_f32_16x16x32_bf16 v[68:71], v[20:23], a[64:67], v[68:71]
    ds_read_b128 v[44:47], v16 offset:22528
    s_add_u32 m0, s21, 17408
    v_mfma_f32_16x16x32_bf16 v[72:75], v[20:23], a[68:71], v[72:75]
    buffer_load_dwordx4 v9, s[8:11], s20 offen lds
    v_mfma_f32_16x16x32_bf16 v[76:79], v[24:27], a[64:67], v[76:79]
    ds_read_b128 v[48:51], v17 offset:22528
    v_and_or_b32 v107, v107, -2, s38
    v_mfma_f32_16x16x32_bf16 v[80:83], v[24:27], a[68:71], v[80:83]
    s_waitcnt lgkmcnt(4)
    s_add_u32 s29, s45, s31
    v_mfma_f32_16x16x32_bf16 v[68:71], v[28:31], a[72:75], v[68:71]
    ds_read_b128 v[20:23], v16 offset:24576
    v_mfma_f32_16x16x32_bf16 v[72:75], v[28:31], a[76:79], v[72:75]
    buffer_store_dwordx4 v[104:107], v112, s[12:15], s29 offen offset:0 sc1
    v_mfma_f32_16x16x32_bf16 v[76:79], v[32:35], a[72:75], v[76:79]
    ds_read_b128 v[24:27], v17 offset:24576
    s_add_u32 s51, s24, 1
    v_mfma_f32_16x16x32_bf16 v[80:83], v[32:35], a[76:79], v[80:83]
    s_waitcnt lgkmcnt(4)
    v_mfma_f32_16x16x32_bf16 v[68:71], v[36:39], a[80:83], v[68:71]
    ds_read_b128 v[28:31], v16 offset:26624
    s_add_u32 m0, s21, 18432
    v_mfma_f32_16x16x32_bf16 v[72:75], v[36:39], a[84:87], v[72:75]
    buffer_load_dwordx4 v10, s[8:11], s20 offen lds
    v_mfma_f32_16x16x32_bf16 v[76:79], v[40:43], a[80:83], v[76:79]
    ds_read_b128 v[32:35], v17 offset:26624
    s_min_u32 s51, s51, s61
    v_mfma_f32_16x16x32_bf16 v[80:83], v[40:43], a[84:87], v[80:83]
    s_waitcnt lgkmcnt(4)
    v_mfma_f32_16x16x32_bf16 v[68:71], v[44:47], a[88:91], v[68:71]
    ds_read_b128 v[36:39], v16 offset:28672
    s_lshl_b32 s51, s51, 7
    v_mfma_f32_16x16x32_bf16 v[72:75], v[44:47], a[92:95], v[72:75]
    buffer_load_dword v135, v137, s[32:35], s42 offen offset:2048
    v_mfma_f32_16x16x32_bf16 v[76:79], v[48:51], a[88:91], v[76:79]
    ds_read_b128 v[40:43], v17 offset:28672
    v_mfma_f32_16x16x32_bf16 v[80:83], v[48:51], a[92:95], v[80:83]
    s_waitcnt lgkmcnt(4)
    s_add_u32 s51, s51, s48
    v_mfma_f32_16x16x32_bf16 v[68:71], v[20:23], a[96:99], v[68:71]
    ds_read_b128 v[44:47], v16 offset:30720
    s_add_u32 m0, s21, 19456
    v_mfma_f32_16x16x32_bf16 v[72:75], v[20:23], a[100:103], v[72:75]
    buffer_load_dwordx4 v11, s[8:11], s20 offen lds
    v_mfma_f32_16x16x32_bf16 v[76:79], v[24:27], a[96:99], v[76:79]
    ds_read_b128 v[48:51], v17 offset:30720
    s_waitcnt vmcnt(12)
    v_xor_b32 v124, s7, v88
    v_mfma_f32_16x16x32_bf16 v[80:83], v[24:27], a[100:103], v[80:83]
    s_waitcnt lgkmcnt(4)
    v_bitop3_b32 v124, v124, v89, s7 bitop3:0xf6
    v_mfma_f32_16x16x32_bf16 v[68:71], v[28:31], a[104:107], v[68:71]
    s_waitcnt vmcnt(22)
    s_barrier
    ds_read_b128 v[20:23], v16 offset:32768
    v_mfma_f32_16x16x32_bf16 v[72:75], v[28:31], a[108:111], v[72:75]
    s_add_u32 s20, s20, 16384
    buffer_load_dword v87, v4, s[12:15], s51 offen sc1
    v_mfma_f32_16x16x32_bf16 v[76:79], v[32:35], a[104:107], v[76:79]
    ds_read_b128 v[24:27], v17 offset:32768
    v_bitop3_b32 v124, v124, v90, s7 bitop3:0xf6
    v_bitop3_b32 v124, v124, v91, s7 bitop3:0xf6
    v_mfma_f32_16x16x32_bf16 v[80:83], v[32:35], a[108:111], v[80:83]
    s_waitcnt lgkmcnt(4)
    v_and_b32 v124, 1, v124
    v_mfma_f32_16x16x32_bf16 v[68:71], v[36:39], a[112:115], v[68:71]
    ds_read_b128 v[28:31], v16 offset:34816
    s_add_u32 m0, s21, 32768
    v_cmp_ne_u32 vcc, 0, v124
    v_mfma_f32_16x16x32_bf16 v[72:75], v[36:39], a[116:119], v[72:75]
    buffer_load_dwordx4 v8, s[8:11], s20 offen lds
    s_nop 0
    v_mfma_f32_16x16x32_bf16 v[76:79], v[40:43], a[112:115], v[76:79]
    ds_read_b128 v[32:35], v17 offset:34816
    s_nop 0
    v_mfma_f32_16x16x32_bf16 v[80:83], v[40:43], a[116:119], v[80:83]
    s_waitcnt lgkmcnt(4)
    s_nop 0
    s_cbranch_vccnz L_rbad_496
L_rok_497:
    v_mfma_f32_16x16x32_bf16 v[68:71], v[44:47], a[120:123], v[68:71]
    ds_read_b128 v[36:39], v16 offset:36864
    v_mfma_f32_16x16x32_bf16 v[72:75], v[44:47], a[124:127], v[72:75]
    v_lshlrev_b32 v124, 16, v88
    v_and_b32 v125, 0xffff0000, v88
    v_mfma_f32_16x16x32_bf16 v[76:79], v[48:51], a[120:123], v[76:79]
    ds_read_b128 v[40:43], v17 offset:36864
    v_add_f32 v96, v116, v124
    v_add_f32 v97, v117, v125
    v_mfma_f32_16x16x32_bf16 v[80:83], v[48:51], a[124:127], v[80:83]
    s_waitcnt lgkmcnt(4)
    v_lshlrev_b32 v124, 16, v89
    v_mfma_f32_16x16x32_bf16 v[68:71], v[20:23], a[128:131], v[68:71]
    ds_read_b128 v[44:47], v16 offset:38912
    s_add_u32 m0, s21, 33792
    v_and_b32 v125, 0xffff0000, v89
    v_mfma_f32_16x16x32_bf16 v[72:75], v[20:23], a[132:135], v[72:75]
    buffer_load_dwordx4 v9, s[8:11], s20 offen lds
    v_mfma_f32_16x16x32_bf16 v[76:79], v[24:27], a[128:131], v[76:79]
    ds_read_b128 v[48:51], v17 offset:38912
    v_add_f32 v98, v118, v124
    v_add_f32 v99, v119, v125
    v_mfma_f32_16x16x32_bf16 v[80:83], v[24:27], a[132:135], v[80:83]
    s_waitcnt lgkmcnt(4)
    v_lshlrev_b32 v124, 16, v90
    v_mfma_f32_16x16x32_bf16 v[68:71], v[28:31], a[136:139], v[68:71]
    ds_read_b128 v[20:23], v16 offset:40960
    v_and_b32 v125, 0xffff0000, v90
    v_add_f32 v100, v120, v124
    v_mfma_f32_16x16x32_bf16 v[72:75], v[28:31], a[140:143], v[72:75]
    v_add_f32 v101, v121, v125
    v_lshlrev_b32 v124, 16, v91
    v_mfma_f32_16x16x32_bf16 v[76:79], v[32:35], a[136:139], v[76:79]
    ds_read_b128 v[24:27], v17 offset:40960
    v_and_b32 v125, 0xffff0000, v91
    v_mfma_f32_16x16x32_bf16 v[80:83], v[32:35], a[140:143], v[80:83]
    s_waitcnt lgkmcnt(4)
    v_add_f32 v102, v122, v124
    v_add_f32 v103, v123, v125
    v_mfma_f32_16x16x32_bf16 v[68:71], v[36:39], a[144:147], v[68:71]
    ds_read_b128 v[28:31], v16 offset:43008
    s_add_u32 m0, s21, 34816
    v_mfma_f32_16x16x32_bf16 v[72:75], v[36:39], a[148:151], v[72:75]
    buffer_load_dwordx4 v10, s[8:11], s20 offen lds
    v_mfma_f32_16x16x32_bf16 v[76:79], v[40:43], a[144:147], v[76:79]
    ds_read_b128 v[32:35], v17 offset:43008
    v_mfma_f32_16x16x32_bf16 v[80:83], v[40:43], a[148:151], v[80:83]
    s_waitcnt lgkmcnt(4)
    v_mfma_f32_16x16x32_bf16 v[68:71], v[44:47], a[152:155], v[68:71]
    ds_read_b128 v[36:39], v16 offset:45056
    s_waitcnt vmcnt(5)
    v_lshlrev_b32 v130, 16, v132
    v_mfma_f32_16x16x32_bf16 v[72:75], v[44:47], a[156:159], v[72:75]
    v_and_b32 v131, 0xffff0000, v132
    v_mfma_f32_16x16x32_bf16 v[76:79], v[48:51], a[152:155], v[76:79]
    ds_read_b128 v[40:43], v17 offset:45056
    v_mul_f32 v130, v130, v128
    v_mul_f32 v131, v131, v129
    v_mfma_f32_16x16x32_bf16 v[80:83], v[48:51], a[156:159], v[80:83]
    s_waitcnt lgkmcnt(4)
    v_cvt_pk_bf16_f32 v130, 0, v130
    v_mfma_f32_16x16x32_bf16 v[68:71], v[20:23], a[160:163], v[68:71]
    ds_read_b128 v[44:47], v16 offset:47104
    s_add_u32 m0, s21, 35840
    v_mfma_f32_16x16x32_bf16 v[72:75], v[20:23], a[164:167], v[72:75]
    buffer_load_dwordx4 v11, s[8:11], s20 offen lds
    v_cvt_pk_bf16_f32 v131, 0, v131
    v_mfma_f32_16x16x32_bf16 v[76:79], v[24:27], a[160:163], v[76:79]
    ds_read_b128 v[48:51], v17 offset:47104
    v_add_f32 v96, v96, v130
    v_mfma_f32_16x16x32_bf16 v[80:83], v[24:27], a[164:167], v[80:83]
    s_waitcnt lgkmcnt(4)
    v_add_f32 v97, v97, v131
    v_mfma_f32_16x16x32_bf16 v[68:71], v[28:31], a[168:171], v[68:71]
    s_waitcnt vmcnt(19)
    s_barrier
    ds_read_b128 v[20:23], v16 offset:49152
    v_mfma_f32_16x16x32_bf16 v[72:75], v[28:31], a[172:175], v[72:75]
    s_add_u32 s20, s20, 16384
    buffer_store_dwordx2 v[96:97], v140, s[16:19], s43 offen
    v_mfma_f32_16x16x32_bf16 v[76:79], v[32:35], a[168:171], v[76:79]
    ds_read_b128 v[24:27], v17 offset:49152
    v_lshlrev_b32 v130, 16, v133
    v_and_b32 v131, 0xffff0000, v133
    v_mfma_f32_16x16x32_bf16 v[80:83], v[32:35], a[172:175], v[80:83]
    s_waitcnt lgkmcnt(4)
    v_mul_f32 v130, v130, v128
    v_mfma_f32_16x16x32_bf16 v[68:71], v[36:39], a[176:179], v[68:71]
    ds_read_b128 v[28:31], v16 offset:51200
    s_add_u32 m0, s21, 49152
    v_mul_f32 v131, v131, v129
    v_mfma_f32_16x16x32_bf16 v[72:75], v[36:39], a[180:183], v[72:75]
    buffer_load_dwordx4 v8, s[8:11], s20 offen lds
    v_mfma_f32_16x16x32_bf16 v[76:79], v[40:43], a[176:179], v[76:79]
    ds_read_b128 v[32:35], v17 offset:51200
    v_cvt_pk_bf16_f32 v130, 0, v130
    v_mfma_f32_16x16x32_bf16 v[80:83], v[40:43], a[180:183], v[80:83]
    s_waitcnt lgkmcnt(4)
    v_cvt_pk_bf16_f32 v131, 0, v131
    v_add_f32 v98, v98, v130
    v_mfma_f32_16x16x32_bf16 v[68:71], v[44:47], a[184:187], v[68:71]
    ds_read_b128 v[36:39], v16 offset:53248
    v_add_f32 v99, v99, v131
    v_mfma_f32_16x16x32_bf16 v[72:75], v[44:47], a[188:191], v[72:75]
    buffer_store_dwordx2 v[98:99], v141, s[16:19], s43 offen
    v_lshlrev_b32 v130, 16, v134
    v_mfma_f32_16x16x32_bf16 v[76:79], v[48:51], a[184:187], v[76:79]
    ds_read_b128 v[40:43], v17 offset:53248
    v_and_b32 v131, 0xffff0000, v134
    v_mfma_f32_16x16x32_bf16 v[80:83], v[48:51], a[188:191], v[80:83]
    s_waitcnt lgkmcnt(4)
    v_mul_f32 v130, v130, v128
    v_mfma_f32_16x16x32_bf16 v[68:71], v[20:23], a[192:195], v[68:71]
    ds_read_b128 v[44:47], v16 offset:55296
    s_add_u32 m0, s21, 50176
    v_mul_f32 v131, v131, v129
    v_mfma_f32_16x16x32_bf16 v[72:75], v[20:23], a[196:199], v[72:75]
    buffer_load_dwordx4 v9, s[8:11], s20 offen lds
    v_mfma_f32_16x16x32_bf16 v[76:79], v[24:27], a[192:195], v[76:79]
    ds_read_b128 v[48:51], v17 offset:55296
    v_cvt_pk_bf16_f32 v130, 0, v130
    v_cvt_pk_bf16_f32 v131, 0, v131
    v_mfma_f32_16x16x32_bf16 v[80:83], v[24:27], a[196:199], v[80:83]
    s_waitcnt lgkmcnt(4)
    v_add_f32 v100, v100, v130
    v_mfma_f32_16x16x32_bf16 v[68:71], v[28:31], a[200:203], v[68:71]
    ds_read_b128 v[20:23], v16 offset:57344
    v_add_f32 v101, v101, v131
    v_mfma_f32_16x16x32_bf16 v[72:75], v[28:31], a[204:207], v[72:75]
    buffer_store_dwordx2 v[100:101], v142, s[16:19], s43 offen
    v_lshlrev_b32 v130, 16, v135
    v_mfma_f32_16x16x32_bf16 v[76:79], v[32:35], a[200:203], v[76:79]
    ds_read_b128 v[24:27], v17 offset:57344
    s_add_u32 s24, s24, 1
    v_and_b32 v131, 0xffff0000, v135
    v_mfma_f32_16x16x32_bf16 v[80:83], v[32:35], a[204:207], v[80:83]
    s_waitcnt lgkmcnt(4)
    s_min_u32 s24, s24, s61
    v_mul_f32 v130, v130, v128
    v_mfma_f32_16x16x32_bf16 v[68:71], v[36:39], a[208:211], v[68:71]
    ds_read_b128 v[28:31], v16 offset:59392
    s_add_u32 m0, s21, 51200
    s_lshl_b32 s53, s24, 17
    v_mul_f32 v131, v131, v129
    v_mfma_f32_16x16x32_bf16 v[72:75], v[36:39], a[212:215], v[72:75]
    buffer_load_dwordx4 v10, s[8:11], s20 offen lds
    v_cvt_pk_bf16_f32 v130, 0, v130
    v_mfma_f32_16x16x32_bf16 v[76:79], v[40:43], a[208:211], v[76:79]
    ds_read_b128 v[32:35], v17 offset:59392
    s_add_u32 s53, s53, s50
    v_cvt_pk_bf16_f32 v131, 0, v131
    v_mfma_f32_16x16x32_bf16 v[80:83], v[40:43], a[212:215], v[80:83]
    s_waitcnt lgkmcnt(4)
    s_waitcnt vmcnt(10)
    v_add_f32 v102, v102, v130
    v_mfma_f32_16x16x32_bf16 v[68:71], v[44:47], a[216:219], v[68:71]
    ds_read_b128 v[36:39], v16 offset:61440
    v_readfirstlane_b32 s30, v87
    v_add_f32 v103, v103, v131
    v_mfma_f32_16x16x32_bf16 v[72:75], v[44:47], a[220:223], v[72:75]
    s_nop 0
    buffer_store_dwordx2 v[102:103], v143, s[16:19], s43 offen
    v_mfma_f32_16x16x32_bf16 v[76:79], v[48:51], a[216:219], v[76:79]
    ds_read_b128 v[40:43], v17 offset:61440
    s_nop 0
    v_mfma_f32_16x16x32_bf16 v[80:83], v[48:51], a[220:223], v[80:83]
    s_waitcnt lgkmcnt(4)
    s_cmp_lt_u32 s30, 16
    s_cbranch_scc1 L_gw_499
L_gok_498:
    v_mfma_f32_16x16x32_bf16 v[68:71], v[20:23], a[224:227], v[68:71]
    ds_read_b128 v[44:47], v16 offset:63488
    s_add_u32 m0, s21, 52224
    v_mfma_f32_16x16x32_bf16 v[72:75], v[20:23], a[228:231], v[72:75]
    buffer_load_dwordx4 v11, s[8:11], s20 offen lds
    v_mfma_f32_16x16x32_bf16 v[76:79], v[24:27], a[224:227], v[76:79]
    ds_read_b128 v[48:51], v17 offset:63488
    v_mov_b32 v116, v52
    v_mov_b32 v117, v56
    v_mfma_f32_16x16x32_bf16 v[80:83], v[24:27], a[228:231], v[80:83]
    s_waitcnt lgkmcnt(4)
    v_mov_b32 v118, v53
    v_mov_b32 v119, v57
    v_mfma_f32_16x16x32_bf16 v[68:71], v[28:31], a[232:235], v[68:71]
    s_waitcnt vmcnt(20)
    s_barrier
    ds_read_b128 v[20:23], v12 offset:0
    v_mfma_f32_16x16x32_bf16 v[72:75], v[28:31], a[236:239], v[72:75]
    s_mov_b32 s20, s53
    v_mov_b32 v120, v54
    v_mov_b32 v121, v58
    v_mfma_f32_16x16x32_bf16 v[76:79], v[32:35], a[232:235], v[76:79]
    ds_read_b128 v[24:27], v13 offset:0
    v_mov_b32 v122, v55
    v_mfma_f32_16x16x32_bf16 v[80:83], v[32:35], a[236:239], v[80:83]
    s_waitcnt lgkmcnt(4)
    v_mov_b32 v123, v59
    s_mov_b32 s7, s38
    v_mfma_f32_16x16x32_bf16 v[68:71], v[36:39], a[240:243], v[68:71]
    ds_read_b128 v[28:31], v12 offset:2048
    s_add_u32 m0, s21, 65536
    s_add_u32 s39, s44, s31
    v_mfma_f32_16x16x32_bf16 v[72:75], v[36:39], a[244:247], v[72:75]
    buffer_load_dwordx4 v8, s[8:11], s20 offen lds
    s_sub_u32 s43, s22, 1
    v_mfma_f32_16x16x32_bf16 v[76:79], v[40:43], a[240:243], v[76:79]
    ds_read_b128 v[32:35], v13 offset:2048
    s_lshl_b32 s42, s43, 16
    v_mfma_f32_16x16x32_bf16 v[80:83], v[40:43], a[244:247], v[80:83]
    s_waitcnt lgkmcnt(4)
    s_lshl_b32 s43, s43, 18
    s_cmp_eq_u32 s37, 0
    s_cselect_b32 s42, 0x7ff00000, s42
    s_cselect_b32 s43, 0x7ff00000, s43
    v_mfma_f32_16x16x32_bf16 v[68:71], v[44:47], a[248:251], v[68:71]
    ds_read_b128 v[36:39], v12 offset:4096
    v_mfma_f32_16x16x32_bf16 v[72:75], v[44:47], a[252:255], v[72:75]
    buffer_load_dwordx4 v[88:91], v112, s[12:15], s39 offen offset:0 sc1
    v_mfma_f32_16x16x32_bf16 v[76:79], v[48:51], a[248:251], v[76:79]
    ds_read_b128 v[40:43], v13 offset:4096
    s_mov_b32 s37, 1
    v_mfma_f32_16x16x32_bf16 v[80:83], v[48:51], a[252:255], v[80:83]
    s_waitcnt lgkmcnt(4)
    s_add_u32 s22, s22, 1
    s_cmp_ge_u32 s22, s23
    s_cbranch_scc0 L_st_491
L_fl1_489:
    s_waitcnt lgkmcnt(0)
    s_nop 7
    s_sub_u32 s38, s22, 1
    s_and_b32 s31, s38, 3
    s_lshl_b32 s31, s31, 11
    s_bfe_u32 s38, s38, 0x10002
    s_xor_b32 s38, s38, 1
    s_cmp_eq_u32 s37, 0
    s_cselect_b32 s31, 0x40000000, s31
    s_cselect_b32 s38, 0, s38
    v_cvt_pk_bf16_f32 v104, v76, v80
    v_cvt_pk_bf16_f32 v105, v77, v81
    v_cvt_pk_bf16_f32 v106, v78, v82
    v_cvt_pk_bf16_f32 v107, v79, v83
    v_and_or_b32 v104, v104, -2, s38
    v_and_or_b32 v105, v105, -2, s38
    v_and_or_b32 v106, v106, -2, s38
    v_and_or_b32 v107, v107, -2, s38
    s_add_u32 s29, s45, s31
    buffer_store_dwordx4 v[104:107], v112, s[12:15], s29 offen offset:0 sc1
    buffer_load_dword v132, v136, s[32:35], s42 offen offset:0
    buffer_load_dword v133, v136, s[32:35], s42 offen offset:2048
    buffer_load_dword v134, v137, s[32:35], s42 offen offset:0
    buffer_load_dword v135, v137, s[32:35], s42 offen offset:2048
    s_waitcnt vmcnt(0)
    v_xor_b32 v124, s7, v88
    v_bitop3_b32 v124, v124, v89, s7 bitop3:0xf6
    v_bitop3_b32 v124, v124, v90, s7 bitop3:0xf6
    v_bitop3_b32 v124, v124, v91, s7 bitop3:0xf6
    v_and_b32 v124, 1, v124
    v_cmp_ne_u32 vcc, 0, v124
    s_nop 0
    s_nop 0
    s_nop 0
    s_cbranch_vccnz L_rbad_500
L_rok_501:
    v_lshlrev_b32 v124, 16, v88
    v_and_b32 v125, 0xffff0000, v88
    v_add_f32 v96, v116, v124
    v_add_f32 v97, v117, v125
    v_lshlrev_b32 v124, 16, v89
    v_and_b32 v125, 0xffff0000, v89
    v_add_f32 v98, v118, v124
    v_add_f32 v99, v119, v125
    v_lshlrev_b32 v124, 16, v90
    v_and_b32 v125, 0xffff0000, v90
    v_add_f32 v100, v120, v124
    v_add_f32 v101, v121, v125
    v_lshlrev_b32 v124, 16, v91
    v_and_b32 v125, 0xffff0000, v91
    v_add_f32 v102, v122, v124
    v_add_f32 v103, v123, v125
    s_waitcnt vmcnt(0)
    v_lshlrev_b32 v130, 16, v132
    v_and_b32 v131, 0xffff0000, v132
    v_mul_f32 v130, v130, v128
    v_mul_f32 v131, v131, v129
    v_cvt_pk_bf16_f32 v130, 0, v130
    v_cvt_pk_bf16_f32 v131, 0, v131
    v_add_f32 v96, v96, v130
    v_add_f32 v97, v97, v131
    buffer_store_dwordx2 v[96:97], v140, s[16:19], s43 offen
    v_lshlrev_b32 v130, 16, v133
    v_and_b32 v131, 0xffff0000, v133
    v_mul_f32 v130, v130, v128
    v_mul_f32 v131, v131, v129
    v_cvt_pk_bf16_f32 v130, 0, v130
    v_cvt_pk_bf16_f32 v131, 0, v131
    v_add_f32 v98, v98, v130
    v_add_f32 v99, v99, v131
    buffer_store_dwordx2 v[98:99], v141, s[16:19], s43 offen
    v_lshlrev_b32 v130, 16, v134
    v_and_b32 v131, 0xffff0000, v134
    v_mul_f32 v130, v130, v128
    v_mul_f32 v131, v131, v129
    v_cvt_pk_bf16_f32 v130, 0, v130
    v_cvt_pk_bf16_f32 v131, 0, v131
    v_add_f32 v100, v100, v130
    v_add_f32 v101, v101, v131
    buffer_store_dwordx2 v[100:101], v142, s[16:19], s43 offen
    v_lshlrev_b32 v130, 16, v135
    v_and_b32 v131, 0xffff0000, v135
    v_mul_f32 v130, v130, v128
    v_mul_f32 v131, v131, v129
    v_cvt_pk_bf16_f32 v130, 0, v130
    v_cvt_pk_bf16_f32 v131, 0, v131
    v_add_f32 v102, v102, v130
    v_add_f32 v103, v103, v131
    buffer_store_dwordx2 v[102:103], v143, s[16:19], s43 offen
    v_mov_b32 v116, v68
    v_mov_b32 v117, v72
    v_mov_b32 v118, v69
    v_mov_b32 v119, v73
    v_mov_b32 v120, v70
    v_mov_b32 v121, v74
    v_mov_b32 v122, v71
    v_mov_b32 v123, v75
    s_mov_b32 s7, s38
    s_add_u32 s39, s44, s31
    s_sub_u32 s43, s22, 1
    s_lshl_b32 s42, s43, 16
    s_lshl_b32 s43, s43, 18
    s_cmp_eq_u32 s37, 0
    s_cselect_b32 s42, 0x7ff00000, s42
    s_cselect_b32 s43, 0x7ff00000, s43
    buffer_load_dwordx4 v[88:91], v112, s[12:15], s39 offen offset:0 sc1
    s_mov_b32 s37, 1
    buffer_load_dword v132, v136, s[32:35], s42 offen offset:0
    buffer_load_dword v133, v136, s[32:35], s42 offen offset:2048
    buffer_load_dword v134, v137, s[32:35], s42 offen offset:0
    buffer_load_dword v135, v137, s[32:35], s42 offen offset:2048
    s_waitcnt vmcnt(0)
    v_xor_b32 v124, s7, v88
    v_bitop3_b32 v124, v124, v89, s7 bitop3:0xf6
    v_bitop3_b32 v124, v124, v90, s7 bitop3:0xf6
    v_bitop3_b32 v124, v124, v91, s7 bitop3:0xf6
    v_and_b32 v124, 1, v124
    v_cmp_ne_u32 vcc, 0, v124
    s_nop 0
    s_nop 0
    s_nop 0
    s_cbranch_vccnz L_rbad_502
L_rok_503:
    v_lshlrev_b32 v124, 16, v88
    v_and_b32 v125, 0xffff0000, v88
    v_add_f32 v96, v116, v124
    v_add_f32 v97, v117, v125
    v_lshlrev_b32 v124, 16, v89
    v_and_b32 v125, 0xffff0000, v89
    v_add_f32 v98, v118, v124
    v_add_f32 v99, v119, v125
    v_lshlrev_b32 v124, 16, v90
    v_and_b32 v125, 0xffff0000, v90
    v_add_f32 v100, v120, v124
    v_add_f32 v101, v121, v125
    v_lshlrev_b32 v124, 16, v91
    v_and_b32 v125, 0xffff0000, v91
    v_add_f32 v102, v122, v124
    v_add_f32 v103, v123, v125
    s_waitcnt vmcnt(0)
    v_lshlrev_b32 v130, 16, v132
    v_and_b32 v131, 0xffff0000, v132
    v_mul_f32 v130, v130, v128
    v_mul_f32 v131, v131, v129
    v_cvt_pk_bf16_f32 v130, 0, v130
    v_cvt_pk_bf16_f32 v131, 0, v131
    v_add_f32 v96, v96, v130
    v_add_f32 v97, v97, v131
    buffer_store_dwordx2 v[96:97], v140, s[16:19], s43 offen
    v_lshlrev_b32 v130, 16, v133
    v_and_b32 v131, 0xffff0000, v133
    v_mul_f32 v130, v130, v128
    v_mul_f32 v131, v131, v129
    v_cvt_pk_bf16_f32 v130, 0, v130
    v_cvt_pk_bf16_f32 v131, 0, v131
    v_add_f32 v98, v98, v130
    v_add_f32 v99, v99, v131
    buffer_store_dwordx2 v[98:99], v141, s[16:19], s43 offen
    v_lshlrev_b32 v130, 16, v134
    v_and_b32 v131, 0xffff0000, v134
    v_mul_f32 v130, v130, v128
    v_mul_f32 v131, v131, v129
    v_cvt_pk_bf16_f32 v130, 0, v130
    v_cvt_pk_bf16_f32 v131, 0, v131
    v_add_f32 v100, v100, v130
    v_add_f32 v101, v101, v131
    buffer_store_dwordx2 v[100:101], v142, s[16:19], s43 offen
    v_lshlrev_b32 v130, 16, v135
    v_and_b32 v131, 0xffff0000, v135
    v_mul_f32 v130, v130, v128
    v_mul_f32 v131, v131, v129
    v_cvt_pk_bf16_f32 v130, 0, v130
    v_cvt_pk_bf16_f32 v131, 0, v131
    v_add_f32 v102, v102, v130
    v_add_f32 v103, v103, v131
    buffer_store_dwordx2 v[102:103], v143, s[16:19], s43 offen
    s_branch L_ste_490
L_rbad_492:
    buffer_load_dwordx4 v[88:91], v112, s[12:15], s39 offen offset:0 sc1
    s_add_u32 s36, s36, 1
    s_cmp_gt_u32 s36, 0x100000
    s_cbranch_scc1 chain_kernel_wend
    s_waitcnt vmcnt(0)
    v_xor_b32 v124, s7, v88
    v_bitop3_b32 v124, v124, v89, s7 bitop3:0xf6
    v_bitop3_b32 v124, v124, v90, s7 bitop3:0xf6
    v_bitop3_b32 v124, v124, v91, s7 bitop3:0xf6
    v_and_b32 v124, 1, v124
    v_cmp_ne_u32 vcc, 0, v124
    s_cbranch_vccnz L_rbad_492
    s_branch L_rok_493
L_gw_495:
    buffer_load_dword v87, v4, s[12:15], s51 offen sc1
    s_add_u32 s36, s36, 1
    s_cmp_gt_u32 s36, 0x100000
    s_cbranch_scc1 chain_kernel_wend
    s_waitcnt vmcnt(0)
    v_readfirstlane_b32 s30, v87
    s_cmp_lt_u32 s30, 16
    s_cbranch_scc0 L_gok_494
    s_sleep 1
    s_branch L_gw_495
L_rbad_496:
    buffer_load_dwordx4 v[88:91], v112, s[12:15], s39 offen offset:0 sc1
    s_add_u32 s36, s36, 1
    s_cmp_gt_u32 s36, 0x100000
    s_cbranch_scc1 chain_kernel_wend
    s_waitcnt vmcnt(0)
    v_xor_b32 v124, s7, v88
    v_bitop3_b32 v124, v124, v89, s7 bitop3:0xf6
    v_bitop3_b32 v124, v124, v90, s7 bitop3:0xf6
    v_bitop3_b32 v124, v124, v91, s7 bitop3:0xf6
    v_and_b32 v124, 1, v124
    v_cmp_ne_u32 vcc, 0, v124
    s_cbranch_vccnz L_rbad_496
    s_branch L_rok_497
L_gw_499:
    buffer_load_dword v87, v4, s[12:15], s51 offen sc1
    s_add_u32 s36, s36, 1
    s_cmp_gt_u32 s36, 0x100000
    s_cbranch_scc1 chain_kernel_wend
    s_waitcnt vmcnt(0)
    v_readfirstlane_b32 s30, v87
    s_cmp_lt_u32 s30, 16
    s_cbranch_scc0 L_gok_498
    s_sleep 1
    s_branch L_gw_499
L_rbad_500:
    buffer_load_dwordx4 v[88:91], v112, s[12:15], s39 offen offset:0 sc1
    s_add_u32 s36, s36, 1
    s_cmp_gt_u32 s36, 0x100000
    s_cbranch_scc1 chain_kernel_wend
    s_waitcnt vmcnt(0)
    v_xor_b32 v124, s7, v88
    v_bitop3_b32 v124, v124, v89, s7 bitop3:0xf6
    v_bitop3_b32 v124, v124, v90, s7 bitop3:0xf6
    v_bitop3_b32 v124, v124, v91, s7 bitop3:0xf6
    v_and_b32 v124, 1, v124
    v_cmp_ne_u32 vcc, 0, v124
    s_cbranch_vccnz L_rbad_500
    s_branch L_rok_501
L_rbad_502:
    buffer_load_dwordx4 v[88:91], v112, s[12:15], s39 offen offset:0 sc1
    s_add_u32 s36, s36, 1
    s_cmp_gt_u32 s36, 0x100000
    s_cbranch_scc1 chain_kernel_wend
    s_waitcnt vmcnt(0)
    v_xor_b32 v124, s7, v88
    v_bitop3_b32 v124, v124, v89, s7 bitop3:0xf6
    v_bitop3_b32 v124, v124, v90, s7 bitop3:0xf6
    v_bitop3_b32 v124, v124, v91, s7 bitop3:0xf6
    v_and_b32 v124, 1, v124
    v_cmp_ne_u32 vcc, 0, v124
    s_cbranch_vccnz L_rbad_502
    s_branch L_rok_503
L_fl0_488:
    s_waitcnt lgkmcnt(0)
    s_nop 7
    s_sub_u32 s38, s22, 1
    s_and_b32 s31, s38, 3
    s_lshl_b32 s31, s31, 11
    s_bfe_u32 s38, s38, 0x10002
    s_xor_b32 s38, s38, 1
    s_cmp_eq_u32 s37, 0
    s_cselect_b32 s31, 0x40000000, s31
    s_cselect_b32 s38, 0, s38
    v_cvt_pk_bf16_f32 v104, v60, v64
    v_cvt_pk_bf16_f32 v105, v61, v65
    v_cvt_pk_bf16_f32 v106, v62, v66
    v_cvt_pk_bf16_f32 v107, v63, v67
    v_and_or_b32 v104, v104, -2, s38
    v_and_or_b32 v105, v105, -2, s38
    v_and_or_b32 v106, v106, -2, s38
    v_and_or_b32 v107, v107, -2, s38
    s_add_u32 s29, s45, s31
    buffer_store_dwordx4 v[104:107], v112, s[12:15], s29 offen offset:0 sc1
    buffer_load_dword v132, v136, s[32:35], s42 offen offset:0
    buffer_load_dword v133, v136, s[32:35], s42 offen offset:2048
    buffer_load_dword v134, v137, s[32:35], s42 offen offset:0
    buffer_load_dword v135, v137, s[32:35], s42 offen offset:2048
    s_waitcnt vmcnt(0)
    v_xor_b32 v124, s7, v88
    v_bitop3_b32 v124, v124, v89, s7 bitop3:0xf6
    v_bitop3_b32 v124, v124, v90, s7 bitop3:0xf6
    v_bitop3_b32 v124, v124, v91, s7 bitop3:0xf6
    v_and_b32 v124, 1, v124
    v_cmp_ne_u32 vcc, 0, v124
    s_nop 0
    s_nop 0
    s_nop 0
    s_cbranch_vccnz L_rbad_504
L_rok_505:
    v_lshlrev_b32 v124, 16, v88
    v_and_b32 v125, 0xffff0000, v88
    v_add_f32 v96, v116, v124
    v_add_f32 v97, v117, v125
    v_lshlrev_b32 v124, 16, v89
    v_and_b32 v125, 0xffff0000, v89
    v_add_f32 v98, v118, v124
    v_add_f32 v99, v119, v125
    v_lshlrev_b32 v124, 16, v90
    v_and_b32 v125, 0xffff0000, v90
    v_add_f32 v100, v120, v124
    v_add_f32 v101, v121, v125
    v_lshlrev_b32 v124, 16, v91
    v_and_b32 v125, 0xffff0000, v91
    v_add_f32 v102, v122, v124
    v_add_f32 v103, v123, v125
    s_waitcnt vmcnt(0)
    v_lshlrev_b32 v130, 16, v132
    v_and_b32 v131, 0xffff0000, v132
    v_mul_f32 v130, v130, v128
    v_mul_f32 v131, v131, v129
    v_cvt_pk_bf16_f32 v130, 0, v130
    v_cvt_pk_bf16_f32 v131, 0, v131
    v_add_f32 v96, v96, v130
    v_add_f32 v97, v97, v131
    buffer_store_dwordx2 v[96:97], v140, s[16:19], s43 offen
    v_lshlrev_b32 v130, 16, v133
    v_and_b32 v131, 0xffff0000, v133
    v_mul_f32 v130, v130, v128
    v_mul_f32 v131, v131, v129
    v_cvt_pk_bf16_f32 v130, 0, v130
    v_cvt_pk_bf16_f32 v131, 0, v131
    v_add_f32 v98, v98, v130
    v_add_f32 v99, v99, v131
    buffer_store_dwordx2 v[98:99], v141, s[16:19], s43 offen
    v_lshlrev_b32 v130, 16, v134
    v_and_b32 v131, 0xffff0000, v134
    v_mul_f32 v130, v130, v128
    v_mul_f32 v131, v131, v129
    v_cvt_pk_bf16_f32 v130, 0, v130
    v_cvt_pk_bf16_f32 v131, 0, v131
    v_add_f32 v100, v100, v130
    v_add_f32 v101, v101, v131
    buffer_store_dwordx2 v[100:101], v142, s[16:19], s43 offen
    v_lshlrev_b32 v130, 16, v135
    v_and_b32 v131, 0xffff0000, v135
    v_mul_f32 v130, v130, v128
    v_mul_f32 v131, v131, v129
    v_cvt_pk_bf16_f32 v130, 0, v130
    v_cvt_pk_bf16_f32 v131, 0, v131
    v_add_f32 v102, v102, v130
    v_add_f32 v103, v103, v131
    buffer_store_dwordx2 v[102:103], v143, s[16:19], s43 offen
    v_mov_b32 v116, v52
    v_mov_b32 v117, v56
    v_mov_b32 v118, v53
    v_mov_b32 v119, v57
    v_mov_b32 v120, v54
    v_mov_b32 v121, v58
    v_mov_b32 v122, v55
    v_mov_b32 v123, v59
    s_mov_b32 s7, s38
    s_add_u32 s39, s44, s31
    s_sub_u32 s43, s22, 1
    s_lshl_b32 s42, s43, 16
    s_lshl_b32 s43, s43, 18
    s_cmp_eq_u32 s37, 0
    s_cselect_b32 s42, 0x7ff00000, s42
    s_cselect_b32 s43, 0x7ff00000, s43
    buffer_load_dwordx4 v[88:91], v112, s[12:15], s39 offen offset:0 sc1
    s_mov_b32 s37, 1
    buffer_load_dword v132, v136, s[32:35], s42 offen offset:0
    buffer_load_dword v133, v136, s[32:35], s42 offen offset:2048
    buffer_load_dword v134, v137, s[32:35], s42 offen offset:0
    buffer_load_dword v135, v137, s[32:35], s42 offen offset:2048
    s_waitcnt vmcnt(0)
    v_xor_b32 v124, s7, v88
    v_bitop3_b32 v124, v124, v89, s7 bitop3:0xf6
    v_bitop3_b32 v124, v124, v90, s7 bitop3:0xf6
    v_bitop3_b32 v124, v124, v91, s7 bitop3:0xf6
    v_and_b32 v124, 1, v124
    v_cmp_ne_u32 vcc, 0, v124
    s_nop 0
    s_nop 0
    s_nop 0
    s_cbranch_vccnz L_rbad_506
L_rok_507:
    v_lshlrev_b32 v124, 16, v88
    v_and_b32 v125, 0xffff0000, v88
    v_add_f32 v96, v116, v124
    v_add_f32 v97, v117, v125
    v_lshlrev_b32 v124, 16, v89
    v_and_b32 v125, 0xffff0000, v89
    v_add_f32 v98, v118, v124
    v_add_f32 v99, v119, v125
    v_lshlrev_b32 v124, 16, v90
    v_and_b32 v125, 0xffff0000, v90
    v_add_f32 v100, v120, v124
    v_add_f32 v101, v121, v125
    v_lshlrev_b32 v124, 16, v91
    v_and_b32 v125, 0xffff0000, v91
    v_add_f32 v102, v122, v124
    v_add_f32 v103, v123, v125
    s_waitcnt vmcnt(0)
    v_lshlrev_b32 v130, 16, v132
    v_and_b32 v131, 0xffff0000, v132
    v_mul_f32 v130, v130, v128
    v_mul_f32 v131, v131, v129
    v_cvt_pk_bf16_f32 v130, 0, v130
    v_cvt_pk_bf16_f32 v131, 0, v131
    v_add_f32 v96, v96, v130
    v_add_f32 v97, v97, v131
    buffer_store_dwordx2 v[96:97], v140, s[16:19], s43 offen
    v_lshlrev_b32 v130, 16, v133
    v_and_b32 v131, 0xffff0000, v133
    v_mul_f32 v130, v130, v128
    v_mul_f32 v131, v131, v129
    v_cvt_pk_bf16_f32 v130, 0, v130
    v_cvt_pk_bf16_f32 v131, 0, v131
    v_add_f32 v98, v98, v130
    v_add_f32 v99, v99, v131
    buffer_store_dwordx2 v[98:99], v141, s[16:19], s43 offen
    v_lshlrev_b32 v130, 16, v134
    v_and_b32 v131, 0xffff0000, v134
    v_mul_f32 v130, v130, v128
    v_mul_f32 v131, v131, v129
    v_cvt_pk_bf16_f32 v130, 0, v130
    v_cvt_pk_bf16_f32 v131, 0, v131
    v_add_f32 v100, v100, v130
    v_add_f32 v101, v101, v131
    buffer_store_dwordx2 v[100:101], v142, s[16:19], s43 offen
    v_lshlrev_b32 v130, 16, v135
    v_and_b32 v131, 0xffff0000, v135
    v_mul_f32 v130, v130, v128
    v_mul_f32 v131, v131, v129
    v_cvt_pk_bf16_f32 v130, 0, v130
    v_cvt_pk_bf16_f32 v131, 0, v131
    v_add_f32 v102, v102, v130
    v_add_f32 v103, v103, v131
    buffer_store_dwordx2 v[102:103], v143, s[16:19], s43 offen
    s_branch L_ste_490
L_rbad_504:
    buffer_load_dwordx4 v[88:91], v112, s[12:15], s39 offen offset:0 sc1
    s_add_u32 s36, s36, 1
    s_cmp_gt_u32 s36, 0x100000
    s_cbranch_scc1 chain_kernel_wend
    s_waitcnt vmcnt(0)
    v_xor_b32 v124, s7, v88
    v_bitop3_b32 v124, v124, v89, s7 bitop3:0xf6
    v_bitop3_b32 v124, v124, v90, s7 bitop3:0xf6
    v_bitop3_b32 v124, v124, v91, s7 bitop3:0xf6
    v_and_b32 v124, 1, v124
    v_cmp_ne_u32 vcc, 0, v124
    s_cbranch_vccnz L_rbad_504
    s_branch L_rok_505
L_rbad_506:
    buffer_load_dwordx4 v[88:91], v112, s[12:15], s39 offen offset:0 sc1
    s_add_u32 s36, s36, 1
    s_cmp_gt_u32 s36, 0x100000
    s_cbranch_scc1 chain_kernel_wend
    s_waitcnt vmcnt(0)
    v_xor_b32 v124, s7, v88
    v_bitop3_b32 v124, v124, v89, s7 bitop3:0xf6
    v_bitop3_b32 v124, v124, v90, s7 bitop3:0xf6
    v_bitop3_b32 v124, v124, v91, s7 bitop3:0xf6
    v_and_b32 v124, 1, v124
    v_cmp_ne_u32 vcc, 0, v124
    s_cbranch_vccnz L_rbad_506
    s_branch L_rok_507
L_ste_490:
L_op_435:
    s_mov_b32 s38, s41
    s_and_b32 s39, s38, 3
    s_lshr_b32 s42, s38, 2
    s_lshl_b32 s44, s40, 5
    s_add_u32 s44, s44, s38
    s_lshl_b32 s44, s44, 15
    s_lshl_b32 s25, s49, 13
    s_add_u32 s44, s44, s25
    s_xor_b32 s45, s44, 0x8000
    s_add_u32 s45, s45, 0x6900000
    s_xor_b32 s46, s44, 0x10000
    s_add_u32 s46, s46, 0x6900000
    s_xor_b32 s47, s44, 0x18000
    s_add_u32 s47, s47, 0x6900000
    s_add_u32 s44, s44, 0x6900000
    s_lshl_b32 s48, s40, 3
    s_lshr_b32 s25, s38, 2
    s_add_u32 s48, s48, s25
    s_lshl_b32 s94, s48, 8
    s_add_u32 s94, s94, 0x590d800
    s_lshl_b32 s95, s42, 7
    s_add_u32 s95, s95, 0x590d400
    s_cmp_eq_u32 s39, 0
    s_cselect_b32 s95, s95, 0x40000000
    s_cselect_b32 s60, s94, 0x40000000
    s_lshl_b32 s48, s48, 7
    s_add_u32 s48, s48, 0x590c000
    s_mov_b32 s16, s92
    s_and_b32 s17, s93, 0xffff
    s_mov_b32 s18, 0x800000
    s_mov_b32 s19, 0x00020000
    s_lshl_b32 s50, s39, 21
    s_lshl_b32 s25, s42, 8
    s_add_u32 s50, s50, s25
    v_mov_b32 v104, 0
    v_mov_b32 v105, 0
    v_mov_b32 v106, 0
    v_mov_b32 v107, 0
    v_and_b32 v2, 63, v0
    v_lshlrev_b32 v3, 4, v2
    v_lshlrev_b32 v112, 3, v2
    s_add_u32 s28, s44, 0
    buffer_store_dwordx4 v[104:107], v3, s[12:15], s28 offen sc1
    s_add_u32 s28, s44, 1024
    buffer_store_dwordx4 v[104:107], v3, s[12:15], s28 offen sc1
    s_add_u32 s28, s44, 2048
    buffer_store_dwordx4 v[104:107], v3, s[12:15], s28 offen sc1
    s_add_u32 s28, s44, 3072
    buffer_store_dwordx4 v[104:107], v3, s[12:15], s28 offen sc1
    s_add_u32 s28, s44, 4096
    buffer_store_dwordx4 v[104:107], v3, s[12:15], s28 offen sc1
    s_add_u32 s28, s44, 5120
    buffer_store_dwordx4 v[104:107], v3, s[12:15], s28 offen sc1
    s_add_u32 s28, s44, 6144
    buffer_store_dwordx4 v[104:107], v3, s[12:15], s28 offen sc1
    s_add_u32 s28, s44, 7168
    buffer_store_dwordx4 v[104:107], v3, s[12:15], s28 offen sc1
    v_lshrrev_b32 v1, 6, v0
    v_lshlrev_b32 v1, 11, v1
    v_add_u32 v1, 0x21000, v1
    v_add_u32 v113, v1, v3
    v_and_b32 v2, 15, v0
    v_lshl_add_u32 v1, v2, 2, v1
    v_bfe_u32 v2, v0, 4, 2
    v_lshl_add_u32 v114, v2, 7, v1
    v_and_b32 v1, 15, v0
    v_bfe_u32 v2, v0, 4, 2
    v_lshrrev_b32 v3, 6, v0
    v_lshlrev_b32 v4, 2, v2
    v_xor_b32 v4, v4, v1
    v_lshlrev_b32 v4, 4, v4
    v_lshl_add_u32 v5, v3, 5, v2
    s_mov_b32 s25, 2048
    v_mul_lo_u32 v5, v5, s25
    v_add_u32 v20, v5, v4
    v_bfe_u32 v4, v0, 2, 2
    v_lshl_add_u32 v5, v2, 3, v4
    v_lshlrev_b32 v5, 8, v5
    v_xor_b32 v4, v4, v3
    v_lshl_add_u32 v5, v4, 6, v5
    v_and_b32 v4, 3, v0
    v_lshl_add_u32 v5, v4, 3, v5
    v_mov_b32 v21, v5
    v_add_u32 v22, 32, v21
    v_add_u32 v23, 0x10000, v21
    v_add_u32 v24, 0x10000, v22
    s_lshl_b32 s26, s49, 13
    s_mov_b32 s25, s50
    s_barrier
    s_add_u32 m0, s26, 0
    s_add_u32 s27, s25, 0
    buffer_load_dwordx4 v20, s[16:19], s27 offen lds
    s_add_u32 m0, s26, 1024
    s_add_u32 s27, s25, 8192
    buffer_load_dwordx4 v20, s[16:19], s27 offen lds
    s_add_u32 m0, s26, 2048
    s_add_u32 s27, s25, 16384
    buffer_load_dwordx4 v20, s[16:19], s27 offen lds
    s_add_u32 m0, s26, 3072
    s_add_u32 s27, s25, 24576
    buffer_load_dwordx4 v20, s[16:19], s27 offen lds
    s_add_u32 m0, s26, 4096
    s_add_u32 s27, s25, 32768
    buffer_load_dwordx4 v20, s[16:19], s27 offen lds
    s_add_u32 m0, s26, 5120
    s_add_u32 s27, s25, 40960
    buffer_load_dwordx4 v20, s[16:19], s27 offen lds
    s_add_u32 m0, s26, 6144
    s_add_u32 s27, s25, 49152
    buffer_load_dwordx4 v20, s[16:19], s27 offen lds
    s_add_u32 m0, s26, 7168
    s_add_u32 s27, s25, 57344
    buffer_load_dwordx4 v20, s[16:19], s27 offen lds
    s_add_u32 m0, s26, 32768
    s_add_u32 s27, s25, 262144
    buffer_load_dwordx4 v20, s[16:19], s27 offen lds
    s_add_u32 m0, s26, 33792
    s_add_u32 s27, s25, 270336
    buffer_load_dwordx4 v20, s[16:19], s27 offen lds
    s_add_u32 m0, s26, 34816
    s_add_u32 s27, s25, 278528
    buffer_load_dwordx4 v20, s[16:19], s27 offen lds
    s_add_u32 m0, s26, 35840
    s_add_u32 s27, s25, 286720
    buffer_load_dwordx4 v20, s[16:19], s27 offen lds
    s_add_u32 m0, s26, 36864
    s_add_u32 s27, s25, 294912
    buffer_load_dwordx4 v20, s[16:19], s27 offen lds
    s_add_u32 m0, s26, 37888
    s_add_u32 s27, s25, 303104
    buffer_load_dwordx4 v20, s[16:19], s27 offen lds
    s_add_u32 m0, s26, 38912
    s_add_u32 s27, s25, 311296
    buffer_load_dwordx4 v20, s[16:19], s27 offen lds
    s_add_u32 m0, s26, 39936
    s_add_u32 s27, s25, 319488
    buffer_load_dwordx4 v20, s[16:19], s27 offen lds
    s_add_u32 m0, s26, 65536
    s_add_u32 s27, s25, 524288
    buffer_load_dwordx4 v20, s[16:19], s27 offen lds
    s_add_u32 m0, s26, 66560
    s_add_u32 s27, s25, 532480
    buffer_load_dwordx4 v20, s[16:19], s27 offen lds
    s_add_u32 m0, s26, 67584
    s_add_u32 s27, s25, 540672
    buffer_load_dwordx4 v20, s[16:19], s27 offen lds
    s_add_u32 m0, s26, 68608
    s_add_u32 s27, s25, 548864
    buffer_load_dwordx4 v20, s[16:19], s27 offen lds
    s_add_u32 m0, s26, 69632
    s_add_u32 s27, s25, 557056
    buffer_load_dwordx4 v20, s[16:19], s27 offen lds
    s_add_u32 m0, s26, 70656
    s_add_u32 s27, s25, 565248
    buffer_load_dwordx4 v20, s[16:19], s27 offen lds
    s_add_u32 m0, s26, 71680
    s_add_u32 s27, s25, 573440
    buffer_load_dwordx4 v20, s[16:19], s27 offen lds
    s_add_u32 m0, s26, 72704
    s_add_u32 s27, s25, 581632
    buffer_load_dwordx4 v20, s[16:19], s27 offen lds
    s_add_u32 m0, s26, 98304
    s_add_u32 s27, s25, 786432
    buffer_load_dwordx4 v20, s[16:19], s27 offen lds
    s_add_u32 m0, s26, 99328
    s_add_u32 s27, s25, 794624
    buffer_load_dwordx4 v20, s[16:19], s27 offen lds
    s_add_u32 m0, s26, 100352
    s_add_u32 s27, s25, 802816
    buffer_load_dwordx4 v20, s[16:19], s27 offen lds
    s_add_u32 m0, s26, 101376
    s_add_u32 s27, s25, 811008
    buffer_load_dwordx4 v20, s[16:19], s27 offen lds
    s_add_u32 m0, s26, 102400
    s_add_u32 s27, s25, 819200
    buffer_load_dwordx4 v20, s[16:19], s27 offen lds
    s_add_u32 m0, s26, 103424
    s_add_u32 s27, s25, 827392
    buffer_load_dwordx4 v20, s[16:19], s27 offen lds
    s_add_u32 m0, s26, 104448
    s_add_u32 s27, s25, 835584
    buffer_load_dwordx4 v20, s[16:19], s27 offen lds
    s_add_u32 m0, s26, 105472
    s_add_u32 s27, s25, 843776
    buffer_load_dwordx4 v20, s[16:19], s27 offen lds
    s_waitcnt vmcnt(24)
    s_barrier
    buffer_atomic_add v84, v85, s[12:15], s48 offen sc1
    ds_read_b64_tr_b16 a[0:1], v21 offset:0
    ds_read_b64_tr_b16 a[2:3], v21 offset:1024
    ds_read_b64_tr_b16 a[4:5], v22 offset:0
    ds_read_b64_tr_b16 a[6:7], v22 offset:1024
    ds_read_b64_tr_b16 a[8:9], v21 offset:8192
    ds_read_b64_tr_b16 a[10:11], v21 offset:9216
    ds_read_b64_tr_b16 a[12:13], v22 offset:8192
    ds_read_b64_tr_b16 a[14:15], v22 offset:9216
    s_waitcnt lgkmcnt(0)
    ds_read_b64_tr_b16 a[16:17], v21 offset:16384
    ds_read_b64_tr_b16 a[18:19], v21 offset:17408
    ds_read_b64_tr_b16 a[20:21], v22 offset:16384
    ds_read_b64_tr_b16 a[22:23], v22 offset:17408
    ds_read_b64_tr_b16 a[24:25], v21 offset:24576
    ds_read_b64_tr_b16 a[26:27], v21 offset:25600
    ds_read_b64_tr_b16 a[28:29], v22 offset:24576
    ds_read_b64_tr_b16 a[30:31], v22 offset:25600
    s_waitcnt lgkmcnt(0)
    s_barrier
    s_add_u32 m0, s26, 0
    s_add_u32 s27, s25, 1048576
    buffer_load_dwordx4 v20, s[16:19], s27 offen lds
    s_add_u32 m0, s26, 1024
    s_add_u32 s27, s25, 1056768
    buffer_load_dwordx4 v20, s[16:19], s27 offen lds
    s_add_u32 m0, s26, 2048
    s_add_u32 s27, s25, 1064960
    buffer_load_dwordx4 v20, s[16:19], s27 offen lds
    s_add_u32 m0, s26, 3072
    s_add_u32 s27, s25, 1073152
    buffer_load_dwordx4 v20, s[16:19], s27 offen lds
    s_add_u32 m0, s26, 4096
    s_add_u32 s27, s25, 1081344
    buffer_load_dwordx4 v20, s[16:19], s27 offen lds
    s_add_u32 m0, s26, 5120
    s_add_u32 s27, s25, 1089536
    buffer_load_dwordx4 v20, s[16:19], s27 offen lds
    s_add_u32 m0, s26, 6144
    s_add_u32 s27, s25, 1097728
    buffer_load_dwordx4 v20, s[16:19], s27 offen lds
    s_add_u32 m0, s26, 7168
    s_add_u32 s27, s25, 1105920
    buffer_load_dwordx4 v20, s[16:19], s27 offen lds
    s_waitcnt vmcnt(24)
    s_barrier
    ds_read_b64_tr_b16 a[32:33], v21 offset:32768
    ds_read_b64_tr_b16 a[34:35], v21 offset:33792
    ds_read_b64_tr_b16 a[36:37], v22 offset:32768
    ds_read_b64_tr_b16 a[38:39], v22 offset:33792
    ds_read_b64_tr_b16 a[40:41], v21 offset:40960
    ds_read_b64_tr_b16 a[42:43], v21 offset:41984
    ds_read_b64_tr_b16 a[44:45], v22 offset:40960
    ds_read_b64_tr_b16 a[46:47], v22 offset:41984
    s_waitcnt lgkmcnt(0)
    ds_read_b64_tr_b16 a[48:49], v21 offset:49152
    ds_read_b64_tr_b16 a[50:51], v21 offset:50176
    ds_read_b64_tr_b16 a[52:53], v22 offset:49152
    ds_read_b64_tr_b16 a[54:55], v22 offset:50176
    ds_read_b64_tr_b16 a[56:57], v21 offset:57344
    ds_read_b64_tr_b16 a[58:59], v21 offset:58368
    ds_read_b64_tr_b16 a[60:61], v22 offset:57344
    ds_read_b64_tr_b16 a[62:63], v22 offset:58368
    s_waitcnt lgkmcnt(0)
    s_barrier
    s_add_u32 m0, s26, 32768
    s_add_u32 s27, s25, 1310720
    buffer_load_dwordx4 v20, s[16:19], s27 offen lds
    s_add_u32 m0, s26, 33792
    s_add_u32 s27, s25, 1318912
    buffer_load_dwordx4 v20, s[16:19], s27 offen lds
    s_add_u32 m0, s26, 34816
    s_add_u32 s27, s25, 1327104
    buffer_load_dwordx4 v20, s[16:19], s27 offen lds
    s_add_u32 m0, s26, 35840
    s_add_u32 s27, s25, 1335296
    buffer_load_dwordx4 v20, s[16:19], s27 offen lds
    s_add_u32 m0, s26, 36864
    s_add_u32 s27, s25, 1343488
    buffer_load_dwordx4 v20, s[16:19], s27 offen lds
    s_add_u32 m0, s26, 37888
    s_add_u32 s27, s25, 1351680
    buffer_load_dwordx4 v20, s[16:19], s27 offen lds
    s_add_u32 m0, s26, 38912
    s_add_u32 s27, s25, 1359872
    buffer_load_dwordx4 v20, s[16:19], s27 offen lds
    s_add_u32 m0, s26, 39936
    s_add_u32 s27, s25, 1368064
    buffer_load_dwordx4 v20, s[16:19], s27 offen lds
    s_waitcnt vmcnt(24)
    s_barrier
    ds_read_b64_tr_b16 a[64:65], v23 offset:0
    ds_read_b64_tr_b16 a[66:67], v23 offset:1024
    ds_read_b64_tr_b16 a[68:69], v24 offset:0
    ds_read_b64_tr_b16 a[70:71], v24 offset:1024
    ds_read_b64_tr_b16 a[72:73], v23 offset:8192
    ds_read_b64_tr_b16 a[74:75], v23 offset:9216
    ds_read_b64_tr_b16 a[76:77], v24 offset:8192
    ds_read_b64_tr_b16 a[78:79], v24 offset:9216
    s_waitcnt lgkmcnt(0)
    ds_read_b64_tr_b16 a[80:81], v23 offset:16384
    ds_read_b64_tr_b16 a[82:83], v23 offset:17408
    ds_read_b64_tr_b16 a[84:85], v24 offset:16384
    ds_read_b64_tr_b16 a[86:87], v24 offset:17408
    ds_read_b64_tr_b16 a[88:89], v23 offset:24576
    ds_read_b64_tr_b16 a[90:91], v23 offset:25600
    ds_read_b64_tr_b16 a[92:93], v24 offset:24576
    ds_read_b64_tr_b16 a[94:95], v24 offset:25600
    s_waitcnt lgkmcnt(0)
    s_barrier
    s_add_u32 m0, s26, 65536
    s_add_u32 s27, s25, 1572864
    buffer_load_dwordx4 v20, s[16:19], s27 offen lds
    s_add_u32 m0, s26, 66560
    s_add_u32 s27, s25, 1581056
    buffer_load_dwordx4 v20, s[16:19], s27 offen lds
    s_add_u32 m0, s26, 67584
    s_add_u32 s27, s25, 1589248
    buffer_load_dwordx4 v20, s[16:19], s27 offen lds
    s_add_u32 m0, s26, 68608
    s_add_u32 s27, s25, 1597440
    buffer_load_dwordx4 v20, s[16:19], s27 offen lds
    s_add_u32 m0, s26, 69632
    s_add_u32 s27, s25, 1605632
    buffer_load_dwordx4 v20, s[16:19], s27 offen lds
    s_add_u32 m0, s26, 70656
    s_add_u32 s27, s25, 1613824
    buffer_load_dwordx4 v20, s[16:19], s27 offen lds
    s_add_u32 m0, s26, 71680
    s_add_u32 s27, s25, 1622016
    buffer_load_dwordx4 v20, s[16:19], s27 offen lds
    s_add_u32 m0, s26, 72704
    s_add_u32 s27, s25, 1630208
    buffer_load_dwordx4 v20, s[16:19], s27 offen lds
    s_waitcnt vmcnt(24)
    s_barrier
    ds_read_b64_tr_b16 a[96:97], v23 offset:32768
    ds_read_b64_tr_b16 a[98:99], v23 offset:33792
    ds_read_b64_tr_b16 a[100:101], v24 offset:32768
    ds_read_b64_tr_b16 a[102:103], v24 offset:33792
    ds_read_b64_tr_b16 a[104:105], v23 offset:40960
    ds_read_b64_tr_b16 a[106:107], v23 offset:41984
    ds_read_b64_tr_b16 a[108:109], v24 offset:40960
    ds_read_b64_tr_b16 a[110:111], v24 offset:41984
    s_waitcnt lgkmcnt(0)
    ds_read_b64_tr_b16 a[112:113], v23 offset:49152
    ds_read_b64_tr_b16 a[114:115], v23 offset:50176
    ds_read_b64_tr_b16 a[116:117], v24 offset:49152
    ds_read_b64_tr_b16 a[118:119], v24 offset:50176
    ds_read_b64_tr_b16 a[120:121], v23 offset:57344
    ds_read_b64_tr_b16 a[122:123], v23 offset:58368
    ds_read_b64_tr_b16 a[124:125], v24 offset:57344
    ds_read_b64_tr_b16 a[126:127], v24 offset:58368
    s_waitcnt lgkmcnt(0)
    s_barrier
    s_add_u32 m0, s26, 98304
    s_add_u32 s27, s25, 1835008
    buffer_load_dwordx4 v20, s[16:19], s27 offen lds
    s_add_u32 m0, s26, 99328
    s_add_u32 s27, s25, 1843200
    buffer_load_dwordx4 v20, s[16:19], s27 offen lds
    s_add_u32 m0, s26, 100352
    s_add_u32 s27, s25, 1851392
    buffer_load_dwordx4 v20, s[16:19], s27 offen lds
    s_add_u32 m0, s26, 101376
    s_add_u32 s27, s25, 1859584
    buffer_load_dwordx4 v20, s[16:19], s27 offen lds
    s_add_u32 m0, s26, 102400
    s_add_u32 s27, s25, 1867776
    buffer_load_dwordx4 v20, s[16:19], s27 offen lds
    s_add_u32 m0, s26, 103424
    s_add_u32 s27, s25, 1875968
    buffer_load_dwordx4 v20, s[16:19], s27 offen lds
    s_add_u32 m0, s26, 104448
    s_add_u32 s27, s25, 1884160
    buffer_load_dwordx4 v20, s[16:19], s27 offen lds
    s_add_u32 m0, s26, 105472
    s_add_u32 s27, s25, 1892352
    buffer_load_dwordx4 v20, s[16:19], s27 offen lds
    s_waitcnt vmcnt(24)
    s_barrier
    ds_read_b64_tr_b16 a[128:129], v21 offset:0
    ds_read_b64_tr_b16 a[130:131], v21 offset:1024
    ds_read_b64_tr_b16 a[132:133], v22 offset:0
    ds_read_b64_tr_b16 a[134:135], v22 offset:1024
    ds_read_b64_tr_b16 a[136:137], v21 offset:8192
    ds_read_b64_tr_b16 a[138:139], v21 offset:9216
    ds_read_b64_tr_b16 a[140:141], v22 offset:8192
    ds_read_b64_tr_b16 a[142:143], v22 offset:9216
    s_waitcnt lgkmcnt(0)
    ds_read_b64_tr_b16 a[144:145], v21 offset:16384
    ds_read_b64_tr_b16 a[146:147], v21 offset:17408
    ds_read_b64_tr_b16 a[148:149], v22 offset:16384
    ds_read_b64_tr_b16 a[150:151], v22 offset:17408
    ds_read_b64_tr_b16 a[152:153], v21 offset:24576
    ds_read_b64_tr_b16 a[154:155], v21 offset:25600
    ds_read_b64_tr_b16 a[156:157], v22 offset:24576
    ds_read_b64_tr_b16 a[158:159], v22 offset:25600
    s_waitcnt lgkmcnt(0)
    s_waitcnt vmcnt(16)
    s_barrier
    ds_read_b64_tr_b16 a[160:161], v21 offset:32768
    ds_read_b64_tr_b16 a[162:163], v21 offset:33792
    ds_read_b64_tr_b16 a[164:165], v22 offset:32768
    ds_read_b64_tr_b16 a[166:167], v22 offset:33792
    ds_read_b64_tr_b16 a[168:169], v21 offset:40960
    ds_read_b64_tr_b16 a[170:171], v21 offset:41984
    ds_read_b64_tr_b16 a[172:173], v22 offset:40960
    ds_read_b64_tr_b16 a[174:175], v22 offset:41984
    s_waitcnt lgkmcnt(0)
    ds_read_b64_tr_b16 a[176:177], v21 offset:49152
    ds_read_b64_tr_b16 a[178:179], v21 offset:50176
    ds_read_b64_tr_b16 a[180:181], v22 offset:49152
    ds_read_b64_tr_b16 a[182:183], v22 offset:50176
    ds_read_b64_tr_b16 a[184:185], v21 offset:57344
    ds_read_b64_tr_b16 a[186:187], v21 offset:58368
    ds_read_b64_tr_b16 a[188:189], v22 offset:57344
    ds_read_b64_tr_b16 a[190:191], v22 offset:58368
    s_waitcnt lgkmcnt(0)
    s_waitcnt vmcnt(8)
    s_barrier
    ds_read_b64_tr_b16 a[192:193], v23 offset:0
    ds_read_b64_tr_b16 a[194:195], v23 offset:1024
    ds_read_b64_tr_b16 a[196:197], v24 offset:0
    ds_read_b64_tr_b16 a[198:199], v24 offset:1024
    ds_read_b64_tr_b16 a[200:201], v23 offset:8192
    ds_read_b64_tr_b16 a[202:203], v23 offset:9216
    ds_read_b64_tr_b16 a[204:205], v24 offset:8192
    ds_read_b64_tr_b16 a[206:207], v24 offset:9216
    s_waitcnt lgkmcnt(0)
    ds_read_b64_tr_b16 a[208:209], v23 offset:16384
    ds_read_b64_tr_b16 a[210:211], v23 offset:17408
    ds_read_b64_tr_b16 a[212:213], v24 offset:16384
    ds_read_b64_tr_b16 a[214:215], v24 offset:17408
    ds_read_b64_tr_b16 a[216:217], v23 offset:24576
    ds_read_b64_tr_b16 a[218:219], v23 offset:25600
    ds_read_b64_tr_b16 a[220:221], v24 offset:24576
    ds_read_b64_tr_b16 a[222:223], v24 offset:25600
    s_waitcnt lgkmcnt(0)
    s_waitcnt vmcnt(0)
    s_barrier
    ds_read_b64_tr_b16 a[224:225], v23 offset:32768
    ds_read_b64_tr_b16 a[226:227], v23 offset:33792
    ds_read_b64_tr_b16 a[228:229], v24 offset:32768
    ds_read_b64_tr_b16 a[230:231], v24 offset:33792
    ds_read_b64_tr_b16 a[232:233], v23 offset:40960
    ds_read_b64_tr_b16 a[234:235], v23 offset:41984
    ds_read_b64_tr_b16 a[236:237], v24 offset:40960
    ds_read_b64_tr_b16 a[238:239], v24 offset:41984
    s_waitcnt lgkmcnt(0)
    ds_read_b64_tr_b16 a[240:241], v23 offset:49152
    ds_read_b64_tr_b16 a[242:243], v23 offset:50176
    ds_read_b64_tr_b16 a[244:245], v24 offset:49152
    ds_read_b64_tr_b16 a[246:247], v24 offset:50176
    ds_read_b64_tr_b16 a[248:249], v23 offset:57344
    ds_read_b64_tr_b16 a[250:251], v23 offset:58368
    ds_read_b64_tr_b16 a[252:253], v24 offset:57344
    ds_read_b64_tr_b16 a[254:255], v24 offset:58368
    s_waitcnt lgkmcnt(0)
    v_mov_b32 v2, 0
L_pl_508:
    buffer_load_dword v1, v2, s[12:15], s48 offen sc1
    s_add_u32 s36, s36, 1
    s_cmp_gt_u32 s36, 0x100000
    s_cbranch_scc1 chain_kernel_wend
    s_waitcnt vmcnt(0)
    v_readfirstlane_b32 s26, v1
    s_cmp_ge_u32 s26, 4
    s_cbranch_scc1 L_plok_509
    s_sleep 4
    s_branch L_pl_508
L_plok_509:
    s_lshl_b32 s25, s42, 9
    s_lshl_b32 s26, s49, 7
    s_add_u32 s25, s25, s26
    s_lshl_b32 s26, s39, 13
    s_add_u32 s25, s25, s26
    s_add_u32 s25, s25, 4096
    v_bfe_u32 v1, v0, 3, 3
    v_and_b32 v2, 7, v0
    v_lshlrev_b32 v1, 15, v1
    v_lshl_add_u32 v1, v2, 4, v1
    v_add_u32 v128, s25, v1
    s_lshl_b32 s48, s39, 7
    s_add_u32 s48, s48, 0x5904000
    s_lshl_b32 s50, s39, 18
    s_add_u32 s50, s50, 2048
    s_mov_b32 s8, s100
    s_and_b32 s9, s101, 0xffff
    s_mov_b32 s10, 0x10000000
    s_mov_b32 s11, 0x00020000
    s_mov_b32 s16, s96
    s_and_b32 s17, s97, 0xffff
    s_mov_b32 s18, 0x1000000
    s_mov_b32 s19, 0x00020000
    s_lshl_b32 s39, s39, 4
    s_lshl_b32 s21, s49, 12
    v_and_b32 v1, 63, v0
    v_and_b32 v2, 15, v0
    v_bfe_u32 v3, v0, 4, 2
    v_lshrrev_b32 v4, 6, v0
    v_lshlrev_b32 v5, 4, v1
    v_lshl_add_u32 v5, v4, 14, v5
    v_add_u32 v8, 0, v5
    v_add_u32 v9, 1024, v5
    v_add_u32 v10, 4096, v5
    v_add_u32 v11, 5120, v5
    v_lshlrev_b32 v5, 4, v2
    v_lshl_add_u32 v5, v3, 9, v5
    v_xor_b32 v12, s39, v5
    v_xor_b32 v13, 0x100, v12
    v_add_u32 v16, 0x10000, v12
    v_add_u32 v17, 0x10000, v13
    v_and_b32 v130, 63, v0
    v_lshlrev_b32 v130, 2, v130
    v_mov_b32 v131, 3
    buffer_atomic_add v131, v85, s[12:15], s95 offen sc0 sc1
    s_waitcnt vmcnt(0)
    v_add_u32 v88, 1, v131
    v_add_u32 v89, 2, v131
    v_add_u32 v90, 3, v131
    buffer_store_dwordx3 v[88:90], v85, s[12:15], s60 offen sc1
    s_mov_b32 s23, 62
    s_mov_b32 s3, 0
L_sw_512:
    buffer_load_dword v129, v130, s[12:15], s94 offen sc1
    s_add_u32 s36, s36, 1
    s_cmp_gt_u32 s36, 0x100000
    s_cbranch_scc1 chain_kernel_wend
    s_waitcnt vmcnt(0)
    v_readlane_b32 s28, v129, s3
    s_cmp_lg_u32 s28, 0
    s_cbranch_scc1 L_sok_511
    s_sleep 1
    s_branch L_sw_512
L_sok_511:
    s_cmp_gt_u32 s28, 64
    s_cselect_b32 s3, s3, 64
    s_min_u32 s23, s23, s3
    s_sub_u32 s61, s23, 1
    s_mov_b32 s3, 1
L_sw_514:
    buffer_load_dword v129, v130, s[12:15], s94 offen sc1
    s_add_u32 s36, s36, 1
    s_cmp_gt_u32 s36, 0x100000
    s_cbranch_scc1 chain_kernel_wend
    s_waitcnt vmcnt(0)
    v_readlane_b32 s28, v129, s3
    s_cmp_lg_u32 s28, 0
    s_cbranch_scc1 L_sok_513
    s_sleep 1
    s_branch L_sw_514
L_sok_513:
    s_cmp_gt_u32 s28, 64
    s_cselect_b32 s3, s3, 64
    s_min_u32 s23, s23, s3
    s_sub_u32 s61, s23, 1
    s_cmp_eq_u32 s23, 0
    s_cbranch_scc1 L_opdone_510
    s_mov_b32 s52, 0
    v_mov_b32 v4, 0
    s_mov_b32 s22, 0
    s_sub_u32 s61, s23, 1
    s_mov_b32 s24, s22
    s_add_u32 s51, s24, 0
    s_min_u32 s51, s51, s61
    v_readlane_b32 s51, v129, s51
    s_nop 0
    s_nop 0
    s_sub_u32 s51, s51, 1
    s_lshl_b32 s51, s51, 9
    s_add_u32 s51, s51, s48
L_gw_516:
    buffer_load_dword v87, v4, s[12:15], s51 offen sc1
    s_add_u32 s36, s36, 1
    s_cmp_gt_u32 s36, 0x100000
    s_cbranch_scc1 chain_kernel_wend
    s_waitcnt vmcnt(0)
    v_readfirstlane_b32 s30, v87
    s_cmp_lt_u32 s30, 8
    s_cbranch_scc0 L_rgo_515
    s_sleep 1
    s_branch L_gw_516
L_rgo_515:
    s_add_u32 s51, s24, 1
    s_min_u32 s51, s51, s61
    v_readlane_b32 s51, v129, s51
    s_nop 0
    s_nop 0
    s_sub_u32 s51, s51, 1
    s_lshl_b32 s51, s51, 9
    s_add_u32 s51, s51, s48
    buffer_load_dword v87, v4, s[12:15], s51 offen sc1
    s_mov_b32 s37, 0
    s_mov_b32 s7, 0
    v_mov_b32 v88, 0
    v_mov_b32 v89, 0
    v_mov_b32 v90, 0
    v_mov_b32 v91, 0
    v_mov_b32 v92, 0
    v_mov_b32 v93, 0
    v_mov_b32 v94, 0
    v_mov_b32 v95, 0
    s_mov_b32 s30, s24
    v_readlane_b32 s30, v129, s30
    s_nop 0
    s_nop 0
    s_sub_u32 s30, s30, 1
    s_bitcmp1_b32 s30, 1
    s_cselect_b32 s53, s54, s55
    s_lshl_b32 s30, s30, 20
    s_add_u32 s53, s53, s30
    s_add_u32 s53, s53, s50
    s_mov_b32 s20, s53
    s_mov_b32 s39, 0x7ff00000
    s_mov_b32 s42, 0x7ff00000
    s_mov_b32 s43, 0x7ff00000
    s_barrier
    s_add_u32 m0, s21, 0
    s_nop 0
    buffer_load_dwordx4 v8, s[8:11], s20 offen lds
    s_add_u32 m0, s21, 1024
    s_nop 0
    buffer_load_dwordx4 v9, s[8:11], s20 offen lds
    s_add_u32 m0, s21, 2048
    s_nop 0
    buffer_load_dwordx4 v10, s[8:11], s20 offen lds
    s_add_u32 m0, s21, 3072
    s_nop 0
    buffer_load_dwordx4 v11, s[8:11], s20 offen lds
    s_add_u32 s20, s20, 65536
    s_add_u32 m0, s21, 16384
    s_nop 0
    buffer_load_dwordx4 v8, s[8:11], s20 offen lds
    s_add_u32 m0, s21, 17408
    s_nop 0
    buffer_load_dwordx4 v9, s[8:11], s20 offen lds
    s_add_u32 m0, s21, 18432
    s_nop 0
    buffer_load_dwordx4 v10, s[8:11], s20 offen lds
    s_add_u32 m0, s21, 19456
    s_nop 0
    buffer_load_dwordx4 v11, s[8:11], s20 offen lds
    s_add_u32 s20, s20, 65536
    s_add_u32 m0, s21, 32768
    s_nop 0
    buffer_load_dwordx4 v8, s[8:11], s20 offen lds
    s_add_u32 m0, s21, 33792
    s_nop 0
    buffer_load_dwordx4 v9, s[8:11], s20 offen lds
    s_add_u32 m0, s21, 34816
    s_nop 0
    buffer_load_dwordx4 v10, s[8:11], s20 offen lds
    s_add_u32 m0, s21, 35840
    s_nop 0
    buffer_load_dwordx4 v11, s[8:11], s20 offen lds
    s_add_u32 s20, s20, 65536
    s_add_u32 m0, s21, 49152
    s_nop 0
    buffer_load_dwordx4 v8, s[8:11], s20 offen lds
    s_waitcnt vmcnt(0)
    s_barrier
    ds_read_b128 v[20:23], v12 offset:0
    ds_read_b128 v[24:27], v13 offset:0
    ds_read_b128 v[28:31], v12 offset:2048
    ds_read_b128 v[32:35], v13 offset:2048
    ds_read_b128 v[36:39], v12 offset:4096
    ds_read_b128 v[40:43], v13 offset:4096
    s_waitcnt lgkmcnt(4)
L_st_520:
    v_mfma_f32_16x16x32_bf16 v[52:55], v[20:23], a[0:3], 0
    ds_read_b128 v[44:47], v12 offset:6144
    s_add_u32 m0, s21, 50176
    s_cmp_lt_u32 s22, 57
    s_cselect_b32 s27, 1, 0
    s_cselect_b32 s26, 1, 0x80
    v_mfma_f32_16x16x32_bf16 v[56:59], v[20:23], a[4:7], 0
    buffer_load_dwordx4 v9, s[8:11], s20 offen lds
    s_sub_u32 s38, s22, 1
    v_mfma_f32_16x16x32_bf16 v[60:63], v[24:27], a[0:3], 0
    ds_read_b128 v[48:51], v13 offset:6144
    s_and_b32 s31, s38, 3
    s_lshl_b32 s31, s31, 11
    v_mfma_f32_16x16x32_bf16 v[64:67], v[24:27], a[4:7], 0
    s_waitcnt lgkmcnt(4)
    s_bfe_u32 s38, s38, 0x10002
    v_mfma_f32_16x16x32_bf16 v[52:55], v[28:31], a[8:11], v[52:55]
    ds_read_b128 v[20:23], v12 offset:8192
    v_mov_b32 v131, s27
    s_xor_b32 s38, s38, 1
    v_mfma_f32_16x16x32_bf16 v[56:59], v[28:31], a[12:15], v[56:59]
    buffer_atomic_add v131, v85, s[12:15], s95 offen sc0 sc1
    v_mfma_f32_16x16x32_bf16 v[60:63], v[32:35], a[8:11], v[60:63]
    ds_read_b128 v[24:27], v13 offset:8192
    s_add_u32 s24, s24, 1
    s_min_u32 s24, s24, s61
    s_cmp_eq_u32 s37, 0
    s_cselect_b32 s31, 0x40000000, s31
    s_cselect_b32 s38, 0, s38
    v_mfma_f32_16x16x32_bf16 v[64:67], v[32:35], a[12:15], v[64:67]
    s_waitcnt lgkmcnt(4)
    s_mov_b32 s30, s24
    v_readlane_b32 s30, v129, s30
    v_mfma_f32_16x16x32_bf16 v[52:55], v[36:39], a[16:19], v[52:55]
    ds_read_b128 v[28:31], v12 offset:10240
    s_add_u32 m0, s21, 51200
    s_nop 0
    v_mfma_f32_16x16x32_bf16 v[56:59], v[36:39], a[20:23], v[56:59]
    buffer_load_dwordx4 v10, s[8:11], s20 offen lds
    v_mfma_f32_16x16x32_bf16 v[60:63], v[40:43], a[16:19], v[60:63]
    ds_read_b128 v[32:35], v13 offset:10240
    s_nop 0
    s_sub_u32 s30, s30, 1
    v_mfma_f32_16x16x32_bf16 v[64:67], v[40:43], a[20:23], v[64:67]
    s_waitcnt lgkmcnt(4)
    s_bitcmp1_b32 s30, 1
    s_cselect_b32 s53, s54, s55
    v_mfma_f32_16x16x32_bf16 v[52:55], v[44:47], a[24:27], v[52:55]
    ds_read_b128 v[36:39], v12 offset:12288
    s_lshl_b32 s30, s30, 20
    v_cvt_pk_bf16_f32 v104, v69, v73
    v_mfma_f32_16x16x32_bf16 v[56:59], v[44:47], a[28:31], v[56:59]
    s_add_u32 s53, s53, s30
    buffer_load_dword v129, v130, s[12:15], s94 offen sc1
    v_mfma_f32_16x16x32_bf16 v[60:63], v[48:51], a[24:27], v[60:63]
    ds_read_b128 v[40:43], v13 offset:12288
    s_add_u32 s53, s53, s50
    s_waitcnt vmcnt(13)
    v_cvt_pk_bf16_f32 v105, v77, v81
    v_mfma_f32_16x16x32_bf16 v[64:67], v[48:51], a[28:31], v[64:67]
    s_waitcnt lgkmcnt(4)
    v_readfirstlane_b32 s30, v87
    s_nop 0
    v_mfma_f32_16x16x32_bf16 v[52:55], v[20:23], a[32:35], v[52:55]
    ds_read_b128 v[44:47], v12 offset:14336
    s_add_u32 m0, s21, 52224
    v_and_or_b32 v104, v104, -2, s38
    v_mfma_f32_16x16x32_bf16 v[56:59], v[20:23], a[36:39], v[56:59]
    buffer_load_dwordx4 v11, s[8:11], s20 offen lds
    s_nop 0
    v_mfma_f32_16x16x32_bf16 v[60:63], v[24:27], a[32:35], v[60:63]
    ds_read_b128 v[48:51], v13 offset:14336
    s_cmp_lt_u32 s30, 8
    s_cbranch_scc1 L_gw_526
L_gok_525:
    v_mfma_f32_16x16x32_bf16 v[64:67], v[24:27], a[36:39], v[64:67]
    s_waitcnt lgkmcnt(4)
    v_and_or_b32 v105, v105, -2, s38
    s_add_u32 s29, s45, s31
    v_mfma_f32_16x16x32_bf16 v[52:55], v[28:31], a[40:43], v[52:55]
    s_waitcnt vmcnt(15)
    s_barrier
    ds_read_b128 v[20:23], v12 offset:16384
    v_mfma_f32_16x16x32_bf16 v[56:59], v[28:31], a[44:47], v[56:59]
    s_mov_b32 s20, s53
    buffer_store_dwordx2 v[104:105], v112, s[12:15], s29 offen offset:0 sc1
    v_mfma_f32_16x16x32_bf16 v[60:63], v[32:35], a[40:43], v[60:63]
    ds_read_b128 v[24:27], v13 offset:16384
    v_cvt_pk_bf16_f32 v106, v70, v74
    v_mfma_f32_16x16x32_bf16 v[64:67], v[32:35], a[44:47], v[64:67]
    s_waitcnt lgkmcnt(4)
    v_cvt_pk_bf16_f32 v107, v78, v82
    v_mfma_f32_16x16x32_bf16 v[52:55], v[36:39], a[48:51], v[52:55]
    ds_read_b128 v[28:31], v12 offset:18432
    s_add_u32 m0, s21, 65536
    v_mfma_f32_16x16x32_bf16 v[56:59], v[36:39], a[52:55], v[56:59]
    buffer_load_dwordx4 v8, s[8:11], s20 offen lds
    v_mfma_f32_16x16x32_bf16 v[60:63], v[40:43], a[48:51], v[60:63]
    ds_read_b128 v[32:35], v13 offset:18432
    v_and_or_b32 v106, v106, -2, s38
    v_mfma_f32_16x16x32_bf16 v[64:67], v[40:43], a[52:55], v[64:67]
    s_waitcnt lgkmcnt(4)
    v_and_or_b32 v107, v107, -2, s38
    v_mfma_f32_16x16x32_bf16 v[52:55], v[44:47], a[56:59], v[52:55]
    ds_read_b128 v[36:39], v12 offset:20480
    s_add_u32 s29, s46, s31
    v_mfma_f32_16x16x32_bf16 v[56:59], v[44:47], a[60:63], v[56:59]
    buffer_store_dwordx2 v[106:107], v112, s[12:15], s29 offen offset:512 sc1
    v_mfma_f32_16x16x32_bf16 v[60:63], v[48:51], a[56:59], v[60:63]
    ds_read_b128 v[40:43], v13 offset:20480
    v_cvt_pk_bf16_f32 v108, v71, v75
    v_mfma_f32_16x16x32_bf16 v[64:67], v[48:51], a[60:63], v[64:67]
    s_waitcnt lgkmcnt(4)
    v_cvt_pk_bf16_f32 v109, v79, v83
    v_mfma_f32_16x16x32_bf16 v[52:55], v[20:23], a[64:67], v[52:55]
    ds_read_b128 v[44:47], v12 offset:22528
    s_add_u32 m0, s21, 66560
    v_mfma_f32_16x16x32_bf16 v[56:59], v[20:23], a[68:71], v[56:59]
    buffer_load_dwordx4 v9, s[8:11], s20 offen lds
    v_mfma_f32_16x16x32_bf16 v[60:63], v[24:27], a[64:67], v[60:63]
    ds_read_b128 v[48:51], v13 offset:22528
    v_and_or_b32 v108, v108, -2, s38
    v_mfma_f32_16x16x32_bf16 v[64:67], v[24:27], a[68:71], v[64:67]
    s_waitcnt lgkmcnt(4)
    v_and_or_b32 v109, v109, -2, s38
    v_mfma_f32_16x16x32_bf16 v[52:55], v[28:31], a[72:75], v[52:55]
    ds_read_b128 v[20:23], v12 offset:24576
    s_add_u32 s29, s47, s31
    v_mfma_f32_16x16x32_bf16 v[56:59], v[28:31], a[76:79], v[56:59]
    buffer_store_dwordx2 v[108:109], v112, s[12:15], s29 offen offset:1024 sc1
    v_mfma_f32_16x16x32_bf16 v[60:63], v[32:35], a[72:75], v[60:63]
    ds_read_b128 v[24:27], v13 offset:24576
    v_mfma_f32_16x16x32_bf16 v[64:67], v[32:35], a[76:79], v[64:67]
    s_waitcnt lgkmcnt(4)
    v_mfma_f32_16x16x32_bf16 v[52:55], v[36:39], a[80:83], v[52:55]
    ds_read_b128 v[28:31], v12 offset:26624
    s_add_u32 m0, s21, 67584
    v_mfma_f32_16x16x32_bf16 v[56:59], v[36:39], a[84:87], v[56:59]
    buffer_load_dwordx4 v10, s[8:11], s20 offen lds
    v_mfma_f32_16x16x32_bf16 v[60:63], v[40:43], a[80:83], v[60:63]
    ds_read_b128 v[32:35], v13 offset:26624
    v_mfma_f32_16x16x32_bf16 v[64:67], v[40:43], a[84:87], v[64:67]
    s_waitcnt lgkmcnt(4)
    v_mfma_f32_16x16x32_bf16 v[52:55], v[44:47], a[88:91], v[52:55]
    ds_read_b128 v[36:39], v12 offset:28672
    v_mfma_f32_16x16x32_bf16 v[56:59], v[44:47], a[92:95], v[56:59]
    v_mfma_f32_16x16x32_bf16 v[60:63], v[48:51], a[88:91], v[60:63]
    ds_read_b128 v[40:43], v13 offset:28672
    v_mfma_f32_16x16x32_bf16 v[64:67], v[48:51], a[92:95], v[64:67]
    s_waitcnt lgkmcnt(4)
    v_mfma_f32_16x16x32_bf16 v[52:55], v[20:23], a[96:99], v[52:55]
    ds_read_b128 v[44:47], v12 offset:30720
    s_add_u32 m0, s21, 68608
    v_mfma_f32_16x16x32_bf16 v[56:59], v[20:23], a[100:103], v[56:59]
    buffer_load_dwordx4 v11, s[8:11], s20 offen lds
    v_mfma_f32_16x16x32_bf16 v[60:63], v[24:27], a[96:99], v[60:63]
    ds_read_b128 v[48:51], v13 offset:30720
    v_mfma_f32_16x16x32_bf16 v[64:67], v[24:27], a[100:103], v[64:67]
    s_waitcnt lgkmcnt(4)
    v_mfma_f32_16x16x32_bf16 v[52:55], v[28:31], a[104:107], v[52:55]
    s_waitcnt vmcnt(15)
    s_barrier
    ds_read_b128 v[20:23], v12 offset:32768
    v_mfma_f32_16x16x32_bf16 v[56:59], v[28:31], a[108:111], v[56:59]
    s_add_u32 s20, s20, 65536
    v_mfma_f32_16x16x32_bf16 v[60:63], v[32:35], a[104:107], v[60:63]
    ds_read_b128 v[24:27], v13 offset:32768
    v_mfma_f32_16x16x32_bf16 v[64:67], v[32:35], a[108:111], v[64:67]
    s_waitcnt lgkmcnt(4)
    v_mfma_f32_16x16x32_bf16 v[52:55], v[36:39], a[112:115], v[52:55]
    ds_read_b128 v[28:31], v12 offset:34816
    s_add_u32 m0, s21, 81920
    s_waitcnt vmcnt(12)
    v_xor_b32 v124, s7, v88
    v_mfma_f32_16x16x32_bf16 v[56:59], v[36:39], a[116:119], v[56:59]
    buffer_load_dwordx4 v8, s[8:11], s20 offen lds
    v_bitop3_b32 v124, v124, v89, s7 bitop3:0xf6
    v_mfma_f32_16x16x32_bf16 v[60:63], v[40:43], a[112:115], v[60:63]
    ds_read_b128 v[32:35], v13 offset:34816
    v_bitop3_b32 v124, v124, v90, s7 bitop3:0xf6
    v_bitop3_b32 v124, v124, v91, s7 bitop3:0xf6
    v_mfma_f32_16x16x32_bf16 v[64:67], v[40:43], a[116:119], v[64:67]
    s_waitcnt lgkmcnt(4)
    v_bitop3_b32 v124, v124, v92, s7 bitop3:0xf6
    v_bitop3_b32 v124, v124, v93, s7 bitop3:0xf6
    v_mfma_f32_16x16x32_bf16 v[52:55], v[44:47], a[120:123], v[52:55]
    ds_read_b128 v[36:39], v12 offset:36864
    s_lshl_b32 s27, s22, 2
    v_and_b32 v124, 1, v124
    v_mfma_f32_16x16x32_bf16 v[56:59], v[44:47], a[124:127], v[56:59]
    s_add_u32 s3, s22, 2
    s_waitcnt vmcnt(9)
    v_cmp_ne_u32 vcc, 0, v124
    v_mfma_f32_16x16x32_bf16 v[60:63], v[48:51], a[120:123], v[60:63]
    ds_read_b128 v[40:43], v13 offset:36864
    v_readlane_b32 s28, v129, s3
    s_nop 0
    v_mfma_f32_16x16x32_bf16 v[64:67], v[48:51], a[124:127], v[64:67]
    s_waitcnt lgkmcnt(4)
    s_nop 0
    s_nop 0
    v_mfma_f32_16x16x32_bf16 v[52:55], v[20:23], a[128:131], v[52:55]
    ds_read_b128 v[44:47], v12 offset:38912
    s_add_u32 m0, s21, 82944
    s_nop 0
    s_cbranch_vccnz L_rbad_521
L_rok_522:
    v_mfma_f32_16x16x32_bf16 v[56:59], v[20:23], a[132:135], v[56:59]
    buffer_load_dwordx4 v9, s[8:11], s20 offen lds
    s_nop 0
    v_mfma_f32_16x16x32_bf16 v[60:63], v[24:27], a[128:131], v[60:63]
    ds_read_b128 v[48:51], v13 offset:38912
    s_cmp_eq_u32 s28, 0
    s_cbranch_scc1 L_sw_524
L_sok_523:
    v_mfma_f32_16x16x32_bf16 v[64:67], v[24:27], a[132:135], v[64:67]
    s_waitcnt lgkmcnt(4)
    s_add_u32 s27, s27, s60
    v_mfma_f32_16x16x32_bf16 v[52:55], v[28:31], a[136:139], v[52:55]
    ds_read_b128 v[20:23], v12 offset:40960
    s_waitcnt vmcnt(12)
    v_lshlrev_b32 v124, 16, v88
    v_and_b32 v125, 0xffff0000, v88
    v_mfma_f32_16x16x32_bf16 v[56:59], v[28:31], a[140:143], v[56:59]
    s_cmp_gt_u32 s28, 64
    s_cselect_b32 s3, s3, 64
    v_add_f32 v96, v116, v124
    v_mfma_f32_16x16x32_bf16 v[60:63], v[32:35], a[136:139], v[60:63]
    ds_read_b128 v[24:27], v13 offset:40960
    v_add_u32 v131, s26, v131
    v_add_f32 v97, v117, v125
    v_mfma_f32_16x16x32_bf16 v[64:67], v[32:35], a[140:143], v[64:67]
    s_waitcnt lgkmcnt(4)
    s_min_u32 s23, s23, s3
    v_lshlrev_b32 v124, 16, v89
    v_mfma_f32_16x16x32_bf16 v[52:55], v[36:39], a[144:147], v[52:55]
    ds_read_b128 v[28:31], v12 offset:43008
    s_add_u32 m0, s21, 83968
    s_sub_u32 s61, s23, 1
    v_and_b32 v125, 0xffff0000, v89
    v_mfma_f32_16x16x32_bf16 v[56:59], v[36:39], a[148:151], v[56:59]
    buffer_load_dwordx4 v10, s[8:11], s20 offen lds
    v_add_f32 v98, v118, v124
    v_mfma_f32_16x16x32_bf16 v[60:63], v[40:43], a[144:147], v[60:63]
    ds_read_b128 v[32:35], v13 offset:43008
    s_add_u32 s51, s24, 1
    v_add_f32 v99, v119, v125
    v_mfma_f32_16x16x32_bf16 v[64:67], v[40:43], a[148:151], v[64:67]
    s_waitcnt lgkmcnt(4)
    s_min_u32 s51, s51, s61
    v_lshlrev_b32 v124, 16, v90
    v_mfma_f32_16x16x32_bf16 v[52:55], v[44:47], a[152:155], v[52:55]
    ds_read_b128 v[36:39], v12 offset:45056
    v_readlane_b32 s51, v129, s51
    v_and_b32 v125, 0xffff0000, v90
    v_add_f32 v96, v96, v124
    v_mfma_f32_16x16x32_bf16 v[56:59], v[44:47], a[156:159], v[56:59]
    s_nop 0
    buffer_store_dword v131, v85, s[12:15], s27 offen offset:12 sc1
    v_mfma_f32_16x16x32_bf16 v[60:63], v[48:51], a[152:155], v[60:63]
    ds_read_b128 v[40:43], v13 offset:45056
    s_nop 0
    v_add_f32 v97, v97, v125
    v_mfma_f32_16x16x32_bf16 v[64:67], v[48:51], a[156:159], v[64:67]
    s_waitcnt lgkmcnt(4)
    s_sub_u32 s51, s51, 1
    v_lshlrev_b32 v124, 16, v91
    v_and_b32 v125, 0xffff0000, v91
    v_mfma_f32_16x16x32_bf16 v[52:55], v[20:23], a[160:163], v[52:55]
    ds_read_b128 v[44:47], v12 offset:47104
    s_add_u32 m0, s21, 84992
    v_add_f32 v98, v98, v124
    v_mfma_f32_16x16x32_bf16 v[56:59], v[20:23], a[164:167], v[56:59]
    buffer_load_dwordx4 v11, s[8:11], s20 offen lds
    s_lshl_b32 s51, s51, 9
    v_mfma_f32_16x16x32_bf16 v[60:63], v[24:27], a[160:163], v[60:63]
    ds_read_b128 v[48:51], v13 offset:47104
    s_add_u32 s51, s51, s48
    v_add_f32 v99, v99, v125
    v_lshlrev_b32 v124, 16, v92
    v_mfma_f32_16x16x32_bf16 v[64:67], v[24:27], a[164:167], v[64:67]
    s_waitcnt lgkmcnt(4)
    v_and_b32 v125, 0xffff0000, v92
    v_mfma_f32_16x16x32_bf16 v[52:55], v[28:31], a[168:171], v[52:55]
    s_waitcnt vmcnt(12)
    s_barrier
    ds_read_b128 v[20:23], v12 offset:49152
    v_add_f32 v96, v96, v124
    v_mfma_f32_16x16x32_bf16 v[56:59], v[28:31], a[172:175], v[56:59]
    s_add_u32 s20, s20, 65536
    buffer_load_dword v87, v4, s[12:15], s51 offen sc1
    v_add_f32 v97, v97, v125
    v_mfma_f32_16x16x32_bf16 v[60:63], v[32:35], a[168:171], v[60:63]
    ds_read_b128 v[24:27], v13 offset:49152
    v_lshlrev_b32 v124, 16, v93
    v_mfma_f32_16x16x32_bf16 v[64:67], v[32:35], a[172:175], v[64:67]
    s_waitcnt lgkmcnt(4)
    v_and_b32 v125, 0xffff0000, v93
    v_add_f32 v98, v98, v124
    v_mfma_f32_16x16x32_bf16 v[52:55], v[36:39], a[176:179], v[52:55]
    ds_read_b128 v[28:31], v12 offset:51200
    s_add_u32 m0, s21, 98304
    v_add_f32 v99, v99, v125
    v_mfma_f32_16x16x32_bf16 v[56:59], v[36:39], a[180:183], v[56:59]
    buffer_load_dwordx4 v8, s[8:11], s20 offen lds
    ds_write2_b32 v114, v96, v97 offset0:0 offset1:16
    ds_write2_b32 v114, v98, v99 offset0:128 offset1:144
    v_mfma_f32_16x16x32_bf16 v[60:63], v[40:43], a[176:179], v[60:63]
    ds_read_b128 v[32:35], v13 offset:51200
    ds_read_b128 v[88:91], v113 offset:0
    v_mfma_f32_16x16x32_bf16 v[64:67], v[40:43], a[180:183], v[64:67]
    s_waitcnt lgkmcnt(4)
    v_mfma_f32_16x16x32_bf16 v[52:55], v[44:47], a[184:187], v[52:55]
    ds_read_b128 v[36:39], v12 offset:53248
    v_mfma_f32_16x16x32_bf16 v[56:59], v[44:47], a[188:191], v[56:59]
    v_mfma_f32_16x16x32_bf16 v[60:63], v[48:51], a[184:187], v[60:63]
    ds_read_b128 v[40:43], v13 offset:53248
    s_waitcnt lgkmcnt(2)
    v_mfma_f32_16x16x32_bf16 v[64:67], v[48:51], a[188:191], v[64:67]
    s_waitcnt lgkmcnt(4)
    v_cvt_pk_bf16_f32 v96, 0, v88
    v_mfma_f32_16x16x32_bf16 v[52:55], v[20:23], a[192:195], v[52:55]
    ds_read_b128 v[44:47], v12 offset:55296
    s_add_u32 m0, s21, 99328
    v_mfma_f32_16x16x32_bf16 v[56:59], v[20:23], a[196:199], v[56:59]
    buffer_load_dwordx4 v9, s[8:11], s20 offen lds
    v_mfma_f32_16x16x32_bf16 v[60:63], v[24:27], a[192:195], v[60:63]
    ds_read_b128 v[48:51], v13 offset:55296
    v_cvt_pk_bf16_f32 v97, 0, v89
    v_mfma_f32_16x16x32_bf16 v[64:67], v[24:27], a[196:199], v[64:67]
    s_waitcnt lgkmcnt(4)
    v_cvt_pk_bf16_f32 v98, 0, v90
    v_mfma_f32_16x16x32_bf16 v[52:55], v[28:31], a[200:203], v[52:55]
    ds_read_b128 v[20:23], v12 offset:57344
    v_cvt_pk_bf16_f32 v99, 0, v91
    v_mfma_f32_16x16x32_bf16 v[56:59], v[28:31], a[204:207], v[56:59]
    buffer_store_dwordx4 v[96:99], v128, s[16:19], s43 offen
    v_mfma_f32_16x16x32_bf16 v[60:63], v[32:35], a[200:203], v[60:63]
    ds_read_b128 v[24:27], v13 offset:57344
    v_mfma_f32_16x16x32_bf16 v[64:67], v[32:35], a[204:207], v[64:67]
    s_waitcnt lgkmcnt(4)
    v_mfma_f32_16x16x32_bf16 v[52:55], v[36:39], a[208:211], v[52:55]
    ds_read_b128 v[28:31], v12 offset:59392
    s_add_u32 m0, s21, 100352
    v_mov_b32 v116, v68
    v_mov_b32 v117, v72
    v_mfma_f32_16x16x32_bf16 v[56:59], v[36:39], a[212:215], v[56:59]
    buffer_load_dwordx4 v10, s[8:11], s20 offen lds
    v_mov_b32 v118, v76
    v_mov_b32 v119, v80
    v_mfma_f32_16x16x32_bf16 v[60:63], v[40:43], a[208:211], v[60:63]
    ds_read_b128 v[32:35], v13 offset:59392
    s_mov_b32 s7, s38
    s_add_u32 s39, s44, s31
    s_sub_u32 s43, s22, 1
    v_mfma_f32_16x16x32_bf16 v[64:67], v[40:43], a[212:215], v[64:67]
    s_waitcnt lgkmcnt(4)
    s_and_b32 s43, s43, 63
    v_readlane_b32 s43, v129, s43
    s_nop 0
    v_mfma_f32_16x16x32_bf16 v[52:55], v[44:47], a[216:219], v[52:55]
    ds_read_b128 v[36:39], v12 offset:61440
    s_nop 0
    s_sub_u32 s43, s43, 1
    s_lshl_b32 s43, s43, 18
    v_mfma_f32_16x16x32_bf16 v[56:59], v[44:47], a[220:223], v[56:59]
    s_cmp_eq_u32 s37, 0
    s_cselect_b32 s43, 0x7ff00000, s43
    buffer_load_dwordx2 v[88:89], v112, s[12:15], s39 offen offset:0 sc1
    v_mfma_f32_16x16x32_bf16 v[60:63], v[48:51], a[216:219], v[60:63]
    ds_read_b128 v[40:43], v13 offset:61440
    v_mfma_f32_16x16x32_bf16 v[64:67], v[48:51], a[220:223], v[64:67]
    s_waitcnt lgkmcnt(4)
    v_mfma_f32_16x16x32_bf16 v[52:55], v[20:23], a[224:227], v[52:55]
    ds_read_b128 v[44:47], v12 offset:63488
    s_add_u32 m0, s21, 101376
    v_mfma_f32_16x16x32_bf16 v[56:59], v[20:23], a[228:231], v[56:59]
    buffer_load_dwordx4 v11, s[8:11], s20 offen lds
    v_mfma_f32_16x16x32_bf16 v[60:63], v[24:27], a[224:227], v[60:63]
    ds_read_b128 v[48:51], v13 offset:63488
    v_mfma_f32_16x16x32_bf16 v[64:67], v[24:27], a[228:231], v[64:67]
    s_waitcnt lgkmcnt(4)
    v_mfma_f32_16x16x32_bf16 v[52:55], v[28:31], a[232:235], v[52:55]
    s_waitcnt vmcnt(12)
    s_barrier
    ds_read_b128 v[20:23], v16 offset:0
    v_mfma_f32_16x16x32_bf16 v[56:59], v[28:31], a[236:239], v[56:59]
    s_add_u32 s20, s20, 65536
    buffer_load_dwordx2 v[90:91], v112, s[12:15], s39 offen offset:512 sc1
    v_mfma_f32_16x16x32_bf16 v[60:63], v[32:35], a[232:235], v[60:63]
    ds_read_b128 v[24:27], v17 offset:0
    v_mfma_f32_16x16x32_bf16 v[64:67], v[32:35], a[236:239], v[64:67]
    s_waitcnt lgkmcnt(4)
    v_mfma_f32_16x16x32_bf16 v[52:55], v[36:39], a[240:243], v[52:55]
    ds_read_b128 v[28:31], v16 offset:2048
    s_add_u32 m0, s21, 114688
    v_mfma_f32_16x16x32_bf16 v[56:59], v[36:39], a[244:247], v[56:59]
    buffer_load_dwordx4 v8, s[8:11], s20 offen lds
    v_mfma_f32_16x16x32_bf16 v[60:63], v[40:43], a[240:243], v[60:63]
    ds_read_b128 v[32:35], v17 offset:2048
    v_mfma_f32_16x16x32_bf16 v[64:67], v[40:43], a[244:247], v[64:67]
    s_waitcnt lgkmcnt(4)
    v_mfma_f32_16x16x32_bf16 v[52:55], v[44:47], a[248:251], v[52:55]
    ds_read_b128 v[36:39], v16 offset:4096
    v_mfma_f32_16x16x32_bf16 v[56:59], v[44:47], a[252:255], v[56:59]
    buffer_load_dwordx2 v[92:93], v112, s[12:15], s39 offen offset:1024 sc1
    v_mfma_f32_16x16x32_bf16 v[60:63], v[48:51], a[248:251], v[60:63]
    ds_read_b128 v[40:43], v17 offset:4096
    s_mov_b32 s37, 1
    v_mfma_f32_16x16x32_bf16 v[64:67], v[48:51], a[252:255], v[64:67]
    s_waitcnt lgkmcnt(4)
    s_add_u32 s22, s22, 1
    s_cmp_ge_u32 s22, s23
    s_cbranch_scc1 L_fl0_517
    v_mfma_f32_16x16x32_bf16 v[68:71], v[20:23], a[0:3], 0
    ds_read_b128 v[44:47], v16 offset:6144
    s_add_u32 m0, s21, 115712
    s_cmp_lt_u32 s22, 57
    s_cselect_b32 s27, 1, 0
    s_cselect_b32 s26, 1, 0x80
    v_mfma_f32_16x16x32_bf16 v[72:75], v[20:23], a[4:7], 0
    buffer_load_dwordx4 v9, s[8:11], s20 offen lds
    s_sub_u32 s38, s22, 1
    v_mfma_f32_16x16x32_bf16 v[76:79], v[24:27], a[0:3], 0
    ds_read_b128 v[48:51], v17 offset:6144
    s_and_b32 s31, s38, 3
    s_lshl_b32 s31, s31, 11
    v_mfma_f32_16x16x32_bf16 v[80:83], v[24:27], a[4:7], 0
    s_waitcnt lgkmcnt(4)
    s_bfe_u32 s38, s38, 0x10002
    v_mfma_f32_16x16x32_bf16 v[68:71], v[28:31], a[8:11], v[68:71]
    ds_read_b128 v[20:23], v16 offset:8192
    v_mov_b32 v131, s27
    s_xor_b32 s38, s38, 1
    v_mfma_f32_16x16x32_bf16 v[72:75], v[28:31], a[12:15], v[72:75]
    buffer_atomic_add v131, v85, s[12:15], s95 offen sc0 sc1
    v_mfma_f32_16x16x32_bf16 v[76:79], v[32:35], a[8:11], v[76:79]
    ds_read_b128 v[24:27], v17 offset:8192
    s_add_u32 s24, s24, 1
    s_min_u32 s24, s24, s61
    s_cmp_eq_u32 s37, 0
    s_cselect_b32 s31, 0x40000000, s31
    s_cselect_b32 s38, 0, s38
    v_mfma_f32_16x16x32_bf16 v[80:83], v[32:35], a[12:15], v[80:83]
    s_waitcnt lgkmcnt(4)
    s_mov_b32 s30, s24
    v_readlane_b32 s30, v129, s30
    v_mfma_f32_16x16x32_bf16 v[68:71], v[36:39], a[16:19], v[68:71]
    ds_read_b128 v[28:31], v16 offset:10240
    s_add_u32 m0, s21, 116736
    s_nop 0
    v_mfma_f32_16x16x32_bf16 v[72:75], v[36:39], a[20:23], v[72:75]
    buffer_load_dwordx4 v10, s[8:11], s20 offen lds
    v_mfma_f32_16x16x32_bf16 v[76:79], v[40:43], a[16:19], v[76:79]
    ds_read_b128 v[32:35], v17 offset:10240
    s_nop 0
    s_sub_u32 s30, s30, 1
    v_mfma_f32_16x16x32_bf16 v[80:83], v[40:43], a[20:23], v[80:83]
    s_waitcnt lgkmcnt(4)
    s_bitcmp1_b32 s30, 1
    s_cselect_b32 s53, s54, s55
    v_mfma_f32_16x16x32_bf16 v[68:71], v[44:47], a[24:27], v[68:71]
    ds_read_b128 v[36:39], v16 offset:12288
    s_lshl_b32 s30, s30, 20
    v_cvt_pk_bf16_f32 v104, v53, v57
    v_mfma_f32_16x16x32_bf16 v[72:75], v[44:47], a[28:31], v[72:75]
    s_add_u32 s53, s53, s30
    buffer_load_dword v129, v130, s[12:15], s94 offen sc1
    v_mfma_f32_16x16x32_bf16 v[76:79], v[48:51], a[24:27], v[76:79]
    ds_read_b128 v[40:43], v17 offset:12288
    s_add_u32 s53, s53, s50
    s_waitcnt vmcnt(13)
    v_cvt_pk_bf16_f32 v105, v61, v65
    v_mfma_f32_16x16x32_bf16 v[80:83], v[48:51], a[28:31], v[80:83]
    s_waitcnt lgkmcnt(4)
    v_readfirstlane_b32 s30, v87
    s_nop 0
    v_mfma_f32_16x16x32_bf16 v[68:71], v[20:23], a[32:35], v[68:71]
    ds_read_b128 v[44:47], v16 offset:14336
    s_add_u32 m0, s21, 117760
    v_and_or_b32 v104, v104, -2, s38
    v_mfma_f32_16x16x32_bf16 v[72:75], v[20:23], a[36:39], v[72:75]
    buffer_load_dwordx4 v11, s[8:11], s20 offen lds
    s_nop 0
    v_mfma_f32_16x16x32_bf16 v[76:79], v[24:27], a[32:35], v[76:79]
    ds_read_b128 v[48:51], v17 offset:14336
    s_cmp_lt_u32 s30, 8
    s_cbranch_scc1 L_gw_532
L_gok_531:
    v_mfma_f32_16x16x32_bf16 v[80:83], v[24:27], a[36:39], v[80:83]
    s_waitcnt lgkmcnt(4)
    v_and_or_b32 v105, v105, -2, s38
    s_add_u32 s29, s45, s31
    v_mfma_f32_16x16x32_bf16 v[68:71], v[28:31], a[40:43], v[68:71]
    s_waitcnt vmcnt(15)
    s_barrier
    ds_read_b128 v[20:23], v16 offset:16384
    v_mfma_f32_16x16x32_bf16 v[72:75], v[28:31], a[44:47], v[72:75]
    s_mov_b32 s20, s53
    buffer_store_dwordx2 v[104:105], v112, s[12:15], s29 offen offset:0 sc1
    v_mfma_f32_16x16x32_bf16 v[76:79], v[32:35], a[40:43], v[76:79]
    ds_read_b128 v[24:27], v17 offset:16384
    v_cvt_pk_bf16_f32 v106, v54, v58
    v_mfma_f32_16x16x32_bf16 v[80:83], v[32:35], a[44:47], v[80:83]
    s_waitcnt lgkmcnt(4)
    v_cvt_pk_bf16_f32 v107, v62, v66
    v_mfma_f32_16x16x32_bf16 v[68:71], v[36:39], a[48:51], v[68:71]
    ds_read_b128 v[28:31], v16 offset:18432
    s_add_u32 m0, s21, 0
    v_mfma_f32_16x16x32_bf16 v[72:75], v[36:39], a[52:55], v[72:75]
    buffer_load_dwordx4 v8, s[8:11], s20 offen lds
    v_mfma_f32_16x16x32_bf16 v[76:79], v[40:43], a[48:51], v[76:79]
    ds_read_b128 v[32:35], v17 offset:18432
    v_and_or_b32 v106, v106, -2, s38
    v_mfma_f32_16x16x32_bf16 v[80:83], v[40:43], a[52:55], v[80:83]
    s_waitcnt lgkmcnt(4)
    v_and_or_b32 v107, v107, -2, s38
    v_mfma_f32_16x16x32_bf16 v[68:71], v[44:47], a[56:59], v[68:71]
    ds_read_b128 v[36:39], v16 offset:20480
    s_add_u32 s29, s46, s31
    v_mfma_f32_16x16x32_bf16 v[72:75], v[44:47], a[60:63], v[72:75]
    buffer_store_dwordx2 v[106:107], v112, s[12:15], s29 offen offset:512 sc1
    v_mfma_f32_16x16x32_bf16 v[76:79], v[48:51], a[56:59], v[76:79]
    ds_read_b128 v[40:43], v17 offset:20480
    v_cvt_pk_bf16_f32 v108, v55, v59
    v_mfma_f32_16x16x32_bf16 v[80:83], v[48:51], a[60:63], v[80:83]
    s_waitcnt lgkmcnt(4)
    v_cvt_pk_bf16_f32 v109, v63, v67
    v_mfma_f32_16x16x32_bf16 v[68:71], v[20:23], a[64:67], v[68:71]
    ds_read_b128 v[44:47], v16 offset:22528
    s_add_u32 m0, s21, 1024
    v_mfma_f32_16x16x32_bf16 v[72:75], v[20:23], a[68:71], v[72:75]
    buffer_load_dwordx4 v9, s[8:11], s20 offen lds
    v_mfma_f32_16x16x32_bf16 v[76:79], v[24:27], a[64:67], v[76:79]
    ds_read_b128 v[48:51], v17 offset:22528
    v_and_or_b32 v108, v108, -2, s38
    v_mfma_f32_16x16x32_bf16 v[80:83], v[24:27], a[68:71], v[80:83]
    s_waitcnt lgkmcnt(4)
    v_and_or_b32 v109, v109, -2, s38
    v_mfma_f32_16x16x32_bf16 v[68:71], v[28:31], a[72:75], v[68:71]
    ds_read_b128 v[20:23], v16 offset:24576
    s_add_u32 s29, s47, s31
    v_mfma_f32_16x16x32_bf16 v[72:75], v[28:31], a[76:79], v[72:75]
    buffer_store_dwordx2 v[108:109], v112, s[12:15], s29 offen offset:1024 sc1
    v_mfma_f32_16x16x32_bf16 v[76:79], v[32:35], a[72:75], v[76:79]
    ds_read_b128 v[24:27], v17 offset:24576
    v_mfma_f32_16x16x32_bf16 v[80:83], v[32:35], a[76:79], v[80:83]
    s_waitcnt lgkmcnt(4)
    v_mfma_f32_16x16x32_bf16 v[68:71], v[36:39], a[80:83], v[68:71]
    ds_read_b128 v[28:31], v16 offset:26624
    s_add_u32 m0, s21, 2048
    v_mfma_f32_16x16x32_bf16 v[72:75], v[36:39], a[84:87], v[72:75]
    buffer_load_dwordx4 v10, s[8:11], s20 offen lds
    v_mfma_f32_16x16x32_bf16 v[76:79], v[40:43], a[80:83], v[76:79]
    ds_read_b128 v[32:35], v17 offset:26624
    v_mfma_f32_16x16x32_bf16 v[80:83], v[40:43], a[84:87], v[80:83]
    s_waitcnt lgkmcnt(4)
    v_mfma_f32_16x16x32_bf16 v[68:71], v[44:47], a[88:91], v[68:71]
    ds_read_b128 v[36:39], v16 offset:28672
    v_mfma_f32_16x16x32_bf16 v[72:75], v[44:47], a[92:95], v[72:75]
    v_mfma_f32_16x16x32_bf16 v[76:79], v[48:51], a[88:91], v[76:79]
    ds_read_b128 v[40:43], v17 offset:28672
    v_mfma_f32_16x16x32_bf16 v[80:83], v[48:51], a[92:95], v[80:83]
    s_waitcnt lgkmcnt(4)
    v_mfma_f32_16x16x32_bf16 v[68:71], v[20:23], a[96:99], v[68:71]
    ds_read_b128 v[44:47], v16 offset:30720
    s_add_u32 m0, s21, 3072
    v_mfma_f32_16x16x32_bf16 v[72:75], v[20:23], a[100:103], v[72:75]
    buffer_load_dwordx4 v11, s[8:11], s20 offen lds
    v_mfma_f32_16x16x32_bf16 v[76:79], v[24:27], a[96:99], v[76:79]
    ds_read_b128 v[48:51], v17 offset:30720
    v_mfma_f32_16x16x32_bf16 v[80:83], v[24:27], a[100:103], v[80:83]
    s_waitcnt lgkmcnt(4)
    v_mfma_f32_16x16x32_bf16 v[68:71], v[28:31], a[104:107], v[68:71]
    s_waitcnt vmcnt(15)
    s_barrier
    ds_read_b128 v[20:23], v16 offset:32768
    v_mfma_f32_16x16x32_bf16 v[72:75], v[28:31], a[108:111], v[72:75]
    s_add_u32 s20, s20, 65536
    v_mfma_f32_16x16x32_bf16 v[76:79], v[32:35], a[104:107], v[76:79]
    ds_read_b128 v[24:27], v17 offset:32768
    v_mfma_f32_16x16x32_bf16 v[80:83], v[32:35], a[108:111], v[80:83]
    s_waitcnt lgkmcnt(4)
    v_mfma_f32_16x16x32_bf16 v[68:71], v[36:39], a[112:115], v[68:71]
    ds_read_b128 v[28:31], v16 offset:34816
    s_add_u32 m0, s21, 16384
    s_waitcnt vmcnt(12)
    v_xor_b32 v124, s7, v88
    v_mfma_f32_16x16x32_bf16 v[72:75], v[36:39], a[116:119], v[72:75]
    buffer_load_dwordx4 v8, s[8:11], s20 offen lds
    v_bitop3_b32 v124, v124, v89, s7 bitop3:0xf6
    v_mfma_f32_16x16x32_bf16 v[76:79], v[40:43], a[112:115], v[76:79]
    ds_read_b128 v[32:35], v17 offset:34816
    v_bitop3_b32 v124, v124, v90, s7 bitop3:0xf6
    v_bitop3_b32 v124, v124, v91, s7 bitop3:0xf6
    v_mfma_f32_16x16x32_bf16 v[80:83], v[40:43], a[116:119], v[80:83]
    s_waitcnt lgkmcnt(4)
    v_bitop3_b32 v124, v124, v92, s7 bitop3:0xf6
    v_bitop3_b32 v124, v124, v93, s7 bitop3:0xf6
    v_mfma_f32_16x16x32_bf16 v[68:71], v[44:47], a[120:123], v[68:71]
    ds_read_b128 v[36:39], v16 offset:36864
    s_lshl_b32 s27, s22, 2
    v_and_b32 v124, 1, v124
    v_mfma_f32_16x16x32_bf16 v[72:75], v[44:47], a[124:127], v[72:75]
    s_add_u32 s3, s22, 2
    s_waitcnt vmcnt(9)
    v_cmp_ne_u32 vcc, 0, v124
    v_mfma_f32_16x16x32_bf16 v[76:79], v[48:51], a[120:123], v[76:79]
    ds_read_b128 v[40:43], v17 offset:36864
    v_readlane_b32 s28, v129, s3
    s_nop 0
    v_mfma_f32_16x16x32_bf16 v[80:83], v[48:51], a[124:127], v[80:83]
    s_waitcnt lgkmcnt(4)
    s_nop 0
    s_nop 0
    v_mfma_f32_16x16x32_bf16 v[68:71], v[20:23], a[128:131], v[68:71]
    ds_read_b128 v[44:47], v16 offset:38912
    s_add_u32 m0, s21, 17408
    s_nop 0
    s_cbranch_vccnz L_rbad_527
L_rok_528:
    v_mfma_f32_16x16x32_bf16 v[72:75], v[20:23], a[132:135], v[72:75]
    buffer_load_dwordx4 v9, s[8:11], s20 offen lds
    s_nop 0
    v_mfma_f32_16x16x32_bf16 v[76:79], v[24:27], a[128:131], v[76:79]
    ds_read_b128 v[48:51], v17 offset:38912
    s_cmp_eq_u32 s28, 0
    s_cbranch_scc1 L_sw_530
L_sok_529:
    v_mfma_f32_16x16x32_bf16 v[80:83], v[24:27], a[132:135], v[80:83]
    s_waitcnt lgkmcnt(4)
    s_add_u32 s27, s27, s60
    v_mfma_f32_16x16x32_bf16 v[68:71], v[28:31], a[136:139], v[68:71]
    ds_read_b128 v[20:23], v16 offset:40960
    s_waitcnt vmcnt(12)
    v_lshlrev_b32 v124, 16, v88
    v_and_b32 v125, 0xffff0000, v88
    v_mfma_f32_16x16x32_bf16 v[72:75], v[28:31], a[140:143], v[72:75]
    s_cmp_gt_u32 s28, 64
    s_cselect_b32 s3, s3, 64
    v_add_f32 v96, v116, v124
    v_mfma_f32_16x16x32_bf16 v[76:79], v[32:35], a[136:139], v[76:79]
    ds_read_b128 v[24:27], v17 offset:40960
    v_add_u32 v131, s26, v131
    v_add_f32 v97, v117, v125
    v_mfma_f32_16x16x32_bf16 v[80:83], v[32:35], a[140:143], v[80:83]
    s_waitcnt lgkmcnt(4)
    s_min_u32 s23, s23, s3
    v_lshlrev_b32 v124, 16, v89
    v_mfma_f32_16x16x32_bf16 v[68:71], v[36:39], a[144:147], v[68:71]
    ds_read_b128 v[28:31], v16 offset:43008
    s_add_u32 m0, s21, 18432
    s_sub_u32 s61, s23, 1
    v_and_b32 v125, 0xffff0000, v89
    v_mfma_f32_16x16x32_bf16 v[72:75], v[36:39], a[148:151], v[72:75]
    buffer_load_dwordx4 v10, s[8:11], s20 offen lds
    v_add_f32 v98, v118, v124
    v_mfma_f32_16x16x32_bf16 v[76:79], v[40:43], a[144:147], v[76:79]
    ds_read_b128 v[32:35], v17 offset:43008
    s_add_u32 s51, s24, 1
    v_add_f32 v99, v119, v125
    v_mfma_f32_16x16x32_bf16 v[80:83], v[40:43], a[148:151], v[80:83]
    s_waitcnt lgkmcnt(4)
    s_min_u32 s51, s51, s61
    v_lshlrev_b32 v124, 16, v90
    v_mfma_f32_16x16x32_bf16 v[68:71], v[44:47], a[152:155], v[68:71]
    ds_read_b128 v[36:39], v16 offset:45056
    v_readlane_b32 s51, v129, s51
    v_and_b32 v125, 0xffff0000, v90
    v_add_f32 v96, v96, v124
    v_mfma_f32_16x16x32_bf16 v[72:75], v[44:47], a[156:159], v[72:75]
    s_nop 0
    buffer_store_dword v131, v85, s[12:15], s27 offen offset:12 sc1
    v_mfma_f32_16x16x32_bf16 v[76:79], v[48:51], a[152:155], v[76:79]
    ds_read_b128 v[40:43], v17 offset:45056
    s_nop 0
    v_add_f32 v97, v97, v125
    v_mfma_f32_16x16x32_bf16 v[80:83], v[48:51], a[156:159], v[80:83]
    s_waitcnt lgkmcnt(4)
    s_sub_u32 s51, s51, 1
    v_lshlrev_b32 v124, 16, v91
    v_and_b32 v125, 0xffff0000, v91
    v_mfma_f32_16x16x32_bf16 v[68:71], v[20:23], a[160:163], v[68:71]
    ds_read_b128 v[44:47], v16 offset:47104
    s_add_u32 m0, s21, 19456
    v_add_f32 v98, v98, v124
    v_mfma_f32_16x16x32_bf16 v[72:75], v[20:23], a[164:167], v[72:75]
    buffer_load_dwordx4 v11, s[8:11], s20 offen lds
    s_lshl_b32 s51, s51, 9
    v_mfma_f32_16x16x32_bf16 v[76:79], v[24:27], a[160:163], v[76:79]
    ds_read_b128 v[48:51], v17 offset:47104
    s_add_u32 s51, s51, s48
    v_add_f32 v99, v99, v125
    v_lshlrev_b32 v124, 16, v92
    v_mfma_f32_16x16x32_bf16 v[80:83], v[24:27], a[164:167], v[80:83]
    s_waitcnt lgkmcnt(4)
    v_and_b32 v125, 0xffff0000, v92
    v_mfma_f32_16x16x32_bf16 v[68:71], v[28:31], a[168:171], v[68:71]
    s_waitcnt vmcnt(12)
    s_barrier
    ds_read_b128 v[20:23], v16 offset:49152
    v_add_f32 v96, v96, v124
    v_mfma_f32_16x16x32_bf16 v[72:75], v[28:31], a[172:175], v[72:75]
    s_add_u32 s20, s20, 65536
    buffer_load_dword v87, v4, s[12:15], s51 offen sc1
    v_add_f32 v97, v97, v125
    v_mfma_f32_16x16x32_bf16 v[76:79], v[32:35], a[168:171], v[76:79]
    ds_read_b128 v[24:27], v17 offset:49152
    v_lshlrev_b32 v124, 16, v93
    v_mfma_f32_16x16x32_bf16 v[80:83], v[32:35], a[172:175], v[80:83]
    s_waitcnt lgkmcnt(4)
    v_and_b32 v125, 0xffff0000, v93
    v_add_f32 v98, v98, v124
    v_mfma_f32_16x16x32_bf16 v[68:71], v[36:39], a[176:179], v[68:71]
    ds_read_b128 v[28:31], v16 offset:51200
    s_add_u32 m0, s21, 32768
    v_add_f32 v99, v99, v125
    v_mfma_f32_16x16x32_bf16 v[72:75], v[36:39], a[180:183], v[72:75]
    buffer_load_dwordx4 v8, s[8:11], s20 offen lds
    ds_write2_b32 v114, v96, v97 offset0:0 offset1:16
    ds_write2_b32 v114, v98, v99 offset0:128 offset1:144
    v_mfma_f32_16x16x32_bf16 v[76:79], v[40:43], a[176:179], v[76:79]
    ds_read_b128 v[32:35], v17 offset:51200
    ds_read_b128 v[88:91], v113 offset:0
    v_mfma_f32_16x16x32_bf16 v[80:83], v[40:43], a[180:183], v[80:83]
    s_waitcnt lgkmcnt(4)
    v_mfma_f32_16x16x32_bf16 v[68:71], v[44:47], a[184:187], v[68:71]
    ds_read_b128 v[36:39], v16 offset:53248
    v_mfma_f32_16x16x32_bf16 v[72:75], v[44:47], a[188:191], v[72:75]
    v_mfma_f32_16x16x32_bf16 v[76:79], v[48:51], a[184:187], v[76:79]
    ds_read_b128 v[40:43], v17 offset:53248
    s_waitcnt lgkmcnt(2)
    v_mfma_f32_16x16x32_bf16 v[80:83], v[48:51], a[188:191], v[80:83]
    s_waitcnt lgkmcnt(4)
    v_cvt_pk_bf16_f32 v96, 0, v88
    v_mfma_f32_16x16x32_bf16 v[68:71], v[20:23], a[192:195], v[68:71]
    ds_read_b128 v[44:47], v16 offset:55296
    s_add_u32 m0, s21, 33792
    v_mfma_f32_16x16x32_bf16 v[72:75], v[20:23], a[196:199], v[72:75]
    buffer_load_dwordx4 v9, s[8:11], s20 offen lds
    v_mfma_f32_16x16x32_bf16 v[76:79], v[24:27], a[192:195], v[76:79]
    ds_read_b128 v[48:51], v17 offset:55296
    v_cvt_pk_bf16_f32 v97, 0, v89
    v_mfma_f32_16x16x32_bf16 v[80:83], v[24:27], a[196:199], v[80:83]
    s_waitcnt lgkmcnt(4)
    v_cvt_pk_bf16_f32 v98, 0, v90
    v_mfma_f32_16x16x32_bf16 v[68:71], v[28:31], a[200:203], v[68:71]
    ds_read_b128 v[20:23], v16 offset:57344
    v_cvt_pk_bf16_f32 v99, 0, v91
    v_mfma_f32_16x16x32_bf16 v[72:75], v[28:31], a[204:207], v[72:75]
    buffer_store_dwordx4 v[96:99], v128, s[16:19], s43 offen
    v_mfma_f32_16x16x32_bf16 v[76:79], v[32:35], a[200:203], v[76:79]
    ds_read_b128 v[24:27], v17 offset:57344
    v_mfma_f32_16x16x32_bf16 v[80:83], v[32:35], a[204:207], v[80:83]
    s_waitcnt lgkmcnt(4)
    v_mfma_f32_16x16x32_bf16 v[68:71], v[36:39], a[208:211], v[68:71]
    ds_read_b128 v[28:31], v16 offset:59392
    s_add_u32 m0, s21, 34816
    v_mov_b32 v116, v52
    v_mov_b32 v117, v56
    v_mfma_f32_16x16x32_bf16 v[72:75], v[36:39], a[212:215], v[72:75]
    buffer_load_dwordx4 v10, s[8:11], s20 offen lds
    v_mov_b32 v118, v60
    v_mov_b32 v119, v64
    v_mfma_f32_16x16x32_bf16 v[76:79], v[40:43], a[208:211], v[76:79]
    ds_read_b128 v[32:35], v17 offset:59392
    s_mov_b32 s7, s38
    s_add_u32 s39, s44, s31
    s_sub_u32 s43, s22, 1
    v_mfma_f32_16x16x32_bf16 v[80:83], v[40:43], a[212:215], v[80:83]
    s_waitcnt lgkmcnt(4)
    s_and_b32 s43, s43, 63
    v_readlane_b32 s43, v129, s43
    s_nop 0
    v_mfma_f32_16x16x32_bf16 v[68:71], v[44:47], a[216:219], v[68:71]
    ds_read_b128 v[36:39], v16 offset:61440
    s_nop 0
    s_sub_u32 s43, s43, 1
    s_lshl_b32 s43, s43, 18
    v_mfma_f32_16x16x32_bf16 v[72:75], v[44:47], a[220:223], v[72:75]
    s_cmp_eq_u32 s37, 0
    s_cselect_b32 s43, 0x7ff00000, s43
    buffer_load_dwordx2 v[88:89], v112, s[12:15], s39 offen offset:0 sc1
    v_mfma_f32_16x16x32_bf16 v[76:79], v[48:51], a[216:219], v[76:79]
    ds_read_b128 v[40:43], v17 offset:61440
    v_mfma_f32_16x16x32_bf16 v[80:83], v[48:51], a[220:223], v[80:83]
    s_waitcnt lgkmcnt(4)
    v_mfma_f32_16x16x32_bf16 v[68:71], v[20:23], a[224:227], v[68:71]
    ds_read_b128 v[44:47], v16 offset:63488
    s_add_u32 m0, s21, 35840
    v_mfma_f32_16x16x32_bf16 v[72:75], v[20:23], a[228:231], v[72:75]
    buffer_load_dwordx4 v11, s[8:11], s20 offen lds
    v_mfma_f32_16x16x32_bf16 v[76:79], v[24:27], a[224:227], v[76:79]
    ds_read_b128 v[48:51], v17 offset:63488
    v_mfma_f32_16x16x32_bf16 v[80:83], v[24:27], a[228:231], v[80:83]
    s_waitcnt lgkmcnt(4)
    v_mfma_f32_16x16x32_bf16 v[68:71], v[28:31], a[232:235], v[68:71]
    s_waitcnt vmcnt(12)
    s_barrier
    ds_read_b128 v[20:23], v12 offset:0
    v_mfma_f32_16x16x32_bf16 v[72:75], v[28:31], a[236:239], v[72:75]
    s_add_u32 s20, s20, 65536
    buffer_load_dwordx2 v[90:91], v112, s[12:15], s39 offen offset:512 sc1
    v_mfma_f32_16x16x32_bf16 v[76:79], v[32:35], a[232:235], v[76:79]
    ds_read_b128 v[24:27], v13 offset:0
    v_mfma_f32_16x16x32_bf16 v[80:83], v[32:35], a[236:239], v[80:83]
    s_waitcnt lgkmcnt(4)
    v_mfma_f32_16x16x32_bf16 v[68:71], v[36:39], a[240:243], v[68:71]
    ds_read_b128 v[28:31], v12 offset:2048
    s_add_u32 m0, s21, 49152
    v_mfma_f32_16x16x32_bf16 v[72:75], v[36:39], a[244:247], v[72:75]
    buffer_load_dwordx4 v8, s[8:11], s20 offen lds
    v_mfma_f32_16x16x32_bf16 v[76:79], v[40:43], a[240:243], v[76:79]
    ds_read_b128 v[32:35], v13 offset:2048
    v_mfma_f32_16x16x32_bf16 v[80:83], v[40:43], a[244:247], v[80:83]
    s_waitcnt lgkmcnt(4)
    v_mfma_f32_16x16x32_bf16 v[68:71], v[44:47], a[248:251], v[68:71]
    ds_read_b128 v[36:39], v12 offset:4096
    v_mfma_f32_16x16x32_bf16 v[72:75], v[44:47], a[252:255], v[72:75]
    buffer_load_dwordx2 v[92:93], v112, s[12:15], s39 offen offset:1024 sc1
    v_mfma_f32_16x16x32_bf16 v[76:79], v[48:51], a[248:251], v[76:79]
    ds_read_b128 v[40:43], v13 offset:4096
    s_mov_b32 s37, 1
    v_mfma_f32_16x16x32_bf16 v[80:83], v[48:51], a[252:255], v[80:83]
    s_waitcnt lgkmcnt(4)
    s_add_u32 s22, s22, 1
    s_cmp_ge_u32 s22, s23
    s_cbranch_scc0 L_st_520
L_fl1_518:
    s_waitcnt lgkmcnt(0)
    s_nop 7
    s_sub_u32 s38, s22, 1
    s_and_b32 s31, s38, 3
    s_lshl_b32 s31, s31, 11
    s_bfe_u32 s38, s38, 0x10002
    s_xor_b32 s38, s38, 1
    s_cmp_eq_u32 s37, 0
    s_cselect_b32 s31, 0x40000000, s31
    s_cselect_b32 s38, 0, s38
    v_cvt_pk_bf16_f32 v104, v69, v73
    v_cvt_pk_bf16_f32 v105, v77, v81
    v_and_or_b32 v104, v104, -2, s38
    v_and_or_b32 v105, v105, -2, s38
    s_add_u32 s29, s45, s31
    buffer_store_dwordx2 v[104:105], v112, s[12:15], s29 offen offset:0 sc1
    v_cvt_pk_bf16_f32 v106, v70, v74
    v_cvt_pk_bf16_f32 v107, v78, v82
    v_and_or_b32 v106, v106, -2, s38
    v_and_or_b32 v107, v107, -2, s38
    s_add_u32 s29, s46, s31
    buffer_store_dwordx2 v[106:107], v112, s[12:15], s29 offen offset:512 sc1
    v_cvt_pk_bf16_f32 v108, v71, v75
    v_cvt_pk_bf16_f32 v109, v79, v83
    v_and_or_b32 v108, v108, -2, s38
    v_and_or_b32 v109, v109, -2, s38
    s_add_u32 s29, s47, s31
    buffer_store_dwordx2 v[108:109], v112, s[12:15], s29 offen offset:1024 sc1
    s_waitcnt vmcnt(0)
    v_xor_b32 v124, s7, v88
    v_bitop3_b32 v124, v124, v89, s7 bitop3:0xf6
    v_bitop3_b32 v124, v124, v90, s7 bitop3:0xf6
    v_bitop3_b32 v124, v124, v91, s7 bitop3:0xf6
    v_bitop3_b32 v124, v124, v92, s7 bitop3:0xf6
    v_bitop3_b32 v124, v124, v93, s7 bitop3:0xf6
    v_and_b32 v124, 1, v124
    v_cmp_ne_u32 vcc, 0, v124
    s_nop 0
    s_nop 0
    s_nop 0
    s_cbranch_vccnz L_rbad_533
L_rok_534:
    v_lshlrev_b32 v124, 16, v88
    v_and_b32 v125, 0xffff0000, v88
    v_add_f32 v96, v116, v124
    v_add_f32 v97, v117, v125
    v_lshlrev_b32 v124, 16, v89
    v_and_b32 v125, 0xffff0000, v89
    v_add_f32 v98, v118, v124
    v_add_f32 v99, v119, v125
    v_lshlrev_b32 v124, 16, v90
    v_and_b32 v125, 0xffff0000, v90
    v_add_f32 v96, v96, v124
    v_add_f32 v97, v97, v125
    v_lshlrev_b32 v124, 16, v91
    v_and_b32 v125, 0xffff0000, v91
    v_add_f32 v98, v98, v124
    v_add_f32 v99, v99, v125
    v_lshlrev_b32 v124, 16, v92
    v_and_b32 v125, 0xffff0000, v92
    v_add_f32 v96, v96, v124
    v_add_f32 v97, v97, v125
    v_lshlrev_b32 v124, 16, v93
    v_and_b32 v125, 0xffff0000, v93
    v_add_f32 v98, v98, v124
    v_add_f32 v99, v99, v125
    ds_write2_b32 v114, v96, v97 offset0:0 offset1:16
    ds_write2_b32 v114, v98, v99 offset0:128 offset1:144
    ds_read_b128 v[88:91], v113 offset:0
    s_waitcnt lgkmcnt(0)
    v_cvt_pk_bf16_f32 v96, 0, v88
    v_cvt_pk_bf16_f32 v97, 0, v89
    v_cvt_pk_bf16_f32 v98, 0, v90
    v_cvt_pk_bf16_f32 v99, 0, v91
    buffer_store_dwordx4 v[96:99], v128, s[16:19], s43 offen
    v_mov_b32 v116, v68
    v_mov_b32 v117, v72
    v_mov_b32 v118, v76
    v_mov_b32 v119, v80
    s_mov_b32 s7, s38
    s_add_u32 s39, s44, s31
    s_sub_u32 s43, s22, 1
    s_and_b32 s43, s43, 63
    v_readlane_b32 s43, v129, s43
    s_nop 0
    s_nop 0
    s_sub_u32 s43, s43, 1
    s_lshl_b32 s43, s43, 18
    s_cmp_eq_u32 s37, 0
    s_cselect_b32 s43, 0x7ff00000, s43
    buffer_load_dwordx2 v[88:89], v112, s[12:15], s39 offen offset:0 sc1
    buffer_load_dwordx2 v[90:91], v112, s[12:15], s39 offen offset:512 sc1
    buffer_load_dwordx2 v[92:93], v112, s[12:15], s39 offen offset:1024 sc1
    s_mov_b32 s37, 1
    s_waitcnt vmcnt(0)
    v_xor_b32 v124, s7, v88
    v_bitop3_b32 v124, v124, v89, s7 bitop3:0xf6
    v_bitop3_b32 v124, v124, v90, s7 bitop3:0xf6
    v_bitop3_b32 v124, v124, v91, s7 bitop3:0xf6
    v_bitop3_b32 v124, v124, v92, s7 bitop3:0xf6
    v_bitop3_b32 v124, v124, v93, s7 bitop3:0xf6
    v_and_b32 v124, 1, v124
    v_cmp_ne_u32 vcc, 0, v124
    s_nop 0
    s_nop 0
    s_nop 0
    s_cbranch_vccnz L_rbad_535
L_rok_536:
    v_lshlrev_b32 v124, 16, v88
    v_and_b32 v125, 0xffff0000, v88
    v_add_f32 v96, v116, v124
    v_add_f32 v97, v117, v125
    v_lshlrev_b32 v124, 16, v89
    v_and_b32 v125, 0xffff0000, v89
    v_add_f32 v98, v118, v124
    v_add_f32 v99, v119, v125
    v_lshlrev_b32 v124, 16, v90
    v_and_b32 v125, 0xffff0000, v90
    v_add_f32 v96, v96, v124
    v_add_f32 v97, v97, v125
    v_lshlrev_b32 v124, 16, v91
    v_and_b32 v125, 0xffff0000, v91
    v_add_f32 v98, v98, v124
    v_add_f32 v99, v99, v125
    v_lshlrev_b32 v124, 16, v92
    v_and_b32 v125, 0xffff0000, v92
    v_add_f32 v96, v96, v124
    v_add_f32 v97, v97, v125
    v_lshlrev_b32 v124, 16, v93
    v_and_b32 v125, 0xffff0000, v93
    v_add_f32 v98, v98, v124
    v_add_f32 v99, v99, v125
    ds_write2_b32 v114, v96, v97 offset0:0 offset1:16
    ds_write2_b32 v114, v98, v99 offset0:128 offset1:144
    ds_read_b128 v[88:91], v113 offset:0
    s_waitcnt lgkmcnt(0)
    v_cvt_pk_bf16_f32 v96, 0, v88
    v_cvt_pk_bf16_f32 v97, 0, v89
    v_cvt_pk_bf16_f32 v98, 0, v90
    v_cvt_pk_bf16_f32 v99, 0, v91
    buffer_store_dwordx4 v[96:99], v128, s[16:19], s43 offen
    s_branch L_ste_519
L_rbad_521:
    buffer_load_dwordx2 v[88:89], v112, s[12:15], s39 offen offset:0 sc1
    buffer_load_dwordx2 v[90:91], v112, s[12:15], s39 offen offset:512 sc1
    buffer_load_dwordx2 v[92:93], v112, s[12:15], s39 offen offset:1024 sc1
    s_add_u32 s36, s36, 1
    s_cmp_gt_u32 s36, 0x100000
    s_cbranch_scc1 chain_kernel_wend
    s_waitcnt vmcnt(0)
    v_xor_b32 v124, s7, v88
    v_bitop3_b32 v124, v124, v89, s7 bitop3:0xf6
    v_bitop3_b32 v124, v124, v90, s7 bitop3:0xf6
    v_bitop3_b32 v124, v124, v91, s7 bitop3:0xf6
    v_bitop3_b32 v124, v124, v92, s7 bitop3:0xf6
    v_bitop3_b32 v124, v124, v93, s7 bitop3:0xf6
    v_and_b32 v124, 1, v124
    v_cmp_ne_u32 vcc, 0, v124
    s_cbranch_vccnz L_rbad_521
    s_branch L_rok_522
L_sw_524:
    buffer_load_dword v129, v130, s[12:15], s94 offen sc1
    s_add_u32 s36, s36, 1
    s_cmp_gt_u32 s36, 0x100000
    s_cbranch_scc1 chain_kernel_wend
    s_waitcnt vmcnt(0)
    v_readlane_b32 s28, v129, s3
    s_cmp_lg_u32 s28, 0
    s_cbranch_scc1 L_sok_523
    s_sleep 1
    s_branch L_sw_524
L_gw_526:
    buffer_load_dword v87, v4, s[12:15], s51 offen sc1
    s_add_u32 s36, s36, 1
    s_cmp_gt_u32 s36, 0x100000
    s_cbranch_scc1 chain_kernel_wend
    s_waitcnt vmcnt(0)
    v_readfirstlane_b32 s30, v87
    s_cmp_lt_u32 s30, 8
    s_cbranch_scc0 L_gok_525
    s_sleep 1
    s_branch L_gw_526
L_rbad_527:
    buffer_load_dwordx2 v[88:89], v112, s[12:15], s39 offen offset:0 sc1
    buffer_load_dwordx2 v[90:91], v112, s[12:15], s39 offen offset:512 sc1
    buffer_load_dwordx2 v[92:93], v112, s[12:15], s39 offen offset:1024 sc1
    s_add_u32 s36, s36, 1
    s_cmp_gt_u32 s36, 0x100000
    s_cbranch_scc1 chain_kernel_wend
    s_waitcnt vmcnt(0)
    v_xor_b32 v124, s7, v88
    v_bitop3_b32 v124, v124, v89, s7 bitop3:0xf6
    v_bitop3_b32 v124, v124, v90, s7 bitop3:0xf6
    v_bitop3_b32 v124, v124, v91, s7 bitop3:0xf6
    v_bitop3_b32 v124, v124, v92, s7 bitop3:0xf6
    v_bitop3_b32 v124, v124, v93, s7 bitop3:0xf6
    v_and_b32 v124, 1, v124
    v_cmp_ne_u32 vcc, 0, v124
    s_cbranch_vccnz L_rbad_527
    s_branch L_rok_528
L_sw_530:
    buffer_load_dword v129, v130, s[12:15], s94 offen sc1
    s_add_u32 s36, s36, 1
    s_cmp_gt_u32 s36, 0x100000
    s_cbranch_scc1 chain_kernel_wend
    s_waitcnt vmcnt(0)
    v_readlane_b32 s28, v129, s3
    s_cmp_lg_u32 s28, 0
    s_cbranch_scc1 L_sok_529
    s_sleep 1
    s_branch L_sw_530
L_gw_532:
    buffer_load_dword v87, v4, s[12:15], s51 offen sc1
    s_add_u32 s36, s36, 1
    s_cmp_gt_u32 s36, 0x100000
    s_cbranch_scc1 chain_kernel_wend
    s_waitcnt vmcnt(0)
    v_readfirstlane_b32 s30, v87
    s_cmp_lt_u32 s30, 8
    s_cbranch_scc0 L_gok_531
    s_sleep 1
    s_branch L_gw_532
L_rbad_533:
    buffer_load_dwordx2 v[88:89], v112, s[12:15], s39 offen offset:0 sc1
    buffer_load_dwordx2 v[90:91], v112, s[12:15], s39 offen offset:512 sc1
    buffer_load_dwordx2 v[92:93], v112, s[12:15], s39 offen offset:1024 sc1
    s_add_u32 s36, s36, 1
    s_cmp_gt_u32 s36, 0x100000
    s_cbranch_scc1 chain_kernel_wend
    s_waitcnt vmcnt(0)
    v_xor_b32 v124, s7, v88
    v_bitop3_b32 v124, v124, v89, s7 bitop3:0xf6
    v_bitop3_b32 v124, v124, v90, s7 bitop3:0xf6
    v_bitop3_b32 v124, v124, v91, s7 bitop3:0xf6
    v_bitop3_b32 v124, v124, v92, s7 bitop3:0xf6
    v_bitop3_b32 v124, v124, v93, s7 bitop3:0xf6
    v_and_b32 v124, 1, v124
    v_cmp_ne_u32 vcc, 0, v124
    s_cbranch_vccnz L_rbad_533
    s_branch L_rok_534
L_rbad_535:
    buffer_load_dwordx2 v[88:89], v112, s[12:15], s39 offen offset:0 sc1
    buffer_load_dwordx2 v[90:91], v112, s[12:15], s39 offen offset:512 sc1
    buffer_load_dwordx2 v[92:93], v112, s[12:15], s39 offen offset:1024 sc1
    s_add_u32 s36, s36, 1
    s_cmp_gt_u32 s36, 0x100000
    s_cbranch_scc1 chain_kernel_wend
    s_waitcnt vmcnt(0)
    v_xor_b32 v124, s7, v88
    v_bitop3_b32 v124, v124, v89, s7 bitop3:0xf6
    v_bitop3_b32 v124, v124, v90, s7 bitop3:0xf6
    v_bitop3_b32 v124, v124, v91, s7 bitop3:0xf6
    v_bitop3_b32 v124, v124, v92, s7 bitop3:0xf6
    v_bitop3_b32 v124, v124, v93, s7 bitop3:0xf6
    v_and_b32 v124, 1, v124
    v_cmp_ne_u32 vcc, 0, v124
    s_cbranch_vccnz L_rbad_535
    s_branch L_rok_536
L_fl0_517:
    s_waitcnt lgkmcnt(0)
    s_nop 7
    s_sub_u32 s38, s22, 1
    s_and_b32 s31, s38, 3
    s_lshl_b32 s31, s31, 11
    s_bfe_u32 s38, s38, 0x10002
    s_xor_b32 s38, s38, 1
    s_cmp_eq_u32 s37, 0
    s_cselect_b32 s31, 0x40000000, s31
    s_cselect_b32 s38, 0, s38
    v_cvt_pk_bf16_f32 v104, v53, v57
    v_cvt_pk_bf16_f32 v105, v61, v65
    v_and_or_b32 v104, v104, -2, s38
    v_and_or_b32 v105, v105, -2, s38
    s_add_u32 s29, s45, s31
    buffer_store_dwordx2 v[104:105], v112, s[12:15], s29 offen offset:0 sc1
    v_cvt_pk_bf16_f32 v106, v54, v58
    v_cvt_pk_bf16_f32 v107, v62, v66
    v_and_or_b32 v106, v106, -2, s38
    v_and_or_b32 v107, v107, -2, s38
    s_add_u32 s29, s46, s31
    buffer_store_dwordx2 v[106:107], v112, s[12:15], s29 offen offset:512 sc1
    v_cvt_pk_bf16_f32 v108, v55, v59
    v_cvt_pk_bf16_f32 v109, v63, v67
    v_and_or_b32 v108, v108, -2, s38
    v_and_or_b32 v109, v109, -2, s38
    s_add_u32 s29, s47, s31
    buffer_store_dwordx2 v[108:109], v112, s[12:15], s29 offen offset:1024 sc1
    s_waitcnt vmcnt(0)
    v_xor_b32 v124, s7, v88
    v_bitop3_b32 v124, v124, v89, s7 bitop3:0xf6
    v_bitop3_b32 v124, v124, v90, s7 bitop3:0xf6
    v_bitop3_b32 v124, v124, v91, s7 bitop3:0xf6
    v_bitop3_b32 v124, v124, v92, s7 bitop3:0xf6
    v_bitop3_b32 v124, v124, v93, s7 bitop3:0xf6
    v_and_b32 v124, 1, v124
    v_cmp_ne_u32 vcc, 0, v124
    s_nop 0
    s_nop 0
    s_nop 0
    s_cbranch_vccnz L_rbad_537
L_rok_538:
    v_lshlrev_b32 v124, 16, v88
    v_and_b32 v125, 0xffff0000, v88
    v_add_f32 v96, v116, v124
    v_add_f32 v97, v117, v125
    v_lshlrev_b32 v124, 16, v89
    v_and_b32 v125, 0xffff0000, v89
    v_add_f32 v98, v118, v124
    v_add_f32 v99, v119, v125
    v_lshlrev_b32 v124, 16, v90
    v_and_b32 v125, 0xffff0000, v90
    v_add_f32 v96, v96, v124
    v_add_f32 v97, v97, v125
    v_lshlrev_b32 v124, 16, v91
    v_and_b32 v125, 0xffff0000, v91
    v_add_f32 v98, v98, v124
    v_add_f32 v99, v99, v125
    v_lshlrev_b32 v124, 16, v92
    v_and_b32 v125, 0xffff0000, v92
    v_add_f32 v96, v96, v124
    v_add_f32 v97, v97, v125
    v_lshlrev_b32 v124, 16, v93
    v_and_b32 v125, 0xffff0000, v93
    v_add_f32 v98, v98, v124
    v_add_f32 v99, v99, v125
    ds_write2_b32 v114, v96, v97 offset0:0 offset1:16
    ds_write2_b32 v114, v98, v99 offset0:128 offset1:144
    ds_read_b128 v[88:91], v113 offset:0
    s_waitcnt lgkmcnt(0)
    v_cvt_pk_bf16_f32 v96, 0, v88
    v_cvt_pk_bf16_f32 v97, 0, v89
    v_cvt_pk_bf16_f32 v98, 0, v90
    v_cvt_pk_bf16_f32 v99, 0, v91
    buffer_store_dwordx4 v[96:99], v128, s[16:19], s43 offen
    v_mov_b32 v116, v52
    v_mov_b32 v117, v56
    v_mov_b32 v118, v60
    v_mov_b32 v119, v64
    s_mov_b32 s7, s38
    s_add_u32 s39, s44, s31
    s_sub_u32 s43, s22, 1
    s_and_b32 s43, s43, 63
    v_readlane_b32 s43, v129, s43
    s_nop 0
    s_nop 0
    s_sub_u32 s43, s43, 1
    s_lshl_b32 s43, s43, 18
    s_cmp_eq_u32 s37, 0
    s_cselect_b32 s43, 0x7ff00000, s43
    buffer_load_dwordx2 v[88:89], v112, s[12:15], s39 offen offset:0 sc1
    buffer_load_dwordx2 v[90:91], v112, s[12:15], s39 offen offset:512 sc1
    buffer_load_dwordx2 v[92:93], v112, s[12:15], s39 offen offset:1024 sc1
    s_mov_b32 s37, 1
    s_waitcnt vmcnt(0)
    v_xor_b32 v124, s7, v88
    v_bitop3_b32 v124, v124, v89, s7 bitop3:0xf6
    v_bitop3_b32 v124, v124, v90, s7 bitop3:0xf6
    v_bitop3_b32 v124, v124, v91, s7 bitop3:0xf6
    v_bitop3_b32 v124, v124, v92, s7 bitop3:0xf6
    v_bitop3_b32 v124, v124, v93, s7 bitop3:0xf6
    v_and_b32 v124, 1, v124
    v_cmp_ne_u32 vcc, 0, v124
    s_nop 0
    s_nop 0
    s_nop 0
    s_cbranch_vccnz L_rbad_539
L_rok_540:
    v_lshlrev_b32 v124, 16, v88
    v_and_b32 v125, 0xffff0000, v88
    v_add_f32 v96, v116, v124
    v_add_f32 v97, v117, v125
    v_lshlrev_b32 v124, 16, v89
    v_and_b32 v125, 0xffff0000, v89
    v_add_f32 v98, v118, v124
    v_add_f32 v99, v119, v125
    v_lshlrev_b32 v124, 16, v90
    v_and_b32 v125, 0xffff0000, v90
    v_add_f32 v96, v96, v124
    v_add_f32 v97, v97, v125
    v_lshlrev_b32 v124, 16, v91
    v_and_b32 v125, 0xffff0000, v91
    v_add_f32 v98, v98, v124
    v_add_f32 v99, v99, v125
    v_lshlrev_b32 v124, 16, v92
    v_and_b32 v125, 0xffff0000, v92
    v_add_f32 v96, v96, v124
    v_add_f32 v97, v97, v125
    v_lshlrev_b32 v124, 16, v93
    v_and_b32 v125, 0xffff0000, v93
    v_add_f32 v98, v98, v124
    v_add_f32 v99, v99, v125
    ds_write2_b32 v114, v96, v97 offset0:0 offset1:16
    ds_write2_b32 v114, v98, v99 offset0:128 offset1:144
    ds_read_b128 v[88:91], v113 offset:0
    s_waitcnt lgkmcnt(0)
    v_cvt_pk_bf16_f32 v96, 0, v88
    v_cvt_pk_bf16_f32 v97, 0, v89
    v_cvt_pk_bf16_f32 v98, 0, v90
    v_cvt_pk_bf16_f32 v99, 0, v91
    buffer_store_dwordx4 v[96:99], v128, s[16:19], s43 offen
    s_branch L_ste_519
L_rbad_537:
    buffer_load_dwordx2 v[88:89], v112, s[12:15], s39 offen offset:0 sc1
    buffer_load_dwordx2 v[90:91], v112, s[12:15], s39 offen offset:512 sc1
    buffer_load_dwordx2 v[92:93], v112, s[12:15], s39 offen offset:1024 sc1
    s_add_u32 s36, s36, 1
    s_cmp_gt_u32 s36, 0x100000
    s_cbranch_scc1 chain_kernel_wend
    s_waitcnt vmcnt(0)
    v_xor_b32 v124, s7, v88
    v_bitop3_b32 v124, v124, v89, s7 bitop3:0xf6
    v_bitop3_b32 v124, v124, v90, s7 bitop3:0xf6
    v_bitop3_b32 v124, v124, v91, s7 bitop3:0xf6
    v_bitop3_b32 v124, v124, v92, s7 bitop3:0xf6
    v_bitop3_b32 v124, v124, v93, s7 bitop3:0xf6
    v_and_b32 v124, 1, v124
    v_cmp_ne_u32 vcc, 0, v124
    s_cbranch_vccnz L_rbad_537
    s_branch L_rok_538
L_rbad_539:
    buffer_load_dwordx2 v[88:89], v112, s[12:15], s39 offen offset:0 sc1
    buffer_load_dwordx2 v[90:91], v112, s[12:15], s39 offen offset:512 sc1
    buffer_load_dwordx2 v[92:93], v112, s[12:15], s39 offen offset:1024 sc1
    s_add_u32 s36, s36, 1
    s_cmp_gt_u32 s36, 0x100000
    s_cbranch_scc1 chain_kernel_wend
    s_waitcnt vmcnt(0)
    v_xor_b32 v124, s7, v88
    v_bitop3_b32 v124, v124, v89, s7 bitop3:0xf6
    v_bitop3_b32 v124, v124, v90, s7 bitop3:0xf6
    v_bitop3_b32 v124, v124, v91, s7 bitop3:0xf6
    v_bitop3_b32 v124, v124, v92, s7 bitop3:0xf6
    v_bitop3_b32 v124, v124, v93, s7 bitop3:0xf6
    v_and_b32 v124, 1, v124
    v_cmp_ne_u32 vcc, 0, v124
    s_cbranch_vccnz L_rbad_539
    s_branch L_rok_540
L_ste_519:
L_opdone_510:
chain_kernel_wend:
chain_kernel_end:
    s_endpgm
.section .rodata,"a"
.p2align 6
.amdhsa_kernel chain_kernel
  .amdhsa_next_free_vgpr 512
  .amdhsa_next_free_sgpr 102
  .amdhsa_accum_offset 256
  .amdhsa_group_segment_fixed_size 0
  .amdhsa_kernarg_size 152
  .amdhsa_user_sgpr_count 2
  .amdhsa_user_sgpr_kernarg_segment_ptr 1
  .amdhsa_system_sgpr_workgroup_id_x 1
  .amdhsa_float_denorm_mode_32 3
  .amdhsa_float_denorm_mode_16_64 3
.end_amdhsa_kernel
```

```asm
; @launch kernel=chain_kernel grid=(256,1,1) block=(256,1,1) lds=163840
.amdgcn_target "amdgcn-amd-amdhsa--gfx950"
.text
.globl chain_kernel
.p2align 8
.type chain_kernel,@function
chain_kernel:
s_cmp_lt_u32 s2, 256
s_cbranch_scc1 chain_kernel_go
chain_kernel_end0:
s_endpgm
chain_kernel_go:
s_load_dwordx16 s[64:79], s[0:1], 0
s_load_dwordx16 s[80:95], s[0:1], 64
s_load_dwordx4 s[96:99], s[0:1], 128
s_load_dwordx2 s[100:101], s[0:1], 144
s_waitcnt lgkmcnt(0)
s_getpc_b64 s[4:5]
L_pc_1:
s_lshr_b32 s3, s2, 3
s_and_b32 s3, s3, 31
s_lshl_b32 s3, s3, 6
v_and_b32 v14, 63, v0
v_add_u32 v14, s3, v14
v_lshlrev_b32 v14, 6, v14
v_min_u32 v14, chain_kernel_end - L_pc_1, v14
global_load_dword v15, v14, s[4:5]
s_getreg_b32 s16, hwreg(HW_REG_XCC_ID)
s_and_b32 s16, s16, 7
v_lshrrev_b32 v3, 6, v0
s_mov_b32 s12, s98
s_and_b32 s13, s99, 0xffff
s_mov_b32 s14, 0x100
s_mov_b32 s15, 0x00020000
v_readfirstlane_b32 s18, v3
s_lshl_b32 s3, s16, 5
v_mov_b32 v12, 1
v_lshlrev_b32 v13, 8, v0
buffer_atomic_add v12, v13, s[12:15], s3 offen offset:24 sc0 sc1
s_add_u32 s8, s100, 0x5000000
s_addc_u32 s9, s101, 0
s_and_b32 s9, s9, 0xffff
s_mov_b32 s10, 0x180000
s_mov_b32 s11, 0x00020000
s_lshl_b32 s3, s2, 13
v_lshlrev_b32 v1, 4, v0
v_mov_b32 v4, 0xff81ff81
v_mov_b32 v5, 0xff81ff81
v_mov_b32 v6, 0xff81ff81
v_mov_b32 v7, 0xff81ff81
buffer_store_dwordx4 v[4:7], v1, s[8:11], s3 offen sc1
s_add_u32 s3, s3, 4096
buffer_store_dwordx4 v[4:7], v1, s[8:11], s3 offen sc1
s_add_u32 s3, s3, 4096
s_add_u32 s8, s100, 0x8000000
s_addc_u32 s9, s101, 0
s_and_b32 s9, s9, 0xffff
s_mov_b32 s10, 0x4600000
s_mov_b32 s11, 0x00020000
s_add_u32 s4, s8, 0x1fffff
s_and_b32 s4, s4, 0xffe00000
s_sub_u32 s4, s4, s8
s_add_u32 s8, s100, 0x5900000
s_addc_u32 s9, s101, 0
s_and_b32 s9, s9, 0xffff
s_mov_b32 s10, 0x10000
s_mov_b32 s11, 0x00020000
s_lshl_b32 s3, s2, 12
v_mov_b32 v8, 0
v_mov_b32 v9, 0
v_mov_b32 v10, 0
v_mov_b32 v11, 0
buffer_store_dwordx4 v[8:11], v1, s[8:11], s3 offen sc1
s_cmp_lg_u32 s18, 1
s_cbranch_scc1 L_role_2
s_mov_b32 s7, 1
s_cmp_lg_u32 s16, 7
s_cbranch_scc1 L_rolew_3
s_lshr_b32 s6, s2, 7
s_lshl_b32 s6, s6, 8
s_add_u32 s4, s4, s6
s_and_b32 s5, s2, 127
s_lshl_b32 s5, s5, 14
s_add_u32 s5, s5, s4
s_add_u32 s5, s5, 0xc000800
s_add_u32 s12, s100, s5
s_addc_u32 s13, s101, 0
s_mov_b32 s5, 0
s_mov_b32 s6, 0
s_atomic_add s5, s[12:13], 0x0 glc
s_atomic_add s6, s[12:13], 0x2000 glc
s_mov_b32 s24, -1
s_mov_b32 s25, -1
s_waitcnt lgkmcnt(0)
s_mov_b32 s5, 0
s_memtime s[20:21]
s_waitcnt lgkmcnt(0)
s_atomic_add s5, s[12:13], 0x0 glc
s_waitcnt lgkmcnt(0)
s_memtime s[22:23]
s_waitcnt lgkmcnt(0)
s_sub_u32 s22, s22, s20
s_min_u32 s24, s24, s22
s_mov_b32 s5, 0
s_memtime s[20:21]
s_waitcnt lgkmcnt(0)
s_atomic_add s5, s[12:13], 0x2000 glc
s_waitcnt lgkmcnt(0)
s_memtime s[22:23]
s_waitcnt lgkmcnt(0)
s_sub_u32 s22, s22, s20
s_min_u32 s25, s25, s22
s_cmp_gt_u32 s25, s24
s_cselect_b32 s7, 0x10001, 1
L_rolew_3:
L_role_2:
v_lshlrev_b32 v2, 2, v0
s_waitcnt vmcnt(0)
ds_write_b32 v2, v12 offset:0
s_waitcnt lgkmcnt(0)
s_barrier
v_mov_b32 v2, 0
ds_read_b32 v4, v2 offset:0
s_waitcnt lgkmcnt(0)
v_readfirstlane_b32 s17, v4
s_cmp_lg_u32 s18, 1
s_cbranch_scc1 L_nosig_4
s_cmp_lt_u32 s17, 32
s_cbranch_scc1 L_noovf_5
s_mov_b32 s5, 1
s_atomic_add s5, s[98:99], 0x8 glc
s_waitcnt lgkmcnt(0)
L_noovf_5:
s_atomic_add s7, s[98:99], 0x0
L_nosig_4:
s_cmp_lt_u32 s17, 32
s_cbranch_scc1 L_hasrole_6
s_mov_b32 s12, s98
s_and_b32 s13, s99, 0xffff
s_mov_b32 s14, 0x100
s_mov_b32 s15, 0x00020000
v_and_b32 v1, 7, v0
v_lshlrev_b32 v1, 5, v1
v_mov_b32 v2, 0
s_mov_b32 s3, 0
L_ovw_7:
buffer_load_dword v4, v2, s[12:15], 0 offen sc1
s_add_u32 s3, s3, 1
s_cmp_gt_u32 s3, 0x100000
s_cbranch_scc1 chain_kernel_end0
s_waitcnt vmcnt(0)
v_readfirstlane_b32 s5, v4
s_and_b32 s5, s5, 0xffff
s_cmp_lt_u32 s5, 256
s_cbranch_scc1 L_ovw_7
buffer_load_dword v4, v1, s[12:15], 0 offen offset:24 sc1
s_sub_u32 s17, s17, 32
s_waitcnt vmcnt(0)
v_readlane_b32 s20, v4, 0
v_readlane_b32 s21, v4, 1
v_readlane_b32 s22, v4, 2
v_readlane_b32 s23, v4, 3
v_readlane_b32 s24, v4, 4
v_readlane_b32 s25, v4, 5
v_readlane_b32 s26, v4, 6
v_readlane_b32 s27, v4, 7
s_max_u32 s5, s20, 32
s_sub_u32 s5, s5, 32
s_cmp_gt_u32 s16, 0
s_cselect_b32 s5, s5, 0
s_add_u32 s17, s17, s5
s_max_u32 s5, s21, 32
s_sub_u32 s5, s5, 32
s_cmp_gt_u32 s16, 1
s_cselect_b32 s5, s5, 0
s_add_u32 s17, s17, s5
s_max_u32 s5, s22, 32
s_sub_u32 s5, s5, 32
s_cmp_gt_u32 s16, 2
s_cselect_b32 s5, s5, 0
s_add_u32 s17, s17, s5
s_max_u32 s5, s23, 32
s_sub_u32 s5, s5, 32
s_cmp_gt_u32 s16, 3
s_cselect_b32 s5, s5, 0
s_add_u32 s17, s17, s5
s_max_u32 s5, s24, 32
s_sub_u32 s5, s5, 32
s_cmp_gt_u32 s16, 4
s_cselect_b32 s5, s5, 0
s_add_u32 s17, s17, s5
s_max_u32 s5, s25, 32
s_sub_u32 s5, s5, 32
s_cmp_gt_u32 s16, 5
s_cselect_b32 s5, s5, 0
s_add_u32 s17, s17, s5
s_max_u32 s5, s26, 32
s_sub_u32 s5, s5, 32
s_cmp_gt_u32 s16, 6
s_cselect_b32 s5, s5, 0
s_add_u32 s17, s17, s5
s_min_u32 s5, s20, 32
s_add_u32 s17, s17, s5
s_mov_b32 s16, 0
s_cmp_lt_u32 s17, 32
s_cbranch_scc1 L_hasrole_6
s_sub_u32 s17, s17, 32
s_min_u32 s5, s21, 32
s_add_u32 s17, s17, s5
s_mov_b32 s16, 1
s_cmp_lt_u32 s17, 32
s_cbranch_scc1 L_hasrole_6
s_sub_u32 s17, s17, 32
s_min_u32 s5, s22, 32
s_add_u32 s17, s17, s5
s_mov_b32 s16, 2
s_cmp_lt_u32 s17, 32
s_cbranch_scc1 L_hasrole_6
s_sub_u32 s17, s17, 32
s_min_u32 s5, s23, 32
s_add_u32 s17, s17, s5
s_mov_b32 s16, 3
s_cmp_lt_u32 s17, 32
s_cbranch_scc1 L_hasrole_6
s_sub_u32 s17, s17, 32
s_min_u32 s5, s24, 32
s_add_u32 s17, s17, s5
s_mov_b32 s16, 4
s_cmp_lt_u32 s17, 32
s_cbranch_scc1 L_hasrole_6
s_sub_u32 s17, s17, 32
s_min_u32 s5, s25, 32
s_add_u32 s17, s17, s5
s_mov_b32 s16, 5
s_cmp_lt_u32 s17, 32
s_cbranch_scc1 L_hasrole_6
s_sub_u32 s17, s17, 32
s_min_u32 s5, s26, 32
s_add_u32 s17, s17, s5
s_mov_b32 s16, 6
s_cmp_lt_u32 s17, 32
s_cbranch_scc1 L_hasrole_6
s_sub_u32 s17, s17, 32
s_min_u32 s5, s27, 32
s_add_u32 s17, s17, s5
s_mov_b32 s16, 7
s_cmp_lt_u32 s17, 32
s_cbranch_scc1 L_hasrole_6
s_sub_u32 s17, s17, 32
s_branch chain_kernel_end0
L_hasrole_6:
s_cmp_ge_u32 s16, 4
s_cbranch_scc1 chain_kernel_worker
s_mov_b32 s8, s100
s_and_b32 s9, s101, 0xffff
s_mov_b32 s10, 0x10000000
s_mov_b32 s11, 0x00020000
s_mov_b32 s33, 0
s_mov_b32 s24, 0xff00ff
s_mov_b32 s25, 0xff00ff
s_mov_b32 s26, 0xff00ff00
s_mov_b32 s27, 0xff00ff00
s_mov_b32 s28, 0x0
s_mov_b32 s29, 0xff00ff
s_mov_b32 s48, 0xffffffff
s_mov_b32 s49, 0x0
s_mov_b32 s50, 0xffff
s_mov_b32 s51, 0x0
s_mov_b32 s44, 0x3e0293ee
s_mov_b32 s45, 0x3e0293ee
s_mov_b32 s46, 0x3db504f3
s_mov_b32 s47, 0x3db504f3
s_mov_b32 s34, 0xff81ff81
s_lshl_b32 s36, s16, 14
s_add_u32 s36, s36, 0x5000000
s_lshl_b32 s37, s16, 16
s_add_u32 s37, s37, 0x5040000
v_mov_b32 v36, s34
v_mov_b32 v44, 0x3f803f80
v_mov_b32 v37, s34
v_mov_b32 v45, 0x3f803f80
v_mov_b32 v38, s34
v_mov_b32 v46, 0x3f803f80
v_mov_b32 v39, s34
v_mov_b32 v47, 0x3f803f80
v_and_b32 v250, 63, v0
v_and_b32 v248, 15, v0
v_bfe_u32 v249, v0, 4, 2
v_lshrrev_b32 v251, 6, v0
v_lshlrev_b32 v1, 4, v250
s_lshl_b32 s20, s16, 10
s_lshl_b32 s21, s17, 5
s_add_u32 s20, s20, s21
s_and_b32 s30, s17, 3
v_lshl_add_u32 v252, v251, 12, v1
s_add_u32 s21, s30, 0
s_and_b32 s21, s21, 3
s_lshl_b32 s21, s21, 10
v_add_u32 v2, s21, v252
s_add_u32 s21, s30, 1
s_and_b32 s21, s21, 3
s_lshl_b32 s21, s21, 10
v_add_u32 v3, s21, v252
s_add_u32 s21, s30, 2
s_and_b32 s21, s21, 3
s_lshl_b32 s21, s21, 10
v_add_u32 v4, s21, v252
s_add_u32 s21, s30, 3
s_and_b32 s21, s21, 3
s_lshl_b32 s21, s21, 10
v_add_u32 v5, s21, v252
v_mov_b32 v6, 0x44444444
v_mov_b32 v252, 0xeeeeeeee
v_cndmask_b32 v6, v6, v252, s[26:27]
v_bfe_u32 v252, v250, 1, 3
v_and_b32 v253, 1, v250
v_lshlrev_b32 v33, 11, v252
v_lshl_add_u32 v33, v253, 3, v33
v_lshl_add_u32 v33, v249, 4, v33
s_xor_b32 s22, s17, 8
s_lshl_b32 s21, s22, 6
v_add_u32 v33, s21, v33
v_lshlrev_b32 v8, 3, v250
s_xor_b32 s21, s17, 2
s_lshl_b32 s21, s21, 9
v_add_u32 v28, s21, v8
s_lshl_b32 s22, s22, 9
v_add_u32 v8, s22, v8
v_lshlrev_b32 v11, 4, v248
v_lshl_add_u32 v11, v249, 7, v11
v_add_u32 v11, s21, v11
s_lshr_b32 s22, s17, 2
s_lshl_b32 s22, s22, 13
s_add_u32 s21, s17, 0
s_and_b32 s21, s21, 3
s_lshl_b32 s21, s21, 10
s_add_u32 s21, s21, s22
v_add_u32 v9, s21, v1
s_add_u32 s21, s17, 1
s_and_b32 s21, s21, 3
s_lshl_b32 s21, s21, 10
s_add_u32 s21, s21, s22
v_add_u32 v13, s21, v1
s_add_u32 s21, s17, 2
s_and_b32 s21, s21, 3
s_lshl_b32 s21, s21, 10
s_add_u32 s21, s21, s22
v_add_u32 v14, s21, v1
s_add_u32 s21, s17, 3
s_and_b32 s21, s21, 3
s_lshl_b32 s21, s21, 10
s_add_u32 s21, s21, s22
v_add_u32 v15, s21, v1
s_add_u32 s22, s22, 4096
v_add_u32 v16, s22, v1
s_and_b32 s21, s17, 3
s_lshl_b32 s21, s21, 8
s_add_u32 s21, s21, s22
v_and_b32 v253, 1, v249
v_lshlrev_b32 v10, 4, v248
v_lshl_add_u32 v10, v253, 7, v10
v_add_u32 v10, s21, v10
v_lshl_add_u32 v20, v251, 11, v1
v_lshrrev_b32 v252, 1, v249
v_lshl_add_u32 v252, v251, 1, v252
v_lshlrev_b32 v21, 10, v252
v_lshl_add_u32 v21, v248, 5, v21
v_lshl_add_u32 v21, v253, 4, v21
v_add_u32 v21, 8192, v21
v_lshlrev_b32 v22, 5, v248
v_lshl_add_u32 v22, v249, 3, v22
v_add_u32 v22, 8192, v22
v_lshrrev_b32 v253, 2, v248
v_and_b32 v252, 3, v248
v_lshl_add_u32 v253, v253, 3, v252
v_add_u32 v25, 24576, v1
v_add_u32 v26, 26624, v1
v_lshlrev_b32 v32, 4, v253
v_lshl_add_u32 v29, v249, 9, v32
v_lshl_add_u32 v32, v249, 2, v32
v_add_u32 v32, 33792, v32
s_add_u32 s21, s16, 0
s_and_b32 s21, s21, 3
s_lshl_b32 s21, s21, 18
s_lshr_b32 s22, s17, 1
s_lshl_b32 s22, s22, 14
s_add_u32 s21, s21, s22
s_and_b32 s22, s17, 1
s_lshl_b32 s22, s22, 12
s_add_u32 s23, s21, s22
v_lshl_add_u32 v12, v250, 3, s23
s_add_u32 s21, s16, 1
s_and_b32 s21, s21, 3
s_lshl_b32 s21, s21, 18
s_lshr_b32 s22, s17, 1
s_lshl_b32 s22, s22, 14
s_add_u32 s21, s21, s22
s_and_b32 s22, s17, 1
s_lshl_b32 s22, s22, 12
s_add_u32 s21, s21, s22
v_lshl_add_u32 v17, v250, 3, s21
s_add_u32 s21, s16, 2
s_and_b32 s21, s21, 3
s_lshl_b32 s21, s21, 18
s_lshr_b32 s22, s17, 1
s_lshl_b32 s22, s22, 14
s_add_u32 s21, s21, s22
s_and_b32 s22, s17, 1
s_lshl_b32 s22, s22, 12
s_add_u32 s21, s21, s22
v_lshl_add_u32 v18, v250, 3, s21
s_add_u32 s21, s16, 3
s_and_b32 s21, s21, 3
s_lshl_b32 s21, s21, 18
s_lshr_b32 s22, s17, 1
s_lshl_b32 s22, s22, 14
s_add_u32 s21, s21, s22
s_and_b32 s22, s17, 1
s_lshl_b32 s22, s22, 12
s_add_u32 s21, s21, s22
v_lshl_add_u32 v19, v250, 3, s21
s_xor_b32 s21, s23, 0x4000
v_add_u32 v29, s21, v29
v_add_u32 v31, s21, v1
v_and_b32 v253, 8, v248
v_add_u32 v253, v253, v248
v_lshlrev_b32 v27, 4, v253
v_lshl_add_u32 v27, v249, 9, v27
v_add_u32 v27, s23, v27
v_bfe_u32 v253, v248, 2, 1
v_lshl_add_u32 v252, v252, 1, v253
v_cndmask_b32 v252, v248, v252, s[26:27]
v_lshlrev_b32 v30, 4, v252
v_lshl_add_u32 v30, v249, 7, v30
v_add_u32 v30, s23, v30
v_and_b32 v253, 1, v252
v_lshlrev_b32 v253, 4, v253
v_mov_b32 v254, 0x3f80
v_lshlrev_b32 v254, v253, v254
v_lshrrev_b32 v253, 2, v252
v_xor_b32 v253, v253, v249
v_and_b32 v253, 1, v253
v_bfe_u32 v252, v252, 1, 1
v_lshl_add_u32 v252, v253, 2, v252
v_lshrrev_b32 v253, 3, v248
v_lshl_add_u32 v252, v253, 1, v252
v_cmp_eq_u32 vcc, 0, v252
s_nop 1
v_cndmask_b32 v40, 0, v254, vcc
v_cmp_eq_u32 vcc, 1, v252
s_nop 1
v_cndmask_b32 v41, 0, v254, vcc
v_cmp_eq_u32 vcc, 2, v252
s_nop 1
v_cndmask_b32 v42, 0, v254, vcc
v_cmp_eq_u32 vcc, 3, v252
s_nop 1
v_cndmask_b32 v43, 0, v254, vcc
v_bfe_u32 v248, v0, 4, 2
v_lshlrev_b32 v250, 1, v248
v_bfe_u32 v248, v0, 2, 1
v_add_u32 v250, v250, v248
v_bfe_u32 v248, v0, 3, 1
v_lshl_add_u32 v250, v248, 3, v250
v_lshrrev_b32 v248, 6, v0
v_lshl_add_u32 v250, v248, 8, v250
v_and_b32 v249, 3, v0
v_lshlrev_b32 v251, 13, v250
v_lshl_add_u32 v251, v249, 4, v251
s_lshl_b32 s21, s20, 1
v_add_u32 v251, s21, v251
s_lshl_b32 s21, s16, 10
v_add_u32 v252, s21, v250
v_lshlrev_b32 v252, 11, v252
v_lshl_add_u32 v252, v249, 4, v252
s_xor_b32 s21, s17, 8
s_lshl_b32 s21, s21, 6
v_add_u32 v252, s21, v252
v_bfe_u32 v248, v0, 4, 2
v_lshlrev_b32 v248, 3, v248
v_bfe_u32 v242, v0, 2, 2
v_add_u32 v248, v248, v242
v_lshlrev_b32 v242, 6, v248
v_lshrrev_b32 v248, 6, v0
v_lshl_add_u32 v242, v248, 14, v242
v_lshl_add_u32 v240, v249, 3, v242
v_and_b32 v241, 2, v249
v_lshl_add_u32 v240, v241, 3, v240
v_lshl_add_u32 v242, v249, 4, v242
v_add_u32 v241, 0x10000, v240
v_add_u32 v243, 0x10000, v242
v_lshl_add_u32 v244, v248, 14, v1
v_add_u32 v245, 0x10000, v244
s_lshl_b32 s22, s18, 14
s_add_u32 s22, s22, 32768
s_and_b32 s23, s17, 14
s_cmp_eq_u32 s23, 6
s_cselect_b64 vcc, 0, -1
v_xor_b32 v253, 128, v251
s_mov_b32 s12, s88
s_and_b32 s13, s89, 0xffff
s_mov_b32 s14, 0x800000
s_mov_b32 s15, 0x00020000
s_add_u32 m0, s22, 0
s_add_u32 s23, s30, 0
s_and_b32 s23, s23, 3
s_lshl_b32 s23, s23, 2
s_add_u32 s23, s23, 0
s_mul_i32 s23, s23, 131072
buffer_load_dwordx4 v251, s[12:15], s23 offen lds
s_add_u32 m0, s22, 1024
s_add_u32 s23, s30, 0
s_and_b32 s23, s23, 3
s_lshl_b32 s23, s23, 2
s_add_u32 s23, s23, 1
s_mul_i32 s23, s23, 131072
buffer_load_dwordx4 v251, s[12:15], s23 offen lds
s_add_u32 m0, s22, 2048
s_add_u32 s23, s30, 0
s_and_b32 s23, s23, 3
s_lshl_b32 s23, s23, 2
s_add_u32 s23, s23, 2
s_mul_i32 s23, s23, 131072
buffer_load_dwordx4 v251, s[12:15], s23 offen lds
s_add_u32 m0, s22, 3072
s_add_u32 s23, s30, 0
s_and_b32 s23, s23, 3
s_lshl_b32 s23, s23, 2
s_add_u32 s23, s23, 3
s_mul_i32 s23, s23, 131072
buffer_load_dwordx4 v251, s[12:15], s23 offen lds
s_add_u32 m0, s22, 4096
s_add_u32 s23, s30, 1
s_and_b32 s23, s23, 3
s_lshl_b32 s23, s23, 2
s_add_u32 s23, s23, 0
s_mul_i32 s23, s23, 131072
buffer_load_dwordx4 v251, s[12:15], s23 offen lds
s_add_u32 m0, s22, 5120
s_add_u32 s23, s30, 1
s_and_b32 s23, s23, 3
s_lshl_b32 s23, s23, 2
s_add_u32 s23, s23, 1
s_mul_i32 s23, s23, 131072
buffer_load_dwordx4 v251, s[12:15], s23 offen lds
s_add_u32 m0, s22, 6144
s_add_u32 s23, s30, 1
s_and_b32 s23, s23, 3
s_lshl_b32 s23, s23, 2
s_add_u32 s23, s23, 2
s_mul_i32 s23, s23, 131072
buffer_load_dwordx4 v251, s[12:15], s23 offen lds
s_add_u32 m0, s22, 7168
s_add_u32 s23, s30, 1
s_and_b32 s23, s23, 3
s_lshl_b32 s23, s23, 2
s_add_u32 s23, s23, 3
s_mul_i32 s23, s23, 131072
buffer_load_dwordx4 v251, s[12:15], s23 offen lds
s_add_u32 m0, s22, 8192
s_add_u32 s23, s30, 2
s_and_b32 s23, s23, 3
s_lshl_b32 s23, s23, 2
s_add_u32 s23, s23, 0
s_mul_i32 s23, s23, 131072
buffer_load_dwordx4 v251, s[12:15], s23 offen lds
s_add_u32 m0, s22, 9216
s_add_u32 s23, s30, 2
s_and_b32 s23, s23, 3
s_lshl_b32 s23, s23, 2
s_add_u32 s23, s23, 1
s_mul_i32 s23, s23, 131072
buffer_load_dwordx4 v251, s[12:15], s23 offen lds
s_add_u32 m0, s22, 10240
s_add_u32 s23, s30, 2
s_and_b32 s23, s23, 3
s_lshl_b32 s23, s23, 2
s_add_u32 s23, s23, 2
s_mul_i32 s23, s23, 131072
buffer_load_dwordx4 v251, s[12:15], s23 offen lds
s_add_u32 m0, s22, 11264
s_add_u32 s23, s30, 2
s_and_b32 s23, s23, 3
s_lshl_b32 s23, s23, 2
s_add_u32 s23, s23, 3
s_mul_i32 s23, s23, 131072
buffer_load_dwordx4 v251, s[12:15], s23 offen lds
s_add_u32 m0, s22, 12288
s_add_u32 s23, s30, 3
s_and_b32 s23, s23, 3
s_lshl_b32 s23, s23, 2
s_add_u32 s23, s23, 0
s_mul_i32 s23, s23, 131072
buffer_load_dwordx4 v251, s[12:15], s23 offen lds
s_add_u32 m0, s22, 13312
s_add_u32 s23, s30, 3
s_and_b32 s23, s23, 3
s_lshl_b32 s23, s23, 2
s_add_u32 s23, s23, 1
s_mul_i32 s23, s23, 131072
buffer_load_dwordx4 v251, s[12:15], s23 offen lds
s_add_u32 m0, s22, 14336
s_add_u32 s23, s30, 3
s_and_b32 s23, s23, 3
s_lshl_b32 s23, s23, 2
s_add_u32 s23, s23, 2
s_mul_i32 s23, s23, 131072
buffer_load_dwordx4 v251, s[12:15], s23 offen lds
s_add_u32 m0, s22, 15360
s_add_u32 s23, s30, 3
s_and_b32 s23, s23, 3
s_lshl_b32 s23, s23, 2
s_add_u32 s23, s23, 3
s_mul_i32 s23, s23, 131072
buffer_load_dwordx4 v251, s[12:15], s23 offen lds
s_mov_b32 s12, s90
s_and_b32 s13, s91, 0xffff
s_mov_b32 s14, 0x800000
s_mov_b32 s15, 0x00020000
s_add_u32 m0, s22, 65536
s_add_u32 s23, s30, 0
s_and_b32 s23, s23, 3
s_lshl_b32 s23, s23, 2
s_add_u32 s23, s23, 0
s_mul_i32 s23, s23, 131072
buffer_load_dwordx4 v253, s[12:15], s23 offen lds
s_add_u32 m0, s22, 66560
s_add_u32 s23, s30, 0
s_and_b32 s23, s23, 3
s_lshl_b32 s23, s23, 2
s_add_u32 s23, s23, 1
s_mul_i32 s23, s23, 131072
buffer_load_dwordx4 v253, s[12:15], s23 offen lds
s_add_u32 m0, s22, 67584
s_add_u32 s23, s30, 0
s_and_b32 s23, s23, 3
s_lshl_b32 s23, s23, 2
s_add_u32 s23, s23, 2
s_mul_i32 s23, s23, 131072
buffer_load_dwordx4 v253, s[12:15], s23 offen lds
s_add_u32 m0, s22, 68608
s_add_u32 s23, s30, 0
s_and_b32 s23, s23, 3
s_lshl_b32 s23, s23, 2
s_add_u32 s23, s23, 3
s_mul_i32 s23, s23, 131072
buffer_load_dwordx4 v253, s[12:15], s23 offen lds
s_add_u32 m0, s22, 69632
s_add_u32 s23, s30, 1
s_and_b32 s23, s23, 3
s_lshl_b32 s23, s23, 2
s_add_u32 s23, s23, 0
s_mul_i32 s23, s23, 131072
buffer_load_dwordx4 v253, s[12:15], s23 offen lds
s_add_u32 m0, s22, 70656
s_add_u32 s23, s30, 1
s_and_b32 s23, s23, 3
s_lshl_b32 s23, s23, 2
s_add_u32 s23, s23, 1
s_mul_i32 s23, s23, 131072
buffer_load_dwordx4 v253, s[12:15], s23 offen lds
s_add_u32 m0, s22, 71680
s_add_u32 s23, s30, 1
s_and_b32 s23, s23, 3
s_lshl_b32 s23, s23, 2
s_add_u32 s23, s23, 2
s_mul_i32 s23, s23, 131072
buffer_load_dwordx4 v253, s[12:15], s23 offen lds
s_add_u32 m0, s22, 72704
s_add_u32 s23, s30, 1
s_and_b32 s23, s23, 3
s_lshl_b32 s23, s23, 2
s_add_u32 s23, s23, 3
s_mul_i32 s23, s23, 131072
buffer_load_dwordx4 v253, s[12:15], s23 offen lds
s_add_u32 m0, s22, 73728
s_add_u32 s23, s30, 2
s_and_b32 s23, s23, 3
s_lshl_b32 s23, s23, 2
s_add_u32 s23, s23, 0
s_mul_i32 s23, s23, 131072
buffer_load_dwordx4 v253, s[12:15], s23 offen lds
s_add_u32 m0, s22, 74752
s_add_u32 s23, s30, 2
s_and_b32 s23, s23, 3
s_lshl_b32 s23, s23, 2
s_add_u32 s23, s23, 1
s_mul_i32 s23, s23, 131072
buffer_load_dwordx4 v253, s[12:15], s23 offen lds
s_add_u32 m0, s22, 75776
s_add_u32 s23, s30, 2
s_and_b32 s23, s23, 3
s_lshl_b32 s23, s23, 2
s_add_u32 s23, s23, 2
s_mul_i32 s23, s23, 131072
buffer_load_dwordx4 v253, s[12:15], s23 offen lds
s_add_u32 m0, s22, 76800
s_add_u32 s23, s30, 2
s_and_b32 s23, s23, 3
s_lshl_b32 s23, s23, 2
s_add_u32 s23, s23, 3
s_mul_i32 s23, s23, 131072
buffer_load_dwordx4 v253, s[12:15], s23 offen lds
s_add_u32 m0, s22, 77824
s_add_u32 s23, s30, 3
s_and_b32 s23, s23, 3
s_lshl_b32 s23, s23, 2
s_add_u32 s23, s23, 0
s_mul_i32 s23, s23, 131072
buffer_load_dwordx4 v253, s[12:15], s23 offen lds
s_add_u32 m0, s22, 78848
s_add_u32 s23, s30, 3
s_and_b32 s23, s23, 3
s_lshl_b32 s23, s23, 2
s_add_u32 s23, s23, 1
s_mul_i32 s23, s23, 131072
buffer_load_dwordx4 v253, s[12:15], s23 offen lds
s_add_u32 m0, s22, 79872
s_add_u32 s23, s30, 3
s_and_b32 s23, s23, 3
s_lshl_b32 s23, s23, 2
s_add_u32 s23, s23, 2
s_mul_i32 s23, s23, 131072
buffer_load_dwordx4 v253, s[12:15], s23 offen lds
s_add_u32 m0, s22, 80896
s_add_u32 s23, s30, 3
s_and_b32 s23, s23, 3
s_lshl_b32 s23, s23, 2
s_add_u32 s23, s23, 3
s_mul_i32 s23, s23, 131072
buffer_load_dwordx4 v253, s[12:15], s23 offen lds
s_mov_b32 s12, s86
s_and_b32 s13, s87, 0xffff
s_mov_b32 s14, 0x800000
s_mov_b32 s15, 0x00020000
s_add_u32 s23, s30, 0
s_and_b32 s23, s23, 3
s_lshl_b32 s23, s23, 2
s_add_u32 s23, s23, 0
s_mul_i32 s23, s23, 131072
buffer_load_dwordx4 v[112:115], v251, s[12:15], s23 offen
s_add_u32 s23, s30, 0
s_and_b32 s23, s23, 3
s_lshl_b32 s23, s23, 2
s_add_u32 s23, s23, 1
s_mul_i32 s23, s23, 131072
buffer_load_dwordx4 v[116:119], v251, s[12:15], s23 offen
s_add_u32 s23, s30, 0
s_and_b32 s23, s23, 3
s_lshl_b32 s23, s23, 2
s_add_u32 s23, s23, 2
s_mul_i32 s23, s23, 131072
buffer_load_dwordx4 v[120:123], v251, s[12:15], s23 offen
s_add_u32 s23, s30, 0
s_and_b32 s23, s23, 3
s_lshl_b32 s23, s23, 2
s_add_u32 s23, s23, 3
s_mul_i32 s23, s23, 131072
buffer_load_dwordx4 v[124:127], v251, s[12:15], s23 offen
s_add_u32 s23, s30, 1
s_and_b32 s23, s23, 3
s_lshl_b32 s23, s23, 2
s_add_u32 s23, s23, 0
s_mul_i32 s23, s23, 131072
buffer_load_dwordx4 v[128:131], v251, s[12:15], s23 offen
s_add_u32 s23, s30, 1
s_and_b32 s23, s23, 3
s_lshl_b32 s23, s23, 2
s_add_u32 s23, s23, 1
s_mul_i32 s23, s23, 131072
buffer_load_dwordx4 v[132:135], v251, s[12:15], s23 offen
s_add_u32 s23, s30, 1
s_and_b32 s23, s23, 3
s_lshl_b32 s23, s23, 2
s_add_u32 s23, s23, 2
s_mul_i32 s23, s23, 131072
buffer_load_dwordx4 v[136:139], v251, s[12:15], s23 offen
s_add_u32 s23, s30, 1
s_and_b32 s23, s23, 3
s_lshl_b32 s23, s23, 2
s_add_u32 s23, s23, 3
s_mul_i32 s23, s23, 131072
buffer_load_dwordx4 v[140:143], v251, s[12:15], s23 offen
s_add_u32 s23, s30, 2
s_and_b32 s23, s23, 3
s_lshl_b32 s23, s23, 2
s_add_u32 s23, s23, 0
s_mul_i32 s23, s23, 131072
buffer_load_dwordx4 v[144:147], v251, s[12:15], s23 offen
s_add_u32 s23, s30, 2
s_and_b32 s23, s23, 3
s_lshl_b32 s23, s23, 2
s_add_u32 s23, s23, 1
s_mul_i32 s23, s23, 131072
buffer_load_dwordx4 v[148:151], v251, s[12:15], s23 offen
s_add_u32 s23, s30, 2
s_and_b32 s23, s23, 3
s_lshl_b32 s23, s23, 2
s_add_u32 s23, s23, 2
s_mul_i32 s23, s23, 131072
buffer_load_dwordx4 v[152:155], v251, s[12:15], s23 offen
s_add_u32 s23, s30, 2
s_and_b32 s23, s23, 3
s_lshl_b32 s23, s23, 2
s_add_u32 s23, s23, 3
s_mul_i32 s23, s23, 131072
buffer_load_dwordx4 v[156:159], v251, s[12:15], s23 offen
s_add_u32 s23, s30, 3
s_and_b32 s23, s23, 3
s_lshl_b32 s23, s23, 2
s_add_u32 s23, s23, 0
s_mul_i32 s23, s23, 131072
buffer_load_dwordx4 v[160:163], v251, s[12:15], s23 offen
s_add_u32 s23, s30, 3
s_and_b32 s23, s23, 3
s_lshl_b32 s23, s23, 2
s_add_u32 s23, s23, 1
s_mul_i32 s23, s23, 131072
buffer_load_dwordx4 v[164:167], v251, s[12:15], s23 offen
s_add_u32 s23, s30, 3
s_and_b32 s23, s23, 3
s_lshl_b32 s23, s23, 2
s_add_u32 s23, s23, 2
s_mul_i32 s23, s23, 131072
buffer_load_dwordx4 v[168:171], v251, s[12:15], s23 offen
s_add_u32 s23, s30, 3
s_and_b32 s23, s23, 3
s_lshl_b32 s23, s23, 2
s_add_u32 s23, s23, 3
s_mul_i32 s23, s23, 131072
buffer_load_dwordx4 v[172:175], v251, s[12:15], s23 offen
s_waitcnt vmcnt(32)
s_mov_b32 s12, s92
s_and_b32 s13, s93, 0xffff
s_mov_b32 s14, 0x800000
s_mov_b32 s15, 0x00020000
s_add_u32 s23, s30, 0
s_and_b32 s23, s23, 3
s_lshl_b32 s23, s23, 2
s_add_u32 s23, s23, 0
s_mul_i32 s23, s23, 32768
buffer_load_dwordx4 v[48:51], v252, s[12:15], s23 offen
s_add_u32 s23, s30, 0
s_and_b32 s23, s23, 3
s_lshl_b32 s23, s23, 2
s_add_u32 s23, s23, 1
s_mul_i32 s23, s23, 32768
buffer_load_dwordx4 v[52:55], v252, s[12:15], s23 offen
s_add_u32 s23, s30, 0
s_and_b32 s23, s23, 3
s_lshl_b32 s23, s23, 2
s_add_u32 s23, s23, 2
s_mul_i32 s23, s23, 32768
buffer_load_dwordx4 v[56:59], v252, s[12:15], s23 offen
s_add_u32 s23, s30, 0
s_and_b32 s23, s23, 3
s_lshl_b32 s23, s23, 2
s_add_u32 s23, s23, 3
s_mul_i32 s23, s23, 32768
buffer_load_dwordx4 v[60:63], v252, s[12:15], s23 offen
s_add_u32 s23, s30, 1
s_and_b32 s23, s23, 3
s_lshl_b32 s23, s23, 2
s_add_u32 s23, s23, 0
s_mul_i32 s23, s23, 32768
buffer_load_dwordx4 v[64:67], v252, s[12:15], s23 offen
s_add_u32 s23, s30, 1
s_and_b32 s23, s23, 3
s_lshl_b32 s23, s23, 2
s_add_u32 s23, s23, 1
s_mul_i32 s23, s23, 32768
buffer_load_dwordx4 v[68:71], v252, s[12:15], s23 offen
s_add_u32 s23, s30, 1
s_and_b32 s23, s23, 3
s_lshl_b32 s23, s23, 2
s_add_u32 s23, s23, 2
s_mul_i32 s23, s23, 32768
buffer_load_dwordx4 v[72:75], v252, s[12:15], s23 offen
s_add_u32 s23, s30, 1
s_and_b32 s23, s23, 3
s_lshl_b32 s23, s23, 2
s_add_u32 s23, s23, 3
s_mul_i32 s23, s23, 32768
buffer_load_dwordx4 v[76:79], v252, s[12:15], s23 offen
s_add_u32 s23, s30, 2
s_and_b32 s23, s23, 3
s_lshl_b32 s23, s23, 2
s_add_u32 s23, s23, 0
s_mul_i32 s23, s23, 32768
buffer_load_dwordx4 v[80:83], v252, s[12:15], s23 offen
s_add_u32 s23, s30, 2
s_and_b32 s23, s23, 3
s_lshl_b32 s23, s23, 2
s_add_u32 s23, s23, 1
s_mul_i32 s23, s23, 32768
buffer_load_dwordx4 v[84:87], v252, s[12:15], s23 offen
s_add_u32 s23, s30, 2
s_and_b32 s23, s23, 3
s_lshl_b32 s23, s23, 2
s_add_u32 s23, s23, 2
s_mul_i32 s23, s23, 32768
buffer_load_dwordx4 v[88:91], v252, s[12:15], s23 offen
s_add_u32 s23, s30, 2
s_and_b32 s23, s23, 3
s_lshl_b32 s23, s23, 2
s_add_u32 s23, s23, 3
s_mul_i32 s23, s23, 32768
buffer_load_dwordx4 v[92:95], v252, s[12:15], s23 offen
s_add_u32 s23, s30, 3
s_and_b32 s23, s23, 3
s_lshl_b32 s23, s23, 2
s_add_u32 s23, s23, 0
s_mul_i32 s23, s23, 32768
buffer_load_dwordx4 v[96:99], v252, s[12:15], s23 offen
s_add_u32 s23, s30, 3
s_and_b32 s23, s23, 3
s_lshl_b32 s23, s23, 2
s_add_u32 s23, s23, 1
s_mul_i32 s23, s23, 32768
buffer_load_dwordx4 v[100:103], v252, s[12:15], s23 offen
s_add_u32 s23, s30, 3
s_and_b32 s23, s23, 3
s_lshl_b32 s23, s23, 2
s_add_u32 s23, s23, 2
s_mul_i32 s23, s23, 32768
buffer_load_dwordx4 v[104:107], v252, s[12:15], s23 offen
s_add_u32 s23, s30, 3
s_and_b32 s23, s23, 3
s_lshl_b32 s23, s23, 2
s_add_u32 s23, s23, 3
s_mul_i32 s23, s23, 32768
buffer_load_dwordx4 v[108:111], v252, s[12:15], s23 offen
ds_read_b64_tr_b16 a[64:65], v240 offset:32768
ds_read_b64_tr_b16 a[66:67], v240 offset:33024
ds_read_b64_tr_b16 a[68:69], v240 offset:34816
ds_read_b64_tr_b16 a[70:71], v240 offset:35072
ds_read_b64_tr_b16 a[96:97], v240 offset:32784
ds_read_b64_tr_b16 a[98:99], v240 offset:33040
ds_read_b64_tr_b16 a[100:101], v240 offset:34832
ds_read_b64_tr_b16 a[102:103], v240 offset:35088
s_waitcnt lgkmcnt(0)
ds_read_b64_tr_b16 a[72:73], v240 offset:36864
ds_read_b64_tr_b16 a[74:75], v240 offset:37120
ds_read_b64_tr_b16 a[76:77], v240 offset:38912
ds_read_b64_tr_b16 a[78:79], v240 offset:39168
ds_read_b64_tr_b16 a[104:105], v240 offset:36880
ds_read_b64_tr_b16 a[106:107], v240 offset:37136
ds_read_b64_tr_b16 a[108:109], v240 offset:38928
ds_read_b64_tr_b16 a[110:111], v240 offset:39184
s_waitcnt lgkmcnt(0)
ds_read_b64_tr_b16 a[80:81], v240 offset:40960
ds_read_b64_tr_b16 a[82:83], v240 offset:41216
ds_read_b64_tr_b16 a[84:85], v240 offset:43008
ds_read_b64_tr_b16 a[86:87], v240 offset:43264
ds_read_b64_tr_b16 a[112:113], v240 offset:40976
ds_read_b64_tr_b16 a[114:115], v240 offset:41232
ds_read_b64_tr_b16 a[116:117], v240 offset:43024
ds_read_b64_tr_b16 a[118:119], v240 offset:43280
s_waitcnt lgkmcnt(0)
ds_read_b64_tr_b16 a[88:89], v240 offset:45056
ds_read_b64_tr_b16 a[90:91], v240 offset:45312
ds_read_b64_tr_b16 a[92:93], v240 offset:47104
ds_read_b64_tr_b16 a[94:95], v240 offset:47360
ds_read_b64_tr_b16 a[120:121], v240 offset:45072
ds_read_b64_tr_b16 a[122:123], v240 offset:45328
ds_read_b64_tr_b16 a[124:125], v240 offset:47120
ds_read_b64_tr_b16 a[126:127], v240 offset:47376
s_waitcnt lgkmcnt(0)
s_waitcnt vmcnt(32)
ds_read_b64_tr_b16 a[128:129], v243 offset:32768
ds_read_b64_tr_b16 a[130:131], v243 offset:33024
ds_read_b64_tr_b16 a[132:133], v243 offset:34816
ds_read_b64_tr_b16 a[134:135], v243 offset:35072
ds_read_b64_tr_b16 a[160:161], v243 offset:32776
ds_read_b64_tr_b16 a[162:163], v243 offset:33032
ds_read_b64_tr_b16 a[164:165], v243 offset:34824
ds_read_b64_tr_b16 a[166:167], v243 offset:35080
s_waitcnt lgkmcnt(0)
ds_read_b64_tr_b16 a[136:137], v243 offset:36864
ds_read_b64_tr_b16 a[138:139], v243 offset:37120
ds_read_b64_tr_b16 a[140:141], v243 offset:38912
ds_read_b64_tr_b16 a[142:143], v243 offset:39168
ds_read_b64_tr_b16 a[168:169], v243 offset:36872
ds_read_b64_tr_b16 a[170:171], v243 offset:37128
ds_read_b64_tr_b16 a[172:173], v243 offset:38920
ds_read_b64_tr_b16 a[174:175], v243 offset:39176
s_waitcnt lgkmcnt(0)
ds_read_b64_tr_b16 a[144:145], v243 offset:40960
ds_read_b64_tr_b16 a[146:147], v243 offset:41216
ds_read_b64_tr_b16 a[148:149], v243 offset:43008
ds_read_b64_tr_b16 a[150:151], v243 offset:43264
ds_read_b64_tr_b16 a[176:177], v243 offset:40968
ds_read_b64_tr_b16 a[178:179], v243 offset:41224
ds_read_b64_tr_b16 a[180:181], v243 offset:43016
ds_read_b64_tr_b16 a[182:183], v243 offset:43272
s_waitcnt lgkmcnt(0)
ds_read_b64_tr_b16 a[152:153], v243 offset:45056
ds_read_b64_tr_b16 a[154:155], v243 offset:45312
ds_read_b64_tr_b16 a[156:157], v243 offset:47104
ds_read_b64_tr_b16 a[158:159], v243 offset:47360
ds_read_b64_tr_b16 a[184:185], v243 offset:45064
ds_read_b64_tr_b16 a[186:187], v243 offset:45320
ds_read_b64_tr_b16 a[188:189], v243 offset:47112
ds_read_b64_tr_b16 a[190:191], v243 offset:47368
s_waitcnt lgkmcnt(0)
s_waitcnt vmcnt(16)
ds_write_b128 v244, v[112:115] offset:32768
ds_write_b128 v244, v[116:119] offset:33792
ds_write_b128 v244, v[120:123] offset:34816
ds_write_b128 v244, v[124:127] offset:35840
ds_write_b128 v244, v[128:131] offset:36864
ds_write_b128 v244, v[132:135] offset:37888
ds_write_b128 v244, v[136:139] offset:38912
ds_write_b128 v244, v[140:143] offset:39936
ds_write_b128 v244, v[144:147] offset:40960
ds_write_b128 v244, v[148:151] offset:41984
ds_write_b128 v244, v[152:155] offset:43008
ds_write_b128 v244, v[156:159] offset:44032
ds_write_b128 v244, v[160:163] offset:45056
ds_write_b128 v244, v[164:167] offset:46080
ds_write_b128 v244, v[168:171] offset:47104
ds_write_b128 v244, v[172:175] offset:48128
s_waitcnt lgkmcnt(0)
ds_read_b64_tr_b16 a[0:1], v240 offset:32768
ds_read_b64_tr_b16 a[2:3], v240 offset:33024
ds_read_b64_tr_b16 a[4:5], v240 offset:34816
ds_read_b64_tr_b16 a[6:7], v240 offset:35072
ds_read_b64_tr_b16 a[32:33], v240 offset:32784
ds_read_b64_tr_b16 a[34:35], v240 offset:33040
ds_read_b64_tr_b16 a[36:37], v240 offset:34832
ds_read_b64_tr_b16 a[38:39], v240 offset:35088
s_waitcnt lgkmcnt(0)
ds_read_b64_tr_b16 a[8:9], v240 offset:36864
ds_read_b64_tr_b16 a[10:11], v240 offset:37120
ds_read_b64_tr_b16 a[12:13], v240 offset:38912
ds_read_b64_tr_b16 a[14:15], v240 offset:39168
ds_read_b64_tr_b16 a[40:41], v240 offset:36880
ds_read_b64_tr_b16 a[42:43], v240 offset:37136
ds_read_b64_tr_b16 a[44:45], v240 offset:38928
ds_read_b64_tr_b16 a[46:47], v240 offset:39184
s_waitcnt lgkmcnt(0)
ds_read_b64_tr_b16 a[16:17], v240 offset:40960
ds_read_b64_tr_b16 a[18:19], v240 offset:41216
ds_read_b64_tr_b16 a[20:21], v240 offset:43008
ds_read_b64_tr_b16 a[22:23], v240 offset:43264
ds_read_b64_tr_b16 a[48:49], v240 offset:40976
ds_read_b64_tr_b16 a[50:51], v240 offset:41232
ds_read_b64_tr_b16 a[52:53], v240 offset:43024
ds_read_b64_tr_b16 a[54:55], v240 offset:43280
s_waitcnt lgkmcnt(0)
ds_read_b64_tr_b16 a[24:25], v240 offset:45056
ds_read_b64_tr_b16 a[26:27], v240 offset:45312
ds_read_b64_tr_b16 a[28:29], v240 offset:47104
ds_read_b64_tr_b16 a[30:31], v240 offset:47360
ds_read_b64_tr_b16 a[56:57], v240 offset:45072
ds_read_b64_tr_b16 a[58:59], v240 offset:45328
ds_read_b64_tr_b16 a[60:61], v240 offset:47120
ds_read_b64_tr_b16 a[62:63], v240 offset:47376
s_waitcnt lgkmcnt(0)
s_waitcnt vmcnt(0)
ds_write_b128 v245, v[48:51] offset:32768
ds_write_b128 v245, v[52:55] offset:33792
ds_write_b128 v245, v[56:59] offset:34816
ds_write_b128 v245, v[60:63] offset:35840
ds_write_b128 v245, v[64:67] offset:36864
ds_write_b128 v245, v[68:71] offset:37888
ds_write_b128 v245, v[72:75] offset:38912
ds_write_b128 v245, v[76:79] offset:39936
ds_write_b128 v245, v[80:83] offset:40960
ds_write_b128 v245, v[84:87] offset:41984
ds_write_b128 v245, v[88:91] offset:43008
ds_write_b128 v245, v[92:95] offset:44032
ds_write_b128 v245, v[96:99] offset:45056
ds_write_b128 v245, v[100:103] offset:46080
ds_write_b128 v245, v[104:107] offset:47104
ds_write_b128 v245, v[108:111] offset:48128
s_waitcnt lgkmcnt(0)
ds_read_b64_tr_b16 a[192:193], v243 offset:32768
ds_read_b64_tr_b16 a[194:195], v243 offset:33024
ds_read_b64_tr_b16 a[196:197], v243 offset:34816
ds_read_b64_tr_b16 a[198:199], v243 offset:35072
ds_read_b64_tr_b16 a[224:225], v243 offset:32776
ds_read_b64_tr_b16 a[226:227], v243 offset:33032
ds_read_b64_tr_b16 a[228:229], v243 offset:34824
ds_read_b64_tr_b16 a[230:231], v243 offset:35080
s_waitcnt lgkmcnt(0)
ds_read_b64_tr_b16 a[200:201], v243 offset:36864
ds_read_b64_tr_b16 a[202:203], v243 offset:37120
ds_read_b64_tr_b16 a[204:205], v243 offset:38912
ds_read_b64_tr_b16 a[206:207], v243 offset:39168
ds_read_b64_tr_b16 a[232:233], v243 offset:36872
ds_read_b64_tr_b16 a[234:235], v243 offset:37128
ds_read_b64_tr_b16 a[236:237], v243 offset:38920
ds_read_b64_tr_b16 a[238:239], v243 offset:39176
s_waitcnt lgkmcnt(0)
ds_read_b64_tr_b16 a[208:209], v243 offset:40960
ds_read_b64_tr_b16 a[210:211], v243 offset:41216
ds_read_b64_tr_b16 a[212:213], v243 offset:43008
ds_read_b64_tr_b16 a[214:215], v243 offset:43264
ds_read_b64_tr_b16 a[240:241], v243 offset:40968
ds_read_b64_tr_b16 a[242:243], v243 offset:41224
ds_read_b64_tr_b16 a[244:245], v243 offset:43016
ds_read_b64_tr_b16 a[246:247], v243 offset:43272
s_waitcnt lgkmcnt(0)
ds_read_b64_tr_b16 a[216:217], v243 offset:45056
ds_read_b64_tr_b16 a[218:219], v243 offset:45312
ds_read_b64_tr_b16 a[220:221], v243 offset:47104
ds_read_b64_tr_b16 a[222:223], v243 offset:47360
ds_read_b64_tr_b16 a[248:249], v243 offset:45064
ds_read_b64_tr_b16 a[250:251], v243 offset:45320
ds_read_b64_tr_b16 a[252:253], v243 offset:47112
ds_read_b64_tr_b16 a[254:255], v243 offset:47368
s_waitcnt lgkmcnt(0)
v_bfe_u32 v249, v0, 1, 1
v_lshlrev_b32 v249, 4, v249
v_mov_b32 v250, 0x3f80
v_lshlrev_b32 v250, v249, v250
v_bfe_u32 v248, v0, 3, 1
v_bfe_u32 v249, v0, 4, 1
v_xor_b32 v249, v249, v248
v_bfe_u32 v248, v0, 2, 1
v_lshl_add_u32 v248, v249, 2, v248
v_and_b32 v249, 1, v0
v_lshl_add_u32 v248, v249, 1, v248
v_cmp_eq_u32 vcc, 0, v248
s_nop 1
v_cndmask_b32 v252, 0, v250, vcc
v_cmp_eq_u32 vcc, 1, v248
s_nop 1
v_cndmask_b32 v253, 0, v250, vcc
v_cmp_eq_u32 vcc, 2, v248
s_nop 1
v_cndmask_b32 v254, 0, v250, vcc
v_cmp_eq_u32 vcc, 3, v248
s_nop 1
v_cndmask_b32 v255, 0, v250, vcc
v_mov_b32 v64, 0
v_mov_b32 v65, 0
v_mov_b32 v66, 0
v_mov_b32 v67, 0
v_mov_b32 v68, 0
v_mov_b32 v69, 0
v_mov_b32 v70, 0
v_mov_b32 v71, 0
v_mov_b32 v72, 0
v_mov_b32 v73, 0
v_mov_b32 v74, 0
v_mov_b32 v75, 0
v_mov_b32 v76, 0
v_mov_b32 v77, 0
v_mov_b32 v78, 0
v_mov_b32 v79, 0
v_mov_b32 v80, 0
v_mov_b32 v81, 0
v_mov_b32 v82, 0
v_mov_b32 v83, 0
v_mov_b32 v84, 0
v_mov_b32 v85, 0
v_mov_b32 v86, 0
v_mov_b32 v87, 0
v_mov_b32 v145, 0
v_mov_b32 v147, 0
v_mov_b32 v165, 0
s_bitcmp1_b32 s17, 2
s_cbranch_scc1 L_cwarme_9
s_lshr_b32 s20, s17, 3
s_lshl_b32 s20, s20, 2
s_and_b32 s21, s17, 3
s_add_u32 s20, s20, s21
s_lshl_b32 s21, s16, 4
s_add_u32 s20, s20, s21
s_lshl_b32 s20, s20, 12
v_lshlrev_b32 v34, 4, v0
s_mov_b32 s12, s82
s_and_b32 s13, s83, 0xffff
s_mov_b32 s14, 0x400000
s_mov_b32 s15, 0x00020000
s_mov_b32 s56, s64
s_and_b32 s57, s65, 0xffff
s_mov_b32 s58, 0x400000
s_mov_b32 s59, 0x00020000
buffer_load_dwordx4 v[168:171], v34, s[12:15], s20 offen
s_add_u32 s20, s20, 0x40000
buffer_load_dwordx4 v[168:171], v34, s[12:15], s20 offen
s_add_u32 s20, s20, 0x40000
buffer_load_dwordx4 v[168:171], v34, s[12:15], s20 offen
s_add_u32 s20, s20, 0x40000
buffer_load_dwordx4 v[168:171], v34, s[12:15], s20 offen
s_add_u32 s20, s20, 0x40000
buffer_load_dwordx4 v[168:171], v34, s[12:15], s20 offen
s_add_u32 s20, s20, 0x40000
buffer_load_dwordx4 v[168:171], v34, s[12:15], s20 offen
s_add_u32 s20, s20, 0x40000
buffer_load_dwordx4 v[168:171], v34, s[12:15], s20 offen
s_add_u32 s20, s20, 0x40000
buffer_load_dwordx4 v[168:171], v34, s[12:15], s20 offen
s_add_u32 s20, s20, 0x40000
buffer_load_dwordx4 v[168:171], v34, s[12:15], s20 offen
s_add_u32 s20, s20, 0x40000
buffer_load_dwordx4 v[168:171], v34, s[12:15], s20 offen
s_add_u32 s20, s20, 0x40000
buffer_load_dwordx4 v[168:171], v34, s[12:15], s20 offen
s_add_u32 s20, s20, 0x40000
buffer_load_dwordx4 v[168:171], v34, s[12:15], s20 offen
s_add_u32 s20, s20, 0x40000
buffer_load_dwordx4 v[168:171], v34, s[12:15], s20 offen
s_add_u32 s20, s20, 0x40000
buffer_load_dwordx4 v[168:171], v34, s[12:15], s20 offen
s_add_u32 s20, s20, 0x40000
buffer_load_dwordx4 v[168:171], v34, s[12:15], s20 offen
s_add_u32 s20, s20, 0x40000
buffer_load_dwordx4 v[168:171], v34, s[12:15], s20 offen
s_add_u32 s20, s20, 0x40000
L_cwarme_9:
s_mov_b32 s12, s84
s_and_b32 s13, s85, 0xffff
s_mov_b32 s14, 0x4000
s_mov_b32 s15, 0x00020000
buffer_load_dwordx2 v[168:169], v33, s[12:15], 0 offen
s_waitcnt vmcnt(0)
s_mov_b32 s12, s98
s_and_b32 s13, s99, 0xffff
s_mov_b32 s14, 0x100
s_mov_b32 s15, 0x00020000
s_mov_b32 s19, 0
s_mov_b32 s53, 1
s_mov_b32 s43, 24576
s_add_u32 s54, s100, 0x5900000
s_addc_u32 s55, s101, 0
v_mov_b32 v34, 0
L_dw_10:
buffer_load_dword v35, v34, s[12:15], 0 offen sc1
s_add_u32 s33, s33, 1
s_cmp_gt_u32 s33, 0x100000
s_waitcnt vmcnt(0)
s_cbranch_scc1 chain_kernel_abort
v_readfirstlane_b32 s20, v35
s_and_b32 s22, s20, 0xffff
s_cmp_ge_u32 s22, 256
s_cbranch_scc1 L_dwok_11
s_sleep 2
s_branch L_dw_10
L_dwok_11:
s_lshr_b32 s21, s20, 16
s_cmp_gt_u32 s21, 16
s_cselect_b32 s21, 0x2000, 0x0
s_add_u32 s35, s100, 0x1fffff
s_and_b32 s35, s35, 0xffe00000
s_sub_u32 s52, s35, s100
s_add_u32 s35, s52, s21
s_xor_b32 s21, s21, 0x2000
s_add_u32 s52, s52, s21
buffer_load_dword v35, v34, s[12:15], 0 offen offset:8 sc1
s_waitcnt vmcnt(0)
v_readfirstlane_b32 s32, v35
s_mov_b32 s31, s35
s_cmp_lg_u32 s18, 3
s_cbranch_scc1 L_init3_12
s_lshl_b32 s21, s19, 7
s_add_u32 s21, s21, 0x5900000
v_mov_b32 v34, 0
L_dw_13:
buffer_load_dword v35, v34, s[8:11], s21 offen sc1
s_add_u32 s33, s33, 1
s_cmp_gt_u32 s33, 0x100000
s_waitcnt vmcnt(0)
s_cbranch_scc1 chain_kernel_abort
v_readfirstlane_b32 s20, v35
s_cmp_ge_u32 s20, 64
s_cbranch_scc1 L_dwok_14
s_sleep 2
s_branch L_dw_13
L_dwok_14:
s_add_u32 m0, s43, 0
s_nop 0
buffer_load_dwordx4 v27, s[8:11], s31 offen offset:0 lds
s_add_u32 m0, s43, 896
s_nop 0
buffer_load_dwordx4 v27, s[8:11], s31 offen offset:128 lds
s_add_u32 m0, s43, 0
s_nop 0
buffer_load_dwordx4 v29, s[8:11], s31 offen offset:2048 lds
s_add_u32 m0, s43, 960
s_nop 0
buffer_load_dwordx4 v29, s[8:11], s31 offen offset:2112 lds
s_xor_b32 s43, s43, 4096
s_waitcnt vmcnt(0)
L_init3_12:
s_and_b32 s20, s19, 3
s_lshl_b32 s21, s20, 16
s_add_u32 s38, s36, s21
s_add_u32 s41, s38, 0x140000
s_lshl_b32 s21, s20, 18
s_add_u32 s40, s37, s21
s_add_u32 s42, s31, 0x8000000
s_add_u32 s21, s19, 1
s_bitcmp1_b32 s21, 1
s_cselect_b32 s31, s52, s35
s_lshl_b32 s21, s21, 20
s_add_u32 s31, s31, s21
s_add_u32 s20, s20, 1
s_and_b32 s20, s20, 3
s_lshl_b32 s20, s20, 16
s_add_u32 s39, s36, s20
s_cmp_lg_u32 s18, 0
s_cbranch_scc1 L_init_15
v_cmp_eq_u32 vcc, s34, v168
s_nop 1
v_cndmask_b32 v168, v168, -1, vcc
v_cmp_eq_u32 vcc, s34, v169
s_nop 1
v_cndmask_b32 v169, v169, -1, vcc
buffer_store_dwordx2 v[168:169], v8, s[8:11], s38 offen sc1
s_xor_b32 s43, s43, 4096
s_setprio 3
L_init_15:
s_barrier
s_cmp_lg_u32 s32, 0
s_cbranch_scc1 L_slow_16
L_step_17:
s_nop 15
s_nop 7
L_step_17_nd:
buffer_load_dwordx4 v[48:51], v2, s[8:11], s38 offen sc1
v_mov_b32 v88, 0
v_mov_b32 v89, 0
v_mov_b32 v90, 0
v_mov_b32 v91, 0
v_mov_b32 v92, 0
v_mov_b32 v93, 0
v_mov_b32 v94, 0
v_mov_b32 v95, 0
ds_read_b128 v[116:119], v25
ds_read_b128 v[120:123], v25 offset:1024
v_xor_b32 v25, 0x1000, v25
s_nop 0
buffer_load_dwordx4 v[52:55], v3, s[8:11], s38 offen sc1
s_nop 11
buffer_load_dwordx4 v[56:59], v4, s[8:11], s38 offen sc1
s_nop 11
buffer_load_dwordx4 v[60:63], v5, s[8:11], s38 offen sc1
s_waitcnt vmcnt(3)
v_max3_u32 v7, v48, v49, v50
v_max_u32 v7, v7, v51
v_cmp_eq_u32 vcc, s34, v7
s_cbranch_vccnz L_q_a_24
L_v_a_25:
v_smfmac_f32_16x16x64_bf16 v[64:67], v[48:51], a[0:7], v6
s_waitcnt vmcnt(2)
v_max3_u32 v7, v52, v53, v54
v_max_u32 v7, v7, v55
v_smfmac_f32_16x16x64_bf16 v[68:71], v[48:51], a[64:71], v6
v_cmp_eq_u32 vcc, s34, v7
v_smfmac_f32_16x16x64_bf16 v[72:75], v[48:51], a[32:39], v6
v_smfmac_f32_16x16x64_bf16 v[76:79], v[48:51], a[96:103], v6
s_cbranch_vccnz L_q_a_26
L_v_a_27:
v_smfmac_f32_16x16x64_bf16 v[64:67], v[52:55], a[8:15], v6
s_waitcnt vmcnt(1)
v_max3_u32 v7, v56, v57, v58
v_max_u32 v7, v7, v59
v_smfmac_f32_16x16x64_bf16 v[68:71], v[52:55], a[72:79], v6
v_cmp_eq_u32 vcc, s34, v7
v_smfmac_f32_16x16x64_bf16 v[72:75], v[52:55], a[40:47], v6
v_smfmac_f32_16x16x64_bf16 v[76:79], v[52:55], a[104:111], v6
s_cbranch_vccnz L_q_a_28
L_v_a_29:
v_smfmac_f32_16x16x64_bf16 v[64:67], v[56:59], a[16:23], v6
s_waitcnt vmcnt(0)
v_max3_u32 v7, v60, v61, v62
v_max_u32 v7, v7, v63
v_smfmac_f32_16x16x64_bf16 v[68:71], v[56:59], a[80:87], v6
v_cmp_eq_u32 vcc, s34, v7
v_smfmac_f32_16x16x64_bf16 v[72:75], v[56:59], a[48:55], v6
v_smfmac_f32_16x16x64_bf16 v[76:79], v[56:59], a[112:119], v6
s_cbranch_vccnz L_q_a_30
L_v_a_31:
v_smfmac_f32_16x16x64_bf16 v[64:67], v[60:63], a[24:31], v6
v_smfmac_f32_16x16x64_bf16 v[68:71], v[60:63], a[88:95], v6
v_smfmac_f32_16x16x64_bf16 v[72:75], v[60:63], a[56:63], v6
v_smfmac_f32_16x16x64_bf16 v[76:79], v[60:63], a[120:127], v6
L_gd_a_23:
v_cvt_pk_bf16_f32 v96, v64, v65
v_cvt_pk_bf16_f32 v97, v66, v67
v_cvt_pk_bf16_f32 v98, v68, v69
v_cvt_pk_bf16_f32 v99, v70, v71
s_cmp_lg_u32 s18, 0
v_cvt_pk_bf16_f32 v100, v72, v73
v_mfma_f32_16x16x32_bf16 v[104:107], v[96:99], v[40:43], 0
v_cvt_pk_bf16_f32 v101, v74, v75
v_cvt_pk_bf16_f32 v102, v76, v77
v_cvt_pk_bf16_f32 v103, v78, v79
s_nop 1
v_mfma_f32_16x16x32_bf16 v[108:111], v[100:103], v[40:43], 0
s_cbranch_scc0 L_help1_18_w0
s_nop 0
ds_write_b128 v20, v[104:107]
s_nop 4
ds_write_b128 v20, v[108:111] offset:1024
s_waitcnt lgkmcnt(0)
s_barrier
v_smfmac_f32_16x16x64_bf16 v[80:83], v[48:51], a[128:135], v6
v_smfmac_f32_16x16x64_bf16 v[84:87], v[48:51], a[160:167], v6
v_smfmac_f32_16x16x64_bf16 v[80:83], v[52:55], a[136:143], v6
v_smfmac_f32_16x16x64_bf16 v[84:87], v[52:55], a[168:175], v6
v_smfmac_f32_16x16x64_bf16 v[80:83], v[56:59], a[144:151], v6
v_smfmac_f32_16x16x64_bf16 v[84:87], v[56:59], a[176:183], v6
v_smfmac_f32_16x16x64_bf16 v[80:83], v[60:63], a[152:159], v6
v_smfmac_f32_16x16x64_bf16 v[84:87], v[60:63], a[184:191], v6
s_nop 4
ds_write_b128 v21, v[80:83]
s_nop 1
ds_write_b128 v21, v[84:87] offset:512
s_waitcnt lgkmcnt(0)
L_bar2b_116_2:
s_barrier
s_cmp_eq_u32 s18, 1
s_cbranch_scc1 L_vred_115
L_bar2b_116:
s_waitcnt lgkmcnt(0)
s_barrier
s_cmp_eq_u32 s19, 63
s_cbranch_scc1 L_fin_22
s_cmp_lg_u32 s18, 2
s_cbranch_scc1 L_poe_117
s_sub_u32 s20, s19, 1
s_and_b32 s20, s20, 3
s_lshl_b32 s21, s20, 16
s_add_u32 s21, s21, s36
s_add_u32 s22, s21, 0x140000
s_lshl_b32 s23, s20, 18
s_add_u32 s23, s23, s37
buffer_store_dwordx2 v[36:37], v8, s[8:11], s21 offen
buffer_store_dwordx2 v[36:37], v28, s[8:11], s22 offen
buffer_store_dwordx4 v[36:39], v9, s[8:11], s23 offen
s_mov_b64 exec, s[28:29]
buffer_store_dwordx4 v[36:39], v10, s[8:11], s23 offen
s_mov_b64 exec, -1
L_poe_117:
s_cmp_lg_u32 s18, 3
s_cbranch_scc1 L_bar3_19
s_cmp_ge_u32 s19, 2
s_cbranch_scc1 L_gated_118
s_add_u32 s23, s19, 1
s_lshl_b32 s21, s23, 7
s_add_u32 s21, s21, 0x5900000
v_mov_b32 v34, 0
L_dw_119:
buffer_load_dword v35, v34, s[8:11], s21 offen sc1
s_add_u32 s33, s33, 1
s_cmp_gt_u32 s33, 0x100000
s_waitcnt vmcnt(0)
s_cbranch_scc1 chain_kernel_abort
v_readfirstlane_b32 s20, v35
s_cmp_ge_u32 s20, 64
s_cbranch_scc1 L_dwok_120
s_sleep 2
s_branch L_dw_119
L_dwok_120:
L_gated_118:
s_add_u32 m0, s43, 0
s_nop 0
buffer_load_dwordx4 v27, s[8:11], s31 offen offset:0 lds
s_add_u32 m0, s43, 896
s_nop 0
buffer_load_dwordx4 v27, s[8:11], s31 offen offset:128 lds
s_add_u32 m0, s43, 0
s_nop 0
buffer_load_dwordx4 v29, s[8:11], s31 offen offset:2048 lds
s_add_u32 m0, s43, 960
s_nop 0
buffer_load_dwordx4 v29, s[8:11], s31 offen offset:2112 lds
s_xor_b32 s43, s43, 4096
s_branch L_bar3_19
L_vred_115:
ds_read_b64 v[168:169], v22 offset:0
ds_read_b64 v[170:171], v22 offset:512
ds_read_b64 v[172:173], v22 offset:1024
ds_read_b64 v[174:175], v22 offset:1536
ds_read_b64 v[176:177], v22 offset:2048
ds_read_b64 v[178:179], v22 offset:2560
ds_read_b64 v[180:181], v22 offset:3072
ds_read_b64 v[182:183], v22 offset:3584
ds_read_b64 v[184:185], v22 offset:4096
ds_read_b64 v[186:187], v22 offset:4608
ds_read_b64 v[188:189], v22 offset:5120
ds_read_b64 v[190:191], v22 offset:5632
ds_read_b64 v[192:193], v22 offset:6144
ds_read_b64 v[194:195], v22 offset:6656
ds_read_b64 v[196:197], v22 offset:7168
s_waitcnt lgkmcnt(11)
ds_read_b64 v[198:199], v22 offset:7680
s_waitcnt lgkmcnt(8)
v_pk_add_f32 v[168:169], v[168:169], v[172:173]
v_pk_add_f32 v[170:171], v[170:171], v[174:175]
v_pk_add_f32 v[176:177], v[176:177], v[180:181]
v_pk_add_f32 v[178:179], v[178:179], v[182:183]
v_pk_add_f32 v[168:169], v[168:169], v[176:177]
v_pk_add_f32 v[170:171], v[170:171], v[178:179]
s_waitcnt lgkmcnt(0)
v_pk_add_f32 v[184:185], v[184:185], v[188:189]
v_pk_add_f32 v[186:187], v[186:187], v[190:191]
v_pk_add_f32 v[192:193], v[192:193], v[196:197]
v_pk_add_f32 v[194:195], v[194:195], v[198:199]
v_pk_add_f32 v[168:169], v[168:169], v[184:185]
v_pk_add_f32 v[170:171], v[170:171], v[186:187]
v_pk_add_f32 v[168:169], v[168:169], v[192:193]
v_pk_add_f32 v[170:171], v[170:171], v[194:195]
v_cvt_pk_bf16_f32 v144, v168, v169
v_cvt_pk_bf16_f32 v146, v170, v171
ds_write2_b32 v32, v144, v146 offset0:0 offset1:16
s_branch L_bar2b_116
L_help1_18_w0:
v_smfmac_f32_16x16x64_bf16 v[80:83], v[48:51], a[128:135], v6
v_smfmac_f32_16x16x64_bf16 v[84:87], v[48:51], a[160:167], v6
v_smfmac_f32_16x16x64_bf16 v[80:83], v[52:55], a[136:143], v6
v_smfmac_f32_16x16x64_bf16 v[84:87], v[52:55], a[168:175], v6
v_smfmac_f32_16x16x64_bf16 v[80:83], v[56:59], a[144:151], v6
v_smfmac_f32_16x16x64_bf16 v[84:87], v[56:59], a[176:183], v6
v_smfmac_f32_16x16x64_bf16 v[80:83], v[60:63], a[152:159], v6
v_smfmac_f32_16x16x64_bf16 v[84:87], v[60:63], a[184:191], v6
s_nop 4
ds_write_b128 v21, v[80:83]
s_nop 1
ds_write_b128 v21, v[84:87] offset:512
s_barrier
ds_read_b128 v[168:171], v1 offset:2048
ds_read_b128 v[172:175], v1 offset:3072
ds_read_b128 v[176:179], v1 offset:4096
ds_read_b128 v[180:183], v1 offset:5120
ds_read_b128 v[184:187], v1 offset:6144
ds_read_b128 v[188:191], v1 offset:7168
s_waitcnt lgkmcnt(4)
v_pk_add_f32 v[104:105], v[104:105], v[168:169]
v_pk_add_f32 v[106:107], v[106:107], v[170:171]
v_pk_add_f32 v[108:109], v[108:109], v[172:173]
v_pk_add_f32 v[110:111], v[110:111], v[174:175]
s_waitcnt lgkmcnt(2)
v_pk_add_f32 v[104:105], v[104:105], v[176:177]
v_pk_add_f32 v[106:107], v[106:107], v[178:179]
v_pk_add_f32 v[108:109], v[108:109], v[180:181]
v_pk_add_f32 v[110:111], v[110:111], v[182:183]
s_waitcnt lgkmcnt(0)
v_pk_add_f32 v[104:105], v[104:105], v[184:185]
v_pk_add_f32 v[106:107], v[106:107], v[186:187]
v_pk_add_f32 v[108:109], v[108:109], v[188:189]
v_pk_add_f32 v[110:111], v[110:111], v[190:191]
v_cvt_pk_bf16_f32 v112, v104, v105
v_cvt_pk_bf16_f32 v113, v106, v107
v_cvt_pk_bf16_f32 v114, v108, v109
v_cvt_pk_bf16_f32 v115, v110, v111
s_mov_b64 exec, s[28:29]
s_nop 0
v_mfma_f32_16x16x32_bf16 v[132:135], v[112:115], v[112:115], 0
v_mfma_f32_16x16x32_bf16 v[124:127], v[116:119], v[112:115], 0
v_mfma_f32_16x16x32_bf16 v[128:131], v[120:123], v[112:115], 0
s_nop 3
buffer_store_dwordx4 v[132:135], v10, s[8:11], s40 offen
s_mov_b64 exec, s[24:25]
buffer_store_dwordx4 v[124:127], v9, s[8:11], s40 offen
s_nop 0
buffer_store_dwordx4 v[128:131], v9, s[8:11], s40 offen offset:128
s_mov_b64 exec, -1
ds_write_b128 v1, v[112:115] offset:32768
ds_read_b128 v[136:139], v26 offset:0
ds_read_b128 v[140:143], v26 offset:1024
v_mov_b32_dpp v124, v128 row_shr:8 row_mask:0xf bank_mask:0xc
v_mov_b32_dpp v125, v129 row_shr:8 row_mask:0xf bank_mask:0xc
v_mov_b32_dpp v126, v130 row_shr:8 row_mask:0xf bank_mask:0xc
v_mov_b32_dpp v127, v131 row_shr:8 row_mask:0xf bank_mask:0xc
v_xor_b32 v26, 0x1000, v26
s_cmp_eq_u32 s19, 63
s_cbranch_scc1 L_bar2b_116_2
s_nop 11
buffer_load_dwordx4 v[200:203], v16, s[8:11], s40 offen sc1
buffer_load_dwordx4 v[204:207], v13, s[8:11], s40 offen sc1
buffer_load_dwordx4 v[208:211], v14, s[8:11], s40 offen sc1
buffer_load_dwordx4 v[212:215], v15, s[8:11], s40 offen sc1
s_barrier
s_nop 15
s_nop 13
buffer_load_dwordx4 v[216:219], v16, s[8:11], s40 offen sc1
buffer_load_dwordx4 v[220:223], v13, s[8:11], s40 offen sc1
buffer_load_dwordx4 v[224:227], v14, s[8:11], s40 offen sc1
buffer_load_dwordx4 v[228:231], v15, s[8:11], s40 offen sc1
s_waitcnt vmcnt(7)
v_permlane32_swap_b32 v200, v202
v_permlane32_swap_b32 v201, v203
s_waitcnt vmcnt(6)
v_pk_add_f32 v[154:155], v[200:201], v[202:203]
v_pk_add_f32 v[148:149], v[124:125], v[204:205]
v_pk_add_f32 v[150:151], v[126:127], v[206:207]
v_permlane16_swap_b32 v154, v155
s_waitcnt vmcnt(5)
v_pk_add_f32 v[148:149], v[148:149], v[208:209]
v_pk_add_f32 v[150:151], v[150:151], v[210:211]
v_add_f32 v152, v154, v155
s_waitcnt vmcnt(4)
v_pk_add_f32 v[148:149], v[148:149], v[212:213]
v_pk_add_f32 v[150:151], v[150:151], v[214:215]
v_pk_add_f32 v[154:155], v[148:149], v[150:151]
v_add_f32 v154, v154, v152
v_cmp_u_f32 vcc, v154, v155
v_max3_f32 v154, v148, v149, v150
v_max3_f32 v154, v154, v151, v152
s_nop 1
v_max_f32_dpp v154, v154, v154 row_ror:8 row_mask:0xf bank_mask:0xf
s_cbranch_vccnz L_cf_122
L_chead_124:
v_mov_b32 v156, v154
s_waitcnt lgkmcnt(0)
s_barrier
v_permlane16_swap_b32 v154, v156
v_max_f32 v154, v154, v156
v_mov_b32 v156, v154
ds_read_b32 v144, v32
ds_read_b32 v146, v32 offset:64
v_permlane32_swap_b32 v154, v156
v_max_f32 v154, v154, v156
v_mul_f32 v154, s44, v154
v_fma_f32 v152, v152, s44, -v154
v_exp_f32 v152, v152
v_pk_fma_f32 v[148:149], v[148:149], s[44:45], v[154:155] op_sel_hi:[1,1,0] neg_lo:[0,0,1] neg_hi:[0,0,1]
v_pk_fma_f32 v[150:151], v[150:151], s[44:45], v[154:155] op_sel_hi:[1,1,0] neg_lo:[0,0,1] neg_hi:[0,0,1]
v_mov_b32_dpp v156, v152 row_ror:8 row_mask:0xf bank_mask:0xf
v_exp_f32 v148, v148
v_cvt_pk_bf16_f32 v164, v152, v156
v_exp_f32 v149, v149
v_exp_f32 v150, v150
v_mfma_f32_16x16x16_bf16 v[176:179], v[44:45], v[164:165], 0
v_exp_f32 v151, v151
s_waitcnt lgkmcnt(0)
v_cvt_pk_bf16_f32 v160, v148, v149
v_mfma_f32_16x16x16_bf16 v[168:171], v[144:145], v[164:165], 0
v_cvt_pk_bf16_f32 v161, v150, v151
v_mov_b32_dpp v162, v160 row_ror:8 row_mask:0xf bank_mask:0xf
v_mfma_f32_16x16x16_bf16 v[172:175], v[146:147], v[164:165], 0
v_mov_b32_dpp v163, v161 row_ror:8 row_mask:0xf bank_mask:0xf
s_nop 0
s_mov_b64 exec, s[24:25]
v_mfma_f32_16x16x32_bf16 v[176:179], v[44:47], v[160:163], v[176:179]
v_mfma_f32_16x16x32_bf16 v[168:171], v[136:139], v[160:163], v[168:171]
v_mfma_f32_16x16x32_bf16 v[172:175], v[140:143], v[160:163], v[172:175]
s_nop 3
v_rcp_f32 v176, v176
s_nop 0
v_pk_mul_f32 v[168:169], v[168:169], v[176:177] op_sel_hi:[1,0]
v_pk_mul_f32 v[170:171], v[170:171], v[176:177] op_sel_hi:[1,0]
v_pk_mul_f32 v[172:173], v[172:173], v[176:177] op_sel_hi:[1,0]
v_pk_mul_f32 v[174:175], v[174:175], v[176:177] op_sel_hi:[1,0]
v_cvt_pk_bf16_f32 v180, v168, v169
v_cvt_pk_bf16_f32 v181, v170, v171
v_cvt_pk_bf16_f32 v182, v172, v173
v_cvt_pk_bf16_f32 v183, v174, v175
buffer_store_dwordx4 v[180:183], v11, s[8:11], s41 offen
s_mov_b64 exec, -1
s_barrier
s_nop 15
s_nop 3
s_branch L_bar3_19_e
L_bar3_19:
s_waitcnt lgkmcnt(0)
s_barrier
s_nop 15
s_nop 7
L_bar3_19_e:
buffer_load_dwordx4 v[48:51], v2, s[8:11], s41 offen sc1
v_mov_b32 v64, 0
v_mov_b32 v65, 0
v_mov_b32 v66, 0
v_mov_b32 v67, 0
v_mov_b32 v68, 0
v_mov_b32 v69, 0
v_mov_b32 v70, 0
v_mov_b32 v71, 0
v_mov_b32 v72, 0
v_mov_b32 v73, 0
v_mov_b32 v74, 0
v_mov_b32 v75, 0
buffer_load_dwordx4 v[52:55], v3, s[8:11], s41 offen sc1
v_mov_b32 v76, 0
v_mov_b32 v77, 0
v_mov_b32 v78, 0
v_mov_b32 v79, 0
v_mov_b32 v80, 0
v_mov_b32 v81, 0
v_mov_b32 v82, 0
v_mov_b32 v83, 0
v_mov_b32 v84, 0
v_mov_b32 v85, 0
v_mov_b32 v86, 0
v_mov_b32 v87, 0
buffer_load_dwordx4 v[56:59], v4, s[8:11], s41 offen sc1
s_nop 11
buffer_load_dwordx4 v[60:63], v5, s[8:11], s41 offen sc1
s_waitcnt vmcnt(3)
v_max3_u32 v7, v48, v49, v50
v_max_u32 v7, v7, v51
v_cmp_eq_u32 vcc, s34, v7
s_cbranch_vccnz L_q_e_126
L_v_e_127:
v_smfmac_f32_16x16x64_bf16 v[88:91], v[48:51], a[192:199], v6
s_waitcnt vmcnt(2)
v_max3_u32 v7, v52, v53, v54
v_max_u32 v7, v7, v55
v_cmp_eq_u32 vcc, s34, v7
v_smfmac_f32_16x16x64_bf16 v[92:95], v[48:51], a[224:231], v6
s_cbranch_vccnz L_q_e_128
L_v_e_129:
v_smfmac_f32_16x16x64_bf16 v[88:91], v[52:55], a[200:207], v6
s_waitcnt vmcnt(1)
v_max3_u32 v7, v56, v57, v58
v_max_u32 v7, v7, v59
v_cmp_eq_u32 vcc, s34, v7
v_smfmac_f32_16x16x64_bf16 v[92:95], v[52:55], a[232:239], v6
s_cbranch_vccnz L_q_e_130
L_v_e_131:
v_smfmac_f32_16x16x64_bf16 v[88:91], v[56:59], a[208:215], v6
s_waitcnt vmcnt(0)
v_max3_u32 v7, v60, v61, v62
v_max_u32 v7, v7, v63
v_cmp_eq_u32 vcc, s34, v7
v_smfmac_f32_16x16x64_bf16 v[92:95], v[56:59], a[240:247], v6
s_cbranch_vccnz L_q_e_132
L_v_e_133:
v_smfmac_f32_16x16x64_bf16 v[88:91], v[60:63], a[216:223], v6
v_smfmac_f32_16x16x64_bf16 v[92:95], v[60:63], a[248:255], v6
L_gd_e_125:
s_add_u32 s19, s19, 1
s_cmp_lg_u32 s18, 0
s_nop 2
v_cvt_pk_bf16_f32 v96, v88, v89
v_cvt_pk_bf16_f32 v97, v90, v91
s_nop 0
v_cvt_pk_bf16_f32 v98, v92, v93
v_cvt_pk_bf16_f32 v99, v94, v95
s_nop 1
v_mfma_f32_16x16x32_bf16 v[104:107], v[96:99], v[252:255], 0
s_cbranch_scc1 L_help2_20
s_barrier
ds_read_b128 v[172:175], v1 offset:18432
ds_read_b128 v[176:179], v1 offset:20480
ds_read_b128 v[180:183], v1 offset:22528
s_waitcnt lgkmcnt(2)
v_pk_add_f32 v[168:169], v[104:105], v[172:173]
v_pk_add_f32 v[170:171], v[106:107], v[174:175]
s_waitcnt lgkmcnt(1)
v_pk_add_f32 v[168:169], v[168:169], v[176:177]
v_pk_add_f32 v[170:171], v[170:171], v[178:179]
s_waitcnt lgkmcnt(0)
v_pk_add_f32 v[168:169], v[168:169], v[180:181]
v_pk_add_f32 v[170:171], v[170:171], v[182:183]
v_cvt_pk_bf16_f32 v96, v168, v169
v_cvt_pk_bf16_f32 v97, v170, v171
buffer_store_dwordx2 v[96:97], v12, s[8:11], s42 offen offset:0 sc1
buffer_store_dwordx2 v[96:97], v12, s[8:11], s42 offen offset:512 sc1
s_mov_b32 s22, s42
s_mov_b32 s23, s39
s_and_b32 s20, s19, 3
s_lshl_b32 s21, s20, 16
s_add_u32 s38, s36, s21
s_add_u32 s41, s38, 0x140000
s_lshl_b32 s21, s20, 18
s_add_u32 s40, s37, s21
s_add_u32 s42, s31, 0x8000000
s_add_u32 s21, s19, 1
s_bitcmp1_b32 s21, 1
s_cselect_b32 s31, s52, s35
s_lshl_b32 s21, s21, 20
s_add_u32 s31, s31, s21
s_add_u32 s20, s20, 1
s_and_b32 s20, s20, 3
s_lshl_b32 s20, s20, 16
s_add_u32 s39, s36, s20
s_nop 15
s_nop 15
s_nop 15
buffer_load_dwordx2 v[200:201], v17, s[8:11], s22 offen offset:0 sc1
buffer_load_dwordx2 v[202:203], v18, s[8:11], s22 offen offset:0 sc1
buffer_load_dwordx2 v[204:205], v19, s[8:11], s22 offen offset:0 sc1
s_nop 15
s_nop 15
s_nop 15
s_nop 11
buffer_load_dwordx2 v[212:213], v17, s[8:11], s22 offen offset:512 sc1
buffer_load_dwordx2 v[214:215], v18, s[8:11], s22 offen offset:512 sc1
buffer_load_dwordx2 v[216:217], v19, s[8:11], s22 offen offset:512 sc1
ds_read_b128 v[172:175], v1 offset:33792
s_mov_b64 exec, s[26:27]
s_waitcnt lgkmcnt(1)
buffer_store_dwordx4 v[112:115], v30, s[8:11], s22 offen offset:3072 sc1
s_mov_b64 exec, s[48:49]
s_waitcnt lgkmcnt(0)
buffer_store_dwordx4 v[172:175], v31, s[8:11], s22 offen offset:3584 sc1
s_mov_b64 exec, -1
s_waitcnt vmcnt(7)
v_lshlrev_b32 v100, 16, v200
v_and_b32 v101, 0xffff0000, v200
v_lshlrev_b32 v102, 16, v201
v_and_b32 v103, 0xffff0000, v201
v_pk_add_f32 v[148:149], v[168:169], v[100:101]
v_pk_add_f32 v[150:151], v[170:171], v[102:103]
s_waitcnt vmcnt(6)
v_lshlrev_b32 v100, 16, v202
v_and_b32 v101, 0xffff0000, v202
v_lshlrev_b32 v102, 16, v203
v_and_b32 v103, 0xffff0000, v203
v_pk_add_f32 v[148:149], v[148:149], v[100:101]
v_pk_add_f32 v[150:151], v[150:151], v[102:103]
s_waitcnt vmcnt(5)
v_lshlrev_b32 v100, 16, v204
v_and_b32 v101, 0xffff0000, v204
v_lshlrev_b32 v102, 16, v205
v_and_b32 v103, 0xffff0000, v205
v_pk_add_f32 v[148:149], v[148:149], v[100:101]
v_pk_add_f32 v[150:151], v[150:151], v[102:103]
v_cmp_u_f32 vcc, v148, v150
v_cvt_pk_bf16_f32 v180, v148, v149
v_cvt_pk_bf16_f32 v181, v150, v151
s_cbranch_vccnz L_gf_217
L_gok_218:
buffer_store_dwordx2 v[180:181], v8, s[8:11], s23 offen
s_barrier
s_branch L_step_17
L_help2_20:
s_nop 2
ds_write_b128 v20, v[104:107] offset:16384
s_waitcnt lgkmcnt(0)
s_barrier
s_and_b32 s20, s19, 3
s_lshl_b32 s21, s20, 16
s_add_u32 s38, s36, s21
s_add_u32 s41, s38, 0x140000
s_lshl_b32 s21, s20, 18
s_add_u32 s40, s37, s21
s_add_u32 s42, s31, 0x8000000
s_add_u32 s21, s19, 1
s_bitcmp1_b32 s21, 1
s_cselect_b32 s31, s52, s35
s_lshl_b32 s21, s21, 20
s_add_u32 s31, s31, s21
s_add_u32 s20, s20, 1
s_and_b32 s20, s20, 3
s_lshl_b32 s20, s20, 16
s_add_u32 s39, s36, s20
s_cmp_eq_u32 s18, 3
s_cbranch_scc1 L_w3_221
s_xor_b32 s20, s18, 2
s_or_b32 s20, s20, s16
s_or_b32 s20, s20, s17
s_cbranch_scc1 L_bar4_21
s_cmp_lt_u32 s19, 3
s_cbranch_scc1 L_bar4_21
s_atomic_add s53, s[98:99], 0x4
s_branch L_bar4_21
L_w3_221:
s_or_b32 s20, s16, s17
s_cbranch_scc1 L_bar4_21
s_add_u32 s23, s19, 2
s_min_u32 s23, s23, 63
s_lshl_b32 s21, s23, 7
v_mov_b32 v34, 0
L_dw_222:
s_load_dword s20, s[54:55], s21 glc
s_add_u32 s33, s33, 1
s_cmp_gt_u32 s33, 0x100000
s_waitcnt lgkmcnt(0)
s_cbranch_scc1 chain_kernel_abort
s_cmp_ge_u32 s20, 64
s_cbranch_scc1 L_dwok_223
s_sleep 2
s_branch L_dw_222
L_dwok_223:
L_bar4_21:
s_barrier
s_branch L_step_17
L_fin_22:
s_cmp_lg_u32 s18, 2
s_cbranch_scc1 chain_kernel_done
ds_read_b128 v[168:171], v1 offset:32768
ds_read_b128 v[172:175], v1 offset:33792
s_mov_b64 exec, s[26:27]
s_waitcnt lgkmcnt(1)
buffer_store_dwordx4 v[168:171], v30, s[8:11], s42 offen offset:3072 sc1
s_mov_b64 exec, s[48:49]
s_waitcnt lgkmcnt(0)
buffer_store_dwordx4 v[172:175], v31, s[8:11], s42 offen offset:3584 sc1
s_mov_b64 exec, -1
s_branch chain_kernel_done
L_q_a_30:
buffer_load_dwordx4 v[60:63], v5, s[8:11], s38 offen sc1
s_waitcnt vmcnt(0)
v_max3_u32 v7, v60, v61, v62
v_max_u32 v7, v7, v63
v_cmp_eq_u32 vcc, s34, v7
s_cbranch_vccnz L_q_a_32
s_branch L_v_a_31
L_q_a_32:
buffer_load_dwordx4 v[60:63], v5, s[8:11], s38 offen sc1
s_waitcnt vmcnt(2)
v_max3_u32 v7, v60, v61, v62
v_max_u32 v7, v7, v63
v_cmp_eq_u32 vcc, s34, v7
s_cbranch_vccz L_ok_a_33
s_add_u32 s33, s33, 1
s_cmp_gt_u32 s33, 0x100000
s_cbranch_scc0 L_q_a_32
s_branch chain_kernel_abort
L_ok_a_33:
v_smfmac_f32_16x16x64_bf16 v[64:67], v[60:63], a[24:31], v6
v_smfmac_f32_16x16x64_bf16 v[68:71], v[60:63], a[88:95], v6
v_smfmac_f32_16x16x64_bf16 v[72:75], v[60:63], a[56:63], v6
v_smfmac_f32_16x16x64_bf16 v[76:79], v[60:63], a[120:127], v6
s_branch L_gd_a_23
L_q_a_28:
buffer_load_dwordx4 v[56:59], v4, s[8:11], s38 offen sc1
s_waitcnt vmcnt(1)
v_max3_u32 v7, v60, v61, v62
v_max_u32 v7, v7, v63
v_cmp_eq_u32 vcc, s34, v7
s_cbranch_vccnz L_q_a_34
L_v_a_35:
v_smfmac_f32_16x16x64_bf16 v[64:67], v[60:63], a[24:31], v6
s_waitcnt vmcnt(0)
v_max3_u32 v7, v56, v57, v58
v_max_u32 v7, v7, v59
v_smfmac_f32_16x16x64_bf16 v[68:71], v[60:63], a[88:95], v6
v_cmp_eq_u32 vcc, s34, v7
v_smfmac_f32_16x16x64_bf16 v[72:75], v[60:63], a[56:63], v6
v_smfmac_f32_16x16x64_bf16 v[76:79], v[60:63], a[120:127], v6
s_cbranch_vccnz L_q_a_36
L_v_a_37:
v_smfmac_f32_16x16x64_bf16 v[64:67], v[56:59], a[16:23], v6
v_smfmac_f32_16x16x64_bf16 v[68:71], v[56:59], a[80:87], v6
v_smfmac_f32_16x16x64_bf16 v[72:75], v[56:59], a[48:55], v6
v_smfmac_f32_16x16x64_bf16 v[76:79], v[56:59], a[112:119], v6
s_branch L_gd_a_23
L_q_a_36:
buffer_load_dwordx4 v[56:59], v4, s[8:11], s38 offen sc1
s_waitcnt vmcnt(2)
v_max3_u32 v7, v56, v57, v58
v_max_u32 v7, v7, v59
v_cmp_eq_u32 vcc, s34, v7
s_cbranch_vccz L_ok_a_38
s_add_u32 s33, s33, 1
s_cmp_gt_u32 s33, 0x100000
s_cbranch_scc0 L_q_a_36
s_branch chain_kernel_abort
L_ok_a_38:
v_smfmac_f32_16x16x64_bf16 v[64:67], v[56:59], a[16:23], v6
v_smfmac_f32_16x16x64_bf16 v[68:71], v[56:59], a[80:87], v6
v_smfmac_f32_16x16x64_bf16 v[72:75], v[56:59], a[48:55], v6
v_smfmac_f32_16x16x64_bf16 v[76:79], v[56:59], a[112:119], v6
s_branch L_gd_a_23
L_q_a_34:
buffer_load_dwordx4 v[60:63], v5, s[8:11], s38 offen sc1
s_waitcnt vmcnt(1)
v_max3_u32 v7, v56, v57, v58
v_max_u32 v7, v7, v59
v_cmp_eq_u32 vcc, s34, v7
s_cbranch_vccnz L_q_a_39
L_v_a_40:
v_smfmac_f32_16x16x64_bf16 v[64:67], v[56:59], a[16:23], v6
s_waitcnt vmcnt(0)
v_max3_u32 v7, v60, v61, v62
v_max_u32 v7, v7, v63
v_smfmac_f32_16x16x64_bf16 v[68:71], v[56:59], a[80:87], v6
v_cmp_eq_u32 vcc, s34, v7
v_smfmac_f32_16x16x64_bf16 v[72:75], v[56:59], a[48:55], v6
v_smfmac_f32_16x16x64_bf16 v[76:79], v[56:59], a[112:119], v6
s_cbranch_vccnz L_q_a_32
s_branch L_v_a_31
L_q_a_39:
buffer_load_dwordx4 v[56:59], v4, s[8:11], s38 offen sc1
s_waitcnt vmcnt(2)
v_max3_u32 v7, v60, v61, v62
v_max_u32 v7, v7, v63
v_cmp_eq_u32 vcc, s34, v7
s_cbranch_vccz L_ok_a_41
buffer_load_dwordx4 v[60:63], v5, s[8:11], s38 offen sc1
s_waitcnt vmcnt(2)
v_max3_u32 v7, v56, v57, v58
v_max_u32 v7, v7, v59
v_cmp_eq_u32 vcc, s34, v7
s_cbranch_vccz L_ok_a_42
s_add_u32 s33, s33, 1
s_cmp_gt_u32 s33, 0x100000
s_cbranch_scc0 L_q_a_39
s_branch chain_kernel_abort
L_ok_a_41:
v_smfmac_f32_16x16x64_bf16 v[64:67], v[60:63], a[24:31], v6
v_smfmac_f32_16x16x64_bf16 v[68:71], v[60:63], a[88:95], v6
v_smfmac_f32_16x16x64_bf16 v[72:75], v[60:63], a[56:63], v6
v_smfmac_f32_16x16x64_bf16 v[76:79], v[60:63], a[120:127], v6
s_branch L_q_a_36
L_ok_a_42:
v_smfmac_f32_16x16x64_bf16 v[64:67], v[56:59], a[16:23], v6
v_smfmac_f32_16x16x64_bf16 v[68:71], v[56:59], a[80:87], v6
v_smfmac_f32_16x16x64_bf16 v[72:75], v[56:59], a[48:55], v6
v_smfmac_f32_16x16x64_bf16 v[76:79], v[56:59], a[112:119], v6
s_branch L_q_a_32
L_q_a_26:
buffer_load_dwordx4 v[52:55], v3, s[8:11], s38 offen sc1
s_waitcnt vmcnt(2)
v_max3_u32 v7, v56, v57, v58
v_max_u32 v7, v7, v59
v_cmp_eq_u32 vcc, s34, v7
s_cbranch_vccnz L_q_a_43
L_v_a_44:
v_smfmac_f32_16x16x64_bf16 v[64:67], v[56:59], a[16:23], v6
s_waitcnt vmcnt(1)
v_max3_u32 v7, v60, v61, v62
v_max_u32 v7, v7, v63
v_smfmac_f32_16x16x64_bf16 v[68:71], v[56:59], a[80:87], v6
v_cmp_eq_u32 vcc, s34, v7
v_smfmac_f32_16x16x64_bf16 v[72:75], v[56:59], a[48:55], v6
v_smfmac_f32_16x16x64_bf16 v[76:79], v[56:59], a[112:119], v6
s_cbranch_vccnz L_q_a_45
L_v_a_46:
v_smfmac_f32_16x16x64_bf16 v[64:67], v[60:63], a[24:31], v6
s_waitcnt vmcnt(0)
v_max3_u32 v7, v52, v53, v54
v_max_u32 v7, v7, v55
v_smfmac_f32_16x16x64_bf16 v[68:71], v[60:63], a[88:95], v6
v_cmp_eq_u32 vcc, s34, v7
v_smfmac_f32_16x16x64_bf16 v[72:75], v[60:63], a[56:63], v6
v_smfmac_f32_16x16x64_bf16 v[76:79], v[60:63], a[120:127], v6
s_cbranch_vccnz L_q_a_47
L_v_a_48:
v_smfmac_f32_16x16x64_bf16 v[64:67], v[52:55], a[8:15], v6
v_smfmac_f32_16x16x64_bf16 v[68:71], v[52:55], a[72:79], v6
v_smfmac_f32_16x16x64_bf16 v[72:75], v[52:55], a[40:47], v6
v_smfmac_f32_16x16x64_bf16 v[76:79], v[52:55], a[104:111], v6
s_branch L_gd_a_23
L_q_a_47:
buffer_load_dwordx4 v[52:55], v3, s[8:11], s38 offen sc1
s_waitcnt vmcnt(2)
v_max3_u32 v7, v52, v53, v54
v_max_u32 v7, v7, v55
v_cmp_eq_u32 vcc, s34, v7
s_cbranch_vccz L_ok_a_49
s_add_u32 s33, s33, 1
s_cmp_gt_u32 s33, 0x100000
s_cbranch_scc0 L_q_a_47
s_branch chain_kernel_abort
L_ok_a_49:
v_smfmac_f32_16x16x64_bf16 v[64:67], v[52:55], a[8:15], v6
v_smfmac_f32_16x16x64_bf16 v[68:71], v[52:55], a[72:79], v6
v_smfmac_f32_16x16x64_bf16 v[72:75], v[52:55], a[40:47], v6
v_smfmac_f32_16x16x64_bf16 v[76:79], v[52:55], a[104:111], v6
s_branch L_gd_a_23
L_q_a_45:
buffer_load_dwordx4 v[60:63], v5, s[8:11], s38 offen sc1
s_waitcnt vmcnt(1)
v_max3_u32 v7, v52, v53, v54
v_max_u32 v7, v7, v55
v_cmp_eq_u32 vcc, s34, v7
s_cbranch_vccnz L_q_a_50
L_v_a_51:
v_smfmac_f32_16x16x64_bf16 v[64:67], v[52:55], a[8:15], v6
s_waitcnt vmcnt(0)
v_max3_u32 v7, v60, v61, v62
v_max_u32 v7, v7, v63
v_smfmac_f32_16x16x64_bf16 v[68:71], v[52:55], a[72:79], v6
v_cmp_eq_u32 vcc, s34, v7
v_smfmac_f32_16x16x64_bf16 v[72:75], v[52:55], a[40:47], v6
v_smfmac_f32_16x16x64_bf16 v[76:79], v[52:55], a[104:111], v6
s_cbranch_vccnz L_q_a_32
s_branch L_v_a_31
L_q_a_50:
buffer_load_dwordx4 v[52:55], v3, s[8:11], s38 offen sc1
s_waitcnt vmcnt(2)
v_max3_u32 v7, v60, v61, v62
v_max_u32 v7, v7, v63
v_cmp_eq_u32 vcc, s34, v7
s_cbranch_vccz L_ok_a_52
buffer_load_dwordx4 v[60:63], v5, s[8:11], s38 offen sc1
s_waitcnt vmcnt(2)
v_max3_u32 v7, v52, v53, v54
v_max_u32 v7, v7, v55
v_cmp_eq_u32 vcc, s34, v7
s_cbranch_vccz L_ok_a_53
s_add_u32 s33, s33, 1
s_cmp_gt_u32 s33, 0x100000
s_cbranch_scc0 L_q_a_50
s_branch chain_kernel_abort
L_ok_a_52:
v_smfmac_f32_16x16x64_bf16 v[64:67], v[60:63], a[24:31], v6
v_smfmac_f32_16x16x64_bf16 v[68:71], v[60:63], a[88:95], v6
v_smfmac_f32_16x16x64_bf16 v[72:75], v[60:63], a[56:63], v6
v_smfmac_f32_16x16x64_bf16 v[76:79], v[60:63], a[120:127], v6
s_branch L_q_a_47
L_ok_a_53:
v_smfmac_f32_16x16x64_bf16 v[64:67], v[52:55], a[8:15], v6
v_smfmac_f32_16x16x64_bf16 v[68:71], v[52:55], a[72:79], v6
v_smfmac_f32_16x16x64_bf16 v[72:75], v[52:55], a[40:47], v6
v_smfmac_f32_16x16x64_bf16 v[76:79], v[52:55], a[104:111], v6
s_branch L_q_a_32
L_q_a_43:
buffer_load_dwordx4 v[56:59], v4, s[8:11], s38 offen sc1
s_waitcnt vmcnt(2)
v_max3_u32 v7, v60, v61, v62
v_max_u32 v7, v7, v63
v_cmp_eq_u32 vcc, s34, v7
s_cbranch_vccnz L_q_a_54
L_v_a_55:
v_smfmac_f32_16x16x64_bf16 v[64:67], v[60:63], a[24:31], v6
s_waitcnt vmcnt(1)
v_max3_u32 v7, v52, v53, v54
v_max_u32 v7, v7, v55
v_smfmac_f32_16x16x64_bf16 v[68:71], v[60:63], a[88:95], v6
v_cmp_eq_u32 vcc, s34, v7
v_smfmac_f32_16x16x64_bf16 v[72:75], v[60:63], a[56:63], v6
v_smfmac_f32_16x16x64_bf16 v[76:79], v[60:63], a[120:127], v6
s_cbranch_vccnz L_q_a_56
L_v_a_57:
v_smfmac_f32_16x16x64_bf16 v[64:67], v[52:55], a[8:15], v6
s_waitcnt vmcnt(0)
v_max3_u32 v7, v56, v57, v58
v_max_u32 v7, v7, v59
v_smfmac_f32_16x16x64_bf16 v[68:71], v[52:55], a[72:79], v6
v_cmp_eq_u32 vcc, s34, v7
v_smfmac_f32_16x16x64_bf16 v[72:75], v[52:55], a[40:47], v6
v_smfmac_f32_16x16x64_bf16 v[76:79], v[52:55], a[104:111], v6
s_cbranch_vccnz L_q_a_36
s_branch L_v_a_37
L_q_a_56:
buffer_load_dwordx4 v[52:55], v3, s[8:11], s38 offen sc1
s_waitcnt vmcnt(2)
v_max3_u32 v7, v56, v57, v58
v_max_u32 v7, v7, v59
v_cmp_eq_u32 vcc, s34, v7
s_cbranch_vccz L_ok_a_58
buffer_load_dwordx4 v[56:59], v4, s[8:11], s38 offen sc1
s_waitcnt vmcnt(2)
v_max3_u32 v7, v52, v53, v54
v_max_u32 v7, v7, v55
v_cmp_eq_u32 vcc, s34, v7
s_cbranch_vccz L_ok_a_59
s_add_u32 s33, s33, 1
s_cmp_gt_u32 s33, 0x100000
s_cbranch_scc0 L_q_a_56
s_branch chain_kernel_abort
L_ok_a_58:
v_smfmac_f32_16x16x64_bf16 v[64:67], v[56:59], a[16:23], v6
v_smfmac_f32_16x16x64_bf16 v[68:71], v[56:59], a[80:87], v6
v_smfmac_f32_16x16x64_bf16 v[72:75], v[56:59], a[48:55], v6
v_smfmac_f32_16x16x64_bf16 v[76:79], v[56:59], a[112:119], v6
s_branch L_q_a_47
L_ok_a_59:
v_smfmac_f32_16x16x64_bf16 v[64:67], v[52:55], a[8:15], v6
v_smfmac_f32_16x16x64_bf16 v[68:71], v[52:55], a[72:79], v6
v_smfmac_f32_16x16x64_bf16 v[72:75], v[52:55], a[40:47], v6
v_smfmac_f32_16x16x64_bf16 v[76:79], v[52:55], a[104:111], v6
s_branch L_q_a_36
L_q_a_54:
buffer_load_dwordx4 v[60:63], v5, s[8:11], s38 offen sc1
s_waitcnt vmcnt(2)
v_max3_u32 v7, v52, v53, v54
v_max_u32 v7, v7, v55
v_cmp_eq_u32 vcc, s34, v7
s_cbranch_vccnz L_q_a_60
L_v_a_61:
v_smfmac_f32_16x16x64_bf16 v[64:67], v[52:55], a[8:15], v6
s_waitcnt vmcnt(1)
v_max3_u32 v7, v56, v57, v58
v_max_u32 v7, v7, v59
v_smfmac_f32_16x16x64_bf16 v[68:71], v[52:55], a[72:79], v6
v_cmp_eq_u32 vcc, s34, v7
v_smfmac_f32_16x16x64_bf16 v[72:75], v[52:55], a[40:47], v6
v_smfmac_f32_16x16x64_bf16 v[76:79], v[52:55], a[104:111], v6
s_cbranch_vccnz L_q_a_39
s_branch L_v_a_40
L_q_a_60:
buffer_load_dwordx4 v[52:55], v3, s[8:11], s38 offen sc1
s_waitcnt vmcnt(2)
v_max3_u32 v7, v56, v57, v58
v_max_u32 v7, v7, v59
v_cmp_eq_u32 vcc, s34, v7
s_cbranch_vccz L_ok_a_62
buffer_load_dwordx4 v[56:59], v4, s[8:11], s38 offen sc1
s_waitcnt vmcnt(2)
v_max3_u32 v7, v60, v61, v62
v_max_u32 v7, v7, v63
v_cmp_eq_u32 vcc, s34, v7
s_cbranch_vccz L_ok_a_63
buffer_load_dwordx4 v[60:63], v5, s[8:11], s38 offen sc1
s_waitcnt vmcnt(2)
v_max3_u32 v7, v52, v53, v54
v_max_u32 v7, v7, v55
v_cmp_eq_u32 vcc, s34, v7
s_cbranch_vccz L_ok_a_64
s_add_u32 s33, s33, 1
s_cmp_gt_u32 s33, 0x100000
s_cbranch_scc0 L_q_a_60
s_branch chain_kernel_abort
L_ok_a_62:
v_smfmac_f32_16x16x64_bf16 v[64:67], v[56:59], a[16:23], v6
v_smfmac_f32_16x16x64_bf16 v[68:71], v[56:59], a[80:87], v6
v_smfmac_f32_16x16x64_bf16 v[72:75], v[56:59], a[48:55], v6
v_smfmac_f32_16x16x64_bf16 v[76:79], v[56:59], a[112:119], v6
s_branch L_q_a_50
L_ok_a_63:
v_smfmac_f32_16x16x64_bf16 v[64:67], v[60:63], a[24:31], v6
v_smfmac_f32_16x16x64_bf16 v[68:71], v[60:63], a[88:95], v6
v_smfmac_f32_16x16x64_bf16 v[72:75], v[60:63], a[56:63], v6
v_smfmac_f32_16x16x64_bf16 v[76:79], v[60:63], a[120:127], v6
s_branch L_q_a_56
L_ok_a_64:
v_smfmac_f32_16x16x64_bf16 v[64:67], v[52:55], a[8:15], v6
v_smfmac_f32_16x16x64_bf16 v[68:71], v[52:55], a[72:79], v6
v_smfmac_f32_16x16x64_bf16 v[72:75], v[52:55], a[40:47], v6
v_smfmac_f32_16x16x64_bf16 v[76:79], v[52:55], a[104:111], v6
s_branch L_q_a_39
L_q_a_24:
buffer_load_dwordx4 v[48:51], v2, s[8:11], s38 offen sc1
s_waitcnt vmcnt(3)
v_max3_u32 v7, v52, v53, v54
v_max_u32 v7, v7, v55
v_cmp_eq_u32 vcc, s34, v7
s_cbranch_vccnz L_q_a_65
L_v_a_66:
v_smfmac_f32_16x16x64_bf16 v[64:67], v[52:55], a[8:15], v6
s_waitcnt vmcnt(2)
v_max3_u32 v7, v56, v57, v58
v_max_u32 v7, v7, v59
v_smfmac_f32_16x16x64_bf16 v[68:71], v[52:55], a[72:79], v6
v_cmp_eq_u32 vcc, s34, v7
v_smfmac_f32_16x16x64_bf16 v[72:75], v[52:55], a[40:47], v6
v_smfmac_f32_16x16x64_bf16 v[76:79], v[52:55], a[104:111], v6
s_cbranch_vccnz L_q_a_67
L_v_a_68:
v_smfmac_f32_16x16x64_bf16 v[64:67], v[56:59], a[16:23], v6
s_waitcnt vmcnt(1)
v_max3_u32 v7, v60, v61, v62
v_max_u32 v7, v7, v63
v_smfmac_f32_16x16x64_bf16 v[68:71], v[56:59], a[80:87], v6
v_cmp_eq_u32 vcc, s34, v7
v_smfmac_f32_16x16x64_bf16 v[72:75], v[56:59], a[48:55], v6
v_smfmac_f32_16x16x64_bf16 v[76:79], v[56:59], a[112:119], v6
s_cbranch_vccnz L_q_a_69
L_v_a_70:
v_smfmac_f32_16x16x64_bf16 v[64:67], v[60:63], a[24:31], v6
s_waitcnt vmcnt(0)
v_max3_u32 v7, v48, v49, v50
v_max_u32 v7, v7, v51
v_smfmac_f32_16x16x64_bf16 v[68:71], v[60:63], a[88:95], v6
v_cmp_eq_u32 vcc, s34, v7
v_smfmac_f32_16x16x64_bf16 v[72:75], v[60:63], a[56:63], v6
v_smfmac_f32_16x16x64_bf16 v[76:79], v[60:63], a[120:127], v6
s_cbranch_vccnz L_q_a_71
L_v_a_72:
v_smfmac_f32_16x16x64_bf16 v[64:67], v[48:51], a[0:7], v6
v_smfmac_f32_16x16x64_bf16 v[68:71], v[48:51], a[64:71], v6
v_smfmac_f32_16x16x64_bf16 v[72:75], v[48:51], a[32:39], v6
v_smfmac_f32_16x16x64_bf16 v[76:79], v[48:51], a[96:103], v6
s_branch L_gd_a_23
L_q_a_71:
buffer_load_dwordx4 v[48:51], v2, s[8:11], s38 offen sc1
s_waitcnt vmcnt(2)
v_max3_u32 v7, v48, v49, v50
v_max_u32 v7, v7, v51
v_cmp_eq_u32 vcc, s34, v7
s_cbranch_vccz L_ok_a_73
s_add_u32 s33, s33, 1
s_cmp_gt_u32 s33, 0x100000
s_cbranch_scc0 L_q_a_71
s_branch chain_kernel_abort
L_ok_a_73:
v_smfmac_f32_16x16x64_bf16 v[64:67], v[48:51], a[0:7], v6
v_smfmac_f32_16x16x64_bf16 v[68:71], v[48:51], a[64:71], v6
v_smfmac_f32_16x16x64_bf16 v[72:75], v[48:51], a[32:39], v6
v_smfmac_f32_16x16x64_bf16 v[76:79], v[48:51], a[96:103], v6
s_branch L_gd_a_23
L_q_a_69:
buffer_load_dwordx4 v[60:63], v5, s[8:11], s38 offen sc1
s_waitcnt vmcnt(1)
v_max3_u32 v7, v48, v49, v50
v_max_u32 v7, v7, v51
v_cmp_eq_u32 vcc, s34, v7
s_cbranch_vccnz L_q_a_74
L_v_a_75:
v_smfmac_f32_16x16x64_bf16 v[64:67], v[48:51], a[0:7], v6
s_waitcnt vmcnt(0)
v_max3_u32 v7, v60, v61, v62
v_max_u32 v7, v7, v63
v_smfmac_f32_16x16x64_bf16 v[68:71], v[48:51], a[64:71], v6
v_cmp_eq_u32 vcc, s34, v7
v_smfmac_f32_16x16x64_bf16 v[72:75], v[48:51], a[32:39], v6
v_smfmac_f32_16x16x64_bf16 v[76:79], v[48:51], a[96:103], v6
s_cbranch_vccnz L_q_a_32
s_branch L_v_a_31
L_q_a_74:
buffer_load_dwordx4 v[48:51], v2, s[8:11], s38 offen sc1
s_waitcnt vmcnt(2)
v_max3_u32 v7, v60, v61, v62
v_max_u32 v7, v7, v63
v_cmp_eq_u32 vcc, s34, v7
s_cbranch_vccz L_ok_a_76
buffer_load_dwordx4 v[60:63], v5, s[8:11], s38 offen sc1
s_waitcnt vmcnt(2)
v_max3_u32 v7, v48, v49, v50
v_max_u32 v7, v7, v51
v_cmp_eq_u32 vcc, s34, v7
s_cbranch_vccz L_ok_a_77
s_add_u32 s33, s33, 1
s_cmp_gt_u32 s33, 0x100000
s_cbranch_scc0 L_q_a_74
s_branch chain_kernel_abort
L_ok_a_76:
v_smfmac_f32_16x16x64_bf16 v[64:67], v[60:63], a[24:31], v6
v_smfmac_f32_16x16x64_bf16 v[68:71], v[60:63], a[88:95], v6
v_smfmac_f32_16x16x64_bf16 v[72:75], v[60:63], a[56:63], v6
v_smfmac_f32_16x16x64_bf16 v[76:79], v[60:63], a[120:127], v6
s_branch L_q_a_71
L_ok_a_77:
v_smfmac_f32_16x16x64_bf16 v[64:67], v[48:51], a[0:7], v6
v_smfmac_f32_16x16x64_bf16 v[68:71], v[48:51], a[64:71], v6
v_smfmac_f32_16x16x64_bf16 v[72:75], v[48:51], a[32:39], v6
v_smfmac_f32_16x16x64_bf16 v[76:79], v[48:51], a[96:103], v6
s_branch L_q_a_32
L_q_a_67:
buffer_load_dwordx4 v[56:59], v4, s[8:11], s38 offen sc1
s_waitcnt vmcnt(2)
v_max3_u32 v7, v60, v61, v62
v_max_u32 v7, v7, v63
v_cmp_eq_u32 vcc, s34, v7
s_cbranch_vccnz L_q_a_78
L_v_a_79:
v_smfmac_f32_16x16x64_bf16 v[64:67], v[60:63], a[24:31], v6
s_waitcnt vmcnt(1)
v_max3_u32 v7, v48, v49, v50
v_max_u32 v7, v7, v51
v_smfmac_f32_16x16x64_bf16 v[68:71], v[60:63], a[88:95], v6
v_cmp_eq_u32 vcc, s34, v7
v_smfmac_f32_16x16x64_bf16 v[72:75], v[60:63], a[56:63], v6
v_smfmac_f32_16x16x64_bf16 v[76:79], v[60:63], a[120:127], v6
s_cbranch_vccnz L_q_a_80
L_v_a_81:
v_smfmac_f32_16x16x64_bf16 v[64:67], v[48:51], a[0:7], v6
s_waitcnt vmcnt(0)
v_max3_u32 v7, v56, v57, v58
v_max_u32 v7, v7, v59
v_smfmac_f32_16x16x64_bf16 v[68:71], v[48:51], a[64:71], v6
v_cmp_eq_u32 vcc, s34, v7
v_smfmac_f32_16x16x64_bf16 v[72:75], v[48:51], a[32:39], v6
v_smfmac_f32_16x16x64_bf16 v[76:79], v[48:51], a[96:103], v6
s_cbranch_vccnz L_q_a_36
s_branch L_v_a_37
L_q_a_80:
buffer_load_dwordx4 v[48:51], v2, s[8:11], s38 offen sc1
s_waitcnt vmcnt(2)
v_max3_u32 v7, v56, v57, v58
v_max_u32 v7, v7, v59
v_cmp_eq_u32 vcc, s34, v7
s_cbranch_vccz L_ok_a_82
buffer_load_dwordx4 v[56:59], v4, s[8:11], s38 offen sc1
s_waitcnt vmcnt(2)
v_max3_u32 v7, v48, v49, v50
v_max_u32 v7, v7, v51
v_cmp_eq_u32 vcc, s34, v7
s_cbranch_vccz L_ok_a_83
s_add_u32 s33, s33, 1
s_cmp_gt_u32 s33, 0x100000
s_cbranch_scc0 L_q_a_80
s_branch chain_kernel_abort
L_ok_a_82:
v_smfmac_f32_16x16x64_bf16 v[64:67], v[56:59], a[16:23], v6
v_smfmac_f32_16x16x64_bf16 v[68:71], v[56:59], a[80:87], v6
v_smfmac_f32_16x16x64_bf16 v[72:75], v[56:59], a[48:55], v6
v_smfmac_f32_16x16x64_bf16 v[76:79], v[56:59], a[112:119], v6
s_branch L_q_a_71
L_ok_a_83:
v_smfmac_f32_16x16x64_bf16 v[64:67], v[48:51], a[0:7], v6
v_smfmac_f32_16x16x64_bf16 v[68:71], v[48:51], a[64:71], v6
v_smfmac_f32_16x16x64_bf16 v[72:75], v[48:51], a[32:39], v6
v_smfmac_f32_16x16x64_bf16 v[76:79], v[48:51], a[96:103], v6
s_branch L_q_a_36
L_q_a_78:
buffer_load_dwordx4 v[60:63], v5, s[8:11], s38 offen sc1
s_waitcnt vmcnt(2)
v_max3_u32 v7, v48, v49, v50
v_max_u32 v7, v7, v51
v_cmp_eq_u32 vcc, s34, v7
s_cbranch_vccnz L_q_a_84
L_v_a_85:
v_smfmac_f32_16x16x64_bf16 v[64:67], v[48:51], a[0:7], v6
s_waitcnt vmcnt(1)
v_max3_u32 v7, v56, v57, v58
v_max_u32 v7, v7, v59
v_smfmac_f32_16x16x64_bf16 v[68:71], v[48:51], a[64:71], v6
v_cmp_eq_u32 vcc, s34, v7
v_smfmac_f32_16x16x64_bf16 v[72:75], v[48:51], a[32:39], v6
v_smfmac_f32_16x16x64_bf16 v[76:79], v[48:51], a[96:103], v6
s_cbranch_vccnz L_q_a_39
s_branch L_v_a_40
L_q_a_84:
buffer_load_dwordx4 v[48:51], v2, s[8:11], s38 offen sc1
s_waitcnt vmcnt(2)
v_max3_u32 v7, v56, v57, v58
v_max_u32 v7, v7, v59
v_cmp_eq_u32 vcc, s34, v7
s_cbranch_vccz L_ok_a_86
buffer_load_dwordx4 v[56:59], v4, s[8:11], s38 offen sc1
s_waitcnt vmcnt(2)
v_max3_u32 v7, v60, v61, v62
v_max_u32 v7, v7, v63
v_cmp_eq_u32 vcc, s34, v7
s_cbranch_vccz L_ok_a_87
buffer_load_dwordx4 v[60:63], v5, s[8:11], s38 offen sc1
s_waitcnt vmcnt(2)
v_max3_u32 v7, v48, v49, v50
v_max_u32 v7, v7, v51
v_cmp_eq_u32 vcc, s34, v7
s_cbranch_vccz L_ok_a_88
s_add_u32 s33, s33, 1
s_cmp_gt_u32 s33, 0x100000
s_cbranch_scc0 L_q_a_84
s_branch chain_kernel_abort
L_ok_a_86:
v_smfmac_f32_16x16x64_bf16 v[64:67], v[56:59], a[16:23], v6
v_smfmac_f32_16x16x64_bf16 v[68:71], v[56:59], a[80:87], v6
v_smfmac_f32_16x16x64_bf16 v[72:75], v[56:59], a[48:55], v6
v_smfmac_f32_16x16x64_bf16 v[76:79], v[56:59], a[112:119], v6
s_branch L_q_a_74
L_ok_a_87:
v_smfmac_f32_16x16x64_bf16 v[64:67], v[60:63], a[24:31], v6
v_smfmac_f32_16x16x64_bf16 v[68:71], v[60:63], a[88:95], v6
v_smfmac_f32_16x16x64_bf16 v[72:75], v[60:63], a[56:63], v6
v_smfmac_f32_16x16x64_bf16 v[76:79], v[60:63], a[120:127], v6
s_branch L_q_a_80
L_ok_a_88:
v_smfmac_f32_16x16x64_bf16 v[64:67], v[48:51], a[0:7], v6
v_smfmac_f32_16x16x64_bf16 v[68:71], v[48:51], a[64:71], v6
v_smfmac_f32_16x16x64_bf16 v[72:75], v[48:51], a[32:39], v6
v_smfmac_f32_16x16x64_bf16 v[76:79], v[48:51], a[96:103], v6
s_branch L_q_a_39
L_q_a_65:
buffer_load_dwordx4 v[52:55], v3, s[8:11], s38 offen sc1
s_waitcnt vmcnt(3)
v_max3_u32 v7, v56, v57, v58
v_max_u32 v7, v7, v59
v_cmp_eq_u32 vcc, s34, v7
s_cbranch_vccnz L_q_a_89
L_v_a_90:
v_smfmac_f32_16x16x64_bf16 v[64:67], v[56:59], a[16:23], v6
s_waitcnt vmcnt(2)
v_max3_u32 v7, v60, v61, v62
v_max_u32 v7, v7, v63
v_smfmac_f32_16x16x64_bf16 v[68:71], v[56:59], a[80:87], v6
v_cmp_eq_u32 vcc, s34, v7
v_smfmac_f32_16x16x64_bf16 v[72:75], v[56:59], a[48:55], v6
v_smfmac_f32_16x16x64_bf16 v[76:79], v[56:59], a[112:119], v6
s_cbranch_vccnz L_q_a_91
L_v_a_92:
v_smfmac_f32_16x16x64_bf16 v[64:67], v[60:63], a[24:31], v6
s_waitcnt vmcnt(1)
v_max3_u32 v7, v48, v49, v50
v_max_u32 v7, v7, v51
v_smfmac_f32_16x16x64_bf16 v[68:71], v[60:63], a[88:95], v6
v_cmp_eq_u32 vcc, s34, v7
v_smfmac_f32_16x16x64_bf16 v[72:75], v[60:63], a[56:63], v6
v_smfmac_f32_16x16x64_bf16 v[76:79], v[60:63], a[120:127], v6
s_cbranch_vccnz L_q_a_93
L_v_a_94:
v_smfmac_f32_16x16x64_bf16 v[64:67], v[48:51], a[0:7], v6
s_waitcnt vmcnt(0)
v_max3_u32 v7, v52, v53, v54
v_max_u32 v7, v7, v55
v_smfmac_f32_16x16x64_bf16 v[68:71], v[48:51], a[64:71], v6
v_cmp_eq_u32 vcc, s34, v7
v_smfmac_f32_16x16x64_bf16 v[72:75], v[48:51], a[32:39], v6
v_smfmac_f32_16x16x64_bf16 v[76:79], v[48:51], a[96:103], v6
s_cbranch_vccnz L_q_a_47
s_branch L_v_a_48
L_q_a_93:
buffer_load_dwordx4 v[48:51], v2, s[8:11], s38 offen sc1
s_waitcnt vmcnt(2)
v_max3_u32 v7, v52, v53, v54
v_max_u32 v7, v7, v55
v_cmp_eq_u32 vcc, s34, v7
s_cbranch_vccz L_ok_a_95
buffer_load_dwordx4 v[52:55], v3, s[8:11], s38 offen sc1
s_waitcnt vmcnt(2)
v_max3_u32 v7, v48, v49, v50
v_max_u32 v7, v7, v51
v_cmp_eq_u32 vcc, s34, v7
s_cbranch_vccz L_ok_a_96
s_add_u32 s33, s33, 1
s_cmp_gt_u32 s33, 0x100000
s_cbranch_scc0 L_q_a_93
s_branch chain_kernel_abort
L_ok_a_95:
v_smfmac_f32_16x16x64_bf16 v[64:67], v[52:55], a[8:15], v6
v_smfmac_f32_16x16x64_bf16 v[68:71], v[52:55], a[72:79], v6
v_smfmac_f32_16x16x64_bf16 v[72:75], v[52:55], a[40:47], v6
v_smfmac_f32_16x16x64_bf16 v[76:79], v[52:55], a[104:111], v6
s_branch L_q_a_71
L_ok_a_96:
v_smfmac_f32_16x16x64_bf16 v[64:67], v[48:51], a[0:7], v6
v_smfmac_f32_16x16x64_bf16 v[68:71], v[48:51], a[64:71], v6
v_smfmac_f32_16x16x64_bf16 v[72:75], v[48:51], a[32:39], v6
v_smfmac_f32_16x16x64_bf16 v[76:79], v[48:51], a[96:103], v6
s_branch L_q_a_47
L_q_a_91:
buffer_load_dwordx4 v[60:63], v5, s[8:11], s38 offen sc1
s_waitcnt vmcnt(2)
v_max3_u32 v7, v48, v49, v50
v_max_u32 v7, v7, v51
v_cmp_eq_u32 vcc, s34, v7
s_cbranch_vccnz L_q_a_97
L_v_a_98:
v_smfmac_f32_16x16x64_bf16 v[64:67], v[48:51], a[0:7], v6
s_waitcnt vmcnt(1)
v_max3_u32 v7, v52, v53, v54
v_max_u32 v7, v7, v55
v_smfmac_f32_16x16x64_bf16 v[68:71], v[48:51], a[64:71], v6
v_cmp_eq_u32 vcc, s34, v7
v_smfmac_f32_16x16x64_bf16 v[72:75], v[48:51], a[32:39], v6
v_smfmac_f32_16x16x64_bf16 v[76:79], v[48:51], a[96:103], v6
s_cbranch_vccnz L_q_a_50
s_branch L_v_a_51
L_q_a_97:
buffer_load_dwordx4 v[48:51], v2, s[8:11], s38 offen sc1
s_waitcnt vmcnt(2)
v_max3_u32 v7, v52, v53, v54
v_max_u32 v7, v7, v55
v_cmp_eq_u32 vcc, s34, v7
s_cbranch_vccz L_ok_a_99
buffer_load_dwordx4 v[52:55], v3, s[8:11], s38 offen sc1
s_waitcnt vmcnt(2)
v_max3_u32 v7, v60, v61, v62
v_max_u32 v7, v7, v63
v_cmp_eq_u32 vcc, s34, v7
s_cbranch_vccz L_ok_a_100
buffer_load_dwordx4 v[60:63], v5, s[8:11], s38 offen sc1
s_waitcnt vmcnt(2)
v_max3_u32 v7, v48, v49, v50
v_max_u32 v7, v7, v51
v_cmp_eq_u32 vcc, s34, v7
s_cbranch_vccz L_ok_a_101
s_add_u32 s33, s33, 1
s_cmp_gt_u32 s33, 0x100000
s_cbranch_scc0 L_q_a_97
s_branch chain_kernel_abort
L_ok_a_99:
v_smfmac_f32_16x16x64_bf16 v[64:67], v[52:55], a[8:15], v6
v_smfmac_f32_16x16x64_bf16 v[68:71], v[52:55], a[72:79], v6
v_smfmac_f32_16x16x64_bf16 v[72:75], v[52:55], a[40:47], v6
v_smfmac_f32_16x16x64_bf16 v[76:79], v[52:55], a[104:111], v6
s_branch L_q_a_74
L_ok_a_100:
v_smfmac_f32_16x16x64_bf16 v[64:67], v[60:63], a[24:31], v6
v_smfmac_f32_16x16x64_bf16 v[68:71], v[60:63], a[88:95], v6
v_smfmac_f32_16x16x64_bf16 v[72:75], v[60:63], a[56:63], v6
v_smfmac_f32_16x16x64_bf16 v[76:79], v[60:63], a[120:127], v6
s_branch L_q_a_93
L_ok_a_101:
v_smfmac_f32_16x16x64_bf16 v[64:67], v[48:51], a[0:7], v6
v_smfmac_f32_16x16x64_bf16 v[68:71], v[48:51], a[64:71], v6
v_smfmac_f32_16x16x64_bf16 v[72:75], v[48:51], a[32:39], v6
v_smfmac_f32_16x16x64_bf16 v[76:79], v[48:51], a[96:103], v6
s_branch L_q_a_50
L_q_a_89:
buffer_load_dwordx4 v[56:59], v4, s[8:11], s38 offen sc1
s_waitcnt vmcnt(3)
v_max3_u32 v7, v60, v61, v62
v_max_u32 v7, v7, v63
v_cmp_eq_u32 vcc, s34, v7
s_cbranch_vccnz L_q_a_102
L_v_a_103:
v_smfmac_f32_16x16x64_bf16 v[64:67], v[60:63], a[24:31], v6
s_waitcnt vmcnt(2)
v_max3_u32 v7, v48, v49, v50
v_max_u32 v7, v7, v51
v_smfmac_f32_16x16x64_bf16 v[68:71], v[60:63], a[88:95], v6
v_cmp_eq_u32 vcc, s34, v7
v_smfmac_f32_16x16x64_bf16 v[72:75], v[60:63], a[56:63], v6
v_smfmac_f32_16x16x64_bf16 v[76:79], v[60:63], a[120:127], v6
s_cbranch_vccnz L_q_a_104
L_v_a_105:
v_smfmac_f32_16x16x64_bf16 v[64:67], v[48:51], a[0:7], v6
s_waitcnt vmcnt(1)
v_max3_u32 v7, v52, v53, v54
v_max_u32 v7, v7, v55
v_smfmac_f32_16x16x64_bf16 v[68:71], v[48:51], a[64:71], v6
v_cmp_eq_u32 vcc, s34, v7
v_smfmac_f32_16x16x64_bf16 v[72:75], v[48:51], a[32:39], v6
v_smfmac_f32_16x16x64_bf16 v[76:79], v[48:51], a[96:103], v6
s_cbranch_vccnz L_q_a_56
s_branch L_v_a_57
L_q_a_104:
buffer_load_dwordx4 v[48:51], v2, s[8:11], s38 offen sc1
s_waitcnt vmcnt(2)
v_max3_u32 v7, v52, v53, v54
v_max_u32 v7, v7, v55
v_cmp_eq_u32 vcc, s34, v7
s_cbranch_vccz L_ok_a_106
buffer_load_dwordx4 v[52:55], v3, s[8:11], s38 offen sc1
s_waitcnt vmcnt(2)
v_max3_u32 v7, v56, v57, v58
v_max_u32 v7, v7, v59
v_cmp_eq_u32 vcc, s34, v7
s_cbranch_vccz L_ok_a_107
buffer_load_dwordx4 v[56:59], v4, s[8:11], s38 offen sc1
s_waitcnt vmcnt(2)
v_max3_u32 v7, v48, v49, v50
v_max_u32 v7, v7, v51
v_cmp_eq_u32 vcc, s34, v7
s_cbranch_vccz L_ok_a_108
s_add_u32 s33, s33, 1
s_cmp_gt_u32 s33, 0x100000
s_cbranch_scc0 L_q_a_104
s_branch chain_kernel_abort
L_ok_a_106:
v_smfmac_f32_16x16x64_bf16 v[64:67], v[52:55], a[8:15], v6
v_smfmac_f32_16x16x64_bf16 v[68:71], v[52:55], a[72:79], v6
v_smfmac_f32_16x16x64_bf16 v[72:75], v[52:55], a[40:47], v6
v_smfmac_f32_16x16x64_bf16 v[76:79], v[52:55], a[104:111], v6
s_branch L_q_a_80
L_ok_a_107:
v_smfmac_f32_16x16x64_bf16 v[64:67], v[56:59], a[16:23], v6
v_smfmac_f32_16x16x64_bf16 v[68:71], v[56:59], a[80:87], v6
v_smfmac_f32_16x16x64_bf16 v[72:75], v[56:59], a[48:55], v6
v_smfmac_f32_16x16x64_bf16 v[76:79], v[56:59], a[112:119], v6
s_branch L_q_a_93
L_ok_a_108:
v_smfmac_f32_16x16x64_bf16 v[64:67], v[48:51], a[0:7], v6
v_smfmac_f32_16x16x64_bf16 v[68:71], v[48:51], a[64:71], v6
v_smfmac_f32_16x16x64_bf16 v[72:75], v[48:51], a[32:39], v6
v_smfmac_f32_16x16x64_bf16 v[76:79], v[48:51], a[96:103], v6
s_branch L_q_a_56
L_q_a_102:
buffer_load_dwordx4 v[60:63], v5, s[8:11], s38 offen sc1
s_waitcnt vmcnt(3)
v_max3_u32 v7, v48, v49, v50
v_max_u32 v7, v7, v51
v_cmp_eq_u32 vcc, s34, v7
s_cbranch_vccnz L_q_a_109
L_v_a_110:
v_smfmac_f32_16x16x64_bf16 v[64:67], v[48:51], a[0:7], v6
s_waitcnt vmcnt(2)
v_max3_u32 v7, v52, v53, v54
v_max_u32 v7, v7, v55
v_smfmac_f32_16x16x64_bf16 v[68:71], v[48:51], a[64:71], v6
v_cmp_eq_u32 vcc, s34, v7
v_smfmac_f32_16x16x64_bf16 v[72:75], v[48:51], a[32:39], v6
v_smfmac_f32_16x16x64_bf16 v[76:79], v[48:51], a[96:103], v6
s_cbranch_vccnz L_q_a_60
s_branch L_v_a_61
L_q_a_109:
buffer_load_dwordx4 v[48:51], v2, s[8:11], s38 offen sc1
s_waitcnt vmcnt(2)
v_max3_u32 v7, v52, v53, v54
v_max_u32 v7, v7, v55
v_cmp_eq_u32 vcc, s34, v7
s_cbranch_vccz L_ok_a_111
buffer_load_dwordx4 v[52:55], v3, s[8:11], s38 offen sc1
s_waitcnt vmcnt(2)
v_max3_u32 v7, v56, v57, v58
v_max_u32 v7, v7, v59
v_cmp_eq_u32 vcc, s34, v7
s_cbranch_vccz L_ok_a_112
buffer_load_dwordx4 v[56:59], v4, s[8:11], s38 offen sc1
s_waitcnt vmcnt(2)
v_max3_u32 v7, v60, v61, v62
v_max_u32 v7, v7, v63
v_cmp_eq_u32 vcc, s34, v7
s_cbranch_vccz L_ok_a_113
buffer_load_dwordx4 v[60:63], v5, s[8:11], s38 offen sc1
s_waitcnt vmcnt(2)
v_max3_u32 v7, v48, v49, v50
v_max_u32 v7, v7, v51
v_cmp_eq_u32 vcc, s34, v7
s_cbranch_vccz L_ok_a_114
s_add_u32 s33, s33, 1
s_cmp_gt_u32 s33, 0x100000
s_cbranch_scc0 L_q_a_109
s_branch chain_kernel_abort
L_ok_a_111:
v_smfmac_f32_16x16x64_bf16 v[64:67], v[52:55], a[8:15], v6
v_smfmac_f32_16x16x64_bf16 v[68:71], v[52:55], a[72:79], v6
v_smfmac_f32_16x16x64_bf16 v[72:75], v[52:55], a[40:47], v6
v_smfmac_f32_16x16x64_bf16 v[76:79], v[52:55], a[104:111], v6
s_branch L_q_a_84
L_ok_a_112:
v_smfmac_f32_16x16x64_bf16 v[64:67], v[56:59], a[16:23], v6
v_smfmac_f32_16x16x64_bf16 v[68:71], v[56:59], a[80:87], v6
v_smfmac_f32_16x16x64_bf16 v[72:75], v[56:59], a[48:55], v6
v_smfmac_f32_16x16x64_bf16 v[76:79], v[56:59], a[112:119], v6
s_branch L_q_a_97
L_ok_a_113:
v_smfmac_f32_16x16x64_bf16 v[64:67], v[60:63], a[24:31], v6
v_smfmac_f32_16x16x64_bf16 v[68:71], v[60:63], a[88:95], v6
v_smfmac_f32_16x16x64_bf16 v[72:75], v[60:63], a[56:63], v6
v_smfmac_f32_16x16x64_bf16 v[76:79], v[60:63], a[120:127], v6
s_branch L_q_a_104
L_ok_a_114:
v_smfmac_f32_16x16x64_bf16 v[64:67], v[48:51], a[0:7], v6
v_smfmac_f32_16x16x64_bf16 v[68:71], v[48:51], a[64:71], v6
v_smfmac_f32_16x16x64_bf16 v[72:75], v[48:51], a[32:39], v6
v_smfmac_f32_16x16x64_bf16 v[76:79], v[48:51], a[96:103], v6
s_branch L_q_a_60
L_cf_122:
L_rt_123:
buffer_load_dwordx4 v[200:203], v16, s[8:11], s40 offen sc1
buffer_load_dwordx4 v[204:207], v13, s[8:11], s40 offen sc1
buffer_load_dwordx4 v[208:211], v14, s[8:11], s40 offen sc1
buffer_load_dwordx4 v[212:215], v15, s[8:11], s40 offen sc1
s_waitcnt vmcnt(7)
v_permlane32_swap_b32 v216, v218
v_permlane32_swap_b32 v217, v219
s_waitcnt vmcnt(6)
v_pk_add_f32 v[154:155], v[216:217], v[218:219]
v_pk_add_f32 v[148:149], v[124:125], v[220:221]
v_pk_add_f32 v[150:151], v[126:127], v[222:223]
v_permlane16_swap_b32 v154, v155
s_waitcnt vmcnt(5)
v_pk_add_f32 v[148:149], v[148:149], v[224:225]
v_pk_add_f32 v[150:151], v[150:151], v[226:227]
v_add_f32 v152, v154, v155
s_waitcnt vmcnt(4)
v_pk_add_f32 v[148:149], v[148:149], v[228:229]
v_pk_add_f32 v[150:151], v[150:151], v[230:231]
v_pk_add_f32 v[154:155], v[148:149], v[150:151]
v_add_f32 v154, v154, v152
v_cmp_u_f32 vcc, v154, v155
s_cbranch_vccz L_cok_121
buffer_load_dwordx4 v[216:219], v16, s[8:11], s40 offen sc1
buffer_load_dwordx4 v[220:223], v13, s[8:11], s40 offen sc1
buffer_load_dwordx4 v[224:227], v14, s[8:11], s40 offen sc1
buffer_load_dwordx4 v[228:231], v15, s[8:11], s40 offen sc1
s_waitcnt vmcnt(7)
v_permlane32_swap_b32 v200, v202
v_permlane32_swap_b32 v201, v203
s_waitcnt vmcnt(6)
v_pk_add_f32 v[154:155], v[200:201], v[202:203]
v_pk_add_f32 v[148:149], v[124:125], v[204:205]
v_pk_add_f32 v[150:151], v[126:127], v[206:207]
v_permlane16_swap_b32 v154, v155
s_waitcnt vmcnt(5)
v_pk_add_f32 v[148:149], v[148:149], v[208:209]
v_pk_add_f32 v[150:151], v[150:151], v[210:211]
v_add_f32 v152, v154, v155
s_waitcnt vmcnt(4)
v_pk_add_f32 v[148:149], v[148:149], v[212:213]
v_pk_add_f32 v[150:151], v[150:151], v[214:215]
v_pk_add_f32 v[154:155], v[148:149], v[150:151]
v_add_f32 v154, v154, v152
v_cmp_u_f32 vcc, v154, v155
s_cbranch_vccz L_cok_121
s_add_u32 s33, s33, 1
s_cmp_gt_u32 s33, 0x100000
s_cbranch_scc1 chain_kernel_abort
s_and_b32 s20, s33, 63
s_cbranch_scc1 L_rt_123
v_cmp_eq_u32 vcc, s34, v200
v_cmp_eq_u32 s[20:21], s34, v201
s_or_b64 vcc, vcc, s[20:21]
v_cmp_eq_u32 s[20:21], s34, v202
s_or_b64 vcc, vcc, s[20:21]
v_cmp_eq_u32 s[20:21], s34, v203
s_or_b64 vcc, vcc, s[20:21]
v_cmp_eq_u32 s[20:21], s34, v204
s_or_b64 vcc, vcc, s[20:21]
v_cmp_eq_u32 s[20:21], s34, v205
s_or_b64 vcc, vcc, s[20:21]
v_cmp_eq_u32 s[20:21], s34, v206
s_or_b64 vcc, vcc, s[20:21]
v_cmp_eq_u32 s[20:21], s34, v207
s_or_b64 vcc, vcc, s[20:21]
v_cmp_eq_u32 s[20:21], s34, v208
s_or_b64 vcc, vcc, s[20:21]
v_cmp_eq_u32 s[20:21], s34, v209
s_or_b64 vcc, vcc, s[20:21]
v_cmp_eq_u32 s[20:21], s34, v210
s_or_b64 vcc, vcc, s[20:21]
v_cmp_eq_u32 s[20:21], s34, v211
s_or_b64 vcc, vcc, s[20:21]
v_cmp_eq_u32 s[20:21], s34, v212
s_or_b64 vcc, vcc, s[20:21]
v_cmp_eq_u32 s[20:21], s34, v213
s_or_b64 vcc, vcc, s[20:21]
v_cmp_eq_u32 s[20:21], s34, v214
s_or_b64 vcc, vcc, s[20:21]
v_cmp_eq_u32 s[20:21], s34, v215
s_or_b64 vcc, vcc, s[20:21]
s_cbranch_vccnz L_rt_123
s_branch L_cok_121
L_cok_121:
v_max3_f32 v154, v148, v149, v150
v_max3_f32 v154, v154, v151, v152
s_nop 1
v_max_f32_dpp v154, v154, v154 row_ror:8 row_mask:0xf bank_mask:0xf
s_branch L_chead_124
L_q_e_132:
buffer_load_dwordx4 v[60:63], v5, s[8:11], s41 offen sc1
s_waitcnt vmcnt(0)
v_max3_u32 v7, v60, v61, v62
v_max_u32 v7, v7, v63
v_cmp_eq_u32 vcc, s34, v7
s_cbranch_vccnz L_q_e_134
s_branch L_v_e_133
L_q_e_134:
buffer_load_dwordx4 v[60:63], v5, s[8:11], s41 offen sc1
s_waitcnt vmcnt(2)
v_max3_u32 v7, v60, v61, v62
v_max_u32 v7, v7, v63
v_cmp_eq_u32 vcc, s34, v7
s_cbranch_vccz L_ok_e_135
s_add_u32 s33, s33, 1
s_cmp_gt_u32 s33, 0x100000
s_cbranch_scc0 L_q_e_134
s_branch chain_kernel_abort
L_ok_e_135:
v_smfmac_f32_16x16x64_bf16 v[88:91], v[60:63], a[216:223], v6
v_smfmac_f32_16x16x64_bf16 v[92:95], v[60:63], a[248:255], v6
s_branch L_gd_e_125
L_q_e_130:
buffer_load_dwordx4 v[56:59], v4, s[8:11], s41 offen sc1
s_waitcnt vmcnt(1)
v_max3_u32 v7, v60, v61, v62
v_max_u32 v7, v7, v63
v_cmp_eq_u32 vcc, s34, v7
s_cbranch_vccnz L_q_e_136
L_v_e_137:
v_smfmac_f32_16x16x64_bf16 v[88:91], v[60:63], a[216:223], v6
s_waitcnt vmcnt(0)
v_max3_u32 v7, v56, v57, v58
v_max_u32 v7, v7, v59
v_cmp_eq_u32 vcc, s34, v7
v_smfmac_f32_16x16x64_bf16 v[92:95], v[60:63], a[248:255], v6
s_cbranch_vccnz L_q_e_138
L_v_e_139:
v_smfmac_f32_16x16x64_bf16 v[88:91], v[56:59], a[208:215], v6
v_smfmac_f32_16x16x64_bf16 v[92:95], v[56:59], a[240:247], v6
s_branch L_gd_e_125
L_q_e_138:
buffer_load_dwordx4 v[56:59], v4, s[8:11], s41 offen sc1
s_waitcnt vmcnt(2)
v_max3_u32 v7, v56, v57, v58
v_max_u32 v7, v7, v59
v_cmp_eq_u32 vcc, s34, v7
s_cbranch_vccz L_ok_e_140
s_add_u32 s33, s33, 1
s_cmp_gt_u32 s33, 0x100000
s_cbranch_scc0 L_q_e_138
s_branch chain_kernel_abort
L_ok_e_140:
v_smfmac_f32_16x16x64_bf16 v[88:91], v[56:59], a[208:215], v6
v_smfmac_f32_16x16x64_bf16 v[92:95], v[56:59], a[240:247], v6
s_branch L_gd_e_125
L_q_e_136:
buffer_load_dwordx4 v[60:63], v5, s[8:11], s41 offen sc1
s_waitcnt vmcnt(1)
v_max3_u32 v7, v56, v57, v58
v_max_u32 v7, v7, v59
v_cmp_eq_u32 vcc, s34, v7
s_cbranch_vccnz L_q_e_141
L_v_e_142:
v_smfmac_f32_16x16x64_bf16 v[88:91], v[56:59], a[208:215], v6
s_waitcnt vmcnt(0)
v_max3_u32 v7, v60, v61, v62
v_max_u32 v7, v7, v63
v_cmp_eq_u32 vcc, s34, v7
v_smfmac_f32_16x16x64_bf16 v[92:95], v[56:59], a[240:247], v6
s_cbranch_vccnz L_q_e_134
s_branch L_v_e_133
L_q_e_141:
buffer_load_dwordx4 v[56:59], v4, s[8:11], s41 offen sc1
s_waitcnt vmcnt(2)
v_max3_u32 v7, v60, v61, v62
v_max_u32 v7, v7, v63
v_cmp_eq_u32 vcc, s34, v7
s_cbranch_vccz L_ok_e_143
buffer_load_dwordx4 v[60:63], v5, s[8:11], s41 offen sc1
s_waitcnt vmcnt(2)
v_max3_u32 v7, v56, v57, v58
v_max_u32 v7, v7, v59
v_cmp_eq_u32 vcc, s34, v7
s_cbranch_vccz L_ok_e_144
s_add_u32 s33, s33, 1
s_cmp_gt_u32 s33, 0x100000
s_cbranch_scc0 L_q_e_141
s_branch chain_kernel_abort
L_ok_e_143:
v_smfmac_f32_16x16x64_bf16 v[88:91], v[60:63], a[216:223], v6
v_smfmac_f32_16x16x64_bf16 v[92:95], v[60:63], a[248:255], v6
s_branch L_q_e_138
L_ok_e_144:
v_smfmac_f32_16x16x64_bf16 v[88:91], v[56:59], a[208:215], v6
v_smfmac_f32_16x16x64_bf16 v[92:95], v[56:59], a[240:247], v6
s_branch L_q_e_134
L_q_e_128:
buffer_load_dwordx4 v[52:55], v3, s[8:11], s41 offen sc1
s_waitcnt vmcnt(2)
v_max3_u32 v7, v56, v57, v58
v_max_u32 v7, v7, v59
v_cmp_eq_u32 vcc, s34, v7
s_cbranch_vccnz L_q_e_145
L_v_e_146:
v_smfmac_f32_16x16x64_bf16 v[88:91], v[56:59], a[208:215], v6
s_waitcnt vmcnt(1)
v_max3_u32 v7, v60, v61, v62
v_max_u32 v7, v7, v63
v_cmp_eq_u32 vcc, s34, v7
v_smfmac_f32_16x16x64_bf16 v[92:95], v[56:59], a[240:247], v6
s_cbranch_vccnz L_q_e_147
L_v_e_148:
v_smfmac_f32_16x16x64_bf16 v[88:91], v[60:63], a[216:223], v6
s_waitcnt vmcnt(0)
v_max3_u32 v7, v52, v53, v54
v_max_u32 v7, v7, v55
v_cmp_eq_u32 vcc, s34, v7
v_smfmac_f32_16x16x64_bf16 v[92:95], v[60:63], a[248:255], v6
s_cbranch_vccnz L_q_e_149
L_v_e_150:
v_smfmac_f32_16x16x64_bf16 v[88:91], v[52:55], a[200:207], v6
v_smfmac_f32_16x16x64_bf16 v[92:95], v[52:55], a[232:239], v6
s_branch L_gd_e_125
L_q_e_149:
buffer_load_dwordx4 v[52:55], v3, s[8:11], s41 offen sc1
s_waitcnt vmcnt(2)
v_max3_u32 v7, v52, v53, v54
v_max_u32 v7, v7, v55
v_cmp_eq_u32 vcc, s34, v7
s_cbranch_vccz L_ok_e_151
s_add_u32 s33, s33, 1
s_cmp_gt_u32 s33, 0x100000
s_cbranch_scc0 L_q_e_149
s_branch chain_kernel_abort
L_ok_e_151:
v_smfmac_f32_16x16x64_bf16 v[88:91], v[52:55], a[200:207], v6
v_smfmac_f32_16x16x64_bf16 v[92:95], v[52:55], a[232:239], v6
s_branch L_gd_e_125
L_q_e_147:
buffer_load_dwordx4 v[60:63], v5, s[8:11], s41 offen sc1
s_waitcnt vmcnt(1)
v_max3_u32 v7, v52, v53, v54
v_max_u32 v7, v7, v55
v_cmp_eq_u32 vcc, s34, v7
s_cbranch_vccnz L_q_e_152
L_v_e_153:
v_smfmac_f32_16x16x64_bf16 v[88:91], v[52:55], a[200:207], v6
s_waitcnt vmcnt(0)
v_max3_u32 v7, v60, v61, v62
v_max_u32 v7, v7, v63
v_cmp_eq_u32 vcc, s34, v7
v_smfmac_f32_16x16x64_bf16 v[92:95], v[52:55], a[232:239], v6
s_cbranch_vccnz L_q_e_134
s_branch L_v_e_133
L_q_e_152:
buffer_load_dwordx4 v[52:55], v3, s[8:11], s41 offen sc1
s_waitcnt vmcnt(2)
v_max3_u32 v7, v60, v61, v62
v_max_u32 v7, v7, v63
v_cmp_eq_u32 vcc, s34, v7
s_cbranch_vccz L_ok_e_154
buffer_load_dwordx4 v[60:63], v5, s[8:11], s41 offen sc1
s_waitcnt vmcnt(2)
v_max3_u32 v7, v52, v53, v54
v_max_u32 v7, v7, v55
v_cmp_eq_u32 vcc, s34, v7
s_cbranch_vccz L_ok_e_155
s_add_u32 s33, s33, 1
s_cmp_gt_u32 s33, 0x100000
s_cbranch_scc0 L_q_e_152
s_branch chain_kernel_abort
L_ok_e_154:
v_smfmac_f32_16x16x64_bf16 v[88:91], v[60:63], a[216:223], v6
v_smfmac_f32_16x16x64_bf16 v[92:95], v[60:63], a[248:255], v6
s_branch L_q_e_149
L_ok_e_155:
v_smfmac_f32_16x16x64_bf16 v[88:91], v[52:55], a[200:207], v6
v_smfmac_f32_16x16x64_bf16 v[92:95], v[52:55], a[232:239], v6
s_branch L_q_e_134
L_q_e_145:
buffer_load_dwordx4 v[56:59], v4, s[8:11], s41 offen sc1
s_waitcnt vmcnt(2)
v_max3_u32 v7, v60, v61, v62
v_max_u32 v7, v7, v63
v_cmp_eq_u32 vcc, s34, v7
s_cbranch_vccnz L_q_e_156
L_v_e_157:
v_smfmac_f32_16x16x64_bf16 v[88:91], v[60:63], a[216:223], v6
s_waitcnt vmcnt(1)
v_max3_u32 v7, v52, v53, v54
v_max_u32 v7, v7, v55
v_cmp_eq_u32 vcc, s34, v7
v_smfmac_f32_16x16x64_bf16 v[92:95], v[60:63], a[248:255], v6
s_cbranch_vccnz L_q_e_158
L_v_e_159:
v_smfmac_f32_16x16x64_bf16 v[88:91], v[52:55], a[200:207], v6
s_waitcnt vmcnt(0)
v_max3_u32 v7, v56, v57, v58
v_max_u32 v7, v7, v59
v_cmp_eq_u32 vcc, s34, v7
v_smfmac_f32_16x16x64_bf16 v[92:95], v[52:55], a[232:239], v6
s_cbranch_vccnz L_q_e_138
s_branch L_v_e_139
L_q_e_158:
buffer_load_dwordx4 v[52:55], v3, s[8:11], s41 offen sc1
s_waitcnt vmcnt(2)
v_max3_u32 v7, v56, v57, v58
v_max_u32 v7, v7, v59
v_cmp_eq_u32 vcc, s34, v7
s_cbranch_vccz L_ok_e_160
buffer_load_dwordx4 v[56:59], v4, s[8:11], s41 offen sc1
s_waitcnt vmcnt(2)
v_max3_u32 v7, v52, v53, v54
v_max_u32 v7, v7, v55
v_cmp_eq_u32 vcc, s34, v7
s_cbranch_vccz L_ok_e_161
s_add_u32 s33, s33, 1
s_cmp_gt_u32 s33, 0x100000
s_cbranch_scc0 L_q_e_158
s_branch chain_kernel_abort
L_ok_e_160:
v_smfmac_f32_16x16x64_bf16 v[88:91], v[56:59], a[208:215], v6
v_smfmac_f32_16x16x64_bf16 v[92:95], v[56:59], a[240:247], v6
s_branch L_q_e_149
L_ok_e_161:
v_smfmac_f32_16x16x64_bf16 v[88:91], v[52:55], a[200:207], v6
v_smfmac_f32_16x16x64_bf16 v[92:95], v[52:55], a[232:239], v6
s_branch L_q_e_138
L_q_e_156:
buffer_load_dwordx4 v[60:63], v5, s[8:11], s41 offen sc1
s_waitcnt vmcnt(2)
v_max3_u32 v7, v52, v53, v54
v_max_u32 v7, v7, v55
v_cmp_eq_u32 vcc, s34, v7
s_cbranch_vccnz L_q_e_162
L_v_e_163:
v_smfmac_f32_16x16x64_bf16 v[88:91], v[52:55], a[200:207], v6
s_waitcnt vmcnt(1)
v_max3_u32 v7, v56, v57, v58
v_max_u32 v7, v7, v59
v_cmp_eq_u32 vcc, s34, v7
v_smfmac_f32_16x16x64_bf16 v[92:95], v[52:55], a[232:239], v6
s_cbranch_vccnz L_q_e_141
s_branch L_v_e_142
L_q_e_162:
buffer_load_dwordx4 v[52:55], v3, s[8:11], s41 offen sc1
s_waitcnt vmcnt(2)
v_max3_u32 v7, v56, v57, v58
v_max_u32 v7, v7, v59
v_cmp_eq_u32 vcc, s34, v7
s_cbranch_vccz L_ok_e_164
buffer_load_dwordx4 v[56:59], v4, s[8:11], s41 offen sc1
s_waitcnt vmcnt(2)
v_max3_u32 v7, v60, v61, v62
v_max_u32 v7, v7, v63
v_cmp_eq_u32 vcc, s34, v7
s_cbranch_vccz L_ok_e_165
buffer_load_dwordx4 v[60:63], v5, s[8:11], s41 offen sc1
s_waitcnt vmcnt(2)
v_max3_u32 v7, v52, v53, v54
v_max_u32 v7, v7, v55
v_cmp_eq_u32 vcc, s34, v7
s_cbranch_vccz L_ok_e_166
s_add_u32 s33, s33, 1
s_cmp_gt_u32 s33, 0x100000
s_cbranch_scc0 L_q_e_162
s_branch chain_kernel_abort
L_ok_e_164:
v_smfmac_f32_16x16x64_bf16 v[88:91], v[56:59], a[208:215], v6
v_smfmac_f32_16x16x64_bf16 v[92:95], v[56:59], a[240:247], v6
s_branch L_q_e_152
L_ok_e_165:
v_smfmac_f32_16x16x64_bf16 v[88:91], v[60:63], a[216:223], v6
v_smfmac_f32_16x16x64_bf16 v[92:95], v[60:63], a[248:255], v6
s_branch L_q_e_158
L_ok_e_166:
v_smfmac_f32_16x16x64_bf16 v[88:91], v[52:55], a[200:207], v6
v_smfmac_f32_16x16x64_bf16 v[92:95], v[52:55], a[232:239], v6
s_branch L_q_e_141
L_q_e_126:
buffer_load_dwordx4 v[48:51], v2, s[8:11], s41 offen sc1
s_waitcnt vmcnt(3)
v_max3_u32 v7, v52, v53, v54
v_max_u32 v7, v7, v55
v_cmp_eq_u32 vcc, s34, v7
s_cbranch_vccnz L_q_e_167
L_v_e_168:
v_smfmac_f32_16x16x64_bf16 v[88:91], v[52:55], a[200:207], v6
s_waitcnt vmcnt(2)
v_max3_u32 v7, v56, v57, v58
v_max_u32 v7, v7, v59
v_cmp_eq_u32 vcc, s34, v7
v_smfmac_f32_16x16x64_bf16 v[92:95], v[52:55], a[232:239], v6
s_cbranch_vccnz L_q_e_169
L_v_e_170:
v_smfmac_f32_16x16x64_bf16 v[88:91], v[56:59], a[208:215], v6
s_waitcnt vmcnt(1)
v_max3_u32 v7, v60, v61, v62
v_max_u32 v7, v7, v63
v_cmp_eq_u32 vcc, s34, v7
v_smfmac_f32_16x16x64_bf16 v[92:95], v[56:59], a[240:247], v6
s_cbranch_vccnz L_q_e_171
L_v_e_172:
v_smfmac_f32_16x16x64_bf16 v[88:91], v[60:63], a[216:223], v6
s_waitcnt vmcnt(0)
v_max3_u32 v7, v48, v49, v50
v_max_u32 v7, v7, v51
v_cmp_eq_u32 vcc, s34, v7
v_smfmac_f32_16x16x64_bf16 v[92:95], v[60:63], a[248:255], v6
s_cbranch_vccnz L_q_e_173
L_v_e_174:
v_smfmac_f32_16x16x64_bf16 v[88:91], v[48:51], a[192:199], v6
v_smfmac_f32_16x16x64_bf16 v[92:95], v[48:51], a[224:231], v6
s_branch L_gd_e_125
L_q_e_173:
buffer_load_dwordx4 v[48:51], v2, s[8:11], s41 offen sc1
s_waitcnt vmcnt(2)
v_max3_u32 v7, v48, v49, v50
v_max_u32 v7, v7, v51
v_cmp_eq_u32 vcc, s34, v7
s_cbranch_vccz L_ok_e_175
s_add_u32 s33, s33, 1
s_cmp_gt_u32 s33, 0x100000
s_cbranch_scc0 L_q_e_173
s_branch chain_kernel_abort
L_ok_e_175:
v_smfmac_f32_16x16x64_bf16 v[88:91], v[48:51], a[192:199], v6
v_smfmac_f32_16x16x64_bf16 v[92:95], v[48:51], a[224:231], v6
s_branch L_gd_e_125
L_q_e_171:
buffer_load_dwordx4 v[60:63], v5, s[8:11], s41 offen sc1
s_waitcnt vmcnt(1)
v_max3_u32 v7, v48, v49, v50
v_max_u32 v7, v7, v51
v_cmp_eq_u32 vcc, s34, v7
s_cbranch_vccnz L_q_e_176
L_v_e_177:
v_smfmac_f32_16x16x64_bf16 v[88:91], v[48:51], a[192:199], v6
s_waitcnt vmcnt(0)
v_max3_u32 v7, v60, v61, v62
v_max_u32 v7, v7, v63
v_cmp_eq_u32 vcc, s34, v7
v_smfmac_f32_16x16x64_bf16 v[92:95], v[48:51], a[224:231], v6
s_cbranch_vccnz L_q_e_134
s_branch L_v_e_133
L_q_e_176:
buffer_load_dwordx4 v[48:51], v2, s[8:11], s41 offen sc1
s_waitcnt vmcnt(2)
v_max3_u32 v7, v60, v61, v62
v_max_u32 v7, v7, v63
v_cmp_eq_u32 vcc, s34, v7
s_cbranch_vccz L_ok_e_178
buffer_load_dwordx4 v[60:63], v5, s[8:11], s41 offen sc1
s_waitcnt vmcnt(2)
v_max3_u32 v7, v48, v49, v50
v_max_u32 v7, v7, v51
v_cmp_eq_u32 vcc, s34, v7
s_cbranch_vccz L_ok_e_179
s_add_u32 s33, s33, 1
s_cmp_gt_u32 s33, 0x100000
s_cbranch_scc0 L_q_e_176
s_branch chain_kernel_abort
L_ok_e_178:
v_smfmac_f32_16x16x64_bf16 v[88:91], v[60:63], a[216:223], v6
v_smfmac_f32_16x16x64_bf16 v[92:95], v[60:63], a[248:255], v6
s_branch L_q_e_173
L_ok_e_179:
v_smfmac_f32_16x16x64_bf16 v[88:91], v[48:51], a[192:199], v6
v_smfmac_f32_16x16x64_bf16 v[92:95], v[48:51], a[224:231], v6
s_branch L_q_e_134
L_q_e_169:
buffer_load_dwordx4 v[56:59], v4, s[8:11], s41 offen sc1
s_waitcnt vmcnt(2)
v_max3_u32 v7, v60, v61, v62
v_max_u32 v7, v7, v63
v_cmp_eq_u32 vcc, s34, v7
s_cbranch_vccnz L_q_e_180
L_v_e_181:
v_smfmac_f32_16x16x64_bf16 v[88:91], v[60:63], a[216:223], v6
s_waitcnt vmcnt(1)
v_max3_u32 v7, v48, v49, v50
v_max_u32 v7, v7, v51
v_cmp_eq_u32 vcc, s34, v7
v_smfmac_f32_16x16x64_bf16 v[92:95], v[60:63], a[248:255], v6
s_cbranch_vccnz L_q_e_182
L_v_e_183:
v_smfmac_f32_16x16x64_bf16 v[88:91], v[48:51], a[192:199], v6
s_waitcnt vmcnt(0)
v_max3_u32 v7, v56, v57, v58
v_max_u32 v7, v7, v59
v_cmp_eq_u32 vcc, s34, v7
v_smfmac_f32_16x16x64_bf16 v[92:95], v[48:51], a[224:231], v6
s_cbranch_vccnz L_q_e_138
s_branch L_v_e_139
L_q_e_182:
buffer_load_dwordx4 v[48:51], v2, s[8:11], s41 offen sc1
s_waitcnt vmcnt(2)
v_max3_u32 v7, v56, v57, v58
v_max_u32 v7, v7, v59
v_cmp_eq_u32 vcc, s34, v7
s_cbranch_vccz L_ok_e_184
buffer_load_dwordx4 v[56:59], v4, s[8:11], s41 offen sc1
s_waitcnt vmcnt(2)
v_max3_u32 v7, v48, v49, v50
v_max_u32 v7, v7, v51
v_cmp_eq_u32 vcc, s34, v7
s_cbranch_vccz L_ok_e_185
s_add_u32 s33, s33, 1
s_cmp_gt_u32 s33, 0x100000
s_cbranch_scc0 L_q_e_182
s_branch chain_kernel_abort
L_ok_e_184:
v_smfmac_f32_16x16x64_bf16 v[88:91], v[56:59], a[208:215], v6
v_smfmac_f32_16x16x64_bf16 v[92:95], v[56:59], a[240:247], v6
s_branch L_q_e_173
L_ok_e_185:
v_smfmac_f32_16x16x64_bf16 v[88:91], v[48:51], a[192:199], v6
v_smfmac_f32_16x16x64_bf16 v[92:95], v[48:51], a[224:231], v6
s_branch L_q_e_138
L_q_e_180:
buffer_load_dwordx4 v[60:63], v5, s[8:11], s41 offen sc1
s_waitcnt vmcnt(2)
v_max3_u32 v7, v48, v49, v50
v_max_u32 v7, v7, v51
v_cmp_eq_u32 vcc, s34, v7
s_cbranch_vccnz L_q_e_186
L_v_e_187:
v_smfmac_f32_16x16x64_bf16 v[88:91], v[48:51], a[192:199], v6
s_waitcnt vmcnt(1)
v_max3_u32 v7, v56, v57, v58
v_max_u32 v7, v7, v59
v_cmp_eq_u32 vcc, s34, v7
v_smfmac_f32_16x16x64_bf16 v[92:95], v[48:51], a[224:231], v6
s_cbranch_vccnz L_q_e_141
s_branch L_v_e_142
L_q_e_186:
buffer_load_dwordx4 v[48:51], v2, s[8:11], s41 offen sc1
s_waitcnt vmcnt(2)
v_max3_u32 v7, v56, v57, v58
v_max_u32 v7, v7, v59
v_cmp_eq_u32 vcc, s34, v7
s_cbranch_vccz L_ok_e_188
buffer_load_dwordx4 v[56:59], v4, s[8:11], s41 offen sc1
s_waitcnt vmcnt(2)
v_max3_u32 v7, v60, v61, v62
v_max_u32 v7, v7, v63
v_cmp_eq_u32 vcc, s34, v7
s_cbranch_vccz L_ok_e_189
buffer_load_dwordx4 v[60:63], v5, s[8:11], s41 offen sc1
s_waitcnt vmcnt(2)
v_max3_u32 v7, v48, v49, v50
v_max_u32 v7, v7, v51
v_cmp_eq_u32 vcc, s34, v7
s_cbranch_vccz L_ok_e_190
s_add_u32 s33, s33, 1
s_cmp_gt_u32 s33, 0x100000
s_cbranch_scc0 L_q_e_186
s_branch chain_kernel_abort
L_ok_e_188:
v_smfmac_f32_16x16x64_bf16 v[88:91], v[56:59], a[208:215], v6
v_smfmac_f32_16x16x64_bf16 v[92:95], v[56:59], a[240:247], v6
s_branch L_q_e_176
L_ok_e_189:
v_smfmac_f32_16x16x64_bf16 v[88:91], v[60:63], a[216:223], v6
v_smfmac_f32_16x16x64_bf16 v[92:95], v[60:63], a[248:255], v6
s_branch L_q_e_182
L_ok_e_190:
v_smfmac_f32_16x16x64_bf16 v[88:91], v[48:51], a[192:199], v6
v_smfmac_f32_16x16x64_bf16 v[92:95], v[48:51], a[224:231], v6
s_branch L_q_e_141
L_q_e_167:
buffer_load_dwordx4 v[52:55], v3, s[8:11], s41 offen sc1
s_waitcnt vmcnt(3)
v_max3_u32 v7, v56, v57, v58
v_max_u32 v7, v7, v59
v_cmp_eq_u32 vcc, s34, v7
s_cbranch_vccnz L_q_e_191
L_v_e_192:
v_smfmac_f32_16x16x64_bf16 v[88:91], v[56:59], a[208:215], v6
s_waitcnt vmcnt(2)
v_max3_u32 v7, v60, v61, v62
v_max_u32 v7, v7, v63
v_cmp_eq_u32 vcc, s34, v7
v_smfmac_f32_16x16x64_bf16 v[92:95], v[56:59], a[240:247], v6
s_cbranch_vccnz L_q_e_193
L_v_e_194:
v_smfmac_f32_16x16x64_bf16 v[88:91], v[60:63], a[216:223], v6
s_waitcnt vmcnt(1)
v_max3_u32 v7, v48, v49, v50
v_max_u32 v7, v7, v51
v_cmp_eq_u32 vcc, s34, v7
v_smfmac_f32_16x16x64_bf16 v[92:95], v[60:63], a[248:255], v6
s_cbranch_vccnz L_q_e_195
L_v_e_196:
v_smfmac_f32_16x16x64_bf16 v[88:91], v[48:51], a[192:199], v6
s_waitcnt vmcnt(0)
v_max3_u32 v7, v52, v53, v54
v_max_u32 v7, v7, v55
v_cmp_eq_u32 vcc, s34, v7
v_smfmac_f32_16x16x64_bf16 v[92:95], v[48:51], a[224:231], v6
s_cbranch_vccnz L_q_e_149
s_branch L_v_e_150
L_q_e_195:
buffer_load_dwordx4 v[48:51], v2, s[8:11], s41 offen sc1
s_waitcnt vmcnt(2)
v_max3_u32 v7, v52, v53, v54
v_max_u32 v7, v7, v55
v_cmp_eq_u32 vcc, s34, v7
s_cbranch_vccz L_ok_e_197
buffer_load_dwordx4 v[52:55], v3, s[8:11], s41 offen sc1
s_waitcnt vmcnt(2)
v_max3_u32 v7, v48, v49, v50
v_max_u32 v7, v7, v51
v_cmp_eq_u32 vcc, s34, v7
s_cbranch_vccz L_ok_e_198
s_add_u32 s33, s33, 1
s_cmp_gt_u32 s33, 0x100000
s_cbranch_scc0 L_q_e_195
s_branch chain_kernel_abort
L_ok_e_197:
v_smfmac_f32_16x16x64_bf16 v[88:91], v[52:55], a[200:207], v6
v_smfmac_f32_16x16x64_bf16 v[92:95], v[52:55], a[232:239], v6
s_branch L_q_e_173
L_ok_e_198:
v_smfmac_f32_16x16x64_bf16 v[88:91], v[48:51], a[192:199], v6
v_smfmac_f32_16x16x64_bf16 v[92:95], v[48:51], a[224:231], v6
s_branch L_q_e_149
L_q_e_193:
buffer_load_dwordx4 v[60:63], v5, s[8:11], s41 offen sc1
s_waitcnt vmcnt(2)
v_max3_u32 v7, v48, v49, v50
v_max_u32 v7, v7, v51
v_cmp_eq_u32 vcc, s34, v7
s_cbranch_vccnz L_q_e_199
L_v_e_200:
v_smfmac_f32_16x16x64_bf16 v[88:91], v[48:51], a[192:199], v6
s_waitcnt vmcnt(1)
v_max3_u32 v7, v52, v53, v54
v_max_u32 v7, v7, v55
v_cmp_eq_u32 vcc, s34, v7
v_smfmac_f32_16x16x64_bf16 v[92:95], v[48:51], a[224:231], v6
s_cbranch_vccnz L_q_e_152
s_branch L_v_e_153
L_q_e_199:
buffer_load_dwordx4 v[48:51], v2, s[8:11], s41 offen sc1
s_waitcnt vmcnt(2)
v_max3_u32 v7, v52, v53, v54
v_max_u32 v7, v7, v55
v_cmp_eq_u32 vcc, s34, v7
s_cbranch_vccz L_ok_e_201
buffer_load_dwordx4 v[52:55], v3, s[8:11], s41 offen sc1
s_waitcnt vmcnt(2)
v_max3_u32 v7, v60, v61, v62
v_max_u32 v7, v7, v63
v_cmp_eq_u32 vcc, s34, v7
s_cbranch_vccz L_ok_e_202
buffer_load_dwordx4 v[60:63], v5, s[8:11], s41 offen sc1
s_waitcnt vmcnt(2)
v_max3_u32 v7, v48, v49, v50
v_max_u32 v7, v7, v51
v_cmp_eq_u32 vcc, s34, v7
s_cbranch_vccz L_ok_e_203
s_add_u32 s33, s33, 1
s_cmp_gt_u32 s33, 0x100000
s_cbranch_scc0 L_q_e_199
s_branch chain_kernel_abort
L_ok_e_201:
v_smfmac_f32_16x16x64_bf16 v[88:91], v[52:55], a[200:207], v6
v_smfmac_f32_16x16x64_bf16 v[92:95], v[52:55], a[232:239], v6
s_branch L_q_e_176
L_ok_e_202:
v_smfmac_f32_16x16x64_bf16 v[88:91], v[60:63], a[216:223], v6
v_smfmac_f32_16x16x64_bf16 v[92:95], v[60:63], a[248:255], v6
s_branch L_q_e_195
L_ok_e_203:
v_smfmac_f32_16x16x64_bf16 v[88:91], v[48:51], a[192:199], v6
v_smfmac_f32_16x16x64_bf16 v[92:95], v[48:51], a[224:231], v6
s_branch L_q_e_152
L_q_e_191:
buffer_load_dwordx4 v[56:59], v4, s[8:11], s41 offen sc1
s_waitcnt vmcnt(3)
v_max3_u32 v7, v60, v61, v62
v_max_u32 v7, v7, v63
v_cmp_eq_u32 vcc, s34, v7
s_cbranch_vccnz L_q_e_204
L_v_e_205:
v_smfmac_f32_16x16x64_bf16 v[88:91], v[60:63], a[216:223], v6
s_waitcnt vmcnt(2)
v_max3_u32 v7, v48, v49, v50
v_max_u32 v7, v7, v51
v_cmp_eq_u32 vcc, s34, v7
v_smfmac_f32_16x16x64_bf16 v[92:95], v[60:63], a[248:255], v6
s_cbranch_vccnz L_q_e_206
L_v_e_207:
v_smfmac_f32_16x16x64_bf16 v[88:91], v[48:51], a[192:199], v6
s_waitcnt vmcnt(1)
v_max3_u32 v7, v52, v53, v54
v_max_u32 v7, v7, v55
v_cmp_eq_u32 vcc, s34, v7
v_smfmac_f32_16x16x64_bf16 v[92:95], v[48:51], a[224:231], v6
s_cbranch_vccnz L_q_e_158
s_branch L_v_e_159
L_q_e_206:
buffer_load_dwordx4 v[48:51], v2, s[8:11], s41 offen sc1
s_waitcnt vmcnt(2)
v_max3_u32 v7, v52, v53, v54
v_max_u32 v7, v7, v55
v_cmp_eq_u32 vcc, s34, v7
s_cbranch_vccz L_ok_e_208
buffer_load_dwordx4 v[52:55], v3, s[8:11], s41 offen sc1
s_waitcnt vmcnt(2)
v_max3_u32 v7, v56, v57, v58
v_max_u32 v7, v7, v59
v_cmp_eq_u32 vcc, s34, v7
s_cbranch_vccz L_ok_e_209
buffer_load_dwordx4 v[56:59], v4, s[8:11], s41 offen sc1
s_waitcnt vmcnt(2)
v_max3_u32 v7, v48, v49, v50
v_max_u32 v7, v7, v51
v_cmp_eq_u32 vcc, s34, v7
s_cbranch_vccz L_ok_e_210
s_add_u32 s33, s33, 1
s_cmp_gt_u32 s33, 0x100000
s_cbranch_scc0 L_q_e_206
s_branch chain_kernel_abort
L_ok_e_208:
v_smfmac_f32_16x16x64_bf16 v[88:91], v[52:55], a[200:207], v6
v_smfmac_f32_16x16x64_bf16 v[92:95], v[52:55], a[232:239], v6
s_branch L_q_e_182
L_ok_e_209:
v_smfmac_f32_16x16x64_bf16 v[88:91], v[56:59], a[208:215], v6
v_smfmac_f32_16x16x64_bf16 v[92:95], v[56:59], a[240:247], v6
s_branch L_q_e_195
L_ok_e_210:
v_smfmac_f32_16x16x64_bf16 v[88:91], v[48:51], a[192:199], v6
v_smfmac_f32_16x16x64_bf16 v[92:95], v[48:51], a[224:231], v6
s_branch L_q_e_158
L_q_e_204:
buffer_load_dwordx4 v[60:63], v5, s[8:11], s41 offen sc1
s_waitcnt vmcnt(3)
v_max3_u32 v7, v48, v49, v50
v_max_u32 v7, v7, v51
v_cmp_eq_u32 vcc, s34, v7
s_cbranch_vccnz L_q_e_211
L_v_e_212:
v_smfmac_f32_16x16x64_bf16 v[88:91], v[48:51], a[192:199], v6
s_waitcnt vmcnt(2)
v_max3_u32 v7, v52, v53, v54
v_max_u32 v7, v7, v55
v_cmp_eq_u32 vcc, s34, v7
v_smfmac_f32_16x16x64_bf16 v[92:95], v[48:51], a[224:231], v6
s_cbranch_vccnz L_q_e_162
s_branch L_v_e_163
L_q_e_211:
buffer_load_dwordx4 v[48:51], v2, s[8:11], s41 offen sc1
s_waitcnt vmcnt(2)
v_max3_u32 v7, v52, v53, v54
v_max_u32 v7, v7, v55
v_cmp_eq_u32 vcc, s34, v7
s_cbranch_vccz L_ok_e_213
buffer_load_dwordx4 v[52:55], v3, s[8:11], s41 offen sc1
s_waitcnt vmcnt(2)
v_max3_u32 v7, v56, v57, v58
v_max_u32 v7, v7, v59
v_cmp_eq_u32 vcc, s34, v7
s_cbranch_vccz L_ok_e_214
buffer_load_dwordx4 v[56:59], v4, s[8:11], s41 offen sc1
s_waitcnt vmcnt(2)
v_max3_u32 v7, v60, v61, v62
v_max_u32 v7, v7, v63
v_cmp_eq_u32 vcc, s34, v7
s_cbranch_vccz L_ok_e_215
buffer_load_dwordx4 v[60:63], v5, s[8:11], s41 offen sc1
s_waitcnt vmcnt(2)
v_max3_u32 v7, v48, v49, v50
v_max_u32 v7, v7, v51
v_cmp_eq_u32 vcc, s34, v7
s_cbranch_vccz L_ok_e_216
s_add_u32 s33, s33, 1
s_cmp_gt_u32 s33, 0x100000
s_cbranch_scc0 L_q_e_211
s_branch chain_kernel_abort
L_ok_e_213:
v_smfmac_f32_16x16x64_bf16 v[88:91], v[52:55], a[200:207], v6
v_smfmac_f32_16x16x64_bf16 v[92:95], v[52:55], a[232:239], v6
s_branch L_q_e_186
L_ok_e_214:
v_smfmac_f32_16x16x64_bf16 v[88:91], v[56:59], a[208:215], v6
v_smfmac_f32_16x16x64_bf16 v[92:95], v[56:59], a[240:247], v6
s_branch L_q_e_199
L_ok_e_215:
v_smfmac_f32_16x16x64_bf16 v[88:91], v[60:63], a[216:223], v6
v_smfmac_f32_16x16x64_bf16 v[92:95], v[60:63], a[248:255], v6
s_branch L_q_e_206
L_ok_e_216:
v_smfmac_f32_16x16x64_bf16 v[88:91], v[48:51], a[192:199], v6
v_smfmac_f32_16x16x64_bf16 v[92:95], v[48:51], a[224:231], v6
s_branch L_q_e_162
L_gf_217:
s_waitcnt vmcnt(4)
v_lshlrev_b32 v100, 16, v212
v_and_b32 v101, 0xffff0000, v212
v_lshlrev_b32 v102, 16, v213
v_and_b32 v103, 0xffff0000, v213
v_pk_add_f32 v[148:149], v[168:169], v[100:101]
v_pk_add_f32 v[150:151], v[170:171], v[102:103]
s_waitcnt vmcnt(3)
v_lshlrev_b32 v100, 16, v214
v_and_b32 v101, 0xffff0000, v214
v_lshlrev_b32 v102, 16, v215
v_and_b32 v103, 0xffff0000, v215
v_pk_add_f32 v[148:149], v[148:149], v[100:101]
v_pk_add_f32 v[150:151], v[150:151], v[102:103]
s_waitcnt vmcnt(2)
v_lshlrev_b32 v100, 16, v216
v_and_b32 v101, 0xffff0000, v216
v_lshlrev_b32 v102, 16, v217
v_and_b32 v103, 0xffff0000, v217
v_pk_add_f32 v[148:149], v[148:149], v[100:101]
v_pk_add_f32 v[150:151], v[150:151], v[102:103]
v_cmp_u_f32 vcc, v148, v150
v_cvt_pk_bf16_f32 v180, v148, v149
v_cvt_pk_bf16_f32 v181, v150, v151
s_cbranch_vccz L_gok_218
buffer_load_dwordx2 v[212:213], v17, s[8:11], s22 offen offset:512 sc1
buffer_load_dwordx2 v[214:215], v18, s[8:11], s22 offen offset:512 sc1
buffer_load_dwordx2 v[216:217], v19, s[8:11], s22 offen offset:512 sc1
s_nop 11
L_rt_220:
buffer_load_dwordx2 v[200:201], v17, s[8:11], s22 offen offset:0 sc1
buffer_load_dwordx2 v[202:203], v18, s[8:11], s22 offen offset:0 sc1
buffer_load_dwordx2 v[204:205], v19, s[8:11], s22 offen offset:0 sc1
s_waitcnt vmcnt(5)
v_lshlrev_b32 v100, 16, v212
v_and_b32 v101, 0xffff0000, v212
v_lshlrev_b32 v102, 16, v213
v_and_b32 v103, 0xffff0000, v213
v_pk_add_f32 v[148:149], v[168:169], v[100:101]
v_pk_add_f32 v[150:151], v[170:171], v[102:103]
s_waitcnt vmcnt(4)
v_lshlrev_b32 v100, 16, v214
v_and_b32 v101, 0xffff0000, v214
v_lshlrev_b32 v102, 16, v215
v_and_b32 v103, 0xffff0000, v215
v_pk_add_f32 v[148:149], v[148:149], v[100:101]
v_pk_add_f32 v[150:151], v[150:151], v[102:103]
s_waitcnt vmcnt(3)
v_lshlrev_b32 v100, 16, v216
v_and_b32 v101, 0xffff0000, v216
v_lshlrev_b32 v102, 16, v217
v_and_b32 v103, 0xffff0000, v217
v_pk_add_f32 v[148:149], v[148:149], v[100:101]
v_pk_add_f32 v[150:151], v[150:151], v[102:103]
v_cmp_u_f32 vcc, v148, v150
v_cvt_pk_bf16_f32 v180, v148, v149
v_cvt_pk_bf16_f32 v181, v150, v151
s_cbranch_vccz L_gok_218
buffer_load_dwordx2 v[212:213], v17, s[8:11], s22 offen offset:512 sc1
buffer_load_dwordx2 v[214:215], v18, s[8:11], s22 offen offset:512 sc1
buffer_load_dwordx2 v[216:217], v19, s[8:11], s22 offen offset:512 sc1
s_waitcnt vmcnt(5)
v_lshlrev_b32 v100, 16, v200
v_and_b32 v101, 0xffff0000, v200
v_lshlrev_b32 v102, 16, v201
v_and_b32 v103, 0xffff0000, v201
v_pk_add_f32 v[148:149], v[168:169], v[100:101]
v_pk_add_f32 v[150:151], v[170:171], v[102:103]
s_waitcnt vmcnt(4)
v_lshlrev_b32 v100, 16, v202
v_and_b32 v101, 0xffff0000, v202
v_lshlrev_b32 v102, 16, v203
v_and_b32 v103, 0xffff0000, v203
v_pk_add_f32 v[148:149], v[148:149], v[100:101]
v_pk_add_f32 v[150:151], v[150:151], v[102:103]
s_waitcnt vmcnt(3)
v_lshlrev_b32 v100, 16, v204
v_and_b32 v101, 0xffff0000, v204
v_lshlrev_b32 v102, 16, v205
v_and_b32 v103, 0xffff0000, v205
v_pk_add_f32 v[148:149], v[148:149], v[100:101]
v_pk_add_f32 v[150:151], v[150:151], v[102:103]
v_cmp_u_f32 vcc, v148, v150
v_cvt_pk_bf16_f32 v180, v148, v149
v_cvt_pk_bf16_f32 v181, v150, v151
s_cbranch_vccz L_gok_218
s_add_u32 s33, s33, 1
s_cmp_gt_u32 s33, 0x100000
s_cbranch_scc1 chain_kernel_abort
s_and_b32 s20, s33, 63
s_cbranch_scc1 L_rt_220
v_cmp_eq_u32 vcc, s34, v200
v_cmp_eq_u32 s[20:21], s34, v201
s_or_b64 vcc, vcc, s[20:21]
v_cmp_eq_u32 s[20:21], s34, v202
s_or_b64 vcc, vcc, s[20:21]
v_cmp_eq_u32 s[20:21], s34, v203
s_or_b64 vcc, vcc, s[20:21]
v_cmp_eq_u32 s[20:21], s34, v204
s_or_b64 vcc, vcc, s[20:21]
v_cmp_eq_u32 s[20:21], s34, v205
s_or_b64 vcc, vcc, s[20:21]
s_cbranch_vccnz L_rt_220
s_branch L_gok_218
L_slow_16:
L_step_224:
s_nop 15
s_nop 7
L_step_224_nd:
buffer_load_dwordx4 v[48:51], v2, s[8:11], s38 offen sc1
v_mov_b32 v88, 0
v_mov_b32 v89, 0
v_mov_b32 v90, 0
v_mov_b32 v91, 0
v_mov_b32 v92, 0
v_mov_b32 v93, 0
v_mov_b32 v94, 0
v_mov_b32 v95, 0
ds_read_b128 v[116:119], v25
ds_read_b128 v[120:123], v25 offset:1024
v_xor_b32 v25, 0x1000, v25
s_nop 0
buffer_load_dwordx4 v[52:55], v3, s[8:11], s38 offen sc1
s_nop 11
buffer_load_dwordx4 v[56:59], v4, s[8:11], s38 offen sc1
s_nop 11
buffer_load_dwordx4 v[60:63], v5, s[8:11], s38 offen sc1
s_waitcnt vmcnt(3)
v_max3_u32 v7, v48, v49, v50
v_max_u32 v7, v7, v51
v_cmp_eq_u32 vcc, s34, v7
s_cbranch_vccnz L_q_a_231
L_v_a_232:
v_smfmac_f32_16x16x64_bf16 v[64:67], v[48:51], a[0:7], v6
s_waitcnt vmcnt(2)
v_max3_u32 v7, v52, v53, v54
v_max_u32 v7, v7, v55
v_smfmac_f32_16x16x64_bf16 v[68:71], v[48:51], a[64:71], v6
v_cmp_eq_u32 vcc, s34, v7
v_smfmac_f32_16x16x64_bf16 v[72:75], v[48:51], a[32:39], v6
v_smfmac_f32_16x16x64_bf16 v[76:79], v[48:51], a[96:103], v6
s_cbranch_vccnz L_q_a_233
L_v_a_234:
v_smfmac_f32_16x16x64_bf16 v[64:67], v[52:55], a[8:15], v6
s_waitcnt vmcnt(1)
v_max3_u32 v7, v56, v57, v58
v_max_u32 v7, v7, v59
v_smfmac_f32_16x16x64_bf16 v[68:71], v[52:55], a[72:79], v6
v_cmp_eq_u32 vcc, s34, v7
v_smfmac_f32_16x16x64_bf16 v[72:75], v[52:55], a[40:47], v6
v_smfmac_f32_16x16x64_bf16 v[76:79], v[52:55], a[104:111], v6
s_cbranch_vccnz L_q_a_235
L_v_a_236:
v_smfmac_f32_16x16x64_bf16 v[64:67], v[56:59], a[16:23], v6
s_waitcnt vmcnt(0)
v_max3_u32 v7, v60, v61, v62
v_max_u32 v7, v7, v63
v_smfmac_f32_16x16x64_bf16 v[68:71], v[56:59], a[80:87], v6
v_cmp_eq_u32 vcc, s34, v7
v_smfmac_f32_16x16x64_bf16 v[72:75], v[56:59], a[48:55], v6
v_smfmac_f32_16x16x64_bf16 v[76:79], v[56:59], a[112:119], v6
s_cbranch_vccnz L_q_a_237
L_v_a_238:
v_smfmac_f32_16x16x64_bf16 v[64:67], v[60:63], a[24:31], v6
v_smfmac_f32_16x16x64_bf16 v[68:71], v[60:63], a[88:95], v6
v_smfmac_f32_16x16x64_bf16 v[72:75], v[60:63], a[56:63], v6
v_smfmac_f32_16x16x64_bf16 v[76:79], v[60:63], a[120:127], v6
L_gd_a_230:
v_cvt_pk_bf16_f32 v96, v64, v65
v_cvt_pk_bf16_f32 v97, v66, v67
v_cvt_pk_bf16_f32 v98, v68, v69
v_cvt_pk_bf16_f32 v99, v70, v71
s_cmp_lg_u32 s18, 0
v_cvt_pk_bf16_f32 v100, v72, v73
v_mfma_f32_16x16x32_bf16 v[104:107], v[96:99], v[40:43], 0
v_cvt_pk_bf16_f32 v101, v74, v75
v_cvt_pk_bf16_f32 v102, v76, v77
v_cvt_pk_bf16_f32 v103, v78, v79
s_nop 1
v_mfma_f32_16x16x32_bf16 v[108:111], v[100:103], v[40:43], 0
s_cbranch_scc0 L_help1_225_w0
s_nop 0
ds_write_b128 v20, v[104:107]
s_nop 4
ds_write_b128 v20, v[108:111] offset:1024
s_waitcnt lgkmcnt(0)
s_barrier
v_smfmac_f32_16x16x64_bf16 v[80:83], v[48:51], a[128:135], v6
v_smfmac_f32_16x16x64_bf16 v[84:87], v[48:51], a[160:167], v6
v_smfmac_f32_16x16x64_bf16 v[80:83], v[52:55], a[136:143], v6
v_smfmac_f32_16x16x64_bf16 v[84:87], v[52:55], a[168:175], v6
v_smfmac_f32_16x16x64_bf16 v[80:83], v[56:59], a[144:151], v6
v_smfmac_f32_16x16x64_bf16 v[84:87], v[56:59], a[176:183], v6
v_smfmac_f32_16x16x64_bf16 v[80:83], v[60:63], a[152:159], v6
v_smfmac_f32_16x16x64_bf16 v[84:87], v[60:63], a[184:191], v6
s_nop 4
ds_write_b128 v21, v[80:83]
s_nop 1
ds_write_b128 v21, v[84:87] offset:512
s_waitcnt lgkmcnt(0)
L_bar2b_323_2:
s_barrier
s_cmp_eq_u32 s18, 1
s_cbranch_scc1 L_vred_322
L_bar2b_323:
s_waitcnt lgkmcnt(0)
s_barrier
s_cmp_eq_u32 s19, 63
s_cbranch_scc1 L_fin_229
s_cmp_lg_u32 s18, 2
s_cbranch_scc1 L_poe_324
s_sub_u32 s20, s19, 1
s_and_b32 s20, s20, 3
s_lshl_b32 s21, s20, 16
s_add_u32 s21, s21, s36
s_add_u32 s22, s21, 0x140000
s_lshl_b32 s23, s20, 18
s_add_u32 s23, s23, s37
buffer_store_dwordx2 v[36:37], v8, s[8:11], s21 offen sc1
buffer_store_dwordx2 v[36:37], v28, s[8:11], s22 offen sc1
buffer_store_dwordx4 v[36:39], v9, s[8:11], s23 offen sc1
s_mov_b64 exec, s[28:29]
buffer_store_dwordx4 v[36:39], v10, s[8:11], s23 offen sc1
s_mov_b64 exec, -1
L_poe_324:
s_cmp_lg_u32 s18, 3
s_cbranch_scc1 L_bar3_226
s_cmp_ge_u32 s19, 2
s_cbranch_scc1 L_gated_325
s_add_u32 s23, s19, 1
s_lshl_b32 s21, s23, 7
s_add_u32 s21, s21, 0x5900000
v_mov_b32 v34, 0
L_dw_326:
buffer_load_dword v35, v34, s[8:11], s21 offen sc1
s_add_u32 s33, s33, 1
s_cmp_gt_u32 s33, 0x100000
s_waitcnt vmcnt(0)
s_cbranch_scc1 chain_kernel_abort
v_readfirstlane_b32 s20, v35
s_cmp_ge_u32 s20, 64
s_cbranch_scc1 L_dwok_327
s_sleep 2
s_branch L_dw_326
L_dwok_327:
L_gated_325:
s_add_u32 m0, s43, 0
s_nop 0
buffer_load_dwordx4 v27, s[8:11], s31 offen offset:0 lds
s_add_u32 m0, s43, 896
s_nop 0
buffer_load_dwordx4 v27, s[8:11], s31 offen offset:128 lds
s_add_u32 m0, s43, 0
s_nop 0
buffer_load_dwordx4 v29, s[8:11], s31 offen offset:2048 lds
s_add_u32 m0, s43, 960
s_nop 0
buffer_load_dwordx4 v29, s[8:11], s31 offen offset:2112 lds
s_xor_b32 s43, s43, 4096
s_branch L_bar3_226
L_vred_322:
ds_read_b64 v[168:169], v22 offset:0
ds_read_b64 v[170:171], v22 offset:512
ds_read_b64 v[172:173], v22 offset:1024
ds_read_b64 v[174:175], v22 offset:1536
ds_read_b64 v[176:177], v22 offset:2048
ds_read_b64 v[178:179], v22 offset:2560
ds_read_b64 v[180:181], v22 offset:3072
ds_read_b64 v[182:183], v22 offset:3584
ds_read_b64 v[184:185], v22 offset:4096
ds_read_b64 v[186:187], v22 offset:4608
ds_read_b64 v[188:189], v22 offset:5120
ds_read_b64 v[190:191], v22 offset:5632
ds_read_b64 v[192:193], v22 offset:6144
ds_read_b64 v[194:195], v22 offset:6656
ds_read_b64 v[196:197], v22 offset:7168
s_waitcnt lgkmcnt(11)
ds_read_b64 v[198:199], v22 offset:7680
s_waitcnt lgkmcnt(8)
v_pk_add_f32 v[168:169], v[168:169], v[172:173]
v_pk_add_f32 v[170:171], v[170:171], v[174:175]
v_pk_add_f32 v[176:177], v[176:177], v[180:181]
v_pk_add_f32 v[178:179], v[178:179], v[182:183]
v_pk_add_f32 v[168:169], v[168:169], v[176:177]
v_pk_add_f32 v[170:171], v[170:171], v[178:179]
s_waitcnt lgkmcnt(0)
v_pk_add_f32 v[184:185], v[184:185], v[188:189]
v_pk_add_f32 v[186:187], v[186:187], v[190:191]
v_pk_add_f32 v[192:193], v[192:193], v[196:197]
v_pk_add_f32 v[194:195], v[194:195], v[198:199]
v_pk_add_f32 v[168:169], v[168:169], v[184:185]
v_pk_add_f32 v[170:171], v[170:171], v[186:187]
v_pk_add_f32 v[168:169], v[168:169], v[192:193]
v_pk_add_f32 v[170:171], v[170:171], v[194:195]
v_cvt_pk_bf16_f32 v144, v168, v169
v_cvt_pk_bf16_f32 v146, v170, v171
ds_write2_b32 v32, v144, v146 offset0:0 offset1:16
s_branch L_bar2b_323
L_help1_225_w0:
v_smfmac_f32_16x16x64_bf16 v[80:83], v[48:51], a[128:135], v6
v_smfmac_f32_16x16x64_bf16 v[84:87], v[48:51], a[160:167], v6
v_smfmac_f32_16x16x64_bf16 v[80:83], v[52:55], a[136:143], v6
v_smfmac_f32_16x16x64_bf16 v[84:87], v[52:55], a[168:175], v6
v_smfmac_f32_16x16x64_bf16 v[80:83], v[56:59], a[144:151], v6
v_smfmac_f32_16x16x64_bf16 v[84:87], v[56:59], a[176:183], v6
v_smfmac_f32_16x16x64_bf16 v[80:83], v[60:63], a[152:159], v6
v_smfmac_f32_16x16x64_bf16 v[84:87], v[60:63], a[184:191], v6
s_nop 4
ds_write_b128 v21, v[80:83]
s_nop 1
ds_write_b128 v21, v[84:87] offset:512
s_barrier
ds_read_b128 v[168:171], v1 offset:2048
ds_read_b128 v[172:175], v1 offset:3072
ds_read_b128 v[176:179], v1 offset:4096
ds_read_b128 v[180:183], v1 offset:5120
ds_read_b128 v[184:187], v1 offset:6144
ds_read_b128 v[188:191], v1 offset:7168
s_waitcnt lgkmcnt(4)
v_pk_add_f32 v[104:105], v[104:105], v[168:169]
v_pk_add_f32 v[106:107], v[106:107], v[170:171]
v_pk_add_f32 v[108:109], v[108:109], v[172:173]
v_pk_add_f32 v[110:111], v[110:111], v[174:175]
s_waitcnt lgkmcnt(2)
v_pk_add_f32 v[104:105], v[104:105], v[176:177]
v_pk_add_f32 v[106:107], v[106:107], v[178:179]
v_pk_add_f32 v[108:109], v[108:109], v[180:181]
v_pk_add_f32 v[110:111], v[110:111], v[182:183]
s_waitcnt lgkmcnt(0)
v_pk_add_f32 v[104:105], v[104:105], v[184:185]
v_pk_add_f32 v[106:107], v[106:107], v[186:187]
v_pk_add_f32 v[108:109], v[108:109], v[188:189]
v_pk_add_f32 v[110:111], v[110:111], v[190:191]
v_cvt_pk_bf16_f32 v112, v104, v105
v_cvt_pk_bf16_f32 v113, v106, v107
v_cvt_pk_bf16_f32 v114, v108, v109
v_cvt_pk_bf16_f32 v115, v110, v111
s_mov_b64 exec, s[28:29]
s_nop 0
v_mfma_f32_16x16x32_bf16 v[132:135], v[112:115], v[112:115], 0
v_mfma_f32_16x16x32_bf16 v[124:127], v[116:119], v[112:115], 0
v_mfma_f32_16x16x32_bf16 v[128:131], v[120:123], v[112:115], 0
s_nop 3
buffer_store_dwordx4 v[132:135], v10, s[8:11], s40 offen sc1
s_mov_b64 exec, s[24:25]
buffer_store_dwordx4 v[124:127], v9, s[8:11], s40 offen sc1
s_nop 0
buffer_store_dwordx4 v[128:131], v9, s[8:11], s40 offen offset:128 sc1
s_mov_b64 exec, -1
ds_write_b128 v1, v[112:115] offset:32768
ds_read_b128 v[136:139], v26 offset:0
ds_read_b128 v[140:143], v26 offset:1024
v_mov_b32_dpp v124, v128 row_shr:8 row_mask:0xf bank_mask:0xc
v_mov_b32_dpp v125, v129 row_shr:8 row_mask:0xf bank_mask:0xc
v_mov_b32_dpp v126, v130 row_shr:8 row_mask:0xf bank_mask:0xc
v_mov_b32_dpp v127, v131 row_shr:8 row_mask:0xf bank_mask:0xc
v_xor_b32 v26, 0x1000, v26
s_cmp_eq_u32 s19, 63
s_cbranch_scc1 L_bar2b_323_2
s_nop 11
buffer_load_dwordx4 v[200:203], v16, s[8:11], s40 offen sc1
buffer_load_dwordx4 v[204:207], v13, s[8:11], s40 offen sc1
buffer_load_dwordx4 v[208:211], v14, s[8:11], s40 offen sc1
buffer_load_dwordx4 v[212:215], v15, s[8:11], s40 offen sc1
s_barrier
s_nop 15
s_nop 13
buffer_load_dwordx4 v[216:219], v16, s[8:11], s40 offen sc1
buffer_load_dwordx4 v[220:223], v13, s[8:11], s40 offen sc1
buffer_load_dwordx4 v[224:227], v14, s[8:11], s40 offen sc1
buffer_load_dwordx4 v[228:231], v15, s[8:11], s40 offen sc1
s_waitcnt vmcnt(7)
v_permlane32_swap_b32 v200, v202
v_permlane32_swap_b32 v201, v203
s_waitcnt vmcnt(6)
v_pk_add_f32 v[154:155], v[200:201], v[202:203]
v_pk_add_f32 v[148:149], v[124:125], v[204:205]
v_pk_add_f32 v[150:151], v[126:127], v[206:207]
v_permlane16_swap_b32 v154, v155
s_waitcnt vmcnt(5)
v_pk_add_f32 v[148:149], v[148:149], v[208:209]
v_pk_add_f32 v[150:151], v[150:151], v[210:211]
v_add_f32 v152, v154, v155
s_waitcnt vmcnt(4)
v_pk_add_f32 v[148:149], v[148:149], v[212:213]
v_pk_add_f32 v[150:151], v[150:151], v[214:215]
v_pk_add_f32 v[154:155], v[148:149], v[150:151]
v_add_f32 v154, v154, v152
v_cmp_u_f32 vcc, v154, v155
v_max3_f32 v154, v148, v149, v150
v_max3_f32 v154, v154, v151, v152
s_nop 1
v_max_f32_dpp v154, v154, v154 row_ror:8 row_mask:0xf bank_mask:0xf
s_cbranch_vccnz L_cf_329
L_chead_331:
v_mov_b32 v156, v154
s_waitcnt lgkmcnt(0)
s_barrier
v_permlane16_swap_b32 v154, v156
v_max_f32 v154, v154, v156
v_mov_b32 v156, v154
ds_read_b32 v144, v32
ds_read_b32 v146, v32 offset:64
v_permlane32_swap_b32 v154, v156
v_max_f32 v154, v154, v156
v_mul_f32 v154, s44, v154
v_fma_f32 v152, v152, s44, -v154
v_exp_f32 v152, v152
v_pk_fma_f32 v[148:149], v[148:149], s[44:45], v[154:155] op_sel_hi:[1,1,0] neg_lo:[0,0,1] neg_hi:[0,0,1]
v_pk_fma_f32 v[150:151], v[150:151], s[44:45], v[154:155] op_sel_hi:[1,1,0] neg_lo:[0,0,1] neg_hi:[0,0,1]
v_mov_b32_dpp v156, v152 row_ror:8 row_mask:0xf bank_mask:0xf
v_exp_f32 v148, v148
v_cvt_pk_bf16_f32 v164, v152, v156
v_exp_f32 v149, v149
v_exp_f32 v150, v150
v_mfma_f32_16x16x16_bf16 v[176:179], v[44:45], v[164:165], 0
v_exp_f32 v151, v151
s_waitcnt lgkmcnt(0)
v_cvt_pk_bf16_f32 v160, v148, v149
v_mfma_f32_16x16x16_bf16 v[168:171], v[144:145], v[164:165], 0
v_cvt_pk_bf16_f32 v161, v150, v151
v_mov_b32_dpp v162, v160 row_ror:8 row_mask:0xf bank_mask:0xf
v_mfma_f32_16x16x16_bf16 v[172:175], v[146:147], v[164:165], 0
v_mov_b32_dpp v163, v161 row_ror:8 row_mask:0xf bank_mask:0xf
s_nop 0
s_mov_b64 exec, s[24:25]
v_mfma_f32_16x16x32_bf16 v[176:179], v[44:47], v[160:163], v[176:179]
v_mfma_f32_16x16x32_bf16 v[168:171], v[136:139], v[160:163], v[168:171]
v_mfma_f32_16x16x32_bf16 v[172:175], v[140:143], v[160:163], v[172:175]
s_nop 3
v_rcp_f32 v176, v176
s_nop 0
v_pk_mul_f32 v[168:169], v[168:169], v[176:177] op_sel_hi:[1,0]
v_pk_mul_f32 v[170:171], v[170:171], v[176:177] op_sel_hi:[1,0]
v_pk_mul_f32 v[172:173], v[172:173], v[176:177] op_sel_hi:[1,0]
v_pk_mul_f32 v[174:175], v[174:175], v[176:177] op_sel_hi:[1,0]
v_cvt_pk_bf16_f32 v180, v168, v169
v_cvt_pk_bf16_f32 v181, v170, v171
v_cvt_pk_bf16_f32 v182, v172, v173
v_cvt_pk_bf16_f32 v183, v174, v175
buffer_store_dwordx4 v[180:183], v11, s[8:11], s41 offen sc1
s_mov_b64 exec, -1
s_barrier
s_nop 15
s_nop 3
s_branch L_bar3_226_e
L_bar3_226:
s_waitcnt lgkmcnt(0)
s_barrier
s_nop 15
s_nop 7
L_bar3_226_e:
buffer_load_dwordx4 v[48:51], v2, s[8:11], s41 offen sc1
v_mov_b32 v64, 0
v_mov_b32 v65, 0
v_mov_b32 v66, 0
v_mov_b32 v67, 0
v_mov_b32 v68, 0
v_mov_b32 v69, 0
v_mov_b32 v70, 0
v_mov_b32 v71, 0
v_mov_b32 v72, 0
v_mov_b32 v73, 0
v_mov_b32 v74, 0
v_mov_b32 v75, 0
buffer_load_dwordx4 v[52:55], v3, s[8:11], s41 offen sc1
v_mov_b32 v76, 0
v_mov_b32 v77, 0
v_mov_b32 v78, 0
v_mov_b32 v79, 0
v_mov_b32 v80, 0
v_mov_b32 v81, 0
v_mov_b32 v82, 0
v_mov_b32 v83, 0
v_mov_b32 v84, 0
v_mov_b32 v85, 0
v_mov_b32 v86, 0
v_mov_b32 v87, 0
buffer_load_dwordx4 v[56:59], v4, s[8:11], s41 offen sc1
s_nop 11
buffer_load_dwordx4 v[60:63], v5, s[8:11], s41 offen sc1
s_waitcnt vmcnt(3)
v_max3_u32 v7, v48, v49, v50
v_max_u32 v7, v7, v51
v_cmp_eq_u32 vcc, s34, v7
s_cbranch_vccnz L_q_e_333
L_v_e_334:
v_smfmac_f32_16x16x64_bf16 v[88:91], v[48:51], a[192:199], v6
s_waitcnt vmcnt(2)
v_max3_u32 v7, v52, v53, v54
v_max_u32 v7, v7, v55
v_cmp_eq_u32 vcc, s34, v7
v_smfmac_f32_16x16x64_bf16 v[92:95], v[48:51], a[224:231], v6
s_cbranch_vccnz L_q_e_335
L_v_e_336:
v_smfmac_f32_16x16x64_bf16 v[88:91], v[52:55], a[200:207], v6
s_waitcnt vmcnt(1)
v_max3_u32 v7, v56, v57, v58
v_max_u32 v7, v7, v59
v_cmp_eq_u32 vcc, s34, v7
v_smfmac_f32_16x16x64_bf16 v[92:95], v[52:55], a[232:239], v6
s_cbranch_vccnz L_q_e_337
L_v_e_338:
v_smfmac_f32_16x16x64_bf16 v[88:91], v[56:59], a[208:215], v6
s_waitcnt vmcnt(0)
v_max3_u32 v7, v60, v61, v62
v_max_u32 v7, v7, v63
v_cmp_eq_u32 vcc, s34, v7
v_smfmac_f32_16x16x64_bf16 v[92:95], v[56:59], a[240:247], v6
s_cbranch_vccnz L_q_e_339
L_v_e_340:
v_smfmac_f32_16x16x64_bf16 v[88:91], v[60:63], a[216:223], v6
v_smfmac_f32_16x16x64_bf16 v[92:95], v[60:63], a[248:255], v6
L_gd_e_332:
s_add_u32 s19, s19, 1
s_cmp_lg_u32 s18, 0
s_nop 2
v_cvt_pk_bf16_f32 v96, v88, v89
v_cvt_pk_bf16_f32 v97, v90, v91
s_nop 0
v_cvt_pk_bf16_f32 v98, v92, v93
v_cvt_pk_bf16_f32 v99, v94, v95
s_nop 1
v_mfma_f32_16x16x32_bf16 v[104:107], v[96:99], v[252:255], 0
s_cbranch_scc1 L_help2_227
s_barrier
ds_read_b128 v[172:175], v1 offset:18432
ds_read_b128 v[176:179], v1 offset:20480
ds_read_b128 v[180:183], v1 offset:22528
s_waitcnt lgkmcnt(2)
v_pk_add_f32 v[168:169], v[104:105], v[172:173]
v_pk_add_f32 v[170:171], v[106:107], v[174:175]
s_waitcnt lgkmcnt(1)
v_pk_add_f32 v[168:169], v[168:169], v[176:177]
v_pk_add_f32 v[170:171], v[170:171], v[178:179]
s_waitcnt lgkmcnt(0)
v_pk_add_f32 v[168:169], v[168:169], v[180:181]
v_pk_add_f32 v[170:171], v[170:171], v[182:183]
v_cvt_pk_bf16_f32 v96, v168, v169
v_cvt_pk_bf16_f32 v97, v170, v171
buffer_store_dwordx2 v[96:97], v12, s[8:11], s42 offen offset:0 sc1
buffer_store_dwordx2 v[96:97], v12, s[8:11], s42 offen offset:512 sc1
s_mov_b32 s22, s42
s_mov_b32 s23, s39
s_and_b32 s20, s19, 3
s_lshl_b32 s21, s20, 16
s_add_u32 s38, s36, s21
s_add_u32 s41, s38, 0x140000
s_lshl_b32 s21, s20, 18
s_add_u32 s40, s37, s21
s_add_u32 s42, s31, 0x8000000
s_add_u32 s21, s19, 1
s_bitcmp1_b32 s21, 1
s_cselect_b32 s31, s52, s35
s_lshl_b32 s21, s21, 20
s_add_u32 s31, s31, s21
s_add_u32 s20, s20, 1
s_and_b32 s20, s20, 3
s_lshl_b32 s20, s20, 16
s_add_u32 s39, s36, s20
s_nop 15
s_nop 15
s_nop 15
buffer_load_dwordx2 v[200:201], v17, s[8:11], s22 offen offset:0 sc1
buffer_load_dwordx2 v[202:203], v18, s[8:11], s22 offen offset:0 sc1
buffer_load_dwordx2 v[204:205], v19, s[8:11], s22 offen offset:0 sc1
s_nop 15
s_nop 15
s_nop 15
s_nop 11
buffer_load_dwordx2 v[212:213], v17, s[8:11], s22 offen offset:512 sc1
buffer_load_dwordx2 v[214:215], v18, s[8:11], s22 offen offset:512 sc1
buffer_load_dwordx2 v[216:217], v19, s[8:11], s22 offen offset:512 sc1
ds_read_b128 v[172:175], v1 offset:33792
s_mov_b64 exec, s[26:27]
s_waitcnt lgkmcnt(1)
buffer_store_dwordx4 v[112:115], v30, s[8:11], s22 offen offset:3072 sc1
s_mov_b64 exec, s[48:49]
s_waitcnt lgkmcnt(0)
buffer_store_dwordx4 v[172:175], v31, s[8:11], s22 offen offset:3584 sc1
s_mov_b64 exec, -1
s_waitcnt vmcnt(7)
v_lshlrev_b32 v100, 16, v200
v_and_b32 v101, 0xffff0000, v200
v_lshlrev_b32 v102, 16, v201
v_and_b32 v103, 0xffff0000, v201
v_pk_add_f32 v[148:149], v[168:169], v[100:101]
v_pk_add_f32 v[150:151], v[170:171], v[102:103]
s_waitcnt vmcnt(6)
v_lshlrev_b32 v100, 16, v202
v_and_b32 v101, 0xffff0000, v202
v_lshlrev_b32 v102, 16, v203
v_and_b32 v103, 0xffff0000, v203
v_pk_add_f32 v[148:149], v[148:149], v[100:101]
v_pk_add_f32 v[150:151], v[150:151], v[102:103]
s_waitcnt vmcnt(5)
v_lshlrev_b32 v100, 16, v204
v_and_b32 v101, 0xffff0000, v204
v_lshlrev_b32 v102, 16, v205
v_and_b32 v103, 0xffff0000, v205
v_pk_add_f32 v[148:149], v[148:149], v[100:101]
v_pk_add_f32 v[150:151], v[150:151], v[102:103]
v_cmp_u_f32 vcc, v148, v150
v_cvt_pk_bf16_f32 v180, v148, v149
v_cvt_pk_bf16_f32 v181, v150, v151
s_cbranch_vccnz L_gf_424
L_gok_425:
buffer_store_dwordx2 v[180:181], v8, s[8:11], s23 offen sc1
s_barrier
s_branch L_step_224
L_help2_227:
s_nop 2
ds_write_b128 v20, v[104:107] offset:16384
s_waitcnt lgkmcnt(0)
s_barrier
s_and_b32 s20, s19, 3
s_lshl_b32 s21, s20, 16
s_add_u32 s38, s36, s21
s_add_u32 s41, s38, 0x140000
s_lshl_b32 s21, s20, 18
s_add_u32 s40, s37, s21
s_add_u32 s42, s31, 0x8000000
s_add_u32 s21, s19, 1
s_bitcmp1_b32 s21, 1
s_cselect_b32 s31, s52, s35
s_lshl_b32 s21, s21, 20
s_add_u32 s31, s31, s21
s_add_u32 s20, s20, 1
s_and_b32 s20, s20, 3
s_lshl_b32 s20, s20, 16
s_add_u32 s39, s36, s20
s_cmp_eq_u32 s18, 3
s_cbranch_scc1 L_w3_428
s_xor_b32 s20, s18, 2
s_or_b32 s20, s20, s16
s_or_b32 s20, s20, s17
s_cbranch_scc1 L_bar4_228
s_cmp_lt_u32 s19, 3
s_cbranch_scc1 L_bar4_228
s_atomic_add s53, s[98:99], 0x4
s_branch L_bar4_228
L_w3_428:
s_or_b32 s20, s16, s17
s_cbranch_scc1 L_bar4_228
s_add_u32 s23, s19, 2
s_min_u32 s23, s23, 63
s_lshl_b32 s21, s23, 7
v_mov_b32 v34, 0
L_dw_429:
s_load_dword s20, s[54:55], s21 glc
s_add_u32 s33, s33, 1
s_cmp_gt_u32 s33, 0x100000
s_waitcnt lgkmcnt(0)
s_cbranch_scc1 chain_kernel_abort
s_cmp_ge_u32 s20, 64
s_cbranch_scc1 L_dwok_430
s_sleep 2
s_branch L_dw_429
L_dwok_430:
L_bar4_228:
s_barrier
s_branch L_step_224
L_fin_229:
s_cmp_lg_u32 s18, 2
s_cbranch_scc1 chain_kernel_done
ds_read_b128 v[168:171], v1 offset:32768
ds_read_b128 v[172:175], v1 offset:33792
s_mov_b64 exec, s[26:27]
s_waitcnt lgkmcnt(1)
buffer_store_dwordx4 v[168:171], v30, s[8:11], s42 offen offset:3072 sc1
s_mov_b64 exec, s[48:49]
s_waitcnt lgkmcnt(0)
buffer_store_dwordx4 v[172:175], v31, s[8:11], s42 offen offset:3584 sc1
s_mov_b64 exec, -1
s_branch chain_kernel_done
L_q_a_237:
buffer_load_dwordx4 v[60:63], v5, s[8:11], s38 offen sc1
s_waitcnt vmcnt(0)
v_max3_u32 v7, v60, v61, v62
v_max_u32 v7, v7, v63
v_cmp_eq_u32 vcc, s34, v7
s_cbranch_vccnz L_q_a_239
s_branch L_v_a_238
L_q_a_239:
buffer_load_dwordx4 v[60:63], v5, s[8:11], s38 offen sc1
s_waitcnt vmcnt(2)
v_max3_u32 v7, v60, v61, v62
v_max_u32 v7, v7, v63
v_cmp_eq_u32 vcc, s34, v7
s_cbranch_vccz L_ok_a_240
s_add_u32 s33, s33, 1
s_cmp_gt_u32 s33, 0x100000
s_cbranch_scc0 L_q_a_239
s_branch chain_kernel_abort
L_ok_a_240:
v_smfmac_f32_16x16x64_bf16 v[64:67], v[60:63], a[24:31], v6
v_smfmac_f32_16x16x64_bf16 v[68:71], v[60:63], a[88:95], v6
v_smfmac_f32_16x16x64_bf16 v[72:75], v[60:63], a[56:63], v6
v_smfmac_f32_16x16x64_bf16 v[76:79], v[60:63], a[120:127], v6
s_branch L_gd_a_230
L_q_a_235:
buffer_load_dwordx4 v[56:59], v4, s[8:11], s38 offen sc1
s_waitcnt vmcnt(1)
v_max3_u32 v7, v60, v61, v62
v_max_u32 v7, v7, v63
v_cmp_eq_u32 vcc, s34, v7
s_cbranch_vccnz L_q_a_241
L_v_a_242:
v_smfmac_f32_16x16x64_bf16 v[64:67], v[60:63], a[24:31], v6
s_waitcnt vmcnt(0)
v_max3_u32 v7, v56, v57, v58
v_max_u32 v7, v7, v59
v_smfmac_f32_16x16x64_bf16 v[68:71], v[60:63], a[88:95], v6
v_cmp_eq_u32 vcc, s34, v7
v_smfmac_f32_16x16x64_bf16 v[72:75], v[60:63], a[56:63], v6
v_smfmac_f32_16x16x64_bf16 v[76:79], v[60:63], a[120:127], v6
s_cbranch_vccnz L_q_a_243
L_v_a_244:
v_smfmac_f32_16x16x64_bf16 v[64:67], v[56:59], a[16:23], v6
v_smfmac_f32_16x16x64_bf16 v[68:71], v[56:59], a[80:87], v6
v_smfmac_f32_16x16x64_bf16 v[72:75], v[56:59], a[48:55], v6
v_smfmac_f32_16x16x64_bf16 v[76:79], v[56:59], a[112:119], v6
s_branch L_gd_a_230
L_q_a_243:
buffer_load_dwordx4 v[56:59], v4, s[8:11], s38 offen sc1
s_waitcnt vmcnt(2)
v_max3_u32 v7, v56, v57, v58
v_max_u32 v7, v7, v59
v_cmp_eq_u32 vcc, s34, v7
s_cbranch_vccz L_ok_a_245
s_add_u32 s33, s33, 1
s_cmp_gt_u32 s33, 0x100000
s_cbranch_scc0 L_q_a_243
s_branch chain_kernel_abort
L_ok_a_245:
v_smfmac_f32_16x16x64_bf16 v[64:67], v[56:59], a[16:23], v6
v_smfmac_f32_16x16x64_bf16 v[68:71], v[56:59], a[80:87], v6
v_smfmac_f32_16x16x64_bf16 v[72:75], v[56:59], a[48:55], v6
v_smfmac_f32_16x16x64_bf16 v[76:79], v[56:59], a[112:119], v6
s_branch L_gd_a_230
L_q_a_241:
buffer_load_dwordx4 v[60:63], v5, s[8:11], s38 offen sc1
s_waitcnt vmcnt(1)
v_max3_u32 v7, v56, v57, v58
v_max_u32 v7, v7, v59
v_cmp_eq_u32 vcc, s34, v7
s_cbranch_vccnz L_q_a_246
L_v_a_247:
v_smfmac_f32_16x16x64_bf16 v[64:67], v[56:59], a[16:23], v6
s_waitcnt vmcnt(0)
v_max3_u32 v7, v60, v61, v62
v_max_u32 v7, v7, v63
v_smfmac_f32_16x16x64_bf16 v[68:71], v[56:59], a[80:87], v6
v_cmp_eq_u32 vcc, s34, v7
v_smfmac_f32_16x16x64_bf16 v[72:75], v[56:59], a[48:55], v6
v_smfmac_f32_16x16x64_bf16 v[76:79], v[56:59], a[112:119], v6
s_cbranch_vccnz L_q_a_239
s_branch L_v_a_238
L_q_a_246:
buffer_load_dwordx4 v[56:59], v4, s[8:11], s38 offen sc1
s_waitcnt vmcnt(2)
v_max3_u32 v7, v60, v61, v62
v_max_u32 v7, v7, v63
v_cmp_eq_u32 vcc, s34, v7
s_cbranch_vccz L_ok_a_248
buffer_load_dwordx4 v[60:63], v5, s[8:11], s38 offen sc1
s_waitcnt vmcnt(2)
v_max3_u32 v7, v56, v57, v58
v_max_u32 v7, v7, v59
v_cmp_eq_u32 vcc, s34, v7
s_cbranch_vccz L_ok_a_249
s_add_u32 s33, s33, 1
s_cmp_gt_u32 s33, 0x100000
s_cbranch_scc0 L_q_a_246
s_branch chain_kernel_abort
L_ok_a_248:
v_smfmac_f32_16x16x64_bf16 v[64:67], v[60:63], a[24:31], v6
v_smfmac_f32_16x16x64_bf16 v[68:71], v[60:63], a[88:95], v6
v_smfmac_f32_16x16x64_bf16 v[72:75], v[60:63], a[56:63], v6
v_smfmac_f32_16x16x64_bf16 v[76:79], v[60:63], a[120:127], v6
s_branch L_q_a_243
L_ok_a_249:
v_smfmac_f32_16x16x64_bf16 v[64:67], v[56:59], a[16:23], v6
v_smfmac_f32_16x16x64_bf16 v[68:71], v[56:59], a[80:87], v6
v_smfmac_f32_16x16x64_bf16 v[72:75], v[56:59], a[48:55], v6
v_smfmac_f32_16x16x64_bf16 v[76:79], v[56:59], a[112:119], v6
s_branch L_q_a_239
L_q_a_233:
buffer_load_dwordx4 v[52:55], v3, s[8:11], s38 offen sc1
s_waitcnt vmcnt(2)
v_max3_u32 v7, v56, v57, v58
v_max_u32 v7, v7, v59
v_cmp_eq_u32 vcc, s34, v7
s_cbranch_vccnz L_q_a_250
L_v_a_251:
v_smfmac_f32_16x16x64_bf16 v[64:67], v[56:59], a[16:23], v6
s_waitcnt vmcnt(1)
v_max3_u32 v7, v60, v61, v62
v_max_u32 v7, v7, v63
v_smfmac_f32_16x16x64_bf16 v[68:71], v[56:59], a[80:87], v6
v_cmp_eq_u32 vcc, s34, v7
v_smfmac_f32_16x16x64_bf16 v[72:75], v[56:59], a[48:55], v6
v_smfmac_f32_16x16x64_bf16 v[76:79], v[56:59], a[112:119], v6
s_cbranch_vccnz L_q_a_252
L_v_a_253:
v_smfmac_f32_16x16x64_bf16 v[64:67], v[60:63], a[24:31], v6
s_waitcnt vmcnt(0)
v_max3_u32 v7, v52, v53, v54
v_max_u32 v7, v7, v55
v_smfmac_f32_16x16x64_bf16 v[68:71], v[60:63], a[88:95], v6
v_cmp_eq_u32 vcc, s34, v7
v_smfmac_f32_16x16x64_bf16 v[72:75], v[60:63], a[56:63], v6
v_smfmac_f32_16x16x64_bf16 v[76:79], v[60:63], a[120:127], v6
s_cbranch_vccnz L_q_a_254
L_v_a_255:
v_smfmac_f32_16x16x64_bf16 v[64:67], v[52:55], a[8:15], v6
v_smfmac_f32_16x16x64_bf16 v[68:71], v[52:55], a[72:79], v6
v_smfmac_f32_16x16x64_bf16 v[72:75], v[52:55], a[40:47], v6
v_smfmac_f32_16x16x64_bf16 v[76:79], v[52:55], a[104:111], v6
s_branch L_gd_a_230
L_q_a_254:
buffer_load_dwordx4 v[52:55], v3, s[8:11], s38 offen sc1
s_waitcnt vmcnt(2)
v_max3_u32 v7, v52, v53, v54
v_max_u32 v7, v7, v55
v_cmp_eq_u32 vcc, s34, v7
s_cbranch_vccz L_ok_a_256
s_add_u32 s33, s33, 1
s_cmp_gt_u32 s33, 0x100000
s_cbranch_scc0 L_q_a_254
s_branch chain_kernel_abort
L_ok_a_256:
v_smfmac_f32_16x16x64_bf16 v[64:67], v[52:55], a[8:15], v6
v_smfmac_f32_16x16x64_bf16 v[68:71], v[52:55], a[72:79], v6
v_smfmac_f32_16x16x64_bf16 v[72:75], v[52:55], a[40:47], v6
v_smfmac_f32_16x16x64_bf16 v[76:79], v[52:55], a[104:111], v6
s_branch L_gd_a_230
L_q_a_252:
buffer_load_dwordx4 v[60:63], v5, s[8:11], s38 offen sc1
s_waitcnt vmcnt(1)
v_max3_u32 v7, v52, v53, v54
v_max_u32 v7, v7, v55
v_cmp_eq_u32 vcc, s34, v7
s_cbranch_vccnz L_q_a_257
L_v_a_258:
v_smfmac_f32_16x16x64_bf16 v[64:67], v[52:55], a[8:15], v6
s_waitcnt vmcnt(0)
v_max3_u32 v7, v60, v61, v62
v_max_u32 v7, v7, v63
v_smfmac_f32_16x16x64_bf16 v[68:71], v[52:55], a[72:79], v6
v_cmp_eq_u32 vcc, s34, v7
v_smfmac_f32_16x16x64_bf16 v[72:75], v[52:55], a[40:47], v6
v_smfmac_f32_16x16x64_bf16 v[76:79], v[52:55], a[104:111], v6
s_cbranch_vccnz L_q_a_239
s_branch L_v_a_238
L_q_a_257:
buffer_load_dwordx4 v[52:55], v3, s[8:11], s38 offen sc1
s_waitcnt vmcnt(2)
v_max3_u32 v7, v60, v61, v62
v_max_u32 v7, v7, v63
v_cmp_eq_u32 vcc, s34, v7
s_cbranch_vccz L_ok_a_259
buffer_load_dwordx4 v[60:63], v5, s[8:11], s38 offen sc1
s_waitcnt vmcnt(2)
v_max3_u32 v7, v52, v53, v54
v_max_u32 v7, v7, v55
v_cmp_eq_u32 vcc, s34, v7
s_cbranch_vccz L_ok_a_260
s_add_u32 s33, s33, 1
s_cmp_gt_u32 s33, 0x100000
s_cbranch_scc0 L_q_a_257
s_branch chain_kernel_abort
L_ok_a_259:
v_smfmac_f32_16x16x64_bf16 v[64:67], v[60:63], a[24:31], v6
v_smfmac_f32_16x16x64_bf16 v[68:71], v[60:63], a[88:95], v6
v_smfmac_f32_16x16x64_bf16 v[72:75], v[60:63], a[56:63], v6
v_smfmac_f32_16x16x64_bf16 v[76:79], v[60:63], a[120:127], v6
s_branch L_q_a_254
L_ok_a_260:
v_smfmac_f32_16x16x64_bf16 v[64:67], v[52:55], a[8:15], v6
v_smfmac_f32_16x16x64_bf16 v[68:71], v[52:55], a[72:79], v6
v_smfmac_f32_16x16x64_bf16 v[72:75], v[52:55], a[40:47], v6
v_smfmac_f32_16x16x64_bf16 v[76:79], v[52:55], a[104:111], v6
s_branch L_q_a_239
L_q_a_250:
buffer_load_dwordx4 v[56:59], v4, s[8:11], s38 offen sc1
s_waitcnt vmcnt(2)
v_max3_u32 v7, v60, v61, v62
v_max_u32 v7, v7, v63
v_cmp_eq_u32 vcc, s34, v7
s_cbranch_vccnz L_q_a_261
L_v_a_262:
v_smfmac_f32_16x16x64_bf16 v[64:67], v[60:63], a[24:31], v6
s_waitcnt vmcnt(1)
v_max3_u32 v7, v52, v53, v54
v_max_u32 v7, v7, v55
v_smfmac_f32_16x16x64_bf16 v[68:71], v[60:63], a[88:95], v6
v_cmp_eq_u32 vcc, s34, v7
v_smfmac_f32_16x16x64_bf16 v[72:75], v[60:63], a[56:63], v6
v_smfmac_f32_16x16x64_bf16 v[76:79], v[60:63], a[120:127], v6
s_cbranch_vccnz L_q_a_263
L_v_a_264:
v_smfmac_f32_16x16x64_bf16 v[64:67], v[52:55], a[8:15], v6
s_waitcnt vmcnt(0)
v_max3_u32 v7, v56, v57, v58
v_max_u32 v7, v7, v59
v_smfmac_f32_16x16x64_bf16 v[68:71], v[52:55], a[72:79], v6
v_cmp_eq_u32 vcc, s34, v7
v_smfmac_f32_16x16x64_bf16 v[72:75], v[52:55], a[40:47], v6
v_smfmac_f32_16x16x64_bf16 v[76:79], v[52:55], a[104:111], v6
s_cbranch_vccnz L_q_a_243
s_branch L_v_a_244
L_q_a_263:
buffer_load_dwordx4 v[52:55], v3, s[8:11], s38 offen sc1
s_waitcnt vmcnt(2)
v_max3_u32 v7, v56, v57, v58
v_max_u32 v7, v7, v59
v_cmp_eq_u32 vcc, s34, v7
s_cbranch_vccz L_ok_a_265
buffer_load_dwordx4 v[56:59], v4, s[8:11], s38 offen sc1
s_waitcnt vmcnt(2)
v_max3_u32 v7, v52, v53, v54
v_max_u32 v7, v7, v55
v_cmp_eq_u32 vcc, s34, v7
s_cbranch_vccz L_ok_a_266
s_add_u32 s33, s33, 1
s_cmp_gt_u32 s33, 0x100000
s_cbranch_scc0 L_q_a_263
s_branch chain_kernel_abort
L_ok_a_265:
v_smfmac_f32_16x16x64_bf16 v[64:67], v[56:59], a[16:23], v6
v_smfmac_f32_16x16x64_bf16 v[68:71], v[56:59], a[80:87], v6
v_smfmac_f32_16x16x64_bf16 v[72:75], v[56:59], a[48:55], v6
v_smfmac_f32_16x16x64_bf16 v[76:79], v[56:59], a[112:119], v6
s_branch L_q_a_254
L_ok_a_266:
v_smfmac_f32_16x16x64_bf16 v[64:67], v[52:55], a[8:15], v6
v_smfmac_f32_16x16x64_bf16 v[68:71], v[52:55], a[72:79], v6
v_smfmac_f32_16x16x64_bf16 v[72:75], v[52:55], a[40:47], v6
v_smfmac_f32_16x16x64_bf16 v[76:79], v[52:55], a[104:111], v6
s_branch L_q_a_243
L_q_a_261:
buffer_load_dwordx4 v[60:63], v5, s[8:11], s38 offen sc1
s_waitcnt vmcnt(2)
v_max3_u32 v7, v52, v53, v54
v_max_u32 v7, v7, v55
v_cmp_eq_u32 vcc, s34, v7
s_cbranch_vccnz L_q_a_267
L_v_a_268:
v_smfmac_f32_16x16x64_bf16 v[64:67], v[52:55], a[8:15], v6
s_waitcnt vmcnt(1)
v_max3_u32 v7, v56, v57, v58
v_max_u32 v7, v7, v59
v_smfmac_f32_16x16x64_bf16 v[68:71], v[52:55], a[72:79], v6
v_cmp_eq_u32 vcc, s34, v7
v_smfmac_f32_16x16x64_bf16 v[72:75], v[52:55], a[40:47], v6
v_smfmac_f32_16x16x64_bf16 v[76:79], v[52:55], a[104:111], v6
s_cbranch_vccnz L_q_a_246
s_branch L_v_a_247
L_q_a_267:
buffer_load_dwordx4 v[52:55], v3, s[8:11], s38 offen sc1
s_waitcnt vmcnt(2)
v_max3_u32 v7, v56, v57, v58
v_max_u32 v7, v7, v59
v_cmp_eq_u32 vcc, s34, v7
s_cbranch_vccz L_ok_a_269
buffer_load_dwordx4 v[56:59], v4, s[8:11], s38 offen sc1
s_waitcnt vmcnt(2)
v_max3_u32 v7, v60, v61, v62
v_max_u32 v7, v7, v63
v_cmp_eq_u32 vcc, s34, v7
s_cbranch_vccz L_ok_a_270
buffer_load_dwordx4 v[60:63], v5, s[8:11], s38 offen sc1
s_waitcnt vmcnt(2)
v_max3_u32 v7, v52, v53, v54
v_max_u32 v7, v7, v55
v_cmp_eq_u32 vcc, s34, v7
s_cbranch_vccz L_ok_a_271
s_add_u32 s33, s33, 1
s_cmp_gt_u32 s33, 0x100000
s_cbranch_scc0 L_q_a_267
s_branch chain_kernel_abort
L_ok_a_269:
v_smfmac_f32_16x16x64_bf16 v[64:67], v[56:59], a[16:23], v6
v_smfmac_f32_16x16x64_bf16 v[68:71], v[56:59], a[80:87], v6
v_smfmac_f32_16x16x64_bf16 v[72:75], v[56:59], a[48:55], v6
v_smfmac_f32_16x16x64_bf16 v[76:79], v[56:59], a[112:119], v6
s_branch L_q_a_257
L_ok_a_270:
v_smfmac_f32_16x16x64_bf16 v[64:67], v[60:63], a[24:31], v6
v_smfmac_f32_16x16x64_bf16 v[68:71], v[60:63], a[88:95], v6
v_smfmac_f32_16x16x64_bf16 v[72:75], v[60:63], a[56:63], v6
v_smfmac_f32_16x16x64_bf16 v[76:79], v[60:63], a[120:127], v6
s_branch L_q_a_263
L_ok_a_271:
v_smfmac_f32_16x16x64_bf16 v[64:67], v[52:55], a[8:15], v6
v_smfmac_f32_16x16x64_bf16 v[68:71], v[52:55], a[72:79], v6
v_smfmac_f32_16x16x64_bf16 v[72:75], v[52:55], a[40:47], v6
v_smfmac_f32_16x16x64_bf16 v[76:79], v[52:55], a[104:111], v6
s_branch L_q_a_246
L_q_a_231:
buffer_load_dwordx4 v[48:51], v2, s[8:11], s38 offen sc1
s_waitcnt vmcnt(3)
v_max3_u32 v7, v52, v53, v54
v_max_u32 v7, v7, v55
v_cmp_eq_u32 vcc, s34, v7
s_cbranch_vccnz L_q_a_272
L_v_a_273:
v_smfmac_f32_16x16x64_bf16 v[64:67], v[52:55], a[8:15], v6
s_waitcnt vmcnt(2)
v_max3_u32 v7, v56, v57, v58
v_max_u32 v7, v7, v59
v_smfmac_f32_16x16x64_bf16 v[68:71], v[52:55], a[72:79], v6
v_cmp_eq_u32 vcc, s34, v7
v_smfmac_f32_16x16x64_bf16 v[72:75], v[52:55], a[40:47], v6
v_smfmac_f32_16x16x64_bf16 v[76:79], v[52:55], a[104:111], v6
s_cbranch_vccnz L_q_a_274
L_v_a_275:
v_smfmac_f32_16x16x64_bf16 v[64:67], v[56:59], a[16:23], v6
s_waitcnt vmcnt(1)
v_max3_u32 v7, v60, v61, v62
v_max_u32 v7, v7, v63
v_smfmac_f32_16x16x64_bf16 v[68:71], v[56:59], a[80:87], v6
v_cmp_eq_u32 vcc, s34, v7
v_smfmac_f32_16x16x64_bf16 v[72:75], v[56:59], a[48:55], v6
v_smfmac_f32_16x16x64_bf16 v[76:79], v[56:59], a[112:119], v6
s_cbranch_vccnz L_q_a_276
L_v_a_277:
v_smfmac_f32_16x16x64_bf16 v[64:67], v[60:63], a[24:31], v6
s_waitcnt vmcnt(0)
v_max3_u32 v7, v48, v49, v50
v_max_u32 v7, v7, v51
v_smfmac_f32_16x16x64_bf16 v[68:71], v[60:63], a[88:95], v6
v_cmp_eq_u32 vcc, s34, v7
v_smfmac_f32_16x16x64_bf16 v[72:75], v[60:63], a[56:63], v6
v_smfmac_f32_16x16x64_bf16 v[76:79], v[60:63], a[120:127], v6
s_cbranch_vccnz L_q_a_278
L_v_a_279:
v_smfmac_f32_16x16x64_bf16 v[64:67], v[48:51], a[0:7], v6
v_smfmac_f32_16x16x64_bf16 v[68:71], v[48:51], a[64:71], v6
v_smfmac_f32_16x16x64_bf16 v[72:75], v[48:51], a[32:39], v6
v_smfmac_f32_16x16x64_bf16 v[76:79], v[48:51], a[96:103], v6
s_branch L_gd_a_230
L_q_a_278:
buffer_load_dwordx4 v[48:51], v2, s[8:11], s38 offen sc1
s_waitcnt vmcnt(2)
v_max3_u32 v7, v48, v49, v50
v_max_u32 v7, v7, v51
v_cmp_eq_u32 vcc, s34, v7
s_cbranch_vccz L_ok_a_280
s_add_u32 s33, s33, 1
s_cmp_gt_u32 s33, 0x100000
s_cbranch_scc0 L_q_a_278
s_branch chain_kernel_abort
L_ok_a_280:
v_smfmac_f32_16x16x64_bf16 v[64:67], v[48:51], a[0:7], v6
v_smfmac_f32_16x16x64_bf16 v[68:71], v[48:51], a[64:71], v6
v_smfmac_f32_16x16x64_bf16 v[72:75], v[48:51], a[32:39], v6
v_smfmac_f32_16x16x64_bf16 v[76:79], v[48:51], a[96:103], v6
s_branch L_gd_a_230
L_q_a_276:
buffer_load_dwordx4 v[60:63], v5, s[8:11], s38 offen sc1
s_waitcnt vmcnt(1)
v_max3_u32 v7, v48, v49, v50
v_max_u32 v7, v7, v51
v_cmp_eq_u32 vcc, s34, v7
s_cbranch_vccnz L_q_a_281
L_v_a_282:
v_smfmac_f32_16x16x64_bf16 v[64:67], v[48:51], a[0:7], v6
s_waitcnt vmcnt(0)
v_max3_u32 v7, v60, v61, v62
v_max_u32 v7, v7, v63
v_smfmac_f32_16x16x64_bf16 v[68:71], v[48:51], a[64:71], v6
v_cmp_eq_u32 vcc, s34, v7
v_smfmac_f32_16x16x64_bf16 v[72:75], v[48:51], a[32:39], v6
v_smfmac_f32_16x16x64_bf16 v[76:79], v[48:51], a[96:103], v6
s_cbranch_vccnz L_q_a_239
s_branch L_v_a_238
L_q_a_281:
buffer_load_dwordx4 v[48:51], v2, s[8:11], s38 offen sc1
s_waitcnt vmcnt(2)
v_max3_u32 v7, v60, v61, v62
v_max_u32 v7, v7, v63
v_cmp_eq_u32 vcc, s34, v7
s_cbranch_vccz L_ok_a_283
buffer_load_dwordx4 v[60:63], v5, s[8:11], s38 offen sc1
s_waitcnt vmcnt(2)
v_max3_u32 v7, v48, v49, v50
v_max_u32 v7, v7, v51
v_cmp_eq_u32 vcc, s34, v7
s_cbranch_vccz L_ok_a_284
s_add_u32 s33, s33, 1
s_cmp_gt_u32 s33, 0x100000
s_cbranch_scc0 L_q_a_281
s_branch chain_kernel_abort
L_ok_a_283:
v_smfmac_f32_16x16x64_bf16 v[64:67], v[60:63], a[24:31], v6
v_smfmac_f32_16x16x64_bf16 v[68:71], v[60:63], a[88:95], v6
v_smfmac_f32_16x16x64_bf16 v[72:75], v[60:63], a[56:63], v6
v_smfmac_f32_16x16x64_bf16 v[76:79], v[60:63], a[120:127], v6
s_branch L_q_a_278
L_ok_a_284:
v_smfmac_f32_16x16x64_bf16 v[64:67], v[48:51], a[0:7], v6
v_smfmac_f32_16x16x64_bf16 v[68:71], v[48:51], a[64:71], v6
v_smfmac_f32_16x16x64_bf16 v[72:75], v[48:51], a[32:39], v6
v_smfmac_f32_16x16x64_bf16 v[76:79], v[48:51], a[96:103], v6
s_branch L_q_a_239
L_q_a_274:
buffer_load_dwordx4 v[56:59], v4, s[8:11], s38 offen sc1
s_waitcnt vmcnt(2)
v_max3_u32 v7, v60, v61, v62
v_max_u32 v7, v7, v63
v_cmp_eq_u32 vcc, s34, v7
s_cbranch_vccnz L_q_a_285
L_v_a_286:
v_smfmac_f32_16x16x64_bf16 v[64:67], v[60:63], a[24:31], v6
s_waitcnt vmcnt(1)
v_max3_u32 v7, v48, v49, v50
v_max_u32 v7, v7, v51
v_smfmac_f32_16x16x64_bf16 v[68:71], v[60:63], a[88:95], v6
v_cmp_eq_u32 vcc, s34, v7
v_smfmac_f32_16x16x64_bf16 v[72:75], v[60:63], a[56:63], v6
v_smfmac_f32_16x16x64_bf16 v[76:79], v[60:63], a[120:127], v6
s_cbranch_vccnz L_q_a_287
L_v_a_288:
v_smfmac_f32_16x16x64_bf16 v[64:67], v[48:51], a[0:7], v6
s_waitcnt vmcnt(0)
v_max3_u32 v7, v56, v57, v58
v_max_u32 v7, v7, v59
v_smfmac_f32_16x16x64_bf16 v[68:71], v[48:51], a[64:71], v6
v_cmp_eq_u32 vcc, s34, v7
v_smfmac_f32_16x16x64_bf16 v[72:75], v[48:51], a[32:39], v6
v_smfmac_f32_16x16x64_bf16 v[76:79], v[48:51], a[96:103], v6
s_cbranch_vccnz L_q_a_243
s_branch L_v_a_244
L_q_a_287:
buffer_load_dwordx4 v[48:51], v2, s[8:11], s38 offen sc1
s_waitcnt vmcnt(2)
v_max3_u32 v7, v56, v57, v58
v_max_u32 v7, v7, v59
v_cmp_eq_u32 vcc, s34, v7
s_cbranch_vccz L_ok_a_289
buffer_load_dwordx4 v[56:59], v4, s[8:11], s38 offen sc1
s_waitcnt vmcnt(2)
v_max3_u32 v7, v48, v49, v50
v_max_u32 v7, v7, v51
v_cmp_eq_u32 vcc, s34, v7
s_cbranch_vccz L_ok_a_290
s_add_u32 s33, s33, 1
s_cmp_gt_u32 s33, 0x100000
s_cbranch_scc0 L_q_a_287
s_branch chain_kernel_abort
L_ok_a_289:
v_smfmac_f32_16x16x64_bf16 v[64:67], v[56:59], a[16:23], v6
v_smfmac_f32_16x16x64_bf16 v[68:71], v[56:59], a[80:87], v6
v_smfmac_f32_16x16x64_bf16 v[72:75], v[56:59], a[48:55], v6
v_smfmac_f32_16x16x64_bf16 v[76:79], v[56:59], a[112:119], v6
s_branch L_q_a_278
L_ok_a_290:
v_smfmac_f32_16x16x64_bf16 v[64:67], v[48:51], a[0:7], v6
v_smfmac_f32_16x16x64_bf16 v[68:71], v[48:51], a[64:71], v6
v_smfmac_f32_16x16x64_bf16 v[72:75], v[48:51], a[32:39], v6
v_smfmac_f32_16x16x64_bf16 v[76:79], v[48:51], a[96:103], v6
s_branch L_q_a_243
L_q_a_285:
buffer_load_dwordx4 v[60:63], v5, s[8:11], s38 offen sc1
s_waitcnt vmcnt(2)
v_max3_u32 v7, v48, v49, v50
v_max_u32 v7, v7, v51
v_cmp_eq_u32 vcc, s34, v7
s_cbranch_vccnz L_q_a_291
L_v_a_292:
v_smfmac_f32_16x16x64_bf16 v[64:67], v[48:51], a[0:7], v6
s_waitcnt vmcnt(1)
v_max3_u32 v7, v56, v57, v58
v_max_u32 v7, v7, v59
v_smfmac_f32_16x16x64_bf16 v[68:71], v[48:51], a[64:71], v6
v_cmp_eq_u32 vcc, s34, v7
v_smfmac_f32_16x16x64_bf16 v[72:75], v[48:51], a[32:39], v6
v_smfmac_f32_16x16x64_bf16 v[76:79], v[48:51], a[96:103], v6
s_cbranch_vccnz L_q_a_246
s_branch L_v_a_247
L_q_a_291:
buffer_load_dwordx4 v[48:51], v2, s[8:11], s38 offen sc1
s_waitcnt vmcnt(2)
v_max3_u32 v7, v56, v57, v58
v_max_u32 v7, v7, v59
v_cmp_eq_u32 vcc, s34, v7
s_cbranch_vccz L_ok_a_293
buffer_load_dwordx4 v[56:59], v4, s[8:11], s38 offen sc1
s_waitcnt vmcnt(2)
v_max3_u32 v7, v60, v61, v62
v_max_u32 v7, v7, v63
v_cmp_eq_u32 vcc, s34, v7
s_cbranch_vccz L_ok_a_294
buffer_load_dwordx4 v[60:63], v5, s[8:11], s38 offen sc1
s_waitcnt vmcnt(2)
v_max3_u32 v7, v48, v49, v50
v_max_u32 v7, v7, v51
v_cmp_eq_u32 vcc, s34, v7
s_cbranch_vccz L_ok_a_295
s_add_u32 s33, s33, 1
s_cmp_gt_u32 s33, 0x100000
s_cbranch_scc0 L_q_a_291
s_branch chain_kernel_abort
L_ok_a_293:
v_smfmac_f32_16x16x64_bf16 v[64:67], v[56:59], a[16:23], v6
v_smfmac_f32_16x16x64_bf16 v[68:71], v[56:59], a[80:87], v6
v_smfmac_f32_16x16x64_bf16 v[72:75], v[56:59], a[48:55], v6
v_smfmac_f32_16x16x64_bf16 v[76:79], v[56:59], a[112:119], v6
s_branch L_q_a_281
L_ok_a_294:
v_smfmac_f32_16x16x64_bf16 v[64:67], v[60:63], a[24:31], v6
v_smfmac_f32_16x16x64_bf16 v[68:71], v[60:63], a[88:95], v6
v_smfmac_f32_16x16x64_bf16 v[72:75], v[60:63], a[56:63], v6
v_smfmac_f32_16x16x64_bf16 v[76:79], v[60:63], a[120:127], v6
s_branch L_q_a_287
L_ok_a_295:
v_smfmac_f32_16x16x64_bf16 v[64:67], v[48:51], a[0:7], v6
v_smfmac_f32_16x16x64_bf16 v[68:71], v[48:51], a[64:71], v6
v_smfmac_f32_16x16x64_bf16 v[72:75], v[48:51], a[32:39], v6
v_smfmac_f32_16x16x64_bf16 v[76:79], v[48:51], a[96:103], v6
s_branch L_q_a_246
L_q_a_272:
buffer_load_dwordx4 v[52:55], v3, s[8:11], s38 offen sc1
s_waitcnt vmcnt(3)
v_max3_u32 v7, v56, v57, v58
v_max_u32 v7, v7, v59
v_cmp_eq_u32 vcc, s34, v7
s_cbranch_vccnz L_q_a_296
L_v_a_297:
v_smfmac_f32_16x16x64_bf16 v[64:67], v[56:59], a[16:23], v6
s_waitcnt vmcnt(2)
v_max3_u32 v7, v60, v61, v62
v_max_u32 v7, v7, v63
v_smfmac_f32_16x16x64_bf16 v[68:71], v[56:59], a[80:87], v6
v_cmp_eq_u32 vcc, s34, v7
v_smfmac_f32_16x16x64_bf16 v[72:75], v[56:59], a[48:55], v6
v_smfmac_f32_16x16x64_bf16 v[76:79], v[56:59], a[112:119], v6
s_cbranch_vccnz L_q_a_298
L_v_a_299:
v_smfmac_f32_16x16x64_bf16 v[64:67], v[60:63], a[24:31], v6
s_waitcnt vmcnt(1)
v_max3_u32 v7, v48, v49, v50
v_max_u32 v7, v7, v51
v_smfmac_f32_16x16x64_bf16 v[68:71], v[60:63], a[88:95], v6
v_cmp_eq_u32 vcc, s34, v7
v_smfmac_f32_16x16x64_bf16 v[72:75], v[60:63], a[56:63], v6
v_smfmac_f32_16x16x64_bf16 v[76:79], v[60:63], a[120:127], v6
s_cbranch_vccnz L_q_a_300
L_v_a_301:
v_smfmac_f32_16x16x64_bf16 v[64:67], v[48:51], a[0:7], v6
s_waitcnt vmcnt(0)
v_max3_u32 v7, v52, v53, v54
v_max_u32 v7, v7, v55
v_smfmac_f32_16x16x64_bf16 v[68:71], v[48:51], a[64:71], v6
v_cmp_eq_u32 vcc, s34, v7
v_smfmac_f32_16x16x64_bf16 v[72:75], v[48:51], a[32:39], v6
v_smfmac_f32_16x16x64_bf16 v[76:79], v[48:51], a[96:103], v6
s_cbranch_vccnz L_q_a_254
s_branch L_v_a_255
L_q_a_300:
buffer_load_dwordx4 v[48:51], v2, s[8:11], s38 offen sc1
s_waitcnt vmcnt(2)
v_max3_u32 v7, v52, v53, v54
v_max_u32 v7, v7, v55
v_cmp_eq_u32 vcc, s34, v7
s_cbranch_vccz L_ok_a_302
buffer_load_dwordx4 v[52:55], v3, s[8:11], s38 offen sc1
s_waitcnt vmcnt(2)
v_max3_u32 v7, v48, v49, v50
v_max_u32 v7, v7, v51
v_cmp_eq_u32 vcc, s34, v7
s_cbranch_vccz L_ok_a_303
s_add_u32 s33, s33, 1
s_cmp_gt_u32 s33, 0x100000
s_cbranch_scc0 L_q_a_300
s_branch chain_kernel_abort
L_ok_a_302:
v_smfmac_f32_16x16x64_bf16 v[64:67], v[52:55], a[8:15], v6
v_smfmac_f32_16x16x64_bf16 v[68:71], v[52:55], a[72:79], v6
v_smfmac_f32_16x16x64_bf16 v[72:75], v[52:55], a[40:47], v6
v_smfmac_f32_16x16x64_bf16 v[76:79], v[52:55], a[104:111], v6
s_branch L_q_a_278
L_ok_a_303:
v_smfmac_f32_16x16x64_bf16 v[64:67], v[48:51], a[0:7], v6
v_smfmac_f32_16x16x64_bf16 v[68:71], v[48:51], a[64:71], v6
v_smfmac_f32_16x16x64_bf16 v[72:75], v[48:51], a[32:39], v6
v_smfmac_f32_16x16x64_bf16 v[76:79], v[48:51], a[96:103], v6
s_branch L_q_a_254
L_q_a_298:
buffer_load_dwordx4 v[60:63], v5, s[8:11], s38 offen sc1
s_waitcnt vmcnt(2)
v_max3_u32 v7, v48, v49, v50
v_max_u32 v7, v7, v51
v_cmp_eq_u32 vcc, s34, v7
s_cbranch_vccnz L_q_a_304
L_v_a_305:
v_smfmac_f32_16x16x64_bf16 v[64:67], v[48:51], a[0:7], v6
s_waitcnt vmcnt(1)
v_max3_u32 v7, v52, v53, v54
v_max_u32 v7, v7, v55
v_smfmac_f32_16x16x64_bf16 v[68:71], v[48:51], a[64:71], v6
v_cmp_eq_u32 vcc, s34, v7
v_smfmac_f32_16x16x64_bf16 v[72:75], v[48:51], a[32:39], v6
v_smfmac_f32_16x16x64_bf16 v[76:79], v[48:51], a[96:103], v6
s_cbranch_vccnz L_q_a_257
s_branch L_v_a_258
L_q_a_304:
buffer_load_dwordx4 v[48:51], v2, s[8:11], s38 offen sc1
s_waitcnt vmcnt(2)
v_max3_u32 v7, v52, v53, v54
v_max_u32 v7, v7, v55
v_cmp_eq_u32 vcc, s34, v7
s_cbranch_vccz L_ok_a_306
buffer_load_dwordx4 v[52:55], v3, s[8:11], s38 offen sc1
s_waitcnt vmcnt(2)
v_max3_u32 v7, v60, v61, v62
v_max_u32 v7, v7, v63
v_cmp_eq_u32 vcc, s34, v7
s_cbranch_vccz L_ok_a_307
buffer_load_dwordx4 v[60:63], v5, s[8:11], s38 offen sc1
s_waitcnt vmcnt(2)
v_max3_u32 v7, v48, v49, v50
v_max_u32 v7, v7, v51
v_cmp_eq_u32 vcc, s34, v7
s_cbranch_vccz L_ok_a_308
s_add_u32 s33, s33, 1
s_cmp_gt_u32 s33, 0x100000
s_cbranch_scc0 L_q_a_304
s_branch chain_kernel_abort
L_ok_a_306:
v_smfmac_f32_16x16x64_bf16 v[64:67], v[52:55], a[8:15], v6
v_smfmac_f32_16x16x64_bf16 v[68:71], v[52:55], a[72:79], v6
v_smfmac_f32_16x16x64_bf16 v[72:75], v[52:55], a[40:47], v6
v_smfmac_f32_16x16x64_bf16 v[76:79], v[52:55], a[104:111], v6
s_branch L_q_a_281
L_ok_a_307:
v_smfmac_f32_16x16x64_bf16 v[64:67], v[60:63], a[24:31], v6
v_smfmac_f32_16x16x64_bf16 v[68:71], v[60:63], a[88:95], v6
v_smfmac_f32_16x16x64_bf16 v[72:75], v[60:63], a[56:63], v6
v_smfmac_f32_16x16x64_bf16 v[76:79], v[60:63], a[120:127], v6
s_branch L_q_a_300
L_ok_a_308:
v_smfmac_f32_16x16x64_bf16 v[64:67], v[48:51], a[0:7], v6
v_smfmac_f32_16x16x64_bf16 v[68:71], v[48:51], a[64:71], v6
v_smfmac_f32_16x16x64_bf16 v[72:75], v[48:51], a[32:39], v6
v_smfmac_f32_16x16x64_bf16 v[76:79], v[48:51], a[96:103], v6
s_branch L_q_a_257
L_q_a_296:
buffer_load_dwordx4 v[56:59], v4, s[8:11], s38 offen sc1
s_waitcnt vmcnt(3)
v_max3_u32 v7, v60, v61, v62
v_max_u32 v7, v7, v63
v_cmp_eq_u32 vcc, s34, v7
s_cbranch_vccnz L_q_a_309
L_v_a_310:
v_smfmac_f32_16x16x64_bf16 v[64:67], v[60:63], a[24:31], v6
s_waitcnt vmcnt(2)
v_max3_u32 v7, v48, v49, v50
v_max_u32 v7, v7, v51
v_smfmac_f32_16x16x64_bf16 v[68:71], v[60:63], a[88:95], v6
v_cmp_eq_u32 vcc, s34, v7
v_smfmac_f32_16x16x64_bf16 v[72:75], v[60:63], a[56:63], v6
v_smfmac_f32_16x16x64_bf16 v[76:79], v[60:63], a[120:127], v6
s_cbranch_vccnz L_q_a_311
L_v_a_312:
v_smfmac_f32_16x16x64_bf16 v[64:67], v[48:51], a[0:7], v6
s_waitcnt vmcnt(1)
v_max3_u32 v7, v52, v53, v54
v_max_u32 v7, v7, v55
v_smfmac_f32_16x16x64_bf16 v[68:71], v[48:51], a[64:71], v6
v_cmp_eq_u32 vcc, s34, v7
v_smfmac_f32_16x16x64_bf16 v[72:75], v[48:51], a[32:39], v6
v_smfmac_f32_16x16x64_bf16 v[76:79], v[48:51], a[96:103], v6
s_cbranch_vccnz L_q_a_263
s_branch L_v_a_264
L_q_a_311:
buffer_load_dwordx4 v[48:51], v2, s[8:11], s38 offen sc1
s_waitcnt vmcnt(2)
v_max3_u32 v7, v52, v53, v54
v_max_u32 v7, v7, v55
v_cmp_eq_u32 vcc, s34, v7
s_cbranch_vccz L_ok_a_313
buffer_load_dwordx4 v[52:55], v3, s[8:11], s38 offen sc1
s_waitcnt vmcnt(2)
v_max3_u32 v7, v56, v57, v58
v_max_u32 v7, v7, v59
v_cmp_eq_u32 vcc, s34, v7
s_cbranch_vccz L_ok_a_314
buffer_load_dwordx4 v[56:59], v4, s[8:11], s38 offen sc1
s_waitcnt vmcnt(2)
v_max3_u32 v7, v48, v49, v50
v_max_u32 v7, v7, v51
v_cmp_eq_u32 vcc, s34, v7
s_cbranch_vccz L_ok_a_315
s_add_u32 s33, s33, 1
s_cmp_gt_u32 s33, 0x100000
s_cbranch_scc0 L_q_a_311
s_branch chain_kernel_abort
L_ok_a_313:
v_smfmac_f32_16x16x64_bf16 v[64:67], v[52:55], a[8:15], v6
v_smfmac_f32_16x16x64_bf16 v[68:71], v[52:55], a[72:79], v6
v_smfmac_f32_16x16x64_bf16 v[72:75], v[52:55], a[40:47], v6
v_smfmac_f32_16x16x64_bf16 v[76:79], v[52:55], a[104:111], v6
s_branch L_q_a_287
L_ok_a_314:
v_smfmac_f32_16x16x64_bf16 v[64:67], v[56:59], a[16:23], v6
v_smfmac_f32_16x16x64_bf16 v[68:71], v[56:59], a[80:87], v6
v_smfmac_f32_16x16x64_bf16 v[72:75], v[56:59], a[48:55], v6
v_smfmac_f32_16x16x64_bf16 v[76:79], v[56:59], a[112:119], v6
s_branch L_q_a_300
L_ok_a_315:
v_smfmac_f32_16x16x64_bf16 v[64:67], v[48:51], a[0:7], v6
v_smfmac_f32_16x16x64_bf16 v[68:71], v[48:51], a[64:71], v6
v_smfmac_f32_16x16x64_bf16 v[72:75], v[48:51], a[32:39], v6
v_smfmac_f32_16x16x64_bf16 v[76:79], v[48:51], a[96:103], v6
s_branch L_q_a_263
L_q_a_309:
buffer_load_dwordx4 v[60:63], v5, s[8:11], s38 offen sc1
s_waitcnt vmcnt(3)
v_max3_u32 v7, v48, v49, v50
v_max_u32 v7, v7, v51
v_cmp_eq_u32 vcc, s34, v7
s_cbranch_vccnz L_q_a_316
L_v_a_317:
v_smfmac_f32_16x16x64_bf16 v[64:67], v[48:51], a[0:7], v6
s_waitcnt vmcnt(2)
v_max3_u32 v7, v52, v53, v54
v_max_u32 v7, v7, v55
v_smfmac_f32_16x16x64_bf16 v[68:71], v[48:51], a[64:71], v6
v_cmp_eq_u32 vcc, s34, v7
v_smfmac_f32_16x16x64_bf16 v[72:75], v[48:51], a[32:39], v6
v_smfmac_f32_16x16x64_bf16 v[76:79], v[48:51], a[96:103], v6
s_cbranch_vccnz L_q_a_267
s_branch L_v_a_268
L_q_a_316:
buffer_load_dwordx4 v[48:51], v2, s[8:11], s38 offen sc1
s_waitcnt vmcnt(2)
v_max3_u32 v7, v52, v53, v54
v_max_u32 v7, v7, v55
v_cmp_eq_u32 vcc, s34, v7
s_cbranch_vccz L_ok_a_318
buffer_load_dwordx4 v[52:55], v3, s[8:11], s38 offen sc1
s_waitcnt vmcnt(2)
v_max3_u32 v7, v56, v57, v58
v_max_u32 v7, v7, v59
v_cmp_eq_u32 vcc, s34, v7
s_cbranch_vccz L_ok_a_319
buffer_load_dwordx4 v[56:59], v4, s[8:11], s38 offen sc1
s_waitcnt vmcnt(2)
v_max3_u32 v7, v60, v61, v62
v_max_u32 v7, v7, v63
v_cmp_eq_u32 vcc, s34, v7
s_cbranch_vccz L_ok_a_320
buffer_load_dwordx4 v[60:63], v5, s[8:11], s38 offen sc1
s_waitcnt vmcnt(2)
v_max3_u32 v7, v48, v49, v50
v_max_u32 v7, v7, v51
v_cmp_eq_u32 vcc, s34, v7
s_cbranch_vccz L_ok_a_321
s_add_u32 s33, s33, 1
s_cmp_gt_u32 s33, 0x100000
s_cbranch_scc0 L_q_a_316
s_branch chain_kernel_abort
L_ok_a_318:
v_smfmac_f32_16x16x64_bf16 v[64:67], v[52:55], a[8:15], v6
v_smfmac_f32_16x16x64_bf16 v[68:71], v[52:55], a[72:79], v6
v_smfmac_f32_16x16x64_bf16 v[72:75], v[52:55], a[40:47], v6
v_smfmac_f32_16x16x64_bf16 v[76:79], v[52:55], a[104:111], v6
s_branch L_q_a_291
L_ok_a_319:
v_smfmac_f32_16x16x64_bf16 v[64:67], v[56:59], a[16:23], v6
v_smfmac_f32_16x16x64_bf16 v[68:71], v[56:59], a[80:87], v6
v_smfmac_f32_16x16x64_bf16 v[72:75], v[56:59], a[48:55], v6
v_smfmac_f32_16x16x64_bf16 v[76:79], v[56:59], a[112:119], v6
s_branch L_q_a_304
L_ok_a_320:
v_smfmac_f32_16x16x64_bf16 v[64:67], v[60:63], a[24:31], v6
v_smfmac_f32_16x16x64_bf16 v[68:71], v[60:63], a[88:95], v6
v_smfmac_f32_16x16x64_bf16 v[72:75], v[60:63], a[56:63], v6
v_smfmac_f32_16x16x64_bf16 v[76:79], v[60:63], a[120:127], v6
s_branch L_q_a_311
L_ok_a_321:
v_smfmac_f32_16x16x64_bf16 v[64:67], v[48:51], a[0:7], v6
v_smfmac_f32_16x16x64_bf16 v[68:71], v[48:51], a[64:71], v6
v_smfmac_f32_16x16x64_bf16 v[72:75], v[48:51], a[32:39], v6
v_smfmac_f32_16x16x64_bf16 v[76:79], v[48:51], a[96:103], v6
s_branch L_q_a_267
L_cf_329:
L_rt_330:
buffer_load_dwordx4 v[200:203], v16, s[8:11], s40 offen sc1
buffer_load_dwordx4 v[204:207], v13, s[8:11], s40 offen sc1
buffer_load_dwordx4 v[208:211], v14, s[8:11], s40 offen sc1
buffer_load_dwordx4 v[212:215], v15, s[8:11], s40 offen sc1
s_waitcnt vmcnt(7)
v_permlane32_swap_b32 v216, v218
v_permlane32_swap_b32 v217, v219
s_waitcnt vmcnt(6)
v_pk_add_f32 v[154:155], v[216:217], v[218:219]
v_pk_add_f32 v[148:149], v[124:125], v[220:221]
v_pk_add_f32 v[150:151], v[126:127], v[222:223]
v_permlane16_swap_b32 v154, v155
s_waitcnt vmcnt(5)
v_pk_add_f32 v[148:149], v[148:149], v[224:225]
v_pk_add_f32 v[150:151], v[150:151], v[226:227]
v_add_f32 v152, v154, v155
s_waitcnt vmcnt(4)
v_pk_add_f32 v[148:149], v[148:149], v[228:229]
v_pk_add_f32 v[150:151], v[150:151], v[230:231]
v_pk_add_f32 v[154:155], v[148:149], v[150:151]
v_add_f32 v154, v154, v152
v_cmp_u_f32 vcc, v154, v155
s_cbranch_vccz L_cok_328
buffer_load_dwordx4 v[216:219], v16, s[8:11], s40 offen sc1
buffer_load_dwordx4 v[220:223], v13, s[8:11], s40 offen sc1
buffer_load_dwordx4 v[224:227], v14, s[8:11], s40 offen sc1
buffer_load_dwordx4 v[228:231], v15, s[8:11], s40 offen sc1
s_waitcnt vmcnt(7)
v_permlane32_swap_b32 v200, v202
v_permlane32_swap_b32 v201, v203
s_waitcnt vmcnt(6)
v_pk_add_f32 v[154:155], v[200:201], v[202:203]
v_pk_add_f32 v[148:149], v[124:125], v[204:205]
v_pk_add_f32 v[150:151], v[126:127], v[206:207]
v_permlane16_swap_b32 v154, v155
s_waitcnt vmcnt(5)
v_pk_add_f32 v[148:149], v[148:149], v[208:209]
v_pk_add_f32 v[150:151], v[150:151], v[210:211]
v_add_f32 v152, v154, v155
s_waitcnt vmcnt(4)
v_pk_add_f32 v[148:149], v[148:149], v[212:213]
v_pk_add_f32 v[150:151], v[150:151], v[214:215]
v_pk_add_f32 v[154:155], v[148:149], v[150:151]
v_add_f32 v154, v154, v152
v_cmp_u_f32 vcc, v154, v155
s_cbranch_vccz L_cok_328
s_add_u32 s33, s33, 1
s_cmp_gt_u32 s33, 0x100000
s_cbranch_scc1 chain_kernel_abort
s_and_b32 s20, s33, 63
s_cbranch_scc1 L_rt_330
v_cmp_eq_u32 vcc, s34, v200
v_cmp_eq_u32 s[20:21], s34, v201
s_or_b64 vcc, vcc, s[20:21]
v_cmp_eq_u32 s[20:21], s34, v202
s_or_b64 vcc, vcc, s[20:21]
v_cmp_eq_u32 s[20:21], s34, v203
s_or_b64 vcc, vcc, s[20:21]
v_cmp_eq_u32 s[20:21], s34, v204
s_or_b64 vcc, vcc, s[20:21]
v_cmp_eq_u32 s[20:21], s34, v205
s_or_b64 vcc, vcc, s[20:21]
v_cmp_eq_u32 s[20:21], s34, v206
s_or_b64 vcc, vcc, s[20:21]
v_cmp_eq_u32 s[20:21], s34, v207
s_or_b64 vcc, vcc, s[20:21]
v_cmp_eq_u32 s[20:21], s34, v208
s_or_b64 vcc, vcc, s[20:21]
v_cmp_eq_u32 s[20:21], s34, v209
s_or_b64 vcc, vcc, s[20:21]
v_cmp_eq_u32 s[20:21], s34, v210
s_or_b64 vcc, vcc, s[20:21]
v_cmp_eq_u32 s[20:21], s34, v211
s_or_b64 vcc, vcc, s[20:21]
v_cmp_eq_u32 s[20:21], s34, v212
s_or_b64 vcc, vcc, s[20:21]
v_cmp_eq_u32 s[20:21], s34, v213
s_or_b64 vcc, vcc, s[20:21]
v_cmp_eq_u32 s[20:21], s34, v214
s_or_b64 vcc, vcc, s[20:21]
v_cmp_eq_u32 s[20:21], s34, v215
s_or_b64 vcc, vcc, s[20:21]
s_cbranch_vccnz L_rt_330
s_branch L_cok_328
L_cok_328:
v_max3_f32 v154, v148, v149, v150
v_max3_f32 v154, v154, v151, v152
s_nop 1
v_max_f32_dpp v154, v154, v154 row_ror:8 row_mask:0xf bank_mask:0xf
s_branch L_chead_331
L_q_e_339:
buffer_load_dwordx4 v[60:63], v5, s[8:11], s41 offen sc1
s_waitcnt vmcnt(0)
v_max3_u32 v7, v60, v61, v62
v_max_u32 v7, v7, v63
v_cmp_eq_u32 vcc, s34, v7
s_cbranch_vccnz L_q_e_341
s_branch L_v_e_340
L_q_e_341:
buffer_load_dwordx4 v[60:63], v5, s[8:11], s41 offen sc1
s_waitcnt vmcnt(2)
v_max3_u32 v7, v60, v61, v62
v_max_u32 v7, v7, v63
v_cmp_eq_u32 vcc, s34, v7
s_cbranch_vccz L_ok_e_342
s_add_u32 s33, s33, 1
s_cmp_gt_u32 s33, 0x100000
s_cbranch_scc0 L_q_e_341
s_branch chain_kernel_abort
L_ok_e_342:
v_smfmac_f32_16x16x64_bf16 v[88:91], v[60:63], a[216:223], v6
v_smfmac_f32_16x16x64_bf16 v[92:95], v[60:63], a[248:255], v6
s_branch L_gd_e_332
L_q_e_337:
buffer_load_dwordx4 v[56:59], v4, s[8:11], s41 offen sc1
s_waitcnt vmcnt(1)
v_max3_u32 v7, v60, v61, v62
v_max_u32 v7, v7, v63
v_cmp_eq_u32 vcc, s34, v7
s_cbranch_vccnz L_q_e_343
L_v_e_344:
v_smfmac_f32_16x16x64_bf16 v[88:91], v[60:63], a[216:223], v6
s_waitcnt vmcnt(0)
v_max3_u32 v7, v56, v57, v58
v_max_u32 v7, v7, v59
v_cmp_eq_u32 vcc, s34, v7
v_smfmac_f32_16x16x64_bf16 v[92:95], v[60:63], a[248:255], v6
s_cbranch_vccnz L_q_e_345
L_v_e_346:
v_smfmac_f32_16x16x64_bf16 v[88:91], v[56:59], a[208:215], v6
v_smfmac_f32_16x16x64_bf16 v[92:95], v[56:59], a[240:247], v6
s_branch L_gd_e_332
L_q_e_345:
buffer_load_dwordx4 v[56:59], v4, s[8:11], s41 offen sc1
s_waitcnt vmcnt(2)
v_max3_u32 v7, v56, v57, v58
v_max_u32 v7, v7, v59
v_cmp_eq_u32 vcc, s34, v7
s_cbranch_vccz L_ok_e_347
s_add_u32 s33, s33, 1
s_cmp_gt_u32 s33, 0x100000
s_cbranch_scc0 L_q_e_345
s_branch chain_kernel_abort
L_ok_e_347:
v_smfmac_f32_16x16x64_bf16 v[88:91], v[56:59], a[208:215], v6
v_smfmac_f32_16x16x64_bf16 v[92:95], v[56:59], a[240:247], v6
s_branch L_gd_e_332
L_q_e_343:
buffer_load_dwordx4 v[60:63], v5, s[8:11], s41 offen sc1
s_waitcnt vmcnt(1)
v_max3_u32 v7, v56, v57, v58
v_max_u32 v7, v7, v59
v_cmp_eq_u32 vcc, s34, v7
s_cbranch_vccnz L_q_e_348
L_v_e_349:
v_smfmac_f32_16x16x64_bf16 v[88:91], v[56:59], a[208:215], v6
s_waitcnt vmcnt(0)
v_max3_u32 v7, v60, v61, v62
v_max_u32 v7, v7, v63
v_cmp_eq_u32 vcc, s34, v7
v_smfmac_f32_16x16x64_bf16 v[92:95], v[56:59], a[240:247], v6
s_cbranch_vccnz L_q_e_341
s_branch L_v_e_340
L_q_e_348:
buffer_load_dwordx4 v[56:59], v4, s[8:11], s41 offen sc1
s_waitcnt vmcnt(2)
v_max3_u32 v7, v60, v61, v62
v_max_u32 v7, v7, v63
v_cmp_eq_u32 vcc, s34, v7
s_cbranch_vccz L_ok_e_350
buffer_load_dwordx4 v[60:63], v5, s[8:11], s41 offen sc1
s_waitcnt vmcnt(2)
v_max3_u32 v7, v56, v57, v58
v_max_u32 v7, v7, v59
v_cmp_eq_u32 vcc, s34, v7
s_cbranch_vccz L_ok_e_351
s_add_u32 s33, s33, 1
s_cmp_gt_u32 s33, 0x100000
s_cbranch_scc0 L_q_e_348
s_branch chain_kernel_abort
L_ok_e_350:
v_smfmac_f32_16x16x64_bf16 v[88:91], v[60:63], a[216:223], v6
v_smfmac_f32_16x16x64_bf16 v[92:95], v[60:63], a[248:255], v6
s_branch L_q_e_345
L_ok_e_351:
v_smfmac_f32_16x16x64_bf16 v[88:91], v[56:59], a[208:215], v6
v_smfmac_f32_16x16x64_bf16 v[92:95], v[56:59], a[240:247], v6
s_branch L_q_e_341
L_q_e_335:
buffer_load_dwordx4 v[52:55], v3, s[8:11], s41 offen sc1
s_waitcnt vmcnt(2)
v_max3_u32 v7, v56, v57, v58
v_max_u32 v7, v7, v59
v_cmp_eq_u32 vcc, s34, v7
s_cbranch_vccnz L_q_e_352
L_v_e_353:
v_smfmac_f32_16x16x64_bf16 v[88:91], v[56:59], a[208:215], v6
s_waitcnt vmcnt(1)
v_max3_u32 v7, v60, v61, v62
v_max_u32 v7, v7, v63
v_cmp_eq_u32 vcc, s34, v7
v_smfmac_f32_16x16x64_bf16 v[92:95], v[56:59], a[240:247], v6
s_cbranch_vccnz L_q_e_354
L_v_e_355:
v_smfmac_f32_16x16x64_bf16 v[88:91], v[60:63], a[216:223], v6
s_waitcnt vmcnt(0)
v_max3_u32 v7, v52, v53, v54
v_max_u32 v7, v7, v55
v_cmp_eq_u32 vcc, s34, v7
v_smfmac_f32_16x16x64_bf16 v[92:95], v[60:63], a[248:255], v6
s_cbranch_vccnz L_q_e_356
L_v_e_357:
v_smfmac_f32_16x16x64_bf16 v[88:91], v[52:55], a[200:207], v6
v_smfmac_f32_16x16x64_bf16 v[92:95], v[52:55], a[232:239], v6
s_branch L_gd_e_332
L_q_e_356:
buffer_load_dwordx4 v[52:55], v3, s[8:11], s41 offen sc1
s_waitcnt vmcnt(2)
v_max3_u32 v7, v52, v53, v54
v_max_u32 v7, v7, v55
v_cmp_eq_u32 vcc, s34, v7
s_cbranch_vccz L_ok_e_358
s_add_u32 s33, s33, 1
s_cmp_gt_u32 s33, 0x100000
s_cbranch_scc0 L_q_e_356
s_branch chain_kernel_abort
L_ok_e_358:
v_smfmac_f32_16x16x64_bf16 v[88:91], v[52:55], a[200:207], v6
v_smfmac_f32_16x16x64_bf16 v[92:95], v[52:55], a[232:239], v6
s_branch L_gd_e_332
L_q_e_354:
buffer_load_dwordx4 v[60:63], v5, s[8:11], s41 offen sc1
s_waitcnt vmcnt(1)
v_max3_u32 v7, v52, v53, v54
v_max_u32 v7, v7, v55
v_cmp_eq_u32 vcc, s34, v7
s_cbranch_vccnz L_q_e_359
L_v_e_360:
v_smfmac_f32_16x16x64_bf16 v[88:91], v[52:55], a[200:207], v6
s_waitcnt vmcnt(0)
v_max3_u32 v7, v60, v61, v62
v_max_u32 v7, v7, v63
v_cmp_eq_u32 vcc, s34, v7
v_smfmac_f32_16x16x64_bf16 v[92:95], v[52:55], a[232:239], v6
s_cbranch_vccnz L_q_e_341
s_branch L_v_e_340
L_q_e_359:
buffer_load_dwordx4 v[52:55], v3, s[8:11], s41 offen sc1
s_waitcnt vmcnt(2)
v_max3_u32 v7, v60, v61, v62
v_max_u32 v7, v7, v63
v_cmp_eq_u32 vcc, s34, v7
s_cbranch_vccz L_ok_e_361
buffer_load_dwordx4 v[60:63], v5, s[8:11], s41 offen sc1
s_waitcnt vmcnt(2)
v_max3_u32 v7, v52, v53, v54
v_max_u32 v7, v7, v55
v_cmp_eq_u32 vcc, s34, v7
s_cbranch_vccz L_ok_e_362
s_add_u32 s33, s33, 1
s_cmp_gt_u32 s33, 0x100000
s_cbranch_scc0 L_q_e_359
s_branch chain_kernel_abort
L_ok_e_361:
v_smfmac_f32_16x16x64_bf16 v[88:91], v[60:63], a[216:223], v6
v_smfmac_f32_16x16x64_bf16 v[92:95], v[60:63], a[248:255], v6
s_branch L_q_e_356
L_ok_e_362:
v_smfmac_f32_16x16x64_bf16 v[88:91], v[52:55], a[200:207], v6
v_smfmac_f32_16x16x64_bf16 v[92:95], v[52:55], a[232:239], v6
s_branch L_q_e_341
L_q_e_352:
buffer_load_dwordx4 v[56:59], v4, s[8:11], s41 offen sc1
s_waitcnt vmcnt(2)
v_max3_u32 v7, v60, v61, v62
v_max_u32 v7, v7, v63
v_cmp_eq_u32 vcc, s34, v7
s_cbranch_vccnz L_q_e_363
L_v_e_364:
v_smfmac_f32_16x16x64_bf16 v[88:91], v[60:63], a[216:223], v6
s_waitcnt vmcnt(1)
v_max3_u32 v7, v52, v53, v54
v_max_u32 v7, v7, v55
v_cmp_eq_u32 vcc, s34, v7
v_smfmac_f32_16x16x64_bf16 v[92:95], v[60:63], a[248:255], v6
s_cbranch_vccnz L_q_e_365
L_v_e_366:
v_smfmac_f32_16x16x64_bf16 v[88:91], v[52:55], a[200:207], v6
s_waitcnt vmcnt(0)
v_max3_u32 v7, v56, v57, v58
v_max_u32 v7, v7, v59
v_cmp_eq_u32 vcc, s34, v7
v_smfmac_f32_16x16x64_bf16 v[92:95], v[52:55], a[232:239], v6
s_cbranch_vccnz L_q_e_345
s_branch L_v_e_346
L_q_e_365:
buffer_load_dwordx4 v[52:55], v3, s[8:11], s41 offen sc1
s_waitcnt vmcnt(2)
v_max3_u32 v7, v56, v57, v58
v_max_u32 v7, v7, v59
v_cmp_eq_u32 vcc, s34, v7
s_cbranch_vccz L_ok_e_367
buffer_load_dwordx4 v[56:59], v4, s[8:11], s41 offen sc1
s_waitcnt vmcnt(2)
v_max3_u32 v7, v52, v53, v54
v_max_u32 v7, v7, v55
v_cmp_eq_u32 vcc, s34, v7
s_cbranch_vccz L_ok_e_368
s_add_u32 s33, s33, 1
s_cmp_gt_u32 s33, 0x100000
s_cbranch_scc0 L_q_e_365
s_branch chain_kernel_abort
L_ok_e_367:
v_smfmac_f32_16x16x64_bf16 v[88:91], v[56:59], a[208:215], v6
v_smfmac_f32_16x16x64_bf16 v[92:95], v[56:59], a[240:247], v6
s_branch L_q_e_356
L_ok_e_368:
v_smfmac_f32_16x16x64_bf16 v[88:91], v[52:55], a[200:207], v6
v_smfmac_f32_16x16x64_bf16 v[92:95], v[52:55], a[232:239], v6
s_branch L_q_e_345
L_q_e_363:
buffer_load_dwordx4 v[60:63], v5, s[8:11], s41 offen sc1
s_waitcnt vmcnt(2)
v_max3_u32 v7, v52, v53, v54
v_max_u32 v7, v7, v55
v_cmp_eq_u32 vcc, s34, v7
s_cbranch_vccnz L_q_e_369
L_v_e_370:
v_smfmac_f32_16x16x64_bf16 v[88:91], v[52:55], a[200:207], v6
s_waitcnt vmcnt(1)
v_max3_u32 v7, v56, v57, v58
v_max_u32 v7, v7, v59
v_cmp_eq_u32 vcc, s34, v7
v_smfmac_f32_16x16x64_bf16 v[92:95], v[52:55], a[232:239], v6
s_cbranch_vccnz L_q_e_348
s_branch L_v_e_349
L_q_e_369:
buffer_load_dwordx4 v[52:55], v3, s[8:11], s41 offen sc1
s_waitcnt vmcnt(2)
v_max3_u32 v7, v56, v57, v58
v_max_u32 v7, v7, v59
v_cmp_eq_u32 vcc, s34, v7
s_cbranch_vccz L_ok_e_371
buffer_load_dwordx4 v[56:59], v4, s[8:11], s41 offen sc1
s_waitcnt vmcnt(2)
v_max3_u32 v7, v60, v61, v62
v_max_u32 v7, v7, v63
v_cmp_eq_u32 vcc, s34, v7
s_cbranch_vccz L_ok_e_372
buffer_load_dwordx4 v[60:63], v5, s[8:11], s41 offen sc1
s_waitcnt vmcnt(2)
v_max3_u32 v7, v52, v53, v54
v_max_u32 v7, v7, v55
v_cmp_eq_u32 vcc, s34, v7
s_cbranch_vccz L_ok_e_373
s_add_u32 s33, s33, 1
s_cmp_gt_u32 s33, 0x100000
s_cbranch_scc0 L_q_e_369
s_branch chain_kernel_abort
L_ok_e_371:
v_smfmac_f32_16x16x64_bf16 v[88:91], v[56:59], a[208:215], v6
v_smfmac_f32_16x16x64_bf16 v[92:95], v[56:59], a[240:247], v6
s_branch L_q_e_359
L_ok_e_372:
v_smfmac_f32_16x16x64_bf16 v[88:91], v[60:63], a[216:223], v6
v_smfmac_f32_16x16x64_bf16 v[92:95], v[60:63], a[248:255], v6
s_branch L_q_e_365
L_ok_e_373:
v_smfmac_f32_16x16x64_bf16 v[88:91], v[52:55], a[200:207], v6
v_smfmac_f32_16x16x64_bf16 v[92:95], v[52:55], a[232:239], v6
s_branch L_q_e_348
L_q_e_333:
buffer_load_dwordx4 v[48:51], v2, s[8:11], s41 offen sc1
s_waitcnt vmcnt(3)
v_max3_u32 v7, v52, v53, v54
v_max_u32 v7, v7, v55
v_cmp_eq_u32 vcc, s34, v7
s_cbranch_vccnz L_q_e_374
L_v_e_375:
v_smfmac_f32_16x16x64_bf16 v[88:91], v[52:55], a[200:207], v6
s_waitcnt vmcnt(2)
v_max3_u32 v7, v56, v57, v58
v_max_u32 v7, v7, v59
v_cmp_eq_u32 vcc, s34, v7
v_smfmac_f32_16x16x64_bf16 v[92:95], v[52:55], a[232:239], v6
s_cbranch_vccnz L_q_e_376
L_v_e_377:
v_smfmac_f32_16x16x64_bf16 v[88:91], v[56:59], a[208:215], v6
s_waitcnt vmcnt(1)
v_max3_u32 v7, v60, v61, v62
v_max_u32 v7, v7, v63
v_cmp_eq_u32 vcc, s34, v7
v_smfmac_f32_16x16x64_bf16 v[92:95], v[56:59], a[240:247], v6
s_cbranch_vccnz L_q_e_378
L_v_e_379:
v_smfmac_f32_16x16x64_bf16 v[88:91], v[60:63], a[216:223], v6
s_waitcnt vmcnt(0)
v_max3_u32 v7, v48, v49, v50
v_max_u32 v7, v7, v51
v_cmp_eq_u32 vcc, s34, v7
v_smfmac_f32_16x16x64_bf16 v[92:95], v[60:63], a[248:255], v6
s_cbranch_vccnz L_q_e_380
L_v_e_381:
v_smfmac_f32_16x16x64_bf16 v[88:91], v[48:51], a[192:199], v6
v_smfmac_f32_16x16x64_bf16 v[92:95], v[48:51], a[224:231], v6
s_branch L_gd_e_332
L_q_e_380:
buffer_load_dwordx4 v[48:51], v2, s[8:11], s41 offen sc1
s_waitcnt vmcnt(2)
v_max3_u32 v7, v48, v49, v50
v_max_u32 v7, v7, v51
v_cmp_eq_u32 vcc, s34, v7
s_cbranch_vccz L_ok_e_382
s_add_u32 s33, s33, 1
s_cmp_gt_u32 s33, 0x100000
s_cbranch_scc0 L_q_e_380
s_branch chain_kernel_abort
L_ok_e_382:
v_smfmac_f32_16x16x64_bf16 v[88:91], v[48:51], a[192:199], v6
v_smfmac_f32_16x16x64_bf16 v[92:95], v[48:51], a[224:231], v6
s_branch L_gd_e_332
L_q_e_378:
buffer_load_dwordx4 v[60:63], v5, s[8:11], s41 offen sc1
s_waitcnt vmcnt(1)
v_max3_u32 v7, v48, v49, v50
v_max_u32 v7, v7, v51
v_cmp_eq_u32 vcc, s34, v7
s_cbranch_vccnz L_q_e_383
L_v_e_384:
v_smfmac_f32_16x16x64_bf16 v[88:91], v[48:51], a[192:199], v6
s_waitcnt vmcnt(0)
v_max3_u32 v7, v60, v61, v62
v_max_u32 v7, v7, v63
v_cmp_eq_u32 vcc, s34, v7
v_smfmac_f32_16x16x64_bf16 v[92:95], v[48:51], a[224:231], v6
s_cbranch_vccnz L_q_e_341
s_branch L_v_e_340
L_q_e_383:
buffer_load_dwordx4 v[48:51], v2, s[8:11], s41 offen sc1
s_waitcnt vmcnt(2)
v_max3_u32 v7, v60, v61, v62
v_max_u32 v7, v7, v63
v_cmp_eq_u32 vcc, s34, v7
s_cbranch_vccz L_ok_e_385
buffer_load_dwordx4 v[60:63], v5, s[8:11], s41 offen sc1
s_waitcnt vmcnt(2)
v_max3_u32 v7, v48, v49, v50
v_max_u32 v7, v7, v51
v_cmp_eq_u32 vcc, s34, v7
s_cbranch_vccz L_ok_e_386
s_add_u32 s33, s33, 1
s_cmp_gt_u32 s33, 0x100000
s_cbranch_scc0 L_q_e_383
s_branch chain_kernel_abort
L_ok_e_385:
v_smfmac_f32_16x16x64_bf16 v[88:91], v[60:63], a[216:223], v6
v_smfmac_f32_16x16x64_bf16 v[92:95], v[60:63], a[248:255], v6
s_branch L_q_e_380
L_ok_e_386:
v_smfmac_f32_16x16x64_bf16 v[88:91], v[48:51], a[192:199], v6
v_smfmac_f32_16x16x64_bf16 v[92:95], v[48:51], a[224:231], v6
s_branch L_q_e_341
L_q_e_376:
buffer_load_dwordx4 v[56:59], v4, s[8:11], s41 offen sc1
s_waitcnt vmcnt(2)
v_max3_u32 v7, v60, v61, v62
v_max_u32 v7, v7, v63
v_cmp_eq_u32 vcc, s34, v7
s_cbranch_vccnz L_q_e_387
L_v_e_388:
v_smfmac_f32_16x16x64_bf16 v[88:91], v[60:63], a[216:223], v6
s_waitcnt vmcnt(1)
v_max3_u32 v7, v48, v49, v50
v_max_u32 v7, v7, v51
v_cmp_eq_u32 vcc, s34, v7
v_smfmac_f32_16x16x64_bf16 v[92:95], v[60:63], a[248:255], v6
s_cbranch_vccnz L_q_e_389
L_v_e_390:
v_smfmac_f32_16x16x64_bf16 v[88:91], v[48:51], a[192:199], v6
s_waitcnt vmcnt(0)
v_max3_u32 v7, v56, v57, v58
v_max_u32 v7, v7, v59
v_cmp_eq_u32 vcc, s34, v7
v_smfmac_f32_16x16x64_bf16 v[92:95], v[48:51], a[224:231], v6
s_cbranch_vccnz L_q_e_345
s_branch L_v_e_346
L_q_e_389:
buffer_load_dwordx4 v[48:51], v2, s[8:11], s41 offen sc1
s_waitcnt vmcnt(2)
v_max3_u32 v7, v56, v57, v58
v_max_u32 v7, v7, v59
v_cmp_eq_u32 vcc, s34, v7
s_cbranch_vccz L_ok_e_391
buffer_load_dwordx4 v[56:59], v4, s[8:11], s41 offen sc1
s_waitcnt vmcnt(2)
v_max3_u32 v7, v48, v49, v50
v_max_u32 v7, v7, v51
v_cmp_eq_u32 vcc, s34, v7
s_cbranch_vccz L_ok_e_392
s_add_u32 s33, s33, 1
s_cmp_gt_u32 s33, 0x100000
s_cbranch_scc0 L_q_e_389
s_branch chain_kernel_abort
L_ok_e_391:
v_smfmac_f32_16x16x64_bf16 v[88:91], v[56:59], a[208:215], v6
v_smfmac_f32_16x16x64_bf16 v[92:95], v[56:59], a[240:247], v6
s_branch L_q_e_380
L_ok_e_392:
v_smfmac_f32_16x16x64_bf16 v[88:91], v[48:51], a[192:199], v6
v_smfmac_f32_16x16x64_bf16 v[92:95], v[48:51], a[224:231], v6
s_branch L_q_e_345
L_q_e_387:
buffer_load_dwordx4 v[60:63], v5, s[8:11], s41 offen sc1
s_waitcnt vmcnt(2)
v_max3_u32 v7, v48, v49, v50
v_max_u32 v7, v7, v51
v_cmp_eq_u32 vcc, s34, v7
s_cbranch_vccnz L_q_e_393
L_v_e_394:
v_smfmac_f32_16x16x64_bf16 v[88:91], v[48:51], a[192:199], v6
s_waitcnt vmcnt(1)
v_max3_u32 v7, v56, v57, v58
v_max_u32 v7, v7, v59
v_cmp_eq_u32 vcc, s34, v7
v_smfmac_f32_16x16x64_bf16 v[92:95], v[48:51], a[224:231], v6
s_cbranch_vccnz L_q_e_348
s_branch L_v_e_349
L_q_e_393:
buffer_load_dwordx4 v[48:51], v2, s[8:11], s41 offen sc1
s_waitcnt vmcnt(2)
v_max3_u32 v7, v56, v57, v58
v_max_u32 v7, v7, v59
v_cmp_eq_u32 vcc, s34, v7
s_cbranch_vccz L_ok_e_395
buffer_load_dwordx4 v[56:59], v4, s[8:11], s41 offen sc1
s_waitcnt vmcnt(2)
v_max3_u32 v7, v60, v61, v62
v_max_u32 v7, v7, v63
v_cmp_eq_u32 vcc, s34, v7
s_cbranch_vccz L_ok_e_396
buffer_load_dwordx4 v[60:63], v5, s[8:11], s41 offen sc1
s_waitcnt vmcnt(2)
v_max3_u32 v7, v48, v49, v50
v_max_u32 v7, v7, v51
v_cmp_eq_u32 vcc, s34, v7
s_cbranch_vccz L_ok_e_397
s_add_u32 s33, s33, 1
s_cmp_gt_u32 s33, 0x100000
s_cbranch_scc0 L_q_e_393
s_branch chain_kernel_abort
L_ok_e_395:
v_smfmac_f32_16x16x64_bf16 v[88:91], v[56:59], a[208:215], v6
v_smfmac_f32_16x16x64_bf16 v[92:95], v[56:59], a[240:247], v6
s_branch L_q_e_383
L_ok_e_396:
v_smfmac_f32_16x16x64_bf16 v[88:91], v[60:63], a[216:223], v6
v_smfmac_f32_16x16x64_bf16 v[92:95], v[60:63], a[248:255], v6
s_branch L_q_e_389
L_ok_e_397:
v_smfmac_f32_16x16x64_bf16 v[88:91], v[48:51], a[192:199], v6
v_smfmac_f32_16x16x64_bf16 v[92:95], v[48:51], a[224:231], v6
s_branch L_q_e_348
L_q_e_374:
buffer_load_dwordx4 v[52:55], v3, s[8:11], s41 offen sc1
s_waitcnt vmcnt(3)
v_max3_u32 v7, v56, v57, v58
v_max_u32 v7, v7, v59
v_cmp_eq_u32 vcc, s34, v7
s_cbranch_vccnz L_q_e_398
L_v_e_399:
v_smfmac_f32_16x16x64_bf16 v[88:91], v[56:59], a[208:215], v6
s_waitcnt vmcnt(2)
v_max3_u32 v7, v60, v61, v62
v_max_u32 v7, v7, v63
v_cmp_eq_u32 vcc, s34, v7
v_smfmac_f32_16x16x64_bf16 v[92:95], v[56:59], a[240:247], v6
s_cbranch_vccnz L_q_e_400
L_v_e_401:
v_smfmac_f32_16x16x64_bf16 v[88:91], v[60:63], a[216:223], v6
s_waitcnt vmcnt(1)
v_max3_u32 v7, v48, v49, v50
v_max_u32 v7, v7, v51
v_cmp_eq_u32 vcc, s34, v7
v_smfmac_f32_16x16x64_bf16 v[92:95], v[60:63], a[248:255], v6
s_cbranch_vccnz L_q_e_402
L_v_e_403:
v_smfmac_f32_16x16x64_bf16 v[88:91], v[48:51], a[192:199], v6
s_waitcnt vmcnt(0)
v_max3_u32 v7, v52, v53, v54
v_max_u32 v7, v7, v55
v_cmp_eq_u32 vcc, s34, v7
v_smfmac_f32_16x16x64_bf16 v[92:95], v[48:51], a[224:231], v6
s_cbranch_vccnz L_q_e_356
s_branch L_v_e_357
L_q_e_402:
buffer_load_dwordx4 v[48:51], v2, s[8:11], s41 offen sc1
s_waitcnt vmcnt(2)
v_max3_u32 v7, v52, v53, v54
v_max_u32 v7, v7, v55
v_cmp_eq_u32 vcc, s34, v7
s_cbranch_vccz L_ok_e_404
buffer_load_dwordx4 v[52:55], v3, s[8:11], s41 offen sc1
s_waitcnt vmcnt(2)
v_max3_u32 v7, v48, v49, v50
v_max_u32 v7, v7, v51
v_cmp_eq_u32 vcc, s34, v7
s_cbranch_vccz L_ok_e_405
s_add_u32 s33, s33, 1
s_cmp_gt_u32 s33, 0x100000
s_cbranch_scc0 L_q_e_402
s_branch chain_kernel_abort
L_ok_e_404:
v_smfmac_f32_16x16x64_bf16 v[88:91], v[52:55], a[200:207], v6
v_smfmac_f32_16x16x64_bf16 v[92:95], v[52:55], a[232:239], v6
s_branch L_q_e_380
L_ok_e_405:
v_smfmac_f32_16x16x64_bf16 v[88:91], v[48:51], a[192:199], v6
v_smfmac_f32_16x16x64_bf16 v[92:95], v[48:51], a[224:231], v6
s_branch L_q_e_356
L_q_e_400:
buffer_load_dwordx4 v[60:63], v5, s[8:11], s41 offen sc1
s_waitcnt vmcnt(2)
v_max3_u32 v7, v48, v49, v50
v_max_u32 v7, v7, v51
v_cmp_eq_u32 vcc, s34, v7
s_cbranch_vccnz L_q_e_406
L_v_e_407:
v_smfmac_f32_16x16x64_bf16 v[88:91], v[48:51], a[192:199], v6
s_waitcnt vmcnt(1)
v_max3_u32 v7, v52, v53, v54
v_max_u32 v7, v7, v55
v_cmp_eq_u32 vcc, s34, v7
v_smfmac_f32_16x16x64_bf16 v[92:95], v[48:51], a[224:231], v6
s_cbranch_vccnz L_q_e_359
s_branch L_v_e_360
L_q_e_406:
buffer_load_dwordx4 v[48:51], v2, s[8:11], s41 offen sc1
s_waitcnt vmcnt(2)
v_max3_u32 v7, v52, v53, v54
v_max_u32 v7, v7, v55
v_cmp_eq_u32 vcc, s34, v7
s_cbranch_vccz L_ok_e_408
buffer_load_dwordx4 v[52:55], v3, s[8:11], s41 offen sc1
s_waitcnt vmcnt(2)
v_max3_u32 v7, v60, v61, v62
v_max_u32 v7, v7, v63
v_cmp_eq_u32 vcc, s34, v7
s_cbranch_vccz L_ok_e_409
buffer_load_dwordx4 v[60:63], v5, s[8:11], s41 offen sc1
s_waitcnt vmcnt(2)
v_max3_u32 v7, v48, v49, v50
v_max_u32 v7, v7, v51
v_cmp_eq_u32 vcc, s34, v7
s_cbranch_vccz L_ok_e_410
s_add_u32 s33, s33, 1
s_cmp_gt_u32 s33, 0x100000
s_cbranch_scc0 L_q_e_406
s_branch chain_kernel_abort
L_ok_e_408:
v_smfmac_f32_16x16x64_bf16 v[88:91], v[52:55], a[200:207], v6
v_smfmac_f32_16x16x64_bf16 v[92:95], v[52:55], a[232:239], v6
s_branch L_q_e_383
L_ok_e_409:
v_smfmac_f32_16x16x64_bf16 v[88:91], v[60:63], a[216:223], v6
v_smfmac_f32_16x16x64_bf16 v[92:95], v[60:63], a[248:255], v6
s_branch L_q_e_402
L_ok_e_410:
v_smfmac_f32_16x16x64_bf16 v[88:91], v[48:51], a[192:199], v6
v_smfmac_f32_16x16x64_bf16 v[92:95], v[48:51], a[224:231], v6
s_branch L_q_e_359
L_q_e_398:
buffer_load_dwordx4 v[56:59], v4, s[8:11], s41 offen sc1
s_waitcnt vmcnt(3)
v_max3_u32 v7, v60, v61, v62
v_max_u32 v7, v7, v63
v_cmp_eq_u32 vcc, s34, v7
s_cbranch_vccnz L_q_e_411
L_v_e_412:
v_smfmac_f32_16x16x64_bf16 v[88:91], v[60:63], a[216:223], v6
s_waitcnt vmcnt(2)
v_max3_u32 v7, v48, v49, v50
v_max_u32 v7, v7, v51
v_cmp_eq_u32 vcc, s34, v7
v_smfmac_f32_16x16x64_bf16 v[92:95], v[60:63], a[248:255], v6
s_cbranch_vccnz L_q_e_413
L_v_e_414:
v_smfmac_f32_16x16x64_bf16 v[88:91], v[48:51], a[192:199], v6
s_waitcnt vmcnt(1)
v_max3_u32 v7, v52, v53, v54
v_max_u32 v7, v7, v55
v_cmp_eq_u32 vcc, s34, v7
v_smfmac_f32_16x16x64_bf16 v[92:95], v[48:51], a[224:231], v6
s_cbranch_vccnz L_q_e_365
s_branch L_v_e_366
L_q_e_413:
buffer_load_dwordx4 v[48:51], v2, s[8:11], s41 offen sc1
s_waitcnt vmcnt(2)
v_max3_u32 v7, v52, v53, v54
v_max_u32 v7, v7, v55
v_cmp_eq_u32 vcc, s34, v7
s_cbranch_vccz L_ok_e_415
buffer_load_dwordx4 v[52:55], v3, s[8:11], s41 offen sc1
s_waitcnt vmcnt(2)
v_max3_u32 v7, v56, v57, v58
v_max_u32 v7, v7, v59
v_cmp_eq_u32 vcc, s34, v7
s_cbranch_vccz L_ok_e_416
buffer_load_dwordx4 v[56:59], v4, s[8:11], s41 offen sc1
s_waitcnt vmcnt(2)
v_max3_u32 v7, v48, v49, v50
v_max_u32 v7, v7, v51
v_cmp_eq_u32 vcc, s34, v7
s_cbranch_vccz L_ok_e_417
s_add_u32 s33, s33, 1
s_cmp_gt_u32 s33, 0x100000
s_cbranch_scc0 L_q_e_413
s_branch chain_kernel_abort
L_ok_e_415:
v_smfmac_f32_16x16x64_bf16 v[88:91], v[52:55], a[200:207], v6
v_smfmac_f32_16x16x64_bf16 v[92:95], v[52:55], a[232:239], v6
s_branch L_q_e_389
L_ok_e_416:
v_smfmac_f32_16x16x64_bf16 v[88:91], v[56:59], a[208:215], v6
v_smfmac_f32_16x16x64_bf16 v[92:95], v[56:59], a[240:247], v6
s_branch L_q_e_402
L_ok_e_417:
v_smfmac_f32_16x16x64_bf16 v[88:91], v[48:51], a[192:199], v6
v_smfmac_f32_16x16x64_bf16 v[92:95], v[48:51], a[224:231], v6
s_branch L_q_e_365
L_q_e_411:
buffer_load_dwordx4 v[60:63], v5, s[8:11], s41 offen sc1
s_waitcnt vmcnt(3)
v_max3_u32 v7, v48, v49, v50
v_max_u32 v7, v7, v51
v_cmp_eq_u32 vcc, s34, v7
s_cbranch_vccnz L_q_e_418
L_v_e_419:
v_smfmac_f32_16x16x64_bf16 v[88:91], v[48:51], a[192:199], v6
s_waitcnt vmcnt(2)
v_max3_u32 v7, v52, v53, v54
v_max_u32 v7, v7, v55
v_cmp_eq_u32 vcc, s34, v7
v_smfmac_f32_16x16x64_bf16 v[92:95], v[48:51], a[224:231], v6
s_cbranch_vccnz L_q_e_369
s_branch L_v_e_370
L_q_e_418:
buffer_load_dwordx4 v[48:51], v2, s[8:11], s41 offen sc1
s_waitcnt vmcnt(2)
v_max3_u32 v7, v52, v53, v54
v_max_u32 v7, v7, v55
v_cmp_eq_u32 vcc, s34, v7
s_cbranch_vccz L_ok_e_420
buffer_load_dwordx4 v[52:55], v3, s[8:11], s41 offen sc1
s_waitcnt vmcnt(2)
v_max3_u32 v7, v56, v57, v58
v_max_u32 v7, v7, v59
v_cmp_eq_u32 vcc, s34, v7
s_cbranch_vccz L_ok_e_421
buffer_load_dwordx4 v[56:59], v4, s[8:11], s41 offen sc1
s_waitcnt vmcnt(2)
v_max3_u32 v7, v60, v61, v62
v_max_u32 v7, v7, v63
v_cmp_eq_u32 vcc, s34, v7
s_cbranch_vccz L_ok_e_422
buffer_load_dwordx4 v[60:63], v5, s[8:11], s41 offen sc1
s_waitcnt vmcnt(2)
v_max3_u32 v7, v48, v49, v50
v_max_u32 v7, v7, v51
v_cmp_eq_u32 vcc, s34, v7
s_cbranch_vccz L_ok_e_423
s_add_u32 s33, s33, 1
s_cmp_gt_u32 s33, 0x100000
s_cbranch_scc0 L_q_e_418
s_branch chain_kernel_abort
L_ok_e_420:
v_smfmac_f32_16x16x64_bf16 v[88:91], v[52:55], a[200:207], v6
v_smfmac_f32_16x16x64_bf16 v[92:95], v[52:55], a[232:239], v6
s_branch L_q_e_393
L_ok_e_421:
v_smfmac_f32_16x16x64_bf16 v[88:91], v[56:59], a[208:215], v6
v_smfmac_f32_16x16x64_bf16 v[92:95], v[56:59], a[240:247], v6
s_branch L_q_e_406
L_ok_e_422:
v_smfmac_f32_16x16x64_bf16 v[88:91], v[60:63], a[216:223], v6
v_smfmac_f32_16x16x64_bf16 v[92:95], v[60:63], a[248:255], v6
s_branch L_q_e_413
L_ok_e_423:
v_smfmac_f32_16x16x64_bf16 v[88:91], v[48:51], a[192:199], v6
v_smfmac_f32_16x16x64_bf16 v[92:95], v[48:51], a[224:231], v6
s_branch L_q_e_369
L_gf_424:
s_waitcnt vmcnt(4)
v_lshlrev_b32 v100, 16, v212
v_and_b32 v101, 0xffff0000, v212
v_lshlrev_b32 v102, 16, v213
v_and_b32 v103, 0xffff0000, v213
v_pk_add_f32 v[148:149], v[168:169], v[100:101]
v_pk_add_f32 v[150:151], v[170:171], v[102:103]
s_waitcnt vmcnt(3)
v_lshlrev_b32 v100, 16, v214
v_and_b32 v101, 0xffff0000, v214
v_lshlrev_b32 v102, 16, v215
v_and_b32 v103, 0xffff0000, v215
v_pk_add_f32 v[148:149], v[148:149], v[100:101]
v_pk_add_f32 v[150:151], v[150:151], v[102:103]
s_waitcnt vmcnt(2)
v_lshlrev_b32 v100, 16, v216
v_and_b32 v101, 0xffff0000, v216
v_lshlrev_b32 v102, 16, v217
v_and_b32 v103, 0xffff0000, v217
v_pk_add_f32 v[148:149], v[148:149], v[100:101]
v_pk_add_f32 v[150:151], v[150:151], v[102:103]
v_cmp_u_f32 vcc, v148, v150
v_cvt_pk_bf16_f32 v180, v148, v149
v_cvt_pk_bf16_f32 v181, v150, v151
s_cbranch_vccz L_gok_425
buffer_load_dwordx2 v[212:213], v17, s[8:11], s22 offen offset:512 sc1
buffer_load_dwordx2 v[214:215], v18, s[8:11], s22 offen offset:512 sc1
buffer_load_dwordx2 v[216:217], v19, s[8:11], s22 offen offset:512 sc1
s_nop 11
L_rt_427:
buffer_load_dwordx2 v[200:201], v17, s[8:11], s22 offen offset:0 sc1
buffer_load_dwordx2 v[202:203], v18, s[8:11], s22 offen offset:0 sc1
buffer_load_dwordx2 v[204:205], v19, s[8:11], s22 offen offset:0 sc1
s_waitcnt vmcnt(5)
v_lshlrev_b32 v100, 16, v212
v_and_b32 v101, 0xffff0000, v212
v_lshlrev_b32 v102, 16, v213
v_and_b32 v103, 0xffff0000, v213
v_pk_add_f32 v[148:149], v[168:169], v[100:101]
v_pk_add_f32 v[150:151], v[170:171], v[102:103]
s_waitcnt vmcnt(4)
v_lshlrev_b32 v100, 16, v214
v_and_b32 v101, 0xffff0000, v214
v_lshlrev_b32 v102, 16, v215
v_and_b32 v103, 0xffff0000, v215
v_pk_add_f32 v[148:149], v[148:149], v[100:101]
v_pk_add_f32 v[150:151], v[150:151], v[102:103]
s_waitcnt vmcnt(3)
v_lshlrev_b32 v100, 16, v216
v_and_b32 v101, 0xffff0000, v216
v_lshlrev_b32 v102, 16, v217
v_and_b32 v103, 0xffff0000, v217
v_pk_add_f32 v[148:149], v[148:149], v[100:101]
v_pk_add_f32 v[150:151], v[150:151], v[102:103]
v_cmp_u_f32 vcc, v148, v150
v_cvt_pk_bf16_f32 v180, v148, v149
v_cvt_pk_bf16_f32 v181, v150, v151
s_cbranch_vccz L_gok_425
buffer_load_dwordx2 v[212:213], v17, s[8:11], s22 offen offset:512 sc1
buffer_load_dwordx2 v[214:215], v18, s[8:11], s22 offen offset:512 sc1
buffer_load_dwordx2 v[216:217], v19, s[8:11], s22 offen offset:512 sc1
s_waitcnt vmcnt(5)
v_lshlrev_b32 v100, 16, v200
v_and_b32 v101, 0xffff0000, v200
v_lshlrev_b32 v102, 16, v201
v_and_b32 v103, 0xffff0000, v201
v_pk_add_f32 v[148:149], v[168:169], v[100:101]
v_pk_add_f32 v[150:151], v[170:171], v[102:103]
s_waitcnt vmcnt(4)
v_lshlrev_b32 v100, 16, v202
v_and_b32 v101, 0xffff0000, v202
v_lshlrev_b32 v102, 16, v203
v_and_b32 v103, 0xffff0000, v203
v_pk_add_f32 v[148:149], v[148:149], v[100:101]
v_pk_add_f32 v[150:151], v[150:151], v[102:103]
s_waitcnt vmcnt(3)
v_lshlrev_b32 v100, 16, v204
v_and_b32 v101, 0xffff0000, v204
v_lshlrev_b32 v102, 16, v205
v_and_b32 v103, 0xffff0000, v205
v_pk_add_f32 v[148:149], v[148:149], v[100:101]
v_pk_add_f32 v[150:151], v[150:151], v[102:103]
v_cmp_u_f32 vcc, v148, v150
v_cvt_pk_bf16_f32 v180, v148, v149
v_cvt_pk_bf16_f32 v181, v150, v151
s_cbranch_vccz L_gok_425
s_add_u32 s33, s33, 1
s_cmp_gt_u32 s33, 0x100000
s_cbranch_scc1 chain_kernel_abort
s_and_b32 s20, s33, 63
s_cbranch_scc1 L_rt_427
v_cmp_eq_u32 vcc, s34, v200
v_cmp_eq_u32 s[20:21], s34, v201
s_or_b64 vcc, vcc, s[20:21]
v_cmp_eq_u32 s[20:21], s34, v202
s_or_b64 vcc, vcc, s[20:21]
v_cmp_eq_u32 s[20:21], s34, v203
s_or_b64 vcc, vcc, s[20:21]
v_cmp_eq_u32 s[20:21], s34, v204
s_or_b64 vcc, vcc, s[20:21]
v_cmp_eq_u32 s[20:21], s34, v205
s_or_b64 vcc, vcc, s[20:21]
s_cbranch_vccnz L_rt_427
s_branch L_gok_425
chain_kernel_abort:
s_mov_b64 exec, 1
v_mov_b32 v1, s19
v_or_b32 v1, 0xdead0000, v1
v_mov_b32 v2, 124
buffer_store_dword v1, v2, s[12:15], 0 offen
chain_kernel_done:
s_endpgm
chain_kernel_worker:
s_sub_u32 s40, s16, 4
s_lshl_b32 s40, s40, 2
s_lshr_b32 s40, 0x3210, s40
s_and_b32 s40, s40, 3
s_mov_b32 s41, s17
s_mov_b32 s49, s18
s_mov_b32 s12, s100
s_and_b32 s13, s101, 0xffff
s_mov_b32 s14, 0x10000000
s_mov_b32 s15, 0x00020000
s_mov_b32 s36, 0
v_mov_b32 v84, 1
v_min_u32 v85, 1, v0
v_lshlrev_b32 v85, 30, v85
s_cmp_eq_u32 s40, 3
s_cbranch_scc1 L_g1_433
s_mov_b32 s25, s40
s_cmp_eq_u32 s25, 1
s_cselect_b32 s16, s90, s88
s_cselect_b32 s17, s91, s89
s_cmp_eq_u32 s25, 2
s_cselect_b32 s16, s86, s16
s_cselect_b32 s17, s87, s17
s_and_b32 s17, s17, 0xffff
s_mov_b32 s18, 0x800000
s_mov_b32 s19, 0x00020000
s_mov_b32 s46, s41
s_lshl_b32 s44, s46, 8
s_mov_b32 s8, s82
s_and_b32 s9, s83, 0xffff
s_mov_b32 s10, 0x400000
s_mov_b32 s11, 0x00020000
v_lshlrev_b32 v1, 4, v0
s_lshl_b32 s25, s41, 12
buffer_load_dwordx4 v[52:55], v1, s[8:11], s25 offen
s_add_u32 s25, s25, 131072
buffer_load_dwordx4 v[52:55], v1, s[8:11], s25 offen
s_add_u32 s25, s25, 131072
v_and_b32 v1, 15, v0
v_bfe_u32 v2, v0, 4, 2
v_lshrrev_b32 v3, 6, v0
v_lshlrev_b32 v4, 2, v2
v_xor_b32 v4, v4, v1
v_lshlrev_b32 v4, 4, v4
v_lshl_add_u32 v5, v3, 5, v2
s_mov_b32 s25, 8192
v_mul_lo_u32 v5, v5, s25
v_add_u32 v20, v5, v4
v_bfe_u32 v4, v0, 2, 2
v_lshl_add_u32 v5, v2, 3, v4
v_lshlrev_b32 v5, 8, v5
v_xor_b32 v4, v4, v3
v_lshl_add_u32 v5, v4, 6, v5
v_and_b32 v4, 3, v0
v_lshl_add_u32 v5, v4, 3, v5
v_and_b32 v4, 2, v4
v_lshl_add_u32 v21, v4, 3, v5
v_add_u32 v22, 16, v21
v_add_u32 v23, 0x10000, v21
v_add_u32 v24, 0x10000, v22
s_lshl_b32 s26, s49, 13
s_mov_b32 s25, s44
s_barrier
s_add_u32 m0, s26, 0
s_add_u32 s27, s25, 0
buffer_load_dwordx4 v20, s[16:19], s27 offen lds
s_add_u32 m0, s26, 1024
s_add_u32 s27, s25, 32768
buffer_load_dwordx4 v20, s[16:19], s27 offen lds
s_add_u32 m0, s26, 2048
s_add_u32 s27, s25, 65536
buffer_load_dwordx4 v20, s[16:19], s27 offen lds
s_add_u32 m0, s26, 3072
s_add_u32 s27, s25, 98304
buffer_load_dwordx4 v20, s[16:19], s27 offen lds
s_add_u32 m0, s26, 4096
s_add_u32 s27, s25, 131072
buffer_load_dwordx4 v20, s[16:19], s27 offen lds
s_add_u32 m0, s26, 5120
s_add_u32 s27, s25, 163840
buffer_load_dwordx4 v20, s[16:19], s27 offen lds
s_add_u32 m0, s26, 6144
s_add_u32 s27, s25, 196608
buffer_load_dwordx4 v20, s[16:19], s27 offen lds
s_add_u32 m0, s26, 7168
s_add_u32 s27, s25, 229376
buffer_load_dwordx4 v20, s[16:19], s27 offen lds
s_add_u32 m0, s26, 32768
s_add_u32 s27, s25, 1048576
buffer_load_dwordx4 v20, s[16:19], s27 offen lds
s_add_u32 m0, s26, 33792
s_add_u32 s27, s25, 1081344
buffer_load_dwordx4 v20, s[16:19], s27 offen lds
s_add_u32 m0, s26, 34816
s_add_u32 s27, s25, 1114112
buffer_load_dwordx4 v20, s[16:19], s27 offen lds
s_add_u32 m0, s26, 35840
s_add_u32 s27, s25, 1146880
buffer_load_dwordx4 v20, s[16:19], s27 offen lds
s_add_u32 m0, s26, 36864
s_add_u32 s27, s25, 1179648
buffer_load_dwordx4 v20, s[16:19], s27 offen lds
s_add_u32 m0, s26, 37888
s_add_u32 s27, s25, 1212416
buffer_load_dwordx4 v20, s[16:19], s27 offen lds
s_add_u32 m0, s26, 38912
s_add_u32 s27, s25, 1245184
buffer_load_dwordx4 v20, s[16:19], s27 offen lds
s_add_u32 m0, s26, 39936
s_add_u32 s27, s25, 1277952
buffer_load_dwordx4 v20, s[16:19], s27 offen lds
s_add_u32 m0, s26, 65536
s_add_u32 s27, s25, 2097152
buffer_load_dwordx4 v20, s[16:19], s27 offen lds
s_add_u32 m0, s26, 66560
s_add_u32 s27, s25, 2129920
buffer_load_dwordx4 v20, s[16:19], s27 offen lds
s_add_u32 m0, s26, 67584
s_add_u32 s27, s25, 2162688
buffer_load_dwordx4 v20, s[16:19], s27 offen lds
s_add_u32 m0, s26, 68608
s_add_u32 s27, s25, 2195456
buffer_load_dwordx4 v20, s[16:19], s27 offen lds
s_add_u32 m0, s26, 69632
s_add_u32 s27, s25, 2228224
buffer_load_dwordx4 v20, s[16:19], s27 offen lds
s_add_u32 m0, s26, 70656
s_add_u32 s27, s25, 2260992
buffer_load_dwordx4 v20, s[16:19], s27 offen lds
s_add_u32 m0, s26, 71680
s_add_u32 s27, s25, 2293760
buffer_load_dwordx4 v20, s[16:19], s27 offen lds
s_add_u32 m0, s26, 72704
s_add_u32 s27, s25, 2326528
buffer_load_dwordx4 v20, s[16:19], s27 offen lds
s_add_u32 m0, s26, 98304
s_add_u32 s27, s25, 3145728
buffer_load_dwordx4 v20, s[16:19], s27 offen lds
s_add_u32 m0, s26, 99328
s_add_u32 s27, s25, 3178496
buffer_load_dwordx4 v20, s[16:19], s27 offen lds
s_add_u32 m0, s26, 100352
s_add_u32 s27, s25, 3211264
buffer_load_dwordx4 v20, s[16:19], s27 offen lds
s_add_u32 m0, s26, 101376
s_add_u32 s27, s25, 3244032
buffer_load_dwordx4 v20, s[16:19], s27 offen lds
s_add_u32 m0, s26, 102400
s_add_u32 s27, s25, 3276800
buffer_load_dwordx4 v20, s[16:19], s27 offen lds
s_add_u32 m0, s26, 103424
s_add_u32 s27, s25, 3309568
buffer_load_dwordx4 v20, s[16:19], s27 offen lds
s_add_u32 m0, s26, 104448
s_add_u32 s27, s25, 3342336
buffer_load_dwordx4 v20, s[16:19], s27 offen lds
s_add_u32 m0, s26, 105472
s_add_u32 s27, s25, 3375104
buffer_load_dwordx4 v20, s[16:19], s27 offen lds
s_waitcnt vmcnt(24)
s_barrier
ds_read_b64_tr_b16 a[0:1], v21 offset:0
ds_read_b64_tr_b16 a[2:3], v21 offset:1024
ds_read_b64_tr_b16 a[4:5], v22 offset:0
ds_read_b64_tr_b16 a[6:7], v22 offset:1024
ds_read_b64_tr_b16 a[8:9], v21 offset:8192
ds_read_b64_tr_b16 a[10:11], v21 offset:9216
ds_read_b64_tr_b16 a[12:13], v22 offset:8192
ds_read_b64_tr_b16 a[14:15], v22 offset:9216
s_waitcnt lgkmcnt(0)
ds_read_b64_tr_b16 a[16:17], v21 offset:16384
ds_read_b64_tr_b16 a[18:19], v21 offset:17408
ds_read_b64_tr_b16 a[20:21], v22 offset:16384
ds_read_b64_tr_b16 a[22:23], v22 offset:17408
ds_read_b64_tr_b16 a[24:25], v21 offset:24576
ds_read_b64_tr_b16 a[26:27], v21 offset:25600
ds_read_b64_tr_b16 a[28:29], v22 offset:24576
ds_read_b64_tr_b16 a[30:31], v22 offset:25600
s_waitcnt lgkmcnt(0)
s_barrier
s_add_u32 m0, s26, 0
s_add_u32 s27, s25, 4194304
buffer_load_dwordx4 v20, s[16:19], s27 offen lds
s_add_u32 m0, s26, 1024
s_add_u32 s27, s25, 4227072
buffer_load_dwordx4 v20, s[16:19], s27 offen lds
s_add_u32 m0, s26, 2048
s_add_u32 s27, s25, 4259840
buffer_load_dwordx4 v20, s[16:19], s27 offen lds
s_add_u32 m0, s26, 3072
s_add_u32 s27, s25, 4292608
buffer_load_dwordx4 v20, s[16:19], s27 offen lds
s_add_u32 m0, s26, 4096
s_add_u32 s27, s25, 4325376
buffer_load_dwordx4 v20, s[16:19], s27 offen lds
s_add_u32 m0, s26, 5120
s_add_u32 s27, s25, 4358144
buffer_load_dwordx4 v20, s[16:19], s27 offen lds
s_add_u32 m0, s26, 6144
s_add_u32 s27, s25, 4390912
buffer_load_dwordx4 v20, s[16:19], s27 offen lds
s_add_u32 m0, s26, 7168
s_add_u32 s27, s25, 4423680
buffer_load_dwordx4 v20, s[16:19], s27 offen lds
s_waitcnt vmcnt(24)
s_barrier
ds_read_b64_tr_b16 a[32:33], v21 offset:32768
ds_read_b64_tr_b16 a[34:35], v21 offset:33792
ds_read_b64_tr_b16 a[36:37], v22 offset:32768
ds_read_b64_tr_b16 a[38:39], v22 offset:33792
ds_read_b64_tr_b16 a[40:41], v21 offset:40960
ds_read_b64_tr_b16 a[42:43], v21 offset:41984
ds_read_b64_tr_b16 a[44:45], v22 offset:40960
ds_read_b64_tr_b16 a[46:47], v22 offset:41984
s_waitcnt lgkmcnt(0)
ds_read_b64_tr_b16 a[48:49], v21 offset:49152
ds_read_b64_tr_b16 a[50:51], v21 offset:50176
ds_read_b64_tr_b16 a[52:53], v22 offset:49152
ds_read_b64_tr_b16 a[54:55], v22 offset:50176
ds_read_b64_tr_b16 a[56:57], v21 offset:57344
ds_read_b64_tr_b16 a[58:59], v21 offset:58368
ds_read_b64_tr_b16 a[60:61], v22 offset:57344
ds_read_b64_tr_b16 a[62:63], v22 offset:58368
s_waitcnt lgkmcnt(0)
s_barrier
s_add_u32 m0, s26, 32768
s_add_u32 s27, s25, 5242880
buffer_load_dwordx4 v20, s[16:19], s27 offen lds
s_add_u32 m0, s26, 33792
s_add_u32 s27, s25, 5275648
buffer_load_dwordx4 v20, s[16:19], s27 offen lds
s_add_u32 m0, s26, 34816
s_add_u32 s27, s25, 5308416
buffer_load_dwordx4 v20, s[16:19], s27 offen lds
s_add_u32 m0, s26, 35840
s_add_u32 s27, s25, 5341184
buffer_load_dwordx4 v20, s[16:19], s27 offen lds
s_add_u32 m0, s26, 36864
s_add_u32 s27, s25, 5373952
buffer_load_dwordx4 v20, s[16:19], s27 offen lds
s_add_u32 m0, s26, 37888
s_add_u32 s27, s25, 5406720
buffer_load_dwordx4 v20, s[16:19], s27 offen lds
s_add_u32 m0, s26, 38912
s_add_u32 s27, s25, 5439488
buffer_load_dwordx4 v20, s[16:19], s27 offen lds
s_add_u32 m0, s26, 39936
s_add_u32 s27, s25, 5472256
buffer_load_dwordx4 v20, s[16:19], s27 offen lds
s_waitcnt vmcnt(24)
s_barrier
ds_read_b64_tr_b16 a[64:65], v23 offset:0
ds_read_b64_tr_b16 a[66:67], v23 offset:1024
ds_read_b64_tr_b16 a[68:69], v24 offset:0
ds_read_b64_tr_b16 a[70:71], v24 offset:1024
ds_read_b64_tr_b16 a[72:73], v23 offset:8192
ds_read_b64_tr_b16 a[74:75], v23 offset:9216
ds_read_b64_tr_b16 a[76:77], v24 offset:8192
ds_read_b64_tr_b16 a[78:79], v24 offset:9216
s_waitcnt lgkmcnt(0)
ds_read_b64_tr_b16 a[80:81], v23 offset:16384
ds_read_b64_tr_b16 a[82:83], v23 offset:17408
ds_read_b64_tr_b16 a[84:85], v24 offset:16384
ds_read_b64_tr_b16 a[86:87], v24 offset:17408
ds_read_b64_tr_b16 a[88:89], v23 offset:24576
ds_read_b64_tr_b16 a[90:91], v23 offset:25600
ds_read_b64_tr_b16 a[92:93], v24 offset:24576
ds_read_b64_tr_b16 a[94:95], v24 offset:25600
s_waitcnt lgkmcnt(0)
s_barrier
s_add_u32 m0, s26, 65536
s_add_u32 s27, s25, 6291456
buffer_load_dwordx4 v20, s[16:19], s27 offen lds
s_add_u32 m0, s26, 66560
s_add_u32 s27, s25, 6324224
buffer_load_dwordx4 v20, s[16:19], s27 offen lds
s_add_u32 m0, s26, 67584
s_add_u32 s27, s25, 6356992
buffer_load_dwordx4 v20, s[16:19], s27 offen lds
s_add_u32 m0, s26, 68608
s_add_u32 s27, s25, 6389760
buffer_load_dwordx4 v20, s[16:19], s27 offen lds
s_add_u32 m0, s26, 69632
s_add_u32 s27, s25, 6422528
buffer_load_dwordx4 v20, s[16:19], s27 offen lds
s_add_u32 m0, s26, 70656
s_add_u32 s27, s25, 6455296
buffer_load_dwordx4 v20, s[16:19], s27 offen lds
s_add_u32 m0, s26, 71680
s_add_u32 s27, s25, 6488064
buffer_load_dwordx4 v20, s[16:19], s27 offen lds
s_add_u32 m0, s26, 72704
s_add_u32 s27, s25, 6520832
buffer_load_dwordx4 v20, s[16:19], s27 offen lds
s_waitcnt vmcnt(24)
s_barrier
ds_read_b64_tr_b16 a[96:97], v23 offset:32768
ds_read_b64_tr_b16 a[98:99], v23 offset:33792
ds_read_b64_tr_b16 a[100:101], v24 offset:32768
ds_read_b64_tr_b16 a[102:103], v24 offset:33792
ds_read_b64_tr_b16 a[104:105], v23 offset:40960
ds_read_b64_tr_b16 a[106:107], v23 offset:41984
ds_read_b64_tr_b16 a[108:109], v24 offset:40960
ds_read_b64_tr_b16 a[110:111], v24 offset:41984
s_waitcnt lgkmcnt(0)
ds_read_b64_tr_b16 a[112:113], v23 offset:49152
ds_read_b64_tr_b16 a[114:115], v23 offset:50176
ds_read_b64_tr_b16 a[116:117], v24 offset:49152
ds_read_b64_tr_b16 a[118:119], v24 offset:50176
ds_read_b64_tr_b16 a[120:121], v23 offset:57344
ds_read_b64_tr_b16 a[122:123], v23 offset:58368
ds_read_b64_tr_b16 a[124:125], v24 offset:57344
ds_read_b64_tr_b16 a[126:127], v24 offset:58368
s_waitcnt lgkmcnt(0)
s_barrier
s_add_u32 m0, s26, 98304
s_add_u32 s27, s25, 7340032
buffer_load_dwordx4 v20, s[16:19], s27 offen lds
s_add_u32 m0, s26, 99328
s_add_u32 s27, s25, 7372800
buffer_load_dwordx4 v20, s[16:19], s27 offen lds
s_add_u32 m0, s26, 100352
s_add_u32 s27, s25, 7405568
buffer_load_dwordx4 v20, s[16:19], s27 offen lds
s_add_u32 m0, s26, 101376
s_add_u32 s27, s25, 7438336
buffer_load_dwordx4 v20, s[16:19], s27 offen lds
s_add_u32 m0, s26, 102400
s_add_u32 s27, s25, 7471104
buffer_load_dwordx4 v20, s[16:19], s27 offen lds
s_add_u32 m0, s26, 103424
s_add_u32 s27, s25, 7503872
buffer_load_dwordx4 v20, s[16:19], s27 offen lds
s_add_u32 m0, s26, 104448
s_add_u32 s27, s25, 7536640
buffer_load_dwordx4 v20, s[16:19], s27 offen lds
s_add_u32 m0, s26, 105472
s_add_u32 s27, s25, 7569408
buffer_load_dwordx4 v20, s[16:19], s27 offen lds
s_waitcnt vmcnt(24)
s_barrier
ds_read_b64_tr_b16 a[128:129], v21 offset:0
ds_read_b64_tr_b16 a[130:131], v21 offset:1024
ds_read_b64_tr_b16 a[132:133], v22 offset:0
ds_read_b64_tr_b16 a[134:135], v22 offset:1024
ds_read_b64_tr_b16 a[136:137], v21 offset:8192
ds_read_b64_tr_b16 a[138:139], v21 offset:9216
ds_read_b64_tr_b16 a[140:141], v22 offset:8192
ds_read_b64_tr_b16 a[142:143], v22 offset:9216
s_waitcnt lgkmcnt(0)
ds_read_b64_tr_b16 a[144:145], v21 offset:16384
ds_read_b64_tr_b16 a[146:147], v21 offset:17408
ds_read_b64_tr_b16 a[148:149], v22 offset:16384
ds_read_b64_tr_b16 a[150:151], v22 offset:17408
ds_read_b64_tr_b16 a[152:153], v21 offset:24576
ds_read_b64_tr_b16 a[154:155], v21 offset:25600
ds_read_b64_tr_b16 a[156:157], v22 offset:24576
ds_read_b64_tr_b16 a[158:159], v22 offset:25600
s_waitcnt lgkmcnt(0)
s_waitcnt vmcnt(16)
s_barrier
ds_read_b64_tr_b16 a[160:161], v21 offset:32768
ds_read_b64_tr_b16 a[162:163], v21 offset:33792
ds_read_b64_tr_b16 a[164:165], v22 offset:32768
ds_read_b64_tr_b16 a[166:167], v22 offset:33792
ds_read_b64_tr_b16 a[168:169], v21 offset:40960
ds_read_b64_tr_b16 a[170:171], v21 offset:41984
ds_read_b64_tr_b16 a[172:173], v22 offset:40960
ds_read_b64_tr_b16 a[174:175], v22 offset:41984
s_waitcnt lgkmcnt(0)
ds_read_b64_tr_b16 a[176:177], v21 offset:49152
ds_read_b64_tr_b16 a[178:179], v21 offset:50176
ds_read_b64_tr_b16 a[180:181], v22 offset:49152
ds_read_b64_tr_b16 a[182:183], v22 offset:50176
ds_read_b64_tr_b16 a[184:185], v21 offset:57344
ds_read_b64_tr_b16 a[186:187], v21 offset:58368
ds_read_b64_tr_b16 a[188:189], v22 offset:57344
ds_read_b64_tr_b16 a[190:191], v22 offset:58368
s_waitcnt lgkmcnt(0)
s_waitcnt vmcnt(8)
s_barrier
ds_read_b64_tr_b16 a[192:193], v23 offset:0
ds_read_b64_tr_b16 a[194:195], v23 offset:1024
ds_read_b64_tr_b16 a[196:197], v24 offset:0
ds_read_b64_tr_b16 a[198:199], v24 offset:1024
ds_read_b64_tr_b16 a[200:201], v23 offset:8192
ds_read_b64_tr_b16 a[202:203], v23 offset:9216
ds_read_b64_tr_b16 a[204:205], v24 offset:8192
ds_read_b64_tr_b16 a[206:207], v24 offset:9216
s_waitcnt lgkmcnt(0)
ds_read_b64_tr_b16 a[208:209], v23 offset:16384
ds_read_b64_tr_b16 a[210:211], v23 offset:17408
ds_read_b64_tr_b16 a[212:213], v24 offset:16384
ds_read_b64_tr_b16 a[214:215], v24 offset:17408
ds_read_b64_tr_b16 a[216:217], v23 offset:24576
ds_read_b64_tr_b16 a[218:219], v23 offset:25600
ds_read_b64_tr_b16 a[220:221], v24 offset:24576
ds_read_b64_tr_b16 a[222:223], v24 offset:25600
s_waitcnt lgkmcnt(0)
s_waitcnt vmcnt(0)
s_barrier
ds_read_b64_tr_b16 a[224:225], v23 offset:32768
ds_read_b64_tr_b16 a[226:227], v23 offset:33792
ds_read_b64_tr_b16 a[228:229], v24 offset:32768
ds_read_b64_tr_b16 a[230:231], v24 offset:33792
ds_read_b64_tr_b16 a[232:233], v23 offset:40960
ds_read_b64_tr_b16 a[234:235], v23 offset:41984
ds_read_b64_tr_b16 a[236:237], v24 offset:40960
ds_read_b64_tr_b16 a[238:239], v24 offset:41984
s_waitcnt lgkmcnt(0)
ds_read_b64_tr_b16 a[240:241], v23 offset:49152
ds_read_b64_tr_b16 a[242:243], v23 offset:50176
ds_read_b64_tr_b16 a[244:245], v24 offset:49152
ds_read_b64_tr_b16 a[246:247], v24 offset:50176
ds_read_b64_tr_b16 a[248:249], v23 offset:57344
ds_read_b64_tr_b16 a[250:251], v23 offset:58368
ds_read_b64_tr_b16 a[252:253], v24 offset:57344
ds_read_b64_tr_b16 a[254:255], v24 offset:58368
s_waitcnt lgkmcnt(0)
s_lshl_b32 s21, s49, 12
v_and_b32 v1, 63, v0
v_and_b32 v2, 15, v0
v_bfe_u32 v3, v0, 4, 2
v_lshrrev_b32 v4, 6, v0
v_lshrrev_b32 v5, 5, v1
v_lshl_add_u32 v5, v4, 3, v5
v_add_u32 v5, 0, v5
v_and_b32 v6, 7, v5
v_lshrrev_b32 v7, 4, v5
v_lshl_add_u32 v6, v7, 3, v6
v_and_b32 v7, 31, v1
v_xor_b32 v6, v6, v7
v_lshlrev_b32 v6, 4, v6
v_lshl_add_u32 v8, v5, 11, v6
v_lshrrev_b32 v5, 5, v1
v_lshl_add_u32 v5, v4, 3, v5
v_add_u32 v5, 2, v5
v_and_b32 v6, 7, v5
v_lshrrev_b32 v7, 4, v5
v_lshl_add_u32 v6, v7, 3, v6
v_and_b32 v7, 31, v1
v_xor_b32 v6, v6, v7
v_lshlrev_b32 v6, 4, v6
v_lshl_add_u32 v9, v5, 11, v6
v_lshrrev_b32 v5, 5, v1
v_lshl_add_u32 v5, v4, 3, v5
v_add_u32 v5, 4, v5
v_and_b32 v6, 7, v5
v_lshrrev_b32 v7, 4, v5
v_lshl_add_u32 v6, v7, 3, v6
v_and_b32 v7, 31, v1
v_xor_b32 v6, v6, v7
v_lshlrev_b32 v6, 4, v6
v_lshl_add_u32 v10, v5, 11, v6
v_lshrrev_b32 v5, 5, v1
v_lshl_add_u32 v5, v4, 3, v5
v_add_u32 v5, 6, v5
v_and_b32 v6, 7, v5
v_lshrrev_b32 v7, 4, v5
v_lshl_add_u32 v6, v7, 3, v6
v_and_b32 v7, 31, v1
v_xor_b32 v6, v6, v7
v_lshlrev_b32 v6, 4, v6
v_lshl_add_u32 v11, v5, 11, v6
v_and_b32 v5, 8, v2
v_add_u32 v5, v5, v2
v_add_u32 v6, 0, v3
v_xor_b32 v6, v6, v2
v_lshlrev_b32 v6, 4, v6
v_lshl_add_u32 v12, v5, 9, v6
v_add_u32 v6, 4, v3
v_xor_b32 v6, v6, v2
v_lshlrev_b32 v6, 4, v6
v_lshl_add_u32 v13, v5, 9, v6
v_add_u32 v6, 8, v3
v_xor_b32 v6, v6, v2
v_lshlrev_b32 v6, 4, v6
v_lshl_add_u32 v14, v5, 9, v6
v_add_u32 v6, 12, v3
v_xor_b32 v6, v6, v2
v_lshlrev_b32 v6, 4, v6
v_lshl_add_u32 v15, v5, 9, v6
v_add_u32 v16, 0x10000, v12
v_add_u32 v17, 0x10000, v13
v_add_u32 v18, 0x10000, v14
v_add_u32 v19, 0x10000, v15
v_lshlrev_b32 v86, 4, v5
v_lshl_add_u32 v86, v3, 9, v86
s_lshl_b32 s44, s46, 15
s_lshr_b32 s25, s49, 1
s_lshl_b32 s25, s25, 14
s_add_u32 s44, s44, s25
s_and_b32 s25, s49, 1
s_lshl_b32 s25, s25, 12
s_add_u32 s44, s44, s25
s_mov_b32 s22, 0
s_mov_b32 s24, 0
s_mov_b32 s20, 0
s_mov_b32 s37, 0
s_mov_b32 s23, 64
s_mov_b32 s32, s98
s_and_b32 s33, s99, 0xffff
s_mov_b32 s34, 0x100
s_mov_b32 s35, 0x00020000
s_mov_b32 s25, 0
v_mov_b32 v2, 0
L_pl_436:
buffer_load_dword v1, v2, s[32:35], s25 offen sc1
s_add_u32 s36, s36, 1
s_cmp_gt_u32 s36, 0x100000
s_cbranch_scc1 chain_kernel_wend
s_waitcnt vmcnt(0)
v_readfirstlane_b32 s26, v1
s_and_b32 s27, s26, 0xffff
s_cmp_ge_u32 s27, 256
s_cbranch_scc1 L_plok_437
s_sleep 4
s_branch L_pl_436
L_plok_437:
s_lshr_b32 s25, s26, 16
s_cmp_gt_u32 s25, 16
s_cselect_b32 s25, 0x2000, 0x0
s_add_u32 s54, s100, 0x1fffff
s_and_b32 s54, s54, 0xffe00000
s_sub_u32 s55, s54, s100
s_add_u32 s54, s55, s25
s_xor_b32 s25, s25, 0x2000
s_add_u32 s55, s55, s25
s_cmp_eq_u32 s40, 2
s_cbranch_scc1 L_q_432
s_cmp_eq_u32 s40, 1
s_cbranch_scc1 L_v_431
v_mov_b32 v96, 0xff81ff81
v_mov_b32 v97, 0xff81ff81
v_mov_b32 v98, 0xff81ff81
v_mov_b32 v99, 0xff81ff81
v_and_b32 v100, 63, v0
v_lshlrev_b32 v101, 3, v100
v_lshlrev_b32 v100, 4, v100
s_barrier
s_add_u32 m0, s21, 0
s_nop 0
buffer_load_dwordx4 v8, s[8:11], s20 offen lds
s_add_u32 m0, s21, 1024
s_nop 0
buffer_load_dwordx4 v9, s[8:11], s20 offen lds
s_add_u32 m0, s21, 2048
s_nop 0
buffer_load_dwordx4 v10, s[8:11], s20 offen lds
s_add_u32 m0, s21, 3072
s_nop 0
buffer_load_dwordx4 v11, s[8:11], s20 offen lds
s_add_u32 s20, s20, 512
s_add_u32 m0, s21, 16384
s_nop 0
buffer_load_dwordx4 v8, s[8:11], s20 offen lds
s_add_u32 m0, s21, 17408
s_nop 0
buffer_load_dwordx4 v9, s[8:11], s20 offen lds
s_add_u32 m0, s21, 18432
s_nop 0
buffer_load_dwordx4 v10, s[8:11], s20 offen lds
s_add_u32 m0, s21, 19456
s_nop 0
buffer_load_dwordx4 v11, s[8:11], s20 offen lds
s_add_u32 s20, s20, 512
s_add_u32 m0, s21, 32768
s_nop 0
buffer_load_dwordx4 v8, s[8:11], s20 offen lds
s_add_u32 m0, s21, 33792
s_nop 0
buffer_load_dwordx4 v9, s[8:11], s20 offen lds
s_add_u32 m0, s21, 34816
s_nop 0
buffer_load_dwordx4 v10, s[8:11], s20 offen lds
s_add_u32 m0, s21, 35840
s_nop 0
buffer_load_dwordx4 v11, s[8:11], s20 offen lds
s_add_u32 s20, s20, 512
s_add_u32 m0, s21, 49152
s_nop 0
buffer_load_dwordx4 v8, s[8:11], s20 offen lds
s_add_u32 m0, s21, 50176
s_nop 0
buffer_load_dwordx4 v9, s[8:11], s20 offen lds
s_add_u32 m0, s21, 51200
s_nop 0
buffer_load_dwordx4 v10, s[8:11], s20 offen lds
s_add_u32 m0, s21, 52224
s_nop 0
buffer_load_dwordx4 v11, s[8:11], s20 offen lds
s_add_u32 s24, s24, 1
s_min_u32 s24, s24, 63
s_lshl_b32 s53, s24, 16
s_mov_b32 s20, s53
s_add_u32 m0, s21, 65536
s_nop 0
buffer_load_dwordx4 v8, s[8:11], s20 offen lds
s_add_u32 m0, s21, 66560
s_nop 0
buffer_load_dwordx4 v9, s[8:11], s20 offen lds
s_add_u32 m0, s21, 67584
s_nop 0
buffer_load_dwordx4 v10, s[8:11], s20 offen lds
s_add_u32 m0, s21, 68608
s_nop 0
buffer_load_dwordx4 v11, s[8:11], s20 offen lds
s_add_u32 s20, s20, 512
s_add_u32 m0, s21, 81920
s_nop 0
buffer_load_dwordx4 v8, s[8:11], s20 offen lds
s_add_u32 m0, s21, 82944
s_nop 0
buffer_load_dwordx4 v9, s[8:11], s20 offen lds
s_add_u32 m0, s21, 83968
s_nop 0
buffer_load_dwordx4 v10, s[8:11], s20 offen lds
s_add_u32 m0, s21, 84992
s_nop 0
buffer_load_dwordx4 v11, s[8:11], s20 offen lds
s_add_u32 s20, s20, 512
s_add_u32 m0, s21, 98304
s_nop 0
buffer_load_dwordx4 v8, s[8:11], s20 offen lds
s_waitcnt vmcnt(21)
s_barrier
ds_read_b128 v[20:23], v12 offset:0
ds_read_b128 v[24:27], v12 offset:4096
ds_read_b128 v[28:31], v13 offset:0
ds_read_b128 v[32:35], v13 offset:4096
ds_read_b128 v[36:39], v14 offset:0
ds_read_b128 v[40:43], v14 offset:4096
s_waitcnt lgkmcnt(4)
L_st_441:
v_mfma_f32_16x16x32_bf16 v[52:55], a[0:3], v[20:23], 0
ds_read_b128 v[44:47], v15 offset:0
s_add_u32 m0, s21, 99328
s_sub_u32 s39, s22, 1
v_mfma_f32_16x16x32_bf16 v[56:59], a[4:7], v[20:23], 0
buffer_load_dwordx4 v9, s[8:11], s20 offen lds
s_bitcmp1_b32 s39, 1
s_cselect_b32 s38, s55, s54
v_mfma_f32_16x16x32_bf16 v[60:63], a[0:3], v[24:27], 0
ds_read_b128 v[48:51], v15 offset:4096
v_mfma_f32_16x16x32_bf16 v[64:67], a[4:7], v[24:27], 0
s_waitcnt lgkmcnt(4)
s_add_u32 s38, s38, s44
v_mfma_f32_16x16x32_bf16 v[52:55], a[8:11], v[28:31], v[52:55]
ds_read_b128 v[20:23], v12 offset:256
s_lshl_b32 s42, s39, 20
v_mfma_f32_16x16x32_bf16 v[56:59], a[12:15], v[28:31], v[56:59]
s_add_u32 s38, s38, s42
s_lshl_b32 s39, s39, 7
v_mfma_f32_16x16x32_bf16 v[60:63], a[8:11], v[32:35], v[60:63]
ds_read_b128 v[24:27], v12 offset:4352
s_add_u32 s39, s39, 0x5900000
s_cmp_eq_u32 s37, 0
s_cselect_b32 s38, 0x7ff00000, s38
s_cselect_b32 s39, 0x7ff00000, s39
v_mfma_f32_16x16x32_bf16 v[64:67], a[12:15], v[32:35], v[64:67]
s_waitcnt lgkmcnt(4)
v_mfma_f32_16x16x32_bf16 v[52:55], a[16:19], v[36:39], v[52:55]
ds_read_b128 v[28:31], v13 offset:256
s_add_u32 m0, s21, 100352
v_mfma_f32_16x16x32_bf16 v[56:59], a[20:23], v[36:39], v[56:59]
buffer_load_dwordx4 v10, s[8:11], s20 offen lds
v_mfma_f32_16x16x32_bf16 v[60:63], a[16:19], v[40:43], v[60:63]
ds_read_b128 v[32:35], v13 offset:4352
v_cvt_pk_bf16_f32 v88, v68, v69
v_mfma_f32_16x16x32_bf16 v[64:67], a[20:23], v[40:43], v[64:67]
s_waitcnt lgkmcnt(4)
v_cvt_pk_bf16_f32 v89, v70, v71
v_cvt_pk_bf16_f32 v90, v72, v73
v_mfma_f32_16x16x32_bf16 v[52:55], a[24:27], v[44:47], v[52:55]
ds_read_b128 v[36:39], v14 offset:256
v_cvt_pk_bf16_f32 v91, v74, v75
v_mfma_f32_16x16x32_bf16 v[56:59], a[28:31], v[44:47], v[56:59]
buffer_store_dwordx4 v[88:91], v86, s[12:15], s38 offen offset:0 sc1
v_mfma_f32_16x16x32_bf16 v[60:63], a[24:27], v[48:51], v[60:63]
ds_read_b128 v[40:43], v14 offset:4352
v_cvt_pk_bf16_f32 v92, v76, v77
v_mfma_f32_16x16x32_bf16 v[64:67], a[28:31], v[48:51], v[64:67]
s_waitcnt lgkmcnt(4)
v_cvt_pk_bf16_f32 v93, v78, v79
v_mfma_f32_16x16x32_bf16 v[52:55], a[32:35], v[20:23], v[52:55]
ds_read_b128 v[44:47], v15 offset:256
s_add_u32 m0, s21, 101376
v_mfma_f32_16x16x32_bf16 v[56:59], a[36:39], v[20:23], v[56:59]
buffer_load_dwordx4 v11, s[8:11], s20 offen lds
v_mfma_f32_16x16x32_bf16 v[60:63], a[32:35], v[24:27], v[60:63]
ds_read_b128 v[48:51], v15 offset:4352
v_cvt_pk_bf16_f32 v94, v80, v81
v_mfma_f32_16x16x32_bf16 v[64:67], a[36:39], v[24:27], v[64:67]
s_waitcnt lgkmcnt(4)
v_cvt_pk_bf16_f32 v95, v82, v83
v_mfma_f32_16x16x32_bf16 v[52:55], a[40:43], v[28:31], v[52:55]
s_waitcnt vmcnt(20)
s_barrier
ds_read_b128 v[20:23], v12 offset:16384
v_mfma_f32_16x16x32_bf16 v[56:59], a[44:47], v[28:31], v[56:59]
s_add_u32 s20, s20, 512
buffer_store_dwordx4 v[92:95], v86, s[12:15], s38 offen offset:128 sc1
v_mfma_f32_16x16x32_bf16 v[60:63], a[40:43], v[32:35], v[60:63]
ds_read_b128 v[24:27], v12 offset:20480
s_add_u32 s42, s38, 0x8000000
v_mfma_f32_16x16x32_bf16 v[64:67], a[44:47], v[32:35], v[64:67]
s_waitcnt lgkmcnt(4)
s_cmp_le_u32 s22, 52
s_cbranch_scc1 L_nokm_442
buffer_store_dwordx4 v[96:99], v100, s[12:15], s42 offen offset:3072 sc1
L_nokm_442:
v_mfma_f32_16x16x32_bf16 v[52:55], a[48:51], v[36:39], v[52:55]
ds_read_b128 v[28:31], v13 offset:16384
s_add_u32 m0, s21, 114688
v_mfma_f32_16x16x32_bf16 v[56:59], a[52:55], v[36:39], v[56:59]
buffer_load_dwordx4 v8, s[8:11], s20 offen lds
v_mfma_f32_16x16x32_bf16 v[60:63], a[48:51], v[40:43], v[60:63]
ds_read_b128 v[32:35], v13 offset:20480
v_mfma_f32_16x16x32_bf16 v[64:67], a[52:55], v[40:43], v[64:67]
s_waitcnt lgkmcnt(4)
v_mfma_f32_16x16x32_bf16 v[52:55], a[56:59], v[44:47], v[52:55]
ds_read_b128 v[36:39], v14 offset:16384
v_mfma_f32_16x16x32_bf16 v[56:59], a[60:63], v[44:47], v[56:59]
buffer_store_dwordx2 v[96:97], v101, s[12:15], s42 offen offset:0 sc1
v_mfma_f32_16x16x32_bf16 v[60:63], a[56:59], v[48:51], v[60:63]
ds_read_b128 v[40:43], v14 offset:20480
v_mfma_f32_16x16x32_bf16 v[64:67], a[60:63], v[48:51], v[64:67]
s_waitcnt lgkmcnt(4)
v_mfma_f32_16x16x32_bf16 v[52:55], a[64:67], v[20:23], v[52:55]
ds_read_b128 v[44:47], v15 offset:16384
s_add_u32 m0, s21, 115712
v_mfma_f32_16x16x32_bf16 v[56:59], a[68:71], v[20:23], v[56:59]
buffer_load_dwordx4 v9, s[8:11], s20 offen lds
v_mfma_f32_16x16x32_bf16 v[60:63], a[64:67], v[24:27], v[60:63]
ds_read_b128 v[48:51], v15 offset:20480
v_mfma_f32_16x16x32_bf16 v[64:67], a[68:71], v[24:27], v[64:67]
s_waitcnt lgkmcnt(4)
v_mfma_f32_16x16x32_bf16 v[52:55], a[72:75], v[28:31], v[52:55]
ds_read_b128 v[20:23], v12 offset:16640
v_mfma_f32_16x16x32_bf16 v[56:59], a[76:79], v[28:31], v[56:59]
v_mfma_f32_16x16x32_bf16 v[60:63], a[72:75], v[32:35], v[60:63]
ds_read_b128 v[24:27], v12 offset:20736
s_add_u32 s24, s24, 1
v_mfma_f32_16x16x32_bf16 v[64:67], a[76:79], v[32:35], v[64:67]
s_waitcnt lgkmcnt(4)
v_mfma_f32_16x16x32_bf16 v[52:55], a[80:83], v[36:39], v[52:55]
ds_read_b128 v[28:31], v13 offset:16640
s_add_u32 m0, s21, 116736
v_mfma_f32_16x16x32_bf16 v[56:59], a[84:87], v[36:39], v[56:59]
buffer_load_dwordx4 v10, s[8:11], s20 offen lds
v_mfma_f32_16x16x32_bf16 v[60:63], a[80:83], v[40:43], v[60:63]
ds_read_b128 v[32:35], v13 offset:20736
v_mfma_f32_16x16x32_bf16 v[64:67], a[84:87], v[40:43], v[64:67]
s_waitcnt lgkmcnt(4)
s_min_u32 s24, s24, 63
v_mfma_f32_16x16x32_bf16 v[52:55], a[88:91], v[44:47], v[52:55]
ds_read_b128 v[36:39], v14 offset:16640
v_mfma_f32_16x16x32_bf16 v[56:59], a[92:95], v[44:47], v[56:59]
v_mfma_f32_16x16x32_bf16 v[60:63], a[88:91], v[48:51], v[60:63]
ds_read_b128 v[40:43], v14 offset:20736
s_lshl_b32 s53, s24, 16
v_mfma_f32_16x16x32_bf16 v[64:67], a[92:95], v[48:51], v[64:67]
s_waitcnt lgkmcnt(4)
v_mfma_f32_16x16x32_bf16 v[52:55], a[96:99], v[20:23], v[52:55]
ds_read_b128 v[44:47], v15 offset:16640
s_add_u32 m0, s21, 117760
v_mfma_f32_16x16x32_bf16 v[56:59], a[100:103], v[20:23], v[56:59]
buffer_load_dwordx4 v11, s[8:11], s20 offen lds
v_mfma_f32_16x16x32_bf16 v[60:63], a[96:99], v[24:27], v[60:63]
ds_read_b128 v[48:51], v15 offset:20736
v_mfma_f32_16x16x32_bf16 v[64:67], a[100:103], v[24:27], v[64:67]
s_waitcnt lgkmcnt(4)
v_mfma_f32_16x16x32_bf16 v[52:55], a[104:107], v[28:31], v[52:55]
s_waitcnt vmcnt(20)
s_barrier
ds_read_b128 v[20:23], v12 offset:32768
v_mfma_f32_16x16x32_bf16 v[56:59], a[108:111], v[28:31], v[56:59]
s_mov_b32 s20, s53
v_mfma_f32_16x16x32_bf16 v[60:63], a[104:107], v[32:35], v[60:63]
ds_read_b128 v[24:27], v12 offset:36864
v_mfma_f32_16x16x32_bf16 v[64:67], a[108:111], v[32:35], v[64:67]
s_waitcnt lgkmcnt(4)
v_mfma_f32_16x16x32_bf16 v[52:55], a[112:115], v[36:39], v[52:55]
ds_read_b128 v[28:31], v13 offset:32768
s_add_u32 m0, s21, 0
v_mfma_f32_16x16x32_bf16 v[56:59], a[116:119], v[36:39], v[56:59]
buffer_load_dwordx4 v8, s[8:11], s20 offen lds
v_mfma_f32_16x16x32_bf16 v[60:63], a[112:115], v[40:43], v[60:63]
ds_read_b128 v[32:35], v13 offset:36864
v_mfma_f32_16x16x32_bf16 v[64:67], a[116:119], v[40:43], v[64:67]
s_waitcnt lgkmcnt(4)
v_mfma_f32_16x16x32_bf16 v[52:55], a[120:123], v[44:47], v[52:55]
ds_read_b128 v[36:39], v14 offset:32768
v_mfma_f32_16x16x32_bf16 v[56:59], a[124:127], v[44:47], v[56:59]
v_mfma_f32_16x16x32_bf16 v[60:63], a[120:123], v[48:51], v[60:63]
ds_read_b128 v[40:43], v14 offset:36864
v_mfma_f32_16x16x32_bf16 v[64:67], a[124:127], v[48:51], v[64:67]
s_waitcnt lgkmcnt(4)
v_mfma_f32_16x16x32_bf16 v[52:55], a[128:131], v[20:23], v[52:55]
ds_read_b128 v[44:47], v15 offset:32768
s_add_u32 m0, s21, 1024
v_mfma_f32_16x16x32_bf16 v[56:59], a[132:135], v[20:23], v[56:59]
buffer_load_dwordx4 v9, s[8:11], s20 offen lds
v_mfma_f32_16x16x32_bf16 v[60:63], a[128:131], v[24:27], v[60:63]
ds_read_b128 v[48:51], v15 offset:36864
v_mfma_f32_16x16x32_bf16 v[64:67], a[132:135], v[24:27], v[64:67]
s_waitcnt lgkmcnt(4)
v_mfma_f32_16x16x32_bf16 v[52:55], a[136:139], v[28:31], v[52:55]
ds_read_b128 v[20:23], v12 offset:33024
v_mfma_f32_16x16x32_bf16 v[56:59], a[140:143], v[28:31], v[56:59]
v_mfma_f32_16x16x32_bf16 v[60:63], a[136:139], v[32:35], v[60:63]
ds_read_b128 v[24:27], v12 offset:37120
v_mfma_f32_16x16x32_bf16 v[64:67], a[140:143], v[32:35], v[64:67]
s_waitcnt lgkmcnt(4)
v_mfma_f32_16x16x32_bf16 v[52:55], a[144:147], v[36:39], v[52:55]
ds_read_b128 v[28:31], v13 offset:33024
s_add_u32 m0, s21, 2048
v_mfma_f32_16x16x32_bf16 v[56:59], a[148:151], v[36:39], v[56:59]
buffer_load_dwordx4 v10, s[8:11], s20 offen lds
v_mfma_f32_16x16x32_bf16 v[60:63], a[144:147], v[40:43], v[60:63]
ds_read_b128 v[32:35], v13 offset:37120
v_mfma_f32_16x16x32_bf16 v[64:67], a[148:151], v[40:43], v[64:67]
s_waitcnt lgkmcnt(4)
v_mfma_f32_16x16x32_bf16 v[52:55], a[152:155], v[44:47], v[52:55]
ds_read_b128 v[36:39], v14 offset:33024
v_mfma_f32_16x16x32_bf16 v[56:59], a[156:159], v[44:47], v[56:59]
v_mfma_f32_16x16x32_bf16 v[60:63], a[152:155], v[48:51], v[60:63]
ds_read_b128 v[40:43], v14 offset:37120
v_mfma_f32_16x16x32_bf16 v[64:67], a[156:159], v[48:51], v[64:67]
s_waitcnt lgkmcnt(4)
v_mfma_f32_16x16x32_bf16 v[52:55], a[160:163], v[20:23], v[52:55]
ds_read_b128 v[44:47], v15 offset:33024
s_add_u32 m0, s21, 3072
v_mfma_f32_16x16x32_bf16 v[56:59], a[164:167], v[20:23], v[56:59]
buffer_load_dwordx4 v11, s[8:11], s20 offen lds
v_mfma_f32_16x16x32_bf16 v[60:63], a[160:163], v[24:27], v[60:63]
ds_read_b128 v[48:51], v15 offset:37120
v_mfma_f32_16x16x32_bf16 v[64:67], a[164:167], v[24:27], v[64:67]
s_waitcnt lgkmcnt(4)
v_mfma_f32_16x16x32_bf16 v[52:55], a[168:171], v[28:31], v[52:55]
s_waitcnt vmcnt(7)
s_barrier
ds_read_b128 v[20:23], v12 offset:49152
v_mfma_f32_16x16x32_bf16 v[56:59], a[172:175], v[28:31], v[56:59]
s_add_u32 s20, s20, 512
buffer_atomic_add v84, v85, s[12:15], s39 offen sc1
v_mfma_f32_16x16x32_bf16 v[60:63], a[168:171], v[32:35], v[60:63]
ds_read_b128 v[24:27], v12 offset:53248
s_mov_b32 s37, 1
v_mfma_f32_16x16x32_bf16 v[64:67], a[172:175], v[32:35], v[64:67]
s_waitcnt lgkmcnt(4)
v_mfma_f32_16x16x32_bf16 v[52:55], a[176:179], v[36:39], v[52:55]
ds_read_b128 v[28:31], v13 offset:49152
s_add_u32 m0, s21, 16384
v_mfma_f32_16x16x32_bf16 v[56:59], a[180:183], v[36:39], v[56:59]
buffer_load_dwordx4 v8, s[8:11], s20 offen lds
v_mfma_f32_16x16x32_bf16 v[60:63], a[176:179], v[40:43], v[60:63]
ds_read_b128 v[32:35], v13 offset:53248
v_mfma_f32_16x16x32_bf16 v[64:67], a[180:183], v[40:43], v[64:67]
s_waitcnt lgkmcnt(4)
v_mfma_f32_16x16x32_bf16 v[52:55], a[184:187], v[44:47], v[52:55]
ds_read_b128 v[36:39], v14 offset:49152
v_mfma_f32_16x16x32_bf16 v[56:59], a[188:191], v[44:47], v[56:59]
v_mfma_f32_16x16x32_bf16 v[60:63], a[184:187], v[48:51], v[60:63]
ds_read_b128 v[40:43], v14 offset:53248
v_mfma_f32_16x16x32_bf16 v[64:67], a[188:191], v[48:51], v[64:67]
s_waitcnt lgkmcnt(4)
v_mfma_f32_16x16x32_bf16 v[52:55], a[192:195], v[20:23], v[52:55]
ds_read_b128 v[44:47], v15 offset:49152
s_add_u32 m0, s21, 17408
v_mfma_f32_16x16x32_bf16 v[56:59], a[196:199], v[20:23], v[56:59]
buffer_load_dwordx4 v9, s[8:11], s20 offen lds
v_mfma_f32_16x16x32_bf16 v[60:63], a[192:195], v[24:27], v[60:63]
ds_read_b128 v[48:51], v15 offset:53248
v_mfma_f32_16x16x32_bf16 v[64:67], a[196:199], v[24:27], v[64:67]
s_waitcnt lgkmcnt(4)
v_mfma_f32_16x16x32_bf16 v[52:55], a[200:203], v[28:31], v[52:55]
ds_read_b128 v[20:23], v12 offset:49408
v_mfma_f32_16x16x32_bf16 v[56:59], a[204:207], v[28:31], v[56:59]
v_mfma_f32_16x16x32_bf16 v[60:63], a[200:203], v[32:35], v[60:63]
ds_read_b128 v[24:27], v12 offset:53504
v_mfma_f32_16x16x32_bf16 v[64:67], a[204:207], v[32:35], v[64:67]
s_waitcnt lgkmcnt(4)
v_mfma_f32_16x16x32_bf16 v[52:55], a[208:211], v[36:39], v[52:55]
ds_read_b128 v[28:31], v13 offset:49408
s_add_u32 m0, s21, 18432
v_mfma_f32_16x16x32_bf16 v[56:59], a[212:215], v[36:39], v[56:59]
buffer_load_dwordx4 v10, s[8:11], s20 offen lds
v_mfma_f32_16x16x32_bf16 v[60:63], a[208:211], v[40:43], v[60:63]
ds_read_b128 v[32:35], v13 offset:53504
v_mfma_f32_16x16x32_bf16 v[64:67], a[212:215], v[40:43], v[64:67]
s_waitcnt lgkmcnt(4)
v_mfma_f32_16x16x32_bf16 v[52:55], a[216:219], v[44:47], v[52:55]
ds_read_b128 v[36:39], v14 offset:49408
v_mfma_f32_16x16x32_bf16 v[56:59], a[220:223], v[44:47], v[56:59]
v_mfma_f32_16x16x32_bf16 v[60:63], a[216:219], v[48:51], v[60:63]
ds_read_b128 v[40:43], v14 offset:53504
v_mfma_f32_16x16x32_bf16 v[64:67], a[220:223], v[48:51], v[64:67]
s_waitcnt lgkmcnt(4)
v_mfma_f32_16x16x32_bf16 v[52:55], a[224:227], v[20:23], v[52:55]
ds_read_b128 v[44:47], v15 offset:49408
s_add_u32 m0, s21, 19456
v_mfma_f32_16x16x32_bf16 v[56:59], a[228:231], v[20:23], v[56:59]
buffer_load_dwordx4 v11, s[8:11], s20 offen lds
v_mfma_f32_16x16x32_bf16 v[60:63], a[224:227], v[24:27], v[60:63]
ds_read_b128 v[48:51], v15 offset:53504
v_mfma_f32_16x16x32_bf16 v[64:67], a[228:231], v[24:27], v[64:67]
s_waitcnt lgkmcnt(4)
v_mfma_f32_16x16x32_bf16 v[52:55], a[232:235], v[28:31], v[52:55]
s_waitcnt vmcnt(20)
s_barrier
ds_read_b128 v[20:23], v16 offset:0
v_mfma_f32_16x16x32_bf16 v[56:59], a[236:239], v[28:31], v[56:59]
s_add_u32 s20, s20, 512
v_mfma_f32_16x16x32_bf16 v[60:63], a[232:235], v[32:35], v[60:63]
ds_read_b128 v[24:27], v16 offset:4096
v_mfma_f32_16x16x32_bf16 v[64:67], a[236:239], v[32:35], v[64:67]
s_waitcnt lgkmcnt(4)
v_mfma_f32_16x16x32_bf16 v[52:55], a[240:243], v[36:39], v[52:55]
ds_read_b128 v[28:31], v17 offset:0
s_add_u32 m0, s21, 32768
v_mfma_f32_16x16x32_bf16 v[56:59], a[244:247], v[36:39], v[56:59]
buffer_load_dwordx4 v8, s[8:11], s20 offen lds
v_mfma_f32_16x16x32_bf16 v[60:63], a[240:243], v[40:43], v[60:63]
ds_read_b128 v[32:35], v17 offset:4096
v_mfma_f32_16x16x32_bf16 v[64:67], a[244:247], v[40:43], v[64:67]
s_waitcnt lgkmcnt(4)
v_mfma_f32_16x16x32_bf16 v[52:55], a[248:251], v[44:47], v[52:55]
ds_read_b128 v[36:39], v18 offset:0
v_mfma_f32_16x16x32_bf16 v[56:59], a[252:255], v[44:47], v[56:59]
v_mfma_f32_16x16x32_bf16 v[60:63], a[248:251], v[48:51], v[60:63]
ds_read_b128 v[40:43], v18 offset:4096
v_mfma_f32_16x16x32_bf16 v[64:67], a[252:255], v[48:51], v[64:67]
s_waitcnt lgkmcnt(4)
s_add_u32 s22, s22, 1
s_cmp_ge_u32 s22, s23
s_cbranch_scc1 L_fl0_438
v_mfma_f32_16x16x32_bf16 v[68:71], a[0:3], v[20:23], 0
ds_read_b128 v[44:47], v19 offset:0
s_add_u32 m0, s21, 33792
s_sub_u32 s39, s22, 1
v_mfma_f32_16x16x32_bf16 v[72:75], a[4:7], v[20:23], 0
buffer_load_dwordx4 v9, s[8:11], s20 offen lds
s_bitcmp1_b32 s39, 1
s_cselect_b32 s38, s55, s54
v_mfma_f32_16x16x32_bf16 v[76:79], a[0:3], v[24:27], 0
ds_read_b128 v[48:51], v19 offset:4096
v_mfma_f32_16x16x32_bf16 v[80:83], a[4:7], v[24:27], 0
s_waitcnt lgkmcnt(4)
s_add_u32 s38, s38, s44
v_mfma_f32_16x16x32_bf16 v[68:71], a[8:11], v[28:31], v[68:71]
ds_read_b128 v[20:23], v16 offset:256
s_lshl_b32 s42, s39, 20
v_mfma_f32_16x16x32_bf16 v[72:75], a[12:15], v[28:31], v[72:75]
s_add_u32 s38, s38, s42
s_lshl_b32 s39, s39, 7
v_mfma_f32_16x16x32_bf16 v[76:79], a[8:11], v[32:35], v[76:79]
ds_read_b128 v[24:27], v16 offset:4352
s_add_u32 s39, s39, 0x5900000
s_cmp_eq_u32 s37, 0
s_cselect_b32 s38, 0x7ff00000, s38
s_cselect_b32 s39, 0x7ff00000, s39
v_mfma_f32_16x16x32_bf16 v[80:83], a[12:15], v[32:35], v[80:83]
s_waitcnt lgkmcnt(4)
v_mfma_f32_16x16x32_bf16 v[68:71], a[16:19], v[36:39], v[68:71]
ds_read_b128 v[28:31], v17 offset:256
s_add_u32 m0, s21, 34816
v_mfma_f32_16x16x32_bf16 v[72:75], a[20:23], v[36:39], v[72:75]
buffer_load_dwordx4 v10, s[8:11], s20 offen lds
v_mfma_f32_16x16x32_bf16 v[76:79], a[16:19], v[40:43], v[76:79]
ds_read_b128 v[32:35], v17 offset:4352
v_cvt_pk_bf16_f32 v88, v52, v53
v_mfma_f32_16x16x32_bf16 v[80:83], a[20:23], v[40:43], v[80:83]
s_waitcnt lgkmcnt(4)
v_cvt_pk_bf16_f32 v89, v54, v55
v_cvt_pk_bf16_f32 v90, v56, v57
v_mfma_f32_16x16x32_bf16 v[68:71], a[24:27], v[44:47], v[68:71]
ds_read_b128 v[36:39], v18 offset:256
v_cvt_pk_bf16_f32 v91, v58, v59
v_mfma_f32_16x16x32_bf16 v[72:75], a[28:31], v[44:47], v[72:75]
buffer_store_dwordx4 v[88:91], v86, s[12:15], s38 offen offset:0 sc1
v_mfma_f32_16x16x32_bf16 v[76:79], a[24:27], v[48:51], v[76:79]
ds_read_b128 v[40:43], v18 offset:4352
v_cvt_pk_bf16_f32 v92, v60, v61
v_mfma_f32_16x16x32_bf16 v[80:83], a[28:31], v[48:51], v[80:83]
s_waitcnt lgkmcnt(4)
v_cvt_pk_bf16_f32 v93, v62, v63
v_mfma_f32_16x16x32_bf16 v[68:71], a[32:35], v[20:23], v[68:71]
ds_read_b128 v[44:47], v19 offset:256
s_add_u32 m0, s21, 35840
v_mfma_f32_16x16x32_bf16 v[72:75], a[36:39], v[20:23], v[72:75]
buffer_load_dwordx4 v11, s[8:11], s20 offen lds
v_mfma_f32_16x16x32_bf16 v[76:79], a[32:35], v[24:27], v[76:79]
ds_read_b128 v[48:51], v19 offset:4352
v_cvt_pk_bf16_f32 v94, v64, v65
v_mfma_f32_16x16x32_bf16 v[80:83], a[36:39], v[24:27], v[80:83]
s_waitcnt lgkmcnt(4)
v_cvt_pk_bf16_f32 v95, v66, v67
v_mfma_f32_16x16x32_bf16 v[68:71], a[40:43], v[28:31], v[68:71]
s_waitcnt vmcnt(20)
s_barrier
ds_read_b128 v[20:23], v16 offset:16384
v_mfma_f32_16x16x32_bf16 v[72:75], a[44:47], v[28:31], v[72:75]
s_add_u32 s20, s20, 512
buffer_store_dwordx4 v[92:95], v86, s[12:15], s38 offen offset:128 sc1
v_mfma_f32_16x16x32_bf16 v[76:79], a[40:43], v[32:35], v[76:79]
ds_read_b128 v[24:27], v16 offset:20480
s_add_u32 s42, s38, 0x8000000
v_mfma_f32_16x16x32_bf16 v[80:83], a[44:47], v[32:35], v[80:83]
s_waitcnt lgkmcnt(4)
s_cmp_le_u32 s22, 52
s_cbranch_scc1 L_nokm_443
buffer_store_dwordx4 v[96:99], v100, s[12:15], s42 offen offset:3072 sc1
L_nokm_443:
v_mfma_f32_16x16x32_bf16 v[68:71], a[48:51], v[36:39], v[68:71]
ds_read_b128 v[28:31], v17 offset:16384
s_add_u32 m0, s21, 49152
v_mfma_f32_16x16x32_bf16 v[72:75], a[52:55], v[36:39], v[72:75]
buffer_load_dwordx4 v8, s[8:11], s20 offen lds
v_mfma_f32_16x16x32_bf16 v[76:79], a[48:51], v[40:43], v[76:79]
ds_read_b128 v[32:35], v17 offset:20480
v_mfma_f32_16x16x32_bf16 v[80:83], a[52:55], v[40:43], v[80:83]
s_waitcnt lgkmcnt(4)
v_mfma_f32_16x16x32_bf16 v[68:71], a[56:59], v[44:47], v[68:71]
ds_read_b128 v[36:39], v18 offset:16384
v_mfma_f32_16x16x32_bf16 v[72:75], a[60:63], v[44:47], v[72:75]
buffer_store_dwordx2 v[96:97], v101, s[12:15], s42 offen offset:0 sc1
v_mfma_f32_16x16x32_bf16 v[76:79], a[56:59], v[48:51], v[76:79]
ds_read_b128 v[40:43], v18 offset:20480
v_mfma_f32_16x16x32_bf16 v[80:83], a[60:63], v[48:51], v[80:83]
s_waitcnt lgkmcnt(4)
v_mfma_f32_16x16x32_bf16 v[68:71], a[64:67], v[20:23], v[68:71]
ds_read_b128 v[44:47], v19 offset:16384
s_add_u32 m0, s21, 50176
v_mfma_f32_16x16x32_bf16 v[72:75], a[68:71], v[20:23], v[72:75]
buffer_load_dwordx4 v9, s[8:11], s20 offen lds
v_mfma_f32_16x16x32_bf16 v[76:79], a[64:67], v[24:27], v[76:79]
ds_read_b128 v[48:51], v19 offset:20480
v_mfma_f32_16x16x32_bf16 v[80:83], a[68:71], v[24:27], v[80:83]
s_waitcnt lgkmcnt(4)
v_mfma_f32_16x16x32_bf16 v[68:71], a[72:75], v[28:31], v[68:71]
ds_read_b128 v[20:23], v16 offset:16640
v_mfma_f32_16x16x32_bf16 v[72:75], a[76:79], v[28:31], v[72:75]
v_mfma_f32_16x16x32_bf16 v[76:79], a[72:75], v[32:35], v[76:79]
ds_read_b128 v[24:27], v16 offset:20736
s_add_u32 s24, s24, 1
v_mfma_f32_16x16x32_bf16 v[80:83], a[76:79], v[32:35], v[80:83]
s_waitcnt lgkmcnt(4)
v_mfma_f32_16x16x32_bf16 v[68:71], a[80:83], v[36:39], v[68:71]
ds_read_b128 v[28:31], v17 offset:16640
s_add_u32 m0, s21, 51200
v_mfma_f32_16x16x32_bf16 v[72:75], a[84:87], v[36:39], v[72:75]
buffer_load_dwordx4 v10, s[8:11], s20 offen lds
v_mfma_f32_16x16x32_bf16 v[76:79], a[80:83], v[40:43], v[76:79]
ds_read_b128 v[32:35], v17 offset:20736
v_mfma_f32_16x16x32_bf16 v[80:83], a[84:87], v[40:43], v[80:83]
s_waitcnt lgkmcnt(4)
s_min_u32 s24, s24, 63
v_mfma_f32_16x16x32_bf16 v[68:71], a[88:91], v[44:47], v[68:71]
ds_read_b128 v[36:39], v18 offset:16640
v_mfma_f32_16x16x32_bf16 v[72:75], a[92:95], v[44:47], v[72:75]
v_mfma_f32_16x16x32_bf16 v[76:79], a[88:91], v[48:51], v[76:79]
ds_read_b128 v[40:43], v18 offset:20736
s_lshl_b32 s53, s24, 16
v_mfma_f32_16x16x32_bf16 v[80:83], a[92:95], v[48:51], v[80:83]
s_waitcnt lgkmcnt(4)
v_mfma_f32_16x16x32_bf16 v[68:71], a[96:99], v[20:23], v[68:71]
ds_read_b128 v[44:47], v19 offset:16640
s_add_u32 m0, s21, 52224
v_mfma_f32_16x16x32_bf16 v[72:75], a[100:103], v[20:23], v[72:75]
buffer_load_dwordx4 v11, s[8:11], s20 offen lds
v_mfma_f32_16x16x32_bf16 v[76:79], a[96:99], v[24:27], v[76:79]
ds_read_b128 v[48:51], v19 offset:20736
v_mfma_f32_16x16x32_bf16 v[80:83], a[100:103], v[24:27], v[80:83]
s_waitcnt lgkmcnt(4)
v_mfma_f32_16x16x32_bf16 v[68:71], a[104:107], v[28:31], v[68:71]
s_waitcnt vmcnt(20)
s_barrier
ds_read_b128 v[20:23], v16 offset:32768
v_mfma_f32_16x16x32_bf16 v[72:75], a[108:111], v[28:31], v[72:75]
s_mov_b32 s20, s53
v_mfma_f32_16x16x32_bf16 v[76:79], a[104:107], v[32:35], v[76:79]
ds_read_b128 v[24:27], v16 offset:36864
v_mfma_f32_16x16x32_bf16 v[80:83], a[108:111], v[32:35], v[80:83]
s_waitcnt lgkmcnt(4)
v_mfma_f32_16x16x32_bf16 v[68:71], a[112:115], v[36:39], v[68:71]
ds_read_b128 v[28:31], v17 offset:32768
s_add_u32 m0, s21, 65536
v_mfma_f32_16x16x32_bf16 v[72:75], a[116:119], v[36:39], v[72:75]
buffer_load_dwordx4 v8, s[8:11], s20 offen lds
v_mfma_f32_16x16x32_bf16 v[76:79], a[112:115], v[40:43], v[76:79]
ds_read_b128 v[32:35], v17 offset:36864
v_mfma_f32_16x16x32_bf16 v[80:83], a[116:119], v[40:43], v[80:83]
s_waitcnt lgkmcnt(4)
v_mfma_f32_16x16x32_bf16 v[68:71], a[120:123], v[44:47], v[68:71]
ds_read_b128 v[36:39], v18 offset:32768
v_mfma_f32_16x16x32_bf16 v[72:75], a[124:127], v[44:47], v[72:75]
v_mfma_f32_16x16x32_bf16 v[76:79], a[120:123], v[48:51], v[76:79]
ds_read_b128 v[40:43], v18 offset:36864
v_mfma_f32_16x16x32_bf16 v[80:83], a[124:127], v[48:51], v[80:83]
s_waitcnt lgkmcnt(4)
v_mfma_f32_16x16x32_bf16 v[68:71], a[128:131], v[20:23], v[68:71]
ds_read_b128 v[44:47], v19 offset:32768
s_add_u32 m0, s21, 66560
v_mfma_f32_16x16x32_bf16 v[72:75], a[132:135], v[20:23], v[72:75]
buffer_load_dwordx4 v9, s[8:11], s20 offen lds
v_mfma_f32_16x16x32_bf16 v[76:79], a[128:131], v[24:27], v[76:79]
ds_read_b128 v[48:51], v19 offset:36864
v_mfma_f32_16x16x32_bf16 v[80:83], a[132:135], v[24:27], v[80:83]
s_waitcnt lgkmcnt(4)
v_mfma_f32_16x16x32_bf16 v[68:71], a[136:139], v[28:31], v[68:71]
ds_read_b128 v[20:23], v16 offset:33024
v_mfma_f32_16x16x32_bf16 v[72:75], a[140:143], v[28:31], v[72:75]
v_mfma_f32_16x16x32_bf16 v[76:79], a[136:139], v[32:35], v[76:79]
ds_read_b128 v[24:27], v16 offset:37120
v_mfma_f32_16x16x32_bf16 v[80:83], a[140:143], v[32:35], v[80:83]
s_waitcnt lgkmcnt(4)
v_mfma_f32_16x16x32_bf16 v[68:71], a[144:147], v[36:39], v[68:71]
ds_read_b128 v[28:31], v17 offset:33024
s_add_u32 m0, s21, 67584
v_mfma_f32_16x16x32_bf16 v[72:75], a[148:151], v[36:39], v[72:75]
buffer_load_dwordx4 v10, s[8:11], s20 offen lds
v_mfma_f32_16x16x32_bf16 v[76:79], a[144:147], v[40:43], v[76:79]
ds_read_b128 v[32:35], v17 offset:37120
v_mfma_f32_16x16x32_bf16 v[80:83], a[148:151], v[40:43], v[80:83]
s_waitcnt lgkmcnt(4)
v_mfma_f32_16x16x32_bf16 v[68:71], a[152:155], v[44:47], v[68:71]
ds_read_b128 v[36:39], v18 offset:33024
v_mfma_f32_16x16x32_bf16 v[72:75], a[156:159], v[44:47], v[72:75]
v_mfma_f32_16x16x32_bf16 v[76:79], a[152:155], v[48:51], v[76:79]
ds_read_b128 v[40:43], v18 offset:37120
v_mfma_f32_16x16x32_bf16 v[80:83], a[156:159], v[48:51], v[80:83]
s_waitcnt lgkmcnt(4)
v_mfma_f32_16x16x32_bf16 v[68:71], a[160:163], v[20:23], v[68:71]
ds_read_b128 v[44:47], v19 offset:33024
s_add_u32 m0, s21, 68608
v_mfma_f32_16x16x32_bf16 v[72:75], a[164:167], v[20:23], v[72:75]
buffer_load_dwordx4 v11, s[8:11], s20 offen lds
v_mfma_f32_16x16x32_bf16 v[76:79], a[160:163], v[24:27], v[76:79]
ds_read_b128 v[48:51], v19 offset:37120
v_mfma_f32_16x16x32_bf16 v[80:83], a[164:167], v[24:27], v[80:83]
s_waitcnt lgkmcnt(4)
v_mfma_f32_16x16x32_bf16 v[68:71], a[168:171], v[28:31], v[68:71]
s_waitcnt vmcnt(7)
s_barrier
ds_read_b128 v[20:23], v16 offset:49152
v_mfma_f32_16x16x32_bf16 v[72:75], a[172:175], v[28:31], v[72:75]
s_add_u32 s20, s20, 512
buffer_atomic_add v84, v85, s[12:15], s39 offen sc1
v_mfma_f32_16x16x32_bf16 v[76:79], a[168:171], v[32:35], v[76:79]
ds_read_b128 v[24:27], v16 offset:53248
s_mov_b32 s37, 1
v_mfma_f32_16x16x32_bf16 v[80:83], a[172:175], v[32:35], v[80:83]
s_waitcnt lgkmcnt(4)
v_mfma_f32_16x16x32_bf16 v[68:71], a[176:179], v[36:39], v[68:71]
ds_read_b128 v[28:31], v17 offset:49152
s_add_u32 m0, s21, 81920
v_mfma_f32_16x16x32_bf16 v[72:75], a[180:183], v[36:39], v[72:75]
buffer_load_dwordx4 v8, s[8:11], s20 offen lds
v_mfma_f32_16x16x32_bf16 v[76:79], a[176:179], v[40:43], v[76:79]
ds_read_b128 v[32:35], v17 offset:53248
v_mfma_f32_16x16x32_bf16 v[80:83], a[180:183], v[40:43], v[80:83]
s_waitcnt lgkmcnt(4)
v_mfma_f32_16x16x32_bf16 v[68:71], a[184:187], v[44:47], v[68:71]
ds_read_b128 v[36:39], v18 offset:49152
v_mfma_f32_16x16x32_bf16 v[72:75], a[188:191], v[44:47], v[72:75]
v_mfma_f32_16x16x32_bf16 v[76:79], a[184:187], v[48:51], v[76:79]
ds_read_b128 v[40:43], v18 offset:53248
v_mfma_f32_16x16x32_bf16 v[80:83], a[188:191], v[48:51], v[80:83]
s_waitcnt lgkmcnt(4)
v_mfma_f32_16x16x32_bf16 v[68:71], a[192:195], v[20:23], v[68:71]
ds_read_b128 v[44:47], v19 offset:49152
s_add_u32 m0, s21, 82944
v_mfma_f32_16x16x32_bf16 v[72:75], a[196:199], v[20:23], v[72:75]
buffer_load_dwordx4 v9, s[8:11], s20 offen lds
v_mfma_f32_16x16x32_bf16 v[76:79], a[192:195], v[24:27], v[76:79]
ds_read_b128 v[48:51], v19 offset:53248
v_mfma_f32_16x16x32_bf16 v[80:83], a[196:199], v[24:27], v[80:83]
s_waitcnt lgkmcnt(4)
v_mfma_f32_16x16x32_bf16 v[68:71], a[200:203], v[28:31], v[68:71]
ds_read_b128 v[20:23], v16 offset:49408
v_mfma_f32_16x16x32_bf16 v[72:75], a[204:207], v[28:31], v[72:75]
v_mfma_f32_16x16x32_bf16 v[76:79], a[200:203], v[32:35], v[76:79]
ds_read_b128 v[24:27], v16 offset:53504
v_mfma_f32_16x16x32_bf16 v[80:83], a[204:207], v[32:35], v[80:83]
s_waitcnt lgkmcnt(4)
v_mfma_f32_16x16x32_bf16 v[68:71], a[208:211], v[36:39], v[68:71]
ds_read_b128 v[28:31], v17 offset:49408
s_add_u32 m0, s21, 83968
v_mfma_f32_16x16x32_bf16 v[72:75], a[212:215], v[36:39], v[72:75]
buffer_load_dwordx4 v10, s[8:11], s20 offen lds
v_mfma_f32_16x16x32_bf16 v[76:79], a[208:211], v[40:43], v[76:79]
ds_read_b128 v[32:35], v17 offset:53504
v_mfma_f32_16x16x32_bf16 v[80:83], a[212:215], v[40:43], v[80:83]
s_waitcnt lgkmcnt(4)
v_mfma_f32_16x16x32_bf16 v[68:71], a[216:219], v[44:47], v[68:71]
ds_read_b128 v[36:39], v18 offset:49408
v_mfma_f32_16x16x32_bf16 v[72:75], a[220:223], v[44:47], v[72:75]
v_mfma_f32_16x16x32_bf16 v[76:79], a[216:219], v[48:51], v[76:79]
ds_read_b128 v[40:43], v18 offset:53504
v_mfma_f32_16x16x32_bf16 v[80:83], a[220:223], v[48:51], v[80:83]
s_waitcnt lgkmcnt(4)
v_mfma_f32_16x16x32_bf16 v[68:71], a[224:227], v[20:23], v[68:71]
ds_read_b128 v[44:47], v19 offset:49408
s_add_u32 m0, s21, 84992
v_mfma_f32_16x16x32_bf16 v[72:75], a[228:231], v[20:23], v[72:75]
buffer_load_dwordx4 v11, s[8:11], s20 offen lds
v_mfma_f32_16x16x32_bf16 v[76:79], a[224:227], v[24:27], v[76:79]
ds_read_b128 v[48:51], v19 offset:53504
v_mfma_f32_16x16x32_bf16 v[80:83], a[228:231], v[24:27], v[80:83]
s_waitcnt lgkmcnt(4)
v_mfma_f32_16x16x32_bf16 v[68:71], a[232:235], v[28:31], v[68:71]
s_waitcnt vmcnt(20)
s_barrier
ds_read_b128 v[20:23], v12 offset:0
v_mfma_f32_16x16x32_bf16 v[72:75], a[236:239], v[28:31], v[72:75]
s_add_u32 s20, s20, 512
v_mfma_f32_16x16x32_bf16 v[76:79], a[232:235], v[32:35], v[76:79]
ds_read_b128 v[24:27], v12 offset:4096
v_mfma_f32_16x16x32_bf16 v[80:83], a[236:239], v[32:35], v[80:83]
s_waitcnt lgkmcnt(4)
v_mfma_f32_16x16x32_bf16 v[68:71], a[240:243], v[36:39], v[68:71]
ds_read_b128 v[28:31], v13 offset:0
s_add_u32 m0, s21, 98304
v_mfma_f32_16x16x32_bf16 v[72:75], a[244:247], v[36:39], v[72:75]
buffer_load_dwordx4 v8, s[8:11], s20 offen lds
v_mfma_f32_16x16x32_bf16 v[76:79], a[240:243], v[40:43], v[76:79]
ds_read_b128 v[32:35], v13 offset:4096
v_mfma_f32_16x16x32_bf16 v[80:83], a[244:247], v[40:43], v[80:83]
s_waitcnt lgkmcnt(4)
v_mfma_f32_16x16x32_bf16 v[68:71], a[248:251], v[44:47], v[68:71]
ds_read_b128 v[36:39], v14 offset:0
v_mfma_f32_16x16x32_bf16 v[72:75], a[252:255], v[44:47], v[72:75]
v_mfma_f32_16x16x32_bf16 v[76:79], a[248:251], v[48:51], v[76:79]
ds_read_b128 v[40:43], v14 offset:4096
v_mfma_f32_16x16x32_bf16 v[80:83], a[252:255], v[48:51], v[80:83]
s_waitcnt lgkmcnt(4)
s_add_u32 s22, s22, 1
s_cmp_ge_u32 s22, s23
s_cbranch_scc0 L_st_441
L_fl1_439:
s_waitcnt lgkmcnt(0)
s_nop 7
s_sub_u32 s39, s22, 1
s_bitcmp1_b32 s39, 1
s_cselect_b32 s38, s55, s54
s_add_u32 s38, s38, s44
s_lshl_b32 s42, s39, 20
s_add_u32 s38, s38, s42
s_lshl_b32 s39, s39, 7
s_add_u32 s39, s39, 0x5900000
s_cmp_eq_u32 s37, 0
s_cselect_b32 s38, 0x7ff00000, s38
s_cselect_b32 s39, 0x7ff00000, s39
v_cvt_pk_bf16_f32 v88, v68, v69
v_cvt_pk_bf16_f32 v89, v70, v71
v_cvt_pk_bf16_f32 v90, v72, v73
v_cvt_pk_bf16_f32 v91, v74, v75
buffer_store_dwordx4 v[88:91], v86, s[12:15], s38 offen offset:0 sc1
v_cvt_pk_bf16_f32 v92, v76, v77
v_cvt_pk_bf16_f32 v93, v78, v79
v_cvt_pk_bf16_f32 v94, v80, v81
v_cvt_pk_bf16_f32 v95, v82, v83
buffer_store_dwordx4 v[92:95], v86, s[12:15], s38 offen offset:128 sc1
s_add_u32 s42, s38, 0x8000000
s_cmp_le_u32 s22, 52
s_cbranch_scc1 L_nokm_444
buffer_store_dwordx4 v[96:99], v100, s[12:15], s42 offen offset:3072 sc1
L_nokm_444:
buffer_store_dwordx2 v[96:97], v101, s[12:15], s42 offen offset:0 sc1
s_waitcnt vmcnt(0)
s_barrier
buffer_atomic_add v84, v85, s[12:15], s39 offen sc1
s_mov_b32 s37, 1
s_branch L_ste_440
L_fl0_438:
s_waitcnt lgkmcnt(0)
s_nop 7
s_sub_u32 s39, s22, 1
s_bitcmp1_b32 s39, 1
s_cselect_b32 s38, s55, s54
s_add_u32 s38, s38, s44
s_lshl_b32 s42, s39, 20
s_add_u32 s38, s38, s42
s_lshl_b32 s39, s39, 7
s_add_u32 s39, s39, 0x5900000
s_cmp_eq_u32 s37, 0
s_cselect_b32 s38, 0x7ff00000, s38
s_cselect_b32 s39, 0x7ff00000, s39
v_cvt_pk_bf16_f32 v88, v52, v53
v_cvt_pk_bf16_f32 v89, v54, v55
v_cvt_pk_bf16_f32 v90, v56, v57
v_cvt_pk_bf16_f32 v91, v58, v59
buffer_store_dwordx4 v[88:91], v86, s[12:15], s38 offen offset:0 sc1
v_cvt_pk_bf16_f32 v92, v60, v61
v_cvt_pk_bf16_f32 v93, v62, v63
v_cvt_pk_bf16_f32 v94, v64, v65
v_cvt_pk_bf16_f32 v95, v66, v67
buffer_store_dwordx4 v[92:95], v86, s[12:15], s38 offen offset:128 sc1
s_add_u32 s42, s38, 0x8000000
s_cmp_le_u32 s22, 52
s_cbranch_scc1 L_nokm_445
buffer_store_dwordx4 v[96:99], v100, s[12:15], s42 offen offset:3072 sc1
L_nokm_445:
buffer_store_dwordx2 v[96:97], v101, s[12:15], s42 offen offset:0 sc1
s_waitcnt vmcnt(0)
s_barrier
buffer_atomic_add v84, v85, s[12:15], s39 offen sc1
s_mov_b32 s37, 1
L_ste_440:
s_branch L_op_435
L_v_431:
v_mov_b32 v96, 0xff81ff81
v_mov_b32 v97, 0xff81ff81
v_mov_b32 v98, 0xff81ff81
v_mov_b32 v99, 0xff81ff81
v_and_b32 v100, 63, v0
v_lshlrev_b32 v101, 3, v100
v_lshlrev_b32 v100, 4, v100
s_barrier
s_add_u32 m0, s21, 0
s_nop 0
buffer_load_dwordx4 v8, s[8:11], s20 offen lds
s_add_u32 m0, s21, 1024
s_nop 0
buffer_load_dwordx4 v9, s[8:11], s20 offen lds
s_add_u32 m0, s21, 2048
s_nop 0
buffer_load_dwordx4 v10, s[8:11], s20 offen lds
s_add_u32 m0, s21, 3072
s_nop 0
buffer_load_dwordx4 v11, s[8:11], s20 offen lds
s_add_u32 s20, s20, 512
s_add_u32 m0, s21, 16384
s_nop 0
buffer_load_dwordx4 v8, s[8:11], s20 offen lds
s_add_u32 m0, s21, 17408
s_nop 0
buffer_load_dwordx4 v9, s[8:11], s20 offen lds
s_add_u32 m0, s21, 18432
s_nop 0
buffer_load_dwordx4 v10, s[8:11], s20 offen lds
s_add_u32 m0, s21, 19456
s_nop 0
buffer_load_dwordx4 v11, s[8:11], s20 offen lds
s_add_u32 s20, s20, 512
s_add_u32 m0, s21, 32768
s_nop 0
buffer_load_dwordx4 v8, s[8:11], s20 offen lds
s_add_u32 m0, s21, 33792
s_nop 0
buffer_load_dwordx4 v9, s[8:11], s20 offen lds
s_add_u32 m0, s21, 34816
s_nop 0
buffer_load_dwordx4 v10, s[8:11], s20 offen lds
s_add_u32 m0, s21, 35840
s_nop 0
buffer_load_dwordx4 v11, s[8:11], s20 offen lds
s_add_u32 s20, s20, 512
s_add_u32 m0, s21, 49152
s_nop 0
buffer_load_dwordx4 v8, s[8:11], s20 offen lds
s_add_u32 m0, s21, 50176
s_nop 0
buffer_load_dwordx4 v9, s[8:11], s20 offen lds
s_add_u32 m0, s21, 51200
s_nop 0
buffer_load_dwordx4 v10, s[8:11], s20 offen lds
s_add_u32 m0, s21, 52224
s_nop 0
buffer_load_dwordx4 v11, s[8:11], s20 offen lds
s_add_u32 s24, s24, 1
s_min_u32 s24, s24, 63
s_lshl_b32 s53, s24, 16
s_mov_b32 s20, s53
s_add_u32 m0, s21, 65536
s_nop 0
buffer_load_dwordx4 v8, s[8:11], s20 offen lds
s_add_u32 m0, s21, 66560
s_nop 0
buffer_load_dwordx4 v9, s[8:11], s20 offen lds
s_add_u32 m0, s21, 67584
s_nop 0
buffer_load_dwordx4 v10, s[8:11], s20 offen lds
s_add_u32 m0, s21, 68608
s_nop 0
buffer_load_dwordx4 v11, s[8:11], s20 offen lds
s_add_u32 s20, s20, 512
s_add_u32 m0, s21, 81920
s_nop 0
buffer_load_dwordx4 v8, s[8:11], s20 offen lds
s_add_u32 m0, s21, 82944
s_nop 0
buffer_load_dwordx4 v9, s[8:11], s20 offen lds
s_add_u32 m0, s21, 83968
s_nop 0
buffer_load_dwordx4 v10, s[8:11], s20 offen lds
s_add_u32 m0, s21, 84992
s_nop 0
buffer_load_dwordx4 v11, s[8:11], s20 offen lds
s_add_u32 s20, s20, 512
s_add_u32 m0, s21, 98304
s_nop 0
buffer_load_dwordx4 v8, s[8:11], s20 offen lds
s_waitcnt vmcnt(21)
s_barrier
ds_read_b128 v[20:23], v12 offset:0
ds_read_b128 v[24:27], v12 offset:4096
ds_read_b128 v[28:31], v13 offset:0
ds_read_b128 v[32:35], v13 offset:4096
ds_read_b128 v[36:39], v14 offset:0
ds_read_b128 v[40:43], v14 offset:4096
s_waitcnt lgkmcnt(4)
L_st_449:
v_mfma_f32_16x16x32_bf16 v[52:55], v[20:23], a[0:3], 0
ds_read_b128 v[44:47], v15 offset:0
s_add_u32 m0, s21, 99328
s_sub_u32 s39, s22, 1
v_mfma_f32_16x16x32_bf16 v[56:59], v[20:23], a[4:7], 0
buffer_load_dwordx4 v9, s[8:11], s20 offen lds
s_bitcmp1_b32 s39, 1
s_cselect_b32 s38, s55, s54
v_mfma_f32_16x16x32_bf16 v[60:63], v[24:27], a[0:3], 0
ds_read_b128 v[48:51], v15 offset:4096
v_mfma_f32_16x16x32_bf16 v[64:67], v[24:27], a[4:7], 0
s_waitcnt lgkmcnt(4)
s_add_u32 s38, s38, s44
v_mfma_f32_16x16x32_bf16 v[52:55], v[28:31], a[8:11], v[52:55]
ds_read_b128 v[20:23], v12 offset:256
s_lshl_b32 s42, s39, 20
v_mfma_f32_16x16x32_bf16 v[56:59], v[28:31], a[12:15], v[56:59]
s_add_u32 s38, s38, s42
s_lshl_b32 s39, s39, 7
v_mfma_f32_16x16x32_bf16 v[60:63], v[32:35], a[8:11], v[60:63]
ds_read_b128 v[24:27], v12 offset:4352
s_add_u32 s39, s39, 0x5900000
s_cmp_eq_u32 s37, 0
s_cselect_b32 s38, 0x7ff00000, s38
s_cselect_b32 s39, 0x7ff00000, s39
v_mfma_f32_16x16x32_bf16 v[64:67], v[32:35], a[12:15], v[64:67]
s_waitcnt lgkmcnt(4)
v_mfma_f32_16x16x32_bf16 v[52:55], v[36:39], a[16:19], v[52:55]
ds_read_b128 v[28:31], v13 offset:256
s_add_u32 m0, s21, 100352
v_mfma_f32_16x16x32_bf16 v[56:59], v[36:39], a[20:23], v[56:59]
buffer_load_dwordx4 v10, s[8:11], s20 offen lds
v_mfma_f32_16x16x32_bf16 v[60:63], v[40:43], a[16:19], v[60:63]
ds_read_b128 v[32:35], v13 offset:4352
v_cvt_pk_bf16_f32 v88, v68, v69
v_mfma_f32_16x16x32_bf16 v[64:67], v[40:43], a[20:23], v[64:67]
s_waitcnt lgkmcnt(4)
v_cvt_pk_bf16_f32 v89, v70, v71
v_cvt_pk_bf16_f32 v90, v76, v77
v_mfma_f32_16x16x32_bf16 v[52:55], v[44:47], a[24:27], v[52:55]
ds_read_b128 v[36:39], v14 offset:256
v_cvt_pk_bf16_f32 v91, v78, v79
v_mfma_f32_16x16x32_bf16 v[56:59], v[44:47], a[28:31], v[56:59]
buffer_store_dwordx4 v[88:91], v86, s[12:15], s38 offen offset:2048 sc1
v_mfma_f32_16x16x32_bf16 v[60:63], v[48:51], a[24:27], v[60:63]
ds_read_b128 v[40:43], v14 offset:4352
v_cvt_pk_bf16_f32 v92, v72, v73
v_mfma_f32_16x16x32_bf16 v[64:67], v[48:51], a[28:31], v[64:67]
s_waitcnt lgkmcnt(4)
v_cvt_pk_bf16_f32 v93, v74, v75
v_mfma_f32_16x16x32_bf16 v[52:55], v[20:23], a[32:35], v[52:55]
ds_read_b128 v[44:47], v15 offset:256
s_add_u32 m0, s21, 101376
v_mfma_f32_16x16x32_bf16 v[56:59], v[20:23], a[36:39], v[56:59]
buffer_load_dwordx4 v11, s[8:11], s20 offen lds
v_mfma_f32_16x16x32_bf16 v[60:63], v[24:27], a[32:35], v[60:63]
ds_read_b128 v[48:51], v15 offset:4352
v_cvt_pk_bf16_f32 v94, v80, v81
v_mfma_f32_16x16x32_bf16 v[64:67], v[24:27], a[36:39], v[64:67]
s_waitcnt lgkmcnt(4)
v_cvt_pk_bf16_f32 v95, v82, v83
v_mfma_f32_16x16x32_bf16 v[52:55], v[28:31], a[40:43], v[52:55]
s_waitcnt vmcnt(20)
s_barrier
ds_read_b128 v[20:23], v12 offset:16384
v_mfma_f32_16x16x32_bf16 v[56:59], v[28:31], a[44:47], v[56:59]
s_add_u32 s20, s20, 512
buffer_store_dwordx4 v[92:95], v86, s[12:15], s38 offen offset:2176 sc1
v_mfma_f32_16x16x32_bf16 v[60:63], v[32:35], a[40:43], v[60:63]
ds_read_b128 v[24:27], v12 offset:20480
s_add_u32 s42, s38, 0x8000000
v_mfma_f32_16x16x32_bf16 v[64:67], v[32:35], a[44:47], v[64:67]
s_waitcnt lgkmcnt(4)
v_mfma_f32_16x16x32_bf16 v[52:55], v[36:39], a[48:51], v[52:55]
ds_read_b128 v[28:31], v13 offset:16384
s_add_u32 m0, s21, 114688
v_mfma_f32_16x16x32_bf16 v[56:59], v[36:39], a[52:55], v[56:59]
buffer_load_dwordx4 v8, s[8:11], s20 offen lds
v_mfma_f32_16x16x32_bf16 v[60:63], v[40:43], a[48:51], v[60:63]
ds_read_b128 v[32:35], v13 offset:20480
v_mfma_f32_16x16x32_bf16 v[64:67], v[40:43], a[52:55], v[64:67]
s_waitcnt lgkmcnt(4)
v_mfma_f32_16x16x32_bf16 v[52:55], v[44:47], a[56:59], v[52:55]
ds_read_b128 v[36:39], v14 offset:16384
v_mfma_f32_16x16x32_bf16 v[56:59], v[44:47], a[60:63], v[56:59]
buffer_store_dwordx2 v[96:97], v101, s[12:15], s42 offen offset:512 sc1
v_mfma_f32_16x16x32_bf16 v[60:63], v[48:51], a[56:59], v[60:63]
ds_read_b128 v[40:43], v14 offset:20480
v_mfma_f32_16x16x32_bf16 v[64:67], v[48:51], a[60:63], v[64:67]
s_waitcnt lgkmcnt(4)
v_mfma_f32_16x16x32_bf16 v[52:55], v[20:23], a[64:67], v[52:55]
ds_read_b128 v[44:47], v15 offset:16384
s_add_u32 m0, s21, 115712
v_mfma_f32_16x16x32_bf16 v[56:59], v[20:23], a[68:71], v[56:59]
buffer_load_dwordx4 v9, s[8:11], s20 offen lds
v_mfma_f32_16x16x32_bf16 v[60:63], v[24:27], a[64:67], v[60:63]
ds_read_b128 v[48:51], v15 offset:20480
v_mfma_f32_16x16x32_bf16 v[64:67], v[24:27], a[68:71], v[64:67]
s_waitcnt lgkmcnt(4)
v_mfma_f32_16x16x32_bf16 v[52:55], v[28:31], a[72:75], v[52:55]
ds_read_b128 v[20:23], v12 offset:16640
v_mfma_f32_16x16x32_bf16 v[56:59], v[28:31], a[76:79], v[56:59]
v_mfma_f32_16x16x32_bf16 v[60:63], v[32:35], a[72:75], v[60:63]
ds_read_b128 v[24:27], v12 offset:20736
s_add_u32 s24, s24, 1
v_mfma_f32_16x16x32_bf16 v[64:67], v[32:35], a[76:79], v[64:67]
s_waitcnt lgkmcnt(4)
v_mfma_f32_16x16x32_bf16 v[52:55], v[36:39], a[80:83], v[52:55]
ds_read_b128 v[28:31], v13 offset:16640
s_add_u32 m0, s21, 116736
v_mfma_f32_16x16x32_bf16 v[56:59], v[36:39], a[84:87], v[56:59]
buffer_load_dwordx4 v10, s[8:11], s20 offen lds
v_mfma_f32_16x16x32_bf16 v[60:63], v[40:43], a[80:83], v[60:63]
ds_read_b128 v[32:35], v13 offset:20736
v_mfma_f32_16x16x32_bf16 v[64:67], v[40:43], a[84:87], v[64:67]
s_waitcnt lgkmcnt(4)
s_min_u32 s24, s24, 63
v_mfma_f32_16x16x32_bf16 v[52:55], v[44:47], a[88:91], v[52:55]
ds_read_b128 v[36:39], v14 offset:16640
v_mfma_f32_16x16x32_bf16 v[56:59], v[44:47], a[92:95], v[56:59]
v_mfma_f32_16x16x32_bf16 v[60:63], v[48:51], a[88:91], v[60:63]
ds_read_b128 v[40:43], v14 offset:20736
s_lshl_b32 s53, s24, 16
v_mfma_f32_16x16x32_bf16 v[64:67], v[48:51], a[92:95], v[64:67]
s_waitcnt lgkmcnt(4)
v_mfma_f32_16x16x32_bf16 v[52:55], v[20:23], a[96:99], v[52:55]
ds_read_b128 v[44:47], v15 offset:16640
s_add_u32 m0, s21, 117760
v_mfma_f32_16x16x32_bf16 v[56:59], v[20:23], a[100:103], v[56:59]
buffer_load_dwordx4 v11, s[8:11], s20 offen lds
v_mfma_f32_16x16x32_bf16 v[60:63], v[24:27], a[96:99], v[60:63]
ds_read_b128 v[48:51], v15 offset:20736
v_mfma_f32_16x16x32_bf16 v[64:67], v[24:27], a[100:103], v[64:67]
s_waitcnt lgkmcnt(4)
v_mfma_f32_16x16x32_bf16 v[52:55], v[28:31], a[104:107], v[52:55]
s_waitcnt vmcnt(20)
s_barrier
ds_read_b128 v[20:23], v12 offset:32768
v_mfma_f32_16x16x32_bf16 v[56:59], v[28:31], a[108:111], v[56:59]
s_mov_b32 s20, s53
v_mfma_f32_16x16x32_bf16 v[60:63], v[32:35], a[104:107], v[60:63]
ds_read_b128 v[24:27], v12 offset:36864
v_mfma_f32_16x16x32_bf16 v[64:67], v[32:35], a[108:111], v[64:67]
s_waitcnt lgkmcnt(4)
v_mfma_f32_16x16x32_bf16 v[52:55], v[36:39], a[112:115], v[52:55]
ds_read_b128 v[28:31], v13 offset:32768
s_add_u32 m0, s21, 0
v_mfma_f32_16x16x32_bf16 v[56:59], v[36:39], a[116:119], v[56:59]
buffer_load_dwordx4 v8, s[8:11], s20 offen lds
v_mfma_f32_16x16x32_bf16 v[60:63], v[40:43], a[112:115], v[60:63]
ds_read_b128 v[32:35], v13 offset:36864
v_mfma_f32_16x16x32_bf16 v[64:67], v[40:43], a[116:119], v[64:67]
s_waitcnt lgkmcnt(4)
v_mfma_f32_16x16x32_bf16 v[52:55], v[44:47], a[120:123], v[52:55]
ds_read_b128 v[36:39], v14 offset:32768
v_mfma_f32_16x16x32_bf16 v[56:59], v[44:47], a[124:127], v[56:59]
v_mfma_f32_16x16x32_bf16 v[60:63], v[48:51], a[120:123], v[60:63]
ds_read_b128 v[40:43], v14 offset:36864
v_mfma_f32_16x16x32_bf16 v[64:67], v[48:51], a[124:127], v[64:67]
s_waitcnt lgkmcnt(4)
v_mfma_f32_16x16x32_bf16 v[52:55], v[20:23], a[128:131], v[52:55]
ds_read_b128 v[44:47], v15 offset:32768
s_add_u32 m0, s21, 1024
v_mfma_f32_16x16x32_bf16 v[56:59], v[20:23], a[132:135], v[56:59]
buffer_load_dwordx4 v9, s[8:11], s20 offen lds
v_mfma_f32_16x16x32_bf16 v[60:63], v[24:27], a[128:131], v[60:63]
ds_read_b128 v[48:51], v15 offset:36864
v_mfma_f32_16x16x32_bf16 v[64:67], v[24:27], a[132:135], v[64:67]
s_waitcnt lgkmcnt(4)
v_mfma_f32_16x16x32_bf16 v[52:55], v[28:31], a[136:139], v[52:55]
ds_read_b128 v[20:23], v12 offset:33024
v_mfma_f32_16x16x32_bf16 v[56:59], v[28:31], a[140:143], v[56:59]
v_mfma_f32_16x16x32_bf16 v[60:63], v[32:35], a[136:139], v[60:63]
ds_read_b128 v[24:27], v12 offset:37120
v_mfma_f32_16x16x32_bf16 v[64:67], v[32:35], a[140:143], v[64:67]
s_waitcnt lgkmcnt(4)
v_mfma_f32_16x16x32_bf16 v[52:55], v[36:39], a[144:147], v[52:55]
ds_read_b128 v[28:31], v13 offset:33024
s_add_u32 m0, s21, 2048
v_mfma_f32_16x16x32_bf16 v[56:59], v[36:39], a[148:151], v[56:59]
buffer_load_dwordx4 v10, s[8:11], s20 offen lds
v_mfma_f32_16x16x32_bf16 v[60:63], v[40:43], a[144:147], v[60:63]
ds_read_b128 v[32:35], v13 offset:37120
v_mfma_f32_16x16x32_bf16 v[64:67], v[40:43], a[148:151], v[64:67]
s_waitcnt lgkmcnt(4)
v_mfma_f32_16x16x32_bf16 v[52:55], v[44:47], a[152:155], v[52:55]
ds_read_b128 v[36:39], v14 offset:33024
v_mfma_f32_16x16x32_bf16 v[56:59], v[44:47], a[156:159], v[56:59]
v_mfma_f32_16x16x32_bf16 v[60:63], v[48:51], a[152:155], v[60:63]
ds_read_b128 v[40:43], v14 offset:37120
v_mfma_f32_16x16x32_bf16 v[64:67], v[48:51], a[156:159], v[64:67]
s_waitcnt lgkmcnt(4)
v_mfma_f32_16x16x32_bf16 v[52:55], v[20:23], a[160:163], v[52:55]
ds_read_b128 v[44:47], v15 offset:33024
s_add_u32 m0, s21, 3072
v_mfma_f32_16x16x32_bf16 v[56:59], v[20:23], a[164:167], v[56:59]
buffer_load_dwordx4 v11, s[8:11], s20 offen lds
v_mfma_f32_16x16x32_bf16 v[60:63], v[24:27], a[160:163], v[60:63]
ds_read_b128 v[48:51], v15 offset:37120
v_mfma_f32_16x16x32_bf16 v[64:67], v[24:27], a[164:167], v[64:67]
s_waitcnt lgkmcnt(4)
v_mfma_f32_16x16x32_bf16 v[52:55], v[28:31], a[168:171], v[52:55]
s_waitcnt vmcnt(7)
s_barrier
ds_read_b128 v[20:23], v12 offset:49152
v_mfma_f32_16x16x32_bf16 v[56:59], v[28:31], a[172:175], v[56:59]
s_add_u32 s20, s20, 512
buffer_atomic_add v84, v85, s[12:15], s39 offen sc1
v_mfma_f32_16x16x32_bf16 v[60:63], v[32:35], a[168:171], v[60:63]
ds_read_b128 v[24:27], v12 offset:53248
s_mov_b32 s37, 1
v_mfma_f32_16x16x32_bf16 v[64:67], v[32:35], a[172:175], v[64:67]
s_waitcnt lgkmcnt(4)
v_mfma_f32_16x16x32_bf16 v[52:55], v[36:39], a[176:179], v[52:55]
ds_read_b128 v[28:31], v13 offset:49152
s_add_u32 m0, s21, 16384
v_mfma_f32_16x16x32_bf16 v[56:59], v[36:39], a[180:183], v[56:59]
buffer_load_dwordx4 v8, s[8:11], s20 offen lds
v_mfma_f32_16x16x32_bf16 v[60:63], v[40:43], a[176:179], v[60:63]
ds_read_b128 v[32:35], v13 offset:53248
v_mfma_f32_16x16x32_bf16 v[64:67], v[40:43], a[180:183], v[64:67]
s_waitcnt lgkmcnt(4)
v_mfma_f32_16x16x32_bf16 v[52:55], v[44:47], a[184:187], v[52:55]
ds_read_b128 v[36:39], v14 offset:49152
v_mfma_f32_16x16x32_bf16 v[56:59], v[44:47], a[188:191], v[56:59]
v_mfma_f32_16x16x32_bf16 v[60:63], v[48:51], a[184:187], v[60:63]
ds_read_b128 v[40:43], v14 offset:53248
v_mfma_f32_16x16x32_bf16 v[64:67], v[48:51], a[188:191], v[64:67]
s_waitcnt lgkmcnt(4)
v_mfma_f32_16x16x32_bf16 v[52:55], v[20:23], a[192:195], v[52:55]
ds_read_b128 v[44:47], v15 offset:49152
s_add_u32 m0, s21, 17408
v_mfma_f32_16x16x32_bf16 v[56:59], v[20:23], a[196:199], v[56:59]
buffer_load_dwordx4 v9, s[8:11], s20 offen lds
v_mfma_f32_16x16x32_bf16 v[60:63], v[24:27], a[192:195], v[60:63]
ds_read_b128 v[48:51], v15 offset:53248
v_mfma_f32_16x16x32_bf16 v[64:67], v[24:27], a[196:199], v[64:67]
s_waitcnt lgkmcnt(4)
v_mfma_f32_16x16x32_bf16 v[52:55], v[28:31], a[200:203], v[52:55]
ds_read_b128 v[20:23], v12 offset:49408
v_mfma_f32_16x16x32_bf16 v[56:59], v[28:31], a[204:207], v[56:59]
v_mfma_f32_16x16x32_bf16 v[60:63], v[32:35], a[200:203], v[60:63]
ds_read_b128 v[24:27], v12 offset:53504
v_mfma_f32_16x16x32_bf16 v[64:67], v[32:35], a[204:207], v[64:67]
s_waitcnt lgkmcnt(4)
v_mfma_f32_16x16x32_bf16 v[52:55], v[36:39], a[208:211], v[52:55]
ds_read_b128 v[28:31], v13 offset:49408
s_add_u32 m0, s21, 18432
v_mfma_f32_16x16x32_bf16 v[56:59], v[36:39], a[212:215], v[56:59]
buffer_load_dwordx4 v10, s[8:11], s20 offen lds
v_mfma_f32_16x16x32_bf16 v[60:63], v[40:43], a[208:211], v[60:63]
ds_read_b128 v[32:35], v13 offset:53504
v_mfma_f32_16x16x32_bf16 v[64:67], v[40:43], a[212:215], v[64:67]
s_waitcnt lgkmcnt(4)
v_mfma_f32_16x16x32_bf16 v[52:55], v[44:47], a[216:219], v[52:55]
ds_read_b128 v[36:39], v14 offset:49408
v_mfma_f32_16x16x32_bf16 v[56:59], v[44:47], a[220:223], v[56:59]
v_mfma_f32_16x16x32_bf16 v[60:63], v[48:51], a[216:219], v[60:63]
ds_read_b128 v[40:43], v14 offset:53504
v_mfma_f32_16x16x32_bf16 v[64:67], v[48:51], a[220:223], v[64:67]
s_waitcnt lgkmcnt(4)
v_mfma_f32_16x16x32_bf16 v[52:55], v[20:23], a[224:227], v[52:55]
ds_read_b128 v[44:47], v15 offset:49408
s_add_u32 m0, s21, 19456
v_mfma_f32_16x16x32_bf16 v[56:59], v[20:23], a[228:231], v[56:59]
buffer_load_dwordx4 v11, s[8:11], s20 offen lds
v_mfma_f32_16x16x32_bf16 v[60:63], v[24:27], a[224:227], v[60:63]
ds_read_b128 v[48:51], v15 offset:53504
v_mfma_f32_16x16x32_bf16 v[64:67], v[24:27], a[228:231], v[64:67]
s_waitcnt lgkmcnt(4)
v_mfma_f32_16x16x32_bf16 v[52:55], v[28:31], a[232:235], v[52:55]
s_waitcnt vmcnt(20)
s_barrier
ds_read_b128 v[20:23], v16 offset:0
v_mfma_f32_16x16x32_bf16 v[56:59], v[28:31], a[236:239], v[56:59]
s_add_u32 s20, s20, 512
v_mfma_f32_16x16x32_bf16 v[60:63], v[32:35], a[232:235], v[60:63]
ds_read_b128 v[24:27], v16 offset:4096
v_mfma_f32_16x16x32_bf16 v[64:67], v[32:35], a[236:239], v[64:67]
s_waitcnt lgkmcnt(4)
v_mfma_f32_16x16x32_bf16 v[52:55], v[36:39], a[240:243], v[52:55]
ds_read_b128 v[28:31], v17 offset:0
s_add_u32 m0, s21, 32768
v_mfma_f32_16x16x32_bf16 v[56:59], v[36:39], a[244:247], v[56:59]
buffer_load_dwordx4 v8, s[8:11], s20 offen lds
v_mfma_f32_16x16x32_bf16 v[60:63], v[40:43], a[240:243], v[60:63]
ds_read_b128 v[32:35], v17 offset:4096
v_mfma_f32_16x16x32_bf16 v[64:67], v[40:43], a[244:247], v[64:67]
s_waitcnt lgkmcnt(4)
v_mfma_f32_16x16x32_bf16 v[52:55], v[44:47], a[248:251], v[52:55]
ds_read_b128 v[36:39], v18 offset:0
v_mfma_f32_16x16x32_bf16 v[56:59], v[44:47], a[252:255], v[56:59]
v_mfma_f32_16x16x32_bf16 v[60:63], v[48:51], a[248:251], v[60:63]
ds_read_b128 v[40:43], v18 offset:4096
v_mfma_f32_16x16x32_bf16 v[64:67], v[48:51], a[252:255], v[64:67]
s_waitcnt lgkmcnt(4)
s_add_u32 s22, s22, 1
s_cmp_ge_u32 s22, s23
s_cbranch_scc1 L_fl0_446
v_mfma_f32_16x16x32_bf16 v[68:71], v[20:23], a[0:3], 0
ds_read_b128 v[44:47], v19 offset:0
s_add_u32 m0, s21, 33792
s_sub_u32 s39, s22, 1
v_mfma_f32_16x16x32_bf16 v[72:75], v[20:23], a[4:7], 0
buffer_load_dwordx4 v9, s[8:11], s20 offen lds
s_bitcmp1_b32 s39, 1
s_cselect_b32 s38, s55, s54
v_mfma_f32_16x16x32_bf16 v[76:79], v[24:27], a[0:3], 0
ds_read_b128 v[48:51], v19 offset:4096
v_mfma_f32_16x16x32_bf16 v[80:83], v[24:27], a[4:7], 0
s_waitcnt lgkmcnt(4)
s_add_u32 s38, s38, s44
v_mfma_f32_16x16x32_bf16 v[68:71], v[28:31], a[8:11], v[68:71]
ds_read_b128 v[20:23], v16 offset:256
s_lshl_b32 s42, s39, 20
v_mfma_f32_16x16x32_bf16 v[72:75], v[28:31], a[12:15], v[72:75]
s_add_u32 s38, s38, s42
s_lshl_b32 s39, s39, 7
v_mfma_f32_16x16x32_bf16 v[76:79], v[32:35], a[8:11], v[76:79]
ds_read_b128 v[24:27], v16 offset:4352
s_add_u32 s39, s39, 0x5900000
s_cmp_eq_u32 s37, 0
s_cselect_b32 s38, 0x7ff00000, s38
s_cselect_b32 s39, 0x7ff00000, s39
v_mfma_f32_16x16x32_bf16 v[80:83], v[32:35], a[12:15], v[80:83]
s_waitcnt lgkmcnt(4)
v_mfma_f32_16x16x32_bf16 v[68:71], v[36:39], a[16:19], v[68:71]
ds_read_b128 v[28:31], v17 offset:256
s_add_u32 m0, s21, 34816
v_mfma_f32_16x16x32_bf16 v[72:75], v[36:39], a[20:23], v[72:75]
buffer_load_dwordx4 v10, s[8:11], s20 offen lds
v_mfma_f32_16x16x32_bf16 v[76:79], v[40:43], a[16:19], v[76:79]
ds_read_b128 v[32:35], v17 offset:4352
v_cvt_pk_bf16_f32 v88, v52, v53
v_mfma_f32_16x16x32_bf16 v[80:83], v[40:43], a[20:23], v[80:83]
s_waitcnt lgkmcnt(4)
v_cvt_pk_bf16_f32 v89, v54, v55
v_cvt_pk_bf16_f32 v90, v60, v61
v_mfma_f32_16x16x32_bf16 v[68:71], v[44:47], a[24:27], v[68:71]
ds_read_b128 v[36:39], v18 offset:256
v_cvt_pk_bf16_f32 v91, v62, v63
v_mfma_f32_16x16x32_bf16 v[72:75], v[44:47], a[28:31], v[72:75]
buffer_store_dwordx4 v[88:91], v86, s[12:15], s38 offen offset:2048 sc1
v_mfma_f32_16x16x32_bf16 v[76:79], v[48:51], a[24:27], v[76:79]
ds_read_b128 v[40:43], v18 offset:4352
v_cvt_pk_bf16_f32 v92, v56, v57
v_mfma_f32_16x16x32_bf16 v[80:83], v[48:51], a[28:31], v[80:83]
s_waitcnt lgkmcnt(4)
v_cvt_pk_bf16_f32 v93, v58, v59
v_mfma_f32_16x16x32_bf16 v[68:71], v[20:23], a[32:35], v[68:71]
ds_read_b128 v[44:47], v19 offset:256
s_add_u32 m0, s21, 35840
v_mfma_f32_16x16x32_bf16 v[72:75], v[20:23], a[36:39], v[72:75]
buffer_load_dwordx4 v11, s[8:11], s20 offen lds
v_mfma_f32_16x16x32_bf16 v[76:79], v[24:27], a[32:35], v[76:79]
ds_read_b128 v[48:51], v19 offset:4352
v_cvt_pk_bf16_f32 v94, v64, v65
v_mfma_f32_16x16x32_bf16 v[80:83], v[24:27], a[36:39], v[80:83]
s_waitcnt lgkmcnt(4)
v_cvt_pk_bf16_f32 v95, v66, v67
v_mfma_f32_16x16x32_bf16 v[68:71], v[28:31], a[40:43], v[68:71]
s_waitcnt vmcnt(20)
s_barrier
ds_read_b128 v[20:23], v16 offset:16384
v_mfma_f32_16x16x32_bf16 v[72:75], v[28:31], a[44:47], v[72:75]
s_add_u32 s20, s20, 512
buffer_store_dwordx4 v[92:95], v86, s[12:15], s38 offen offset:2176 sc1
v_mfma_f32_16x16x32_bf16 v[76:79], v[32:35], a[40:43], v[76:79]
ds_read_b128 v[24:27], v16 offset:20480
s_add_u32 s42, s38, 0x8000000
v_mfma_f32_16x16x32_bf16 v[80:83], v[32:35], a[44:47], v[80:83]
s_waitcnt lgkmcnt(4)
v_mfma_f32_16x16x32_bf16 v[68:71], v[36:39], a[48:51], v[68:71]
ds_read_b128 v[28:31], v17 offset:16384
s_add_u32 m0, s21, 49152
v_mfma_f32_16x16x32_bf16 v[72:75], v[36:39], a[52:55], v[72:75]
buffer_load_dwordx4 v8, s[8:11], s20 offen lds
v_mfma_f32_16x16x32_bf16 v[76:79], v[40:43], a[48:51], v[76:79]
ds_read_b128 v[32:35], v17 offset:20480
v_mfma_f32_16x16x32_bf16 v[80:83], v[40:43], a[52:55], v[80:83]
s_waitcnt lgkmcnt(4)
v_mfma_f32_16x16x32_bf16 v[68:71], v[44:47], a[56:59], v[68:71]
ds_read_b128 v[36:39], v18 offset:16384
v_mfma_f32_16x16x32_bf16 v[72:75], v[44:47], a[60:63], v[72:75]
buffer_store_dwordx2 v[96:97], v101, s[12:15], s42 offen offset:512 sc1
v_mfma_f32_16x16x32_bf16 v[76:79], v[48:51], a[56:59], v[76:79]
ds_read_b128 v[40:43], v18 offset:20480
v_mfma_f32_16x16x32_bf16 v[80:83], v[48:51], a[60:63], v[80:83]
s_waitcnt lgkmcnt(4)
v_mfma_f32_16x16x32_bf16 v[68:71], v[20:23], a[64:67], v[68:71]
ds_read_b128 v[44:47], v19 offset:16384
s_add_u32 m0, s21, 50176
v_mfma_f32_16x16x32_bf16 v[72:75], v[20:23], a[68:71], v[72:75]
buffer_load_dwordx4 v9, s[8:11], s20 offen lds
v_mfma_f32_16x16x32_bf16 v[76:79], v[24:27], a[64:67], v[76:79]
ds_read_b128 v[48:51], v19 offset:20480
v_mfma_f32_16x16x32_bf16 v[80:83], v[24:27], a[68:71], v[80:83]
s_waitcnt lgkmcnt(4)
v_mfma_f32_16x16x32_bf16 v[68:71], v[28:31], a[72:75], v[68:71]
ds_read_b128 v[20:23], v16 offset:16640
v_mfma_f32_16x16x32_bf16 v[72:75], v[28:31], a[76:79], v[72:75]
v_mfma_f32_16x16x32_bf16 v[76:79], v[32:35], a[72:75], v[76:79]
ds_read_b128 v[24:27], v16 offset:20736
s_add_u32 s24, s24, 1
v_mfma_f32_16x16x32_bf16 v[80:83], v[32:35], a[76:79], v[80:83]
s_waitcnt lgkmcnt(4)
v_mfma_f32_16x16x32_bf16 v[68:71], v[36:39], a[80:83], v[68:71]
ds_read_b128 v[28:31], v17 offset:16640
s_add_u32 m0, s21, 51200
v_mfma_f32_16x16x32_bf16 v[72:75], v[36:39], a[84:87], v[72:75]
buffer_load_dwordx4 v10, s[8:11], s20 offen lds
v_mfma_f32_16x16x32_bf16 v[76:79], v[40:43], a[80:83], v[76:79]
ds_read_b128 v[32:35], v17 offset:20736
v_mfma_f32_16x16x32_bf16 v[80:83], v[40:43], a[84:87], v[80:83]
s_waitcnt lgkmcnt(4)
s_min_u32 s24, s24, 63
v_mfma_f32_16x16x32_bf16 v[68:71], v[44:47], a[88:91], v[68:71]
ds_read_b128 v[36:39], v18 offset:16640
v_mfma_f32_16x16x32_bf16 v[72:75], v[44:47], a[92:95], v[72:75]
v_mfma_f32_16x16x32_bf16 v[76:79], v[48:51], a[88:91], v[76:79]
ds_read_b128 v[40:43], v18 offset:20736
s_lshl_b32 s53, s24, 16
v_mfma_f32_16x16x32_bf16 v[80:83], v[48:51], a[92:95], v[80:83]
s_waitcnt lgkmcnt(4)
v_mfma_f32_16x16x32_bf16 v[68:71], v[20:23], a[96:99], v[68:71]
ds_read_b128 v[44:47], v19 offset:16640
s_add_u32 m0, s21, 52224
v_mfma_f32_16x16x32_bf16 v[72:75], v[20:23], a[100:103], v[72:75]
buffer_load_dwordx4 v11, s[8:11], s20 offen lds
v_mfma_f32_16x16x32_bf16 v[76:79], v[24:27], a[96:99], v[76:79]
ds_read_b128 v[48:51], v19 offset:20736
v_mfma_f32_16x16x32_bf16 v[80:83], v[24:27], a[100:103], v[80:83]
s_waitcnt lgkmcnt(4)
v_mfma_f32_16x16x32_bf16 v[68:71], v[28:31], a[104:107], v[68:71]
s_waitcnt vmcnt(20)
s_barrier
ds_read_b128 v[20:23], v16 offset:32768
v_mfma_f32_16x16x32_bf16 v[72:75], v[28:31], a[108:111], v[72:75]
s_mov_b32 s20, s53
v_mfma_f32_16x16x32_bf16 v[76:79], v[32:35], a[104:107], v[76:79]
ds_read_b128 v[24:27], v16 offset:36864
v_mfma_f32_16x16x32_bf16 v[80:83], v[32:35], a[108:111], v[80:83]
s_waitcnt lgkmcnt(4)
v_mfma_f32_16x16x32_bf16 v[68:71], v[36:39], a[112:115], v[68:71]
ds_read_b128 v[28:31], v17 offset:32768
s_add_u32 m0, s21, 65536
v_mfma_f32_16x16x32_bf16 v[72:75], v[36:39], a[116:119], v[72:75]
buffer_load_dwordx4 v8, s[8:11], s20 offen lds
v_mfma_f32_16x16x32_bf16 v[76:79], v[40:43], a[112:115], v[76:79]
ds_read_b128 v[32:35], v17 offset:36864
v_mfma_f32_16x16x32_bf16 v[80:83], v[40:43], a[116:119], v[80:83]
s_waitcnt lgkmcnt(4)
v_mfma_f32_16x16x32_bf16 v[68:71], v[44:47], a[120:123], v[68:71]
ds_read_b128 v[36:39], v18 offset:32768
v_mfma_f32_16x16x32_bf16 v[72:75], v[44:47], a[124:127], v[72:75]
v_mfma_f32_16x16x32_bf16 v[76:79], v[48:51], a[120:123], v[76:79]
ds_read_b128 v[40:43], v18 offset:36864
v_mfma_f32_16x16x32_bf16 v[80:83], v[48:51], a[124:127], v[80:83]
s_waitcnt lgkmcnt(4)
v_mfma_f32_16x16x32_bf16 v[68:71], v[20:23], a[128:131], v[68:71]
ds_read_b128 v[44:47], v19 offset:32768
s_add_u32 m0, s21, 66560
v_mfma_f32_16x16x32_bf16 v[72:75], v[20:23], a[132:135], v[72:75]
buffer_load_dwordx4 v9, s[8:11], s20 offen lds
v_mfma_f32_16x16x32_bf16 v[76:79], v[24:27], a[128:131], v[76:79]
ds_read_b128 v[48:51], v19 offset:36864
v_mfma_f32_16x16x32_bf16 v[80:83], v[24:27], a[132:135], v[80:83]
s_waitcnt lgkmcnt(4)
v_mfma_f32_16x16x32_bf16 v[68:71], v[28:31], a[136:139], v[68:71]
ds_read_b128 v[20:23], v16 offset:33024
v_mfma_f32_16x16x32_bf16 v[72:75], v[28:31], a[140:143], v[72:75]
v_mfma_f32_16x16x32_bf16 v[76:79], v[32:35], a[136:139], v[76:79]
ds_read_b128 v[24:27], v16 offset:37120
v_mfma_f32_16x16x32_bf16 v[80:83], v[32:35], a[140:143], v[80:83]
s_waitcnt lgkmcnt(4)
v_mfma_f32_16x16x32_bf16 v[68:71], v[36:39], a[144:147], v[68:71]
ds_read_b128 v[28:31], v17 offset:33024
s_add_u32 m0, s21, 67584
v_mfma_f32_16x16x32_bf16 v[72:75], v[36:39], a[148:151], v[72:75]
buffer_load_dwordx4 v10, s[8:11], s20 offen lds
v_mfma_f32_16x16x32_bf16 v[76:79], v[40:43], a[144:147], v[76:79]
ds_read_b128 v[32:35], v17 offset:37120
v_mfma_f32_16x16x32_bf16 v[80:83], v[40:43], a[148:151], v[80:83]
s_waitcnt lgkmcnt(4)
v_mfma_f32_16x16x32_bf16 v[68:71], v[44:47], a[152:155], v[68:71]
ds_read_b128 v[36:39], v18 offset:33024
v_mfma_f32_16x16x32_bf16 v[72:75], v[44:47], a[156:159], v[72:75]
v_mfma_f32_16x16x32_bf16 v[76:79], v[48:51], a[152:155], v[76:79]
ds_read_b128 v[40:43], v18 offset:37120
v_mfma_f32_16x16x32_bf16 v[80:83], v[48:51], a[156:159], v[80:83]
s_waitcnt lgkmcnt(4)
v_mfma_f32_16x16x32_bf16 v[68:71], v[20:23], a[160:163], v[68:71]
ds_read_b128 v[44:47], v19 offset:33024
s_add_u32 m0, s21, 68608
v_mfma_f32_16x16x32_bf16 v[72:75], v[20:23], a[164:167], v[72:75]
buffer_load_dwordx4 v11, s[8:11], s20 offen lds
v_mfma_f32_16x16x32_bf16 v[76:79], v[24:27], a[160:163], v[76:79]
ds_read_b128 v[48:51], v19 offset:37120
v_mfma_f32_16x16x32_bf16 v[80:83], v[24:27], a[164:167], v[80:83]
s_waitcnt lgkmcnt(4)
v_mfma_f32_16x16x32_bf16 v[68:71], v[28:31], a[168:171], v[68:71]
s_waitcnt vmcnt(7)
s_barrier
ds_read_b128 v[20:23], v16 offset:49152
v_mfma_f32_16x16x32_bf16 v[72:75], v[28:31], a[172:175], v[72:75]
s_add_u32 s20, s20, 512
buffer_atomic_add v84, v85, s[12:15], s39 offen sc1
v_mfma_f32_16x16x32_bf16 v[76:79], v[32:35], a[168:171], v[76:79]
ds_read_b128 v[24:27], v16 offset:53248
s_mov_b32 s37, 1
v_mfma_f32_16x16x32_bf16 v[80:83], v[32:35], a[172:175], v[80:83]
s_waitcnt lgkmcnt(4)
v_mfma_f32_16x16x32_bf16 v[68:71], v[36:39], a[176:179], v[68:71]
ds_read_b128 v[28:31], v17 offset:49152
s_add_u32 m0, s21, 81920
v_mfma_f32_16x16x32_bf16 v[72:75], v[36:39], a[180:183], v[72:75]
buffer_load_dwordx4 v8, s[8:11], s20 offen lds
v_mfma_f32_16x16x32_bf16 v[76:79], v[40:43], a[176:179], v[76:79]
ds_read_b128 v[32:35], v17 offset:53248
v_mfma_f32_16x16x32_bf16 v[80:83], v[40:43], a[180:183], v[80:83]
s_waitcnt lgkmcnt(4)
v_mfma_f32_16x16x32_bf16 v[68:71], v[44:47], a[184:187], v[68:71]
ds_read_b128 v[36:39], v18 offset:49152
v_mfma_f32_16x16x32_bf16 v[72:75], v[44:47], a[188:191], v[72:75]
v_mfma_f32_16x16x32_bf16 v[76:79], v[48:51], a[184:187], v[76:79]
ds_read_b128 v[40:43], v18 offset:53248
v_mfma_f32_16x16x32_bf16 v[80:83], v[48:51], a[188:191], v[80:83]
s_waitcnt lgkmcnt(4)
v_mfma_f32_16x16x32_bf16 v[68:71], v[20:23], a[192:195], v[68:71]
ds_read_b128 v[44:47], v19 offset:49152
s_add_u32 m0, s21, 82944
v_mfma_f32_16x16x32_bf16 v[72:75], v[20:23], a[196:199], v[72:75]
buffer_load_dwordx4 v9, s[8:11], s20 offen lds
v_mfma_f32_16x16x32_bf16 v[76:79], v[24:27], a[192:195], v[76:79]
ds_read_b128 v[48:51], v19 offset:53248
v_mfma_f32_16x16x32_bf16 v[80:83], v[24:27], a[196:199], v[80:83]
s_waitcnt lgkmcnt(4)
v_mfma_f32_16x16x32_bf16 v[68:71], v[28:31], a[200:203], v[68:71]
ds_read_b128 v[20:23], v16 offset:49408
v_mfma_f32_16x16x32_bf16 v[72:75], v[28:31], a[204:207], v[72:75]
v_mfma_f32_16x16x32_bf16 v[76:79], v[32:35], a[200:203], v[76:79]
ds_read_b128 v[24:27], v16 offset:53504
v_mfma_f32_16x16x32_bf16 v[80:83], v[32:35], a[204:207], v[80:83]
s_waitcnt lgkmcnt(4)
v_mfma_f32_16x16x32_bf16 v[68:71], v[36:39], a[208:211], v[68:71]
ds_read_b128 v[28:31], v17 offset:49408
s_add_u32 m0, s21, 83968
v_mfma_f32_16x16x32_bf16 v[72:75], v[36:39], a[212:215], v[72:75]
buffer_load_dwordx4 v10, s[8:11], s20 offen lds
v_mfma_f32_16x16x32_bf16 v[76:79], v[40:43], a[208:211], v[76:79]
ds_read_b128 v[32:35], v17 offset:53504
v_mfma_f32_16x16x32_bf16 v[80:83], v[40:43], a[212:215], v[80:83]
s_waitcnt lgkmcnt(4)
v_mfma_f32_16x16x32_bf16 v[68:71], v[44:47], a[216:219], v[68:71]
ds_read_b128 v[36:39], v18 offset:49408
v_mfma_f32_16x16x32_bf16 v[72:75], v[44:47], a[220:223], v[72:75]
v_mfma_f32_16x16x32_bf16 v[76:79], v[48:51], a[216:219], v[76:79]
ds_read_b128 v[40:43], v18 offset:53504
v_mfma_f32_16x16x32_bf16 v[80:83], v[48:51], a[220:223], v[80:83]
s_waitcnt lgkmcnt(4)
v_mfma_f32_16x16x32_bf16 v[68:71], v[20:23], a[224:227], v[68:71]
ds_read_b128 v[44:47], v19 offset:49408
s_add_u32 m0, s21, 84992
v_mfma_f32_16x16x32_bf16 v[72:75], v[20:23], a[228:231], v[72:75]
buffer_load_dwordx4 v11, s[8:11], s20 offen lds
v_mfma_f32_16x16x32_bf16 v[76:79], v[24:27], a[224:227], v[76:79]
ds_read_b128 v[48:51], v19 offset:53504
v_mfma_f32_16x16x32_bf16 v[80:83], v[24:27], a[228:231], v[80:83]
s_waitcnt lgkmcnt(4)
v_mfma_f32_16x16x32_bf16 v[68:71], v[28:31], a[232:235], v[68:71]
s_waitcnt vmcnt(20)
s_barrier
ds_read_b128 v[20:23], v12 offset:0
v_mfma_f32_16x16x32_bf16 v[72:75], v[28:31], a[236:239], v[72:75]
s_add_u32 s20, s20, 512
v_mfma_f32_16x16x32_bf16 v[76:79], v[32:35], a[232:235], v[76:79]
ds_read_b128 v[24:27], v12 offset:4096
v_mfma_f32_16x16x32_bf16 v[80:83], v[32:35], a[236:239], v[80:83]
s_waitcnt lgkmcnt(4)
v_mfma_f32_16x16x32_bf16 v[68:71], v[36:39], a[240:243], v[68:71]
ds_read_b128 v[28:31], v13 offset:0
s_add_u32 m0, s21, 98304
v_mfma_f32_16x16x32_bf16 v[72:75], v[36:39], a[244:247], v[72:75]
buffer_load_dwordx4 v8, s[8:11], s20 offen lds
v_mfma_f32_16x16x32_bf16 v[76:79], v[40:43], a[240:243], v[76:79]
ds_read_b128 v[32:35], v13 offset:4096
v_mfma_f32_16x16x32_bf16 v[80:83], v[40:43], a[244:247], v[80:83]
s_waitcnt lgkmcnt(4)
v_mfma_f32_16x16x32_bf16 v[68:71], v[44:47], a[248:251], v[68:71]
ds_read_b128 v[36:39], v14 offset:0
v_mfma_f32_16x16x32_bf16 v[72:75], v[44:47], a[252:255], v[72:75]
v_mfma_f32_16x16x32_bf16 v[76:79], v[48:51], a[248:251], v[76:79]
ds_read_b128 v[40:43], v14 offset:4096
v_mfma_f32_16x16x32_bf16 v[80:83], v[48:51], a[252:255], v[80:83]
s_waitcnt lgkmcnt(4)
s_add_u32 s22, s22, 1
s_cmp_ge_u32 s22, s23
s_cbranch_scc0 L_st_449
L_fl1_447:
s_waitcnt lgkmcnt(0)
s_nop 7
s_sub_u32 s39, s22, 1
s_bitcmp1_b32 s39, 1
s_cselect_b32 s38, s55, s54
s_add_u32 s38, s38, s44
s_lshl_b32 s42, s39, 20
s_add_u32 s38, s38, s42
s_lshl_b32 s39, s39, 7
s_add_u32 s39, s39, 0x5900000
s_cmp_eq_u32 s37, 0
s_cselect_b32 s38, 0x7ff00000, s38
s_cselect_b32 s39, 0x7ff00000, s39
v_cvt_pk_bf16_f32 v88, v68, v69
v_cvt_pk_bf16_f32 v89, v70, v71
v_cvt_pk_bf16_f32 v90, v76, v77
v_cvt_pk_bf16_f32 v91, v78, v79
buffer_store_dwordx4 v[88:91], v86, s[12:15], s38 offen offset:2048 sc1
v_cvt_pk_bf16_f32 v92, v72, v73
v_cvt_pk_bf16_f32 v93, v74, v75
v_cvt_pk_bf16_f32 v94, v80, v81
v_cvt_pk_bf16_f32 v95, v82, v83
buffer_store_dwordx4 v[92:95], v86, s[12:15], s38 offen offset:2176 sc1
s_add_u32 s42, s38, 0x8000000
buffer_store_dwordx2 v[96:97], v101, s[12:15], s42 offen offset:512 sc1
s_waitcnt vmcnt(0)
s_barrier
buffer_atomic_add v84, v85, s[12:15], s39 offen sc1
s_mov_b32 s37, 1
s_branch L_ste_448
L_fl0_446:
s_waitcnt lgkmcnt(0)
s_nop 7
s_sub_u32 s39, s22, 1
s_bitcmp1_b32 s39, 1
s_cselect_b32 s38, s55, s54
s_add_u32 s38, s38, s44
s_lshl_b32 s42, s39, 20
s_add_u32 s38, s38, s42
s_lshl_b32 s39, s39, 7
s_add_u32 s39, s39, 0x5900000
s_cmp_eq_u32 s37, 0
s_cselect_b32 s38, 0x7ff00000, s38
s_cselect_b32 s39, 0x7ff00000, s39
v_cvt_pk_bf16_f32 v88, v52, v53
v_cvt_pk_bf16_f32 v89, v54, v55
v_cvt_pk_bf16_f32 v90, v60, v61
v_cvt_pk_bf16_f32 v91, v62, v63
buffer_store_dwordx4 v[88:91], v86, s[12:15], s38 offen offset:2048 sc1
v_cvt_pk_bf16_f32 v92, v56, v57
v_cvt_pk_bf16_f32 v93, v58, v59
v_cvt_pk_bf16_f32 v94, v64, v65
v_cvt_pk_bf16_f32 v95, v66, v67
buffer_store_dwordx4 v[92:95], v86, s[12:15], s38 offen offset:2176 sc1
s_add_u32 s42, s38, 0x8000000
buffer_store_dwordx2 v[96:97], v101, s[12:15], s42 offen offset:512 sc1
s_waitcnt vmcnt(0)
s_barrier
buffer_atomic_add v84, v85, s[12:15], s39 offen sc1
s_mov_b32 s37, 1
L_ste_448:
s_branch L_op_435
L_q_432:
v_and_b32 v1, 31, v0
v_bfe_u32 v2, v0, 5, 1
v_and_b32 v96, 63, v0
v_lshlrev_b32 v96, 4, v96
v_and_b32 v4, 7, v1
v_lshlrev_b32 v4, 4, v4
s_lshl_b32 s7, s49, 12
s_add_u32 s7, s7, 0x21000
v_lshl_add_u32 v97, v2, 7, v4
v_add_u32 v97, s7, v97
v_bfe_u32 v5, v1, 2, 1
v_lshlrev_b32 v5, 4, v5
v_lshrrev_b32 v6, 3, v1
v_lshl_add_u32 v5, v6, 2, v5
v_and_b32 v6, 3, v1
v_add_u32 v5, v5, v6
v_lshlrev_b32 v5, 4, v5
v_lshl_add_u32 v98, v2, 9, v5
v_lshl_add_u32 v99, v2, 3, v5
v_add_u32 v99, s7, v99
v_lshlrev_b32 v4, 4, v1
v_lshl_add_u32 v100, v2, 10, v4
v_and_b32 v85, 63, v0
v_min_u32 v85, 1, v85
v_lshlrev_b32 v85, 30, v85
v_lshlrev_b32 v4, 2, v2
v_sub_u32 v4, v1, v4
v_mov_b32 v5, 0xff800000
v_cmp_gt_i32 vcc, 0, v4
s_nop 1
v_cndmask_b32 v240, 0, v5, vcc
v_cmp_gt_i32 vcc, 1, v4
s_nop 1
v_cndmask_b32 v241, 0, v5, vcc
v_cmp_gt_i32 vcc, 2, v4
s_nop 1
v_cndmask_b32 v242, 0, v5, vcc
v_cmp_gt_i32 vcc, 3, v4
s_nop 1
v_cndmask_b32 v243, 0, v5, vcc
v_cmp_gt_i32 vcc, 8, v4
s_nop 1
v_cndmask_b32 v244, 0, v5, vcc
v_cmp_gt_i32 vcc, 9, v4
s_nop 1
v_cndmask_b32 v245, 0, v5, vcc
v_cmp_gt_i32 vcc, 10, v4
s_nop 1
v_cndmask_b32 v246, 0, v5, vcc
v_cmp_gt_i32 vcc, 11, v4
s_nop 1
v_cndmask_b32 v247, 0, v5, vcc
v_cmp_gt_i32 vcc, 16, v4
s_nop 1
v_cndmask_b32 v248, 0, v5, vcc
v_cmp_gt_i32 vcc, 17, v4
s_nop 1
v_cndmask_b32 v249, 0, v5, vcc
v_cmp_gt_i32 vcc, 18, v4
s_nop 1
v_cndmask_b32 v250, 0, v5, vcc
v_cmp_gt_i32 vcc, 19, v4
s_nop 1
v_cndmask_b32 v251, 0, v5, vcc
v_cmp_gt_i32 vcc, 24, v4
s_nop 1
v_cndmask_b32 v252, 0, v5, vcc
v_cmp_gt_i32 vcc, 25, v4
s_nop 1
v_cndmask_b32 v253, 0, v5, vcc
v_cmp_gt_i32 vcc, 26, v4
s_nop 1
v_cndmask_b32 v254, 0, v5, vcc
v_cmp_gt_i32 vcc, 27, v4
s_nop 1
v_cndmask_b32 v255, 0, v5, vcc
s_mov_b32 s47, 0
v_mov_b32 v102, 0x20000
v_lshl_add_u32 v101, v0, 2, v102
v_mov_b32 v103, 4
v_mov_b32 v87, 0
s_mov_b32 s45, 0
s_barrier
s_add_u32 m0, s21, 0
s_nop 0
buffer_load_dwordx4 v8, s[8:11], s20 offen lds
s_add_u32 m0, s21, 1024
s_nop 0
buffer_load_dwordx4 v9, s[8:11], s20 offen lds
s_add_u32 m0, s21, 2048
s_nop 0
buffer_load_dwordx4 v10, s[8:11], s20 offen lds
s_add_u32 m0, s21, 3072
s_nop 0
buffer_load_dwordx4 v11, s[8:11], s20 offen lds
s_add_u32 s20, s20, 512
s_add_u32 m0, s21, 16384
s_nop 0
buffer_load_dwordx4 v8, s[8:11], s20 offen lds
s_add_u32 m0, s21, 17408
s_nop 0
buffer_load_dwordx4 v9, s[8:11], s20 offen lds
s_add_u32 m0, s21, 18432
s_nop 0
buffer_load_dwordx4 v10, s[8:11], s20 offen lds
s_add_u32 m0, s21, 19456
s_nop 0
buffer_load_dwordx4 v11, s[8:11], s20 offen lds
s_add_u32 s20, s20, 512
s_add_u32 m0, s21, 32768
s_nop 0
buffer_load_dwordx4 v8, s[8:11], s20 offen lds
s_add_u32 m0, s21, 33792
s_nop 0
buffer_load_dwordx4 v9, s[8:11], s20 offen lds
s_add_u32 m0, s21, 34816
s_nop 0
buffer_load_dwordx4 v10, s[8:11], s20 offen lds
s_add_u32 m0, s21, 35840
s_nop 0
buffer_load_dwordx4 v11, s[8:11], s20 offen lds
s_add_u32 s20, s20, 512
s_add_u32 m0, s21, 49152
s_nop 0
buffer_load_dwordx4 v8, s[8:11], s20 offen lds
s_add_u32 m0, s21, 50176
s_nop 0
buffer_load_dwordx4 v9, s[8:11], s20 offen lds
s_add_u32 m0, s21, 51200
s_nop 0
buffer_load_dwordx4 v10, s[8:11], s20 offen lds
s_add_u32 m0, s21, 52224
s_nop 0
buffer_load_dwordx4 v11, s[8:11], s20 offen lds
s_add_u32 s24, s24, 1
s_min_u32 s24, s24, 63
s_lshl_b32 s53, s24, 16
s_mov_b32 s20, s53
s_add_u32 m0, s21, 65536
s_nop 0
buffer_load_dwordx4 v8, s[8:11], s20 offen lds
s_add_u32 m0, s21, 66560
s_nop 0
buffer_load_dwordx4 v9, s[8:11], s20 offen lds
s_add_u32 m0, s21, 67584
s_nop 0
buffer_load_dwordx4 v10, s[8:11], s20 offen lds
s_add_u32 m0, s21, 68608
s_nop 0
buffer_load_dwordx4 v11, s[8:11], s20 offen lds
s_add_u32 s20, s20, 512
s_add_u32 m0, s21, 81920
s_nop 0
buffer_load_dwordx4 v8, s[8:11], s20 offen lds
s_add_u32 m0, s21, 82944
s_nop 0
buffer_load_dwordx4 v9, s[8:11], s20 offen lds
s_add_u32 m0, s21, 83968
s_nop 0
buffer_load_dwordx4 v10, s[8:11], s20 offen lds
s_add_u32 m0, s21, 84992
s_nop 0
buffer_load_dwordx4 v11, s[8:11], s20 offen lds
s_add_u32 s20, s20, 512
s_add_u32 m0, s21, 98304
s_nop 0
buffer_load_dwordx4 v8, s[8:11], s20 offen lds
s_waitcnt vmcnt(0)
s_barrier
ds_read_b128 v[20:23], v12 offset:0
ds_read_b128 v[24:27], v12 offset:4096
ds_read_b128 v[28:31], v13 offset:0
ds_read_b128 v[32:35], v13 offset:4096
ds_read_b128 v[36:39], v14 offset:0
ds_read_b128 v[40:43], v14 offset:4096
s_waitcnt lgkmcnt(4)
L_st_459:
v_mfma_f32_16x16x32_bf16 v[52:55], a[0:3], v[20:23], 0
ds_read_b128 v[44:47], v15 offset:0
s_add_u32 m0, s21, 99328
s_sub_u32 s39, s22, 1
v_mfma_f32_16x16x32_bf16 v[56:59], a[4:7], v[20:23], 0
buffer_load_dwordx4 v9, s[8:11], s20 offen lds
v_mfma_f32_16x16x32_bf16 v[60:63], a[0:3], v[24:27], 0
ds_read_b128 v[48:51], v15 offset:4096
s_bitcmp1_b32 s39, 1
s_cselect_b32 s38, s54, s55
v_mfma_f32_16x16x32_bf16 v[64:67], a[4:7], v[24:27], 0
s_waitcnt lgkmcnt(4)
v_mfma_f32_16x16x32_bf16 v[52:55], a[8:11], v[28:31], v[52:55]
ds_read_b128 v[20:23], v12 offset:256
s_add_u32 s38, s38, s44
s_waitcnt vmcnt(5)
v_mfma_f32_16x16x32_bf16 v[56:59], a[12:15], v[28:31], v[56:59]
s_lshl_b32 s42, s39, 20
s_add_u32 s38, s38, s42
ds_write_b32 v101, v87
v_mfma_f32_16x16x32_bf16 v[60:63], a[8:11], v[32:35], v[60:63]
ds_read_b128 v[24:27], v12 offset:4352
s_cmp_eq_u32 s37, 0
s_cselect_b32 s38, 0x7ff00000, s38
v_mfma_f32_16x16x32_bf16 v[64:67], a[12:15], v[32:35], v[64:67]
s_waitcnt lgkmcnt(4)
v_mfma_f32_16x16x32_bf16 v[52:55], a[16:19], v[36:39], v[52:55]
ds_read_b128 v[28:31], v13 offset:256
s_add_u32 m0, s21, 100352
v_mfma_f32_16x16x32_bf16 v[56:59], a[20:23], v[36:39], v[56:59]
buffer_load_dwordx4 v10, s[8:11], s20 offen lds
s_mov_b32 s37, 1
v_mfma_f32_16x16x32_bf16 v[60:63], a[16:19], v[40:43], v[60:63]
ds_read_b128 v[32:35], v13 offset:4352
v_cvt_pk_bf16_f32 v88, v68, v69
v_mfma_f32_16x16x32_bf16 v[64:67], a[20:23], v[40:43], v[64:67]
s_waitcnt lgkmcnt(4)
v_cvt_pk_bf16_f32 v89, v70, v71
v_mfma_f32_16x16x32_bf16 v[52:55], a[24:27], v[44:47], v[52:55]
ds_read_b128 v[36:39], v14 offset:256
v_cvt_pk_bf16_f32 v90, v72, v73
v_mfma_f32_16x16x32_bf16 v[56:59], a[28:31], v[44:47], v[56:59]
v_cvt_pk_bf16_f32 v91, v74, v75
v_mfma_f32_16x16x32_bf16 v[60:63], a[24:27], v[48:51], v[60:63]
ds_read_b128 v[40:43], v14 offset:4352
buffer_store_dwordx4 v[88:91], v86, s[12:15], s38 offen offset:0
v_mfma_f32_16x16x32_bf16 v[64:67], a[28:31], v[48:51], v[64:67]
s_waitcnt lgkmcnt(4)
v_cvt_pk_bf16_f32 v92, v76, v77
v_cvt_pk_bf16_f32 v93, v78, v79
v_mfma_f32_16x16x32_bf16 v[52:55], a[32:35], v[20:23], v[52:55]
ds_read_b128 v[44:47], v15 offset:256
s_add_u32 m0, s21, 101376
v_mfma_f32_16x16x32_bf16 v[56:59], a[36:39], v[20:23], v[56:59]
buffer_load_dwordx4 v11, s[8:11], s20 offen lds
v_cvt_pk_bf16_f32 v94, v80, v81
v_mfma_f32_16x16x32_bf16 v[60:63], a[32:35], v[24:27], v[60:63]
ds_read_b128 v[48:51], v15 offset:4352
v_cvt_pk_bf16_f32 v95, v82, v83
v_mfma_f32_16x16x32_bf16 v[64:67], a[36:39], v[24:27], v[64:67]
s_waitcnt lgkmcnt(4)
buffer_store_dwordx4 v[92:95], v86, s[12:15], s38 offen offset:128
v_mfma_f32_16x16x32_bf16 v[52:55], a[40:43], v[28:31], v[52:55]
s_waitcnt vmcnt(25)
s_barrier
ds_read_b128 v[20:23], v12 offset:16384
v_mfma_f32_16x16x32_bf16 v[56:59], a[44:47], v[28:31], v[56:59]
s_add_u32 s20, s20, 512
v_mfma_f32_16x16x32_bf16 v[60:63], a[40:43], v[32:35], v[60:63]
ds_read_b128 v[24:27], v12 offset:20480
ds_read_b32 v87, v102
v_mfma_f32_16x16x32_bf16 v[64:67], a[44:47], v[32:35], v[64:67]
s_waitcnt lgkmcnt(4)
v_mfma_f32_16x16x32_bf16 v[52:55], a[48:51], v[36:39], v[52:55]
ds_read_b128 v[28:31], v13 offset:16384
s_add_u32 m0, s21, 114688
v_mfma_f32_16x16x32_bf16 v[56:59], a[52:55], v[36:39], v[56:59]
buffer_load_dwordx4 v8, s[8:11], s20 offen lds
v_mfma_f32_16x16x32_bf16 v[60:63], a[48:51], v[40:43], v[60:63]
ds_read_b128 v[32:35], v13 offset:20480
v_mfma_f32_16x16x32_bf16 v[64:67], a[52:55], v[40:43], v[64:67]
s_waitcnt lgkmcnt(4)
v_mfma_f32_16x16x32_bf16 v[52:55], a[56:59], v[44:47], v[52:55]
ds_read_b128 v[36:39], v14 offset:16384
v_mfma_f32_16x16x32_bf16 v[56:59], a[60:63], v[44:47], v[56:59]
v_mfma_f32_16x16x32_bf16 v[60:63], a[56:59], v[48:51], v[60:63]
ds_read_b128 v[40:43], v14 offset:20480
v_mfma_f32_16x16x32_bf16 v[64:67], a[60:63], v[48:51], v[64:67]
s_waitcnt lgkmcnt(4)
v_mfma_f32_16x16x32_bf16 v[52:55], a[64:67], v[20:23], v[52:55]
ds_read_b128 v[44:47], v15 offset:16384
s_add_u32 m0, s21, 115712
v_mfma_f32_16x16x32_bf16 v[56:59], a[68:71], v[20:23], v[56:59]
buffer_load_dwordx4 v9, s[8:11], s20 offen lds
v_mfma_f32_16x16x32_bf16 v[60:63], a[64:67], v[24:27], v[60:63]
ds_read_b128 v[48:51], v15 offset:20480
s_branch L_anext_451
L_attr_452:
v_mfma_f32_16x16x32_bf16 v[64:67], a[68:71], v[24:27], v[64:67]
s_waitcnt lgkmcnt(4)
v_mfma_f32_16x16x32_bf16 v[52:55], a[72:75], v[28:31], v[52:55]
ds_read_b128 v[20:23], v12 offset:16640
v_mfma_f32_16x16x32_bf16 v[56:59], a[76:79], v[28:31], v[56:59]
v_mfma_f32_16x16x32_bf16 v[60:63], a[72:75], v[32:35], v[60:63]
ds_read_b128 v[24:27], v12 offset:20736
s_add_u32 s24, s24, 1
v_mfma_f32_16x16x32_bf16 v[64:67], a[76:79], v[32:35], v[64:67]
s_waitcnt lgkmcnt(4)
v_mfma_f32_16x16x32_bf16 v[52:55], a[80:83], v[36:39], v[52:55]
ds_read_b128 v[28:31], v13 offset:16640
s_add_u32 m0, s21, 116736
v_mfma_f32_16x16x32_bf16 v[56:59], a[84:87], v[36:39], v[56:59]
buffer_load_dwordx4 v10, s[8:11], s20 offen lds
v_mfma_f32_16x16x32_bf16 v[60:63], a[80:83], v[40:43], v[60:63]
ds_read_b128 v[32:35], v13 offset:20736
v_mfma_f32_16x16x32_bf16 v[64:67], a[84:87], v[40:43], v[64:67]
s_waitcnt lgkmcnt(4)
s_min_u32 s24, s24, 63
v_mfma_f32_16x16x32_bf16 v[52:55], a[88:91], v[44:47], v[52:55]
ds_read_b128 v[36:39], v14 offset:16640
v_mfma_f32_16x16x32_bf16 v[56:59], a[92:95], v[44:47], v[56:59]
v_mfma_f32_16x16x32_bf16 v[60:63], a[88:91], v[48:51], v[60:63]
ds_read_b128 v[40:43], v14 offset:20736
s_lshl_b32 s53, s24, 16
v_mfma_f32_16x16x32_bf16 v[64:67], a[92:95], v[48:51], v[64:67]
s_waitcnt lgkmcnt(4)
v_mfma_f32_16x16x32_bf16 v[52:55], a[96:99], v[20:23], v[52:55]
ds_read_b128 v[44:47], v15 offset:16640
s_add_u32 m0, s21, 117760
v_mfma_f32_16x16x32_bf16 v[56:59], a[100:103], v[20:23], v[56:59]
buffer_load_dwordx4 v11, s[8:11], s20 offen lds
v_mfma_f32_16x16x32_bf16 v[60:63], a[96:99], v[24:27], v[60:63]
ds_read_b128 v[48:51], v15 offset:20736
v_mfma_f32_16x16x32_bf16 v[64:67], a[100:103], v[24:27], v[64:67]
s_waitcnt lgkmcnt(4)
v_mfma_f32_16x16x32_bf16 v[52:55], a[104:107], v[28:31], v[52:55]
s_waitcnt vmcnt(24)
s_barrier
ds_read_b128 v[20:23], v12 offset:32768
v_mfma_f32_16x16x32_bf16 v[56:59], a[108:111], v[28:31], v[56:59]
s_mov_b32 s20, s53
v_mfma_f32_16x16x32_bf16 v[60:63], a[104:107], v[32:35], v[60:63]
ds_read_b128 v[24:27], v12 offset:36864
v_mfma_f32_16x16x32_bf16 v[64:67], a[108:111], v[32:35], v[64:67]
s_waitcnt lgkmcnt(4)
v_mfma_f32_16x16x32_bf16 v[52:55], a[112:115], v[36:39], v[52:55]
ds_read_b128 v[28:31], v13 offset:32768
s_add_u32 m0, s21, 0
v_mfma_f32_16x16x32_bf16 v[56:59], a[116:119], v[36:39], v[56:59]
buffer_load_dwordx4 v8, s[8:11], s20 offen lds
v_mfma_f32_16x16x32_bf16 v[60:63], a[112:115], v[40:43], v[60:63]
ds_read_b128 v[32:35], v13 offset:36864
v_mfma_f32_16x16x32_bf16 v[64:67], a[116:119], v[40:43], v[64:67]
s_waitcnt lgkmcnt(4)
v_mfma_f32_16x16x32_bf16 v[52:55], a[120:123], v[44:47], v[52:55]
ds_read_b128 v[36:39], v14 offset:32768
v_mfma_f32_16x16x32_bf16 v[56:59], a[124:127], v[44:47], v[56:59]
v_mfma_f32_16x16x32_bf16 v[60:63], a[120:123], v[48:51], v[60:63]
ds_read_b128 v[40:43], v14 offset:36864
v_mfma_f32_16x16x32_bf16 v[64:67], a[124:127], v[48:51], v[64:67]
s_waitcnt lgkmcnt(4)
v_mfma_f32_16x16x32_bf16 v[52:55], a[128:131], v[20:23], v[52:55]
ds_read_b128 v[44:47], v15 offset:32768
s_add_u32 m0, s21, 1024
v_mfma_f32_16x16x32_bf16 v[56:59], a[132:135], v[20:23], v[56:59]
buffer_load_dwordx4 v9, s[8:11], s20 offen lds
v_mfma_f32_16x16x32_bf16 v[60:63], a[128:131], v[24:27], v[60:63]
ds_read_b128 v[48:51], v15 offset:36864
v_mfma_f32_16x16x32_bf16 v[64:67], a[132:135], v[24:27], v[64:67]
s_waitcnt lgkmcnt(4)
v_mfma_f32_16x16x32_bf16 v[52:55], a[136:139], v[28:31], v[52:55]
ds_read_b128 v[20:23], v12 offset:33024
v_mfma_f32_16x16x32_bf16 v[56:59], a[140:143], v[28:31], v[56:59]
v_mfma_f32_16x16x32_bf16 v[60:63], a[136:139], v[32:35], v[60:63]
ds_read_b128 v[24:27], v12 offset:37120
v_mfma_f32_16x16x32_bf16 v[64:67], a[140:143], v[32:35], v[64:67]
s_waitcnt lgkmcnt(4)
v_mfma_f32_16x16x32_bf16 v[52:55], a[144:147], v[36:39], v[52:55]
ds_read_b128 v[28:31], v13 offset:33024
s_add_u32 m0, s21, 2048
v_mfma_f32_16x16x32_bf16 v[56:59], a[148:151], v[36:39], v[56:59]
buffer_load_dwordx4 v10, s[8:11], s20 offen lds
v_mfma_f32_16x16x32_bf16 v[60:63], a[144:147], v[40:43], v[60:63]
ds_read_b128 v[32:35], v13 offset:37120
v_mfma_f32_16x16x32_bf16 v[64:67], a[148:151], v[40:43], v[64:67]
s_waitcnt lgkmcnt(4)
v_mfma_f32_16x16x32_bf16 v[52:55], a[152:155], v[44:47], v[52:55]
ds_read_b128 v[36:39], v14 offset:33024
v_mfma_f32_16x16x32_bf16 v[56:59], a[156:159], v[44:47], v[56:59]
v_mfma_f32_16x16x32_bf16 v[60:63], a[152:155], v[48:51], v[60:63]
ds_read_b128 v[40:43], v14 offset:37120
v_mfma_f32_16x16x32_bf16 v[64:67], a[156:159], v[48:51], v[64:67]
s_waitcnt lgkmcnt(4)
v_mfma_f32_16x16x32_bf16 v[52:55], a[160:163], v[20:23], v[52:55]
ds_read_b128 v[44:47], v15 offset:33024
s_add_u32 m0, s21, 3072
v_mfma_f32_16x16x32_bf16 v[56:59], a[164:167], v[20:23], v[56:59]
buffer_load_dwordx4 v11, s[8:11], s20 offen lds
v_mfma_f32_16x16x32_bf16 v[60:63], a[160:163], v[24:27], v[60:63]
ds_read_b128 v[48:51], v15 offset:37120
v_mfma_f32_16x16x32_bf16 v[64:67], a[164:167], v[24:27], v[64:67]
s_waitcnt lgkmcnt(4)
v_mfma_f32_16x16x32_bf16 v[52:55], a[168:171], v[28:31], v[52:55]
s_waitcnt vmcnt(23)
s_barrier
ds_read_b128 v[20:23], v12 offset:49152
v_mfma_f32_16x16x32_bf16 v[56:59], a[172:175], v[28:31], v[56:59]
s_add_u32 s20, s20, 512
v_mfma_f32_16x16x32_bf16 v[60:63], a[168:171], v[32:35], v[60:63]
ds_read_b128 v[24:27], v12 offset:53248
v_mfma_f32_16x16x32_bf16 v[64:67], a[172:175], v[32:35], v[64:67]
s_waitcnt lgkmcnt(4)
v_mfma_f32_16x16x32_bf16 v[52:55], a[176:179], v[36:39], v[52:55]
ds_read_b128 v[28:31], v13 offset:49152
s_add_u32 m0, s21, 16384
v_mfma_f32_16x16x32_bf16 v[56:59], a[180:183], v[36:39], v[56:59]
buffer_load_dwordx4 v8, s[8:11], s20 offen lds
v_mfma_f32_16x16x32_bf16 v[60:63], a[176:179], v[40:43], v[60:63]
ds_read_b128 v[32:35], v13 offset:53248
v_mfma_f32_16x16x32_bf16 v[64:67], a[180:183], v[40:43], v[64:67]
s_waitcnt lgkmcnt(4)
v_mfma_f32_16x16x32_bf16 v[52:55], a[184:187], v[44:47], v[52:55]
ds_read_b128 v[36:39], v14 offset:49152
v_mfma_f32_16x16x32_bf16 v[56:59], a[188:191], v[44:47], v[56:59]
v_mfma_f32_16x16x32_bf16 v[60:63], a[184:187], v[48:51], v[60:63]
ds_read_b128 v[40:43], v14 offset:53248
v_mfma_f32_16x16x32_bf16 v[64:67], a[188:191], v[48:51], v[64:67]
s_waitcnt lgkmcnt(4)
v_mfma_f32_16x16x32_bf16 v[52:55], a[192:195], v[20:23], v[52:55]
ds_read_b128 v[44:47], v15 offset:49152
s_add_u32 m0, s21, 17408
v_mfma_f32_16x16x32_bf16 v[56:59], a[196:199], v[20:23], v[56:59]
buffer_load_dwordx4 v9, s[8:11], s20 offen lds
v_mfma_f32_16x16x32_bf16 v[60:63], a[192:195], v[24:27], v[60:63]
ds_read_b128 v[48:51], v15 offset:53248
v_mfma_f32_16x16x32_bf16 v[64:67], a[196:199], v[24:27], v[64:67]
s_waitcnt lgkmcnt(4)
v_mfma_f32_16x16x32_bf16 v[52:55], a[200:203], v[28:31], v[52:55]
ds_read_b128 v[20:23], v12 offset:49408
v_mfma_f32_16x16x32_bf16 v[56:59], a[204:207], v[28:31], v[56:59]
v_mfma_f32_16x16x32_bf16 v[60:63], a[200:203], v[32:35], v[60:63]
ds_read_b128 v[24:27], v12 offset:53504
v_mfma_f32_16x16x32_bf16 v[64:67], a[204:207], v[32:35], v[64:67]
s_waitcnt lgkmcnt(4)
v_mfma_f32_16x16x32_bf16 v[52:55], a[208:211], v[36:39], v[52:55]
ds_read_b128 v[28:31], v13 offset:49408
s_add_u32 m0, s21, 18432
v_mfma_f32_16x16x32_bf16 v[56:59], a[212:215], v[36:39], v[56:59]
buffer_load_dwordx4 v10, s[8:11], s20 offen lds
v_mfma_f32_16x16x32_bf16 v[60:63], a[208:211], v[40:43], v[60:63]
ds_read_b128 v[32:35], v13 offset:53504
v_mfma_f32_16x16x32_bf16 v[64:67], a[212:215], v[40:43], v[64:67]
s_waitcnt lgkmcnt(4)
v_mfma_f32_16x16x32_bf16 v[52:55], a[216:219], v[44:47], v[52:55]
ds_read_b128 v[36:39], v14 offset:49408
v_mfma_f32_16x16x32_bf16 v[56:59], a[220:223], v[44:47], v[56:59]
v_mfma_f32_16x16x32_bf16 v[60:63], a[216:219], v[48:51], v[60:63]
ds_read_b128 v[40:43], v14 offset:53504
v_mfma_f32_16x16x32_bf16 v[64:67], a[220:223], v[48:51], v[64:67]
s_waitcnt lgkmcnt(4)
v_mfma_f32_16x16x32_bf16 v[52:55], a[224:227], v[20:23], v[52:55]
ds_read_b128 v[44:47], v15 offset:49408
s_add_u32 m0, s21, 19456
v_mfma_f32_16x16x32_bf16 v[56:59], a[228:231], v[20:23], v[56:59]
buffer_load_dwordx4 v11, s[8:11], s20 offen lds
v_mfma_f32_16x16x32_bf16 v[60:63], a[224:227], v[24:27], v[60:63]
ds_read_b128 v[48:51], v15 offset:53504
v_mfma_f32_16x16x32_bf16 v[64:67], a[228:231], v[24:27], v[64:67]
s_waitcnt lgkmcnt(4)
v_mfma_f32_16x16x32_bf16 v[52:55], a[232:235], v[28:31], v[52:55]
s_waitcnt vmcnt(23)
s_barrier
ds_read_b128 v[20:23], v16 offset:0
v_mfma_f32_16x16x32_bf16 v[56:59], a[236:239], v[28:31], v[56:59]
s_add_u32 s20, s20, 512
v_mfma_f32_16x16x32_bf16 v[60:63], a[232:235], v[32:35], v[60:63]
ds_read_b128 v[24:27], v16 offset:4096
v_mfma_f32_16x16x32_bf16 v[64:67], a[236:239], v[32:35], v[64:67]
s_waitcnt lgkmcnt(4)
v_mfma_f32_16x16x32_bf16 v[52:55], a[240:243], v[36:39], v[52:55]
ds_read_b128 v[28:31], v17 offset:0
s_add_u32 m0, s21, 32768
v_mfma_f32_16x16x32_bf16 v[56:59], a[244:247], v[36:39], v[56:59]
buffer_load_dwordx4 v8, s[8:11], s20 offen lds
v_mfma_f32_16x16x32_bf16 v[60:63], a[240:243], v[40:43], v[60:63]
ds_read_b128 v[32:35], v17 offset:4096
v_mfma_f32_16x16x32_bf16 v[64:67], a[244:247], v[40:43], v[64:67]
s_waitcnt lgkmcnt(4)
v_mfma_f32_16x16x32_bf16 v[52:55], a[248:251], v[44:47], v[52:55]
ds_read_b128 v[36:39], v18 offset:0
v_mfma_f32_16x16x32_bf16 v[56:59], a[252:255], v[44:47], v[56:59]
v_mfma_f32_16x16x32_bf16 v[60:63], a[248:251], v[48:51], v[60:63]
ds_read_b128 v[40:43], v18 offset:4096
v_mfma_f32_16x16x32_bf16 v[64:67], a[252:255], v[48:51], v[64:67]
s_waitcnt lgkmcnt(4)
s_add_u32 s22, s22, 1
s_cmp_ge_u32 s22, s23
s_cbranch_scc1 L_fl0_456
v_mfma_f32_16x16x32_bf16 v[68:71], a[0:3], v[20:23], 0
ds_read_b128 v[44:47], v19 offset:0
s_add_u32 m0, s21, 33792
s_sub_u32 s39, s22, 1
v_mfma_f32_16x16x32_bf16 v[72:75], a[4:7], v[20:23], 0
buffer_load_dwordx4 v9, s[8:11], s20 offen lds
v_mfma_f32_16x16x32_bf16 v[76:79], a[0:3], v[24:27], 0
ds_read_b128 v[48:51], v19 offset:4096
s_bitcmp1_b32 s39, 1
s_cselect_b32 s38, s54, s55
v_mfma_f32_16x16x32_bf16 v[80:83], a[4:7], v[24:27], 0
s_waitcnt lgkmcnt(4)
v_mfma_f32_16x16x32_bf16 v[68:71], a[8:11], v[28:31], v[68:71]
ds_read_b128 v[20:23], v16 offset:256
s_add_u32 s38, s38, s44
v_mfma_f32_16x16x32_bf16 v[72:75], a[12:15], v[28:31], v[72:75]
s_lshl_b32 s42, s39, 20
s_add_u32 s38, s38, s42
v_mfma_f32_16x16x32_bf16 v[76:79], a[8:11], v[32:35], v[76:79]
ds_read_b128 v[24:27], v16 offset:4352
s_cmp_eq_u32 s37, 0
s_cselect_b32 s38, 0x7ff00000, s38
v_mfma_f32_16x16x32_bf16 v[80:83], a[12:15], v[32:35], v[80:83]
s_waitcnt lgkmcnt(4)
v_mfma_f32_16x16x32_bf16 v[68:71], a[16:19], v[36:39], v[68:71]
ds_read_b128 v[28:31], v17 offset:256
s_add_u32 m0, s21, 34816
v_mfma_f32_16x16x32_bf16 v[72:75], a[20:23], v[36:39], v[72:75]
buffer_load_dwordx4 v10, s[8:11], s20 offen lds
s_mov_b32 s37, 1
v_mfma_f32_16x16x32_bf16 v[76:79], a[16:19], v[40:43], v[76:79]
ds_read_b128 v[32:35], v17 offset:4352
v_cvt_pk_bf16_f32 v88, v52, v53
v_mfma_f32_16x16x32_bf16 v[80:83], a[20:23], v[40:43], v[80:83]
s_waitcnt lgkmcnt(4)
v_cvt_pk_bf16_f32 v89, v54, v55
v_mfma_f32_16x16x32_bf16 v[68:71], a[24:27], v[44:47], v[68:71]
ds_read_b128 v[36:39], v18 offset:256
v_cvt_pk_bf16_f32 v90, v56, v57
v_mfma_f32_16x16x32_bf16 v[72:75], a[28:31], v[44:47], v[72:75]
v_cvt_pk_bf16_f32 v91, v58, v59
v_mfma_f32_16x16x32_bf16 v[76:79], a[24:27], v[48:51], v[76:79]
ds_read_b128 v[40:43], v18 offset:4352
buffer_store_dwordx4 v[88:91], v86, s[12:15], s38 offen offset:0
v_mfma_f32_16x16x32_bf16 v[80:83], a[28:31], v[48:51], v[80:83]
s_waitcnt lgkmcnt(4)
v_cvt_pk_bf16_f32 v92, v60, v61
v_cvt_pk_bf16_f32 v93, v62, v63
v_mfma_f32_16x16x32_bf16 v[68:71], a[32:35], v[20:23], v[68:71]
ds_read_b128 v[44:47], v19 offset:256
s_add_u32 m0, s21, 35840
v_mfma_f32_16x16x32_bf16 v[72:75], a[36:39], v[20:23], v[72:75]
buffer_load_dwordx4 v11, s[8:11], s20 offen lds
v_cvt_pk_bf16_f32 v94, v64, v65
v_mfma_f32_16x16x32_bf16 v[76:79], a[32:35], v[24:27], v[76:79]
ds_read_b128 v[48:51], v19 offset:4352
v_cvt_pk_bf16_f32 v95, v66, v67
v_mfma_f32_16x16x32_bf16 v[80:83], a[36:39], v[24:27], v[80:83]
s_waitcnt lgkmcnt(4)
buffer_store_dwordx4 v[92:95], v86, s[12:15], s38 offen offset:128
v_mfma_f32_16x16x32_bf16 v[68:71], a[40:43], v[28:31], v[68:71]
s_waitcnt vmcnt(24)
s_barrier
ds_read_b128 v[20:23], v16 offset:16384
v_mfma_f32_16x16x32_bf16 v[72:75], a[44:47], v[28:31], v[72:75]
s_add_u32 s20, s20, 512
v_mfma_f32_16x16x32_bf16 v[76:79], a[40:43], v[32:35], v[76:79]
ds_read_b128 v[24:27], v16 offset:20480
v_mfma_f32_16x16x32_bf16 v[80:83], a[44:47], v[32:35], v[80:83]
s_waitcnt lgkmcnt(4)
v_mfma_f32_16x16x32_bf16 v[68:71], a[48:51], v[36:39], v[68:71]
ds_read_b128 v[28:31], v17 offset:16384
s_add_u32 m0, s21, 49152
v_mfma_f32_16x16x32_bf16 v[72:75], a[52:55], v[36:39], v[72:75]
buffer_load_dwordx4 v8, s[8:11], s20 offen lds
v_mfma_f32_16x16x32_bf16 v[76:79], a[48:51], v[40:43], v[76:79]
ds_read_b128 v[32:35], v17 offset:20480
v_mfma_f32_16x16x32_bf16 v[80:83], a[52:55], v[40:43], v[80:83]
s_waitcnt lgkmcnt(4)
v_mfma_f32_16x16x32_bf16 v[68:71], a[56:59], v[44:47], v[68:71]
ds_read_b128 v[36:39], v18 offset:16384
v_mfma_f32_16x16x32_bf16 v[72:75], a[60:63], v[44:47], v[72:75]
v_mfma_f32_16x16x32_bf16 v[76:79], a[56:59], v[48:51], v[76:79]
ds_read_b128 v[40:43], v18 offset:20480
v_mfma_f32_16x16x32_bf16 v[80:83], a[60:63], v[48:51], v[80:83]
s_waitcnt lgkmcnt(4)
v_mfma_f32_16x16x32_bf16 v[68:71], a[64:67], v[20:23], v[68:71]
ds_read_b128 v[44:47], v19 offset:16384
s_add_u32 m0, s21, 50176
v_mfma_f32_16x16x32_bf16 v[72:75], a[68:71], v[20:23], v[72:75]
buffer_load_dwordx4 v9, s[8:11], s20 offen lds
v_mfma_f32_16x16x32_bf16 v[76:79], a[64:67], v[24:27], v[76:79]
ds_read_b128 v[48:51], v19 offset:20480
v_mfma_f32_16x16x32_bf16 v[80:83], a[68:71], v[24:27], v[80:83]
s_waitcnt lgkmcnt(4)
v_mfma_f32_16x16x32_bf16 v[68:71], a[72:75], v[28:31], v[68:71]
ds_read_b128 v[20:23], v16 offset:16640
v_mfma_f32_16x16x32_bf16 v[72:75], a[76:79], v[28:31], v[72:75]
v_mfma_f32_16x16x32_bf16 v[76:79], a[72:75], v[32:35], v[76:79]
ds_read_b128 v[24:27], v16 offset:20736
s_add_u32 s24, s24, 1
v_mfma_f32_16x16x32_bf16 v[80:83], a[76:79], v[32:35], v[80:83]
s_waitcnt lgkmcnt(4)
v_mfma_f32_16x16x32_bf16 v[68:71], a[80:83], v[36:39], v[68:71]
ds_read_b128 v[28:31], v17 offset:16640
s_add_u32 m0, s21, 51200
v_mfma_f32_16x16x32_bf16 v[72:75], a[84:87], v[36:39], v[72:75]
buffer_load_dwordx4 v10, s[8:11], s20 offen lds
v_mfma_f32_16x16x32_bf16 v[76:79], a[80:83], v[40:43], v[76:79]
ds_read_b128 v[32:35], v17 offset:20736
v_mfma_f32_16x16x32_bf16 v[80:83], a[84:87], v[40:43], v[80:83]
s_waitcnt lgkmcnt(4)
s_min_u32 s24, s24, 63
v_mfma_f32_16x16x32_bf16 v[68:71], a[88:91], v[44:47], v[68:71]
ds_read_b128 v[36:39], v18 offset:16640
v_mfma_f32_16x16x32_bf16 v[72:75], a[92:95], v[44:47], v[72:75]
v_mfma_f32_16x16x32_bf16 v[76:79], a[88:91], v[48:51], v[76:79]
ds_read_b128 v[40:43], v18 offset:20736
s_lshl_b32 s53, s24, 16
v_mfma_f32_16x16x32_bf16 v[80:83], a[92:95], v[48:51], v[80:83]
s_waitcnt lgkmcnt(4)
v_mfma_f32_16x16x32_bf16 v[68:71], a[96:99], v[20:23], v[68:71]
ds_read_b128 v[44:47], v19 offset:16640
s_add_u32 m0, s21, 52224
v_mfma_f32_16x16x32_bf16 v[72:75], a[100:103], v[20:23], v[72:75]
buffer_load_dwordx4 v11, s[8:11], s20 offen lds
v_mfma_f32_16x16x32_bf16 v[76:79], a[96:99], v[24:27], v[76:79]
ds_read_b128 v[48:51], v19 offset:20736
v_mfma_f32_16x16x32_bf16 v[80:83], a[100:103], v[24:27], v[80:83]
s_waitcnt lgkmcnt(4)
v_mfma_f32_16x16x32_bf16 v[68:71], a[104:107], v[28:31], v[68:71]
s_waitcnt vmcnt(23)
s_barrier
ds_read_b128 v[20:23], v16 offset:32768
v_mfma_f32_16x16x32_bf16 v[72:75], a[108:111], v[28:31], v[72:75]
s_mov_b32 s20, s53
v_mfma_f32_16x16x32_bf16 v[76:79], a[104:107], v[32:35], v[76:79]
ds_read_b128 v[24:27], v16 offset:36864
v_mfma_f32_16x16x32_bf16 v[80:83], a[108:111], v[32:35], v[80:83]
s_waitcnt lgkmcnt(4)
v_mfma_f32_16x16x32_bf16 v[68:71], a[112:115], v[36:39], v[68:71]
ds_read_b128 v[28:31], v17 offset:32768
s_add_u32 m0, s21, 65536
v_mfma_f32_16x16x32_bf16 v[72:75], a[116:119], v[36:39], v[72:75]
buffer_load_dwordx4 v8, s[8:11], s20 offen lds
v_mfma_f32_16x16x32_bf16 v[76:79], a[112:115], v[40:43], v[76:79]
ds_read_b128 v[32:35], v17 offset:36864
v_mfma_f32_16x16x32_bf16 v[80:83], a[116:119], v[40:43], v[80:83]
s_waitcnt lgkmcnt(4)
v_mfma_f32_16x16x32_bf16 v[68:71], a[120:123], v[44:47], v[68:71]
ds_read_b128 v[36:39], v18 offset:32768
v_mfma_f32_16x16x32_bf16 v[72:75], a[124:127], v[44:47], v[72:75]
v_mfma_f32_16x16x32_bf16 v[76:79], a[120:123], v[48:51], v[76:79]
ds_read_b128 v[40:43], v18 offset:36864
v_mfma_f32_16x16x32_bf16 v[80:83], a[124:127], v[48:51], v[80:83]
s_waitcnt lgkmcnt(4)
v_mfma_f32_16x16x32_bf16 v[68:71], a[128:131], v[20:23], v[68:71]
ds_read_b128 v[44:47], v19 offset:32768
s_add_u32 m0, s21, 66560
v_mfma_f32_16x16x32_bf16 v[72:75], a[132:135], v[20:23], v[72:75]
buffer_load_dwordx4 v9, s[8:11], s20 offen lds
v_mfma_f32_16x16x32_bf16 v[76:79], a[128:131], v[24:27], v[76:79]
ds_read_b128 v[48:51], v19 offset:36864
v_mfma_f32_16x16x32_bf16 v[80:83], a[132:135], v[24:27], v[80:83]
s_waitcnt lgkmcnt(4)
v_mfma_f32_16x16x32_bf16 v[68:71], a[136:139], v[28:31], v[68:71]
ds_read_b128 v[20:23], v16 offset:33024
v_mfma_f32_16x16x32_bf16 v[72:75], a[140:143], v[28:31], v[72:75]
v_mfma_f32_16x16x32_bf16 v[76:79], a[136:139], v[32:35], v[76:79]
ds_read_b128 v[24:27], v16 offset:37120
v_mfma_f32_16x16x32_bf16 v[80:83], a[140:143], v[32:35], v[80:83]
s_waitcnt lgkmcnt(4)
v_mfma_f32_16x16x32_bf16 v[68:71], a[144:147], v[36:39], v[68:71]
ds_read_b128 v[28:31], v17 offset:33024
s_add_u32 m0, s21, 67584
v_mfma_f32_16x16x32_bf16 v[72:75], a[148:151], v[36:39], v[72:75]
buffer_load_dwordx4 v10, s[8:11], s20 offen lds
v_mfma_f32_16x16x32_bf16 v[76:79], a[144:147], v[40:43], v[76:79]
ds_read_b128 v[32:35], v17 offset:37120
v_mfma_f32_16x16x32_bf16 v[80:83], a[148:151], v[40:43], v[80:83]
s_waitcnt lgkmcnt(4)
v_mfma_f32_16x16x32_bf16 v[68:71], a[152:155], v[44:47], v[68:71]
ds_read_b128 v[36:39], v18 offset:33024
v_mfma_f32_16x16x32_bf16 v[72:75], a[156:159], v[44:47], v[72:75]
v_mfma_f32_16x16x32_bf16 v[76:79], a[152:155], v[48:51], v[76:79]
ds_read_b128 v[40:43], v18 offset:37120
v_mfma_f32_16x16x32_bf16 v[80:83], a[156:159], v[48:51], v[80:83]
s_waitcnt lgkmcnt(4)
v_mfma_f32_16x16x32_bf16 v[68:71], a[160:163], v[20:23], v[68:71]
ds_read_b128 v[44:47], v19 offset:33024
s_add_u32 m0, s21, 68608
v_mfma_f32_16x16x32_bf16 v[72:75], a[164:167], v[20:23], v[72:75]
buffer_load_dwordx4 v11, s[8:11], s20 offen lds
v_mfma_f32_16x16x32_bf16 v[76:79], a[160:163], v[24:27], v[76:79]
ds_read_b128 v[48:51], v19 offset:37120
v_mfma_f32_16x16x32_bf16 v[80:83], a[164:167], v[24:27], v[80:83]
s_waitcnt lgkmcnt(4)
v_mfma_f32_16x16x32_bf16 v[68:71], a[168:171], v[28:31], v[68:71]
s_waitcnt vmcnt(22)
s_barrier
ds_read_b128 v[20:23], v16 offset:49152
v_mfma_f32_16x16x32_bf16 v[72:75], a[172:175], v[28:31], v[72:75]
s_add_u32 s20, s20, 512
v_mfma_f32_16x16x32_bf16 v[76:79], a[168:171], v[32:35], v[76:79]
ds_read_b128 v[24:27], v16 offset:53248
v_mfma_f32_16x16x32_bf16 v[80:83], a[172:175], v[32:35], v[80:83]
s_waitcnt lgkmcnt(4)
v_mfma_f32_16x16x32_bf16 v[68:71], a[176:179], v[36:39], v[68:71]
ds_read_b128 v[28:31], v17 offset:49152
s_add_u32 m0, s21, 81920
v_mfma_f32_16x16x32_bf16 v[72:75], a[180:183], v[36:39], v[72:75]
buffer_load_dwordx4 v8, s[8:11], s20 offen lds
v_mfma_f32_16x16x32_bf16 v[76:79], a[176:179], v[40:43], v[76:79]
ds_read_b128 v[32:35], v17 offset:53248
v_mfma_f32_16x16x32_bf16 v[80:83], a[180:183], v[40:43], v[80:83]
s_waitcnt lgkmcnt(4)
buffer_load_dword v87, v103, s[32:35], 0 offen sc1
v_mfma_f32_16x16x32_bf16 v[68:71], a[184:187], v[44:47], v[68:71]
ds_read_b128 v[36:39], v18 offset:49152
v_mfma_f32_16x16x32_bf16 v[72:75], a[188:191], v[44:47], v[72:75]
v_mfma_f32_16x16x32_bf16 v[76:79], a[184:187], v[48:51], v[76:79]
ds_read_b128 v[40:43], v18 offset:53248
v_mfma_f32_16x16x32_bf16 v[80:83], a[188:191], v[48:51], v[80:83]
s_waitcnt lgkmcnt(4)
v_mfma_f32_16x16x32_bf16 v[68:71], a[192:195], v[20:23], v[68:71]
ds_read_b128 v[44:47], v19 offset:49152
s_add_u32 m0, s21, 82944
v_mfma_f32_16x16x32_bf16 v[72:75], a[196:199], v[20:23], v[72:75]
buffer_load_dwordx4 v9, s[8:11], s20 offen lds
v_mfma_f32_16x16x32_bf16 v[76:79], a[192:195], v[24:27], v[76:79]
ds_read_b128 v[48:51], v19 offset:53248
v_mfma_f32_16x16x32_bf16 v[80:83], a[196:199], v[24:27], v[80:83]
s_waitcnt lgkmcnt(4)
v_mfma_f32_16x16x32_bf16 v[68:71], a[200:203], v[28:31], v[68:71]
ds_read_b128 v[20:23], v16 offset:49408
v_mfma_f32_16x16x32_bf16 v[72:75], a[204:207], v[28:31], v[72:75]
v_mfma_f32_16x16x32_bf16 v[76:79], a[200:203], v[32:35], v[76:79]
ds_read_b128 v[24:27], v16 offset:53504
v_mfma_f32_16x16x32_bf16 v[80:83], a[204:207], v[32:35], v[80:83]
s_waitcnt lgkmcnt(4)
v_mfma_f32_16x16x32_bf16 v[68:71], a[208:211], v[36:39], v[68:71]
ds_read_b128 v[28:31], v17 offset:49408
s_add_u32 m0, s21, 83968
v_mfma_f32_16x16x32_bf16 v[72:75], a[212:215], v[36:39], v[72:75]
buffer_load_dwordx4 v10, s[8:11], s20 offen lds
v_mfma_f32_16x16x32_bf16 v[76:79], a[208:211], v[40:43], v[76:79]
ds_read_b128 v[32:35], v17 offset:53504
v_mfma_f32_16x16x32_bf16 v[80:83], a[212:215], v[40:43], v[80:83]
s_waitcnt lgkmcnt(4)
v_mfma_f32_16x16x32_bf16 v[68:71], a[216:219], v[44:47], v[68:71]
ds_read_b128 v[36:39], v18 offset:49408
v_mfma_f32_16x16x32_bf16 v[72:75], a[220:223], v[44:47], v[72:75]
v_mfma_f32_16x16x32_bf16 v[76:79], a[216:219], v[48:51], v[76:79]
ds_read_b128 v[40:43], v18 offset:53504
v_mfma_f32_16x16x32_bf16 v[80:83], a[220:223], v[48:51], v[80:83]
s_waitcnt lgkmcnt(4)
v_mfma_f32_16x16x32_bf16 v[68:71], a[224:227], v[20:23], v[68:71]
ds_read_b128 v[44:47], v19 offset:49408
s_add_u32 m0, s21, 84992
v_mfma_f32_16x16x32_bf16 v[72:75], a[228:231], v[20:23], v[72:75]
buffer_load_dwordx4 v11, s[8:11], s20 offen lds
v_mfma_f32_16x16x32_bf16 v[76:79], a[224:227], v[24:27], v[76:79]
ds_read_b128 v[48:51], v19 offset:53504
v_mfma_f32_16x16x32_bf16 v[80:83], a[228:231], v[24:27], v[80:83]
s_waitcnt lgkmcnt(4)
v_mfma_f32_16x16x32_bf16 v[68:71], a[232:235], v[28:31], v[68:71]
s_waitcnt vmcnt(23)
s_barrier
ds_read_b128 v[20:23], v12 offset:0
v_mfma_f32_16x16x32_bf16 v[72:75], a[236:239], v[28:31], v[72:75]
s_add_u32 s20, s20, 512
v_mfma_f32_16x16x32_bf16 v[76:79], a[232:235], v[32:35], v[76:79]
ds_read_b128 v[24:27], v12 offset:4096
v_mfma_f32_16x16x32_bf16 v[80:83], a[236:239], v[32:35], v[80:83]
s_waitcnt lgkmcnt(4)
v_mfma_f32_16x16x32_bf16 v[68:71], a[240:243], v[36:39], v[68:71]
ds_read_b128 v[28:31], v13 offset:0
s_add_u32 m0, s21, 98304
v_mfma_f32_16x16x32_bf16 v[72:75], a[244:247], v[36:39], v[72:75]
buffer_load_dwordx4 v8, s[8:11], s20 offen lds
v_mfma_f32_16x16x32_bf16 v[76:79], a[240:243], v[40:43], v[76:79]
ds_read_b128 v[32:35], v13 offset:4096
v_mfma_f32_16x16x32_bf16 v[80:83], a[244:247], v[40:43], v[80:83]
s_waitcnt lgkmcnt(4)
v_mfma_f32_16x16x32_bf16 v[68:71], a[248:251], v[44:47], v[68:71]
ds_read_b128 v[36:39], v14 offset:0
v_mfma_f32_16x16x32_bf16 v[72:75], a[252:255], v[44:47], v[72:75]
v_mfma_f32_16x16x32_bf16 v[76:79], a[248:251], v[48:51], v[76:79]
ds_read_b128 v[40:43], v14 offset:4096
v_mfma_f32_16x16x32_bf16 v[80:83], a[252:255], v[48:51], v[80:83]
s_waitcnt lgkmcnt(4)
s_add_u32 s22, s22, 1
s_cmp_ge_u32 s22, s23
s_cbranch_scc0 L_st_459
s_branch L_fl1_457
L_st_460:
v_mfma_f32_16x16x32_bf16 v[52:55], a[0:3], v[20:23], 0
ds_read_b128 v[44:47], v15 offset:0
s_add_u32 m0, s21, 99328
s_sub_u32 s39, s22, 1
v_mfma_f32_16x16x32_bf16 v[56:59], a[4:7], v[20:23], 0
buffer_load_dwordx4 v9, s[8:11], s20 offen lds
v_mfma_f32_16x16x32_bf16 v[60:63], a[0:3], v[24:27], 0
ds_read_b128 v[48:51], v15 offset:4096
s_bitcmp1_b32 s39, 1
s_cselect_b32 s38, s54, s55
v_mfma_f32_16x16x32_bf16 v[64:67], a[4:7], v[24:27], 0
s_waitcnt lgkmcnt(4)
v_mfma_f32_16x16x32_bf16 v[52:55], a[8:11], v[28:31], v[52:55]
ds_read_b128 v[20:23], v12 offset:256
s_add_u32 s38, s38, s44
s_waitcnt vmcnt(5)
v_mfma_f32_16x16x32_bf16 v[56:59], a[12:15], v[28:31], v[56:59]
s_lshl_b32 s42, s39, 20
s_add_u32 s38, s38, s42
ds_write_b32 v101, v87
v_mfma_f32_16x16x32_bf16 v[60:63], a[8:11], v[32:35], v[60:63]
ds_read_b128 v[24:27], v12 offset:4352
s_cmp_eq_u32 s37, 0
s_cselect_b32 s38, 0x7ff00000, s38
v_mfma_f32_16x16x32_bf16 v[64:67], a[12:15], v[32:35], v[64:67]
s_waitcnt lgkmcnt(4)
v_mfma_f32_16x16x32_bf16 v[52:55], a[16:19], v[36:39], v[52:55]
ds_read_b128 v[28:31], v13 offset:256
s_add_u32 m0, s21, 100352
v_mfma_f32_16x16x32_bf16 v[56:59], a[20:23], v[36:39], v[56:59]
buffer_load_dwordx4 v10, s[8:11], s20 offen lds
s_mov_b32 s37, 1
v_mfma_f32_16x16x32_bf16 v[60:63], a[16:19], v[40:43], v[60:63]
ds_read_b128 v[32:35], v13 offset:4352
v_cvt_pk_bf16_f32 v88, v68, v69
v_mfma_f32_16x16x32_bf16 v[64:67], a[20:23], v[40:43], v[64:67]
s_waitcnt lgkmcnt(4)
v_cvt_pk_bf16_f32 v89, v70, v71
v_mfma_f32_16x16x32_bf16 v[52:55], a[24:27], v[44:47], v[52:55]
ds_read_b128 v[36:39], v14 offset:256
v_cvt_pk_bf16_f32 v90, v72, v73
v_mfma_f32_16x16x32_bf16 v[56:59], a[28:31], v[44:47], v[56:59]
v_cvt_pk_bf16_f32 v91, v74, v75
v_mfma_f32_16x16x32_bf16 v[60:63], a[24:27], v[48:51], v[60:63]
ds_read_b128 v[40:43], v14 offset:4352
buffer_store_dwordx4 v[88:91], v86, s[12:15], s38 offen offset:0
v_mfma_f32_16x16x32_bf16 v[64:67], a[28:31], v[48:51], v[64:67]
s_waitcnt lgkmcnt(4)
v_cvt_pk_bf16_f32 v92, v76, v77
v_cvt_pk_bf16_f32 v93, v78, v79
v_mfma_f32_16x16x32_bf16 v[52:55], a[32:35], v[20:23], v[52:55]
ds_read_b128 v[44:47], v15 offset:256
s_add_u32 m0, s21, 101376
v_mfma_f32_16x16x32_bf16 v[56:59], a[36:39], v[20:23], v[56:59]
buffer_load_dwordx4 v11, s[8:11], s20 offen lds
v_cvt_pk_bf16_f32 v94, v80, v81
v_mfma_f32_16x16x32_bf16 v[60:63], a[32:35], v[24:27], v[60:63]
ds_read_b128 v[48:51], v15 offset:4352
v_cvt_pk_bf16_f32 v95, v82, v83
v_mfma_f32_16x16x32_bf16 v[64:67], a[36:39], v[24:27], v[64:67]
s_waitcnt lgkmcnt(4)
buffer_store_dwordx4 v[92:95], v86, s[12:15], s38 offen offset:128
v_mfma_f32_16x16x32_bf16 v[52:55], a[40:43], v[28:31], v[52:55]
s_waitcnt vmcnt(40)
s_barrier
ds_read_b128 v[20:23], v12 offset:16384
v_mfma_f32_16x16x32_bf16 v[56:59], a[44:47], v[28:31], v[56:59]
s_add_u32 s20, s20, 512
v_mfma_f32_16x16x32_bf16 v[60:63], a[40:43], v[32:35], v[60:63]
ds_read_b128 v[24:27], v12 offset:20480
ds_read_b32 v87, v102
v_mfma_f32_16x16x32_bf16 v[64:67], a[44:47], v[32:35], v[64:67]
s_waitcnt lgkmcnt(4)
v_mfma_f32_16x16x32_bf16 v[52:55], a[48:51], v[36:39], v[52:55]
ds_read_b128 v[28:31], v13 offset:16384
s_add_u32 m0, s21, 114688
v_mfma_f32_16x16x32_bf16 v[56:59], a[52:55], v[36:39], v[56:59]
buffer_load_dwordx4 v8, s[8:11], s20 offen lds
v_mfma_f32_16x16x32_bf16 v[60:63], a[48:51], v[40:43], v[60:63]
ds_read_b128 v[32:35], v13 offset:20480
v_mfma_f32_16x16x32_bf16 v[64:67], a[52:55], v[40:43], v[64:67]
s_waitcnt lgkmcnt(4)
v_mfma_f32_16x16x32_bf16 v[52:55], a[56:59], v[44:47], v[52:55]
ds_read_b128 v[36:39], v14 offset:16384
v_mfma_f32_16x16x32_bf16 v[56:59], a[60:63], v[44:47], v[56:59]
v_mfma_f32_16x16x32_bf16 v[60:63], a[56:59], v[48:51], v[60:63]
ds_read_b128 v[40:43], v14 offset:20480
v_mfma_f32_16x16x32_bf16 v[64:67], a[60:63], v[48:51], v[64:67]
s_waitcnt lgkmcnt(4)
v_mfma_f32_16x16x32_bf16 v[52:55], a[64:67], v[20:23], v[52:55]
ds_read_b128 v[44:47], v15 offset:16384
s_add_u32 m0, s21, 115712
v_mfma_f32_16x16x32_bf16 v[56:59], a[68:71], v[20:23], v[56:59]
buffer_load_dwordx4 v9, s[8:11], s20 offen lds
v_mfma_f32_16x16x32_bf16 v[60:63], a[64:67], v[24:27], v[60:63]
ds_read_b128 v[48:51], v15 offset:20480
s_waitcnt vmcnt(13)
s_branch L_att_450
L_attr_453:
v_mfma_f32_16x16x32_bf16 v[64:67], a[68:71], v[24:27], v[64:67]
s_waitcnt lgkmcnt(4)
s_add_u32 s43, s50, 0
buffer_load_dwordx4 v[136:139], v96, s[12:15], s43 offen offset:0
v_mfma_f32_16x16x32_bf16 v[52:55], a[72:75], v[28:31], v[52:55]
ds_read_b128 v[20:23], v12 offset:16640
v_mfma_f32_16x16x32_bf16 v[56:59], a[76:79], v[28:31], v[56:59]
v_mfma_f32_16x16x32_bf16 v[60:63], a[72:75], v[32:35], v[60:63]
ds_read_b128 v[24:27], v12 offset:20736
s_add_u32 s24, s24, 1
v_mfma_f32_16x16x32_bf16 v[64:67], a[76:79], v[32:35], v[64:67]
s_waitcnt lgkmcnt(4)
v_mfma_f32_16x16x32_bf16 v[52:55], a[80:83], v[36:39], v[52:55]
ds_read_b128 v[28:31], v13 offset:16640
s_add_u32 m0, s21, 116736
v_mfma_f32_16x16x32_bf16 v[56:59], a[84:87], v[36:39], v[56:59]
buffer_load_dwordx4 v10, s[8:11], s20 offen lds
v_mfma_f32_16x16x32_bf16 v[60:63], a[80:83], v[40:43], v[60:63]
ds_read_b128 v[32:35], v13 offset:20736
v_mfma_f32_16x16x32_bf16 v[64:67], a[84:87], v[40:43], v[64:67]
s_waitcnt lgkmcnt(4)
s_add_u32 s43, s50, 0
buffer_load_dwordx4 v[140:143], v96, s[12:15], s43 offen offset:1024
v_mfma_f32_16x16x32_bf16 v[52:55], a[88:91], v[44:47], v[52:55]
ds_read_b128 v[36:39], v14 offset:16640
s_min_u32 s24, s24, 63
v_mfma_f32_16x16x32_bf16 v[56:59], a[92:95], v[44:47], v[56:59]
v_mfma_f32_16x16x32_bf16 v[60:63], a[88:91], v[48:51], v[60:63]
ds_read_b128 v[40:43], v14 offset:20736
s_add_u32 s43, s48, 0
buffer_load_dwordx4 v[104:107], v96, s[12:15], s43 offen offset:0
v_mfma_f32_16x16x32_bf16 v[64:67], a[92:95], v[48:51], v[64:67]
s_waitcnt lgkmcnt(4)
s_lshl_b32 s53, s24, 16
v_mfma_f32_16x16x32_bf16 v[52:55], a[96:99], v[20:23], v[52:55]
ds_read_b128 v[44:47], v15 offset:16640
s_add_u32 m0, s21, 117760
v_mfma_f32_16x16x32_bf16 v[56:59], a[100:103], v[20:23], v[56:59]
buffer_load_dwordx4 v11, s[8:11], s20 offen lds
v_mfma_f32_16x16x32_bf16 v[60:63], a[96:99], v[24:27], v[60:63]
ds_read_b128 v[48:51], v15 offset:20736
v_mfma_f32_16x16x32_bf16 v[64:67], a[100:103], v[24:27], v[64:67]
s_waitcnt lgkmcnt(4)
v_mfma_f32_16x16x32_bf16 v[52:55], a[104:107], v[28:31], v[52:55]
s_waitcnt vmcnt(27)
s_barrier
ds_read_b128 v[20:23], v12 offset:32768
v_mfma_f32_16x16x32_bf16 v[56:59], a[108:111], v[28:31], v[56:59]
s_mov_b32 s20, s53
v_mfma_f32_16x16x32_bf16 v[60:63], a[104:107], v[32:35], v[60:63]
ds_read_b128 v[24:27], v12 offset:36864
s_add_u32 s43, s48, 0
buffer_load_dwordx4 v[108:111], v96, s[12:15], s43 offen offset:1024
v_mfma_f32_16x16x32_bf16 v[64:67], a[108:111], v[32:35], v[64:67]
s_waitcnt lgkmcnt(4)
v_mfma_f32_16x16x32_bf16 v[52:55], a[112:115], v[36:39], v[52:55]
ds_read_b128 v[28:31], v13 offset:32768
s_add_u32 m0, s21, 0
v_mfma_f32_16x16x32_bf16 v[56:59], a[116:119], v[36:39], v[56:59]
buffer_load_dwordx4 v8, s[8:11], s20 offen lds
v_mfma_f32_16x16x32_bf16 v[60:63], a[112:115], v[40:43], v[60:63]
ds_read_b128 v[32:35], v13 offset:36864
v_mfma_f32_16x16x32_bf16 v[64:67], a[116:119], v[40:43], v[64:67]
s_waitcnt lgkmcnt(4)
s_add_u32 s43, s50, 4096
buffer_load_dwordx4 v[144:147], v96, s[12:15], s43 offen offset:0
v_mfma_f32_16x16x32_bf16 v[52:55], a[120:123], v[44:47], v[52:55]
ds_read_b128 v[36:39], v14 offset:32768
v_mfma_f32_16x16x32_bf16 v[56:59], a[124:127], v[44:47], v[56:59]
v_mfma_f32_16x16x32_bf16 v[60:63], a[120:123], v[48:51], v[60:63]
ds_read_b128 v[40:43], v14 offset:36864
v_mfma_f32_16x16x32_bf16 v[64:67], a[124:127], v[48:51], v[64:67]
s_waitcnt lgkmcnt(4)
v_mfma_f32_16x16x32_bf16 v[52:55], a[128:131], v[20:23], v[52:55]
ds_read_b128 v[44:47], v15 offset:32768
s_add_u32 m0, s21, 1024
v_mfma_f32_16x16x32_bf16 v[56:59], a[132:135], v[20:23], v[56:59]
buffer_load_dwordx4 v9, s[8:11], s20 offen lds
v_mfma_f32_16x16x32_bf16 v[60:63], a[128:131], v[24:27], v[60:63]
ds_read_b128 v[48:51], v15 offset:36864
v_mfma_f32_16x16x32_bf16 v[64:67], a[132:135], v[24:27], v[64:67]
s_waitcnt lgkmcnt(4)
s_add_u32 s43, s50, 4096
buffer_load_dwordx4 v[148:151], v96, s[12:15], s43 offen offset:1024
v_mfma_f32_16x16x32_bf16 v[52:55], a[136:139], v[28:31], v[52:55]
ds_read_b128 v[20:23], v12 offset:33024
v_mfma_f32_16x16x32_bf16 v[56:59], a[140:143], v[28:31], v[56:59]
v_mfma_f32_16x16x32_bf16 v[60:63], a[136:139], v[32:35], v[60:63]
ds_read_b128 v[24:27], v12 offset:37120
s_add_u32 s43, s48, 4096
buffer_load_dwordx4 v[112:115], v96, s[12:15], s43 offen offset:0
v_mfma_f32_16x16x32_bf16 v[64:67], a[140:143], v[32:35], v[64:67]
s_waitcnt lgkmcnt(4)
v_mfma_f32_16x16x32_bf16 v[52:55], a[144:147], v[36:39], v[52:55]
ds_read_b128 v[28:31], v13 offset:33024
s_add_u32 m0, s21, 2048
v_mfma_f32_16x16x32_bf16 v[56:59], a[148:151], v[36:39], v[56:59]
buffer_load_dwordx4 v10, s[8:11], s20 offen lds
v_mfma_f32_16x16x32_bf16 v[60:63], a[144:147], v[40:43], v[60:63]
ds_read_b128 v[32:35], v13 offset:37120
v_mfma_f32_16x16x32_bf16 v[64:67], a[148:151], v[40:43], v[64:67]
s_waitcnt lgkmcnt(4)
v_mfma_f32_16x16x32_bf16 v[52:55], a[152:155], v[44:47], v[52:55]
ds_read_b128 v[36:39], v14 offset:33024
v_mfma_f32_16x16x32_bf16 v[56:59], a[156:159], v[44:47], v[56:59]
v_mfma_f32_16x16x32_bf16 v[60:63], a[152:155], v[48:51], v[60:63]
ds_read_b128 v[40:43], v14 offset:37120
s_add_u32 s43, s48, 4096
buffer_load_dwordx4 v[116:119], v96, s[12:15], s43 offen offset:1024
v_mfma_f32_16x16x32_bf16 v[64:67], a[156:159], v[48:51], v[64:67]
s_waitcnt lgkmcnt(4)
v_mfma_f32_16x16x32_bf16 v[52:55], a[160:163], v[20:23], v[52:55]
ds_read_b128 v[44:47], v15 offset:33024
s_add_u32 m0, s21, 3072
v_mfma_f32_16x16x32_bf16 v[56:59], a[164:167], v[20:23], v[56:59]
buffer_load_dwordx4 v11, s[8:11], s20 offen lds
v_mfma_f32_16x16x32_bf16 v[60:63], a[160:163], v[24:27], v[60:63]
ds_read_b128 v[48:51], v15 offset:37120
v_mfma_f32_16x16x32_bf16 v[64:67], a[164:167], v[24:27], v[64:67]
s_waitcnt lgkmcnt(4)
s_add_u32 s43, s50, 16384
buffer_load_dwordx4 v[152:155], v96, s[12:15], s43 offen offset:0
v_mfma_f32_16x16x32_bf16 v[52:55], a[168:171], v[28:31], v[52:55]
s_waitcnt vmcnt(32)
s_barrier
ds_read_b128 v[20:23], v12 offset:49152
v_mfma_f32_16x16x32_bf16 v[56:59], a[172:175], v[28:31], v[56:59]
s_add_u32 s20, s20, 512
v_mfma_f32_16x16x32_bf16 v[60:63], a[168:171], v[32:35], v[60:63]
ds_read_b128 v[24:27], v12 offset:53248
v_mfma_f32_16x16x32_bf16 v[64:67], a[172:175], v[32:35], v[64:67]
s_waitcnt lgkmcnt(4)
v_mfma_f32_16x16x32_bf16 v[52:55], a[176:179], v[36:39], v[52:55]
ds_read_b128 v[28:31], v13 offset:49152
s_add_u32 m0, s21, 16384
v_mfma_f32_16x16x32_bf16 v[56:59], a[180:183], v[36:39], v[56:59]
buffer_load_dwordx4 v8, s[8:11], s20 offen lds
v_mfma_f32_16x16x32_bf16 v[60:63], a[176:179], v[40:43], v[60:63]
ds_read_b128 v[32:35], v13 offset:53248
v_mfma_f32_16x16x32_bf16 v[64:67], a[180:183], v[40:43], v[64:67]
s_waitcnt lgkmcnt(4)
s_add_u32 s43, s50, 16384
buffer_load_dwordx4 v[156:159], v96, s[12:15], s43 offen offset:1024
v_mfma_f32_16x16x32_bf16 v[52:55], a[184:187], v[44:47], v[52:55]
ds_read_b128 v[36:39], v14 offset:49152
v_mfma_f32_16x16x32_bf16 v[56:59], a[188:191], v[44:47], v[56:59]
v_mfma_f32_16x16x32_bf16 v[60:63], a[184:187], v[48:51], v[60:63]
ds_read_b128 v[40:43], v14 offset:53248
s_add_u32 s43, s48, 16384
buffer_load_dwordx4 v[120:123], v96, s[12:15], s43 offen offset:0
v_mfma_f32_16x16x32_bf16 v[64:67], a[188:191], v[48:51], v[64:67]
s_waitcnt lgkmcnt(4)
v_mfma_f32_16x16x32_bf16 v[52:55], a[192:195], v[20:23], v[52:55]
ds_read_b128 v[44:47], v15 offset:49152
s_add_u32 m0, s21, 17408
v_mfma_f32_16x16x32_bf16 v[56:59], a[196:199], v[20:23], v[56:59]
buffer_load_dwordx4 v9, s[8:11], s20 offen lds
v_mfma_f32_16x16x32_bf16 v[60:63], a[192:195], v[24:27], v[60:63]
ds_read_b128 v[48:51], v15 offset:53248
v_mfma_f32_16x16x32_bf16 v[64:67], a[196:199], v[24:27], v[64:67]
s_waitcnt lgkmcnt(4)
v_mfma_f32_16x16x32_bf16 v[52:55], a[200:203], v[28:31], v[52:55]
ds_read_b128 v[20:23], v12 offset:49408
v_mfma_f32_16x16x32_bf16 v[56:59], a[204:207], v[28:31], v[56:59]
v_mfma_f32_16x16x32_bf16 v[60:63], a[200:203], v[32:35], v[60:63]
ds_read_b128 v[24:27], v12 offset:53504
s_add_u32 s43, s48, 16384
buffer_load_dwordx4 v[124:127], v96, s[12:15], s43 offen offset:1024
v_mfma_f32_16x16x32_bf16 v[64:67], a[204:207], v[32:35], v[64:67]
s_waitcnt lgkmcnt(4)
v_mfma_f32_16x16x32_bf16 v[52:55], a[208:211], v[36:39], v[52:55]
ds_read_b128 v[28:31], v13 offset:49408
s_add_u32 m0, s21, 18432
v_mfma_f32_16x16x32_bf16 v[56:59], a[212:215], v[36:39], v[56:59]
buffer_load_dwordx4 v10, s[8:11], s20 offen lds
v_mfma_f32_16x16x32_bf16 v[60:63], a[208:211], v[40:43], v[60:63]
ds_read_b128 v[32:35], v13 offset:53504
v_mfma_f32_16x16x32_bf16 v[64:67], a[212:215], v[40:43], v[64:67]
s_waitcnt lgkmcnt(4)
s_add_u32 s43, s50, 20480
buffer_load_dwordx4 v[160:163], v96, s[12:15], s43 offen offset:0
v_mfma_f32_16x16x32_bf16 v[52:55], a[216:219], v[44:47], v[52:55]
ds_read_b128 v[36:39], v14 offset:49408
v_mfma_f32_16x16x32_bf16 v[56:59], a[220:223], v[44:47], v[56:59]
v_mfma_f32_16x16x32_bf16 v[60:63], a[216:219], v[48:51], v[60:63]
ds_read_b128 v[40:43], v14 offset:53504
v_mfma_f32_16x16x32_bf16 v[64:67], a[220:223], v[48:51], v[64:67]
s_waitcnt lgkmcnt(4)
v_mfma_f32_16x16x32_bf16 v[52:55], a[224:227], v[20:23], v[52:55]
ds_read_b128 v[44:47], v15 offset:49408
s_add_u32 m0, s21, 19456
v_mfma_f32_16x16x32_bf16 v[56:59], a[228:231], v[20:23], v[56:59]
buffer_load_dwordx4 v11, s[8:11], s20 offen lds
v_mfma_f32_16x16x32_bf16 v[60:63], a[224:227], v[24:27], v[60:63]
ds_read_b128 v[48:51], v15 offset:53504
v_mfma_f32_16x16x32_bf16 v[64:67], a[228:231], v[24:27], v[64:67]
s_waitcnt lgkmcnt(4)
s_add_u32 s43, s50, 20480
buffer_load_dwordx4 v[164:167], v96, s[12:15], s43 offen offset:1024
v_mfma_f32_16x16x32_bf16 v[52:55], a[232:235], v[28:31], v[52:55]
s_waitcnt vmcnt(37)
s_barrier
ds_read_b128 v[20:23], v16 offset:0
v_mfma_f32_16x16x32_bf16 v[56:59], a[236:239], v[28:31], v[56:59]
s_add_u32 s20, s20, 512
v_mfma_f32_16x16x32_bf16 v[60:63], a[232:235], v[32:35], v[60:63]
ds_read_b128 v[24:27], v16 offset:4096
s_add_u32 s43, s48, 20480
buffer_load_dwordx4 v[128:131], v96, s[12:15], s43 offen offset:0
v_mfma_f32_16x16x32_bf16 v[64:67], a[236:239], v[32:35], v[64:67]
s_waitcnt lgkmcnt(4)
v_mfma_f32_16x16x32_bf16 v[52:55], a[240:243], v[36:39], v[52:55]
ds_read_b128 v[28:31], v17 offset:0
s_add_u32 m0, s21, 32768
v_mfma_f32_16x16x32_bf16 v[56:59], a[244:247], v[36:39], v[56:59]
buffer_load_dwordx4 v8, s[8:11], s20 offen lds
v_mfma_f32_16x16x32_bf16 v[60:63], a[240:243], v[40:43], v[60:63]
ds_read_b128 v[32:35], v17 offset:4096
v_mfma_f32_16x16x32_bf16 v[64:67], a[244:247], v[40:43], v[64:67]
s_waitcnt lgkmcnt(4)
v_mfma_f32_16x16x32_bf16 v[52:55], a[248:251], v[44:47], v[52:55]
ds_read_b128 v[36:39], v18 offset:0
v_mfma_f32_16x16x32_bf16 v[56:59], a[252:255], v[44:47], v[56:59]
v_mfma_f32_16x16x32_bf16 v[60:63], a[248:251], v[48:51], v[60:63]
ds_read_b128 v[40:43], v18 offset:4096
v_mfma_f32_16x16x32_bf16 v[64:67], a[252:255], v[48:51], v[64:67]
s_waitcnt lgkmcnt(4)
s_add_u32 s22, s22, 1
s_cmp_ge_u32 s22, s23
s_cbranch_scc1 L_fl0_456
v_mfma_f32_16x16x32_bf16 v[68:71], a[0:3], v[20:23], 0
ds_read_b128 v[44:47], v19 offset:0
s_add_u32 m0, s21, 33792
s_sub_u32 s39, s22, 1
v_mfma_f32_16x16x32_bf16 v[72:75], a[4:7], v[20:23], 0
buffer_load_dwordx4 v9, s[8:11], s20 offen lds
s_bitcmp1_b32 s39, 1
s_cselect_b32 s38, s54, s55
v_mfma_f32_16x16x32_bf16 v[76:79], a[0:3], v[24:27], 0
ds_read_b128 v[48:51], v19 offset:4096
v_mfma_f32_16x16x32_bf16 v[80:83], a[4:7], v[24:27], 0
s_waitcnt lgkmcnt(4)
s_add_u32 s43, s48, 20480
buffer_load_dwordx4 v[132:135], v96, s[12:15], s43 offen offset:1024
v_mfma_f32_16x16x32_bf16 v[68:71], a[8:11], v[28:31], v[68:71]
ds_read_b128 v[20:23], v16 offset:256
s_add_u32 s38, s38, s44
v_mfma_f32_16x16x32_bf16 v[72:75], a[12:15], v[28:31], v[72:75]
s_lshl_b32 s42, s39, 20
s_add_u32 s38, s38, s42
v_mfma_f32_16x16x32_bf16 v[76:79], a[8:11], v[32:35], v[76:79]
ds_read_b128 v[24:27], v16 offset:4352
s_add_u32 s43, s48, 0
buffer_load_dwordx4 v[168:171], v98, s[12:15], s43 offen offset:2048
v_mfma_f32_16x16x32_bf16 v[80:83], a[12:15], v[32:35], v[80:83]
s_waitcnt lgkmcnt(4)
s_cmp_eq_u32 s37, 0
s_cselect_b32 s38, 0x7ff00000, s38
v_mfma_f32_16x16x32_bf16 v[68:71], a[16:19], v[36:39], v[68:71]
ds_read_b128 v[28:31], v17 offset:256
s_add_u32 m0, s21, 34816
v_mfma_f32_16x16x32_bf16 v[72:75], a[20:23], v[36:39], v[72:75]
buffer_load_dwordx4 v10, s[8:11], s20 offen lds
s_mov_b32 s37, 1
v_mfma_f32_16x16x32_bf16 v[76:79], a[16:19], v[40:43], v[76:79]
ds_read_b128 v[32:35], v17 offset:4352
v_cvt_pk_bf16_f32 v88, v52, v53
v_mfma_f32_16x16x32_bf16 v[80:83], a[20:23], v[40:43], v[80:83]
s_waitcnt lgkmcnt(4)
s_add_u32 s43, s48, 0
buffer_load_dwordx4 v[172:175], v98, s[12:15], s43 offen offset:3072
v_mfma_f32_16x16x32_bf16 v[68:71], a[24:27], v[44:47], v[68:71]
ds_read_b128 v[36:39], v18 offset:256
v_cvt_pk_bf16_f32 v89, v54, v55
v_cvt_pk_bf16_f32 v90, v56, v57
v_mfma_f32_16x16x32_bf16 v[72:75], a[28:31], v[44:47], v[72:75]
v_cvt_pk_bf16_f32 v91, v58, v59
v_mfma_f32_16x16x32_bf16 v[76:79], a[24:27], v[48:51], v[76:79]
ds_read_b128 v[40:43], v18 offset:4352
buffer_store_dwordx4 v[88:91], v86, s[12:15], s38 offen offset:0
v_mfma_f32_16x16x32_bf16 v[80:83], a[28:31], v[48:51], v[80:83]
s_waitcnt lgkmcnt(4)
v_cvt_pk_bf16_f32 v92, v60, v61
v_cvt_pk_bf16_f32 v93, v62, v63
v_mfma_f32_16x16x32_bf16 v[68:71], a[32:35], v[20:23], v[68:71]
ds_read_b128 v[44:47], v19 offset:256
s_add_u32 m0, s21, 35840
v_mfma_f32_16x16x32_bf16 v[72:75], a[36:39], v[20:23], v[72:75]
buffer_load_dwordx4 v11, s[8:11], s20 offen lds
v_cvt_pk_bf16_f32 v94, v64, v65
v_mfma_f32_16x16x32_bf16 v[76:79], a[32:35], v[24:27], v[76:79]
ds_read_b128 v[48:51], v19 offset:4352
v_cvt_pk_bf16_f32 v95, v66, v67
v_mfma_f32_16x16x32_bf16 v[80:83], a[36:39], v[24:27], v[80:83]
s_waitcnt lgkmcnt(4)
buffer_store_dwordx4 v[92:95], v86, s[12:15], s38 offen offset:128
v_mfma_f32_16x16x32_bf16 v[68:71], a[40:43], v[28:31], v[68:71]
s_waitcnt vmcnt(42)
s_barrier
ds_read_b128 v[20:23], v16 offset:16384
v_mfma_f32_16x16x32_bf16 v[72:75], a[44:47], v[28:31], v[72:75]
s_add_u32 s20, s20, 512
v_mfma_f32_16x16x32_bf16 v[76:79], a[40:43], v[32:35], v[76:79]
ds_read_b128 v[24:27], v16 offset:20480
s_add_u32 s43, s48, 4096
buffer_load_dwordx4 v[176:179], v98, s[12:15], s43 offen offset:2048
v_mfma_f32_16x16x32_bf16 v[80:83], a[44:47], v[32:35], v[80:83]
s_waitcnt lgkmcnt(4)
v_mfma_f32_16x16x32_bf16 v[68:71], a[48:51], v[36:39], v[68:71]
ds_read_b128 v[28:31], v17 offset:16384
s_add_u32 m0, s21, 49152
v_mfma_f32_16x16x32_bf16 v[72:75], a[52:55], v[36:39], v[72:75]
buffer_load_dwordx4 v8, s[8:11], s20 offen lds
v_mfma_f32_16x16x32_bf16 v[76:79], a[48:51], v[40:43], v[76:79]
ds_read_b128 v[32:35], v17 offset:20480
v_mfma_f32_16x16x32_bf16 v[80:83], a[52:55], v[40:43], v[80:83]
s_waitcnt lgkmcnt(4)
s_add_u32 s43, s48, 4096
buffer_load_dwordx4 v[180:183], v98, s[12:15], s43 offen offset:3072
v_mfma_f32_16x16x32_bf16 v[68:71], a[56:59], v[44:47], v[68:71]
ds_read_b128 v[36:39], v18 offset:16384
v_mfma_f32_16x16x32_bf16 v[72:75], a[60:63], v[44:47], v[72:75]
v_mfma_f32_16x16x32_bf16 v[76:79], a[56:59], v[48:51], v[76:79]
ds_read_b128 v[40:43], v18 offset:20480
s_add_u32 s43, s48, 16384
buffer_load_dwordx4 v[184:187], v98, s[12:15], s43 offen offset:2048
v_mfma_f32_16x16x32_bf16 v[80:83], a[60:63], v[48:51], v[80:83]
s_waitcnt lgkmcnt(4)
v_mfma_f32_16x16x32_bf16 v[68:71], a[64:67], v[20:23], v[68:71]
ds_read_b128 v[44:47], v19 offset:16384
s_add_u32 m0, s21, 50176
v_mfma_f32_16x16x32_bf16 v[72:75], a[68:71], v[20:23], v[72:75]
buffer_load_dwordx4 v9, s[8:11], s20 offen lds
v_mfma_f32_16x16x32_bf16 v[76:79], a[64:67], v[24:27], v[76:79]
ds_read_b128 v[48:51], v19 offset:20480
v_mfma_f32_16x16x32_bf16 v[80:83], a[68:71], v[24:27], v[80:83]
s_waitcnt lgkmcnt(4)
s_add_u32 s43, s48, 16384
buffer_load_dwordx4 v[188:191], v98, s[12:15], s43 offen offset:3072
v_mfma_f32_16x16x32_bf16 v[68:71], a[72:75], v[28:31], v[68:71]
ds_read_b128 v[20:23], v16 offset:16640
v_mfma_f32_16x16x32_bf16 v[72:75], a[76:79], v[28:31], v[72:75]
v_mfma_f32_16x16x32_bf16 v[76:79], a[72:75], v[32:35], v[76:79]
ds_read_b128 v[24:27], v16 offset:20736
s_add_u32 s24, s24, 1
v_mfma_f32_16x16x32_bf16 v[80:83], a[76:79], v[32:35], v[80:83]
s_waitcnt lgkmcnt(4)
v_mfma_f32_16x16x32_bf16 v[68:71], a[80:83], v[36:39], v[68:71]
ds_read_b128 v[28:31], v17 offset:16640
s_add_u32 m0, s21, 51200
v_mfma_f32_16x16x32_bf16 v[72:75], a[84:87], v[36:39], v[72:75]
buffer_load_dwordx4 v10, s[8:11], s20 offen lds
v_mfma_f32_16x16x32_bf16 v[76:79], a[80:83], v[40:43], v[76:79]
ds_read_b128 v[32:35], v17 offset:20736
v_mfma_f32_16x16x32_bf16 v[80:83], a[84:87], v[40:43], v[80:83]
s_waitcnt lgkmcnt(4)
s_add_u32 s43, s48, 20480
buffer_load_dwordx4 v[192:195], v98, s[12:15], s43 offen offset:2048
v_mfma_f32_16x16x32_bf16 v[68:71], a[88:91], v[44:47], v[68:71]
ds_read_b128 v[36:39], v18 offset:16640
s_min_u32 s24, s24, 63
v_mfma_f32_16x16x32_bf16 v[72:75], a[92:95], v[44:47], v[72:75]
v_mfma_f32_16x16x32_bf16 v[76:79], a[88:91], v[48:51], v[76:79]
ds_read_b128 v[40:43], v18 offset:20736
s_add_u32 s43, s48, 20480
buffer_load_dwordx4 v[196:199], v98, s[12:15], s43 offen offset:3072
v_mfma_f32_16x16x32_bf16 v[80:83], a[92:95], v[48:51], v[80:83]
s_waitcnt lgkmcnt(4)
s_lshl_b32 s53, s24, 16
v_mfma_f32_16x16x32_bf16 v[68:71], a[96:99], v[20:23], v[68:71]
ds_read_b128 v[44:47], v19 offset:16640
s_add_u32 m0, s21, 52224
v_mfma_f32_16x16x32_bf16 v[72:75], a[100:103], v[20:23], v[72:75]
buffer_load_dwordx4 v11, s[8:11], s20 offen lds
v_mfma_f32_16x16x32_bf16 v[76:79], a[96:99], v[24:27], v[76:79]
ds_read_b128 v[48:51], v19 offset:20736
v_mfma_f32_16x16x32_bf16 v[80:83], a[100:103], v[24:27], v[80:83]
s_waitcnt lgkmcnt(4)
v_mfma_f32_16x16x32_bf16 v[68:71], a[104:107], v[28:31], v[68:71]
s_waitcnt vmcnt(47)
s_barrier
ds_read_b128 v[20:23], v16 offset:32768
v_mfma_f32_16x16x32_bf16 v[72:75], a[108:111], v[28:31], v[72:75]
s_mov_b32 s20, s53
v_mfma_f32_16x16x32_bf16 v[76:79], a[104:107], v[32:35], v[76:79]
ds_read_b128 v[24:27], v16 offset:36864
s_add_u32 m0, s7, 0
s_add_u32 s43, s48, 0x8000c00
buffer_load_dwordx4 v96, s[12:15], s43 offen sc1 lds
v_mfma_f32_16x16x32_bf16 v[80:83], a[108:111], v[32:35], v[80:83]
s_waitcnt lgkmcnt(4)
v_mfma_f32_16x16x32_bf16 v[68:71], a[112:115], v[36:39], v[68:71]
ds_read_b128 v[28:31], v17 offset:32768
s_add_u32 m0, s21, 65536
v_mfma_f32_16x16x32_bf16 v[72:75], a[116:119], v[36:39], v[72:75]
buffer_load_dwordx4 v8, s[8:11], s20 offen lds
v_mfma_f32_16x16x32_bf16 v[76:79], a[112:115], v[40:43], v[76:79]
ds_read_b128 v[32:35], v17 offset:36864
v_mfma_f32_16x16x32_bf16 v[80:83], a[116:119], v[40:43], v[80:83]
s_waitcnt lgkmcnt(4)
v_mfma_f32_16x16x32_bf16 v[68:71], a[120:123], v[44:47], v[68:71]
ds_read_b128 v[36:39], v18 offset:32768
v_mfma_f32_16x16x32_bf16 v[72:75], a[124:127], v[44:47], v[72:75]
v_mfma_f32_16x16x32_bf16 v[76:79], a[120:123], v[48:51], v[76:79]
ds_read_b128 v[40:43], v18 offset:36864
s_add_u32 m0, s7, 1024
s_add_u32 s43, s48, 0x8001c00
buffer_load_dwordx4 v96, s[12:15], s43 offen sc1 lds
v_mfma_f32_16x16x32_bf16 v[80:83], a[124:127], v[48:51], v[80:83]
s_waitcnt lgkmcnt(4)
v_mfma_f32_16x16x32_bf16 v[68:71], a[128:131], v[20:23], v[68:71]
ds_read_b128 v[44:47], v19 offset:32768
s_add_u32 m0, s21, 66560
v_mfma_f32_16x16x32_bf16 v[72:75], a[132:135], v[20:23], v[72:75]
buffer_load_dwordx4 v9, s[8:11], s20 offen lds
v_mfma_f32_16x16x32_bf16 v[76:79], a[128:131], v[24:27], v[76:79]
ds_read_b128 v[48:51], v19 offset:36864
v_mfma_f32_16x16x32_bf16 v[80:83], a[132:135], v[24:27], v[80:83]
s_waitcnt lgkmcnt(4)
v_mfma_f32_16x16x32_bf16 v[68:71], a[136:139], v[28:31], v[68:71]
ds_read_b128 v[20:23], v16 offset:33024
v_mfma_f32_16x16x32_bf16 v[72:75], a[140:143], v[28:31], v[72:75]
v_mfma_f32_16x16x32_bf16 v[76:79], a[136:139], v[32:35], v[76:79]
ds_read_b128 v[24:27], v16 offset:37120
s_add_u32 m0, s7, 2048
s_add_u32 s43, s48, 0x8004c00
buffer_load_dwordx4 v96, s[12:15], s43 offen sc1 lds
v_mfma_f32_16x16x32_bf16 v[80:83], a[140:143], v[32:35], v[80:83]
s_waitcnt lgkmcnt(4)
v_mfma_f32_16x16x32_bf16 v[68:71], a[144:147], v[36:39], v[68:71]
ds_read_b128 v[28:31], v17 offset:33024
s_add_u32 m0, s21, 67584
v_mfma_f32_16x16x32_bf16 v[72:75], a[148:151], v[36:39], v[72:75]
buffer_load_dwordx4 v10, s[8:11], s20 offen lds
v_mfma_f32_16x16x32_bf16 v[76:79], a[144:147], v[40:43], v[76:79]
ds_read_b128 v[32:35], v17 offset:37120
v_mfma_f32_16x16x32_bf16 v[80:83], a[148:151], v[40:43], v[80:83]
s_waitcnt lgkmcnt(4)
v_mfma_f32_16x16x32_bf16 v[68:71], a[152:155], v[44:47], v[68:71]
ds_read_b128 v[36:39], v18 offset:33024
v_mfma_f32_16x16x32_bf16 v[72:75], a[156:159], v[44:47], v[72:75]
v_mfma_f32_16x16x32_bf16 v[76:79], a[152:155], v[48:51], v[76:79]
ds_read_b128 v[40:43], v18 offset:37120
v_mfma_f32_16x16x32_bf16 v[80:83], a[156:159], v[48:51], v[80:83]
s_waitcnt lgkmcnt(4)
v_mfma_f32_16x16x32_bf16 v[68:71], a[160:163], v[20:23], v[68:71]
ds_read_b128 v[44:47], v19 offset:33024
s_add_u32 m0, s21, 68608
v_mfma_f32_16x16x32_bf16 v[72:75], a[164:167], v[20:23], v[72:75]
buffer_load_dwordx4 v11, s[8:11], s20 offen lds
v_mfma_f32_16x16x32_bf16 v[76:79], a[160:163], v[24:27], v[76:79]
ds_read_b128 v[48:51], v19 offset:37120
v_mfma_f32_16x16x32_bf16 v[80:83], a[164:167], v[24:27], v[80:83]
s_waitcnt lgkmcnt(4)
s_add_u32 m0, s7, 3072
s_add_u32 s43, s48, 0x8005c00
buffer_load_dwordx4 v96, s[12:15], s43 offen sc1 lds
v_mfma_f32_16x16x32_bf16 v[68:71], a[168:171], v[28:31], v[68:71]
s_waitcnt vmcnt(47)
s_barrier
ds_read_b128 v[20:23], v16 offset:49152
v_mfma_f32_16x16x32_bf16 v[72:75], a[172:175], v[28:31], v[72:75]
s_add_u32 s20, s20, 512
v_mfma_f32_16x16x32_bf16 v[76:79], a[168:171], v[32:35], v[76:79]
ds_read_b128 v[24:27], v16 offset:53248
v_mfma_f32_16x16x32_bf16 v[80:83], a[172:175], v[32:35], v[80:83]
s_waitcnt lgkmcnt(4)
v_mfma_f32_16x16x32_bf16 v[68:71], a[176:179], v[36:39], v[68:71]
ds_read_b128 v[28:31], v17 offset:49152
s_add_u32 m0, s21, 81920
v_mfma_f32_16x16x32_bf16 v[72:75], a[180:183], v[36:39], v[72:75]
buffer_load_dwordx4 v8, s[8:11], s20 offen lds
v_mfma_f32_16x16x32_bf16 v[76:79], a[176:179], v[40:43], v[76:79]
ds_read_b128 v[32:35], v17 offset:53248
v_mfma_f32_16x16x32_bf16 v[80:83], a[180:183], v[40:43], v[80:83]
s_waitcnt lgkmcnt(4)
buffer_load_dword v87, v103, s[32:35], 0 offen sc1
v_mfma_f32_16x16x32_bf16 v[68:71], a[184:187], v[44:47], v[68:71]
ds_read_b128 v[36:39], v18 offset:49152
v_mfma_f32_16x16x32_bf16 v[72:75], a[188:191], v[44:47], v[72:75]
v_mfma_f32_16x16x32_bf16 v[76:79], a[184:187], v[48:51], v[76:79]
ds_read_b128 v[40:43], v18 offset:53248
v_mfma_f32_16x16x32_bf16 v[80:83], a[188:191], v[48:51], v[80:83]
s_waitcnt lgkmcnt(4)
v_mfma_f32_16x16x32_bf16 v[68:71], a[192:195], v[20:23], v[68:71]
ds_read_b128 v[44:47], v19 offset:49152
s_add_u32 m0, s21, 82944
v_mfma_f32_16x16x32_bf16 v[72:75], a[196:199], v[20:23], v[72:75]
buffer_load_dwordx4 v9, s[8:11], s20 offen lds
v_mfma_f32_16x16x32_bf16 v[76:79], a[192:195], v[24:27], v[76:79]
ds_read_b128 v[48:51], v19 offset:53248
v_mfma_f32_16x16x32_bf16 v[80:83], a[196:199], v[24:27], v[80:83]
s_waitcnt lgkmcnt(4)
v_mfma_f32_16x16x32_bf16 v[68:71], a[200:203], v[28:31], v[68:71]
ds_read_b128 v[20:23], v16 offset:49408
v_mfma_f32_16x16x32_bf16 v[72:75], a[204:207], v[28:31], v[72:75]
v_mfma_f32_16x16x32_bf16 v[76:79], a[200:203], v[32:35], v[76:79]
ds_read_b128 v[24:27], v16 offset:53504
v_mfma_f32_16x16x32_bf16 v[80:83], a[204:207], v[32:35], v[80:83]
s_waitcnt lgkmcnt(4)
v_mfma_f32_16x16x32_bf16 v[68:71], a[208:211], v[36:39], v[68:71]
ds_read_b128 v[28:31], v17 offset:49408
s_add_u32 m0, s21, 83968
v_mfma_f32_16x16x32_bf16 v[72:75], a[212:215], v[36:39], v[72:75]
buffer_load_dwordx4 v10, s[8:11], s20 offen lds
v_mfma_f32_16x16x32_bf16 v[76:79], a[208:211], v[40:43], v[76:79]
ds_read_b128 v[32:35], v17 offset:53504
v_mfma_f32_16x16x32_bf16 v[80:83], a[212:215], v[40:43], v[80:83]
s_waitcnt lgkmcnt(4)
v_mfma_f32_16x16x32_bf16 v[68:71], a[216:219], v[44:47], v[68:71]
ds_read_b128 v[36:39], v18 offset:49408
v_mfma_f32_16x16x32_bf16 v[72:75], a[220:223], v[44:47], v[72:75]
v_mfma_f32_16x16x32_bf16 v[76:79], a[216:219], v[48:51], v[76:79]
ds_read_b128 v[40:43], v18 offset:53504
v_mfma_f32_16x16x32_bf16 v[80:83], a[220:223], v[48:51], v[80:83]
s_waitcnt lgkmcnt(4)
v_mfma_f32_16x16x32_bf16 v[68:71], a[224:227], v[20:23], v[68:71]
ds_read_b128 v[44:47], v19 offset:49408
s_add_u32 m0, s21, 84992
v_mfma_f32_16x16x32_bf16 v[72:75], a[228:231], v[20:23], v[72:75]
buffer_load_dwordx4 v11, s[8:11], s20 offen lds
v_mfma_f32_16x16x32_bf16 v[76:79], a[224:227], v[24:27], v[76:79]
ds_read_b128 v[48:51], v19 offset:53504
v_mfma_f32_16x16x32_bf16 v[80:83], a[228:231], v[24:27], v[80:83]
s_waitcnt lgkmcnt(4)
v_mfma_f32_16x16x32_bf16 v[68:71], a[232:235], v[28:31], v[68:71]
s_waitcnt vmcnt(43)
s_barrier
ds_read_b128 v[20:23], v12 offset:0
v_mfma_f32_16x16x32_bf16 v[72:75], a[236:239], v[28:31], v[72:75]
s_add_u32 s20, s20, 512
v_mfma_f32_16x16x32_bf16 v[76:79], a[232:235], v[32:35], v[76:79]
ds_read_b128 v[24:27], v12 offset:4096
v_mfma_f32_16x16x32_bf16 v[80:83], a[236:239], v[32:35], v[80:83]
s_waitcnt lgkmcnt(4)
v_mfma_f32_16x16x32_bf16 v[68:71], a[240:243], v[36:39], v[68:71]
ds_read_b128 v[28:31], v13 offset:0
s_add_u32 m0, s21, 98304
v_mfma_f32_16x16x32_bf16 v[72:75], a[244:247], v[36:39], v[72:75]
buffer_load_dwordx4 v8, s[8:11], s20 offen lds
v_mfma_f32_16x16x32_bf16 v[76:79], a[240:243], v[40:43], v[76:79]
ds_read_b128 v[32:35], v13 offset:4096
v_mfma_f32_16x16x32_bf16 v[80:83], a[244:247], v[40:43], v[80:83]
s_waitcnt lgkmcnt(4)
v_mfma_f32_16x16x32_bf16 v[68:71], a[248:251], v[44:47], v[68:71]
ds_read_b128 v[36:39], v14 offset:0
v_mfma_f32_16x16x32_bf16 v[72:75], a[252:255], v[44:47], v[72:75]
v_mfma_f32_16x16x32_bf16 v[76:79], a[248:251], v[48:51], v[76:79]
ds_read_b128 v[40:43], v14 offset:4096
v_mfma_f32_16x16x32_bf16 v[80:83], a[252:255], v[48:51], v[80:83]
s_waitcnt lgkmcnt(4)
s_add_u32 s22, s22, 1
s_cmp_ge_u32 s22, s23
s_cbranch_scc0 L_st_460
s_branch L_fl1_457
L_st_461:
v_mfma_f32_16x16x32_bf16 v[52:55], a[0:3], v[20:23], 0
ds_read_b128 v[44:47], v15 offset:0
s_add_u32 m0, s21, 99328
s_sub_u32 s39, s22, 1
v_mfma_f32_16x16x32_bf16 v[56:59], a[4:7], v[20:23], 0
buffer_load_dwordx4 v9, s[8:11], s20 offen lds
v_mfma_f32_16x16x32_bf16 v[60:63], a[0:3], v[24:27], 0
ds_read_b128 v[48:51], v15 offset:4096
s_bitcmp1_b32 s39, 1
s_cselect_b32 s38, s54, s55
v_mfma_f32_16x16x32_bf16 v[64:67], a[4:7], v[24:27], 0
s_waitcnt lgkmcnt(4)
v_mfma_f32_16x16x32_bf16 v[52:55], a[8:11], v[28:31], v[52:55]
ds_read_b128 v[20:23], v12 offset:256
s_add_u32 s38, s38, s44
s_waitcnt vmcnt(5)
v_mfma_f32_16x16x32_bf16 v[56:59], a[12:15], v[28:31], v[56:59]
s_lshl_b32 s42, s39, 20
s_add_u32 s38, s38, s42
ds_write_b32 v101, v87
v_mfma_f32_16x16x32_bf16 v[60:63], a[8:11], v[32:35], v[60:63]
ds_read_b128 v[24:27], v12 offset:4352
s_cmp_eq_u32 s37, 0
s_cselect_b32 s38, 0x7ff00000, s38
v_mfma_f32_16x16x32_bf16 v[64:67], a[12:15], v[32:35], v[64:67]
s_waitcnt lgkmcnt(4)
v_mfma_f32_16x16x32_bf16 v[52:55], a[16:19], v[36:39], v[52:55]
ds_read_b128 v[28:31], v13 offset:256
s_add_u32 m0, s21, 100352
v_mfma_f32_16x16x32_bf16 v[56:59], a[20:23], v[36:39], v[56:59]
buffer_load_dwordx4 v10, s[8:11], s20 offen lds
s_mov_b32 s37, 1
v_mfma_f32_16x16x32_bf16 v[60:63], a[16:19], v[40:43], v[60:63]
ds_read_b128 v[32:35], v13 offset:4352
v_cvt_pk_bf16_f32 v88, v68, v69
v_mfma_f32_16x16x32_bf16 v[64:67], a[20:23], v[40:43], v[64:67]
s_waitcnt lgkmcnt(4)
v_cvt_pk_bf16_f32 v89, v70, v71
v_mfma_f32_16x16x32_bf16 v[52:55], a[24:27], v[44:47], v[52:55]
ds_read_b128 v[36:39], v14 offset:256
v_cvt_pk_bf16_f32 v90, v72, v73
v_mfma_f32_16x16x32_bf16 v[56:59], a[28:31], v[44:47], v[56:59]
v_cvt_pk_bf16_f32 v91, v74, v75
v_mfma_f32_16x16x32_bf16 v[60:63], a[24:27], v[48:51], v[60:63]
ds_read_b128 v[40:43], v14 offset:4352
buffer_store_dwordx4 v[88:91], v86, s[12:15], s38 offen offset:0
v_mfma_f32_16x16x32_bf16 v[64:67], a[28:31], v[48:51], v[64:67]
s_waitcnt lgkmcnt(4)
v_cvt_pk_bf16_f32 v92, v76, v77
v_cvt_pk_bf16_f32 v93, v78, v79
v_mfma_f32_16x16x32_bf16 v[52:55], a[32:35], v[20:23], v[52:55]
ds_read_b128 v[44:47], v15 offset:256
s_add_u32 m0, s21, 101376
v_mfma_f32_16x16x32_bf16 v[56:59], a[36:39], v[20:23], v[56:59]
buffer_load_dwordx4 v11, s[8:11], s20 offen lds
v_cvt_pk_bf16_f32 v94, v80, v81
v_mfma_f32_16x16x32_bf16 v[60:63], a[32:35], v[24:27], v[60:63]
ds_read_b128 v[48:51], v15 offset:4352
v_cvt_pk_bf16_f32 v95, v82, v83
v_mfma_f32_16x16x32_bf16 v[64:67], a[36:39], v[24:27], v[64:67]
s_waitcnt lgkmcnt(4)
buffer_store_dwordx4 v[92:95], v86, s[12:15], s38 offen offset:128
v_mfma_f32_16x16x32_bf16 v[52:55], a[40:43], v[28:31], v[52:55]
s_waitcnt vmcnt(27)
s_barrier
ds_read_b128 v[20:23], v12 offset:16384
v_mfma_f32_16x16x32_bf16 v[56:59], a[44:47], v[28:31], v[56:59]
s_add_u32 s20, s20, 512
v_mfma_f32_16x16x32_bf16 v[60:63], a[40:43], v[32:35], v[60:63]
ds_read_b128 v[24:27], v12 offset:20480
ds_read_b32 v87, v102
v_mfma_f32_16x16x32_bf16 v[64:67], a[44:47], v[32:35], v[64:67]
s_waitcnt lgkmcnt(4)
v_mfma_f32_16x16x32_bf16 v[52:55], a[48:51], v[36:39], v[52:55]
ds_read_b128 v[28:31], v13 offset:16384
s_add_u32 m0, s21, 114688
v_mfma_f32_16x16x32_bf16 v[56:59], a[52:55], v[36:39], v[56:59]
buffer_load_dwordx4 v8, s[8:11], s20 offen lds
v_mfma_f32_16x16x32_bf16 v[60:63], a[48:51], v[40:43], v[60:63]
ds_read_b128 v[32:35], v13 offset:20480
v_mfma_f32_16x16x32_bf16 v[64:67], a[52:55], v[40:43], v[64:67]
s_waitcnt lgkmcnt(4)
v_mfma_f32_16x16x32_bf16 v[52:55], a[56:59], v[44:47], v[52:55]
ds_read_b128 v[36:39], v14 offset:16384
v_mfma_f32_16x16x32_bf16 v[56:59], a[60:63], v[44:47], v[56:59]
v_mfma_f32_16x16x32_bf16 v[60:63], a[56:59], v[48:51], v[60:63]
ds_read_b128 v[40:43], v14 offset:20480
v_mfma_f32_16x16x32_bf16 v[64:67], a[60:63], v[48:51], v[64:67]
s_waitcnt lgkmcnt(4)
v_mfma_f32_16x16x32_bf16 v[52:55], a[64:67], v[20:23], v[52:55]
ds_read_b128 v[44:47], v15 offset:16384
s_add_u32 m0, s21, 115712
v_mfma_f32_16x16x32_bf16 v[56:59], a[68:71], v[20:23], v[56:59]
buffer_load_dwordx4 v9, s[8:11], s20 offen lds
v_mfma_f32_16x16x32_bf16 v[60:63], a[64:67], v[24:27], v[60:63]
ds_read_b128 v[48:51], v15 offset:20480
s_branch L_anext_451
L_attr_454:
v_mfma_f32_16x16x32_bf16 v[64:67], a[68:71], v[24:27], v[64:67]
s_waitcnt lgkmcnt(4)
s_add_u32 s43, s94, 0
buffer_store_dwordx4 v[168:171], v100, s[12:15], s43 offen offset:2048 sc1
v_mfma_f32_16x16x32_bf16 v[52:55], a[72:75], v[28:31], v[52:55]
ds_read_b128 v[20:23], v12 offset:16640
v_mfma_f32_16x16x32_bf16 v[56:59], a[76:79], v[28:31], v[56:59]
v_mfma_f32_16x16x32_bf16 v[60:63], a[72:75], v[32:35], v[60:63]
ds_read_b128 v[24:27], v12 offset:20736
s_add_u32 s24, s24, 1
v_mfma_f32_16x16x32_bf16 v[64:67], a[76:79], v[32:35], v[64:67]
s_waitcnt lgkmcnt(4)
v_mfma_f32_16x16x32_bf16 v[52:55], a[80:83], v[36:39], v[52:55]
ds_read_b128 v[28:31], v13 offset:16640
s_add_u32 m0, s21, 116736
v_mfma_f32_16x16x32_bf16 v[56:59], a[84:87], v[36:39], v[56:59]
buffer_load_dwordx4 v10, s[8:11], s20 offen lds
v_mfma_f32_16x16x32_bf16 v[60:63], a[80:83], v[40:43], v[60:63]
ds_read_b128 v[32:35], v13 offset:20736
v_mfma_f32_16x16x32_bf16 v[64:67], a[84:87], v[40:43], v[64:67]
s_waitcnt lgkmcnt(4)
s_min_u32 s24, s24, 63
v_mfma_f32_16x16x32_bf16 v[52:55], a[88:91], v[44:47], v[52:55]
ds_read_b128 v[36:39], v14 offset:16640
v_mfma_f32_16x16x32_bf16 v[56:59], a[92:95], v[44:47], v[56:59]
s_lshl_b32 s53, s24, 16
v_mfma_f32_16x16x32_bf16 v[60:63], a[88:91], v[48:51], v[60:63]
ds_read_b128 v[40:43], v14 offset:20736
s_add_u32 s43, s94, 0
buffer_store_dwordx4 v[172:175], v100, s[12:15], s43 offen offset:2560 sc1
v_mfma_f32_16x16x32_bf16 v[64:67], a[92:95], v[48:51], v[64:67]
s_waitcnt lgkmcnt(4)
v_mfma_f32_16x16x32_bf16 v[52:55], a[96:99], v[20:23], v[52:55]
ds_read_b128 v[44:47], v15 offset:16640
s_add_u32 m0, s21, 117760
v_mfma_f32_16x16x32_bf16 v[56:59], a[100:103], v[20:23], v[56:59]
buffer_load_dwordx4 v11, s[8:11], s20 offen lds
v_mfma_f32_16x16x32_bf16 v[60:63], a[96:99], v[24:27], v[60:63]
ds_read_b128 v[48:51], v15 offset:20736
v_mfma_f32_16x16x32_bf16 v[64:67], a[100:103], v[24:27], v[64:67]
s_waitcnt lgkmcnt(4)
v_mfma_f32_16x16x32_bf16 v[52:55], a[104:107], v[28:31], v[52:55]
s_waitcnt vmcnt(26)
s_barrier
ds_read_b128 v[20:23], v12 offset:32768
v_mfma_f32_16x16x32_bf16 v[56:59], a[108:111], v[28:31], v[56:59]
s_mov_b32 s20, s53
v_mfma_f32_16x16x32_bf16 v[60:63], a[104:107], v[32:35], v[60:63]
ds_read_b128 v[24:27], v12 offset:36864
v_mfma_f32_16x16x32_bf16 v[64:67], a[108:111], v[32:35], v[64:67]
s_waitcnt lgkmcnt(4)
v_mfma_f32_16x16x32_bf16 v[52:55], a[112:115], v[36:39], v[52:55]
ds_read_b128 v[28:31], v13 offset:32768
s_add_u32 m0, s21, 0
v_mfma_f32_16x16x32_bf16 v[56:59], a[116:119], v[36:39], v[56:59]
buffer_load_dwordx4 v8, s[8:11], s20 offen lds
v_mfma_f32_16x16x32_bf16 v[60:63], a[112:115], v[40:43], v[60:63]
ds_read_b128 v[32:35], v13 offset:36864
v_mfma_f32_16x16x32_bf16 v[64:67], a[116:119], v[40:43], v[64:67]
s_waitcnt lgkmcnt(4)
s_add_u32 s43, s94, 4096
buffer_store_dwordx4 v[176:179], v100, s[12:15], s43 offen offset:2048 sc1
v_mfma_f32_16x16x32_bf16 v[52:55], a[120:123], v[44:47], v[52:55]
ds_read_b128 v[36:39], v14 offset:32768
v_mfma_f32_16x16x32_bf16 v[56:59], a[124:127], v[44:47], v[56:59]
v_mfma_f32_16x16x32_bf16 v[60:63], a[120:123], v[48:51], v[60:63]
ds_read_b128 v[40:43], v14 offset:36864
v_mfma_f32_16x16x32_bf16 v[64:67], a[124:127], v[48:51], v[64:67]
s_waitcnt lgkmcnt(4)
v_mfma_f32_16x16x32_bf16 v[52:55], a[128:131], v[20:23], v[52:55]
ds_read_b128 v[44:47], v15 offset:32768
s_add_u32 m0, s21, 1024
v_mfma_f32_16x16x32_bf16 v[56:59], a[132:135], v[20:23], v[56:59]
buffer_load_dwordx4 v9, s[8:11], s20 offen lds
v_mfma_f32_16x16x32_bf16 v[60:63], a[128:131], v[24:27], v[60:63]
ds_read_b128 v[48:51], v15 offset:36864
v_mfma_f32_16x16x32_bf16 v[64:67], a[132:135], v[24:27], v[64:67]
s_waitcnt lgkmcnt(4)
v_mfma_f32_16x16x32_bf16 v[52:55], a[136:139], v[28:31], v[52:55]
ds_read_b128 v[20:23], v12 offset:33024
v_mfma_f32_16x16x32_bf16 v[56:59], a[140:143], v[28:31], v[56:59]
v_mfma_f32_16x16x32_bf16 v[60:63], a[136:139], v[32:35], v[60:63]
ds_read_b128 v[24:27], v12 offset:37120
s_add_u32 s43, s94, 4096
buffer_store_dwordx4 v[180:183], v100, s[12:15], s43 offen offset:2560 sc1
v_mfma_f32_16x16x32_bf16 v[64:67], a[140:143], v[32:35], v[64:67]
s_waitcnt lgkmcnt(4)
v_mfma_f32_16x16x32_bf16 v[52:55], a[144:147], v[36:39], v[52:55]
ds_read_b128 v[28:31], v13 offset:33024
s_add_u32 m0, s21, 2048
v_mfma_f32_16x16x32_bf16 v[56:59], a[148:151], v[36:39], v[56:59]
buffer_load_dwordx4 v10, s[8:11], s20 offen lds
v_mfma_f32_16x16x32_bf16 v[60:63], a[144:147], v[40:43], v[60:63]
ds_read_b128 v[32:35], v13 offset:37120
v_mfma_f32_16x16x32_bf16 v[64:67], a[148:151], v[40:43], v[64:67]
s_waitcnt lgkmcnt(4)
v_mfma_f32_16x16x32_bf16 v[52:55], a[152:155], v[44:47], v[52:55]
ds_read_b128 v[36:39], v14 offset:33024
v_mfma_f32_16x16x32_bf16 v[56:59], a[156:159], v[44:47], v[56:59]
v_mfma_f32_16x16x32_bf16 v[60:63], a[152:155], v[48:51], v[60:63]
ds_read_b128 v[40:43], v14 offset:37120
v_mfma_f32_16x16x32_bf16 v[64:67], a[156:159], v[48:51], v[64:67]
s_waitcnt lgkmcnt(4)
v_mfma_f32_16x16x32_bf16 v[52:55], a[160:163], v[20:23], v[52:55]
ds_read_b128 v[44:47], v15 offset:33024
s_add_u32 m0, s21, 3072
v_mfma_f32_16x16x32_bf16 v[56:59], a[164:167], v[20:23], v[56:59]
buffer_load_dwordx4 v11, s[8:11], s20 offen lds
v_mfma_f32_16x16x32_bf16 v[60:63], a[160:163], v[24:27], v[60:63]
ds_read_b128 v[48:51], v15 offset:37120
v_mfma_f32_16x16x32_bf16 v[64:67], a[164:167], v[24:27], v[64:67]
s_waitcnt lgkmcnt(4)
s_add_u32 s43, s94, 16384
buffer_store_dwordx4 v[184:187], v100, s[12:15], s43 offen offset:2048 sc1
v_mfma_f32_16x16x32_bf16 v[52:55], a[168:171], v[28:31], v[52:55]
s_waitcnt vmcnt(28)
s_barrier
ds_read_b128 v[20:23], v12 offset:49152
v_mfma_f32_16x16x32_bf16 v[56:59], a[172:175], v[28:31], v[56:59]
s_add_u32 s20, s20, 512
v_mfma_f32_16x16x32_bf16 v[60:63], a[168:171], v[32:35], v[60:63]
ds_read_b128 v[24:27], v12 offset:53248
v_mfma_f32_16x16x32_bf16 v[64:67], a[172:175], v[32:35], v[64:67]
s_waitcnt lgkmcnt(4)
v_mfma_f32_16x16x32_bf16 v[52:55], a[176:179], v[36:39], v[52:55]
ds_read_b128 v[28:31], v13 offset:49152
s_add_u32 m0, s21, 16384
v_mfma_f32_16x16x32_bf16 v[56:59], a[180:183], v[36:39], v[56:59]
buffer_load_dwordx4 v8, s[8:11], s20 offen lds
v_mfma_f32_16x16x32_bf16 v[60:63], a[176:179], v[40:43], v[60:63]
ds_read_b128 v[32:35], v13 offset:53248
v_mfma_f32_16x16x32_bf16 v[64:67], a[180:183], v[40:43], v[64:67]
s_waitcnt lgkmcnt(4)
s_add_u32 s43, s94, 16384
buffer_store_dwordx4 v[188:191], v100, s[12:15], s43 offen offset:2560 sc1
v_mfma_f32_16x16x32_bf16 v[52:55], a[184:187], v[44:47], v[52:55]
ds_read_b128 v[36:39], v14 offset:49152
v_mfma_f32_16x16x32_bf16 v[56:59], a[188:191], v[44:47], v[56:59]
v_mfma_f32_16x16x32_bf16 v[60:63], a[184:187], v[48:51], v[60:63]
ds_read_b128 v[40:43], v14 offset:53248
v_mfma_f32_16x16x32_bf16 v[64:67], a[188:191], v[48:51], v[64:67]
s_waitcnt lgkmcnt(4)
v_mfma_f32_16x16x32_bf16 v[52:55], a[192:195], v[20:23], v[52:55]
ds_read_b128 v[44:47], v15 offset:49152
s_add_u32 m0, s21, 17408
v_mfma_f32_16x16x32_bf16 v[56:59], a[196:199], v[20:23], v[56:59]
buffer_load_dwordx4 v9, s[8:11], s20 offen lds
v_mfma_f32_16x16x32_bf16 v[60:63], a[192:195], v[24:27], v[60:63]
ds_read_b128 v[48:51], v15 offset:53248
v_mfma_f32_16x16x32_bf16 v[64:67], a[196:199], v[24:27], v[64:67]
s_waitcnt lgkmcnt(4)
v_mfma_f32_16x16x32_bf16 v[52:55], a[200:203], v[28:31], v[52:55]
ds_read_b128 v[20:23], v12 offset:49408
v_mfma_f32_16x16x32_bf16 v[56:59], a[204:207], v[28:31], v[56:59]
v_mfma_f32_16x16x32_bf16 v[60:63], a[200:203], v[32:35], v[60:63]
ds_read_b128 v[24:27], v12 offset:53504
s_add_u32 s43, s94, 20480
buffer_store_dwordx4 v[192:195], v100, s[12:15], s43 offen offset:2048 sc1
v_mfma_f32_16x16x32_bf16 v[64:67], a[204:207], v[32:35], v[64:67]
s_waitcnt lgkmcnt(4)
v_mfma_f32_16x16x32_bf16 v[52:55], a[208:211], v[36:39], v[52:55]
ds_read_b128 v[28:31], v13 offset:49408
s_add_u32 m0, s21, 18432
v_mfma_f32_16x16x32_bf16 v[56:59], a[212:215], v[36:39], v[56:59]
buffer_load_dwordx4 v10, s[8:11], s20 offen lds
v_mfma_f32_16x16x32_bf16 v[60:63], a[208:211], v[40:43], v[60:63]
ds_read_b128 v[32:35], v13 offset:53504
v_mfma_f32_16x16x32_bf16 v[64:67], a[212:215], v[40:43], v[64:67]
s_waitcnt lgkmcnt(4)
v_mfma_f32_16x16x32_bf16 v[52:55], a[216:219], v[44:47], v[52:55]
ds_read_b128 v[36:39], v14 offset:49408
v_mfma_f32_16x16x32_bf16 v[56:59], a[220:223], v[44:47], v[56:59]
v_mfma_f32_16x16x32_bf16 v[60:63], a[216:219], v[48:51], v[60:63]
ds_read_b128 v[40:43], v14 offset:53504
v_mfma_f32_16x16x32_bf16 v[64:67], a[220:223], v[48:51], v[64:67]
s_waitcnt lgkmcnt(4)
v_mfma_f32_16x16x32_bf16 v[52:55], a[224:227], v[20:23], v[52:55]
ds_read_b128 v[44:47], v15 offset:49408
s_add_u32 m0, s21, 19456
v_mfma_f32_16x16x32_bf16 v[56:59], a[228:231], v[20:23], v[56:59]
buffer_load_dwordx4 v11, s[8:11], s20 offen lds
v_mfma_f32_16x16x32_bf16 v[60:63], a[224:227], v[24:27], v[60:63]
ds_read_b128 v[48:51], v15 offset:53504
v_mfma_f32_16x16x32_bf16 v[64:67], a[228:231], v[24:27], v[64:67]
s_waitcnt lgkmcnt(4)
s_add_u32 s43, s94, 20480
buffer_store_dwordx4 v[196:199], v100, s[12:15], s43 offen offset:2560 sc1
v_mfma_f32_16x16x32_bf16 v[52:55], a[232:235], v[28:31], v[52:55]
s_waitcnt vmcnt(31)
s_barrier
ds_read_b128 v[20:23], v16 offset:0
v_mfma_f32_16x16x32_bf16 v[56:59], a[236:239], v[28:31], v[56:59]
s_add_u32 s20, s20, 512
v_mfma_f32_16x16x32_bf16 v[60:63], a[232:235], v[32:35], v[60:63]
ds_read_b128 v[24:27], v16 offset:4096
v_mfma_f32_16x16x32_bf16 v[64:67], a[236:239], v[32:35], v[64:67]
s_waitcnt lgkmcnt(4)
v_mfma_f32_16x16x32_bf16 v[52:55], a[240:243], v[36:39], v[52:55]
ds_read_b128 v[28:31], v17 offset:0
s_add_u32 m0, s21, 32768
v_mfma_f32_16x16x32_bf16 v[56:59], a[244:247], v[36:39], v[56:59]
buffer_load_dwordx4 v8, s[8:11], s20 offen lds
v_mfma_f32_16x16x32_bf16 v[60:63], a[240:243], v[40:43], v[60:63]
ds_read_b128 v[32:35], v17 offset:4096
v_mfma_f32_16x16x32_bf16 v[64:67], a[244:247], v[40:43], v[64:67]
s_waitcnt lgkmcnt(4)
v_mfma_f32_16x16x32_bf16 v[52:55], a[248:251], v[44:47], v[52:55]
ds_read_b128 v[36:39], v18 offset:0
v_mfma_f32_16x16x32_bf16 v[56:59], a[252:255], v[44:47], v[56:59]
v_mfma_f32_16x16x32_bf16 v[60:63], a[248:251], v[48:51], v[60:63]
ds_read_b128 v[40:43], v18 offset:4096
v_mfma_f32_16x16x32_bf16 v[64:67], a[252:255], v[48:51], v[64:67]
s_waitcnt lgkmcnt(4)
s_add_u32 s22, s22, 1
s_cmp_ge_u32 s22, s23
s_cbranch_scc1 L_fl0_456
v_mfma_f32_16x16x32_bf16 v[68:71], a[0:3], v[20:23], 0
ds_read_b128 v[44:47], v19 offset:0
s_add_u32 m0, s21, 33792
s_sub_u32 s39, s22, 1
v_mfma_f32_16x16x32_bf16 v[72:75], a[4:7], v[20:23], 0
buffer_load_dwordx4 v9, s[8:11], s20 offen lds
v_mfma_f32_16x16x32_bf16 v[76:79], a[0:3], v[24:27], 0
ds_read_b128 v[48:51], v19 offset:4096
s_bitcmp1_b32 s39, 1
s_cselect_b32 s38, s54, s55
v_mfma_f32_16x16x32_bf16 v[80:83], a[4:7], v[24:27], 0
s_waitcnt lgkmcnt(4)
v_mfma_f32_16x16x32_bf16 v[68:71], a[8:11], v[28:31], v[68:71]
ds_read_b128 v[20:23], v16 offset:256
s_add_u32 s38, s38, s44
v_mfma_f32_16x16x32_bf16 v[72:75], a[12:15], v[28:31], v[72:75]
s_lshl_b32 s42, s39, 20
s_add_u32 s38, s38, s42
v_mfma_f32_16x16x32_bf16 v[76:79], a[8:11], v[32:35], v[76:79]
ds_read_b128 v[24:27], v16 offset:4352
s_cmp_eq_u32 s37, 0
s_cselect_b32 s38, 0x7ff00000, s38
v_mfma_f32_16x16x32_bf16 v[80:83], a[12:15], v[32:35], v[80:83]
s_waitcnt lgkmcnt(4)
v_mfma_f32_16x16x32_bf16 v[68:71], a[16:19], v[36:39], v[68:71]
ds_read_b128 v[28:31], v17 offset:256
s_add_u32 m0, s21, 34816
v_mfma_f32_16x16x32_bf16 v[72:75], a[20:23], v[36:39], v[72:75]
buffer_load_dwordx4 v10, s[8:11], s20 offen lds
s_mov_b32 s37, 1
v_mfma_f32_16x16x32_bf16 v[76:79], a[16:19], v[40:43], v[76:79]
ds_read_b128 v[32:35], v17 offset:4352
v_cvt_pk_bf16_f32 v88, v52, v53
v_mfma_f32_16x16x32_bf16 v[80:83], a[20:23], v[40:43], v[80:83]
s_waitcnt lgkmcnt(4)
v_cvt_pk_bf16_f32 v89, v54, v55
v_mfma_f32_16x16x32_bf16 v[68:71], a[24:27], v[44:47], v[68:71]
ds_read_b128 v[36:39], v18 offset:256
v_cvt_pk_bf16_f32 v90, v56, v57
v_mfma_f32_16x16x32_bf16 v[72:75], a[28:31], v[44:47], v[72:75]
v_cvt_pk_bf16_f32 v91, v58, v59
v_mfma_f32_16x16x32_bf16 v[76:79], a[24:27], v[48:51], v[76:79]
ds_read_b128 v[40:43], v18 offset:4352
buffer_store_dwordx4 v[88:91], v86, s[12:15], s38 offen offset:0
v_mfma_f32_16x16x32_bf16 v[80:83], a[28:31], v[48:51], v[80:83]
s_waitcnt lgkmcnt(4)
v_cvt_pk_bf16_f32 v92, v60, v61
v_cvt_pk_bf16_f32 v93, v62, v63
v_mfma_f32_16x16x32_bf16 v[68:71], a[32:35], v[20:23], v[68:71]
ds_read_b128 v[44:47], v19 offset:256
s_add_u32 m0, s21, 35840
v_mfma_f32_16x16x32_bf16 v[72:75], a[36:39], v[20:23], v[72:75]
buffer_load_dwordx4 v11, s[8:11], s20 offen lds
v_cvt_pk_bf16_f32 v94, v64, v65
v_mfma_f32_16x16x32_bf16 v[76:79], a[32:35], v[24:27], v[76:79]
ds_read_b128 v[48:51], v19 offset:4352
v_cvt_pk_bf16_f32 v95, v66, v67
v_mfma_f32_16x16x32_bf16 v[80:83], a[36:39], v[24:27], v[80:83]
s_waitcnt lgkmcnt(4)
buffer_store_dwordx4 v[92:95], v86, s[12:15], s38 offen offset:128
v_mfma_f32_16x16x32_bf16 v[68:71], a[40:43], v[28:31], v[68:71]
s_waitcnt vmcnt(32)
s_barrier
ds_read_b128 v[20:23], v16 offset:16384
v_mfma_f32_16x16x32_bf16 v[72:75], a[44:47], v[28:31], v[72:75]
s_add_u32 s20, s20, 512
v_mfma_f32_16x16x32_bf16 v[76:79], a[40:43], v[32:35], v[76:79]
ds_read_b128 v[24:27], v16 offset:20480
v_mfma_f32_16x16x32_bf16 v[80:83], a[44:47], v[32:35], v[80:83]
s_waitcnt lgkmcnt(4)
v_mfma_f32_16x16x32_bf16 v[68:71], a[48:51], v[36:39], v[68:71]
ds_read_b128 v[28:31], v17 offset:16384
s_add_u32 m0, s21, 49152
v_mfma_f32_16x16x32_bf16 v[72:75], a[52:55], v[36:39], v[72:75]
buffer_load_dwordx4 v8, s[8:11], s20 offen lds
v_mfma_f32_16x16x32_bf16 v[76:79], a[48:51], v[40:43], v[76:79]
ds_read_b128 v[32:35], v17 offset:20480
v_mfma_f32_16x16x32_bf16 v[80:83], a[52:55], v[40:43], v[80:83]
s_waitcnt lgkmcnt(4)
v_mfma_f32_16x16x32_bf16 v[68:71], a[56:59], v[44:47], v[68:71]
ds_read_b128 v[36:39], v18 offset:16384
v_mfma_f32_16x16x32_bf16 v[72:75], a[60:63], v[44:47], v[72:75]
v_mfma_f32_16x16x32_bf16 v[76:79], a[56:59], v[48:51], v[76:79]
ds_read_b128 v[40:43], v18 offset:20480
v_mfma_f32_16x16x32_bf16 v[80:83], a[60:63], v[48:51], v[80:83]
s_waitcnt lgkmcnt(4)
v_mfma_f32_16x16x32_bf16 v[68:71], a[64:67], v[20:23], v[68:71]
ds_read_b128 v[44:47], v19 offset:16384
s_add_u32 m0, s21, 50176
v_mfma_f32_16x16x32_bf16 v[72:75], a[68:71], v[20:23], v[72:75]
buffer_load_dwordx4 v9, s[8:11], s20 offen lds
v_mfma_f32_16x16x32_bf16 v[76:79], a[64:67], v[24:27], v[76:79]
ds_read_b128 v[48:51], v19 offset:20480
v_mfma_f32_16x16x32_bf16 v[80:83], a[68:71], v[24:27], v[80:83]
s_waitcnt lgkmcnt(4)
v_mfma_f32_16x16x32_bf16 v[68:71], a[72:75], v[28:31], v[68:71]
ds_read_b128 v[20:23], v16 offset:16640
v_mfma_f32_16x16x32_bf16 v[72:75], a[76:79], v[28:31], v[72:75]
v_mfma_f32_16x16x32_bf16 v[76:79], a[72:75], v[32:35], v[76:79]
ds_read_b128 v[24:27], v16 offset:20736
s_add_u32 s24, s24, 1
v_mfma_f32_16x16x32_bf16 v[80:83], a[76:79], v[32:35], v[80:83]
s_waitcnt lgkmcnt(4)
v_mfma_f32_16x16x32_bf16 v[68:71], a[80:83], v[36:39], v[68:71]
ds_read_b128 v[28:31], v17 offset:16640
s_add_u32 m0, s21, 51200
v_mfma_f32_16x16x32_bf16 v[72:75], a[84:87], v[36:39], v[72:75]
buffer_load_dwordx4 v10, s[8:11], s20 offen lds
v_mfma_f32_16x16x32_bf16 v[76:79], a[80:83], v[40:43], v[76:79]
ds_read_b128 v[32:35], v17 offset:20736
v_mfma_f32_16x16x32_bf16 v[80:83], a[84:87], v[40:43], v[80:83]
s_waitcnt lgkmcnt(4)
s_min_u32 s24, s24, 63
v_mfma_f32_16x16x32_bf16 v[68:71], a[88:91], v[44:47], v[68:71]
ds_read_b128 v[36:39], v18 offset:16640
v_mfma_f32_16x16x32_bf16 v[72:75], a[92:95], v[44:47], v[72:75]
v_mfma_f32_16x16x32_bf16 v[76:79], a[88:91], v[48:51], v[76:79]
ds_read_b128 v[40:43], v18 offset:20736
s_lshl_b32 s53, s24, 16
v_mfma_f32_16x16x32_bf16 v[80:83], a[92:95], v[48:51], v[80:83]
s_waitcnt lgkmcnt(4)
v_mfma_f32_16x16x32_bf16 v[68:71], a[96:99], v[20:23], v[68:71]
ds_read_b128 v[44:47], v19 offset:16640
s_add_u32 m0, s21, 52224
v_mfma_f32_16x16x32_bf16 v[72:75], a[100:103], v[20:23], v[72:75]
buffer_load_dwordx4 v11, s[8:11], s20 offen lds
v_mfma_f32_16x16x32_bf16 v[76:79], a[96:99], v[24:27], v[76:79]
ds_read_b128 v[48:51], v19 offset:20736
s_waitcnt vmcnt(10)
v_mfma_f32_16x16x32_bf16 v[80:83], a[100:103], v[24:27], v[80:83]
s_waitcnt lgkmcnt(4)
v_mfma_f32_16x16x32_bf16 v[68:71], a[104:107], v[28:31], v[68:71]
s_waitcnt vmcnt(31)
s_barrier
ds_read_b128 v[20:23], v16 offset:32768
v_mfma_f32_16x16x32_bf16 v[72:75], a[108:111], v[28:31], v[72:75]
s_mov_b32 s20, s53
v_mfma_f32_16x16x32_bf16 v[76:79], a[104:107], v[32:35], v[76:79]
ds_read_b128 v[24:27], v16 offset:36864
buffer_atomic_add v84, v85, s[12:15], s51 offen sc1
v_mfma_f32_16x16x32_bf16 v[80:83], a[108:111], v[32:35], v[80:83]
s_waitcnt lgkmcnt(4)
v_mfma_f32_16x16x32_bf16 v[68:71], a[112:115], v[36:39], v[68:71]
ds_read_b128 v[28:31], v17 offset:32768
s_add_u32 m0, s21, 65536
v_mfma_f32_16x16x32_bf16 v[72:75], a[116:119], v[36:39], v[72:75]
buffer_load_dwordx4 v8, s[8:11], s20 offen lds
v_mfma_f32_16x16x32_bf16 v[76:79], a[112:115], v[40:43], v[76:79]
ds_read_b128 v[32:35], v17 offset:36864
v_mfma_f32_16x16x32_bf16 v[80:83], a[116:119], v[40:43], v[80:83]
s_waitcnt lgkmcnt(4)
v_mfma_f32_16x16x32_bf16 v[68:71], a[120:123], v[44:47], v[68:71]
ds_read_b128 v[36:39], v18 offset:32768
v_mfma_f32_16x16x32_bf16 v[72:75], a[124:127], v[44:47], v[72:75]
v_mfma_f32_16x16x32_bf16 v[76:79], a[120:123], v[48:51], v[76:79]
ds_read_b128 v[40:43], v18 offset:36864
v_mfma_f32_16x16x32_bf16 v[80:83], a[124:127], v[48:51], v[80:83]
s_waitcnt lgkmcnt(4)
v_mfma_f32_16x16x32_bf16 v[68:71], a[128:131], v[20:23], v[68:71]
ds_read_b128 v[44:47], v19 offset:32768
s_add_u32 m0, s21, 66560
v_mfma_f32_16x16x32_bf16 v[72:75], a[132:135], v[20:23], v[72:75]
buffer_load_dwordx4 v9, s[8:11], s20 offen lds
v_mfma_f32_16x16x32_bf16 v[76:79], a[128:131], v[24:27], v[76:79]
ds_read_b128 v[48:51], v19 offset:36864
v_mfma_f32_16x16x32_bf16 v[80:83], a[132:135], v[24:27], v[80:83]
s_waitcnt lgkmcnt(4)
v_mfma_f32_16x16x32_bf16 v[68:71], a[136:139], v[28:31], v[68:71]
ds_read_b128 v[20:23], v16 offset:33024
v_mfma_f32_16x16x32_bf16 v[72:75], a[140:143], v[28:31], v[72:75]
v_mfma_f32_16x16x32_bf16 v[76:79], a[136:139], v[32:35], v[76:79]
ds_read_b128 v[24:27], v16 offset:37120
v_mfma_f32_16x16x32_bf16 v[80:83], a[140:143], v[32:35], v[80:83]
s_waitcnt lgkmcnt(4)
v_mfma_f32_16x16x32_bf16 v[68:71], a[144:147], v[36:39], v[68:71]
ds_read_b128 v[28:31], v17 offset:33024
s_add_u32 m0, s21, 67584
v_mfma_f32_16x16x32_bf16 v[72:75], a[148:151], v[36:39], v[72:75]
buffer_load_dwordx4 v10, s[8:11], s20 offen lds
v_mfma_f32_16x16x32_bf16 v[76:79], a[144:147], v[40:43], v[76:79]
ds_read_b128 v[32:35], v17 offset:37120
v_mfma_f32_16x16x32_bf16 v[80:83], a[148:151], v[40:43], v[80:83]
s_waitcnt lgkmcnt(4)
v_mfma_f32_16x16x32_bf16 v[68:71], a[152:155], v[44:47], v[68:71]
ds_read_b128 v[36:39], v18 offset:33024
v_mfma_f32_16x16x32_bf16 v[72:75], a[156:159], v[44:47], v[72:75]
v_mfma_f32_16x16x32_bf16 v[76:79], a[152:155], v[48:51], v[76:79]
ds_read_b128 v[40:43], v18 offset:37120
v_mfma_f32_16x16x32_bf16 v[80:83], a[156:159], v[48:51], v[80:83]
s_waitcnt lgkmcnt(4)
v_mfma_f32_16x16x32_bf16 v[68:71], a[160:163], v[20:23], v[68:71]
ds_read_b128 v[44:47], v19 offset:33024
s_add_u32 m0, s21, 68608
v_mfma_f32_16x16x32_bf16 v[72:75], a[164:167], v[20:23], v[72:75]
buffer_load_dwordx4 v11, s[8:11], s20 offen lds
v_mfma_f32_16x16x32_bf16 v[76:79], a[160:163], v[24:27], v[76:79]
ds_read_b128 v[48:51], v19 offset:37120
v_mfma_f32_16x16x32_bf16 v[80:83], a[164:167], v[24:27], v[80:83]
s_waitcnt lgkmcnt(4)
v_mfma_f32_16x16x32_bf16 v[68:71], a[168:171], v[28:31], v[68:71]
s_waitcnt vmcnt(29)
s_barrier
ds_read_b128 v[20:23], v16 offset:49152
v_mfma_f32_16x16x32_bf16 v[72:75], a[172:175], v[28:31], v[72:75]
s_add_u32 s20, s20, 512
v_mfma_f32_16x16x32_bf16 v[76:79], a[168:171], v[32:35], v[76:79]
ds_read_b128 v[24:27], v16 offset:53248
v_mfma_f32_16x16x32_bf16 v[80:83], a[172:175], v[32:35], v[80:83]
s_waitcnt lgkmcnt(4)
v_mfma_f32_16x16x32_bf16 v[68:71], a[176:179], v[36:39], v[68:71]
ds_read_b128 v[28:31], v17 offset:49152
s_add_u32 m0, s21, 81920
v_mfma_f32_16x16x32_bf16 v[72:75], a[180:183], v[36:39], v[72:75]
buffer_load_dwordx4 v8, s[8:11], s20 offen lds
v_mfma_f32_16x16x32_bf16 v[76:79], a[176:179], v[40:43], v[76:79]
ds_read_b128 v[32:35], v17 offset:53248
v_mfma_f32_16x16x32_bf16 v[80:83], a[180:183], v[40:43], v[80:83]
s_waitcnt lgkmcnt(4)
buffer_load_dword v87, v103, s[32:35], 0 offen sc1
v_mfma_f32_16x16x32_bf16 v[68:71], a[184:187], v[44:47], v[68:71]
ds_read_b128 v[36:39], v18 offset:49152
v_mfma_f32_16x16x32_bf16 v[72:75], a[188:191], v[44:47], v[72:75]
v_mfma_f32_16x16x32_bf16 v[76:79], a[184:187], v[48:51], v[76:79]
ds_read_b128 v[40:43], v18 offset:53248
v_mfma_f32_16x16x32_bf16 v[80:83], a[188:191], v[48:51], v[80:83]
s_waitcnt lgkmcnt(4)
v_mfma_f32_16x16x32_bf16 v[68:71], a[192:195], v[20:23], v[68:71]
ds_read_b128 v[44:47], v19 offset:49152
s_add_u32 m0, s21, 82944
v_mfma_f32_16x16x32_bf16 v[72:75], a[196:199], v[20:23], v[72:75]
buffer_load_dwordx4 v9, s[8:11], s20 offen lds
v_mfma_f32_16x16x32_bf16 v[76:79], a[192:195], v[24:27], v[76:79]
ds_read_b128 v[48:51], v19 offset:53248
v_mfma_f32_16x16x32_bf16 v[80:83], a[196:199], v[24:27], v[80:83]
s_waitcnt lgkmcnt(4)
v_mfma_f32_16x16x32_bf16 v[68:71], a[200:203], v[28:31], v[68:71]
ds_read_b128 v[20:23], v16 offset:49408
v_mfma_f32_16x16x32_bf16 v[72:75], a[204:207], v[28:31], v[72:75]
v_mfma_f32_16x16x32_bf16 v[76:79], a[200:203], v[32:35], v[76:79]
ds_read_b128 v[24:27], v16 offset:53504
v_mfma_f32_16x16x32_bf16 v[80:83], a[204:207], v[32:35], v[80:83]
s_waitcnt lgkmcnt(4)
v_mfma_f32_16x16x32_bf16 v[68:71], a[208:211], v[36:39], v[68:71]
ds_read_b128 v[28:31], v17 offset:49408
s_add_u32 m0, s21, 83968
v_mfma_f32_16x16x32_bf16 v[72:75], a[212:215], v[36:39], v[72:75]
buffer_load_dwordx4 v10, s[8:11], s20 offen lds
v_mfma_f32_16x16x32_bf16 v[76:79], a[208:211], v[40:43], v[76:79]
ds_read_b128 v[32:35], v17 offset:53504
v_mfma_f32_16x16x32_bf16 v[80:83], a[212:215], v[40:43], v[80:83]
s_waitcnt lgkmcnt(4)
v_mfma_f32_16x16x32_bf16 v[68:71], a[216:219], v[44:47], v[68:71]
ds_read_b128 v[36:39], v18 offset:49408
v_mfma_f32_16x16x32_bf16 v[72:75], a[220:223], v[44:47], v[72:75]
v_mfma_f32_16x16x32_bf16 v[76:79], a[216:219], v[48:51], v[76:79]
ds_read_b128 v[40:43], v18 offset:53504
v_mfma_f32_16x16x32_bf16 v[80:83], a[220:223], v[48:51], v[80:83]
s_waitcnt lgkmcnt(4)
v_mfma_f32_16x16x32_bf16 v[68:71], a[224:227], v[20:23], v[68:71]
ds_read_b128 v[44:47], v19 offset:49408
s_add_u32 m0, s21, 84992
v_mfma_f32_16x16x32_bf16 v[72:75], a[228:231], v[20:23], v[72:75]
buffer_load_dwordx4 v11, s[8:11], s20 offen lds
v_mfma_f32_16x16x32_bf16 v[76:79], a[224:227], v[24:27], v[76:79]
ds_read_b128 v[48:51], v19 offset:53504
v_mfma_f32_16x16x32_bf16 v[80:83], a[228:231], v[24:27], v[80:83]
s_waitcnt lgkmcnt(4)
v_mfma_f32_16x16x32_bf16 v[68:71], a[232:235], v[28:31], v[68:71]
s_waitcnt vmcnt(28)
s_barrier
ds_read_b128 v[20:23], v12 offset:0
v_mfma_f32_16x16x32_bf16 v[72:75], a[236:239], v[28:31], v[72:75]
s_add_u32 s20, s20, 512
v_mfma_f32_16x16x32_bf16 v[76:79], a[232:235], v[32:35], v[76:79]
ds_read_b128 v[24:27], v12 offset:4096
v_mfma_f32_16x16x32_bf16 v[80:83], a[236:239], v[32:35], v[80:83]
s_waitcnt lgkmcnt(4)
v_mfma_f32_16x16x32_bf16 v[68:71], a[240:243], v[36:39], v[68:71]
ds_read_b128 v[28:31], v13 offset:0
s_add_u32 m0, s21, 98304
v_mfma_f32_16x16x32_bf16 v[72:75], a[244:247], v[36:39], v[72:75]
buffer_load_dwordx4 v8, s[8:11], s20 offen lds
v_mfma_f32_16x16x32_bf16 v[76:79], a[240:243], v[40:43], v[76:79]
ds_read_b128 v[32:35], v13 offset:4096
v_mfma_f32_16x16x32_bf16 v[80:83], a[244:247], v[40:43], v[80:83]
s_waitcnt lgkmcnt(4)
v_mfma_f32_16x16x32_bf16 v[68:71], a[248:251], v[44:47], v[68:71]
ds_read_b128 v[36:39], v14 offset:0
v_mfma_f32_16x16x32_bf16 v[72:75], a[252:255], v[44:47], v[72:75]
v_mfma_f32_16x16x32_bf16 v[76:79], a[248:251], v[48:51], v[76:79]
ds_read_b128 v[40:43], v14 offset:4096
v_mfma_f32_16x16x32_bf16 v[80:83], a[252:255], v[48:51], v[80:83]
s_waitcnt lgkmcnt(4)
s_add_u32 s22, s22, 1
s_cmp_ge_u32 s22, s23
s_cbranch_scc0 L_st_461
s_branch L_fl1_457
L_st_462:
v_mfma_f32_16x16x32_bf16 v[52:55], a[0:3], v[20:23], 0
ds_read_b128 v[44:47], v15 offset:0
s_add_u32 m0, s21, 99328
s_sub_u32 s39, s22, 1
v_mfma_f32_16x16x32_bf16 v[56:59], a[4:7], v[20:23], 0
buffer_load_dwordx4 v9, s[8:11], s20 offen lds
v_mfma_f32_16x16x32_bf16 v[60:63], a[0:3], v[24:27], 0
ds_read_b128 v[48:51], v15 offset:4096
s_bitcmp1_b32 s39, 1
s_cselect_b32 s38, s54, s55
v_mfma_f32_16x16x32_bf16 v[64:67], a[4:7], v[24:27], 0
s_waitcnt lgkmcnt(4)
v_mfma_f32_16x16x32_bf16 v[52:55], a[8:11], v[28:31], v[52:55]
ds_read_b128 v[20:23], v12 offset:256
s_add_u32 s38, s38, s44
s_waitcnt vmcnt(5)
v_mfma_f32_16x16x32_bf16 v[56:59], a[12:15], v[28:31], v[56:59]
s_lshl_b32 s42, s39, 20
s_add_u32 s38, s38, s42
ds_write_b32 v101, v87
v_mfma_f32_16x16x32_bf16 v[60:63], a[8:11], v[32:35], v[60:63]
ds_read_b128 v[24:27], v12 offset:4352
s_cmp_eq_u32 s37, 0
s_cselect_b32 s38, 0x7ff00000, s38
v_mfma_f32_16x16x32_bf16 v[64:67], a[12:15], v[32:35], v[64:67]
s_waitcnt lgkmcnt(4)
v_mfma_f32_16x16x32_bf16 v[52:55], a[16:19], v[36:39], v[52:55]
ds_read_b128 v[28:31], v13 offset:256
s_add_u32 m0, s21, 100352
v_mfma_f32_16x16x32_bf16 v[56:59], a[20:23], v[36:39], v[56:59]
buffer_load_dwordx4 v10, s[8:11], s20 offen lds
s_mov_b32 s37, 1
v_mfma_f32_16x16x32_bf16 v[60:63], a[16:19], v[40:43], v[60:63]
ds_read_b128 v[32:35], v13 offset:4352
v_cvt_pk_bf16_f32 v88, v68, v69
v_mfma_f32_16x16x32_bf16 v[64:67], a[20:23], v[40:43], v[64:67]
s_waitcnt lgkmcnt(4)
v_cvt_pk_bf16_f32 v89, v70, v71
v_mfma_f32_16x16x32_bf16 v[52:55], a[24:27], v[44:47], v[52:55]
ds_read_b128 v[36:39], v14 offset:256
v_cvt_pk_bf16_f32 v90, v72, v73
v_mfma_f32_16x16x32_bf16 v[56:59], a[28:31], v[44:47], v[56:59]
v_cvt_pk_bf16_f32 v91, v74, v75
v_mfma_f32_16x16x32_bf16 v[60:63], a[24:27], v[48:51], v[60:63]
ds_read_b128 v[40:43], v14 offset:4352
buffer_store_dwordx4 v[88:91], v86, s[12:15], s38 offen offset:0
v_mfma_f32_16x16x32_bf16 v[64:67], a[28:31], v[48:51], v[64:67]
s_waitcnt lgkmcnt(4)
v_cvt_pk_bf16_f32 v92, v76, v77
v_cvt_pk_bf16_f32 v93, v78, v79
v_mfma_f32_16x16x32_bf16 v[52:55], a[32:35], v[20:23], v[52:55]
ds_read_b128 v[44:47], v15 offset:256
s_add_u32 m0, s21, 101376
v_mfma_f32_16x16x32_bf16 v[56:59], a[36:39], v[20:23], v[56:59]
buffer_load_dwordx4 v11, s[8:11], s20 offen lds
v_cvt_pk_bf16_f32 v94, v80, v81
v_mfma_f32_16x16x32_bf16 v[60:63], a[32:35], v[24:27], v[60:63]
ds_read_b128 v[48:51], v15 offset:4352
v_cvt_pk_bf16_f32 v95, v82, v83
v_mfma_f32_16x16x32_bf16 v[64:67], a[36:39], v[24:27], v[64:67]
s_waitcnt lgkmcnt(4)
buffer_store_dwordx4 v[92:95], v86, s[12:15], s38 offen offset:128
v_mfma_f32_16x16x32_bf16 v[52:55], a[40:43], v[28:31], v[52:55]
s_waitcnt vmcnt(44)
s_barrier
ds_read_b128 v[20:23], v12 offset:16384
v_mfma_f32_16x16x32_bf16 v[56:59], a[44:47], v[28:31], v[56:59]
s_add_u32 s20, s20, 512
v_mfma_f32_16x16x32_bf16 v[60:63], a[40:43], v[32:35], v[60:63]
ds_read_b128 v[24:27], v12 offset:20480
ds_read_b32 v87, v102
v_mfma_f32_16x16x32_bf16 v[64:67], a[44:47], v[32:35], v[64:67]
s_waitcnt lgkmcnt(4)
v_mfma_f32_16x16x32_bf16 v[52:55], a[48:51], v[36:39], v[52:55]
ds_read_b128 v[28:31], v13 offset:16384
s_add_u32 m0, s21, 114688
v_mfma_f32_16x16x32_bf16 v[56:59], a[52:55], v[36:39], v[56:59]
buffer_load_dwordx4 v8, s[8:11], s20 offen lds
v_mfma_f32_16x16x32_bf16 v[60:63], a[48:51], v[40:43], v[60:63]
ds_read_b128 v[32:35], v13 offset:20480
v_mfma_f32_16x16x32_bf16 v[64:67], a[52:55], v[40:43], v[64:67]
s_waitcnt lgkmcnt(4)
v_mfma_f32_16x16x32_bf16 v[52:55], a[56:59], v[44:47], v[52:55]
ds_read_b128 v[36:39], v14 offset:16384
v_mfma_f32_16x16x32_bf16 v[56:59], a[60:63], v[44:47], v[56:59]
v_mfma_f32_16x16x32_bf16 v[60:63], a[56:59], v[48:51], v[60:63]
ds_read_b128 v[40:43], v14 offset:20480
v_mfma_f32_16x16x32_bf16 v[64:67], a[60:63], v[48:51], v[64:67]
s_waitcnt lgkmcnt(4)
v_mfma_f32_16x16x32_bf16 v[52:55], a[64:67], v[20:23], v[52:55]
ds_read_b128 v[44:47], v15 offset:16384
s_add_u32 m0, s21, 115712
v_mfma_f32_16x16x32_bf16 v[56:59], a[68:71], v[20:23], v[56:59]
buffer_load_dwordx4 v9, s[8:11], s20 offen lds
v_mfma_f32_16x16x32_bf16 v[60:63], a[64:67], v[24:27], v[60:63]
ds_read_b128 v[48:51], v15 offset:20480
s_waitcnt vmcnt(13)
s_branch L_att_450
L_attr_455:
v_mfma_f32_16x16x32_bf16 v[64:67], a[68:71], v[24:27], v[64:67]
s_waitcnt lgkmcnt(4)
s_add_u32 s43, s94, 0
buffer_store_dwordx4 v[168:171], v100, s[12:15], s43 offen offset:2048 sc1
v_mfma_f32_16x16x32_bf16 v[52:55], a[72:75], v[28:31], v[52:55]
ds_read_b128 v[20:23], v12 offset:16640
v_mfma_f32_16x16x32_bf16 v[56:59], a[76:79], v[28:31], v[56:59]
v_mfma_f32_16x16x32_bf16 v[60:63], a[72:75], v[32:35], v[60:63]
ds_read_b128 v[24:27], v12 offset:20736
s_add_u32 s43, s50, 0
buffer_load_dwordx4 v[136:139], v96, s[12:15], s43 offen offset:0
v_mfma_f32_16x16x32_bf16 v[64:67], a[76:79], v[32:35], v[64:67]
s_waitcnt lgkmcnt(4)
s_add_u32 s24, s24, 1
v_mfma_f32_16x16x32_bf16 v[52:55], a[80:83], v[36:39], v[52:55]
ds_read_b128 v[28:31], v13 offset:16640
s_add_u32 m0, s21, 116736
v_mfma_f32_16x16x32_bf16 v[56:59], a[84:87], v[36:39], v[56:59]
buffer_load_dwordx4 v10, s[8:11], s20 offen lds
v_mfma_f32_16x16x32_bf16 v[60:63], a[80:83], v[40:43], v[60:63]
ds_read_b128 v[32:35], v13 offset:20736
v_mfma_f32_16x16x32_bf16 v[64:67], a[84:87], v[40:43], v[64:67]
s_waitcnt lgkmcnt(4)
s_add_u32 s43, s50, 0
buffer_load_dwordx4 v[140:143], v96, s[12:15], s43 offen offset:1024
v_mfma_f32_16x16x32_bf16 v[52:55], a[88:91], v[44:47], v[52:55]
ds_read_b128 v[36:39], v14 offset:16640
s_min_u32 s24, s24, 63
v_mfma_f32_16x16x32_bf16 v[56:59], a[92:95], v[44:47], v[56:59]
s_lshl_b32 s53, s24, 16
v_mfma_f32_16x16x32_bf16 v[60:63], a[88:91], v[48:51], v[60:63]
ds_read_b128 v[40:43], v14 offset:20736
s_add_u32 s43, s94, 0
buffer_store_dwordx4 v[172:175], v100, s[12:15], s43 offen offset:2560 sc1
v_mfma_f32_16x16x32_bf16 v[64:67], a[92:95], v[48:51], v[64:67]
s_waitcnt lgkmcnt(4)
v_mfma_f32_16x16x32_bf16 v[52:55], a[96:99], v[20:23], v[52:55]
ds_read_b128 v[44:47], v15 offset:16640
s_add_u32 m0, s21, 117760
v_mfma_f32_16x16x32_bf16 v[56:59], a[100:103], v[20:23], v[56:59]
buffer_load_dwordx4 v11, s[8:11], s20 offen lds
v_mfma_f32_16x16x32_bf16 v[60:63], a[96:99], v[24:27], v[60:63]
ds_read_b128 v[48:51], v15 offset:20736
v_mfma_f32_16x16x32_bf16 v[64:67], a[100:103], v[24:27], v[64:67]
s_waitcnt lgkmcnt(4)
s_add_u32 s43, s48, 0
buffer_load_dwordx4 v[104:107], v96, s[12:15], s43 offen offset:0
v_mfma_f32_16x16x32_bf16 v[52:55], a[104:107], v[28:31], v[52:55]
s_waitcnt vmcnt(29)
s_barrier
ds_read_b128 v[20:23], v12 offset:32768
v_mfma_f32_16x16x32_bf16 v[56:59], a[108:111], v[28:31], v[56:59]
s_mov_b32 s20, s53
v_mfma_f32_16x16x32_bf16 v[60:63], a[104:107], v[32:35], v[60:63]
ds_read_b128 v[24:27], v12 offset:36864
s_add_u32 s43, s48, 0
buffer_load_dwordx4 v[108:111], v96, s[12:15], s43 offen offset:1024
v_mfma_f32_16x16x32_bf16 v[64:67], a[108:111], v[32:35], v[64:67]
s_waitcnt lgkmcnt(4)
v_mfma_f32_16x16x32_bf16 v[52:55], a[112:115], v[36:39], v[52:55]
ds_read_b128 v[28:31], v13 offset:32768
s_add_u32 m0, s21, 0
v_mfma_f32_16x16x32_bf16 v[56:59], a[116:119], v[36:39], v[56:59]
buffer_load_dwordx4 v8, s[8:11], s20 offen lds
v_mfma_f32_16x16x32_bf16 v[60:63], a[112:115], v[40:43], v[60:63]
ds_read_b128 v[32:35], v13 offset:36864
v_mfma_f32_16x16x32_bf16 v[64:67], a[116:119], v[40:43], v[64:67]
s_waitcnt lgkmcnt(4)
s_add_u32 s43, s94, 4096
buffer_store_dwordx4 v[176:179], v100, s[12:15], s43 offen offset:2048 sc1
v_mfma_f32_16x16x32_bf16 v[52:55], a[120:123], v[44:47], v[52:55]
ds_read_b128 v[36:39], v14 offset:32768
v_mfma_f32_16x16x32_bf16 v[56:59], a[124:127], v[44:47], v[56:59]
v_mfma_f32_16x16x32_bf16 v[60:63], a[120:123], v[48:51], v[60:63]
ds_read_b128 v[40:43], v14 offset:36864
v_mfma_f32_16x16x32_bf16 v[64:67], a[124:127], v[48:51], v[64:67]
s_waitcnt lgkmcnt(4)
v_mfma_f32_16x16x32_bf16 v[52:55], a[128:131], v[20:23], v[52:55]
ds_read_b128 v[44:47], v15 offset:32768
s_add_u32 m0, s21, 1024
v_mfma_f32_16x16x32_bf16 v[56:59], a[132:135], v[20:23], v[56:59]
buffer_load_dwordx4 v9, s[8:11], s20 offen lds
v_mfma_f32_16x16x32_bf16 v[60:63], a[128:131], v[24:27], v[60:63]
ds_read_b128 v[48:51], v15 offset:36864
v_mfma_f32_16x16x32_bf16 v[64:67], a[132:135], v[24:27], v[64:67]
s_waitcnt lgkmcnt(4)
s_add_u32 s43, s50, 4096
buffer_load_dwordx4 v[144:147], v96, s[12:15], s43 offen offset:0
v_mfma_f32_16x16x32_bf16 v[52:55], a[136:139], v[28:31], v[52:55]
ds_read_b128 v[20:23], v12 offset:33024
v_mfma_f32_16x16x32_bf16 v[56:59], a[140:143], v[28:31], v[56:59]
v_mfma_f32_16x16x32_bf16 v[60:63], a[136:139], v[32:35], v[60:63]
ds_read_b128 v[24:27], v12 offset:37120
s_add_u32 s43, s94, 4096
buffer_store_dwordx4 v[180:183], v100, s[12:15], s43 offen offset:2560 sc1
v_mfma_f32_16x16x32_bf16 v[64:67], a[140:143], v[32:35], v[64:67]
s_waitcnt lgkmcnt(4)
v_mfma_f32_16x16x32_bf16 v[52:55], a[144:147], v[36:39], v[52:55]
ds_read_b128 v[28:31], v13 offset:33024
s_add_u32 m0, s21, 2048
v_mfma_f32_16x16x32_bf16 v[56:59], a[148:151], v[36:39], v[56:59]
buffer_load_dwordx4 v10, s[8:11], s20 offen lds
v_mfma_f32_16x16x32_bf16 v[60:63], a[144:147], v[40:43], v[60:63]
ds_read_b128 v[32:35], v13 offset:37120
v_mfma_f32_16x16x32_bf16 v[64:67], a[148:151], v[40:43], v[64:67]
s_waitcnt lgkmcnt(4)
s_add_u32 s43, s50, 4096
buffer_load_dwordx4 v[148:151], v96, s[12:15], s43 offen offset:1024
v_mfma_f32_16x16x32_bf16 v[52:55], a[152:155], v[44:47], v[52:55]
ds_read_b128 v[36:39], v14 offset:33024
v_mfma_f32_16x16x32_bf16 v[56:59], a[156:159], v[44:47], v[56:59]
v_mfma_f32_16x16x32_bf16 v[60:63], a[152:155], v[48:51], v[60:63]
ds_read_b128 v[40:43], v14 offset:37120
s_add_u32 s43, s48, 4096
buffer_load_dwordx4 v[112:115], v96, s[12:15], s43 offen offset:0
v_mfma_f32_16x16x32_bf16 v[64:67], a[156:159], v[48:51], v[64:67]
s_waitcnt lgkmcnt(4)
v_mfma_f32_16x16x32_bf16 v[52:55], a[160:163], v[20:23], v[52:55]
ds_read_b128 v[44:47], v15 offset:33024
s_add_u32 m0, s21, 3072
v_mfma_f32_16x16x32_bf16 v[56:59], a[164:167], v[20:23], v[56:59]
buffer_load_dwordx4 v11, s[8:11], s20 offen lds
v_mfma_f32_16x16x32_bf16 v[60:63], a[160:163], v[24:27], v[60:63]
ds_read_b128 v[48:51], v15 offset:37120
v_mfma_f32_16x16x32_bf16 v[64:67], a[164:167], v[24:27], v[64:67]
s_waitcnt lgkmcnt(4)
s_add_u32 s43, s94, 16384
buffer_store_dwordx4 v[184:187], v100, s[12:15], s43 offen offset:2048 sc1
v_mfma_f32_16x16x32_bf16 v[52:55], a[168:171], v[28:31], v[52:55]
s_waitcnt vmcnt(35)
s_barrier
ds_read_b128 v[20:23], v12 offset:49152
v_mfma_f32_16x16x32_bf16 v[56:59], a[172:175], v[28:31], v[56:59]
s_add_u32 s20, s20, 512
v_mfma_f32_16x16x32_bf16 v[60:63], a[168:171], v[32:35], v[60:63]
ds_read_b128 v[24:27], v12 offset:53248
s_add_u32 s43, s48, 4096
buffer_load_dwordx4 v[116:119], v96, s[12:15], s43 offen offset:1024
v_mfma_f32_16x16x32_bf16 v[64:67], a[172:175], v[32:35], v[64:67]
s_waitcnt lgkmcnt(4)
v_mfma_f32_16x16x32_bf16 v[52:55], a[176:179], v[36:39], v[52:55]
ds_read_b128 v[28:31], v13 offset:49152
s_add_u32 m0, s21, 16384
v_mfma_f32_16x16x32_bf16 v[56:59], a[180:183], v[36:39], v[56:59]
buffer_load_dwordx4 v8, s[8:11], s20 offen lds
v_mfma_f32_16x16x32_bf16 v[60:63], a[176:179], v[40:43], v[60:63]
ds_read_b128 v[32:35], v13 offset:53248
v_mfma_f32_16x16x32_bf16 v[64:67], a[180:183], v[40:43], v[64:67]
s_waitcnt lgkmcnt(4)
s_add_u32 s43, s94, 16384
buffer_store_dwordx4 v[188:191], v100, s[12:15], s43 offen offset:2560 sc1
v_mfma_f32_16x16x32_bf16 v[52:55], a[184:187], v[44:47], v[52:55]
ds_read_b128 v[36:39], v14 offset:49152
v_mfma_f32_16x16x32_bf16 v[56:59], a[188:191], v[44:47], v[56:59]
v_mfma_f32_16x16x32_bf16 v[60:63], a[184:187], v[48:51], v[60:63]
ds_read_b128 v[40:43], v14 offset:53248
s_add_u32 s43, s50, 16384
buffer_load_dwordx4 v[152:155], v96, s[12:15], s43 offen offset:0
v_mfma_f32_16x16x32_bf16 v[64:67], a[188:191], v[48:51], v[64:67]
s_waitcnt lgkmcnt(4)
v_mfma_f32_16x16x32_bf16 v[52:55], a[192:195], v[20:23], v[52:55]
ds_read_b128 v[44:47], v15 offset:49152
s_add_u32 m0, s21, 17408
v_mfma_f32_16x16x32_bf16 v[56:59], a[196:199], v[20:23], v[56:59]
buffer_load_dwordx4 v9, s[8:11], s20 offen lds
v_mfma_f32_16x16x32_bf16 v[60:63], a[192:195], v[24:27], v[60:63]
ds_read_b128 v[48:51], v15 offset:53248
v_mfma_f32_16x16x32_bf16 v[64:67], a[196:199], v[24:27], v[64:67]
s_waitcnt lgkmcnt(4)
v_mfma_f32_16x16x32_bf16 v[52:55], a[200:203], v[28:31], v[52:55]
ds_read_b128 v[20:23], v12 offset:49408
v_mfma_f32_16x16x32_bf16 v[56:59], a[204:207], v[28:31], v[56:59]
v_mfma_f32_16x16x32_bf16 v[60:63], a[200:203], v[32:35], v[60:63]
ds_read_b128 v[24:27], v12 offset:53504
s_add_u32 s43, s94, 20480
buffer_store_dwordx4 v[192:195], v100, s[12:15], s43 offen offset:2048 sc1
v_mfma_f32_16x16x32_bf16 v[64:67], a[204:207], v[32:35], v[64:67]
s_waitcnt lgkmcnt(4)
v_mfma_f32_16x16x32_bf16 v[52:55], a[208:211], v[36:39], v[52:55]
ds_read_b128 v[28:31], v13 offset:49408
s_add_u32 m0, s21, 18432
v_mfma_f32_16x16x32_bf16 v[56:59], a[212:215], v[36:39], v[56:59]
buffer_load_dwordx4 v10, s[8:11], s20 offen lds
v_mfma_f32_16x16x32_bf16 v[60:63], a[208:211], v[40:43], v[60:63]
ds_read_b128 v[32:35], v13 offset:53504
v_mfma_f32_16x16x32_bf16 v[64:67], a[212:215], v[40:43], v[64:67]
s_waitcnt lgkmcnt(4)
s_add_u32 s43, s50, 16384
buffer_load_dwordx4 v[156:159], v96, s[12:15], s43 offen offset:1024
v_mfma_f32_16x16x32_bf16 v[52:55], a[216:219], v[44:47], v[52:55]
ds_read_b128 v[36:39], v14 offset:49408
v_mfma_f32_16x16x32_bf16 v[56:59], a[220:223], v[44:47], v[56:59]
v_mfma_f32_16x16x32_bf16 v[60:63], a[216:219], v[48:51], v[60:63]
ds_read_b128 v[40:43], v14 offset:53504
s_add_u32 s43, s48, 16384
buffer_load_dwordx4 v[120:123], v96, s[12:15], s43 offen offset:0
v_mfma_f32_16x16x32_bf16 v[64:67], a[220:223], v[48:51], v[64:67]
s_waitcnt lgkmcnt(4)
v_mfma_f32_16x16x32_bf16 v[52:55], a[224:227], v[20:23], v[52:55]
ds_read_b128 v[44:47], v15 offset:49408
s_add_u32 m0, s21, 19456
v_mfma_f32_16x16x32_bf16 v[56:59], a[228:231], v[20:23], v[56:59]
buffer_load_dwordx4 v11, s[8:11], s20 offen lds
v_mfma_f32_16x16x32_bf16 v[60:63], a[224:227], v[24:27], v[60:63]
ds_read_b128 v[48:51], v15 offset:53504
v_mfma_f32_16x16x32_bf16 v[64:67], a[228:231], v[24:27], v[64:67]
s_waitcnt lgkmcnt(4)
s_add_u32 s43, s94, 20480
buffer_store_dwordx4 v[196:199], v100, s[12:15], s43 offen offset:2560 sc1
v_mfma_f32_16x16x32_bf16 v[52:55], a[232:235], v[28:31], v[52:55]
s_waitcnt vmcnt(42)
s_barrier
ds_read_b128 v[20:23], v16 offset:0
v_mfma_f32_16x16x32_bf16 v[56:59], a[236:239], v[28:31], v[56:59]
s_add_u32 s20, s20, 512
v_mfma_f32_16x16x32_bf16 v[60:63], a[232:235], v[32:35], v[60:63]
ds_read_b128 v[24:27], v16 offset:4096
s_add_u32 s43, s48, 16384
buffer_load_dwordx4 v[124:127], v96, s[12:15], s43 offen offset:1024
v_mfma_f32_16x16x32_bf16 v[64:67], a[236:239], v[32:35], v[64:67]
s_waitcnt lgkmcnt(4)
v_mfma_f32_16x16x32_bf16 v[52:55], a[240:243], v[36:39], v[52:55]
ds_read_b128 v[28:31], v17 offset:0
s_add_u32 m0, s21, 32768
v_mfma_f32_16x16x32_bf16 v[56:59], a[244:247], v[36:39], v[56:59]
buffer_load_dwordx4 v8, s[8:11], s20 offen lds
v_mfma_f32_16x16x32_bf16 v[60:63], a[240:243], v[40:43], v[60:63]
ds_read_b128 v[32:35], v17 offset:4096
v_mfma_f32_16x16x32_bf16 v[64:67], a[244:247], v[40:43], v[64:67]
s_waitcnt lgkmcnt(4)
v_mfma_f32_16x16x32_bf16 v[52:55], a[248:251], v[44:47], v[52:55]
ds_read_b128 v[36:39], v18 offset:0
v_mfma_f32_16x16x32_bf16 v[56:59], a[252:255], v[44:47], v[56:59]
v_mfma_f32_16x16x32_bf16 v[60:63], a[248:251], v[48:51], v[60:63]
ds_read_b128 v[40:43], v18 offset:4096
v_mfma_f32_16x16x32_bf16 v[64:67], a[252:255], v[48:51], v[64:67]
s_waitcnt lgkmcnt(4)
s_add_u32 s22, s22, 1
s_cmp_ge_u32 s22, s23
s_cbranch_scc1 L_fl0_456
v_mfma_f32_16x16x32_bf16 v[68:71], a[0:3], v[20:23], 0
ds_read_b128 v[44:47], v19 offset:0
s_add_u32 m0, s21, 33792
s_sub_u32 s39, s22, 1
v_mfma_f32_16x16x32_bf16 v[72:75], a[4:7], v[20:23], 0
buffer_load_dwordx4 v9, s[8:11], s20 offen lds
s_bitcmp1_b32 s39, 1
s_cselect_b32 s38, s54, s55
v_mfma_f32_16x16x32_bf16 v[76:79], a[0:3], v[24:27], 0
ds_read_b128 v[48:51], v19 offset:4096
v_mfma_f32_16x16x32_bf16 v[80:83], a[4:7], v[24:27], 0
s_waitcnt lgkmcnt(4)
s_add_u32 s43, s50, 20480
buffer_load_dwordx4 v[160:163], v96, s[12:15], s43 offen offset:0
v_mfma_f32_16x16x32_bf16 v[68:71], a[8:11], v[28:31], v[68:71]
ds_read_b128 v[20:23], v16 offset:256
s_add_u32 s38, s38, s44
v_mfma_f32_16x16x32_bf16 v[72:75], a[12:15], v[28:31], v[72:75]
s_lshl_b32 s42, s39, 20
s_add_u32 s38, s38, s42
v_mfma_f32_16x16x32_bf16 v[76:79], a[8:11], v[32:35], v[76:79]
ds_read_b128 v[24:27], v16 offset:4352
s_add_u32 s43, s50, 20480
buffer_load_dwordx4 v[164:167], v96, s[12:15], s43 offen offset:1024
v_mfma_f32_16x16x32_bf16 v[80:83], a[12:15], v[32:35], v[80:83]
s_waitcnt lgkmcnt(4)
s_cmp_eq_u32 s37, 0
s_cselect_b32 s38, 0x7ff00000, s38
v_mfma_f32_16x16x32_bf16 v[68:71], a[16:19], v[36:39], v[68:71]
ds_read_b128 v[28:31], v17 offset:256
s_add_u32 m0, s21, 34816
v_mfma_f32_16x16x32_bf16 v[72:75], a[20:23], v[36:39], v[72:75]
buffer_load_dwordx4 v10, s[8:11], s20 offen lds
s_mov_b32 s37, 1
v_mfma_f32_16x16x32_bf16 v[76:79], a[16:19], v[40:43], v[76:79]
ds_read_b128 v[32:35], v17 offset:4352
v_cvt_pk_bf16_f32 v88, v52, v53
v_mfma_f32_16x16x32_bf16 v[80:83], a[20:23], v[40:43], v[80:83]
s_waitcnt lgkmcnt(4)
s_add_u32 s43, s48, 20480
buffer_load_dwordx4 v[128:131], v96, s[12:15], s43 offen offset:0
v_mfma_f32_16x16x32_bf16 v[68:71], a[24:27], v[44:47], v[68:71]
ds_read_b128 v[36:39], v18 offset:256
v_cvt_pk_bf16_f32 v89, v54, v55
v_cvt_pk_bf16_f32 v90, v56, v57
v_mfma_f32_16x16x32_bf16 v[72:75], a[28:31], v[44:47], v[72:75]
v_cvt_pk_bf16_f32 v91, v58, v59
v_mfma_f32_16x16x32_bf16 v[76:79], a[24:27], v[48:51], v[76:79]
ds_read_b128 v[40:43], v18 offset:4352
buffer_store_dwordx4 v[88:91], v86, s[12:15], s38 offen offset:0
v_mfma_f32_16x16x32_bf16 v[80:83], a[28:31], v[48:51], v[80:83]
s_waitcnt lgkmcnt(4)
v_cvt_pk_bf16_f32 v92, v60, v61
v_cvt_pk_bf16_f32 v93, v62, v63
v_mfma_f32_16x16x32_bf16 v[68:71], a[32:35], v[20:23], v[68:71]
ds_read_b128 v[44:47], v19 offset:256
s_add_u32 m0, s21, 35840
v_mfma_f32_16x16x32_bf16 v[72:75], a[36:39], v[20:23], v[72:75]
buffer_load_dwordx4 v11, s[8:11], s20 offen lds
v_cvt_pk_bf16_f32 v94, v64, v65
v_mfma_f32_16x16x32_bf16 v[76:79], a[32:35], v[24:27], v[76:79]
ds_read_b128 v[48:51], v19 offset:4352
v_cvt_pk_bf16_f32 v95, v66, v67
v_mfma_f32_16x16x32_bf16 v[80:83], a[36:39], v[24:27], v[80:83]
s_waitcnt lgkmcnt(4)
buffer_store_dwordx4 v[92:95], v86, s[12:15], s38 offen offset:128
v_mfma_f32_16x16x32_bf16 v[68:71], a[40:43], v[28:31], v[68:71]
s_waitcnt vmcnt(47)
s_barrier
ds_read_b128 v[20:23], v16 offset:16384
v_mfma_f32_16x16x32_bf16 v[72:75], a[44:47], v[28:31], v[72:75]
s_add_u32 s20, s20, 512
v_mfma_f32_16x16x32_bf16 v[76:79], a[40:43], v[32:35], v[76:79]
ds_read_b128 v[24:27], v16 offset:20480
s_add_u32 s43, s48, 20480
buffer_load_dwordx4 v[132:135], v96, s[12:15], s43 offen offset:1024
v_mfma_f32_16x16x32_bf16 v[80:83], a[44:47], v[32:35], v[80:83]
s_waitcnt lgkmcnt(4)
v_mfma_f32_16x16x32_bf16 v[68:71], a[48:51], v[36:39], v[68:71]
ds_read_b128 v[28:31], v17 offset:16384
s_add_u32 m0, s21, 49152
v_mfma_f32_16x16x32_bf16 v[72:75], a[52:55], v[36:39], v[72:75]
buffer_load_dwordx4 v8, s[8:11], s20 offen lds
v_mfma_f32_16x16x32_bf16 v[76:79], a[48:51], v[40:43], v[76:79]
ds_read_b128 v[32:35], v17 offset:20480
v_mfma_f32_16x16x32_bf16 v[80:83], a[52:55], v[40:43], v[80:83]
s_waitcnt lgkmcnt(4)
s_add_u32 s43, s48, 0
buffer_load_dwordx4 v[168:171], v98, s[12:15], s43 offen offset:2048
v_mfma_f32_16x16x32_bf16 v[68:71], a[56:59], v[44:47], v[68:71]
ds_read_b128 v[36:39], v18 offset:16384
v_mfma_f32_16x16x32_bf16 v[72:75], a[60:63], v[44:47], v[72:75]
v_mfma_f32_16x16x32_bf16 v[76:79], a[56:59], v[48:51], v[76:79]
ds_read_b128 v[40:43], v18 offset:20480
s_add_u32 s43, s48, 0
buffer_load_dwordx4 v[172:175], v98, s[12:15], s43 offen offset:3072
v_mfma_f32_16x16x32_bf16 v[80:83], a[60:63], v[48:51], v[80:83]
s_waitcnt lgkmcnt(4)
v_mfma_f32_16x16x32_bf16 v[68:71], a[64:67], v[20:23], v[68:71]
ds_read_b128 v[44:47], v19 offset:16384
s_add_u32 m0, s21, 50176
v_mfma_f32_16x16x32_bf16 v[72:75], a[68:71], v[20:23], v[72:75]
buffer_load_dwordx4 v9, s[8:11], s20 offen lds
v_mfma_f32_16x16x32_bf16 v[76:79], a[64:67], v[24:27], v[76:79]
ds_read_b128 v[48:51], v19 offset:20480
v_mfma_f32_16x16x32_bf16 v[80:83], a[68:71], v[24:27], v[80:83]
s_waitcnt lgkmcnt(4)
s_add_u32 s43, s48, 4096
buffer_load_dwordx4 v[176:179], v98, s[12:15], s43 offen offset:2048
v_mfma_f32_16x16x32_bf16 v[68:71], a[72:75], v[28:31], v[68:71]
ds_read_b128 v[20:23], v16 offset:16640
v_mfma_f32_16x16x32_bf16 v[72:75], a[76:79], v[28:31], v[72:75]
v_mfma_f32_16x16x32_bf16 v[76:79], a[72:75], v[32:35], v[76:79]
ds_read_b128 v[24:27], v16 offset:20736
s_add_u32 s43, s48, 4096
buffer_load_dwordx4 v[180:183], v98, s[12:15], s43 offen offset:3072
v_mfma_f32_16x16x32_bf16 v[80:83], a[76:79], v[32:35], v[80:83]
s_waitcnt lgkmcnt(4)
s_add_u32 s24, s24, 1
v_mfma_f32_16x16x32_bf16 v[68:71], a[80:83], v[36:39], v[68:71]
ds_read_b128 v[28:31], v17 offset:16640
s_add_u32 m0, s21, 51200
v_mfma_f32_16x16x32_bf16 v[72:75], a[84:87], v[36:39], v[72:75]
buffer_load_dwordx4 v10, s[8:11], s20 offen lds
v_mfma_f32_16x16x32_bf16 v[76:79], a[80:83], v[40:43], v[76:79]
ds_read_b128 v[32:35], v17 offset:20736
v_mfma_f32_16x16x32_bf16 v[80:83], a[84:87], v[40:43], v[80:83]
s_waitcnt lgkmcnt(4)
s_add_u32 s43, s48, 16384
buffer_load_dwordx4 v[184:187], v98, s[12:15], s43 offen offset:2048
v_mfma_f32_16x16x32_bf16 v[68:71], a[88:91], v[44:47], v[68:71]
ds_read_b128 v[36:39], v18 offset:16640
s_min_u32 s24, s24, 63
v_mfma_f32_16x16x32_bf16 v[72:75], a[92:95], v[44:47], v[72:75]
s_lshl_b32 s53, s24, 16
v_mfma_f32_16x16x32_bf16 v[76:79], a[88:91], v[48:51], v[76:79]
ds_read_b128 v[40:43], v18 offset:20736
s_add_u32 s43, s48, 16384
buffer_load_dwordx4 v[188:191], v98, s[12:15], s43 offen offset:3072
v_mfma_f32_16x16x32_bf16 v[80:83], a[92:95], v[48:51], v[80:83]
s_waitcnt lgkmcnt(4)
v_mfma_f32_16x16x32_bf16 v[68:71], a[96:99], v[20:23], v[68:71]
ds_read_b128 v[44:47], v19 offset:16640
s_add_u32 m0, s21, 52224
v_mfma_f32_16x16x32_bf16 v[72:75], a[100:103], v[20:23], v[72:75]
buffer_load_dwordx4 v11, s[8:11], s20 offen lds
v_mfma_f32_16x16x32_bf16 v[76:79], a[96:99], v[24:27], v[76:79]
ds_read_b128 v[48:51], v19 offset:20736
s_waitcnt vmcnt(21)
v_mfma_f32_16x16x32_bf16 v[80:83], a[100:103], v[24:27], v[80:83]
s_waitcnt lgkmcnt(4)
s_add_u32 s43, s48, 20480
buffer_load_dwordx4 v[192:195], v98, s[12:15], s43 offen offset:2048
v_mfma_f32_16x16x32_bf16 v[68:71], a[104:107], v[28:31], v[68:71]
s_waitcnt vmcnt(54)
s_barrier
ds_read_b128 v[20:23], v16 offset:32768
v_mfma_f32_16x16x32_bf16 v[72:75], a[108:111], v[28:31], v[72:75]
s_mov_b32 s20, s53
v_mfma_f32_16x16x32_bf16 v[76:79], a[104:107], v[32:35], v[76:79]
ds_read_b128 v[24:27], v16 offset:36864
buffer_atomic_add v84, v85, s[12:15], s51 offen sc1
v_mfma_f32_16x16x32_bf16 v[80:83], a[108:111], v[32:35], v[80:83]
s_waitcnt lgkmcnt(4)
v_mfma_f32_16x16x32_bf16 v[68:71], a[112:115], v[36:39], v[68:71]
ds_read_b128 v[28:31], v17 offset:32768
s_add_u32 m0, s21, 65536
v_mfma_f32_16x16x32_bf16 v[72:75], a[116:119], v[36:39], v[72:75]
buffer_load_dwordx4 v8, s[8:11], s20 offen lds
v_mfma_f32_16x16x32_bf16 v[76:79], a[112:115], v[40:43], v[76:79]
ds_read_b128 v[32:35], v17 offset:36864
v_mfma_f32_16x16x32_bf16 v[80:83], a[116:119], v[40:43], v[80:83]
s_waitcnt lgkmcnt(4)
s_add_u32 s43, s48, 20480
buffer_load_dwordx4 v[196:199], v98, s[12:15], s43 offen offset:3072
v_mfma_f32_16x16x32_bf16 v[68:71], a[120:123], v[44:47], v[68:71]
ds_read_b128 v[36:39], v18 offset:32768
v_mfma_f32_16x16x32_bf16 v[72:75], a[124:127], v[44:47], v[72:75]
v_mfma_f32_16x16x32_bf16 v[76:79], a[120:123], v[48:51], v[76:79]
ds_read_b128 v[40:43], v18 offset:36864
s_add_u32 m0, s7, 0
s_add_u32 s43, s48, 0x8000c00
buffer_load_dwordx4 v96, s[12:15], s43 offen sc1 lds
v_mfma_f32_16x16x32_bf16 v[80:83], a[124:127], v[48:51], v[80:83]
s_waitcnt lgkmcnt(4)
v_mfma_f32_16x16x32_bf16 v[68:71], a[128:131], v[20:23], v[68:71]
ds_read_b128 v[44:47], v19 offset:32768
s_add_u32 m0, s21, 66560
v_mfma_f32_16x16x32_bf16 v[72:75], a[132:135], v[20:23], v[72:75]
buffer_load_dwordx4 v9, s[8:11], s20 offen lds
v_mfma_f32_16x16x32_bf16 v[76:79], a[128:131], v[24:27], v[76:79]
ds_read_b128 v[48:51], v19 offset:36864
v_mfma_f32_16x16x32_bf16 v[80:83], a[132:135], v[24:27], v[80:83]
s_waitcnt lgkmcnt(4)
s_add_u32 m0, s7, 1024
s_add_u32 s43, s48, 0x8001c00
buffer_load_dwordx4 v96, s[12:15], s43 offen sc1 lds
v_mfma_f32_16x16x32_bf16 v[68:71], a[136:139], v[28:31], v[68:71]
ds_read_b128 v[20:23], v16 offset:33024
v_mfma_f32_16x16x32_bf16 v[72:75], a[140:143], v[28:31], v[72:75]
v_mfma_f32_16x16x32_bf16 v[76:79], a[136:139], v[32:35], v[76:79]
ds_read_b128 v[24:27], v16 offset:37120
v_mfma_f32_16x16x32_bf16 v[80:83], a[140:143], v[32:35], v[80:83]
s_waitcnt lgkmcnt(4)
v_mfma_f32_16x16x32_bf16 v[68:71], a[144:147], v[36:39], v[68:71]
ds_read_b128 v[28:31], v17 offset:33024
s_add_u32 m0, s21, 67584
v_mfma_f32_16x16x32_bf16 v[72:75], a[148:151], v[36:39], v[72:75]
buffer_load_dwordx4 v10, s[8:11], s20 offen lds
v_mfma_f32_16x16x32_bf16 v[76:79], a[144:147], v[40:43], v[76:79]
ds_read_b128 v[32:35], v17 offset:37120
v_mfma_f32_16x16x32_bf16 v[80:83], a[148:151], v[40:43], v[80:83]
s_waitcnt lgkmcnt(4)
s_add_u32 m0, s7, 2048
s_add_u32 s43, s48, 0x8004c00
buffer_load_dwordx4 v96, s[12:15], s43 offen sc1 lds
v_mfma_f32_16x16x32_bf16 v[68:71], a[152:155], v[44:47], v[68:71]
ds_read_b128 v[36:39], v18 offset:33024
v_mfma_f32_16x16x32_bf16 v[72:75], a[156:159], v[44:47], v[72:75]
v_mfma_f32_16x16x32_bf16 v[76:79], a[152:155], v[48:51], v[76:79]
ds_read_b128 v[40:43], v18 offset:37120
v_mfma_f32_16x16x32_bf16 v[80:83], a[156:159], v[48:51], v[80:83]
s_waitcnt lgkmcnt(4)
v_mfma_f32_16x16x32_bf16 v[68:71], a[160:163], v[20:23], v[68:71]
ds_read_b128 v[44:47], v19 offset:33024
s_add_u32 m0, s21, 68608
v_mfma_f32_16x16x32_bf16 v[72:75], a[164:167], v[20:23], v[72:75]
buffer_load_dwordx4 v11, s[8:11], s20 offen lds
v_mfma_f32_16x16x32_bf16 v[76:79], a[160:163], v[24:27], v[76:79]
ds_read_b128 v[48:51], v19 offset:37120
v_mfma_f32_16x16x32_bf16 v[80:83], a[164:167], v[24:27], v[80:83]
s_waitcnt lgkmcnt(4)
s_add_u32 m0, s7, 3072
s_add_u32 s43, s48, 0x8005c00
buffer_load_dwordx4 v96, s[12:15], s43 offen sc1 lds
v_mfma_f32_16x16x32_bf16 v[68:71], a[168:171], v[28:31], v[68:71]
s_waitcnt vmcnt(55)
s_barrier
ds_read_b128 v[20:23], v16 offset:49152
v_mfma_f32_16x16x32_bf16 v[72:75], a[172:175], v[28:31], v[72:75]
s_add_u32 s20, s20, 512
v_mfma_f32_16x16x32_bf16 v[76:79], a[168:171], v[32:35], v[76:79]
ds_read_b128 v[24:27], v16 offset:53248
v_mfma_f32_16x16x32_bf16 v[80:83], a[172:175], v[32:35], v[80:83]
s_waitcnt lgkmcnt(4)
v_mfma_f32_16x16x32_bf16 v[68:71], a[176:179], v[36:39], v[68:71]
ds_read_b128 v[28:31], v17 offset:49152
s_add_u32 m0, s21, 81920
v_mfma_f32_16x16x32_bf16 v[72:75], a[180:183], v[36:39], v[72:75]
buffer_load_dwordx4 v8, s[8:11], s20 offen lds
v_mfma_f32_16x16x32_bf16 v[76:79], a[176:179], v[40:43], v[76:79]
ds_read_b128 v[32:35], v17 offset:53248
v_mfma_f32_16x16x32_bf16 v[80:83], a[180:183], v[40:43], v[80:83]
s_waitcnt lgkmcnt(4)
buffer_load_dword v87, v103, s[32:35], 0 offen sc1
v_mfma_f32_16x16x32_bf16 v[68:71], a[184:187], v[44:47], v[68:71]
ds_read_b128 v[36:39], v18 offset:49152
v_mfma_f32_16x16x32_bf16 v[72:75], a[188:191], v[44:47], v[72:75]
v_mfma_f32_16x16x32_bf16 v[76:79], a[184:187], v[48:51], v[76:79]
ds_read_b128 v[40:43], v18 offset:53248
v_mfma_f32_16x16x32_bf16 v[80:83], a[188:191], v[48:51], v[80:83]
s_waitcnt lgkmcnt(4)
v_mfma_f32_16x16x32_bf16 v[68:71], a[192:195], v[20:23], v[68:71]
ds_read_b128 v[44:47], v19 offset:49152
s_add_u32 m0, s21, 82944
v_mfma_f32_16x16x32_bf16 v[72:75], a[196:199], v[20:23], v[72:75]
buffer_load_dwordx4 v9, s[8:11], s20 offen lds
v_mfma_f32_16x16x32_bf16 v[76:79], a[192:195], v[24:27], v[76:79]
ds_read_b128 v[48:51], v19 offset:53248
v_mfma_f32_16x16x32_bf16 v[80:83], a[196:199], v[24:27], v[80:83]
s_waitcnt lgkmcnt(4)
v_mfma_f32_16x16x32_bf16 v[68:71], a[200:203], v[28:31], v[68:71]
ds_read_b128 v[20:23], v16 offset:49408
v_mfma_f32_16x16x32_bf16 v[72:75], a[204:207], v[28:31], v[72:75]
v_mfma_f32_16x16x32_bf16 v[76:79], a[200:203], v[32:35], v[76:79]
ds_read_b128 v[24:27], v16 offset:53504
v_mfma_f32_16x16x32_bf16 v[80:83], a[204:207], v[32:35], v[80:83]
s_waitcnt lgkmcnt(4)
v_mfma_f32_16x16x32_bf16 v[68:71], a[208:211], v[36:39], v[68:71]
ds_read_b128 v[28:31], v17 offset:49408
s_add_u32 m0, s21, 83968
v_mfma_f32_16x16x32_bf16 v[72:75], a[212:215], v[36:39], v[72:75]
buffer_load_dwordx4 v10, s[8:11], s20 offen lds
v_mfma_f32_16x16x32_bf16 v[76:79], a[208:211], v[40:43], v[76:79]
ds_read_b128 v[32:35], v17 offset:53504
v_mfma_f32_16x16x32_bf16 v[80:83], a[212:215], v[40:43], v[80:83]
s_waitcnt lgkmcnt(4)
v_mfma_f32_16x16x32_bf16 v[68:71], a[216:219], v[44:47], v[68:71]
ds_read_b128 v[36:39], v18 offset:49408
v_mfma_f32_16x16x32_bf16 v[72:75], a[220:223], v[44:47], v[72:75]
v_mfma_f32_16x16x32_bf16 v[76:79], a[216:219], v[48:51], v[76:79]
ds_read_b128 v[40:43], v18 offset:53504
v_mfma_f32_16x16x32_bf16 v[80:83], a[220:223], v[48:51], v[80:83]
s_waitcnt lgkmcnt(4)
v_mfma_f32_16x16x32_bf16 v[68:71], a[224:227], v[20:23], v[68:71]
ds_read_b128 v[44:47], v19 offset:49408
s_add_u32 m0, s21, 84992
v_mfma_f32_16x16x32_bf16 v[72:75], a[228:231], v[20:23], v[72:75]
buffer_load_dwordx4 v11, s[8:11], s20 offen lds
v_mfma_f32_16x16x32_bf16 v[76:79], a[224:227], v[24:27], v[76:79]
ds_read_b128 v[48:51], v19 offset:53504
v_mfma_f32_16x16x32_bf16 v[80:83], a[228:231], v[24:27], v[80:83]
s_waitcnt lgkmcnt(4)
v_mfma_f32_16x16x32_bf16 v[68:71], a[232:235], v[28:31], v[68:71]
s_waitcnt vmcnt(49)
s_barrier
ds_read_b128 v[20:23], v12 offset:0
v_mfma_f32_16x16x32_bf16 v[72:75], a[236:239], v[28:31], v[72:75]
s_add_u32 s20, s20, 512
v_mfma_f32_16x16x32_bf16 v[76:79], a[232:235], v[32:35], v[76:79]
ds_read_b128 v[24:27], v12 offset:4096
v_mfma_f32_16x16x32_bf16 v[80:83], a[236:239], v[32:35], v[80:83]
s_waitcnt lgkmcnt(4)
v_mfma_f32_16x16x32_bf16 v[68:71], a[240:243], v[36:39], v[68:71]
ds_read_b128 v[28:31], v13 offset:0
s_add_u32 m0, s21, 98304
v_mfma_f32_16x16x32_bf16 v[72:75], a[244:247], v[36:39], v[72:75]
buffer_load_dwordx4 v8, s[8:11], s20 offen lds
v_mfma_f32_16x16x32_bf16 v[76:79], a[240:243], v[40:43], v[76:79]
ds_read_b128 v[32:35], v13 offset:4096
v_mfma_f32_16x16x32_bf16 v[80:83], a[244:247], v[40:43], v[80:83]
s_waitcnt lgkmcnt(4)
v_mfma_f32_16x16x32_bf16 v[68:71], a[248:251], v[44:47], v[68:71]
ds_read_b128 v[36:39], v14 offset:0
v_mfma_f32_16x16x32_bf16 v[72:75], a[252:255], v[44:47], v[72:75]
v_mfma_f32_16x16x32_bf16 v[76:79], a[248:251], v[48:51], v[76:79]
ds_read_b128 v[40:43], v14 offset:4096
v_mfma_f32_16x16x32_bf16 v[80:83], a[252:255], v[48:51], v[80:83]
s_waitcnt lgkmcnt(4)
s_add_u32 s22, s22, 1
s_cmp_ge_u32 s22, s23
s_cbranch_scc0 L_st_462
L_fl1_457:
s_waitcnt lgkmcnt(0)
s_nop 7
s_sub_u32 s39, s22, 1
s_bitcmp1_b32 s39, 1
s_cselect_b32 s38, s54, s55
s_add_u32 s38, s38, s44
s_lshl_b32 s42, s39, 20
s_add_u32 s38, s38, s42
s_cmp_eq_u32 s37, 0
s_cselect_b32 s38, 0x7ff00000, s38
s_mov_b32 s37, 1
v_cvt_pk_bf16_f32 v88, v68, v69
v_cvt_pk_bf16_f32 v89, v70, v71
v_cvt_pk_bf16_f32 v90, v72, v73
v_cvt_pk_bf16_f32 v91, v74, v75
buffer_store_dwordx4 v[88:91], v86, s[12:15], s38 offen offset:0
v_cvt_pk_bf16_f32 v92, v76, v77
v_cvt_pk_bf16_f32 v93, v78, v79
v_cvt_pk_bf16_f32 v94, v80, v81
v_cvt_pk_bf16_f32 v95, v82, v83
buffer_store_dwordx4 v[92:95], v86, s[12:15], s38 offen offset:128
s_waitcnt vmcnt(0)
s_barrier
s_mov_b32 s25, 0x5901f80
v_mov_b32 v2, 0
L_pl_465:
buffer_load_dword v1, v2, s[12:15], s25 offen sc1
s_add_u32 s36, s36, 1
s_cmp_gt_u32 s36, 0x100000
s_cbranch_scc1 chain_kernel_wend
s_waitcnt vmcnt(0)
v_readfirstlane_b32 s26, v1
s_cmp_ge_u32 s26, 64
s_cbranch_scc1 L_plok_466
s_sleep 4
s_branch L_pl_465
L_plok_466:
s_cmp_eq_u32 s45, 0
s_cbranch_scc1 L_anext_451
L_att_450:
s_waitcnt lgkmcnt(0)
s_add_u32 s38, s47, s49
s_mov_b32 s28, 0x3e0293ee
s_mov_b32 s29, 0x3db504f3
s_cmp_ge_u32 s22, 64
s_cbranch_scc1 L_asrv_467
ds_read_b64 v[216:217], v99 offset:512
ds_read_b64 v[218:219], v99 offset:1536
ds_read_b64 v[220:221], v99 offset:2560
ds_read_b64 v[222:223], v99 offset:3584
v_mfma_f32_32x32x16_bf16 v[200:215], v[104:107], v[136:139], v[240:255]
v_mfma_f32_32x32x16_bf16 v[200:215], v[108:111], v[140:143], v[200:215]
ds_read_b128 v[104:107], v97 offset:0
v_mfma_f32_32x32x16_bf16 v[200:215], v[112:115], v[144:147], v[200:215]
ds_read_b128 v[108:111], v97 offset:256
v_mfma_f32_32x32x16_bf16 v[200:215], v[116:119], v[148:151], v[200:215]
ds_read_b128 v[112:115], v97 offset:1024
v_mfma_f32_32x32x16_bf16 v[200:215], v[120:123], v[152:155], v[200:215]
ds_read_b128 v[116:119], v97 offset:1280
v_mfma_f32_32x32x16_bf16 v[200:215], v[124:127], v[156:159], v[200:215]
ds_read_b128 v[120:123], v97 offset:2048
v_mfma_f32_32x32x16_bf16 v[200:215], v[128:131], v[160:163], v[200:215]
ds_read_b128 v[124:127], v97 offset:2304
v_mfma_f32_32x32x16_bf16 v[200:215], v[132:135], v[164:167], v[200:215]
ds_read_b128 v[128:131], v97 offset:3072
ds_read_b128 v[132:135], v97 offset:3328
s_waitcnt lgkmcnt(2)
v_mfma_f32_32x32x16_bf16 v[68:83], v[104:107], v[136:139], 0
s_nop 0
v_mfma_f32_32x32x16_bf16 v[68:83], v[108:111], v[140:143], v[68:83]
v_max3_f32 v234, v200, v201, v202
s_nop 0
v_mfma_f32_32x32x16_bf16 v[68:83], v[112:115], v[144:147], v[68:83]
v_max3_f32 v235, v203, v204, v205
s_nop 0
v_mfma_f32_32x32x16_bf16 v[68:83], v[116:119], v[148:151], v[68:83]
v_max3_f32 v234, v234, v206, v207
s_nop 0
v_mfma_f32_32x32x16_bf16 v[68:83], v[120:123], v[152:155], v[68:83]
v_max3_f32 v235, v235, v208, v209
s_nop 0
v_mfma_f32_32x32x16_bf16 v[68:83], v[124:127], v[156:159], v[68:83]
v_max3_f32 v234, v234, v210, v211
s_waitcnt lgkmcnt(1)
v_mfma_f32_32x32x16_bf16 v[68:83], v[128:131], v[160:163], v[68:83]
v_max3_f32 v235, v235, v212, v213
s_waitcnt lgkmcnt(0)
v_mfma_f32_32x32x16_bf16 v[68:83], v[132:135], v[164:167], v[68:83]
v_max3_f32 v234, v234, v214, v215
s_nop 10
s_branch L_atail_468
L_asrv_467:
v_mfma_f32_32x32x16_bf16 v[200:215], v[104:107], v[136:139], v[240:255]
v_mfma_f32_32x32x16_bf16 v[200:215], v[108:111], v[140:143], v[200:215]
v_mfma_f32_32x32x16_bf16 v[200:215], v[112:115], v[144:147], v[200:215]
v_mfma_f32_32x32x16_bf16 v[200:215], v[116:119], v[148:151], v[200:215]
v_mfma_f32_32x32x16_bf16 v[200:215], v[120:123], v[152:155], v[200:215]
v_mfma_f32_32x32x16_bf16 v[200:215], v[124:127], v[156:159], v[200:215]
v_mfma_f32_32x32x16_bf16 v[200:215], v[128:131], v[160:163], v[200:215]
v_mfma_f32_32x32x16_bf16 v[200:215], v[132:135], v[164:167], v[200:215]
s_nop 11
v_max3_f32 v234, v200, v201, v202
v_max3_f32 v235, v203, v204, v205
v_max3_f32 v234, v234, v206, v207
v_max3_f32 v235, v235, v208, v209
v_max3_f32 v234, v234, v210, v211
v_max3_f32 v235, v235, v212, v213
v_max3_f32 v234, v234, v214, v215
s_add_u32 s27, s38, 1
s_sub_u32 s26, s38, 1
s_min_u32 s26, s26, 61
s_cmp_ge_u32 s38, 52
s_cselect_b32 s27, s26, s27
v_mov_b32 v2, 4
L_cw_469:
buffer_load_dword v1, v2, s[32:35], 0 offen sc1
s_add_u32 s36, s36, 1
s_cmp_gt_u32 s36, 0x100000
s_cbranch_scc1 chain_kernel_wend
s_waitcnt vmcnt(0)
v_readfirstlane_b32 s25, v1
s_cmp_ge_u32 s25, s27
s_cbranch_scc1 L_cwok_470
s_sleep 4
s_branch L_cw_469
L_cwok_470:
s_add_u32 m0, s7, 0
s_add_u32 s43, s48, 0x8000c00
buffer_load_dwordx4 v96, s[12:15], s43 offen sc1 lds
s_add_u32 m0, s7, 1024
s_add_u32 s43, s48, 0x8001c00
buffer_load_dwordx4 v96, s[12:15], s43 offen sc1 lds
s_add_u32 m0, s7, 2048
s_add_u32 s43, s48, 0x8004c00
buffer_load_dwordx4 v96, s[12:15], s43 offen sc1 lds
s_add_u32 m0, s7, 3072
s_add_u32 s43, s48, 0x8005c00
buffer_load_dwordx4 v96, s[12:15], s43 offen sc1 lds
s_add_u32 s36, s36, 1
s_cmp_gt_u32 s36, 0x100000
s_cbranch_scc1 chain_kernel_wend
s_waitcnt vmcnt(0)
ds_read_b128 v[104:107], v97 offset:0
ds_read_b128 v[108:111], v97 offset:256
ds_read_b64 v[216:217], v99 offset:512
ds_read_b128 v[112:115], v97 offset:1024
ds_read_b128 v[116:119], v97 offset:1280
ds_read_b64 v[218:219], v99 offset:1536
ds_read_b128 v[120:123], v97 offset:2048
ds_read_b128 v[124:127], v97 offset:2304
ds_read_b64 v[220:221], v99 offset:2560
ds_read_b128 v[128:131], v97 offset:3072
ds_read_b128 v[132:135], v97 offset:3328
ds_read_b64 v[222:223], v99 offset:3584
v_mov_b32 v1, 0
s_waitcnt lgkmcnt(11)
v_mfma_f32_32x32x16_bf16 v[68:83], v[104:107], v[136:139], 0
v_max3_u32 v1, v1, v104, v105
v_max3_u32 v1, v1, v106, v107
s_waitcnt lgkmcnt(9)
v_mfma_f32_32x32x16_bf16 v[68:83], v[108:111], v[140:143], v[68:83]
v_max3_u32 v1, v1, v108, v109
v_max3_u32 v1, v1, v110, v111
v_max3_u32 v1, v1, v216, v217
s_waitcnt lgkmcnt(8)
v_mfma_f32_32x32x16_bf16 v[68:83], v[112:115], v[144:147], v[68:83]
v_max3_u32 v1, v1, v112, v113
v_max3_u32 v1, v1, v114, v115
s_waitcnt lgkmcnt(6)
v_mfma_f32_32x32x16_bf16 v[68:83], v[116:119], v[148:151], v[68:83]
v_max3_u32 v1, v1, v116, v117
v_max3_u32 v1, v1, v118, v119
v_max3_u32 v1, v1, v218, v219
s_waitcnt lgkmcnt(5)
v_mfma_f32_32x32x16_bf16 v[68:83], v[120:123], v[152:155], v[68:83]
v_max3_u32 v1, v1, v120, v121
v_max3_u32 v1, v1, v122, v123
s_waitcnt lgkmcnt(3)
v_mfma_f32_32x32x16_bf16 v[68:83], v[124:127], v[156:159], v[68:83]
v_max3_u32 v1, v1, v124, v125
v_max3_u32 v1, v1, v126, v127
v_max3_u32 v1, v1, v220, v221
s_waitcnt lgkmcnt(2)
v_mfma_f32_32x32x16_bf16 v[68:83], v[128:131], v[160:163], v[68:83]
v_max3_u32 v1, v1, v128, v129
v_max3_u32 v1, v1, v130, v131
s_waitcnt lgkmcnt(0)
v_mfma_f32_32x32x16_bf16 v[68:83], v[132:135], v[164:167], v[68:83]
v_max3_u32 v1, v1, v132, v133
v_max3_u32 v1, v1, v134, v135
v_max3_u32 v1, v1, v222, v223
v_cmp_eq_u32 vcc, 0xff81ff81, v1
s_cbranch_vccnz L_cwok_470
s_nop 4
s_cmp_ge_u32 s47, 60
s_cbranch_scc1 L_atail_468
s_add_u32 s43, s50, 4194304
buffer_load_dwordx4 a[32:35], v96, s[12:15], s43 offen offset:0
s_add_u32 s43, s50, 4194304
buffer_load_dwordx4 a[36:39], v96, s[12:15], s43 offen offset:1024
s_add_u32 s43, s48, 4194304
buffer_load_dwordx4 a[0:3], v96, s[12:15], s43 offen offset:0
s_add_u32 s43, s48, 4194304
buffer_load_dwordx4 a[4:7], v96, s[12:15], s43 offen offset:1024
s_add_u32 s43, s50, 4198400
buffer_load_dwordx4 a[40:43], v96, s[12:15], s43 offen offset:0
s_add_u32 s43, s50, 4198400
buffer_load_dwordx4 a[44:47], v96, s[12:15], s43 offen offset:1024
s_add_u32 s43, s48, 4198400
buffer_load_dwordx4 a[8:11], v96, s[12:15], s43 offen offset:0
s_add_u32 s43, s48, 4198400
buffer_load_dwordx4 a[12:15], v96, s[12:15], s43 offen offset:1024
s_add_u32 s43, s50, 4210688
buffer_load_dwordx4 a[48:51], v96, s[12:15], s43 offen offset:0
s_add_u32 s43, s50, 4210688
buffer_load_dwordx4 a[52:55], v96, s[12:15], s43 offen offset:1024
s_add_u32 s43, s48, 4210688
buffer_load_dwordx4 a[16:19], v96, s[12:15], s43 offen offset:0
s_add_u32 s43, s48, 4210688
buffer_load_dwordx4 a[20:23], v96, s[12:15], s43 offen offset:1024
s_add_u32 s43, s50, 4214784
buffer_load_dwordx4 a[56:59], v96, s[12:15], s43 offen offset:0
s_add_u32 s43, s50, 4214784
buffer_load_dwordx4 a[60:63], v96, s[12:15], s43 offen offset:1024
s_add_u32 s43, s48, 4214784
buffer_load_dwordx4 a[24:27], v96, s[12:15], s43 offen offset:0
s_add_u32 s43, s48, 4214784
buffer_load_dwordx4 a[28:31], v96, s[12:15], s43 offen offset:1024
s_add_u32 s43, s48, 4194304
buffer_load_dwordx4 a[64:67], v98, s[12:15], s43 offen offset:2048
s_add_u32 s43, s48, 4194304
buffer_load_dwordx4 a[68:71], v98, s[12:15], s43 offen offset:3072
s_add_u32 s43, s48, 4198400
buffer_load_dwordx4 a[72:75], v98, s[12:15], s43 offen offset:2048
s_add_u32 s43, s48, 4198400
buffer_load_dwordx4 a[76:79], v98, s[12:15], s43 offen offset:3072
s_add_u32 s43, s48, 4210688
buffer_load_dwordx4 a[80:83], v98, s[12:15], s43 offen offset:2048
s_add_u32 s43, s48, 4210688
buffer_load_dwordx4 a[84:87], v98, s[12:15], s43 offen offset:3072
s_add_u32 s43, s48, 4214784
buffer_load_dwordx4 a[88:91], v98, s[12:15], s43 offen offset:2048
s_add_u32 s43, s48, 4214784
buffer_load_dwordx4 a[92:95], v98, s[12:15], s43 offen offset:3072
L_atail_468:
v_max3_f32 v235, v235, v68, v69
v_max3_f32 v234, v234, v70, v71
v_max_f32 v234, v234, v235
v_mov_b32 v235, v234
s_nop 1
v_permlane32_swap_b32 v234, v235
s_nop 0
v_max_f32 v234, v234, v235
v_mul_f32 v234, s28, v234
v_fma_f32 v200, v200, s28, -v234
v_fma_f32 v201, v201, s28, -v234
v_fma_f32 v202, v202, s28, -v234
v_fma_f32 v203, v203, s28, -v234
v_fma_f32 v204, v204, s28, -v234
v_fma_f32 v205, v205, s28, -v234
v_fma_f32 v206, v206, s28, -v234
v_fma_f32 v207, v207, s28, -v234
v_fma_f32 v208, v208, s28, -v234
v_fma_f32 v209, v209, s28, -v234
v_fma_f32 v210, v210, s28, -v234
v_fma_f32 v211, v211, s28, -v234
v_fma_f32 v212, v212, s28, -v234
v_fma_f32 v213, v213, s28, -v234
v_fma_f32 v214, v214, s28, -v234
v_fma_f32 v215, v215, s28, -v234
v_fma_f32 v68, v68, s28, -v234
v_fma_f32 v69, v69, s28, -v234
v_fma_f32 v70, v70, s28, -v234
v_fma_f32 v71, v71, s28, -v234
v_exp_f32 v200, v200
v_exp_f32 v201, v201
v_exp_f32 v202, v202
v_exp_f32 v203, v203
v_exp_f32 v204, v204
v_exp_f32 v205, v205
v_exp_f32 v206, v206
v_exp_f32 v207, v207
v_exp_f32 v208, v208
v_exp_f32 v209, v209
v_exp_f32 v210, v210
v_exp_f32 v211, v211
v_exp_f32 v212, v212
v_exp_f32 v213, v213
v_exp_f32 v214, v214
v_exp_f32 v215, v215
v_exp_f32 v68, v68
v_exp_f32 v69, v69
v_exp_f32 v70, v70
v_exp_f32 v71, v71
v_pk_add_f32 v[236:237], v[200:201], v[202:203]
v_pk_add_f32 v[236:237], v[236:237], v[204:205]
v_pk_add_f32 v[236:237], v[236:237], v[206:207]
v_pk_add_f32 v[236:237], v[236:237], v[208:209]
v_pk_add_f32 v[236:237], v[236:237], v[210:211]
v_pk_add_f32 v[236:237], v[236:237], v[212:213]
v_pk_add_f32 v[236:237], v[236:237], v[214:215]
v_pk_add_f32 v[236:237], v[236:237], v[68:69]
v_pk_add_f32 v[236:237], v[236:237], v[70:71]
v_add_f32 v236, v236, v237
v_mov_b32 v235, v236
s_nop 1
v_permlane32_swap_b32 v236, v235
s_nop 0
v_add_f32 v236, v236, v235
v_rcp_f32 v236, v236
s_nop 0
v_pk_mul_f32 v[200:201], v[200:201], v[236:237] op_sel_hi:[1,0]
v_pk_mul_f32 v[202:203], v[202:203], v[236:237] op_sel_hi:[1,0]
v_pk_mul_f32 v[204:205], v[204:205], v[236:237] op_sel_hi:[1,0]
v_pk_mul_f32 v[206:207], v[206:207], v[236:237] op_sel_hi:[1,0]
v_pk_mul_f32 v[208:209], v[208:209], v[236:237] op_sel_hi:[1,0]
v_pk_mul_f32 v[210:211], v[210:211], v[236:237] op_sel_hi:[1,0]
v_pk_mul_f32 v[212:213], v[212:213], v[236:237] op_sel_hi:[1,0]
v_pk_mul_f32 v[214:215], v[214:215], v[236:237] op_sel_hi:[1,0]
v_pk_mul_f32 v[68:69], v[68:69], v[236:237] op_sel_hi:[1,0]
v_pk_mul_f32 v[70:71], v[70:71], v[236:237] op_sel_hi:[1,0]
v_cvt_pk_bf16_f32 v224, v200, v201
v_cvt_pk_bf16_f32 v225, v202, v203
v_cvt_pk_bf16_f32 v226, v204, v205
v_cvt_pk_bf16_f32 v227, v206, v207
v_cvt_pk_bf16_f32 v228, v208, v209
v_cvt_pk_bf16_f32 v229, v210, v211
v_cvt_pk_bf16_f32 v230, v212, v213
v_cvt_pk_bf16_f32 v231, v214, v215
v_cvt_pk_bf16_f32 v232, v68, v69
v_cvt_pk_bf16_f32 v233, v70, v71
s_nop 1
v_mfma_f32_32x32x16_bf16 v[104:119], v[168:171], v[224:227], 0
v_mfma_f32_32x32x16_bf16 v[104:119], v[172:175], v[228:231], v[104:119]
s_lshl_b32 s25, s38, 9
s_lshr_b32 s26, s46, 3
s_lshl_b32 s26, s26, 7
s_add_u32 s25, s25, s26
v_mfma_f32_32x32x8_bf16 v[104:119], v[216:217], v[232:233], v[104:119]
s_add_u32 s51, s25, 0x5904000
s_mov_b32 s94, s50
s_add_u32 s47, s47, 4
v_mfma_f32_32x32x16_bf16 v[120:135], v[176:179], v[224:227], 0
v_mfma_f32_32x32x16_bf16 v[120:135], v[180:183], v[228:231], v[120:135]
v_cvt_pk_bf16_f32 v168, v104, v105
v_cvt_pk_bf16_f32 v169, v106, v107
v_cvt_pk_bf16_f32 v170, v108, v109
v_cvt_pk_bf16_f32 v171, v110, v111
v_mfma_f32_32x32x8_bf16 v[120:135], v[218:219], v[232:233], v[120:135]
v_cvt_pk_bf16_f32 v172, v112, v113
v_cvt_pk_bf16_f32 v173, v114, v115
v_cvt_pk_bf16_f32 v174, v116, v117
v_cvt_pk_bf16_f32 v175, v118, v119
v_mfma_f32_32x32x16_bf16 v[136:151], v[184:187], v[224:227], 0
v_mfma_f32_32x32x16_bf16 v[136:151], v[188:191], v[228:231], v[136:151]
v_cvt_pk_bf16_f32 v176, v120, v121
v_cvt_pk_bf16_f32 v177, v122, v123
v_cvt_pk_bf16_f32 v178, v124, v125
v_cvt_pk_bf16_f32 v179, v126, v127
v_mfma_f32_32x32x8_bf16 v[136:151], v[220:221], v[232:233], v[136:151]
v_cvt_pk_bf16_f32 v180, v128, v129
v_cvt_pk_bf16_f32 v181, v130, v131
v_cvt_pk_bf16_f32 v182, v132, v133
v_cvt_pk_bf16_f32 v183, v134, v135
v_mfma_f32_32x32x16_bf16 v[152:167], v[192:195], v[224:227], 0
v_mfma_f32_32x32x16_bf16 v[152:167], v[196:199], v[228:231], v[152:167]
v_cvt_pk_bf16_f32 v184, v136, v137
v_cvt_pk_bf16_f32 v185, v138, v139
v_cvt_pk_bf16_f32 v186, v140, v141
v_cvt_pk_bf16_f32 v187, v142, v143
v_mfma_f32_32x32x8_bf16 v[152:167], v[222:223], v[232:233], v[152:167]
v_cvt_pk_bf16_f32 v188, v144, v145
v_cvt_pk_bf16_f32 v189, v146, v147
v_cvt_pk_bf16_f32 v190, v148, v149
v_cvt_pk_bf16_f32 v191, v150, v151
s_nop 7
v_cvt_pk_bf16_f32 v192, v152, v153
v_cvt_pk_bf16_f32 v193, v154, v155
v_cvt_pk_bf16_f32 v194, v156, v157
v_cvt_pk_bf16_f32 v195, v158, v159
v_cvt_pk_bf16_f32 v196, v160, v161
v_cvt_pk_bf16_f32 v197, v162, v163
v_cvt_pk_bf16_f32 v198, v164, v165
v_cvt_pk_bf16_f32 v199, v166, v167
L_anext_451:
s_add_u32 s27, s47, s49
s_lshl_b32 s25, s27, 20
s_lshl_b32 s26, s46, 15
s_add_u32 s25, s25, s26
s_bitcmp1_b32 s27, 1
s_cselect_b32 s48, s55, s54
s_cselect_b32 s50, s54, s55
s_add_u32 s48, s48, s25
s_add_u32 s50, s50, s25
s_waitcnt lgkmcnt(4)
s_cmp_ge_u32 s22, 64
s_cbranch_scc1 L_aserve_463
v_readfirstlane_b32 s25, v87
s_and_b32 s26, s46, 1
s_mul_i32 s26, s26, 2
s_sub_u32 s25, s25, s26
s_sub_u32 s26, s22, 3
s_min_i32 s25, s25, s26
s_add_u32 s26, s47, 4
s_cmp_ge_i32 s25, s26
s_cbranch_scc1 L_ago_471
s_cmp_eq_u32 s45, 0
s_mov_b32 s45, 0
s_cbranch_scc1 L_attr_452
s_branch L_attr_454
L_ago_471:
s_cmp_eq_u32 s45, 0
s_mov_b32 s45, 1
s_cbranch_scc1 L_attr_453
s_branch L_attr_455
L_aserve_463:
s_cmp_eq_u32 s45, 0
s_cbranch_scc1 L_afirst_472
s_add_u32 s43, s94, 0
buffer_store_dwordx4 v[168:171], v100, s[12:15], s43 offen offset:2048 sc1
s_add_u32 s43, s94, 0
buffer_store_dwordx4 v[172:175], v100, s[12:15], s43 offen offset:2560 sc1
s_add_u32 s43, s94, 4096
buffer_store_dwordx4 v[176:179], v100, s[12:15], s43 offen offset:2048 sc1
s_add_u32 s43, s94, 4096
buffer_store_dwordx4 v[180:183], v100, s[12:15], s43 offen offset:2560 sc1
s_add_u32 s43, s94, 16384
buffer_store_dwordx4 v[184:187], v100, s[12:15], s43 offen offset:2048 sc1
s_add_u32 s43, s94, 16384
buffer_store_dwordx4 v[188:191], v100, s[12:15], s43 offen offset:2560 sc1
s_add_u32 s43, s94, 20480
buffer_store_dwordx4 v[192:195], v100, s[12:15], s43 offen offset:2048 sc1
s_add_u32 s43, s94, 20480
buffer_store_dwordx4 v[196:199], v100, s[12:15], s43 offen offset:2560 sc1
s_waitcnt vmcnt(0)
buffer_atomic_add v84, v85, s[12:15], s51 offen sc1
s_cmp_ge_u32 s47, 64
s_cbranch_scc1 L_afin_464
v_accvgpr_read_b32 v104, a0
v_accvgpr_read_b32 v105, a1
v_accvgpr_read_b32 v106, a2
v_accvgpr_read_b32 v107, a3
v_accvgpr_read_b32 v108, a4
v_accvgpr_read_b32 v109, a5
v_accvgpr_read_b32 v110, a6
v_accvgpr_read_b32 v111, a7
v_accvgpr_read_b32 v112, a8
v_accvgpr_read_b32 v113, a9
v_accvgpr_read_b32 v114, a10
v_accvgpr_read_b32 v115, a11
v_accvgpr_read_b32 v116, a12
v_accvgpr_read_b32 v117, a13
v_accvgpr_read_b32 v118, a14
v_accvgpr_read_b32 v119, a15
v_accvgpr_read_b32 v120, a16
v_accvgpr_read_b32 v121, a17
v_accvgpr_read_b32 v122, a18
v_accvgpr_read_b32 v123, a19
v_accvgpr_read_b32 v124, a20
v_accvgpr_read_b32 v125, a21
v_accvgpr_read_b32 v126, a22
v_accvgpr_read_b32 v127, a23
v_accvgpr_read_b32 v128, a24
v_accvgpr_read_b32 v129, a25
v_accvgpr_read_b32 v130, a26
v_accvgpr_read_b32 v131, a27
v_accvgpr_read_b32 v132, a28
v_accvgpr_read_b32 v133, a29
v_accvgpr_read_b32 v134, a30
v_accvgpr_read_b32 v135, a31
v_accvgpr_read_b32 v136, a32
v_accvgpr_read_b32 v137, a33
v_accvgpr_read_b32 v138, a34
v_accvgpr_read_b32 v139, a35
v_accvgpr_read_b32 v140, a36
v_accvgpr_read_b32 v141, a37
v_accvgpr_read_b32 v142, a38
v_accvgpr_read_b32 v143, a39
v_accvgpr_read_b32 v144, a40
v_accvgpr_read_b32 v145, a41
v_accvgpr_read_b32 v146, a42
v_accvgpr_read_b32 v147, a43
v_accvgpr_read_b32 v148, a44
v_accvgpr_read_b32 v149, a45
v_accvgpr_read_b32 v150, a46
v_accvgpr_read_b32 v151, a47
v_accvgpr_read_b32 v152, a48
v_accvgpr_read_b32 v153, a49
v_accvgpr_read_b32 v154, a50
v_accvgpr_read_b32 v155, a51
v_accvgpr_read_b32 v156, a52
v_accvgpr_read_b32 v157, a53
v_accvgpr_read_b32 v158, a54
v_accvgpr_read_b32 v159, a55
v_accvgpr_read_b32 v160, a56
v_accvgpr_read_b32 v161, a57
v_accvgpr_read_b32 v162, a58
v_accvgpr_read_b32 v163, a59
v_accvgpr_read_b32 v164, a60
v_accvgpr_read_b32 v165, a61
v_accvgpr_read_b32 v166, a62
v_accvgpr_read_b32 v167, a63
v_accvgpr_read_b32 v168, a64
v_accvgpr_read_b32 v169, a65
v_accvgpr_read_b32 v170, a66
v_accvgpr_read_b32 v171, a67
v_accvgpr_read_b32 v172, a68
v_accvgpr_read_b32 v173, a69
v_accvgpr_read_b32 v174, a70
v_accvgpr_read_b32 v175, a71
v_accvgpr_read_b32 v176, a72
v_accvgpr_read_b32 v177, a73
v_accvgpr_read_b32 v178, a74
v_accvgpr_read_b32 v179, a75
v_accvgpr_read_b32 v180, a76
v_accvgpr_read_b32 v181, a77
v_accvgpr_read_b32 v182, a78
v_accvgpr_read_b32 v183, a79
v_accvgpr_read_b32 v184, a80
v_accvgpr_read_b32 v185, a81
v_accvgpr_read_b32 v186, a82
v_accvgpr_read_b32 v187, a83
v_accvgpr_read_b32 v188, a84
v_accvgpr_read_b32 v189, a85
v_accvgpr_read_b32 v190, a86
v_accvgpr_read_b32 v191, a87
v_accvgpr_read_b32 v192, a88
v_accvgpr_read_b32 v193, a89
v_accvgpr_read_b32 v194, a90
v_accvgpr_read_b32 v195, a91
v_accvgpr_read_b32 v196, a92
v_accvgpr_read_b32 v197, a93
v_accvgpr_read_b32 v198, a94
v_accvgpr_read_b32 v199, a95
s_branch L_att_450
L_afirst_472:
s_add_u32 s43, s50, 0
buffer_load_dwordx4 v[136:139], v96, s[12:15], s43 offen offset:0
s_add_u32 s43, s50, 0
buffer_load_dwordx4 v[140:143], v96, s[12:15], s43 offen offset:1024
s_add_u32 s43, s48, 0
buffer_load_dwordx4 v[104:107], v96, s[12:15], s43 offen offset:0
s_add_u32 s43, s48, 0
buffer_load_dwordx4 v[108:111], v96, s[12:15], s43 offen offset:1024
s_add_u32 s43, s50, 4096
buffer_load_dwordx4 v[144:147], v96, s[12:15], s43 offen offset:0
s_add_u32 s43, s50, 4096
buffer_load_dwordx4 v[148:151], v96, s[12:15], s43 offen offset:1024
s_add_u32 s43, s48, 4096
buffer_load_dwordx4 v[112:115], v96, s[12:15], s43 offen offset:0
s_add_u32 s43, s48, 4096
buffer_load_dwordx4 v[116:119], v96, s[12:15], s43 offen offset:1024
s_add_u32 s43, s50, 16384
buffer_load_dwordx4 v[152:155], v96, s[12:15], s43 offen offset:0
s_add_u32 s43, s50, 16384
buffer_load_dwordx4 v[156:159], v96, s[12:15], s43 offen offset:1024
s_add_u32 s43, s48, 16384
buffer_load_dwordx4 v[120:123], v96, s[12:15], s43 offen offset:0
s_add_u32 s43, s48, 16384
buffer_load_dwordx4 v[124:127], v96, s[12:15], s43 offen offset:1024
s_add_u32 s43, s50, 20480
buffer_load_dwordx4 v[160:163], v96, s[12:15], s43 offen offset:0
s_add_u32 s43, s50, 20480
buffer_load_dwordx4 v[164:167], v96, s[12:15], s43 offen offset:1024
s_add_u32 s43, s48, 20480
buffer_load_dwordx4 v[128:131], v96, s[12:15], s43 offen offset:0
s_add_u32 s43, s48, 20480
buffer_load_dwordx4 v[132:135], v96, s[12:15], s43 offen offset:1024
s_add_u32 s43, s48, 0
buffer_load_dwordx4 v[168:171], v98, s[12:15], s43 offen offset:2048
s_add_u32 s43, s48, 0
buffer_load_dwordx4 v[172:175], v98, s[12:15], s43 offen offset:3072
s_add_u32 s43, s48, 4096
buffer_load_dwordx4 v[176:179], v98, s[12:15], s43 offen offset:2048
s_add_u32 s43, s48, 4096
buffer_load_dwordx4 v[180:183], v98, s[12:15], s43 offen offset:3072
s_add_u32 s43, s48, 16384
buffer_load_dwordx4 v[184:187], v98, s[12:15], s43 offen offset:2048
s_add_u32 s43, s48, 16384
buffer_load_dwordx4 v[188:191], v98, s[12:15], s43 offen offset:3072
s_add_u32 s43, s48, 20480
buffer_load_dwordx4 v[192:195], v98, s[12:15], s43 offen offset:2048
s_add_u32 s43, s48, 20480
buffer_load_dwordx4 v[196:199], v98, s[12:15], s43 offen offset:3072
s_mov_b32 s45, 1
s_waitcnt vmcnt(0)
s_branch L_att_450
L_afin_464:
s_branch L_ste_458
L_fl0_456:
s_waitcnt lgkmcnt(0)
s_nop 7
L_ste_458:
s_branch chain_kernel_wend
L_g1_433:
s_cmp_ge_u32 s41, 16
s_cbranch_scc1 L_g2_434
s_mov_b32 s8, s64
s_and_b32 s9, s65, 0xffff
s_mov_b32 s10, 0x400000
s_mov_b32 s11, 0x00020000
v_lshlrev_b32 v1, 4, v0
s_lshl_b32 s25, s41, 12
buffer_load_dwordx4 v[52:55], v1, s[8:11], s25 offen
s_add_u32 s25, s25, 65536
buffer_load_dwordx4 v[52:55], v1, s[8:11], s25 offen
s_add_u32 s25, s25, 65536
buffer_load_dwordx4 v[52:55], v1, s[8:11], s25 offen
s_add_u32 s25, s25, 65536
buffer_load_dwordx4 v[52:55], v1, s[8:11], s25 offen
s_add_u32 s25, s25, 65536
s_lshl_b32 s46, s41, 6
s_lshl_b32 s25, s49, 4
s_add_u32 s46, s46, s25
v_and_b32 v1, 15, v0
v_add_u32 v1, s46, v1
v_bfe_u32 v2, v0, 4, 2
v_lshlrev_b32 v3, 1, v1
s_mov_b32 s16, s66
s_and_b32 s17, s67, 0xffff
s_mov_b32 s18, 0x800
s_mov_b32 s19, 0x00020000
buffer_load_ushort v128, v3, s[16:19], 0 offen
s_mov_b32 s16, s68
s_and_b32 s17, s69, 0xffff
s_mov_b32 s18, 0x800
s_mov_b32 s19, 0x00020000
buffer_load_ushort v129, v3, s[16:19], 0 offen
s_mov_b32 s16, s78
s_and_b32 s17, s79, 0xffff
s_mov_b32 s18, 0x800
s_mov_b32 s19, 0x00020000
buffer_load_ushort v130, v3, s[16:19], 0 offen
s_mov_b32 s16, s70
s_and_b32 s17, s71, 0xffff
s_mov_b32 s18, 0x200000
s_mov_b32 s19, 0x00020000
s_mov_b32 s32, s72
s_and_b32 s33, s73, 0xffff
s_mov_b32 s34, 0x200000
s_mov_b32 s35, 0x00020000
v_and_b32 v5, 3, v0
v_cmp_eq_u32 vcc, v5, v2
v_and_b32 v5, 1, v0
v_lshlrev_b32 v5, 4, v5
v_cndmask_b32 v116, 0, 1.0, vcc
v_mov_b32 v6, 0x3f80
v_lshlrev_b32 v6, v5, v6
v_bfe_u32 v5, v0, 1, 3
v_lshlrev_b32 v7, 2, v2
v_sub_u32 v5, v5, v7
v_cmp_eq_i32 vcc, 0, v5
s_nop 1
v_cndmask_b32 v172, 0, v6, vcc
v_cmp_eq_i32 vcc, 1, v5
s_nop 1
v_cndmask_b32 v173, 0, v6, vcc
v_cmp_eq_i32 vcc, 2, v5
s_nop 1
v_cndmask_b32 v174, 0, v6, vcc
v_cmp_eq_i32 vcc, 3, v5
s_nop 1
v_cndmask_b32 v175, 0, v6, vcc
v_cmp_eq_i32 vcc, -8, v5
s_nop 1
v_cndmask_b32 v176, 0, v6, vcc
v_cmp_eq_i32 vcc, -7, v5
s_nop 1
v_cndmask_b32 v177, 0, v6, vcc
v_cmp_eq_i32 vcc, -6, v5
s_nop 1
v_cndmask_b32 v178, 0, v6, vcc
v_cmp_eq_i32 vcc, -5, v5
s_nop 1
v_cndmask_b32 v179, 0, v6, vcc
s_lshl_b32 s25, s46, 6
v_and_b32 v5, 15, v0
v_lshlrev_b32 v5, 4, v5
v_bfe_u32 v6, v0, 5, 1
v_lshl_add_u32 v5, v6, 9, v5
v_bfe_u32 v6, v0, 4, 1
v_lshl_add_u32 v5, v6, 3, v5
v_add_u32 v86, s25, v5
v_and_b32 v1, 31, v0
v_bfe_u32 v2, v0, 5, 1
v_add_u32 v3, 0, v2
v_xor_b32 v4, v3, v1
v_lshlrev_b32 v4, 4, v4
v_add_u32 v3, s46, v3
v_lshl_add_u32 v20, v3, 11, v4
v_add_u32 v3, 2, v2
v_xor_b32 v4, v3, v1
v_lshlrev_b32 v4, 4, v4
v_add_u32 v3, s46, v3
v_lshl_add_u32 v21, v3, 11, v4
v_add_u32 v3, 4, v2
v_xor_b32 v4, v3, v1
v_lshlrev_b32 v4, 4, v4
v_add_u32 v3, s46, v3
v_lshl_add_u32 v22, v3, 11, v4
v_add_u32 v3, 6, v2
v_xor_b32 v4, v3, v1
v_lshlrev_b32 v4, 4, v4
v_add_u32 v3, s46, v3
v_lshl_add_u32 v23, v3, 11, v4
v_add_u32 v3, 8, v2
v_xor_b32 v4, v3, v1
v_lshlrev_b32 v4, 4, v4
v_add_u32 v3, s46, v3
v_lshl_add_u32 v24, v3, 11, v4
v_add_u32 v3, 10, v2
v_xor_b32 v4, v3, v1
v_lshlrev_b32 v4, 4, v4
v_add_u32 v3, s46, v3
v_lshl_add_u32 v25, v3, 11, v4
v_add_u32 v3, 12, v2
v_xor_b32 v4, v3, v1
v_lshlrev_b32 v4, 4, v4
v_add_u32 v3, s46, v3
v_lshl_add_u32 v26, v3, 11, v4
v_add_u32 v3, 14, v2
v_xor_b32 v4, v3, v1
v_lshlrev_b32 v4, 4, v4
v_add_u32 v3, s46, v3
v_lshl_add_u32 v27, v3, 11, v4
v_and_b32 v1, 15, v0
v_bfe_u32 v2, v0, 4, 2
v_lshrrev_b32 v3, 6, v0
v_lshlrev_b32 v3, 15, v3
v_lshl_add_u32 v3, v1, 9, v3
v_add_u32 v4, 0, v2
v_xor_b32 v4, v4, v1
v_lshl_add_u32 v28, v4, 4, v3
v_add_u32 v4, 4, v2
v_xor_b32 v4, v4, v1
v_lshl_add_u32 v29, v4, 4, v3
v_add_u32 v4, 8, v2
v_xor_b32 v4, v4, v1
v_lshl_add_u32 v30, v4, 4, v3
v_add_u32 v4, 12, v2
v_xor_b32 v4, v4, v1
v_lshl_add_u32 v31, v4, 4, v3
s_lshl_b32 s26, s49, 15
s_barrier
s_mov_b32 s27, 0
s_add_u32 m0, s26, 0
s_nop 0
buffer_load_dwordx4 v20, s[16:19], s27 offen nt lds
s_add_u32 m0, s26, 1024
s_nop 0
buffer_load_dwordx4 v21, s[16:19], s27 offen nt lds
s_add_u32 m0, s26, 2048
s_nop 0
buffer_load_dwordx4 v22, s[16:19], s27 offen nt lds
s_add_u32 m0, s26, 3072
s_nop 0
buffer_load_dwordx4 v23, s[16:19], s27 offen nt lds
s_add_u32 m0, s26, 4096
s_nop 0
buffer_load_dwordx4 v24, s[16:19], s27 offen nt lds
s_add_u32 m0, s26, 5120
s_nop 0
buffer_load_dwordx4 v25, s[16:19], s27 offen nt lds
s_add_u32 m0, s26, 6144
s_nop 0
buffer_load_dwordx4 v26, s[16:19], s27 offen nt lds
s_add_u32 m0, s26, 7168
s_nop 0
buffer_load_dwordx4 v27, s[16:19], s27 offen nt lds
s_mov_b32 s27, 0
s_add_u32 m0, s26, 8192
s_nop 0
buffer_load_dwordx4 v20, s[32:35], s27 offen nt lds
s_add_u32 m0, s26, 9216
s_nop 0
buffer_load_dwordx4 v21, s[32:35], s27 offen nt lds
s_add_u32 m0, s26, 10240
s_nop 0
buffer_load_dwordx4 v22, s[32:35], s27 offen nt lds
s_add_u32 m0, s26, 11264
s_nop 0
buffer_load_dwordx4 v23, s[32:35], s27 offen nt lds
s_add_u32 m0, s26, 12288
s_nop 0
buffer_load_dwordx4 v24, s[32:35], s27 offen nt lds
s_add_u32 m0, s26, 13312
s_nop 0
buffer_load_dwordx4 v25, s[32:35], s27 offen nt lds
s_add_u32 m0, s26, 14336
s_nop 0
buffer_load_dwordx4 v26, s[32:35], s27 offen nt lds
s_add_u32 m0, s26, 15360
s_nop 0
buffer_load_dwordx4 v27, s[32:35], s27 offen nt lds
s_mov_b32 s27, 512
s_add_u32 m0, s26, 16384
s_nop 0
buffer_load_dwordx4 v20, s[16:19], s27 offen nt lds
s_add_u32 m0, s26, 17408
s_nop 0
buffer_load_dwordx4 v21, s[16:19], s27 offen nt lds
s_add_u32 m0, s26, 18432
s_nop 0
buffer_load_dwordx4 v22, s[16:19], s27 offen nt lds
s_add_u32 m0, s26, 19456
s_nop 0
buffer_load_dwordx4 v23, s[16:19], s27 offen nt lds
s_add_u32 m0, s26, 20480
s_nop 0
buffer_load_dwordx4 v24, s[16:19], s27 offen nt lds
s_add_u32 m0, s26, 21504
s_nop 0
buffer_load_dwordx4 v25, s[16:19], s27 offen nt lds
s_add_u32 m0, s26, 22528
s_nop 0
buffer_load_dwordx4 v26, s[16:19], s27 offen nt lds
s_add_u32 m0, s26, 23552
s_nop 0
buffer_load_dwordx4 v27, s[16:19], s27 offen nt lds
s_mov_b32 s27, 512
s_add_u32 m0, s26, 24576
s_nop 0
buffer_load_dwordx4 v20, s[32:35], s27 offen nt lds
s_add_u32 m0, s26, 25600
s_nop 0
buffer_load_dwordx4 v21, s[32:35], s27 offen nt lds
s_add_u32 m0, s26, 26624
s_nop 0
buffer_load_dwordx4 v22, s[32:35], s27 offen nt lds
s_add_u32 m0, s26, 27648
s_nop 0
buffer_load_dwordx4 v23, s[32:35], s27 offen nt lds
s_add_u32 m0, s26, 28672
s_nop 0
buffer_load_dwordx4 v24, s[32:35], s27 offen nt lds
s_add_u32 m0, s26, 29696
s_nop 0
buffer_load_dwordx4 v25, s[32:35], s27 offen nt lds
s_add_u32 m0, s26, 30720
s_nop 0
buffer_load_dwordx4 v26, s[32:35], s27 offen nt lds
s_add_u32 m0, s26, 31744
s_nop 0
buffer_load_dwordx4 v27, s[32:35], s27 offen nt lds
s_waitcnt vmcnt(16)
ds_read_b128 a[0:3], v28 offset:0
ds_read_b128 a[4:7], v28 offset:8192
ds_read_b128 a[8:11], v29 offset:0
ds_read_b128 a[12:15], v29 offset:8192
ds_read_b128 a[16:19], v30 offset:0
ds_read_b128 a[20:23], v30 offset:8192
ds_read_b128 a[24:27], v31 offset:0
ds_read_b128 a[28:31], v31 offset:8192
s_waitcnt lgkmcnt(0)
ds_read_b128 a[32:35], v28 offset:256
ds_read_b128 a[36:39], v28 offset:8448
ds_read_b128 a[40:43], v29 offset:256
ds_read_b128 a[44:47], v29 offset:8448
ds_read_b128 a[48:51], v30 offset:256
ds_read_b128 a[52:55], v30 offset:8448
ds_read_b128 a[56:59], v31 offset:256
ds_read_b128 a[60:63], v31 offset:8448
s_waitcnt lgkmcnt(0)
s_mov_b32 s27, 1024
s_add_u32 m0, s26, 0
s_nop 0
buffer_load_dwordx4 v20, s[16:19], s27 offen nt lds
s_add_u32 m0, s26, 1024
s_nop 0
buffer_load_dwordx4 v21, s[16:19], s27 offen nt lds
s_add_u32 m0, s26, 2048
s_nop 0
buffer_load_dwordx4 v22, s[16:19], s27 offen nt lds
s_add_u32 m0, s26, 3072
s_nop 0
buffer_load_dwordx4 v23, s[16:19], s27 offen nt lds
s_add_u32 m0, s26, 4096
s_nop 0
buffer_load_dwordx4 v24, s[16:19], s27 offen nt lds
s_add_u32 m0, s26, 5120
s_nop 0
buffer_load_dwordx4 v25, s[16:19], s27 offen nt lds
s_add_u32 m0, s26, 6144
s_nop 0
buffer_load_dwordx4 v26, s[16:19], s27 offen nt lds
s_add_u32 m0, s26, 7168
s_nop 0
buffer_load_dwordx4 v27, s[16:19], s27 offen nt lds
s_mov_b32 s27, 1024
s_add_u32 m0, s26, 8192
s_nop 0
buffer_load_dwordx4 v20, s[32:35], s27 offen nt lds
s_add_u32 m0, s26, 9216
s_nop 0
buffer_load_dwordx4 v21, s[32:35], s27 offen nt lds
s_add_u32 m0, s26, 10240
s_nop 0
buffer_load_dwordx4 v22, s[32:35], s27 offen nt lds
s_add_u32 m0, s26, 11264
s_nop 0
buffer_load_dwordx4 v23, s[32:35], s27 offen nt lds
s_add_u32 m0, s26, 12288
s_nop 0
buffer_load_dwordx4 v24, s[32:35], s27 offen nt lds
s_add_u32 m0, s26, 13312
s_nop 0
buffer_load_dwordx4 v25, s[32:35], s27 offen nt lds
s_add_u32 m0, s26, 14336
s_nop 0
buffer_load_dwordx4 v26, s[32:35], s27 offen nt lds
s_add_u32 m0, s26, 15360
s_nop 0
buffer_load_dwordx4 v27, s[32:35], s27 offen nt lds
s_waitcnt vmcnt(16)
ds_read_b128 a[64:67], v28 offset:16384
ds_read_b128 a[68:71], v28 offset:24576
ds_read_b128 a[72:75], v29 offset:16384
ds_read_b128 a[76:79], v29 offset:24576
ds_read_b128 a[80:83], v30 offset:16384
ds_read_b128 a[84:87], v30 offset:24576
ds_read_b128 a[88:91], v31 offset:16384
ds_read_b128 a[92:95], v31 offset:24576
s_waitcnt lgkmcnt(0)
ds_read_b128 a[96:99], v28 offset:16640
ds_read_b128 a[100:103], v28 offset:24832
ds_read_b128 a[104:107], v29 offset:16640
ds_read_b128 a[108:111], v29 offset:24832
ds_read_b128 a[112:115], v30 offset:16640
ds_read_b128 a[116:119], v30 offset:24832
ds_read_b128 a[120:123], v31 offset:16640
ds_read_b128 a[124:127], v31 offset:24832
s_waitcnt lgkmcnt(0)
s_mov_b32 s27, 1536
s_add_u32 m0, s26, 16384
s_nop 0
buffer_load_dwordx4 v20, s[16:19], s27 offen nt lds
s_add_u32 m0, s26, 17408
s_nop 0
buffer_load_dwordx4 v21, s[16:19], s27 offen nt lds
s_add_u32 m0, s26, 18432
s_nop 0
buffer_load_dwordx4 v22, s[16:19], s27 offen nt lds
s_add_u32 m0, s26, 19456
s_nop 0
buffer_load_dwordx4 v23, s[16:19], s27 offen nt lds
s_add_u32 m0, s26, 20480
s_nop 0
buffer_load_dwordx4 v24, s[16:19], s27 offen nt lds
s_add_u32 m0, s26, 21504
s_nop 0
buffer_load_dwordx4 v25, s[16:19], s27 offen nt lds
s_add_u32 m0, s26, 22528
s_nop 0
buffer_load_dwordx4 v26, s[16:19], s27 offen nt lds
s_add_u32 m0, s26, 23552
s_nop 0
buffer_load_dwordx4 v27, s[16:19], s27 offen nt lds
s_mov_b32 s27, 1536
s_add_u32 m0, s26, 24576
s_nop 0
buffer_load_dwordx4 v20, s[32:35], s27 offen nt lds
s_add_u32 m0, s26, 25600
s_nop 0
buffer_load_dwordx4 v21, s[32:35], s27 offen nt lds
s_add_u32 m0, s26, 26624
s_nop 0
buffer_load_dwordx4 v22, s[32:35], s27 offen nt lds
s_add_u32 m0, s26, 27648
s_nop 0
buffer_load_dwordx4 v23, s[32:35], s27 offen nt lds
s_add_u32 m0, s26, 28672
s_nop 0
buffer_load_dwordx4 v24, s[32:35], s27 offen nt lds
s_add_u32 m0, s26, 29696
s_nop 0
buffer_load_dwordx4 v25, s[32:35], s27 offen nt lds
s_add_u32 m0, s26, 30720
s_nop 0
buffer_load_dwordx4 v26, s[32:35], s27 offen nt lds
s_add_u32 m0, s26, 31744
s_nop 0
buffer_load_dwordx4 v27, s[32:35], s27 offen nt lds
s_waitcnt vmcnt(16)
ds_read_b128 a[128:131], v28 offset:0
ds_read_b128 a[132:135], v28 offset:8192
ds_read_b128 a[136:139], v29 offset:0
ds_read_b128 a[140:143], v29 offset:8192
ds_read_b128 a[144:147], v30 offset:0
ds_read_b128 a[148:151], v30 offset:8192
ds_read_b128 a[152:155], v31 offset:0
ds_read_b128 a[156:159], v31 offset:8192
s_waitcnt lgkmcnt(0)
ds_read_b128 a[160:163], v28 offset:256
ds_read_b128 a[164:167], v28 offset:8448
ds_read_b128 a[168:171], v29 offset:256
ds_read_b128 a[172:175], v29 offset:8448
ds_read_b128 a[176:179], v30 offset:256
ds_read_b128 a[180:183], v30 offset:8448
ds_read_b128 a[184:187], v31 offset:256
ds_read_b128 a[188:191], v31 offset:8448
s_waitcnt lgkmcnt(0)
s_waitcnt vmcnt(0)
ds_read_b128 a[192:195], v28 offset:16384
ds_read_b128 a[196:199], v28 offset:24576
ds_read_b128 a[200:203], v29 offset:16384
ds_read_b128 a[204:207], v29 offset:24576
ds_read_b128 a[208:211], v30 offset:16384
ds_read_b128 a[212:215], v30 offset:24576
ds_read_b128 a[216:219], v31 offset:16384
ds_read_b128 a[220:223], v31 offset:24576
s_waitcnt lgkmcnt(0)
ds_read_b128 a[224:227], v28 offset:16640
ds_read_b128 a[228:231], v28 offset:24832
ds_read_b128 a[232:235], v29 offset:16640
ds_read_b128 a[236:239], v29 offset:24832
ds_read_b128 a[240:243], v30 offset:16640
ds_read_b128 a[244:247], v30 offset:24832
ds_read_b128 a[248:251], v31 offset:16640
ds_read_b128 a[252:255], v31 offset:24832
s_waitcnt lgkmcnt(0)
v_lshlrev_b32 v128, 16, v128
v_lshlrev_b32 v129, 16, v129
v_lshlrev_b32 v130, 16, v130
v_mul_f32 v131, 0x3fb8aa3b, v130
v_exp_f32 v131, v131
s_nop 0
v_cvt_pk_bf16_f32 v131, 0, v131
v_mul_f32 v132, v131, v128
v_mul_f32 v133, v131, v129
v_mul_f32 v132, 0x3fb8aa3b, v132
v_exp_f32 v132, v132
v_mul_f32 v133, 0x3e22f983, v133
v_fract_f32 v133, v133
v_cos_f32 v134, v133
v_sin_f32 v133, v133
s_nop 0
v_mul_f32 v88, v132, v134
v_mul_f32 v89, v132, v133
v_add_f32 v131, -1.0, v88
v_mul_f32 v132, v131, v128
v_fma_f32 v132, v89, v129, v132
v_mul_f32 v133, v89, v128
v_fma_f32 v133, -v131, v129, v133
v_mul_f32 v134, v128, v128
v_fma_f32 v134, v129, v129, v134
v_rcp_f32 v134, v134
s_nop 0
v_add_f32 v134, v134, v134
v_mul_f32 v90, v132, v134
v_mul_f32 v91, v133, v134
v_mov_b32 v92, v88
v_mov_b32 v93, v89
v_mul_f32 v131, v93, v93
v_mul_f32 v93, v92, v93
v_fma_f32 v92, v92, v92, -v131
v_add_f32 v93, v93, v93
v_mul_f32 v131, v93, v93
v_mul_f32 v93, v92, v93
v_fma_f32 v92, v92, v92, -v131
v_add_f32 v93, v93, v93
v_mul_f32 v131, v93, v93
v_mul_f32 v93, v92, v93
v_fma_f32 v92, v92, v92, -v131
v_add_f32 v93, v93, v93
v_xor_b32 v152, 0x80000000, v89
v_xor_b32 v153, 0x80000000, v93
v_xor_b32 v154, 0x80000000, v90
v_xor_b32 v155, 0x80000000, v91
v_mul_f32 v156, v88, v90
v_mul_f32 v157, v88, v91
v_fmac_f32 v156, v152, v91
v_fmac_f32 v157, v89, v90
v_mul_f32 v158, v88, v156
v_mul_f32 v159, v88, v157
v_fmac_f32 v158, v152, v157
v_fmac_f32 v159, v89, v156
v_mul_f32 v160, v88, v158
v_mul_f32 v161, v88, v159
v_fmac_f32 v160, v152, v159
v_fmac_f32 v161, v89, v158
v_mul_f32 v162, v88, v160
v_mul_f32 v163, v88, v161
v_fmac_f32 v162, v152, v161
v_fmac_f32 v163, v89, v160
v_mul_f32 v164, v88, v162
v_mul_f32 v165, v88, v163
v_fmac_f32 v164, v152, v163
v_fmac_f32 v165, v89, v162
v_mul_f32 v166, v88, v164
v_mul_f32 v167, v88, v165
v_fmac_f32 v166, v152, v165
v_fmac_f32 v167, v89, v164
v_mul_f32 v168, v88, v166
v_mul_f32 v169, v88, v167
v_fmac_f32 v168, v152, v167
v_fmac_f32 v169, v89, v166
v_mul_f32 v170, v88, v168
v_mul_f32 v171, v88, v169
v_fmac_f32 v170, v152, v169
v_fmac_f32 v171, v89, v168
v_mov_b32 v94, 0
v_mov_b32 v95, 0
v_mov_b32 v68, 0
v_mov_b32 v69, 0
v_mov_b32 v70, 0
v_mov_b32 v71, 0
v_mov_b32 v72, 0
v_mov_b32 v73, 0
v_mov_b32 v74, 0
v_mov_b32 v75, 0
v_mov_b32 v76, 0
v_mov_b32 v77, 0
v_mov_b32 v78, 0
v_mov_b32 v79, 0
v_mov_b32 v80, 0
v_mov_b32 v81, 0
v_mov_b32 v82, 0
v_mov_b32 v83, 0
s_lshl_b32 s21, s49, 12
v_and_b32 v1, 63, v0
v_and_b32 v2, 15, v0
v_bfe_u32 v3, v0, 4, 2
v_lshrrev_b32 v4, 6, v0
v_lshrrev_b32 v5, 5, v1
v_lshl_add_u32 v5, v4, 3, v5
v_add_u32 v5, 0, v5
v_and_b32 v6, 3, v5
v_lshrrev_b32 v7, 3, v5
v_lshl_add_u32 v6, v7, 2, v6
v_and_b32 v7, 31, v1
v_xor_b32 v6, v6, v7
v_lshlrev_b32 v6, 4, v6
v_lshl_add_u32 v8, v5, 11, v6
v_lshrrev_b32 v5, 5, v1
v_lshl_add_u32 v5, v4, 3, v5
v_add_u32 v5, 2, v5
v_and_b32 v6, 3, v5
v_lshrrev_b32 v7, 3, v5
v_lshl_add_u32 v6, v7, 2, v6
v_and_b32 v7, 31, v1
v_xor_b32 v6, v6, v7
v_lshlrev_b32 v6, 4, v6
v_lshl_add_u32 v9, v5, 11, v6
v_lshrrev_b32 v5, 5, v1
v_lshl_add_u32 v5, v4, 3, v5
v_add_u32 v5, 4, v5
v_and_b32 v6, 3, v5
v_lshrrev_b32 v7, 3, v5
v_lshl_add_u32 v6, v7, 2, v6
v_and_b32 v7, 31, v1
v_xor_b32 v6, v6, v7
v_lshlrev_b32 v6, 4, v6
v_lshl_add_u32 v10, v5, 11, v6
v_lshrrev_b32 v5, 5, v1
v_lshl_add_u32 v5, v4, 3, v5
v_add_u32 v5, 6, v5
v_and_b32 v6, 3, v5
v_lshrrev_b32 v7, 3, v5
v_lshl_add_u32 v6, v7, 2, v6
v_and_b32 v7, 31, v1
v_xor_b32 v6, v6, v7
v_lshlrev_b32 v6, 4, v6
v_lshl_add_u32 v11, v5, 11, v6
v_and_b32 v5, 12, v2
v_add_u32 v5, v5, v2
v_add_u32 v6, 0, v3
v_xor_b32 v6, v6, v2
v_lshlrev_b32 v6, 4, v6
v_lshl_add_u32 v12, v5, 9, v6
v_add_u32 v6, 4, v3
v_xor_b32 v6, v6, v2
v_lshlrev_b32 v6, 4, v6
v_lshl_add_u32 v13, v5, 9, v6
v_add_u32 v6, 8, v3
v_xor_b32 v6, v6, v2
v_lshlrev_b32 v6, 4, v6
v_lshl_add_u32 v14, v5, 9, v6
v_add_u32 v6, 12, v3
v_xor_b32 v6, v6, v2
v_lshlrev_b32 v6, 4, v6
v_lshl_add_u32 v15, v5, 9, v6
v_add_u32 v16, 0x10000, v12
v_add_u32 v17, 0x10000, v13
v_add_u32 v18, 0x10000, v14
v_add_u32 v19, 0x10000, v15
s_mov_b32 s32, s98
s_and_b32 s33, s99, 0xffff
s_mov_b32 s34, 0x100
s_mov_b32 s35, 0x00020000
s_mov_b32 s25, 0
v_mov_b32 v2, 0
L_pl_473:
buffer_load_dword v1, v2, s[32:35], s25 offen sc1
s_add_u32 s36, s36, 1
s_cmp_gt_u32 s36, 0x100000
s_cbranch_scc1 chain_kernel_wend
s_waitcnt vmcnt(0)
v_readfirstlane_b32 s26, v1
s_and_b32 s27, s26, 0xffff
s_cmp_ge_u32 s27, 256
s_cbranch_scc1 L_plok_474
s_sleep 4
s_branch L_pl_473
L_plok_474:
s_lshr_b32 s25, s26, 16
s_cmp_gt_u32 s25, 16
s_cselect_b32 s25, 0x2000, 0x0
s_add_u32 s54, s100, 0x1fffff
s_and_b32 s54, s54, 0xffe00000
s_sub_u32 s55, s54, s100
s_add_u32 s54, s55, s25
s_xor_b32 s25, s25, 0x2000
s_add_u32 s55, s55, s25
s_mov_b32 s56, 0xffff0000
s_mov_b32 s57, 0xffffffff
s_mov_b32 s58, 0x0
s_mov_b32 s59, 0xffffffff
s_mov_b32 s60, 0x0
s_mov_b32 s61, 0xffff0000
s_mov_b32 s22, 0
s_mov_b32 s24, 0
s_mov_b32 s20, 0
s_mov_b32 s37, 0
s_mov_b32 s23, 64
s_mov_b32 s38, 0x7ff00000
s_mov_b32 s39, 0x7ff00000
s_mov_b32 s43, 0x7ff00000
s_barrier
s_add_u32 m0, s21, 0
s_nop 0
buffer_load_dwordx4 v8, s[8:11], s20 offen lds
s_add_u32 m0, s21, 1024
s_nop 0
buffer_load_dwordx4 v9, s[8:11], s20 offen lds
s_add_u32 m0, s21, 2048
s_nop 0
buffer_load_dwordx4 v10, s[8:11], s20 offen lds
s_add_u32 m0, s21, 3072
s_nop 0
buffer_load_dwordx4 v11, s[8:11], s20 offen lds
s_add_u32 s20, s20, 512
s_add_u32 m0, s21, 16384
s_nop 0
buffer_load_dwordx4 v8, s[8:11], s20 offen lds
s_add_u32 m0, s21, 17408
s_nop 0
buffer_load_dwordx4 v9, s[8:11], s20 offen lds
s_add_u32 m0, s21, 18432
s_nop 0
buffer_load_dwordx4 v10, s[8:11], s20 offen lds
s_add_u32 m0, s21, 19456
s_nop 0
buffer_load_dwordx4 v11, s[8:11], s20 offen lds
s_add_u32 s20, s20, 512
s_add_u32 m0, s21, 32768
s_nop 0
buffer_load_dwordx4 v8, s[8:11], s20 offen lds
s_add_u32 m0, s21, 33792
s_nop 0
buffer_load_dwordx4 v9, s[8:11], s20 offen lds
s_add_u32 m0, s21, 34816
s_nop 0
buffer_load_dwordx4 v10, s[8:11], s20 offen lds
s_add_u32 m0, s21, 35840
s_nop 0
buffer_load_dwordx4 v11, s[8:11], s20 offen lds
s_add_u32 s20, s20, 512
s_add_u32 m0, s21, 49152
s_nop 0
buffer_load_dwordx4 v8, s[8:11], s20 offen lds
s_add_u32 m0, s21, 50176
s_nop 0
buffer_load_dwordx4 v9, s[8:11], s20 offen lds
s_add_u32 m0, s21, 51200
s_nop 0
buffer_load_dwordx4 v10, s[8:11], s20 offen lds
s_add_u32 m0, s21, 52224
s_nop 0
buffer_load_dwordx4 v11, s[8:11], s20 offen lds
s_add_u32 s24, s24, 1
s_min_u32 s24, s24, 63
s_lshl_b32 s53, s24, 16
s_mov_b32 s20, s53
s_add_u32 m0, s21, 65536
s_nop 0
buffer_load_dwordx4 v8, s[8:11], s20 offen lds
s_add_u32 m0, s21, 66560
s_nop 0
buffer_load_dwordx4 v9, s[8:11], s20 offen lds
s_add_u32 m0, s21, 67584
s_nop 0
buffer_load_dwordx4 v10, s[8:11], s20 offen lds
s_add_u32 m0, s21, 68608
s_nop 0
buffer_load_dwordx4 v11, s[8:11], s20 offen lds
s_add_u32 s20, s20, 512
s_add_u32 m0, s21, 81920
s_nop 0
buffer_load_dwordx4 v8, s[8:11], s20 offen lds
s_add_u32 m0, s21, 82944
s_nop 0
buffer_load_dwordx4 v9, s[8:11], s20 offen lds
s_add_u32 m0, s21, 83968
s_nop 0
buffer_load_dwordx4 v10, s[8:11], s20 offen lds
s_add_u32 m0, s21, 84992
s_nop 0
buffer_load_dwordx4 v11, s[8:11], s20 offen lds
s_add_u32 s20, s20, 512
s_add_u32 m0, s21, 98304
s_nop 0
buffer_load_dwordx4 v8, s[8:11], s20 offen lds
s_waitcnt vmcnt(21)
s_barrier
ds_read_b128 v[20:23], v12 offset:0
ds_read_b128 v[24:27], v12 offset:2048
ds_read_b128 v[28:31], v13 offset:0
ds_read_b128 v[32:35], v13 offset:2048
ds_read_b128 v[36:39], v14 offset:0
ds_read_b128 v[40:43], v14 offset:2048
s_waitcnt lgkmcnt(4)
L_st_478:
v_mfma_f32_16x16x32_bf16 v[52:55], v[20:23], a[0:3], 0
ds_read_b128 v[44:47], v15 offset:0
s_add_u32 m0, s21, 99328
v_mfma_f32_16x16x32_bf16 v[56:59], v[20:23], a[4:7], 0
buffer_load_dwordx4 v9, s[8:11], s20 offen lds
v_mfma_f32_16x16x32_bf16 v[60:63], v[24:27], a[0:3], 0
ds_read_b128 v[48:51], v15 offset:2048
v_cvt_pk_bf16_f32 v144, v180, v181
v_mfma_f32_16x16x32_bf16 v[64:67], v[24:27], a[4:7], 0
s_waitcnt lgkmcnt(4)
v_cvt_pk_bf16_f32 v145, v182, v183
v_fmac_f32 v69, v88, v68
v_mfma_f32_16x16x32_bf16 v[52:55], v[28:31], a[8:11], v[52:55]
ds_read_b128 v[20:23], v12 offset:256
v_fmac_f32 v73, v88, v72
v_mul_f32 v128, v90, v68
v_mfma_f32_16x16x32_bf16 v[56:59], v[28:31], a[12:15], v[56:59]
buffer_store_dwordx2 v[144:145], v86, s[12:15], s38 offen offset:0 sc1
v_mfma_f32_16x16x32_bf16 v[60:63], v[32:35], a[8:11], v[60:63]
ds_read_b128 v[24:27], v12 offset:2304
v_cvt_pk_bf16_f32 v146, v184, v185
v_mul_f32 v136, v154, v72
v_mfma_f32_16x16x32_bf16 v[64:67], v[32:35], a[12:15], v[64:67]
s_waitcnt lgkmcnt(4)
v_fmac_f32 v69, v152, v72
v_fmac_f32 v73, v89, v68
v_mfma_f32_16x16x32_bf16 v[52:55], v[36:39], a[16:19], v[52:55]
ds_read_b128 v[28:31], v13 offset:256
s_add_u32 m0, s21, 100352
v_mfma_f32_16x16x32_bf16 v[56:59], v[36:39], a[20:23], v[56:59]
buffer_load_dwordx4 v10, s[8:11], s20 offen lds
v_fmac_f32 v128, v155, v72
v_mfma_f32_16x16x32_bf16 v[60:63], v[40:43], a[16:19], v[60:63]
ds_read_b128 v[32:35], v13 offset:2304
v_cvt_pk_bf16_f32 v147, v186, v187
v_fmac_f32 v136, v155, v68
v_mfma_f32_16x16x32_bf16 v[64:67], v[40:43], a[20:23], v[64:67]
s_waitcnt lgkmcnt(4)
v_fmac_f32 v70, v88, v69
v_mfma_f32_16x16x32_bf16 v[52:55], v[44:47], a[24:27], v[52:55]
ds_read_b128 v[36:39], v14 offset:256
v_fmac_f32 v74, v88, v73
v_mul_f32 v129, v90, v69
v_mfma_f32_16x16x32_bf16 v[56:59], v[44:47], a[28:31], v[56:59]
buffer_store_dwordx2 v[146:147], v86, s[12:15], s38 offen offset:256 sc1
v_mul_f32 v137, v154, v73
v_mfma_f32_16x16x32_bf16 v[60:63], v[48:51], a[24:27], v[60:63]
ds_read_b128 v[40:43], v14 offset:2304
v_cvt_pk_bf16_f32 v148, v188, v189
v_mfma_f32_16x16x32_bf16 v[64:67], v[48:51], a[28:31], v[64:67]
s_waitcnt lgkmcnt(4)
v_fmac_f32 v70, v152, v73
v_fmac_f32 v74, v89, v69
v_mfma_f32_16x16x32_bf16 v[52:55], v[20:23], a[32:35], v[52:55]
ds_read_b128 v[44:47], v15 offset:256
s_add_u32 m0, s21, 101376
v_fmac_f32 v129, v155, v73
v_mfma_f32_16x16x32_bf16 v[56:59], v[20:23], a[36:39], v[56:59]
buffer_load_dwordx4 v11, s[8:11], s20 offen lds
v_mfma_f32_16x16x32_bf16 v[60:63], v[24:27], a[32:35], v[60:63]
ds_read_b128 v[48:51], v15 offset:2304
v_cvt_pk_bf16_f32 v149, v190, v191
v_fmac_f32 v137, v155, v69
v_mfma_f32_16x16x32_bf16 v[64:67], v[24:27], a[36:39], v[64:67]
s_waitcnt lgkmcnt(4)
v_fmac_f32 v71, v88, v70
v_fmac_f32 v75, v88, v74
v_mfma_f32_16x16x32_bf16 v[52:55], v[28:31], a[40:43], v[52:55]
s_waitcnt vmcnt(20)
s_barrier
ds_read_b128 v[20:23], v12 offset:16384
v_mfma_f32_16x16x32_bf16 v[56:59], v[28:31], a[44:47], v[56:59]
s_add_u32 s20, s20, 512
buffer_store_dwordx2 v[148:149], v86, s[12:15], s43 offen offset:0 sc1
v_mfma_f32_16x16x32_bf16 v[60:63], v[32:35], a[40:43], v[60:63]
ds_read_b128 v[24:27], v12 offset:18432
v_cvt_pk_bf16_f32 v150, v192, v193
v_mfma_f32_16x16x32_bf16 v[64:67], v[32:35], a[44:47], v[64:67]
s_waitcnt lgkmcnt(4)
v_mul_f32 v130, v90, v70
v_mul_f32 v138, v154, v74
v_mfma_f32_16x16x32_bf16 v[52:55], v[36:39], a[48:51], v[52:55]
ds_read_b128 v[28:31], v13 offset:16384
s_add_u32 m0, s21, 114688
v_fmac_f32 v71, v152, v74
v_mfma_f32_16x16x32_bf16 v[56:59], v[36:39], a[52:55], v[56:59]
buffer_load_dwordx4 v8, s[8:11], s20 offen lds
v_mfma_f32_16x16x32_bf16 v[60:63], v[40:43], a[48:51], v[60:63]
ds_read_b128 v[32:35], v13 offset:18432
v_cvt_pk_bf16_f32 v151, v194, v195
v_fmac_f32 v75, v89, v70
v_mfma_f32_16x16x32_bf16 v[64:67], v[40:43], a[52:55], v[64:67]
s_waitcnt lgkmcnt(4)
v_fmac_f32 v130, v155, v74
v_fmac_f32 v138, v155, v70
v_mfma_f32_16x16x32_bf16 v[52:55], v[44:47], a[56:59], v[52:55]
ds_read_b128 v[36:39], v14 offset:16384
v_fmac_f32 v76, v88, v71
v_mfma_f32_16x16x32_bf16 v[56:59], v[44:47], a[60:63], v[56:59]
buffer_store_dwordx2 v[150:151], v86, s[12:15], s43 offen offset:256 sc1
v_fmac_f32 v80, v88, v75
v_mfma_f32_16x16x32_bf16 v[60:63], v[48:51], a[56:59], v[60:63]
ds_read_b128 v[40:43], v14 offset:18432
v_mul_f32 v131, v90, v71
v_mfma_f32_16x16x32_bf16 v[64:67], v[48:51], a[60:63], v[64:67]
s_waitcnt lgkmcnt(4)
v_mul_f32 v139, v154, v75
v_fmac_f32 v76, v152, v75
v_mfma_f32_16x16x32_bf16 v[52:55], v[20:23], a[64:67], v[52:55]
ds_read_b128 v[44:47], v15 offset:16384
s_add_u32 m0, s21, 115712
v_fmac_f32 v80, v89, v71
v_mfma_f32_16x16x32_bf16 v[56:59], v[20:23], a[68:71], v[56:59]
buffer_load_dwordx4 v9, s[8:11], s20 offen lds
v_mfma_f32_16x16x32_bf16 v[60:63], v[24:27], a[64:67], v[60:63]
ds_read_b128 v[48:51], v15 offset:18432
v_fmac_f32 v131, v155, v75
v_fmac_f32 v139, v155, v71
v_mfma_f32_16x16x32_bf16 v[64:67], v[24:27], a[68:71], v[64:67]
s_waitcnt lgkmcnt(4)
v_fmac_f32 v77, v88, v76
v_mfma_f32_16x16x32_bf16 v[52:55], v[28:31], a[72:75], v[52:55]
ds_read_b128 v[20:23], v12 offset:16640
v_fmac_f32 v81, v88, v80
v_mul_f32 v132, v90, v76
v_mfma_f32_16x16x32_bf16 v[56:59], v[28:31], a[76:79], v[56:59]
v_mul_f32 v140, v154, v80
v_fmac_f32 v77, v152, v80
v_mfma_f32_16x16x32_bf16 v[60:63], v[32:35], a[72:75], v[60:63]
ds_read_b128 v[24:27], v12 offset:18688
s_add_u32 s24, s24, 1
v_fmac_f32 v81, v89, v76
v_mfma_f32_16x16x32_bf16 v[64:67], v[32:35], a[76:79], v[64:67]
s_waitcnt lgkmcnt(4)
v_fmac_f32 v132, v155, v80
v_mfma_f32_16x16x32_bf16 v[52:55], v[36:39], a[80:83], v[52:55]
ds_read_b128 v[28:31], v13 offset:16640
s_add_u32 m0, s21, 116736
v_fmac_f32 v140, v155, v76
v_mfma_f32_16x16x32_bf16 v[56:59], v[36:39], a[84:87], v[56:59]
buffer_load_dwordx4 v10, s[8:11], s20 offen lds
v_fmac_f32 v78, v88, v77
v_mfma_f32_16x16x32_bf16 v[60:63], v[40:43], a[80:83], v[60:63]
ds_read_b128 v[32:35], v13 offset:18688
v_fmac_f32 v82, v88, v81
v_mfma_f32_16x16x32_bf16 v[64:67], v[40:43], a[84:87], v[64:67]
s_waitcnt lgkmcnt(4)
s_min_u32 s24, s24, 63
v_mul_f32 v133, v90, v77
v_mfma_f32_16x16x32_bf16 v[52:55], v[44:47], a[88:91], v[52:55]
ds_read_b128 v[36:39], v14 offset:16640
v_mul_f32 v141, v154, v81
v_mfma_f32_16x16x32_bf16 v[56:59], v[44:47], a[92:95], v[56:59]
v_fmac_f32 v78, v152, v81
v_fmac_f32 v82, v89, v77
v_fmac_f32 v133, v155, v81
v_mfma_f32_16x16x32_bf16 v[60:63], v[48:51], a[88:91], v[60:63]
ds_read_b128 v[40:43], v14 offset:18688
s_lshl_b32 s53, s24, 16
v_mfma_f32_16x16x32_bf16 v[64:67], v[48:51], a[92:95], v[64:67]
s_waitcnt lgkmcnt(4)
v_fmac_f32 v141, v155, v77
v_fmac_f32 v79, v88, v78
v_mfma_f32_16x16x32_bf16 v[52:55], v[20:23], a[96:99], v[52:55]
ds_read_b128 v[44:47], v15 offset:16640
s_add_u32 m0, s21, 117760
v_fmac_f32 v83, v88, v82
v_mfma_f32_16x16x32_bf16 v[56:59], v[20:23], a[100:103], v[56:59]
buffer_load_dwordx4 v11, s[8:11], s20 offen lds
v_mfma_f32_16x16x32_bf16 v[60:63], v[24:27], a[96:99], v[60:63]
ds_read_b128 v[48:51], v15 offset:18688
v_mul_f32 v134, v90, v78
v_mul_f32 v142, v154, v82
v_mfma_f32_16x16x32_bf16 v[64:67], v[24:27], a[100:103], v[64:67]
s_waitcnt lgkmcnt(4)
v_fmac_f32 v79, v152, v82
v_mfma_f32_16x16x32_bf16 v[52:55], v[28:31], a[104:107], v[52:55]
s_waitcnt vmcnt(20)
s_barrier
ds_read_b128 v[20:23], v12 offset:32768
v_mfma_f32_16x16x32_bf16 v[56:59], v[28:31], a[108:111], v[56:59]
s_mov_b32 s20, s53
v_fmac_f32 v83, v89, v78
v_fmac_f32 v134, v155, v82
v_mfma_f32_16x16x32_bf16 v[60:63], v[32:35], a[104:107], v[60:63]
ds_read_b128 v[24:27], v12 offset:34816
v_fmac_f32 v142, v155, v78
v_mfma_f32_16x16x32_bf16 v[64:67], v[32:35], a[108:111], v[64:67]
s_waitcnt lgkmcnt(4)
v_mfma_f32_16x16x4_f32 v[104:107], v116, v79, 0
v_mfma_f32_16x16x4_f32 v[108:111], v116, v83, 0
v_mfma_f32_16x16x32_bf16 v[52:55], v[36:39], a[112:115], v[52:55]
ds_read_b128 v[28:31], v13 offset:32768
s_add_u32 m0, s21, 0
v_mul_f32 v135, v90, v79
v_mfma_f32_16x16x32_bf16 v[56:59], v[36:39], a[116:119], v[56:59]
buffer_load_dwordx4 v8, s[8:11], s20 offen lds
v_mfma_f32_16x16x32_bf16 v[60:63], v[40:43], a[112:115], v[60:63]
ds_read_b128 v[32:35], v13 offset:34816
v_mul_f32 v143, v154, v83
v_fmac_f32 v135, v155, v83
v_mfma_f32_16x16x32_bf16 v[64:67], v[40:43], a[116:119], v[64:67]
s_waitcnt lgkmcnt(4)
v_fmac_f32 v143, v155, v79
v_mfma_f32_16x16x32_bf16 v[52:55], v[44:47], a[120:123], v[52:55]
ds_read_b128 v[36:39], v14 offset:32768
s_nop 0
s_nop 0
v_mfma_f32_16x16x32_bf16 v[56:59], v[44:47], a[124:127], v[56:59]
s_nop 0
s_nop 0
v_mfma_f32_16x16x32_bf16 v[60:63], v[48:51], a[120:123], v[60:63]
ds_read_b128 v[40:43], v14 offset:34816
s_nop 0
s_nop 0
v_mfma_f32_16x16x32_bf16 v[64:67], v[48:51], a[124:127], v[64:67]
s_waitcnt lgkmcnt(4)
s_nop 0
v_mfma_f32_16x16x32_bf16 v[52:55], v[20:23], a[128:131], v[52:55]
ds_read_b128 v[44:47], v15 offset:32768
s_add_u32 m0, s21, 1024
v_fmac_f32 v104, v92, v94
v_mfma_f32_16x16x32_bf16 v[56:59], v[20:23], a[132:135], v[56:59]
buffer_load_dwordx4 v9, s[8:11], s20 offen lds
v_fmac_f32 v108, v92, v95
v_mfma_f32_16x16x32_bf16 v[60:63], v[24:27], a[128:131], v[60:63]
ds_read_b128 v[48:51], v15 offset:34816
v_fmac_f32 v104, v153, v95
v_mfma_f32_16x16x32_bf16 v[64:67], v[24:27], a[132:135], v[64:67]
s_waitcnt lgkmcnt(4)
v_fmac_f32 v108, v93, v94
v_cndmask_b32 v96, v94, v104, s[56:57]
v_mfma_f32_16x16x32_bf16 v[52:55], v[28:31], a[136:139], v[52:55]
ds_read_b128 v[20:23], v12 offset:33024
v_cndmask_b32 v97, v95, v108, s[56:57]
v_mfma_f32_16x16x32_bf16 v[56:59], v[28:31], a[140:143], v[56:59]
v_fmac_f32 v105, v92, v104
v_fmac_f32 v109, v92, v108
v_mfma_f32_16x16x32_bf16 v[60:63], v[32:35], a[136:139], v[60:63]
ds_read_b128 v[24:27], v12 offset:35072
v_fmac_f32 v105, v153, v108
v_fmac_f32 v109, v93, v104
v_mfma_f32_16x16x32_bf16 v[64:67], v[32:35], a[140:143], v[64:67]
s_waitcnt lgkmcnt(4)
v_cndmask_b32 v96, v96, v105, s[58:59]
v_mfma_f32_16x16x32_bf16 v[52:55], v[36:39], a[144:147], v[52:55]
ds_read_b128 v[28:31], v13 offset:33024
s_add_u32 m0, s21, 2048
v_cndmask_b32 v97, v97, v109, s[58:59]
v_mfma_f32_16x16x32_bf16 v[56:59], v[36:39], a[148:151], v[56:59]
buffer_load_dwordx4 v10, s[8:11], s20 offen lds
v_fmac_f32 v106, v92, v105
v_mfma_f32_16x16x32_bf16 v[60:63], v[40:43], a[144:147], v[60:63]
ds_read_b128 v[32:35], v13 offset:35072
v_fmac_f32 v110, v92, v109
v_mfma_f32_16x16x32_bf16 v[64:67], v[40:43], a[148:151], v[64:67]
s_waitcnt lgkmcnt(4)
v_fmac_f32 v106, v153, v109
v_fmac_f32 v110, v93, v105
v_mfma_f32_16x16x32_bf16 v[52:55], v[44:47], a[152:155], v[52:55]
ds_read_b128 v[36:39], v14 offset:33024
v_cndmask_b32 v96, v96, v106, s[60:61]
v_mfma_f32_16x16x32_bf16 v[56:59], v[44:47], a[156:159], v[56:59]
v_cndmask_b32 v97, v97, v110, s[60:61]
v_fmac_f32 v107, v92, v106
v_mfma_f32_16x16x32_bf16 v[60:63], v[48:51], a[152:155], v[60:63]
ds_read_b128 v[40:43], v14 offset:35072
v_fmac_f32 v111, v92, v110
v_fmac_f32 v107, v153, v110
v_mfma_f32_16x16x32_bf16 v[64:67], v[48:51], a[156:159], v[64:67]
s_waitcnt lgkmcnt(4)
v_fmac_f32 v111, v93, v106
v_mfma_f32_16x16x32_bf16 v[52:55], v[20:23], a[160:163], v[52:55]
ds_read_b128 v[44:47], v15 offset:33024
s_add_u32 m0, s21, 3072
v_xor_b32 v98, 0x80000000, v96
v_mfma_f32_16x16x32_bf16 v[56:59], v[20:23], a[164:167], v[56:59]
buffer_load_dwordx4 v11, s[8:11], s20 offen lds
v_xor_b32 v99, 0x80000000, v97
v_mfma_f32_16x16x32_bf16 v[60:63], v[24:27], a[160:163], v[60:63]
ds_read_b128 v[48:51], v15 offset:35072
v_mov_b32 v94, v107
v_mfma_f32_16x16x32_bf16 v[64:67], v[24:27], a[164:167], v[64:67]
s_waitcnt lgkmcnt(4)
v_mov_b32 v95, v111
v_fmac_f32 v128, v156, v96
v_mfma_f32_16x16x32_bf16 v[52:55], v[28:31], a[168:171], v[52:55]
s_waitcnt vmcnt(7)
s_barrier
ds_read_b128 v[20:23], v12 offset:49152
v_mfma_f32_16x16x32_bf16 v[56:59], v[28:31], a[172:175], v[56:59]
s_add_u32 s20, s20, 512
buffer_atomic_add v84, v85, s[12:15], s39 offen sc1
v_mfma_f32_16x16x32_bf16 v[60:63], v[32:35], a[168:171], v[60:63]
ds_read_b128 v[24:27], v12 offset:51200
v_fmac_f32 v136, v156, v99
v_mfma_f32_16x16x32_bf16 v[64:67], v[32:35], a[172:175], v[64:67]
s_waitcnt lgkmcnt(4)
v_fmac_f32 v128, v157, v99
v_fmac_f32 v136, v157, v98
v_mfma_f32_16x16x32_bf16 v[52:55], v[36:39], a[176:179], v[52:55]
ds_read_b128 v[28:31], v13 offset:49152
s_add_u32 m0, s21, 16384
v_fmac_f32 v129, v158, v96
v_mfma_f32_16x16x32_bf16 v[56:59], v[36:39], a[180:183], v[56:59]
buffer_load_dwordx4 v8, s[8:11], s20 offen lds
v_mfma_f32_16x16x32_bf16 v[60:63], v[40:43], a[176:179], v[60:63]
ds_read_b128 v[32:35], v13 offset:51200
v_fmac_f32 v137, v158, v99
v_fmac_f32 v129, v159, v99
v_mfma_f32_16x16x32_bf16 v[64:67], v[40:43], a[180:183], v[64:67]
s_waitcnt lgkmcnt(4)
v_fmac_f32 v137, v159, v98
v_mfma_f32_16x16x32_bf16 v[52:55], v[44:47], a[184:187], v[52:55]
ds_read_b128 v[36:39], v14 offset:49152
v_cvt_pk_bf16_f32 v120, v128, v129
v_cvt_pk_bf16_f32 v124, v136, v137
v_mfma_f32_16x16x32_bf16 v[56:59], v[44:47], a[188:191], v[56:59]
v_fmac_f32 v130, v160, v96
v_fmac_f32 v138, v160, v99
v_mfma_f32_16x16x32_bf16 v[60:63], v[48:51], a[184:187], v[60:63]
ds_read_b128 v[40:43], v14 offset:51200
v_fmac_f32 v130, v161, v99
v_fmac_f32 v138, v161, v98
v_mfma_f32_16x16x32_bf16 v[64:67], v[48:51], a[188:191], v[64:67]
s_waitcnt lgkmcnt(4)
v_fmac_f32 v131, v162, v96
v_mfma_f32_16x16x32_bf16 v[52:55], v[20:23], a[192:195], v[52:55]
ds_read_b128 v[44:47], v15 offset:49152
s_add_u32 m0, s21, 17408
v_fmac_f32 v139, v162, v99
v_mfma_f32_16x16x32_bf16 v[56:59], v[20:23], a[196:199], v[56:59]
buffer_load_dwordx4 v9, s[8:11], s20 offen lds
v_fmac_f32 v131, v163, v99
v_mfma_f32_16x16x32_bf16 v[60:63], v[24:27], a[192:195], v[60:63]
ds_read_b128 v[48:51], v15 offset:51200
v_fmac_f32 v139, v163, v98
v_mfma_f32_16x16x32_bf16 v[64:67], v[24:27], a[196:199], v[64:67]
s_waitcnt lgkmcnt(4)
v_cvt_pk_bf16_f32 v121, v130, v131
v_mfma_f32_16x16x32_bf16 v[52:55], v[28:31], a[200:203], v[52:55]
ds_read_b128 v[20:23], v12 offset:49408
v_cvt_pk_bf16_f32 v125, v138, v139
v_fmac_f32 v132, v164, v96
v_mfma_f32_16x16x32_bf16 v[56:59], v[28:31], a[204:207], v[56:59]
v_fmac_f32 v140, v164, v99
v_fmac_f32 v132, v165, v99
v_mfma_f32_16x16x32_bf16 v[60:63], v[32:35], a[200:203], v[60:63]
ds_read_b128 v[24:27], v12 offset:51456
v_fmac_f32 v140, v165, v98
v_fmac_f32 v133, v166, v96
v_mfma_f32_16x16x32_bf16 v[64:67], v[32:35], a[204:207], v[64:67]
s_waitcnt lgkmcnt(4)
v_fmac_f32 v141, v166, v99
v_mfma_f32_16x16x32_bf16 v[52:55], v[36:39], a[208:211], v[52:55]
ds_read_b128 v[28:31], v13 offset:49408
s_add_u32 m0, s21, 18432
v_fmac_f32 v133, v167, v99
v_mfma_f32_16x16x32_bf16 v[56:59], v[36:39], a[212:215], v[56:59]
buffer_load_dwordx4 v10, s[8:11], s20 offen lds
v_fmac_f32 v141, v167, v98
v_mfma_f32_16x16x32_bf16 v[60:63], v[40:43], a[208:211], v[60:63]
ds_read_b128 v[32:35], v13 offset:51456
v_cvt_pk_bf16_f32 v122, v132, v133
v_mfma_f32_16x16x32_bf16 v[64:67], v[40:43], a[212:215], v[64:67]
s_waitcnt lgkmcnt(4)
v_cvt_pk_bf16_f32 v126, v140, v141
v_fmac_f32 v134, v168, v96
v_mfma_f32_16x16x32_bf16 v[52:55], v[44:47], a[216:219], v[52:55]
ds_read_b128 v[36:39], v14 offset:49408
v_fmac_f32 v142, v168, v99
v_mfma_f32_16x16x32_bf16 v[56:59], v[44:47], a[220:223], v[56:59]
v_fmac_f32 v134, v169, v99
v_fmac_f32 v142, v169, v98
v_mfma_f32_16x16x32_bf16 v[60:63], v[48:51], a[216:219], v[60:63]
ds_read_b128 v[40:43], v14 offset:51456
v_fmac_f32 v135, v170, v96
v_fmac_f32 v143, v170, v99
v_mfma_f32_16x16x32_bf16 v[64:67], v[48:51], a[220:223], v[64:67]
s_waitcnt lgkmcnt(4)
v_fmac_f32 v135, v171, v99
v_mfma_f32_16x16x32_bf16 v[52:55], v[20:23], a[224:227], v[52:55]
ds_read_b128 v[44:47], v15 offset:49408
s_add_u32 m0, s21, 19456
v_fmac_f32 v143, v171, v98
v_mfma_f32_16x16x32_bf16 v[56:59], v[20:23], a[228:231], v[56:59]
buffer_load_dwordx4 v11, s[8:11], s20 offen lds
v_cvt_pk_bf16_f32 v123, v134, v135
v_mfma_f32_16x16x32_bf16 v[60:63], v[24:27], a[224:227], v[60:63]
ds_read_b128 v[48:51], v15 offset:51456
v_cvt_pk_bf16_f32 v127, v142, v143
v_mfma_f32_16x16x32_bf16 v[64:67], v[24:27], a[228:231], v[64:67]
s_waitcnt lgkmcnt(4)
s_nop 0
s_nop 0
v_mfma_f32_16x16x32_bf16 v[52:55], v[28:31], a[232:235], v[52:55]
s_waitcnt vmcnt(20)
s_barrier
ds_read_b128 v[20:23], v16 offset:0
v_mfma_f32_16x16x32_bf16 v[56:59], v[28:31], a[236:239], v[56:59]
s_add_u32 s20, s20, 512
v_mfma_f32_16x16x32_bf16 v[180:183], v[120:123], v[172:175], 0
v_mfma_f32_16x16x32_bf16 v[60:63], v[32:35], a[232:235], v[60:63]
ds_read_b128 v[24:27], v16 offset:2048
v_mfma_f32_16x16x32_bf16 v[184:187], v[120:123], v[176:179], 0
v_mfma_f32_16x16x32_bf16 v[188:191], v[124:127], v[172:175], 0
v_mfma_f32_16x16x32_bf16 v[64:67], v[32:35], a[236:239], v[64:67]
s_waitcnt lgkmcnt(4)
v_mfma_f32_16x16x32_bf16 v[192:195], v[124:127], v[176:179], 0
v_mfma_f32_16x16x32_bf16 v[52:55], v[36:39], a[240:243], v[52:55]
ds_read_b128 v[28:31], v17 offset:0
s_add_u32 m0, s21, 32768
s_sub_u32 s39, s22, 1
v_mfma_f32_16x16x32_bf16 v[56:59], v[36:39], a[244:247], v[56:59]
buffer_load_dwordx4 v8, s[8:11], s20 offen lds
s_lshl_b32 s38, s39, 17
v_mfma_f32_16x16x32_bf16 v[60:63], v[40:43], a[240:243], v[60:63]
ds_read_b128 v[32:35], v17 offset:2048
s_add_u32 s38, s38, 0x4400000
v_mfma_f32_16x16x32_bf16 v[64:67], v[40:43], a[244:247], v[64:67]
s_waitcnt lgkmcnt(4)
s_add_u32 s43, s38, 0x10000
s_lshl_b32 s39, s39, 7
v_mfma_f32_16x16x32_bf16 v[52:55], v[44:47], a[248:251], v[52:55]
ds_read_b128 v[36:39], v18 offset:0
s_add_u32 s39, s39, 0x5902000
v_mfma_f32_16x16x32_bf16 v[56:59], v[44:47], a[252:255], v[56:59]
s_cmp_eq_u32 s37, 0
s_cselect_b32 s38, 0x7ff00000, s38
s_cselect_b32 s39, 0x7ff00000, s39
s_cselect_b32 s43, 0x7ff00000, s43
v_mfma_f32_16x16x32_bf16 v[60:63], v[48:51], a[248:251], v[60:63]
ds_read_b128 v[40:43], v18 offset:2048
v_mfma_f32_16x16x32_bf16 v[64:67], v[48:51], a[252:255], v[64:67]
s_waitcnt lgkmcnt(4)
s_mov_b32 s37, 1
s_add_u32 s22, s22, 1
s_cmp_ge_u32 s22, s23
s_cbranch_scc1 L_fl0_475
v_mfma_f32_16x16x32_bf16 v[68:71], v[20:23], a[0:3], 0
ds_read_b128 v[44:47], v19 offset:0
s_add_u32 m0, s21, 33792
v_mfma_f32_16x16x32_bf16 v[72:75], v[20:23], a[4:7], 0
buffer_load_dwordx4 v9, s[8:11], s20 offen lds
v_mfma_f32_16x16x32_bf16 v[76:79], v[24:27], a[0:3], 0
ds_read_b128 v[48:51], v19 offset:2048
v_cvt_pk_bf16_f32 v144, v180, v181
v_mfma_f32_16x16x32_bf16 v[80:83], v[24:27], a[4:7], 0
s_waitcnt lgkmcnt(4)
v_cvt_pk_bf16_f32 v145, v182, v183
v_fmac_f32 v53, v88, v52
v_mfma_f32_16x16x32_bf16 v[68:71], v[28:31], a[8:11], v[68:71]
ds_read_b128 v[20:23], v16 offset:256
v_fmac_f32 v57, v88, v56
v_mul_f32 v128, v90, v52
v_mfma_f32_16x16x32_bf16 v[72:75], v[28:31], a[12:15], v[72:75]
buffer_store_dwordx2 v[144:145], v86, s[12:15], s38 offen offset:0 sc1
v_mfma_f32_16x16x32_bf16 v[76:79], v[32:35], a[8:11], v[76:79]
ds_read_b128 v[24:27], v16 offset:2304
v_cvt_pk_bf16_f32 v146, v184, v185
v_mul_f32 v136, v154, v56
v_mfma_f32_16x16x32_bf16 v[80:83], v[32:35], a[12:15], v[80:83]
s_waitcnt lgkmcnt(4)
v_fmac_f32 v53, v152, v56
v_fmac_f32 v57, v89, v52
v_mfma_f32_16x16x32_bf16 v[68:71], v[36:39], a[16:19], v[68:71]
ds_read_b128 v[28:31], v17 offset:256
s_add_u32 m0, s21, 34816
v_mfma_f32_16x16x32_bf16 v[72:75], v[36:39], a[20:23], v[72:75]
buffer_load_dwordx4 v10, s[8:11], s20 offen lds
v_fmac_f32 v128, v155, v56
v_mfma_f32_16x16x32_bf16 v[76:79], v[40:43], a[16:19], v[76:79]
ds_read_b128 v[32:35], v17 offset:2304
v_cvt_pk_bf16_f32 v147, v186, v187
v_fmac_f32 v136, v155, v52
v_mfma_f32_16x16x32_bf16 v[80:83], v[40:43], a[20:23], v[80:83]
s_waitcnt lgkmcnt(4)
v_fmac_f32 v54, v88, v53
v_mfma_f32_16x16x32_bf16 v[68:71], v[44:47], a[24:27], v[68:71]
ds_read_b128 v[36:39], v18 offset:256
v_fmac_f32 v58, v88, v57
v_mul_f32 v129, v90, v53
v_mfma_f32_16x16x32_bf16 v[72:75], v[44:47], a[28:31], v[72:75]
buffer_store_dwordx2 v[146:147], v86, s[12:15], s38 offen offset:256 sc1
v_mul_f32 v137, v154, v57
v_mfma_f32_16x16x32_bf16 v[76:79], v[48:51], a[24:27], v[76:79]
ds_read_b128 v[40:43], v18 offset:2304
v_cvt_pk_bf16_f32 v148, v188, v189
v_mfma_f32_16x16x32_bf16 v[80:83], v[48:51], a[28:31], v[80:83]
s_waitcnt lgkmcnt(4)
v_fmac_f32 v54, v152, v57
v_fmac_f32 v58, v89, v53
v_mfma_f32_16x16x32_bf16 v[68:71], v[20:23], a[32:35], v[68:71]
ds_read_b128 v[44:47], v19 offset:256
s_add_u32 m0, s21, 35840
v_fmac_f32 v129, v155, v57
v_mfma_f32_16x16x32_bf16 v[72:75], v[20:23], a[36:39], v[72:75]
buffer_load_dwordx4 v11, s[8:11], s20 offen lds
v_mfma_f32_16x16x32_bf16 v[76:79], v[24:27], a[32:35], v[76:79]
ds_read_b128 v[48:51], v19 offset:2304
v_cvt_pk_bf16_f32 v149, v190, v191
v_fmac_f32 v137, v155, v53
v_mfma_f32_16x16x32_bf16 v[80:83], v[24:27], a[36:39], v[80:83]
s_waitcnt lgkmcnt(4)
v_fmac_f32 v55, v88, v54
v_fmac_f32 v59, v88, v58
v_mfma_f32_16x16x32_bf16 v[68:71], v[28:31], a[40:43], v[68:71]
s_waitcnt vmcnt(20)
s_barrier
ds_read_b128 v[20:23], v16 offset:16384
v_mfma_f32_16x16x32_bf16 v[72:75], v[28:31], a[44:47], v[72:75]
s_add_u32 s20, s20, 512
buffer_store_dwordx2 v[148:149], v86, s[12:15], s43 offen offset:0 sc1
v_mfma_f32_16x16x32_bf16 v[76:79], v[32:35], a[40:43], v[76:79]
ds_read_b128 v[24:27], v16 offset:18432
v_cvt_pk_bf16_f32 v150, v192, v193
v_mfma_f32_16x16x32_bf16 v[80:83], v[32:35], a[44:47], v[80:83]
s_waitcnt lgkmcnt(4)
v_mul_f32 v130, v90, v54
v_mul_f32 v138, v154, v58
v_mfma_f32_16x16x32_bf16 v[68:71], v[36:39], a[48:51], v[68:71]
ds_read_b128 v[28:31], v17 offset:16384
s_add_u32 m0, s21, 49152
v_fmac_f32 v55, v152, v58
v_mfma_f32_16x16x32_bf16 v[72:75], v[36:39], a[52:55], v[72:75]
buffer_load_dwordx4 v8, s[8:11], s20 offen lds
v_mfma_f32_16x16x32_bf16 v[76:79], v[40:43], a[48:51], v[76:79]
ds_read_b128 v[32:35], v17 offset:18432
v_cvt_pk_bf16_f32 v151, v194, v195
v_fmac_f32 v59, v89, v54
v_mfma_f32_16x16x32_bf16 v[80:83], v[40:43], a[52:55], v[80:83]
s_waitcnt lgkmcnt(4)
v_fmac_f32 v130, v155, v58
v_fmac_f32 v138, v155, v54
v_mfma_f32_16x16x32_bf16 v[68:71], v[44:47], a[56:59], v[68:71]
ds_read_b128 v[36:39], v18 offset:16384
v_fmac_f32 v60, v88, v55
v_mfma_f32_16x16x32_bf16 v[72:75], v[44:47], a[60:63], v[72:75]
buffer_store_dwordx2 v[150:151], v86, s[12:15], s43 offen offset:256 sc1
v_fmac_f32 v64, v88, v59
v_mfma_f32_16x16x32_bf16 v[76:79], v[48:51], a[56:59], v[76:79]
ds_read_b128 v[40:43], v18 offset:18432
v_mul_f32 v131, v90, v55
v_mfma_f32_16x16x32_bf16 v[80:83], v[48:51], a[60:63], v[80:83]
s_waitcnt lgkmcnt(4)
v_mul_f32 v139, v154, v59
v_fmac_f32 v60, v152, v59
v_mfma_f32_16x16x32_bf16 v[68:71], v[20:23], a[64:67], v[68:71]
ds_read_b128 v[44:47], v19 offset:16384
s_add_u32 m0, s21, 50176
v_fmac_f32 v64, v89, v55
v_mfma_f32_16x16x32_bf16 v[72:75], v[20:23], a[68:71], v[72:75]
buffer_load_dwordx4 v9, s[8:11], s20 offen lds
v_mfma_f32_16x16x32_bf16 v[76:79], v[24:27], a[64:67], v[76:79]
ds_read_b128 v[48:51], v19 offset:18432
v_fmac_f32 v131, v155, v59
v_fmac_f32 v139, v155, v55
v_mfma_f32_16x16x32_bf16 v[80:83], v[24:27], a[68:71], v[80:83]
s_waitcnt lgkmcnt(4)
v_fmac_f32 v61, v88, v60
v_mfma_f32_16x16x32_bf16 v[68:71], v[28:31], a[72:75], v[68:71]
ds_read_b128 v[20:23], v16 offset:16640
v_fmac_f32 v65, v88, v64
v_mul_f32 v132, v90, v60
v_mfma_f32_16x16x32_bf16 v[72:75], v[28:31], a[76:79], v[72:75]
v_mul_f32 v140, v154, v64
v_fmac_f32 v61, v152, v64
v_mfma_f32_16x16x32_bf16 v[76:79], v[32:35], a[72:75], v[76:79]
ds_read_b128 v[24:27], v16 offset:18688
s_add_u32 s24, s24, 1
v_fmac_f32 v65, v89, v60
v_mfma_f32_16x16x32_bf16 v[80:83], v[32:35], a[76:79], v[80:83]
s_waitcnt lgkmcnt(4)
v_fmac_f32 v132, v155, v64
v_mfma_f32_16x16x32_bf16 v[68:71], v[36:39], a[80:83], v[68:71]
ds_read_b128 v[28:31], v17 offset:16640
s_add_u32 m0, s21, 51200
v_fmac_f32 v140, v155, v60
v_mfma_f32_16x16x32_bf16 v[72:75], v[36:39], a[84:87], v[72:75]
buffer_load_dwordx4 v10, s[8:11], s20 offen lds
v_fmac_f32 v62, v88, v61
v_mfma_f32_16x16x32_bf16 v[76:79], v[40:43], a[80:83], v[76:79]
ds_read_b128 v[32:35], v17 offset:18688
v_fmac_f32 v66, v88, v65
v_mfma_f32_16x16x32_bf16 v[80:83], v[40:43], a[84:87], v[80:83]
s_waitcnt lgkmcnt(4)
s_min_u32 s24, s24, 63
v_mul_f32 v133, v90, v61
v_mfma_f32_16x16x32_bf16 v[68:71], v[44:47], a[88:91], v[68:71]
ds_read_b128 v[36:39], v18 offset:16640
v_mul_f32 v141, v154, v65
v_mfma_f32_16x16x32_bf16 v[72:75], v[44:47], a[92:95], v[72:75]
v_fmac_f32 v62, v152, v65
v_fmac_f32 v66, v89, v61
v_fmac_f32 v133, v155, v65
v_mfma_f32_16x16x32_bf16 v[76:79], v[48:51], a[88:91], v[76:79]
ds_read_b128 v[40:43], v18 offset:18688
s_lshl_b32 s53, s24, 16
v_mfma_f32_16x16x32_bf16 v[80:83], v[48:51], a[92:95], v[80:83]
s_waitcnt lgkmcnt(4)
v_fmac_f32 v141, v155, v61
v_fmac_f32 v63, v88, v62
v_mfma_f32_16x16x32_bf16 v[68:71], v[20:23], a[96:99], v[68:71]
ds_read_b128 v[44:47], v19 offset:16640
s_add_u32 m0, s21, 52224
v_fmac_f32 v67, v88, v66
v_mfma_f32_16x16x32_bf16 v[72:75], v[20:23], a[100:103], v[72:75]
buffer_load_dwordx4 v11, s[8:11], s20 offen lds
v_mfma_f32_16x16x32_bf16 v[76:79], v[24:27], a[96:99], v[76:79]
ds_read_b128 v[48:51], v19 offset:18688
v_mul_f32 v134, v90, v62
v_mul_f32 v142, v154, v66
v_mfma_f32_16x16x32_bf16 v[80:83], v[24:27], a[100:103], v[80:83]
s_waitcnt lgkmcnt(4)
v_fmac_f32 v63, v152, v66
v_mfma_f32_16x16x32_bf16 v[68:71], v[28:31], a[104:107], v[68:71]
s_waitcnt vmcnt(20)
s_barrier
ds_read_b128 v[20:23], v16 offset:32768
v_mfma_f32_16x16x32_bf16 v[72:75], v[28:31], a[108:111], v[72:75]
s_mov_b32 s20, s53
v_fmac_f32 v67, v89, v62
v_fmac_f32 v134, v155, v66
v_mfma_f32_16x16x32_bf16 v[76:79], v[32:35], a[104:107], v[76:79]
ds_read_b128 v[24:27], v16 offset:34816
v_fmac_f32 v142, v155, v62
v_mfma_f32_16x16x32_bf16 v[80:83], v[32:35], a[108:111], v[80:83]
s_waitcnt lgkmcnt(4)
v_mfma_f32_16x16x4_f32 v[104:107], v116, v63, 0
v_mfma_f32_16x16x4_f32 v[108:111], v116, v67, 0
v_mfma_f32_16x16x32_bf16 v[68:71], v[36:39], a[112:115], v[68:71]
ds_read_b128 v[28:31], v17 offset:32768
s_add_u32 m0, s21, 65536
v_mul_f32 v135, v90, v63
v_mfma_f32_16x16x32_bf16 v[72:75], v[36:39], a[116:119], v[72:75]
buffer_load_dwordx4 v8, s[8:11], s20 offen lds
v_mfma_f32_16x16x32_bf16 v[76:79], v[40:43], a[112:115], v[76:79]
ds_read_b128 v[32:35], v17 offset:34816
v_mul_f32 v143, v154, v67
v_fmac_f32 v135, v155, v67
v_mfma_f32_16x16x32_bf16 v[80:83], v[40:43], a[116:119], v[80:83]
s_waitcnt lgkmcnt(4)
v_fmac_f32 v143, v155, v63
v_mfma_f32_16x16x32_bf16 v[68:71], v[44:47], a[120:123], v[68:71]
ds_read_b128 v[36:39], v18 offset:32768
s_nop 0
s_nop 0
v_mfma_f32_16x16x32_bf16 v[72:75], v[44:47], a[124:127], v[72:75]
s_nop 0
s_nop 0
v_mfma_f32_16x16x32_bf16 v[76:79], v[48:51], a[120:123], v[76:79]
ds_read_b128 v[40:43], v18 offset:34816
s_nop 0
s_nop 0
v_mfma_f32_16x16x32_bf16 v[80:83], v[48:51], a[124:127], v[80:83]
s_waitcnt lgkmcnt(4)
s_nop 0
v_mfma_f32_16x16x32_bf16 v[68:71], v[20:23], a[128:131], v[68:71]
ds_read_b128 v[44:47], v19 offset:32768
s_add_u32 m0, s21, 66560
v_fmac_f32 v104, v92, v94
v_mfma_f32_16x16x32_bf16 v[72:75], v[20:23], a[132:135], v[72:75]
buffer_load_dwordx4 v9, s[8:11], s20 offen lds
v_fmac_f32 v108, v92, v95
v_mfma_f32_16x16x32_bf16 v[76:79], v[24:27], a[128:131], v[76:79]
ds_read_b128 v[48:51], v19 offset:34816
v_fmac_f32 v104, v153, v95
v_mfma_f32_16x16x32_bf16 v[80:83], v[24:27], a[132:135], v[80:83]
s_waitcnt lgkmcnt(4)
v_fmac_f32 v108, v93, v94
v_cndmask_b32 v96, v94, v104, s[56:57]
v_mfma_f32_16x16x32_bf16 v[68:71], v[28:31], a[136:139], v[68:71]
ds_read_b128 v[20:23], v16 offset:33024
v_cndmask_b32 v97, v95, v108, s[56:57]
v_mfma_f32_16x16x32_bf16 v[72:75], v[28:31], a[140:143], v[72:75]
v_fmac_f32 v105, v92, v104
v_fmac_f32 v109, v92, v108
v_mfma_f32_16x16x32_bf16 v[76:79], v[32:35], a[136:139], v[76:79]
ds_read_b128 v[24:27], v16 offset:35072
v_fmac_f32 v105, v153, v108
v_fmac_f32 v109, v93, v104
v_mfma_f32_16x16x32_bf16 v[80:83], v[32:35], a[140:143], v[80:83]
s_waitcnt lgkmcnt(4)
v_cndmask_b32 v96, v96, v105, s[58:59]
v_mfma_f32_16x16x32_bf16 v[68:71], v[36:39], a[144:147], v[68:71]
ds_read_b128 v[28:31], v17 offset:33024
s_add_u32 m0, s21, 67584
v_cndmask_b32 v97, v97, v109, s[58:59]
v_mfma_f32_16x16x32_bf16 v[72:75], v[36:39], a[148:151], v[72:75]
buffer_load_dwordx4 v10, s[8:11], s20 offen lds
v_fmac_f32 v106, v92, v105
v_mfma_f32_16x16x32_bf16 v[76:79], v[40:43], a[144:147], v[76:79]
ds_read_b128 v[32:35], v17 offset:35072
v_fmac_f32 v110, v92, v109
v_mfma_f32_16x16x32_bf16 v[80:83], v[40:43], a[148:151], v[80:83]
s_waitcnt lgkmcnt(4)
v_fmac_f32 v106, v153, v109
v_fmac_f32 v110, v93, v105
v_mfma_f32_16x16x32_bf16 v[68:71], v[44:47], a[152:155], v[68:71]
ds_read_b128 v[36:39], v18 offset:33024
v_cndmask_b32 v96, v96, v106, s[60:61]
v_mfma_f32_16x16x32_bf16 v[72:75], v[44:47], a[156:159], v[72:75]
v_cndmask_b32 v97, v97, v110, s[60:61]
v_fmac_f32 v107, v92, v106
v_mfma_f32_16x16x32_bf16 v[76:79], v[48:51], a[152:155], v[76:79]
ds_read_b128 v[40:43], v18 offset:35072
v_fmac_f32 v111, v92, v110
v_fmac_f32 v107, v153, v110
v_mfma_f32_16x16x32_bf16 v[80:83], v[48:51], a[156:159], v[80:83]
s_waitcnt lgkmcnt(4)
v_fmac_f32 v111, v93, v106
v_mfma_f32_16x16x32_bf16 v[68:71], v[20:23], a[160:163], v[68:71]
ds_read_b128 v[44:47], v19 offset:33024
s_add_u32 m0, s21, 68608
v_xor_b32 v98, 0x80000000, v96
v_mfma_f32_16x16x32_bf16 v[72:75], v[20:23], a[164:167], v[72:75]
buffer_load_dwordx4 v11, s[8:11], s20 offen lds
v_xor_b32 v99, 0x80000000, v97
v_mfma_f32_16x16x32_bf16 v[76:79], v[24:27], a[160:163], v[76:79]
ds_read_b128 v[48:51], v19 offset:35072
v_mov_b32 v94, v107
v_mfma_f32_16x16x32_bf16 v[80:83], v[24:27], a[164:167], v[80:83]
s_waitcnt lgkmcnt(4)
v_mov_b32 v95, v111
v_fmac_f32 v128, v156, v96
v_mfma_f32_16x16x32_bf16 v[68:71], v[28:31], a[168:171], v[68:71]
s_waitcnt vmcnt(7)
s_barrier
ds_read_b128 v[20:23], v16 offset:49152
v_mfma_f32_16x16x32_bf16 v[72:75], v[28:31], a[172:175], v[72:75]
s_add_u32 s20, s20, 512
buffer_atomic_add v84, v85, s[12:15], s39 offen sc1
v_mfma_f32_16x16x32_bf16 v[76:79], v[32:35], a[168:171], v[76:79]
ds_read_b128 v[24:27], v16 offset:51200
v_fmac_f32 v136, v156, v99
v_mfma_f32_16x16x32_bf16 v[80:83], v[32:35], a[172:175], v[80:83]
s_waitcnt lgkmcnt(4)
v_fmac_f32 v128, v157, v99
v_fmac_f32 v136, v157, v98
v_mfma_f32_16x16x32_bf16 v[68:71], v[36:39], a[176:179], v[68:71]
ds_read_b128 v[28:31], v17 offset:49152
s_add_u32 m0, s21, 81920
v_fmac_f32 v129, v158, v96
v_mfma_f32_16x16x32_bf16 v[72:75], v[36:39], a[180:183], v[72:75]
buffer_load_dwordx4 v8, s[8:11], s20 offen lds
v_mfma_f32_16x16x32_bf16 v[76:79], v[40:43], a[176:179], v[76:79]
ds_read_b128 v[32:35], v17 offset:51200
v_fmac_f32 v137, v158, v99
v_fmac_f32 v129, v159, v99
v_mfma_f32_16x16x32_bf16 v[80:83], v[40:43], a[180:183], v[80:83]
s_waitcnt lgkmcnt(4)
v_fmac_f32 v137, v159, v98
v_mfma_f32_16x16x32_bf16 v[68:71], v[44:47], a[184:187], v[68:71]
ds_read_b128 v[36:39], v18 offset:49152
v_cvt_pk_bf16_f32 v120, v128, v129
v_cvt_pk_bf16_f32 v124, v136, v137
v_mfma_f32_16x16x32_bf16 v[72:75], v[44:47], a[188:191], v[72:75]
v_fmac_f32 v130, v160, v96
v_fmac_f32 v138, v160, v99
v_mfma_f32_16x16x32_bf16 v[76:79], v[48:51], a[184:187], v[76:79]
ds_read_b128 v[40:43], v18 offset:51200
v_fmac_f32 v130, v161, v99
v_fmac_f32 v138, v161, v98
v_mfma_f32_16x16x32_bf16 v[80:83], v[48:51], a[188:191], v[80:83]
s_waitcnt lgkmcnt(4)
v_fmac_f32 v131, v162, v96
v_mfma_f32_16x16x32_bf16 v[68:71], v[20:23], a[192:195], v[68:71]
ds_read_b128 v[44:47], v19 offset:49152
s_add_u32 m0, s21, 82944
v_fmac_f32 v139, v162, v99
v_mfma_f32_16x16x32_bf16 v[72:75], v[20:23], a[196:199], v[72:75]
buffer_load_dwordx4 v9, s[8:11], s20 offen lds
v_fmac_f32 v131, v163, v99
v_mfma_f32_16x16x32_bf16 v[76:79], v[24:27], a[192:195], v[76:79]
ds_read_b128 v[48:51], v19 offset:51200
v_fmac_f32 v139, v163, v98
v_mfma_f32_16x16x32_bf16 v[80:83], v[24:27], a[196:199], v[80:83]
s_waitcnt lgkmcnt(4)
v_cvt_pk_bf16_f32 v121, v130, v131
v_mfma_f32_16x16x32_bf16 v[68:71], v[28:31], a[200:203], v[68:71]
ds_read_b128 v[20:23], v16 offset:49408
v_cvt_pk_bf16_f32 v125, v138, v139
v_fmac_f32 v132, v164, v96
v_mfma_f32_16x16x32_bf16 v[72:75], v[28:31], a[204:207], v[72:75]
v_fmac_f32 v140, v164, v99
v_fmac_f32 v132, v165, v99
v_mfma_f32_16x16x32_bf16 v[76:79], v[32:35], a[200:203], v[76:79]
ds_read_b128 v[24:27], v16 offset:51456
v_fmac_f32 v140, v165, v98
v_fmac_f32 v133, v166, v96
v_mfma_f32_16x16x32_bf16 v[80:83], v[32:35], a[204:207], v[80:83]
s_waitcnt lgkmcnt(4)
v_fmac_f32 v141, v166, v99
v_mfma_f32_16x16x32_bf16 v[68:71], v[36:39], a[208:211], v[68:71]
ds_read_b128 v[28:31], v17 offset:49408
s_add_u32 m0, s21, 83968
v_fmac_f32 v133, v167, v99
v_mfma_f32_16x16x32_bf16 v[72:75], v[36:39], a[212:215], v[72:75]
buffer_load_dwordx4 v10, s[8:11], s20 offen lds
v_fmac_f32 v141, v167, v98
v_mfma_f32_16x16x32_bf16 v[76:79], v[40:43], a[208:211], v[76:79]
ds_read_b128 v[32:35], v17 offset:51456
v_cvt_pk_bf16_f32 v122, v132, v133
v_mfma_f32_16x16x32_bf16 v[80:83], v[40:43], a[212:215], v[80:83]
s_waitcnt lgkmcnt(4)
v_cvt_pk_bf16_f32 v126, v140, v141
v_fmac_f32 v134, v168, v96
v_mfma_f32_16x16x32_bf16 v[68:71], v[44:47], a[216:219], v[68:71]
ds_read_b128 v[36:39], v18 offset:49408
v_fmac_f32 v142, v168, v99
v_mfma_f32_16x16x32_bf16 v[72:75], v[44:47], a[220:223], v[72:75]
v_fmac_f32 v134, v169, v99
v_fmac_f32 v142, v169, v98
v_mfma_f32_16x16x32_bf16 v[76:79], v[48:51], a[216:219], v[76:79]
ds_read_b128 v[40:43], v18 offset:51456
v_fmac_f32 v135, v170, v96
v_fmac_f32 v143, v170, v99
v_mfma_f32_16x16x32_bf16 v[80:83], v[48:51], a[220:223], v[80:83]
s_waitcnt lgkmcnt(4)
v_fmac_f32 v135, v171, v99
v_mfma_f32_16x16x32_bf16 v[68:71], v[20:23], a[224:227], v[68:71]
ds_read_b128 v[44:47], v19 offset:49408
s_add_u32 m0, s21, 84992
v_fmac_f32 v143, v171, v98
v_mfma_f32_16x16x32_bf16 v[72:75], v[20:23], a[228:231], v[72:75]
buffer_load_dwordx4 v11, s[8:11], s20 offen lds
v_cvt_pk_bf16_f32 v123, v134, v135
v_mfma_f32_16x16x32_bf16 v[76:79], v[24:27], a[224:227], v[76:79]
ds_read_b128 v[48:51], v19 offset:51456
v_cvt_pk_bf16_f32 v127, v142, v143
v_mfma_f32_16x16x32_bf16 v[80:83], v[24:27], a[228:231], v[80:83]
s_waitcnt lgkmcnt(4)
s_nop 0
s_nop 0
v_mfma_f32_16x16x32_bf16 v[68:71], v[28:31], a[232:235], v[68:71]
s_waitcnt vmcnt(20)
s_barrier
ds_read_b128 v[20:23], v12 offset:0
v_mfma_f32_16x16x32_bf16 v[72:75], v[28:31], a[236:239], v[72:75]
s_add_u32 s20, s20, 512
v_mfma_f32_16x16x32_bf16 v[180:183], v[120:123], v[172:175], 0
v_mfma_f32_16x16x32_bf16 v[76:79], v[32:35], a[232:235], v[76:79]
ds_read_b128 v[24:27], v12 offset:2048
v_mfma_f32_16x16x32_bf16 v[184:187], v[120:123], v[176:179], 0
v_mfma_f32_16x16x32_bf16 v[188:191], v[124:127], v[172:175], 0
v_mfma_f32_16x16x32_bf16 v[80:83], v[32:35], a[236:239], v[80:83]
s_waitcnt lgkmcnt(4)
v_mfma_f32_16x16x32_bf16 v[192:195], v[124:127], v[176:179], 0
v_mfma_f32_16x16x32_bf16 v[68:71], v[36:39], a[240:243], v[68:71]
ds_read_b128 v[28:31], v13 offset:0
s_add_u32 m0, s21, 98304
s_sub_u32 s39, s22, 1
v_mfma_f32_16x16x32_bf16 v[72:75], v[36:39], a[244:247], v[72:75]
buffer_load_dwordx4 v8, s[8:11], s20 offen lds
s_lshl_b32 s38, s39, 17
v_mfma_f32_16x16x32_bf16 v[76:79], v[40:43], a[240:243], v[76:79]
ds_read_b128 v[32:35], v13 offset:2048
s_add_u32 s38, s38, 0x4400000
v_mfma_f32_16x16x32_bf16 v[80:83], v[40:43], a[244:247], v[80:83]
s_waitcnt lgkmcnt(4)
s_add_u32 s43, s38, 0x10000
s_lshl_b32 s39, s39, 7
v_mfma_f32_16x16x32_bf16 v[68:71], v[44:47], a[248:251], v[68:71]
ds_read_b128 v[36:39], v14 offset:0
s_add_u32 s39, s39, 0x5902000
v_mfma_f32_16x16x32_bf16 v[72:75], v[44:47], a[252:255], v[72:75]
s_cmp_eq_u32 s37, 0
s_cselect_b32 s38, 0x7ff00000, s38
s_cselect_b32 s39, 0x7ff00000, s39
s_cselect_b32 s43, 0x7ff00000, s43
v_mfma_f32_16x16x32_bf16 v[76:79], v[48:51], a[248:251], v[76:79]
ds_read_b128 v[40:43], v14 offset:2048
v_mfma_f32_16x16x32_bf16 v[80:83], v[48:51], a[252:255], v[80:83]
s_waitcnt lgkmcnt(4)
s_mov_b32 s37, 1
s_add_u32 s22, s22, 1
s_cmp_ge_u32 s22, s23
s_cbranch_scc0 L_st_478
L_fl1_476:
s_waitcnt lgkmcnt(0)
s_nop 7
v_cvt_pk_bf16_f32 v144, v180, v181
v_cvt_pk_bf16_f32 v145, v182, v183
buffer_store_dwordx2 v[144:145], v86, s[12:15], s38 offen offset:0 sc1
v_cvt_pk_bf16_f32 v146, v184, v185
v_cvt_pk_bf16_f32 v147, v186, v187
buffer_store_dwordx2 v[146:147], v86, s[12:15], s38 offen offset:256 sc1
v_cvt_pk_bf16_f32 v148, v188, v189
v_cvt_pk_bf16_f32 v149, v190, v191
buffer_store_dwordx2 v[148:149], v86, s[12:15], s43 offen offset:0 sc1
v_cvt_pk_bf16_f32 v150, v192, v193
v_cvt_pk_bf16_f32 v151, v194, v195
buffer_store_dwordx2 v[150:151], v86, s[12:15], s43 offen offset:256 sc1
s_waitcnt vmcnt(0)
s_barrier
buffer_atomic_add v84, v85, s[12:15], s39 offen sc1
v_fmac_f32 v69, v88, v68
v_fmac_f32 v73, v88, v72
v_mul_f32 v128, v90, v68
v_mul_f32 v136, v154, v72
v_fmac_f32 v69, v152, v72
v_fmac_f32 v73, v89, v68
v_fmac_f32 v128, v155, v72
v_fmac_f32 v136, v155, v68
v_fmac_f32 v70, v88, v69
v_fmac_f32 v74, v88, v73
v_mul_f32 v129, v90, v69
v_mul_f32 v137, v154, v73
v_fmac_f32 v70, v152, v73
v_fmac_f32 v74, v89, v69
v_fmac_f32 v129, v155, v73
v_fmac_f32 v137, v155, v69
v_fmac_f32 v71, v88, v70
v_fmac_f32 v75, v88, v74
v_mul_f32 v130, v90, v70
v_mul_f32 v138, v154, v74
v_fmac_f32 v71, v152, v74
v_fmac_f32 v75, v89, v70
v_fmac_f32 v130, v155, v74
v_fmac_f32 v138, v155, v70
v_fmac_f32 v76, v88, v71
v_fmac_f32 v80, v88, v75
v_mul_f32 v131, v90, v71
v_mul_f32 v139, v154, v75
v_fmac_f32 v76, v152, v75
v_fmac_f32 v80, v89, v71
v_fmac_f32 v131, v155, v75
v_fmac_f32 v139, v155, v71
v_fmac_f32 v77, v88, v76
v_fmac_f32 v81, v88, v80
v_mul_f32 v132, v90, v76
v_mul_f32 v140, v154, v80
v_fmac_f32 v77, v152, v80
v_fmac_f32 v81, v89, v76
v_fmac_f32 v132, v155, v80
v_fmac_f32 v140, v155, v76
v_fmac_f32 v78, v88, v77
v_fmac_f32 v82, v88, v81
v_mul_f32 v133, v90, v77
v_mul_f32 v141, v154, v81
v_fmac_f32 v78, v152, v81
v_fmac_f32 v82, v89, v77
v_fmac_f32 v133, v155, v81
v_fmac_f32 v141, v155, v77
v_fmac_f32 v79, v88, v78
v_fmac_f32 v83, v88, v82
v_mul_f32 v134, v90, v78
v_mul_f32 v142, v154, v82
v_fmac_f32 v79, v152, v82
v_fmac_f32 v83, v89, v78
v_fmac_f32 v134, v155, v82
v_fmac_f32 v142, v155, v78
v_mfma_f32_16x16x4_f32 v[104:107], v116, v79, 0
v_mfma_f32_16x16x4_f32 v[108:111], v116, v83, 0
v_mul_f32 v135, v90, v79
v_mul_f32 v143, v154, v83
v_fmac_f32 v135, v155, v83
v_fmac_f32 v143, v155, v79
s_nop 0
s_nop 0
s_nop 0
s_nop 0
s_nop 0
s_nop 0
s_nop 0
v_fmac_f32 v104, v92, v94
v_fmac_f32 v108, v92, v95
v_fmac_f32 v104, v153, v95
v_fmac_f32 v108, v93, v94
v_cndmask_b32 v96, v94, v104, s[56:57]
v_cndmask_b32 v97, v95, v108, s[56:57]
v_fmac_f32 v105, v92, v104
v_fmac_f32 v109, v92, v108
v_fmac_f32 v105, v153, v108
v_fmac_f32 v109, v93, v104
v_cndmask_b32 v96, v96, v105, s[58:59]
v_cndmask_b32 v97, v97, v109, s[58:59]
v_fmac_f32 v106, v92, v105
v_fmac_f32 v110, v92, v109
v_fmac_f32 v106, v153, v109
v_fmac_f32 v110, v93, v105
v_cndmask_b32 v96, v96, v106, s[60:61]
v_cndmask_b32 v97, v97, v110, s[60:61]
v_fmac_f32 v107, v92, v106
v_fmac_f32 v111, v92, v110
v_fmac_f32 v107, v153, v110
v_fmac_f32 v111, v93, v106
v_xor_b32 v98, 0x80000000, v96
v_xor_b32 v99, 0x80000000, v97
v_mov_b32 v94, v107
v_mov_b32 v95, v111
v_fmac_f32 v128, v156, v96
v_fmac_f32 v136, v156, v99
v_fmac_f32 v128, v157, v99
v_fmac_f32 v136, v157, v98
v_fmac_f32 v129, v158, v96
v_fmac_f32 v137, v158, v99
v_fmac_f32 v129, v159, v99
v_fmac_f32 v137, v159, v98
v_cvt_pk_bf16_f32 v120, v128, v129
v_cvt_pk_bf16_f32 v124, v136, v137
v_fmac_f32 v130, v160, v96
v_fmac_f32 v138, v160, v99
v_fmac_f32 v130, v161, v99
v_fmac_f32 v138, v161, v98
v_fmac_f32 v131, v162, v96
v_fmac_f32 v139, v162, v99
v_fmac_f32 v131, v163, v99
v_fmac_f32 v139, v163, v98
v_cvt_pk_bf16_f32 v121, v130, v131
v_cvt_pk_bf16_f32 v125, v138, v139
v_fmac_f32 v132, v164, v96
v_fmac_f32 v140, v164, v99
v_fmac_f32 v132, v165, v99
v_fmac_f32 v140, v165, v98
v_fmac_f32 v133, v166, v96
v_fmac_f32 v141, v166, v99
v_fmac_f32 v133, v167, v99
v_fmac_f32 v141, v167, v98
v_cvt_pk_bf16_f32 v122, v132, v133
v_cvt_pk_bf16_f32 v126, v140, v141
v_fmac_f32 v134, v168, v96
v_fmac_f32 v142, v168, v99
v_fmac_f32 v134, v169, v99
v_fmac_f32 v142, v169, v98
v_fmac_f32 v135, v170, v96
v_fmac_f32 v143, v170, v99
v_fmac_f32 v135, v171, v99
v_fmac_f32 v143, v171, v98
v_cvt_pk_bf16_f32 v123, v134, v135
v_cvt_pk_bf16_f32 v127, v142, v143
s_nop 0
s_nop 0
v_mfma_f32_16x16x32_bf16 v[180:183], v[120:123], v[172:175], 0
v_mfma_f32_16x16x32_bf16 v[184:187], v[120:123], v[176:179], 0
v_mfma_f32_16x16x32_bf16 v[188:191], v[124:127], v[172:175], 0
v_mfma_f32_16x16x32_bf16 v[192:195], v[124:127], v[176:179], 0
s_sub_u32 s39, s22, 1
s_lshl_b32 s38, s39, 17
s_add_u32 s38, s38, 0x4400000
s_add_u32 s43, s38, 0x10000
s_lshl_b32 s39, s39, 7
s_add_u32 s39, s39, 0x5902000
s_cmp_eq_u32 s37, 0
s_cselect_b32 s38, 0x7ff00000, s38
s_cselect_b32 s39, 0x7ff00000, s39
s_cselect_b32 s43, 0x7ff00000, s43
s_mov_b32 s37, 1
v_cvt_pk_bf16_f32 v144, v180, v181
v_cvt_pk_bf16_f32 v145, v182, v183
buffer_store_dwordx2 v[144:145], v86, s[12:15], s38 offen offset:0 sc1
v_cvt_pk_bf16_f32 v146, v184, v185
v_cvt_pk_bf16_f32 v147, v186, v187
buffer_store_dwordx2 v[146:147], v86, s[12:15], s38 offen offset:256 sc1
v_cvt_pk_bf16_f32 v148, v188, v189
v_cvt_pk_bf16_f32 v149, v190, v191
buffer_store_dwordx2 v[148:149], v86, s[12:15], s43 offen offset:0 sc1
v_cvt_pk_bf16_f32 v150, v192, v193
v_cvt_pk_bf16_f32 v151, v194, v195
buffer_store_dwordx2 v[150:151], v86, s[12:15], s43 offen offset:256 sc1
s_waitcnt vmcnt(0)
s_barrier
buffer_atomic_add v84, v85, s[12:15], s39 offen sc1
s_branch L_ste_477
L_fl0_475:
s_waitcnt lgkmcnt(0)
s_nop 7
v_cvt_pk_bf16_f32 v144, v180, v181
v_cvt_pk_bf16_f32 v145, v182, v183
buffer_store_dwordx2 v[144:145], v86, s[12:15], s38 offen offset:0 sc1
v_cvt_pk_bf16_f32 v146, v184, v185
v_cvt_pk_bf16_f32 v147, v186, v187
buffer_store_dwordx2 v[146:147], v86, s[12:15], s38 offen offset:256 sc1
v_cvt_pk_bf16_f32 v148, v188, v189
v_cvt_pk_bf16_f32 v149, v190, v191
buffer_store_dwordx2 v[148:149], v86, s[12:15], s43 offen offset:0 sc1
v_cvt_pk_bf16_f32 v150, v192, v193
v_cvt_pk_bf16_f32 v151, v194, v195
buffer_store_dwordx2 v[150:151], v86, s[12:15], s43 offen offset:256 sc1
s_waitcnt vmcnt(0)
s_barrier
buffer_atomic_add v84, v85, s[12:15], s39 offen sc1
v_fmac_f32 v53, v88, v52
v_fmac_f32 v57, v88, v56
v_mul_f32 v128, v90, v52
v_mul_f32 v136, v154, v56
v_fmac_f32 v53, v152, v56
v_fmac_f32 v57, v89, v52
v_fmac_f32 v128, v155, v56
v_fmac_f32 v136, v155, v52
v_fmac_f32 v54, v88, v53
v_fmac_f32 v58, v88, v57
v_mul_f32 v129, v90, v53
v_mul_f32 v137, v154, v57
v_fmac_f32 v54, v152, v57
v_fmac_f32 v58, v89, v53
v_fmac_f32 v129, v155, v57
v_fmac_f32 v137, v155, v53
v_fmac_f32 v55, v88, v54
v_fmac_f32 v59, v88, v58
v_mul_f32 v130, v90, v54
v_mul_f32 v138, v154, v58
v_fmac_f32 v55, v152, v58
v_fmac_f32 v59, v89, v54
v_fmac_f32 v130, v155, v58
v_fmac_f32 v138, v155, v54
v_fmac_f32 v60, v88, v55
v_fmac_f32 v64, v88, v59
v_mul_f32 v131, v90, v55
v_mul_f32 v139, v154, v59
v_fmac_f32 v60, v152, v59
v_fmac_f32 v64, v89, v55
v_fmac_f32 v131, v155, v59
v_fmac_f32 v139, v155, v55
v_fmac_f32 v61, v88, v60
v_fmac_f32 v65, v88, v64
v_mul_f32 v132, v90, v60
v_mul_f32 v140, v154, v64
v_fmac_f32 v61, v152, v64
v_fmac_f32 v65, v89, v60
v_fmac_f32 v132, v155, v64
v_fmac_f32 v140, v155, v60
v_fmac_f32 v62, v88, v61
v_fmac_f32 v66, v88, v65
v_mul_f32 v133, v90, v61
v_mul_f32 v141, v154, v65
v_fmac_f32 v62, v152, v65
v_fmac_f32 v66, v89, v61
v_fmac_f32 v133, v155, v65
v_fmac_f32 v141, v155, v61
v_fmac_f32 v63, v88, v62
v_fmac_f32 v67, v88, v66
v_mul_f32 v134, v90, v62
v_mul_f32 v142, v154, v66
v_fmac_f32 v63, v152, v66
v_fmac_f32 v67, v89, v62
v_fmac_f32 v134, v155, v66
v_fmac_f32 v142, v155, v62
v_mfma_f32_16x16x4_f32 v[104:107], v116, v63, 0
v_mfma_f32_16x16x4_f32 v[108:111], v116, v67, 0
v_mul_f32 v135, v90, v63
v_mul_f32 v143, v154, v67
v_fmac_f32 v135, v155, v67
v_fmac_f32 v143, v155, v63
s_nop 0
s_nop 0
s_nop 0
s_nop 0
s_nop 0
s_nop 0
s_nop 0
v_fmac_f32 v104, v92, v94
v_fmac_f32 v108, v92, v95
v_fmac_f32 v104, v153, v95
v_fmac_f32 v108, v93, v94
v_cndmask_b32 v96, v94, v104, s[56:57]
v_cndmask_b32 v97, v95, v108, s[56:57]
v_fmac_f32 v105, v92, v104
v_fmac_f32 v109, v92, v108
v_fmac_f32 v105, v153, v108
v_fmac_f32 v109, v93, v104
v_cndmask_b32 v96, v96, v105, s[58:59]
v_cndmask_b32 v97, v97, v109, s[58:59]
v_fmac_f32 v106, v92, v105
v_fmac_f32 v110, v92, v109
v_fmac_f32 v106, v153, v109
v_fmac_f32 v110, v93, v105
v_cndmask_b32 v96, v96, v106, s[60:61]
v_cndmask_b32 v97, v97, v110, s[60:61]
v_fmac_f32 v107, v92, v106
v_fmac_f32 v111, v92, v110
v_fmac_f32 v107, v153, v110
v_fmac_f32 v111, v93, v106
v_xor_b32 v98, 0x80000000, v96
v_xor_b32 v99, 0x80000000, v97
v_mov_b32 v94, v107
v_mov_b32 v95, v111
v_fmac_f32 v128, v156, v96
v_fmac_f32 v136, v156, v99
v_fmac_f32 v128, v157, v99
v_fmac_f32 v136, v157, v98
v_fmac_f32 v129, v158, v96
v_fmac_f32 v137, v158, v99
v_fmac_f32 v129, v159, v99
v_fmac_f32 v137, v159, v98
v_cvt_pk_bf16_f32 v120, v128, v129
v_cvt_pk_bf16_f32 v124, v136, v137
v_fmac_f32 v130, v160, v96
v_fmac_f32 v138, v160, v99
v_fmac_f32 v130, v161, v99
v_fmac_f32 v138, v161, v98
v_fmac_f32 v131, v162, v96
v_fmac_f32 v139, v162, v99
v_fmac_f32 v131, v163, v99
v_fmac_f32 v139, v163, v98
v_cvt_pk_bf16_f32 v121, v130, v131
v_cvt_pk_bf16_f32 v125, v138, v139
v_fmac_f32 v132, v164, v96
v_fmac_f32 v140, v164, v99
v_fmac_f32 v132, v165, v99
v_fmac_f32 v140, v165, v98
v_fmac_f32 v133, v166, v96
v_fmac_f32 v141, v166, v99
v_fmac_f32 v133, v167, v99
v_fmac_f32 v141, v167, v98
v_cvt_pk_bf16_f32 v122, v132, v133
v_cvt_pk_bf16_f32 v126, v140, v141
v_fmac_f32 v134, v168, v96
v_fmac_f32 v142, v168, v99
v_fmac_f32 v134, v169, v99
v_fmac_f32 v142, v169, v98
v_fmac_f32 v135, v170, v96
v_fmac_f32 v143, v170, v99
v_fmac_f32 v135, v171, v99
v_fmac_f32 v143, v171, v98
v_cvt_pk_bf16_f32 v123, v134, v135
v_cvt_pk_bf16_f32 v127, v142, v143
s_nop 0
s_nop 0
v_mfma_f32_16x16x32_bf16 v[180:183], v[120:123], v[172:175], 0
v_mfma_f32_16x16x32_bf16 v[184:187], v[120:123], v[176:179], 0
v_mfma_f32_16x16x32_bf16 v[188:191], v[124:127], v[172:175], 0
v_mfma_f32_16x16x32_bf16 v[192:195], v[124:127], v[176:179], 0
s_sub_u32 s39, s22, 1
s_lshl_b32 s38, s39, 17
s_add_u32 s38, s38, 0x4400000
s_add_u32 s43, s38, 0x10000
s_lshl_b32 s39, s39, 7
s_add_u32 s39, s39, 0x5902000
s_cmp_eq_u32 s37, 0
s_cselect_b32 s38, 0x7ff00000, s38
s_cselect_b32 s39, 0x7ff00000, s39
s_cselect_b32 s43, 0x7ff00000, s43
s_mov_b32 s37, 1
v_cvt_pk_bf16_f32 v144, v180, v181
v_cvt_pk_bf16_f32 v145, v182, v183
buffer_store_dwordx2 v[144:145], v86, s[12:15], s38 offen offset:0 sc1
v_cvt_pk_bf16_f32 v146, v184, v185
v_cvt_pk_bf16_f32 v147, v186, v187
buffer_store_dwordx2 v[146:147], v86, s[12:15], s38 offen offset:256 sc1
v_cvt_pk_bf16_f32 v148, v188, v189
v_cvt_pk_bf16_f32 v149, v190, v191
buffer_store_dwordx2 v[148:149], v86, s[12:15], s43 offen offset:0 sc1
v_cvt_pk_bf16_f32 v150, v192, v193
v_cvt_pk_bf16_f32 v151, v194, v195
buffer_store_dwordx2 v[150:151], v86, s[12:15], s43 offen offset:256 sc1
s_waitcnt vmcnt(0)
s_barrier
buffer_atomic_add v84, v85, s[12:15], s39 offen sc1
L_ste_477:
s_branch L_op_435
L_g2_434:
s_and_b32 s46, s41, 15
s_mov_b32 s32, s64
s_and_b32 s33, s65, 0xffff
s_mov_b32 s34, 0x400000
s_mov_b32 s35, 0x00020000
v_lshlrev_b32 v1, 4, v0
s_lshl_b32 s25, s46, 12
L_warm_479:
buffer_load_dwordx4 v[20:23], v1, s[32:35], s25 offen
s_add_u32 s25, s25, 0x10000
buffer_load_dwordx4 v[24:27], v1, s[32:35], s25 offen
s_add_u32 s25, s25, 0x10000
buffer_load_dwordx4 v[28:31], v1, s[32:35], s25 offen
s_add_u32 s25, s25, 0x10000
buffer_load_dwordx4 v[32:35], v1, s[32:35], s25 offen
s_add_u32 s25, s25, 0x10000
buffer_load_dwordx4 v[36:39], v1, s[32:35], s25 offen
s_add_u32 s25, s25, 0x10000
buffer_load_dwordx4 v[40:43], v1, s[32:35], s25 offen
s_add_u32 s25, s25, 0x10000
buffer_load_dwordx4 v[44:47], v1, s[32:35], s25 offen
s_add_u32 s25, s25, 0x10000
buffer_load_dwordx4 v[48:51], v1, s[32:35], s25 offen
s_add_u32 s25, s25, 0x10000
buffer_load_dwordx4 v[52:55], v1, s[32:35], s25 offen
s_add_u32 s25, s25, 0x10000
buffer_load_dwordx4 v[56:59], v1, s[32:35], s25 offen
s_add_u32 s25, s25, 0x10000
buffer_load_dwordx4 v[60:63], v1, s[32:35], s25 offen
s_add_u32 s25, s25, 0x10000
buffer_load_dwordx4 v[64:67], v1, s[32:35], s25 offen
s_add_u32 s25, s25, 0x10000
buffer_load_dwordx4 v[68:71], v1, s[32:35], s25 offen
s_add_u32 s25, s25, 0x10000
buffer_load_dwordx4 v[72:75], v1, s[32:35], s25 offen
s_add_u32 s25, s25, 0x10000
buffer_load_dwordx4 v[76:79], v1, s[32:35], s25 offen
s_add_u32 s25, s25, 0x10000
buffer_load_dwordx4 v[80:83], v1, s[32:35], s25 offen
s_add_u32 s25, s25, 0x10000
s_waitcnt vmcnt(16)
s_cmp_lt_u32 s25, 0x400000
s_cbranch_scc1 L_warm_479
s_waitcnt vmcnt(0)
s_mov_b32 s32, s98
s_and_b32 s33, s99, 0xffff
s_mov_b32 s34, 0x100
s_mov_b32 s35, 0x00020000
s_mov_b32 s25, 0
v_mov_b32 v2, 0
L_pl_480:
buffer_load_dword v1, v2, s[32:35], s25 offen sc1
s_add_u32 s36, s36, 1
s_cmp_gt_u32 s36, 0x100000
s_cbranch_scc1 chain_kernel_wend
s_waitcnt vmcnt(0)
v_readfirstlane_b32 s26, v1
s_and_b32 s27, s26, 0xffff
s_cmp_ge_u32 s27, 256
s_cbranch_scc1 L_plok_481
s_sleep 4
s_branch L_pl_480
L_plok_481:
s_lshr_b32 s25, s26, 16
s_cmp_gt_u32 s25, 16
s_cselect_b32 s25, 0x2000, 0x0
s_add_u32 s54, s100, 0x1fffff
s_and_b32 s54, s54, 0xffe00000
s_sub_u32 s55, s54, s100
s_add_u32 s54, s55, s25
s_xor_b32 s25, s25, 0x2000
s_add_u32 s55, s55, s25
s_lshl_b32 s44, s46, 15
s_lshl_b32 s25, s49, 13
s_add_u32 s44, s44, s25
s_xor_b32 s45, s44, 0x8000
s_add_u32 s44, s44, 0x6800000
s_add_u32 s45, s45, 0x6800000
s_lshr_b32 s48, s46, 1
s_lshl_b32 s48, s48, 7
s_add_u32 s48, s48, 0x590d000
v_mov_b32 v104, 0
v_mov_b32 v105, 0
v_mov_b32 v106, 0
v_mov_b32 v107, 0
v_and_b32 v2, 63, v0
v_lshlrev_b32 v3, 4, v2
v_lshlrev_b32 v112, 4, v2
s_add_u32 s28, s44, 0
buffer_store_dwordx4 v[104:107], v3, s[12:15], s28 offen sc1
s_add_u32 s28, s44, 1024
buffer_store_dwordx4 v[104:107], v3, s[12:15], s28 offen sc1
s_add_u32 s28, s44, 2048
buffer_store_dwordx4 v[104:107], v3, s[12:15], s28 offen sc1
s_add_u32 s28, s44, 3072
buffer_store_dwordx4 v[104:107], v3, s[12:15], s28 offen sc1
s_add_u32 s28, s44, 4096
buffer_store_dwordx4 v[104:107], v3, s[12:15], s28 offen sc1
s_add_u32 s28, s44, 5120
buffer_store_dwordx4 v[104:107], v3, s[12:15], s28 offen sc1
s_add_u32 s28, s44, 6144
buffer_store_dwordx4 v[104:107], v3, s[12:15], s28 offen sc1
s_add_u32 s28, s44, 7168
buffer_store_dwordx4 v[104:107], v3, s[12:15], s28 offen sc1
v_lshrrev_b32 v1, 6, v0
v_lshlrev_b32 v1, 11, v1
v_add_u32 v1, 0x21000, v1
s_waitcnt vmcnt(0)
s_barrier
buffer_atomic_add v84, v85, s[12:15], s48 offen sc1
v_mov_b32 v2, 0
L_pl_482:
buffer_load_dword v1, v2, s[12:15], s48 offen sc1
s_add_u32 s36, s36, 1
s_cmp_gt_u32 s36, 0x100000
s_cbranch_scc1 chain_kernel_wend
s_waitcnt vmcnt(0)
v_readfirstlane_b32 s26, v1
s_cmp_ge_u32 s26, 2
s_cbranch_scc1 L_plok_483
s_sleep 4
s_branch L_pl_482
L_plok_483:
s_and_b32 s47, s46, 1
s_cmp_eq_u32 s47, 1
s_cselect_b32 s16, s76, s74
s_cselect_b32 s17, s77, s75
s_and_b32 s17, s17, 0xffff
s_mov_b32 s18, 0x200000
s_mov_b32 s19, 0x00020000
s_lshr_b32 s25, s46, 1
s_lshl_b32 s25, s25, 7
s_lshl_b32 s26, s49, 5
s_add_u32 s25, s25, s26
v_and_b32 v5, 15, v0
v_lshl_add_u32 v5, v5, 1, s25
s_lshl_b32 s26, s47, 4
v_bfe_u32 v6, v0, 4, 2
v_lshl_add_u32 v6, v6, 2, s26
v_lshlrev_b32 v7, 1, v5
v_lshl_add_u32 v136, v6, 11, v7
v_add_u32 v137, 0x1000, v136
v_lshlrev_b32 v5, 2, v5
v_lshl_add_u32 v140, v6, 13, v5
v_add_u32 v141, 0x2000, v140
v_add_u32 v142, 0x4000, v140
v_add_u32 v143, 0x6000, v140
s_mov_b32 s32, s80
s_and_b32 s33, s81, 0xffff
s_mov_b32 s34, 0x800
s_mov_b32 s35, 0x00020000
buffer_load_dword v132, v7, s[32:35], 0 offen
v_and_b32 v1, 31, v0
v_bfe_u32 v2, v0, 5, 1
v_add_u32 v3, 0, v2
v_xor_b32 v4, v3, v1
v_lshlrev_b32 v4, 4, v4
v_lshlrev_b32 v3, 1, v3
v_add_u32 v3, s25, v3
v_lshl_add_u32 v20, v3, 11, v4
v_add_u32 v3, 2, v2
v_xor_b32 v4, v3, v1
v_lshlrev_b32 v4, 4, v4
v_lshlrev_b32 v3, 1, v3
v_add_u32 v3, s25, v3
v_lshl_add_u32 v21, v3, 11, v4
v_add_u32 v3, 4, v2
v_xor_b32 v4, v3, v1
v_lshlrev_b32 v4, 4, v4
v_lshlrev_b32 v3, 1, v3
v_add_u32 v3, s25, v3
v_lshl_add_u32 v22, v3, 11, v4
v_add_u32 v3, 6, v2
v_xor_b32 v4, v3, v1
v_lshlrev_b32 v4, 4, v4
v_lshlrev_b32 v3, 1, v3
v_add_u32 v3, s25, v3
v_lshl_add_u32 v23, v3, 11, v4
v_add_u32 v3, 8, v2
v_xor_b32 v4, v3, v1
v_lshlrev_b32 v4, 4, v4
v_lshlrev_b32 v3, 1, v3
v_add_u32 v3, s25, v3
v_lshl_add_u32 v24, v3, 11, v4
v_add_u32 v3, 10, v2
v_xor_b32 v4, v3, v1
v_lshlrev_b32 v4, 4, v4
v_lshlrev_b32 v3, 1, v3
v_add_u32 v3, s25, v3
v_lshl_add_u32 v25, v3, 11, v4
v_add_u32 v3, 12, v2
v_xor_b32 v4, v3, v1
v_lshlrev_b32 v4, 4, v4
v_lshlrev_b32 v3, 1, v3
v_add_u32 v3, s25, v3
v_lshl_add_u32 v26, v3, 11, v4
v_add_u32 v3, 14, v2
v_xor_b32 v4, v3, v1
v_lshlrev_b32 v4, 4, v4
v_lshlrev_b32 v3, 1, v3
v_add_u32 v3, s25, v3
v_lshl_add_u32 v27, v3, 11, v4
v_and_b32 v1, 15, v0
v_bfe_u32 v2, v0, 4, 2
v_lshrrev_b32 v3, 6, v0
v_lshlrev_b32 v3, 15, v3
v_lshl_add_u32 v3, v1, 9, v3
v_add_u32 v4, 0, v2
v_xor_b32 v4, v4, v1
v_lshl_add_u32 v28, v4, 4, v3
v_add_u32 v4, 4, v2
v_xor_b32 v4, v4, v1
v_lshl_add_u32 v29, v4, 4, v3
v_add_u32 v4, 8, v2
v_xor_b32 v4, v4, v1
v_lshl_add_u32 v30, v4, 4, v3
v_add_u32 v4, 12, v2
v_xor_b32 v4, v4, v1
v_lshl_add_u32 v31, v4, 4, v3
s_lshl_b32 s26, s49, 15
s_barrier
s_mov_b32 s27, 0
s_add_u32 m0, s26, 0
s_nop 0
buffer_load_dwordx4 v20, s[16:19], s27 offen nt lds
s_add_u32 m0, s26, 1024
s_nop 0
buffer_load_dwordx4 v21, s[16:19], s27 offen nt lds
s_add_u32 m0, s26, 2048
s_nop 0
buffer_load_dwordx4 v22, s[16:19], s27 offen nt lds
s_add_u32 m0, s26, 3072
s_nop 0
buffer_load_dwordx4 v23, s[16:19], s27 offen nt lds
s_add_u32 m0, s26, 4096
s_nop 0
buffer_load_dwordx4 v24, s[16:19], s27 offen nt lds
s_add_u32 m0, s26, 5120
s_nop 0
buffer_load_dwordx4 v25, s[16:19], s27 offen nt lds
s_add_u32 m0, s26, 6144
s_nop 0
buffer_load_dwordx4 v26, s[16:19], s27 offen nt lds
s_add_u32 m0, s26, 7168
s_nop 0
buffer_load_dwordx4 v27, s[16:19], s27 offen nt lds
s_mov_b32 s27, 2048
s_add_u32 m0, s26, 8192
s_nop 0
buffer_load_dwordx4 v20, s[16:19], s27 offen nt lds
s_add_u32 m0, s26, 9216
s_nop 0
buffer_load_dwordx4 v21, s[16:19], s27 offen nt lds
s_add_u32 m0, s26, 10240
s_nop 0
buffer_load_dwordx4 v22, s[16:19], s27 offen nt lds
s_add_u32 m0, s26, 11264
s_nop 0
buffer_load_dwordx4 v23, s[16:19], s27 offen nt lds
s_add_u32 m0, s26, 12288
s_nop 0
buffer_load_dwordx4 v24, s[16:19], s27 offen nt lds
s_add_u32 m0, s26, 13312
s_nop 0
buffer_load_dwordx4 v25, s[16:19], s27 offen nt lds
s_add_u32 m0, s26, 14336
s_nop 0
buffer_load_dwordx4 v26, s[16:19], s27 offen nt lds
s_add_u32 m0, s26, 15360
s_nop 0
buffer_load_dwordx4 v27, s[16:19], s27 offen nt lds
s_mov_b32 s27, 512
s_add_u32 m0, s26, 16384
s_nop 0
buffer_load_dwordx4 v20, s[16:19], s27 offen nt lds
s_add_u32 m0, s26, 17408
s_nop 0
buffer_load_dwordx4 v21, s[16:19], s27 offen nt lds
s_add_u32 m0, s26, 18432
s_nop 0
buffer_load_dwordx4 v22, s[16:19], s27 offen nt lds
s_add_u32 m0, s26, 19456
s_nop 0
buffer_load_dwordx4 v23, s[16:19], s27 offen nt lds
s_add_u32 m0, s26, 20480
s_nop 0
buffer_load_dwordx4 v24, s[16:19], s27 offen nt lds
s_add_u32 m0, s26, 21504
s_nop 0
buffer_load_dwordx4 v25, s[16:19], s27 offen nt lds
s_add_u32 m0, s26, 22528
s_nop 0
buffer_load_dwordx4 v26, s[16:19], s27 offen nt lds
s_add_u32 m0, s26, 23552
s_nop 0
buffer_load_dwordx4 v27, s[16:19], s27 offen nt lds
s_mov_b32 s27, 2560
s_add_u32 m0, s26, 24576
s_nop 0
buffer_load_dwordx4 v20, s[16:19], s27 offen nt lds
s_add_u32 m0, s26, 25600
s_nop 0
buffer_load_dwordx4 v21, s[16:19], s27 offen nt lds
s_add_u32 m0, s26, 26624
s_nop 0
buffer_load_dwordx4 v22, s[16:19], s27 offen nt lds
s_add_u32 m0, s26, 27648
s_nop 0
buffer_load_dwordx4 v23, s[16:19], s27 offen nt lds
s_add_u32 m0, s26, 28672
s_nop 0
buffer_load_dwordx4 v24, s[16:19], s27 offen nt lds
s_add_u32 m0, s26, 29696
s_nop 0
buffer_load_dwordx4 v25, s[16:19], s27 offen nt lds
s_add_u32 m0, s26, 30720
s_nop 0
buffer_load_dwordx4 v26, s[16:19], s27 offen nt lds
s_add_u32 m0, s26, 31744
s_nop 0
buffer_load_dwordx4 v27, s[16:19], s27 offen nt lds
s_waitcnt vmcnt(16)
ds_read_b128 a[0:3], v28 offset:0
ds_read_b128 a[4:7], v28 offset:8192
ds_read_b128 a[8:11], v29 offset:0
ds_read_b128 a[12:15], v29 offset:8192
ds_read_b128 a[16:19], v30 offset:0
ds_read_b128 a[20:23], v30 offset:8192
ds_read_b128 a[24:27], v31 offset:0
ds_read_b128 a[28:31], v31 offset:8192
s_waitcnt lgkmcnt(0)
ds_read_b128 a[32:35], v28 offset:256
ds_read_b128 a[36:39], v28 offset:8448
ds_read_b128 a[40:43], v29 offset:256
ds_read_b128 a[44:47], v29 offset:8448
ds_read_b128 a[48:51], v30 offset:256
ds_read_b128 a[52:55], v30 offset:8448
ds_read_b128 a[56:59], v31 offset:256
ds_read_b128 a[60:63], v31 offset:8448
s_waitcnt lgkmcnt(0)
s_mov_b32 s27, 1024
s_add_u32 m0, s26, 0
s_nop 0
buffer_load_dwordx4 v20, s[16:19], s27 offen nt lds
s_add_u32 m0, s26, 1024
s_nop 0
buffer_load_dwordx4 v21, s[16:19], s27 offen nt lds
s_add_u32 m0, s26, 2048
s_nop 0
buffer_load_dwordx4 v22, s[16:19], s27 offen nt lds
s_add_u32 m0, s26, 3072
s_nop 0
buffer_load_dwordx4 v23, s[16:19], s27 offen nt lds
s_add_u32 m0, s26, 4096
s_nop 0
buffer_load_dwordx4 v24, s[16:19], s27 offen nt lds
s_add_u32 m0, s26, 5120
s_nop 0
buffer_load_dwordx4 v25, s[16:19], s27 offen nt lds
s_add_u32 m0, s26, 6144
s_nop 0
buffer_load_dwordx4 v26, s[16:19], s27 offen nt lds
s_add_u32 m0, s26, 7168
s_nop 0
buffer_load_dwordx4 v27, s[16:19], s27 offen nt lds
s_mov_b32 s27, 3072
s_add_u32 m0, s26, 8192
s_nop 0
buffer_load_dwordx4 v20, s[16:19], s27 offen nt lds
s_add_u32 m0, s26, 9216
s_nop 0
buffer_load_dwordx4 v21, s[16:19], s27 offen nt lds
s_add_u32 m0, s26, 10240
s_nop 0
buffer_load_dwordx4 v22, s[16:19], s27 offen nt lds
s_add_u32 m0, s26, 11264
s_nop 0
buffer_load_dwordx4 v23, s[16:19], s27 offen nt lds
s_add_u32 m0, s26, 12288
s_nop 0
buffer_load_dwordx4 v24, s[16:19], s27 offen nt lds
s_add_u32 m0, s26, 13312
s_nop 0
buffer_load_dwordx4 v25, s[16:19], s27 offen nt lds
s_add_u32 m0, s26, 14336
s_nop 0
buffer_load_dwordx4 v26, s[16:19], s27 offen nt lds
s_add_u32 m0, s26, 15360
s_nop 0
buffer_load_dwordx4 v27, s[16:19], s27 offen nt lds
s_waitcnt vmcnt(16)
ds_read_b128 a[64:67], v28 offset:16384
ds_read_b128 a[68:71], v28 offset:24576
ds_read_b128 a[72:75], v29 offset:16384
ds_read_b128 a[76:79], v29 offset:24576
ds_read_b128 a[80:83], v30 offset:16384
ds_read_b128 a[84:87], v30 offset:24576
ds_read_b128 a[88:91], v31 offset:16384
ds_read_b128 a[92:95], v31 offset:24576
s_waitcnt lgkmcnt(0)
ds_read_b128 a[96:99], v28 offset:16640
ds_read_b128 a[100:103], v28 offset:24832
ds_read_b128 a[104:107], v29 offset:16640
ds_read_b128 a[108:111], v29 offset:24832
ds_read_b128 a[112:115], v30 offset:16640
ds_read_b128 a[116:119], v30 offset:24832
ds_read_b128 a[120:123], v31 offset:16640
ds_read_b128 a[124:127], v31 offset:24832
s_waitcnt lgkmcnt(0)
s_mov_b32 s27, 1536
s_add_u32 m0, s26, 16384
s_nop 0
buffer_load_dwordx4 v20, s[16:19], s27 offen nt lds
s_add_u32 m0, s26, 17408
s_nop 0
buffer_load_dwordx4 v21, s[16:19], s27 offen nt lds
s_add_u32 m0, s26, 18432
s_nop 0
buffer_load_dwordx4 v22, s[16:19], s27 offen nt lds
s_add_u32 m0, s26, 19456
s_nop 0
buffer_load_dwordx4 v23, s[16:19], s27 offen nt lds
s_add_u32 m0, s26, 20480
s_nop 0
buffer_load_dwordx4 v24, s[16:19], s27 offen nt lds
s_add_u32 m0, s26, 21504
s_nop 0
buffer_load_dwordx4 v25, s[16:19], s27 offen nt lds
s_add_u32 m0, s26, 22528
s_nop 0
buffer_load_dwordx4 v26, s[16:19], s27 offen nt lds
s_add_u32 m0, s26, 23552
s_nop 0
buffer_load_dwordx4 v27, s[16:19], s27 offen nt lds
s_mov_b32 s27, 3584
s_add_u32 m0, s26, 24576
s_nop 0
buffer_load_dwordx4 v20, s[16:19], s27 offen nt lds
s_add_u32 m0, s26, 25600
s_nop 0
buffer_load_dwordx4 v21, s[16:19], s27 offen nt lds
s_add_u32 m0, s26, 26624
s_nop 0
buffer_load_dwordx4 v22, s[16:19], s27 offen nt lds
s_add_u32 m0, s26, 27648
s_nop 0
buffer_load_dwordx4 v23, s[16:19], s27 offen nt lds
s_add_u32 m0, s26, 28672
s_nop 0
buffer_load_dwordx4 v24, s[16:19], s27 offen nt lds
s_add_u32 m0, s26, 29696
s_nop 0
buffer_load_dwordx4 v25, s[16:19], s27 offen nt lds
s_add_u32 m0, s26, 30720
s_nop 0
buffer_load_dwordx4 v26, s[16:19], s27 offen nt lds
s_add_u32 m0, s26, 31744
s_nop 0
buffer_load_dwordx4 v27, s[16:19], s27 offen nt lds
s_waitcnt vmcnt(16)
ds_read_b128 a[128:131], v28 offset:0
ds_read_b128 a[132:135], v28 offset:8192
ds_read_b128 a[136:139], v29 offset:0
ds_read_b128 a[140:143], v29 offset:8192
ds_read_b128 a[144:147], v30 offset:0
ds_read_b128 a[148:151], v30 offset:8192
ds_read_b128 a[152:155], v31 offset:0
ds_read_b128 a[156:159], v31 offset:8192
s_waitcnt lgkmcnt(0)
ds_read_b128 a[160:163], v28 offset:256
ds_read_b128 a[164:167], v28 offset:8448
ds_read_b128 a[168:171], v29 offset:256
ds_read_b128 a[172:175], v29 offset:8448
ds_read_b128 a[176:179], v30 offset:256
ds_read_b128 a[180:183], v30 offset:8448
ds_read_b128 a[184:187], v31 offset:256
ds_read_b128 a[188:191], v31 offset:8448
s_waitcnt lgkmcnt(0)
s_waitcnt vmcnt(0)
ds_read_b128 a[192:195], v28 offset:16384
ds_read_b128 a[196:199], v28 offset:24576
ds_read_b128 a[200:203], v29 offset:16384
ds_read_b128 a[204:207], v29 offset:24576
ds_read_b128 a[208:211], v30 offset:16384
ds_read_b128 a[212:215], v30 offset:24576
ds_read_b128 a[216:219], v31 offset:16384
ds_read_b128 a[220:223], v31 offset:24576
s_waitcnt lgkmcnt(0)
ds_read_b128 a[224:227], v28 offset:16640
ds_read_b128 a[228:231], v28 offset:24832
ds_read_b128 a[232:235], v29 offset:16640
ds_read_b128 a[236:239], v29 offset:24832
ds_read_b128 a[240:243], v30 offset:16640
ds_read_b128 a[244:247], v30 offset:24832
ds_read_b128 a[248:251], v31 offset:16640
ds_read_b128 a[252:255], v31 offset:24832
s_waitcnt lgkmcnt(0)
v_lshlrev_b32 v128, 16, v132
v_and_b32 v129, 0xffff0000, v132
s_mov_b32 s48, 0x5902000
s_lshl_b32 s50, s47, 16
s_add_u32 s50, s50, 0x4400000
s_mov_b32 s8, s100
s_and_b32 s9, s101, 0xffff
s_mov_b32 s10, 0x10000000
s_mov_b32 s11, 0x00020000
s_mov_b32 s16, s96
s_and_b32 s17, s97, 0xffff
s_mov_b32 s18, 0x1000000
s_mov_b32 s19, 0x00020000
s_mov_b32 s32, s64
s_and_b32 s33, s65, 0xffff
s_mov_b32 s34, 0x400000
s_mov_b32 s35, 0x00020000
s_lshl_b32 s47, s47, 8
s_lshl_b32 s21, s49, 12
v_and_b32 v1, 63, v0
v_and_b32 v2, 15, v0
v_bfe_u32 v3, v0, 4, 2
v_lshrrev_b32 v4, 6, v0
v_lshlrev_b32 v5, 4, v1
v_lshl_add_u32 v5, v4, 12, v5
v_add_u32 v8, 0, v5
v_add_u32 v9, 1024, v5
v_add_u32 v10, 2048, v5
v_add_u32 v11, 3072, v5
v_lshlrev_b32 v5, 4, v2
v_lshl_add_u32 v5, v3, 9, v5
v_xor_b32 v12, s47, v5
v_xor_b32 v13, 0x100, v12
v_add_u32 v16, 0x10000, v12
v_add_u32 v17, 0x10000, v13
s_mov_b32 s23, 64
s_mov_b32 s52, 0
v_mov_b32 v4, 0
s_mov_b32 s22, 0
s_sub_u32 s61, s23, 1
s_mov_b32 s24, s22
s_add_u32 s51, s24, 1
s_min_u32 s51, s51, s61
s_lshl_b32 s51, s51, 7
s_add_u32 s51, s51, s48
L_gw_485:
buffer_load_dword v87, v4, s[12:15], s51 offen sc1
s_add_u32 s36, s36, 1
s_cmp_gt_u32 s36, 0x100000
s_cbranch_scc1 chain_kernel_wend
s_waitcnt vmcnt(0)
v_readfirstlane_b32 s30, v87
s_cmp_lt_u32 s30, 16
s_cbranch_scc0 L_rgo_484
s_sleep 1
s_branch L_gw_485
L_rgo_484:
s_add_u32 s51, s24, 1
s_min_u32 s51, s51, s61
s_lshl_b32 s51, s51, 7
s_add_u32 s51, s51, s48
buffer_load_dword v87, v4, s[12:15], s51 offen sc1
s_mov_b32 s37, 0
s_mov_b32 s7, 0
v_mov_b32 v88, 0
v_mov_b32 v89, 0
v_mov_b32 v90, 0
v_mov_b32 v91, 0
v_mov_b32 v92, 0
v_mov_b32 v93, 0
v_mov_b32 v94, 0
v_mov_b32 v95, 0
s_lshl_b32 s53, s24, 17
s_add_u32 s53, s53, s50
s_mov_b32 s20, s53
s_mov_b32 s39, 0x7ff00000
s_mov_b32 s42, 0x7ff00000
s_mov_b32 s43, 0x7ff00000
s_barrier
s_add_u32 m0, s21, 0
s_nop 0
buffer_load_dwordx4 v8, s[8:11], s20 offen lds
s_add_u32 m0, s21, 1024
s_nop 0
buffer_load_dwordx4 v9, s[8:11], s20 offen lds
s_add_u32 m0, s21, 2048
s_nop 0
buffer_load_dwordx4 v10, s[8:11], s20 offen lds
s_add_u32 m0, s21, 3072
s_nop 0
buffer_load_dwordx4 v11, s[8:11], s20 offen lds
s_add_u32 s20, s20, 16384
s_add_u32 m0, s21, 16384
s_nop 0
buffer_load_dwordx4 v8, s[8:11], s20 offen lds
s_add_u32 m0, s21, 17408
s_nop 0
buffer_load_dwordx4 v9, s[8:11], s20 offen lds
s_add_u32 m0, s21, 18432
s_nop 0
buffer_load_dwordx4 v10, s[8:11], s20 offen lds
s_add_u32 m0, s21, 19456
s_nop 0
buffer_load_dwordx4 v11, s[8:11], s20 offen lds
s_add_u32 s20, s20, 16384
s_add_u32 m0, s21, 32768
s_nop 0
buffer_load_dwordx4 v8, s[8:11], s20 offen lds
s_add_u32 m0, s21, 33792
s_nop 0
buffer_load_dwordx4 v9, s[8:11], s20 offen lds
s_add_u32 m0, s21, 34816
s_nop 0
buffer_load_dwordx4 v10, s[8:11], s20 offen lds
s_add_u32 m0, s21, 35840
s_nop 0
buffer_load_dwordx4 v11, s[8:11], s20 offen lds
s_add_u32 s20, s20, 16384
s_add_u32 m0, s21, 49152
s_nop 0
buffer_load_dwordx4 v8, s[8:11], s20 offen lds
s_add_u32 m0, s21, 50176
s_nop 0
buffer_load_dwordx4 v9, s[8:11], s20 offen lds
s_add_u32 m0, s21, 51200
s_nop 0
buffer_load_dwordx4 v10, s[8:11], s20 offen lds
s_add_u32 m0, s21, 52224
s_nop 0
buffer_load_dwordx4 v11, s[8:11], s20 offen lds
L_gw_487:
buffer_load_dword v87, v4, s[12:15], s51 offen sc1
s_add_u32 s36, s36, 1
s_cmp_gt_u32 s36, 0x100000
s_cbranch_scc1 chain_kernel_wend
s_waitcnt vmcnt(0)
v_readfirstlane_b32 s30, v87
s_cmp_lt_u32 s30, 16
s_cbranch_scc0 L_gok_486
s_sleep 1
s_branch L_gw_487
L_gok_486:
s_add_u32 s24, s24, 1
s_min_u32 s24, s24, s61
s_lshl_b32 s53, s24, 17
s_add_u32 s53, s53, s50
s_add_u32 s51, s24, 1
s_min_u32 s51, s51, s61
s_lshl_b32 s51, s51, 7
s_add_u32 s51, s51, s48
buffer_load_dword v87, v4, s[12:15], s51 offen sc1
s_mov_b32 s20, s53
s_add_u32 m0, s21, 65536
s_nop 0
buffer_load_dwordx4 v8, s[8:11], s20 offen lds
s_waitcnt vmcnt(0)
s_barrier
ds_read_b128 v[20:23], v12 offset:0
ds_read_b128 v[24:27], v13 offset:0
ds_read_b128 v[28:31], v12 offset:2048
ds_read_b128 v[32:35], v13 offset:2048
ds_read_b128 v[36:39], v12 offset:4096
ds_read_b128 v[40:43], v13 offset:4096
s_waitcnt lgkmcnt(4)
L_st_491:
v_mfma_f32_16x16x32_bf16 v[52:55], v[20:23], a[0:3], 0
ds_read_b128 v[44:47], v12 offset:6144
s_add_u32 m0, s21, 66560
v_mfma_f32_16x16x32_bf16 v[56:59], v[20:23], a[4:7], 0
buffer_load_dwordx4 v9, s[8:11], s20 offen lds
v_mfma_f32_16x16x32_bf16 v[60:63], v[24:27], a[0:3], 0
ds_read_b128 v[48:51], v13 offset:6144
s_sub_u32 s38, s22, 1
v_mfma_f32_16x16x32_bf16 v[64:67], v[24:27], a[4:7], 0
s_waitcnt lgkmcnt(4)
s_and_b32 s31, s38, 3
v_mfma_f32_16x16x32_bf16 v[52:55], v[28:31], a[8:11], v[52:55]
ds_read_b128 v[20:23], v12 offset:8192
s_lshl_b32 s31, s31, 11
v_mfma_f32_16x16x32_bf16 v[56:59], v[28:31], a[12:15], v[56:59]
buffer_load_dword v132, v136, s[32:35], s42 offen offset:0
v_mfma_f32_16x16x32_bf16 v[60:63], v[32:35], a[8:11], v[60:63]
ds_read_b128 v[24:27], v13 offset:8192
v_mfma_f32_16x16x32_bf16 v[64:67], v[32:35], a[12:15], v[64:67]
s_waitcnt lgkmcnt(4)
s_bfe_u32 s38, s38, 0x10002
v_mfma_f32_16x16x32_bf16 v[52:55], v[36:39], a[16:19], v[52:55]
ds_read_b128 v[28:31], v12 offset:10240
s_add_u32 m0, s21, 67584
v_mfma_f32_16x16x32_bf16 v[56:59], v[36:39], a[20:23], v[56:59]
buffer_load_dwordx4 v10, s[8:11], s20 offen lds
v_mfma_f32_16x16x32_bf16 v[60:63], v[40:43], a[16:19], v[60:63]
ds_read_b128 v[32:35], v13 offset:10240
s_xor_b32 s38, s38, 1
v_mfma_f32_16x16x32_bf16 v[64:67], v[40:43], a[20:23], v[64:67]
s_waitcnt lgkmcnt(4)
s_cmp_eq_u32 s37, 0
s_cselect_b32 s31, 0x40000000, s31
s_cselect_b32 s38, 0, s38
v_mfma_f32_16x16x32_bf16 v[52:55], v[44:47], a[24:27], v[52:55]
ds_read_b128 v[36:39], v12 offset:12288
v_mfma_f32_16x16x32_bf16 v[56:59], v[44:47], a[28:31], v[56:59]
buffer_load_dword v133, v136, s[32:35], s42 offen offset:2048
v_mfma_f32_16x16x32_bf16 v[60:63], v[48:51], a[24:27], v[60:63]
ds_read_b128 v[40:43], v13 offset:12288
v_mfma_f32_16x16x32_bf16 v[64:67], v[48:51], a[28:31], v[64:67]
s_waitcnt lgkmcnt(4)
v_mfma_f32_16x16x32_bf16 v[52:55], v[20:23], a[32:35], v[52:55]
ds_read_b128 v[44:47], v12 offset:14336
s_add_u32 m0, s21, 68608
v_mfma_f32_16x16x32_bf16 v[56:59], v[20:23], a[36:39], v[56:59]
buffer_load_dwordx4 v11, s[8:11], s20 offen lds
v_mfma_f32_16x16x32_bf16 v[60:63], v[24:27], a[32:35], v[60:63]
ds_read_b128 v[48:51], v13 offset:14336
v_cvt_pk_bf16_f32 v104, v76, v80
v_mfma_f32_16x16x32_bf16 v[64:67], v[24:27], a[36:39], v[64:67]
s_waitcnt lgkmcnt(4)
v_mfma_f32_16x16x32_bf16 v[52:55], v[28:31], a[40:43], v[52:55]
s_waitcnt vmcnt(20)
s_barrier
ds_read_b128 v[20:23], v12 offset:16384
v_mfma_f32_16x16x32_bf16 v[56:59], v[28:31], a[44:47], v[56:59]
s_add_u32 s20, s20, 16384
v_cvt_pk_bf16_f32 v105, v77, v81
v_mfma_f32_16x16x32_bf16 v[60:63], v[32:35], a[40:43], v[60:63]
ds_read_b128 v[24:27], v13 offset:16384
v_cvt_pk_bf16_f32 v106, v78, v82
v_mfma_f32_16x16x32_bf16 v[64:67], v[32:35], a[44:47], v[64:67]
s_waitcnt lgkmcnt(4)
v_cvt_pk_bf16_f32 v107, v79, v83
v_mfma_f32_16x16x32_bf16 v[52:55], v[36:39], a[48:51], v[52:55]
ds_read_b128 v[28:31], v12 offset:18432
s_add_u32 m0, s21, 81920
v_mfma_f32_16x16x32_bf16 v[56:59], v[36:39], a[52:55], v[56:59]
buffer_load_dwordx4 v8, s[8:11], s20 offen lds
v_mfma_f32_16x16x32_bf16 v[60:63], v[40:43], a[48:51], v[60:63]
ds_read_b128 v[32:35], v13 offset:18432
v_mfma_f32_16x16x32_bf16 v[64:67], v[40:43], a[52:55], v[64:67]
s_waitcnt lgkmcnt(4)
v_and_or_b32 v104, v104, -2, s38
v_mfma_f32_16x16x32_bf16 v[52:55], v[44:47], a[56:59], v[52:55]
ds_read_b128 v[36:39], v12 offset:20480
v_and_or_b32 v105, v105, -2, s38
v_mfma_f32_16x16x32_bf16 v[56:59], v[44:47], a[60:63], v[56:59]
buffer_load_dword v134, v137, s[32:35], s42 offen offset:0
v_mfma_f32_16x16x32_bf16 v[60:63], v[48:51], a[56:59], v[60:63]
ds_read_b128 v[40:43], v13 offset:20480
v_and_or_b32 v106, v106, -2, s38
v_mfma_f32_16x16x32_bf16 v[64:67], v[48:51], a[60:63], v[64:67]
s_waitcnt lgkmcnt(4)
v_mfma_f32_16x16x32_bf16 v[52:55], v[20:23], a[64:67], v[52:55]
ds_read_b128 v[44:47], v12 offset:22528
s_add_u32 m0, s21, 82944
v_mfma_f32_16x16x32_bf16 v[56:59], v[20:23], a[68:71], v[56:59]
buffer_load_dwordx4 v9, s[8:11], s20 offen lds
v_mfma_f32_16x16x32_bf16 v[60:63], v[24:27], a[64:67], v[60:63]
ds_read_b128 v[48:51], v13 offset:22528
v_and_or_b32 v107, v107, -2, s38
v_mfma_f32_16x16x32_bf16 v[64:67], v[24:27], a[68:71], v[64:67]
s_waitcnt lgkmcnt(4)
s_add_u32 s29, s45, s31
v_mfma_f32_16x16x32_bf16 v[52:55], v[28:31], a[72:75], v[52:55]
ds_read_b128 v[20:23], v12 offset:24576
v_mfma_f32_16x16x32_bf16 v[56:59], v[28:31], a[76:79], v[56:59]
buffer_store_dwordx4 v[104:107], v112, s[12:15], s29 offen offset:0 sc1
v_mfma_f32_16x16x32_bf16 v[60:63], v[32:35], a[72:75], v[60:63]
ds_read_b128 v[24:27], v13 offset:24576
s_add_u32 s51, s24, 1
v_mfma_f32_16x16x32_bf16 v[64:67], v[32:35], a[76:79], v[64:67]
s_waitcnt lgkmcnt(4)
v_mfma_f32_16x16x32_bf16 v[52:55], v[36:39], a[80:83], v[52:55]
ds_read_b128 v[28:31], v12 offset:26624
s_add_u32 m0, s21, 83968
v_mfma_f32_16x16x32_bf16 v[56:59], v[36:39], a[84:87], v[56:59]
buffer_load_dwordx4 v10, s[8:11], s20 offen lds
v_mfma_f32_16x16x32_bf16 v[60:63], v[40:43], a[80:83], v[60:63]
ds_read_b128 v[32:35], v13 offset:26624
s_min_u32 s51, s51, s61
v_mfma_f32_16x16x32_bf16 v[64:67], v[40:43], a[84:87], v[64:67]
s_waitcnt lgkmcnt(4)
v_mfma_f32_16x16x32_bf16 v[52:55], v[44:47], a[88:91], v[52:55]
ds_read_b128 v[36:39], v12 offset:28672
s_lshl_b32 s51, s51, 7
v_mfma_f32_16x16x32_bf16 v[56:59], v[44:47], a[92:95], v[56:59]
buffer_load_dword v135, v137, s[32:35], s42 offen offset:2048
v_mfma_f32_16x16x32_bf16 v[60:63], v[48:51], a[88:91], v[60:63]
ds_read_b128 v[40:43], v13 offset:28672
v_mfma_f32_16x16x32_bf16 v[64:67], v[48:51], a[92:95], v[64:67]
s_waitcnt lgkmcnt(4)
s_add_u32 s51, s51, s48
v_mfma_f32_16x16x32_bf16 v[52:55], v[20:23], a[96:99], v[52:55]
ds_read_b128 v[44:47], v12 offset:30720
s_add_u32 m0, s21, 84992
v_mfma_f32_16x16x32_bf16 v[56:59], v[20:23], a[100:103], v[56:59]
buffer_load_dwordx4 v11, s[8:11], s20 offen lds
v_mfma_f32_16x16x32_bf16 v[60:63], v[24:27], a[96:99], v[60:63]
ds_read_b128 v[48:51], v13 offset:30720
s_waitcnt vmcnt(12)
v_xor_b32 v124, s7, v88
v_mfma_f32_16x16x32_bf16 v[64:67], v[24:27], a[100:103], v[64:67]
s_waitcnt lgkmcnt(4)
v_bitop3_b32 v124, v124, v89, s7 bitop3:0xf6
v_bitop3_b32 v124, v124, v90, s7 bitop3:0xf6
v_mfma_f32_16x16x32_bf16 v[52:55], v[28:31], a[104:107], v[52:55]
s_waitcnt vmcnt(22)
s_barrier
ds_read_b128 v[20:23], v12 offset:32768
v_mfma_f32_16x16x32_bf16 v[56:59], v[28:31], a[108:111], v[56:59]
s_add_u32 s20, s20, 16384
buffer_load_dword v87, v4, s[12:15], s51 offen sc1
v_mfma_f32_16x16x32_bf16 v[60:63], v[32:35], a[104:107], v[60:63]
ds_read_b128 v[24:27], v13 offset:32768
v_bitop3_b32 v124, v124, v91, s7 bitop3:0xf6
v_mfma_f32_16x16x32_bf16 v[64:67], v[32:35], a[108:111], v[64:67]
s_waitcnt lgkmcnt(4)
v_and_b32 v124, 1, v124
v_cmp_ne_u32 vcc, 0, v124
v_mfma_f32_16x16x32_bf16 v[52:55], v[36:39], a[112:115], v[52:55]
ds_read_b128 v[28:31], v12 offset:34816
s_add_u32 m0, s21, 98304
s_nop 0
v_mfma_f32_16x16x32_bf16 v[56:59], v[36:39], a[116:119], v[56:59]
buffer_load_dwordx4 v8, s[8:11], s20 offen lds
s_nop 0
v_mfma_f32_16x16x32_bf16 v[60:63], v[40:43], a[112:115], v[60:63]
ds_read_b128 v[32:35], v13 offset:34816
s_nop 0
v_mfma_f32_16x16x32_bf16 v[64:67], v[40:43], a[116:119], v[64:67]
s_waitcnt lgkmcnt(4)
s_cbranch_vccnz L_rbad_492
L_rok_493:
v_mfma_f32_16x16x32_bf16 v[52:55], v[44:47], a[120:123], v[52:55]
ds_read_b128 v[36:39], v12 offset:36864
v_lshlrev_b32 v124, 16, v88
v_and_b32 v125, 0xffff0000, v88
v_mfma_f32_16x16x32_bf16 v[56:59], v[44:47], a[124:127], v[56:59]
v_and_b32 v124, 0xfffe0000, v124
v_add_f32 v96, v116, v124
v_mfma_f32_16x16x32_bf16 v[60:63], v[48:51], a[120:123], v[60:63]
ds_read_b128 v[40:43], v13 offset:36864
v_add_f32 v97, v117, v125
v_lshlrev_b32 v124, 16, v89
v_mfma_f32_16x16x32_bf16 v[64:67], v[48:51], a[124:127], v[64:67]
s_waitcnt lgkmcnt(4)
v_and_b32 v125, 0xffff0000, v89
v_mfma_f32_16x16x32_bf16 v[52:55], v[20:23], a[128:131], v[52:55]
ds_read_b128 v[44:47], v12 offset:38912
s_add_u32 m0, s21, 99328
v_and_b32 v124, 0xfffe0000, v124
v_mfma_f32_16x16x32_bf16 v[56:59], v[20:23], a[132:135], v[56:59]
buffer_load_dwordx4 v9, s[8:11], s20 offen lds
v_add_f32 v98, v118, v124
v_mfma_f32_16x16x32_bf16 v[60:63], v[24:27], a[128:131], v[60:63]
ds_read_b128 v[48:51], v13 offset:38912
v_add_f32 v99, v119, v125
v_lshlrev_b32 v124, 16, v90
v_mfma_f32_16x16x32_bf16 v[64:67], v[24:27], a[132:135], v[64:67]
s_waitcnt lgkmcnt(4)
v_and_b32 v125, 0xffff0000, v90
v_mfma_f32_16x16x32_bf16 v[52:55], v[28:31], a[136:139], v[52:55]
ds_read_b128 v[20:23], v12 offset:40960
v_and_b32 v124, 0xfffe0000, v124
v_add_f32 v100, v120, v124
v_mfma_f32_16x16x32_bf16 v[56:59], v[28:31], a[140:143], v[56:59]
v_add_f32 v101, v121, v125
v_lshlrev_b32 v124, 16, v91
v_mfma_f32_16x16x32_bf16 v[60:63], v[32:35], a[136:139], v[60:63]
ds_read_b128 v[24:27], v13 offset:40960
v_and_b32 v125, 0xffff0000, v91
v_and_b32 v124, 0xfffe0000, v124
v_mfma_f32_16x16x32_bf16 v[64:67], v[32:35], a[140:143], v[64:67]
s_waitcnt lgkmcnt(4)
v_add_f32 v102, v122, v124
v_add_f32 v103, v123, v125
v_mfma_f32_16x16x32_bf16 v[52:55], v[36:39], a[144:147], v[52:55]
ds_read_b128 v[28:31], v12 offset:43008
s_add_u32 m0, s21, 100352
v_mfma_f32_16x16x32_bf16 v[56:59], v[36:39], a[148:151], v[56:59]
buffer_load_dwordx4 v10, s[8:11], s20 offen lds
v_mfma_f32_16x16x32_bf16 v[60:63], v[40:43], a[144:147], v[60:63]
ds_read_b128 v[32:35], v13 offset:43008
v_mfma_f32_16x16x32_bf16 v[64:67], v[40:43], a[148:151], v[64:67]
s_waitcnt lgkmcnt(4)
v_mfma_f32_16x16x32_bf16 v[52:55], v[44:47], a[152:155], v[52:55]
ds_read_b128 v[36:39], v12 offset:45056
s_waitcnt vmcnt(5)
v_lshlrev_b32 v130, 16, v132
v_mfma_f32_16x16x32_bf16 v[56:59], v[44:47], a[156:159], v[56:59]
v_and_b32 v131, 0xffff0000, v132
v_mfma_f32_16x16x32_bf16 v[60:63], v[48:51], a[152:155], v[60:63]
ds_read_b128 v[40:43], v13 offset:45056
v_mul_f32 v130, v130, v128
v_mul_f32 v131, v131, v129
v_mfma_f32_16x16x32_bf16 v[64:67], v[48:51], a[156:159], v[64:67]
s_waitcnt lgkmcnt(4)
v_cvt_pk_bf16_f32 v130, 0, v130
v_mfma_f32_16x16x32_bf16 v[52:55], v[20:23], a[160:163], v[52:55]
ds_read_b128 v[44:47], v12 offset:47104
s_add_u32 m0, s21, 101376
v_mfma_f32_16x16x32_bf16 v[56:59], v[20:23], a[164:167], v[56:59]
buffer_load_dwordx4 v11, s[8:11], s20 offen lds
v_cvt_pk_bf16_f32 v131, 0, v131
v_mfma_f32_16x16x32_bf16 v[60:63], v[24:27], a[160:163], v[60:63]
ds_read_b128 v[48:51], v13 offset:47104
v_add_f32 v96, v96, v130
v_mfma_f32_16x16x32_bf16 v[64:67], v[24:27], a[164:167], v[64:67]
s_waitcnt lgkmcnt(4)
v_add_f32 v97, v97, v131
v_mfma_f32_16x16x32_bf16 v[52:55], v[28:31], a[168:171], v[52:55]
s_waitcnt vmcnt(19)
s_barrier
ds_read_b128 v[20:23], v12 offset:49152
v_mfma_f32_16x16x32_bf16 v[56:59], v[28:31], a[172:175], v[56:59]
s_add_u32 s20, s20, 16384
buffer_store_dwordx2 v[96:97], v140, s[16:19], s43 offen
v_mfma_f32_16x16x32_bf16 v[60:63], v[32:35], a[168:171], v[60:63]
ds_read_b128 v[24:27], v13 offset:49152
v_lshlrev_b32 v130, 16, v133
v_and_b32 v131, 0xffff0000, v133
v_mfma_f32_16x16x32_bf16 v[64:67], v[32:35], a[172:175], v[64:67]
s_waitcnt lgkmcnt(4)
v_mul_f32 v130, v130, v128
v_mfma_f32_16x16x32_bf16 v[52:55], v[36:39], a[176:179], v[52:55]
ds_read_b128 v[28:31], v12 offset:51200
s_add_u32 m0, s21, 114688
v_mul_f32 v131, v131, v129
v_mfma_f32_16x16x32_bf16 v[56:59], v[36:39], a[180:183], v[56:59]
buffer_load_dwordx4 v8, s[8:11], s20 offen lds
v_mfma_f32_16x16x32_bf16 v[60:63], v[40:43], a[176:179], v[60:63]
ds_read_b128 v[32:35], v13 offset:51200
v_cvt_pk_bf16_f32 v130, 0, v130
v_mfma_f32_16x16x32_bf16 v[64:67], v[40:43], a[180:183], v[64:67]
s_waitcnt lgkmcnt(4)
v_cvt_pk_bf16_f32 v131, 0, v131
v_add_f32 v98, v98, v130
v_mfma_f32_16x16x32_bf16 v[52:55], v[44:47], a[184:187], v[52:55]
ds_read_b128 v[36:39], v12 offset:53248
v_add_f32 v99, v99, v131
v_mfma_f32_16x16x32_bf16 v[56:59], v[44:47], a[188:191], v[56:59]
buffer_store_dwordx2 v[98:99], v141, s[16:19], s43 offen
v_lshlrev_b32 v130, 16, v134
v_mfma_f32_16x16x32_bf16 v[60:63], v[48:51], a[184:187], v[60:63]
ds_read_b128 v[40:43], v13 offset:53248
v_and_b32 v131, 0xffff0000, v134
v_mfma_f32_16x16x32_bf16 v[64:67], v[48:51], a[188:191], v[64:67]
s_waitcnt lgkmcnt(4)
v_mul_f32 v130, v130, v128
v_mfma_f32_16x16x32_bf16 v[52:55], v[20:23], a[192:195], v[52:55]
ds_read_b128 v[44:47], v12 offset:55296
s_add_u32 m0, s21, 115712
v_mul_f32 v131, v131, v129
v_mfma_f32_16x16x32_bf16 v[56:59], v[20:23], a[196:199], v[56:59]
buffer_load_dwordx4 v9, s[8:11], s20 offen lds
v_mfma_f32_16x16x32_bf16 v[60:63], v[24:27], a[192:195], v[60:63]
ds_read_b128 v[48:51], v13 offset:55296
v_cvt_pk_bf16_f32 v130, 0, v130
v_cvt_pk_bf16_f32 v131, 0, v131
v_mfma_f32_16x16x32_bf16 v[64:67], v[24:27], a[196:199], v[64:67]
s_waitcnt lgkmcnt(4)
v_add_f32 v100, v100, v130
v_mfma_f32_16x16x32_bf16 v[52:55], v[28:31], a[200:203], v[52:55]
ds_read_b128 v[20:23], v12 offset:57344
v_add_f32 v101, v101, v131
v_mfma_f32_16x16x32_bf16 v[56:59], v[28:31], a[204:207], v[56:59]
buffer_store_dwordx2 v[100:101], v142, s[16:19], s43 offen
v_lshlrev_b32 v130, 16, v135
v_mfma_f32_16x16x32_bf16 v[60:63], v[32:35], a[200:203], v[60:63]
ds_read_b128 v[24:27], v13 offset:57344
s_add_u32 s24, s24, 1
v_and_b32 v131, 0xffff0000, v135
v_mfma_f32_16x16x32_bf16 v[64:67], v[32:35], a[204:207], v[64:67]
s_waitcnt lgkmcnt(4)
s_min_u32 s24, s24, s61
v_mul_f32 v130, v130, v128
v_mfma_f32_16x16x32_bf16 v[52:55], v[36:39], a[208:211], v[52:55]
ds_read_b128 v[28:31], v12 offset:59392
s_add_u32 m0, s21, 116736
s_lshl_b32 s53, s24, 17
v_mul_f32 v131, v131, v129
v_mfma_f32_16x16x32_bf16 v[56:59], v[36:39], a[212:215], v[56:59]
buffer_load_dwordx4 v10, s[8:11], s20 offen lds
v_cvt_pk_bf16_f32 v130, 0, v130
v_mfma_f32_16x16x32_bf16 v[60:63], v[40:43], a[208:211], v[60:63]
ds_read_b128 v[32:35], v13 offset:59392
s_add_u32 s53, s53, s50
v_cvt_pk_bf16_f32 v131, 0, v131
v_mfma_f32_16x16x32_bf16 v[64:67], v[40:43], a[212:215], v[64:67]
s_waitcnt lgkmcnt(4)
s_waitcnt vmcnt(10)
v_add_f32 v102, v102, v130
v_mfma_f32_16x16x32_bf16 v[52:55], v[44:47], a[216:219], v[52:55]
ds_read_b128 v[36:39], v12 offset:61440
v_readfirstlane_b32 s30, v87
v_add_f32 v103, v103, v131
v_mfma_f32_16x16x32_bf16 v[56:59], v[44:47], a[220:223], v[56:59]
s_nop 0
buffer_store_dwordx2 v[102:103], v143, s[16:19], s43 offen
v_mfma_f32_16x16x32_bf16 v[60:63], v[48:51], a[216:219], v[60:63]
ds_read_b128 v[40:43], v13 offset:61440
s_nop 0
v_mfma_f32_16x16x32_bf16 v[64:67], v[48:51], a[220:223], v[64:67]
s_waitcnt lgkmcnt(4)
s_cmp_lt_u32 s30, 16
s_cbranch_scc1 L_gw_495
L_gok_494:
v_mfma_f32_16x16x32_bf16 v[52:55], v[20:23], a[224:227], v[52:55]
ds_read_b128 v[44:47], v12 offset:63488
s_add_u32 m0, s21, 117760
v_mfma_f32_16x16x32_bf16 v[56:59], v[20:23], a[228:231], v[56:59]
buffer_load_dwordx4 v11, s[8:11], s20 offen lds
v_mfma_f32_16x16x32_bf16 v[60:63], v[24:27], a[224:227], v[60:63]
ds_read_b128 v[48:51], v13 offset:63488
v_mov_b32 v116, v68
v_mov_b32 v117, v72
v_mfma_f32_16x16x32_bf16 v[64:67], v[24:27], a[228:231], v[64:67]
s_waitcnt lgkmcnt(4)
v_mov_b32 v118, v69
v_mov_b32 v119, v73
v_mfma_f32_16x16x32_bf16 v[52:55], v[28:31], a[232:235], v[52:55]
s_waitcnt vmcnt(20)
s_barrier
ds_read_b128 v[20:23], v16 offset:0
v_mfma_f32_16x16x32_bf16 v[56:59], v[28:31], a[236:239], v[56:59]
s_mov_b32 s20, s53
v_mov_b32 v120, v70
v_mov_b32 v121, v74
v_mfma_f32_16x16x32_bf16 v[60:63], v[32:35], a[232:235], v[60:63]
ds_read_b128 v[24:27], v17 offset:0
v_mov_b32 v122, v71
v_mfma_f32_16x16x32_bf16 v[64:67], v[32:35], a[236:239], v[64:67]
s_waitcnt lgkmcnt(4)
v_mov_b32 v123, v75
s_mov_b32 s7, s38
v_mfma_f32_16x16x32_bf16 v[52:55], v[36:39], a[240:243], v[52:55]
ds_read_b128 v[28:31], v16 offset:2048
s_add_u32 m0, s21, 0
s_add_u32 s39, s44, s31
v_mfma_f32_16x16x32_bf16 v[56:59], v[36:39], a[244:247], v[56:59]
buffer_load_dwordx4 v8, s[8:11], s20 offen lds
s_sub_u32 s43, s22, 1
v_mfma_f32_16x16x32_bf16 v[60:63], v[40:43], a[240:243], v[60:63]
ds_read_b128 v[32:35], v17 offset:2048
s_lshl_b32 s42, s43, 16
v_mfma_f32_16x16x32_bf16 v[64:67], v[40:43], a[244:247], v[64:67]
s_waitcnt lgkmcnt(4)
s_lshl_b32 s43, s43, 18
s_cmp_eq_u32 s37, 0
s_cselect_b32 s42, 0x7ff00000, s42
s_cselect_b32 s43, 0x7ff00000, s43
v_mfma_f32_16x16x32_bf16 v[52:55], v[44:47], a[248:251], v[52:55]
ds_read_b128 v[36:39], v16 offset:4096
v_mfma_f32_16x16x32_bf16 v[56:59], v[44:47], a[252:255], v[56:59]
buffer_load_dwordx4 v[88:91], v112, s[12:15], s39 offen offset:0 sc1
v_mfma_f32_16x16x32_bf16 v[60:63], v[48:51], a[248:251], v[60:63]
ds_read_b128 v[40:43], v17 offset:4096
s_mov_b32 s37, 1
v_mfma_f32_16x16x32_bf16 v[64:67], v[48:51], a[252:255], v[64:67]
s_waitcnt lgkmcnt(4)
s_add_u32 s22, s22, 1
s_cmp_ge_u32 s22, s23
s_cbranch_scc1 L_fl0_488
v_mfma_f32_16x16x32_bf16 v[68:71], v[20:23], a[0:3], 0
ds_read_b128 v[44:47], v16 offset:6144
s_add_u32 m0, s21, 1024
v_mfma_f32_16x16x32_bf16 v[72:75], v[20:23], a[4:7], 0
buffer_load_dwordx4 v9, s[8:11], s20 offen lds
v_mfma_f32_16x16x32_bf16 v[76:79], v[24:27], a[0:3], 0
ds_read_b128 v[48:51], v17 offset:6144
s_sub_u32 s38, s22, 1
v_mfma_f32_16x16x32_bf16 v[80:83], v[24:27], a[4:7], 0
s_waitcnt lgkmcnt(4)
s_and_b32 s31, s38, 3
v_mfma_f32_16x16x32_bf16 v[68:71], v[28:31], a[8:11], v[68:71]
ds_read_b128 v[20:23], v16 offset:8192
s_lshl_b32 s31, s31, 11
v_mfma_f32_16x16x32_bf16 v[72:75], v[28:31], a[12:15], v[72:75]
buffer_load_dword v132, v136, s[32:35], s42 offen offset:0
v_mfma_f32_16x16x32_bf16 v[76:79], v[32:35], a[8:11], v[76:79]
ds_read_b128 v[24:27], v17 offset:8192
v_mfma_f32_16x16x32_bf16 v[80:83], v[32:35], a[12:15], v[80:83]
s_waitcnt lgkmcnt(4)
s_bfe_u32 s38, s38, 0x10002
v_mfma_f32_16x16x32_bf16 v[68:71], v[36:39], a[16:19], v[68:71]
ds_read_b128 v[28:31], v16 offset:10240
s_add_u32 m0, s21, 2048
v_mfma_f32_16x16x32_bf16 v[72:75], v[36:39], a[20:23], v[72:75]
buffer_load_dwordx4 v10, s[8:11], s20 offen lds
v_mfma_f32_16x16x32_bf16 v[76:79], v[40:43], a[16:19], v[76:79]
ds_read_b128 v[32:35], v17 offset:10240
s_xor_b32 s38, s38, 1
v_mfma_f32_16x16x32_bf16 v[80:83], v[40:43], a[20:23], v[80:83]
s_waitcnt lgkmcnt(4)
s_cmp_eq_u32 s37, 0
s_cselect_b32 s31, 0x40000000, s31
s_cselect_b32 s38, 0, s38
v_mfma_f32_16x16x32_bf16 v[68:71], v[44:47], a[24:27], v[68:71]
ds_read_b128 v[36:39], v16 offset:12288
v_mfma_f32_16x16x32_bf16 v[72:75], v[44:47], a[28:31], v[72:75]
buffer_load_dword v133, v136, s[32:35], s42 offen offset:2048
v_mfma_f32_16x16x32_bf16 v[76:79], v[48:51], a[24:27], v[76:79]
ds_read_b128 v[40:43], v17 offset:12288
v_mfma_f32_16x16x32_bf16 v[80:83], v[48:51], a[28:31], v[80:83]
s_waitcnt lgkmcnt(4)
v_mfma_f32_16x16x32_bf16 v[68:71], v[20:23], a[32:35], v[68:71]
ds_read_b128 v[44:47], v16 offset:14336
s_add_u32 m0, s21, 3072
v_mfma_f32_16x16x32_bf16 v[72:75], v[20:23], a[36:39], v[72:75]
buffer_load_dwordx4 v11, s[8:11], s20 offen lds
v_mfma_f32_16x16x32_bf16 v[76:79], v[24:27], a[32:35], v[76:79]
ds_read_b128 v[48:51], v17 offset:14336
v_cvt_pk_bf16_f32 v104, v60, v64
v_mfma_f32_16x16x32_bf16 v[80:83], v[24:27], a[36:39], v[80:83]
s_waitcnt lgkmcnt(4)
v_mfma_f32_16x16x32_bf16 v[68:71], v[28:31], a[40:43], v[68:71]
s_waitcnt vmcnt(20)
s_barrier
ds_read_b128 v[20:23], v16 offset:16384
v_mfma_f32_16x16x32_bf16 v[72:75], v[28:31], a[44:47], v[72:75]
s_add_u32 s20, s20, 16384
v_cvt_pk_bf16_f32 v105, v61, v65
v_mfma_f32_16x16x32_bf16 v[76:79], v[32:35], a[40:43], v[76:79]
ds_read_b128 v[24:27], v17 offset:16384
v_cvt_pk_bf16_f32 v106, v62, v66
v_mfma_f32_16x16x32_bf16 v[80:83], v[32:35], a[44:47], v[80:83]
s_waitcnt lgkmcnt(4)
v_cvt_pk_bf16_f32 v107, v63, v67
v_mfma_f32_16x16x32_bf16 v[68:71], v[36:39], a[48:51], v[68:71]
ds_read_b128 v[28:31], v16 offset:18432
s_add_u32 m0, s21, 16384
v_mfma_f32_16x16x32_bf16 v[72:75], v[36:39], a[52:55], v[72:75]
buffer_load_dwordx4 v8, s[8:11], s20 offen lds
v_mfma_f32_16x16x32_bf16 v[76:79], v[40:43], a[48:51], v[76:79]
ds_read_b128 v[32:35], v17 offset:18432
v_mfma_f32_16x16x32_bf16 v[80:83], v[40:43], a[52:55], v[80:83]
s_waitcnt lgkmcnt(4)
v_and_or_b32 v104, v104, -2, s38
v_mfma_f32_16x16x32_bf16 v[68:71], v[44:47], a[56:59], v[68:71]
ds_read_b128 v[36:39], v16 offset:20480
v_and_or_b32 v105, v105, -2, s38
v_mfma_f32_16x16x32_bf16 v[72:75], v[44:47], a[60:63], v[72:75]
buffer_load_dword v134, v137, s[32:35], s42 offen offset:0
v_mfma_f32_16x16x32_bf16 v[76:79], v[48:51], a[56:59], v[76:79]
ds_read_b128 v[40:43], v17 offset:20480
v_and_or_b32 v106, v106, -2, s38
v_mfma_f32_16x16x32_bf16 v[80:83], v[48:51], a[60:63], v[80:83]
s_waitcnt lgkmcnt(4)
v_mfma_f32_16x16x32_bf16 v[68:71], v[20:23], a[64:67], v[68:71]
ds_read_b128 v[44:47], v16 offset:22528
s_add_u32 m0, s21, 17408
v_mfma_f32_16x16x32_bf16 v[72:75], v[20:23], a[68:71], v[72:75]
buffer_load_dwordx4 v9, s[8:11], s20 offen lds
v_mfma_f32_16x16x32_bf16 v[76:79], v[24:27], a[64:67], v[76:79]
ds_read_b128 v[48:51], v17 offset:22528
v_and_or_b32 v107, v107, -2, s38
v_mfma_f32_16x16x32_bf16 v[80:83], v[24:27], a[68:71], v[80:83]
s_waitcnt lgkmcnt(4)
s_add_u32 s29, s45, s31
v_mfma_f32_16x16x32_bf16 v[68:71], v[28:31], a[72:75], v[68:71]
ds_read_b128 v[20:23], v16 offset:24576
v_mfma_f32_16x16x32_bf16 v[72:75], v[28:31], a[76:79], v[72:75]
buffer_store_dwordx4 v[104:107], v112, s[12:15], s29 offen offset:0 sc1
v_mfma_f32_16x16x32_bf16 v[76:79], v[32:35], a[72:75], v[76:79]
ds_read_b128 v[24:27], v17 offset:24576
s_add_u32 s51, s24, 1
v_mfma_f32_16x16x32_bf16 v[80:83], v[32:35], a[76:79], v[80:83]
s_waitcnt lgkmcnt(4)
v_mfma_f32_16x16x32_bf16 v[68:71], v[36:39], a[80:83], v[68:71]
ds_read_b128 v[28:31], v16 offset:26624
s_add_u32 m0, s21, 18432
v_mfma_f32_16x16x32_bf16 v[72:75], v[36:39], a[84:87], v[72:75]
buffer_load_dwordx4 v10, s[8:11], s20 offen lds
v_mfma_f32_16x16x32_bf16 v[76:79], v[40:43], a[80:83], v[76:79]
ds_read_b128 v[32:35], v17 offset:26624
s_min_u32 s51, s51, s61
v_mfma_f32_16x16x32_bf16 v[80:83], v[40:43], a[84:87], v[80:83]
s_waitcnt lgkmcnt(4)
v_mfma_f32_16x16x32_bf16 v[68:71], v[44:47], a[88:91], v[68:71]
ds_read_b128 v[36:39], v16 offset:28672
s_lshl_b32 s51, s51, 7
v_mfma_f32_16x16x32_bf16 v[72:75], v[44:47], a[92:95], v[72:75]
buffer_load_dword v135, v137, s[32:35], s42 offen offset:2048
v_mfma_f32_16x16x32_bf16 v[76:79], v[48:51], a[88:91], v[76:79]
ds_read_b128 v[40:43], v17 offset:28672
v_mfma_f32_16x16x32_bf16 v[80:83], v[48:51], a[92:95], v[80:83]
s_waitcnt lgkmcnt(4)
s_add_u32 s51, s51, s48
v_mfma_f32_16x16x32_bf16 v[68:71], v[20:23], a[96:99], v[68:71]
ds_read_b128 v[44:47], v16 offset:30720
s_add_u32 m0, s21, 19456
v_mfma_f32_16x16x32_bf16 v[72:75], v[20:23], a[100:103], v[72:75]
buffer_load_dwordx4 v11, s[8:11], s20 offen lds
v_mfma_f32_16x16x32_bf16 v[76:79], v[24:27], a[96:99], v[76:79]
ds_read_b128 v[48:51], v17 offset:30720
s_waitcnt vmcnt(12)
v_xor_b32 v124, s7, v88
v_mfma_f32_16x16x32_bf16 v[80:83], v[24:27], a[100:103], v[80:83]
s_waitcnt lgkmcnt(4)
v_bitop3_b32 v124, v124, v89, s7 bitop3:0xf6
v_bitop3_b32 v124, v124, v90, s7 bitop3:0xf6
v_mfma_f32_16x16x32_bf16 v[68:71], v[28:31], a[104:107], v[68:71]
s_waitcnt vmcnt(22)
s_barrier
ds_read_b128 v[20:23], v16 offset:32768
v_mfma_f32_16x16x32_bf16 v[72:75], v[28:31], a[108:111], v[72:75]
s_add_u32 s20, s20, 16384
buffer_load_dword v87, v4, s[12:15], s51 offen sc1
v_mfma_f32_16x16x32_bf16 v[76:79], v[32:35], a[104:107], v[76:79]
ds_read_b128 v[24:27], v17 offset:32768
v_bitop3_b32 v124, v124, v91, s7 bitop3:0xf6
v_mfma_f32_16x16x32_bf16 v[80:83], v[32:35], a[108:111], v[80:83]
s_waitcnt lgkmcnt(4)
v_and_b32 v124, 1, v124
v_cmp_ne_u32 vcc, 0, v124
v_mfma_f32_16x16x32_bf16 v[68:71], v[36:39], a[112:115], v[68:71]
ds_read_b128 v[28:31], v16 offset:34816
s_add_u32 m0, s21, 32768
s_nop 0
v_mfma_f32_16x16x32_bf16 v[72:75], v[36:39], a[116:119], v[72:75]
buffer_load_dwordx4 v8, s[8:11], s20 offen lds
s_nop 0
v_mfma_f32_16x16x32_bf16 v[76:79], v[40:43], a[112:115], v[76:79]
ds_read_b128 v[32:35], v17 offset:34816
s_nop 0
v_mfma_f32_16x16x32_bf16 v[80:83], v[40:43], a[116:119], v[80:83]
s_waitcnt lgkmcnt(4)
s_cbranch_vccnz L_rbad_496
L_rok_497:
v_mfma_f32_16x16x32_bf16 v[68:71], v[44:47], a[120:123], v[68:71]
ds_read_b128 v[36:39], v16 offset:36864
v_lshlrev_b32 v124, 16, v88
v_and_b32 v125, 0xffff0000, v88
v_mfma_f32_16x16x32_bf16 v[72:75], v[44:47], a[124:127], v[72:75]
v_and_b32 v124, 0xfffe0000, v124
v_add_f32 v96, v116, v124
v_mfma_f32_16x16x32_bf16 v[76:79], v[48:51], a[120:123], v[76:79]
ds_read_b128 v[40:43], v17 offset:36864
v_add_f32 v97, v117, v125
v_lshlrev_b32 v124, 16, v89
v_mfma_f32_16x16x32_bf16 v[80:83], v[48:51], a[124:127], v[80:83]
s_waitcnt lgkmcnt(4)
v_and_b32 v125, 0xffff0000, v89
v_mfma_f32_16x16x32_bf16 v[68:71], v[20:23], a[128:131], v[68:71]
ds_read_b128 v[44:47], v16 offset:38912
s_add_u32 m0, s21, 33792
v_and_b32 v124, 0xfffe0000, v124
v_mfma_f32_16x16x32_bf16 v[72:75], v[20:23], a[132:135], v[72:75]
buffer_load_dwordx4 v9, s[8:11], s20 offen lds
v_add_f32 v98, v118, v124
v_mfma_f32_16x16x32_bf16 v[76:79], v[24:27], a[128:131], v[76:79]
ds_read_b128 v[48:51], v17 offset:38912
v_add_f32 v99, v119, v125
v_lshlrev_b32 v124, 16, v90
v_mfma_f32_16x16x32_bf16 v[80:83], v[24:27], a[132:135], v[80:83]
s_waitcnt lgkmcnt(4)
v_and_b32 v125, 0xffff0000, v90
v_mfma_f32_16x16x32_bf16 v[68:71], v[28:31], a[136:139], v[68:71]
ds_read_b128 v[20:23], v16 offset:40960
v_and_b32 v124, 0xfffe0000, v124
v_add_f32 v100, v120, v124
v_mfma_f32_16x16x32_bf16 v[72:75], v[28:31], a[140:143], v[72:75]
v_add_f32 v101, v121, v125
v_lshlrev_b32 v124, 16, v91
v_mfma_f32_16x16x32_bf16 v[76:79], v[32:35], a[136:139], v[76:79]
ds_read_b128 v[24:27], v17 offset:40960
v_and_b32 v125, 0xffff0000, v91
v_and_b32 v124, 0xfffe0000, v124
v_mfma_f32_16x16x32_bf16 v[80:83], v[32:35], a[140:143], v[80:83]
s_waitcnt lgkmcnt(4)
v_add_f32 v102, v122, v124
v_add_f32 v103, v123, v125
v_mfma_f32_16x16x32_bf16 v[68:71], v[36:39], a[144:147], v[68:71]
ds_read_b128 v[28:31], v16 offset:43008
s_add_u32 m0, s21, 34816
v_mfma_f32_16x16x32_bf16 v[72:75], v[36:39], a[148:151], v[72:75]
buffer_load_dwordx4 v10, s[8:11], s20 offen lds
v_mfma_f32_16x16x32_bf16 v[76:79], v[40:43], a[144:147], v[76:79]
ds_read_b128 v[32:35], v17 offset:43008
v_mfma_f32_16x16x32_bf16 v[80:83], v[40:43], a[148:151], v[80:83]
s_waitcnt lgkmcnt(4)
v_mfma_f32_16x16x32_bf16 v[68:71], v[44:47], a[152:155], v[68:71]
ds_read_b128 v[36:39], v16 offset:45056
s_waitcnt vmcnt(5)
v_lshlrev_b32 v130, 16, v132
v_mfma_f32_16x16x32_bf16 v[72:75], v[44:47], a[156:159], v[72:75]
v_and_b32 v131, 0xffff0000, v132
v_mfma_f32_16x16x32_bf16 v[76:79], v[48:51], a[152:155], v[76:79]
ds_read_b128 v[40:43], v17 offset:45056
v_mul_f32 v130, v130, v128
v_mul_f32 v131, v131, v129
v_mfma_f32_16x16x32_bf16 v[80:83], v[48:51], a[156:159], v[80:83]
s_waitcnt lgkmcnt(4)
v_cvt_pk_bf16_f32 v130, 0, v130
v_mfma_f32_16x16x32_bf16 v[68:71], v[20:23], a[160:163], v[68:71]
ds_read_b128 v[44:47], v16 offset:47104
s_add_u32 m0, s21, 35840
v_mfma_f32_16x16x32_bf16 v[72:75], v[20:23], a[164:167], v[72:75]
buffer_load_dwordx4 v11, s[8:11], s20 offen lds
v_cvt_pk_bf16_f32 v131, 0, v131
v_mfma_f32_16x16x32_bf16 v[76:79], v[24:27], a[160:163], v[76:79]
ds_read_b128 v[48:51], v17 offset:47104
v_add_f32 v96, v96, v130
v_mfma_f32_16x16x32_bf16 v[80:83], v[24:27], a[164:167], v[80:83]
s_waitcnt lgkmcnt(4)
v_add_f32 v97, v97, v131
v_mfma_f32_16x16x32_bf16 v[68:71], v[28:31], a[168:171], v[68:71]
s_waitcnt vmcnt(19)
s_barrier
ds_read_b128 v[20:23], v16 offset:49152
v_mfma_f32_16x16x32_bf16 v[72:75], v[28:31], a[172:175], v[72:75]
s_add_u32 s20, s20, 16384
buffer_store_dwordx2 v[96:97], v140, s[16:19], s43 offen
v_mfma_f32_16x16x32_bf16 v[76:79], v[32:35], a[168:171], v[76:79]
ds_read_b128 v[24:27], v17 offset:49152
v_lshlrev_b32 v130, 16, v133
v_and_b32 v131, 0xffff0000, v133
v_mfma_f32_16x16x32_bf16 v[80:83], v[32:35], a[172:175], v[80:83]
s_waitcnt lgkmcnt(4)
v_mul_f32 v130, v130, v128
v_mfma_f32_16x16x32_bf16 v[68:71], v[36:39], a[176:179], v[68:71]
ds_read_b128 v[28:31], v16 offset:51200
s_add_u32 m0, s21, 49152
v_mul_f32 v131, v131, v129
v_mfma_f32_16x16x32_bf16 v[72:75], v[36:39], a[180:183], v[72:75]
buffer_load_dwordx4 v8, s[8:11], s20 offen lds
v_mfma_f32_16x16x32_bf16 v[76:79], v[40:43], a[176:179], v[76:79]
ds_read_b128 v[32:35], v17 offset:51200
v_cvt_pk_bf16_f32 v130, 0, v130
v_mfma_f32_16x16x32_bf16 v[80:83], v[40:43], a[180:183], v[80:83]
s_waitcnt lgkmcnt(4)
v_cvt_pk_bf16_f32 v131, 0, v131
v_add_f32 v98, v98, v130
v_mfma_f32_16x16x32_bf16 v[68:71], v[44:47], a[184:187], v[68:71]
ds_read_b128 v[36:39], v16 offset:53248
v_add_f32 v99, v99, v131
v_mfma_f32_16x16x32_bf16 v[72:75], v[44:47], a[188:191], v[72:75]
buffer_store_dwordx2 v[98:99], v141, s[16:19], s43 offen
v_lshlrev_b32 v130, 16, v134
v_mfma_f32_16x16x32_bf16 v[76:79], v[48:51], a[184:187], v[76:79]
ds_read_b128 v[40:43], v17 offset:53248
v_and_b32 v131, 0xffff0000, v134
v_mfma_f32_16x16x32_bf16 v[80:83], v[48:51], a[188:191], v[80:83]
s_waitcnt lgkmcnt(4)
v_mul_f32 v130, v130, v128
v_mfma_f32_16x16x32_bf16 v[68:71], v[20:23], a[192:195], v[68:71]
ds_read_b128 v[44:47], v16 offset:55296
s_add_u32 m0, s21, 50176
v_mul_f32 v131, v131, v129
v_mfma_f32_16x16x32_bf16 v[72:75], v[20:23], a[196:199], v[72:75]
buffer_load_dwordx4 v9, s[8:11], s20 offen lds
v_mfma_f32_16x16x32_bf16 v[76:79], v[24:27], a[192:195], v[76:79]
ds_read_b128 v[48:51], v17 offset:55296
v_cvt_pk_bf16_f32 v130, 0, v130
v_cvt_pk_bf16_f32 v131, 0, v131
v_mfma_f32_16x16x32_bf16 v[80:83], v[24:27], a[196:199], v[80:83]
s_waitcnt lgkmcnt(4)
v_add_f32 v100, v100, v130
v_mfma_f32_16x16x32_bf16 v[68:71], v[28:31], a[200:203], v[68:71]
ds_read_b128 v[20:23], v16 offset:57344
v_add_f32 v101, v101, v131
v_mfma_f32_16x16x32_bf16 v[72:75], v[28:31], a[204:207], v[72:75]
buffer_store_dwordx2 v[100:101], v142, s[16:19], s43 offen
v_lshlrev_b32 v130, 16, v135
v_mfma_f32_16x16x32_bf16 v[76:79], v[32:35], a[200:203], v[76:79]
ds_read_b128 v[24:27], v17 offset:57344
s_add_u32 s24, s24, 1
v_and_b32 v131, 0xffff0000, v135
v_mfma_f32_16x16x32_bf16 v[80:83], v[32:35], a[204:207], v[80:83]
s_waitcnt lgkmcnt(4)
s_min_u32 s24, s24, s61
v_mul_f32 v130, v130, v128
v_mfma_f32_16x16x32_bf16 v[68:71], v[36:39], a[208:211], v[68:71]
ds_read_b128 v[28:31], v16 offset:59392
s_add_u32 m0, s21, 51200
s_lshl_b32 s53, s24, 17
v_mul_f32 v131, v131, v129
v_mfma_f32_16x16x32_bf16 v[72:75], v[36:39], a[212:215], v[72:75]
buffer_load_dwordx4 v10, s[8:11], s20 offen lds
v_cvt_pk_bf16_f32 v130, 0, v130
v_mfma_f32_16x16x32_bf16 v[76:79], v[40:43], a[208:211], v[76:79]
ds_read_b128 v[32:35], v17 offset:59392
s_add_u32 s53, s53, s50
v_cvt_pk_bf16_f32 v131, 0, v131
v_mfma_f32_16x16x32_bf16 v[80:83], v[40:43], a[212:215], v[80:83]
s_waitcnt lgkmcnt(4)
s_waitcnt vmcnt(10)
v_add_f32 v102, v102, v130
v_mfma_f32_16x16x32_bf16 v[68:71], v[44:47], a[216:219], v[68:71]
ds_read_b128 v[36:39], v16 offset:61440
v_readfirstlane_b32 s30, v87
v_add_f32 v103, v103, v131
v_mfma_f32_16x16x32_bf16 v[72:75], v[44:47], a[220:223], v[72:75]
s_nop 0
buffer_store_dwordx2 v[102:103], v143, s[16:19], s43 offen
v_mfma_f32_16x16x32_bf16 v[76:79], v[48:51], a[216:219], v[76:79]
ds_read_b128 v[40:43], v17 offset:61440
s_nop 0
v_mfma_f32_16x16x32_bf16 v[80:83], v[48:51], a[220:223], v[80:83]
s_waitcnt lgkmcnt(4)
s_cmp_lt_u32 s30, 16
s_cbranch_scc1 L_gw_499
L_gok_498:
v_mfma_f32_16x16x32_bf16 v[68:71], v[20:23], a[224:227], v[68:71]
ds_read_b128 v[44:47], v16 offset:63488
s_add_u32 m0, s21, 52224
v_mfma_f32_16x16x32_bf16 v[72:75], v[20:23], a[228:231], v[72:75]
buffer_load_dwordx4 v11, s[8:11], s20 offen lds
v_mfma_f32_16x16x32_bf16 v[76:79], v[24:27], a[224:227], v[76:79]
ds_read_b128 v[48:51], v17 offset:63488
v_mov_b32 v116, v52
v_mov_b32 v117, v56
v_mfma_f32_16x16x32_bf16 v[80:83], v[24:27], a[228:231], v[80:83]
s_waitcnt lgkmcnt(4)
v_mov_b32 v118, v53
v_mov_b32 v119, v57
v_mfma_f32_16x16x32_bf16 v[68:71], v[28:31], a[232:235], v[68:71]
s_waitcnt vmcnt(20)
s_barrier
ds_read_b128 v[20:23], v12 offset:0
v_mfma_f32_16x16x32_bf16 v[72:75], v[28:31], a[236:239], v[72:75]
s_mov_b32 s20, s53
v_mov_b32 v120, v54
v_mov_b32 v121, v58
v_mfma_f32_16x16x32_bf16 v[76:79], v[32:35], a[232:235], v[76:79]
ds_read_b128 v[24:27], v13 offset:0
v_mov_b32 v122, v55
v_mfma_f32_16x16x32_bf16 v[80:83], v[32:35], a[236:239], v[80:83]
s_waitcnt lgkmcnt(4)
v_mov_b32 v123, v59
s_mov_b32 s7, s38
v_mfma_f32_16x16x32_bf16 v[68:71], v[36:39], a[240:243], v[68:71]
ds_read_b128 v[28:31], v12 offset:2048
s_add_u32 m0, s21, 65536
s_add_u32 s39, s44, s31
v_mfma_f32_16x16x32_bf16 v[72:75], v[36:39], a[244:247], v[72:75]
buffer_load_dwordx4 v8, s[8:11], s20 offen lds
s_sub_u32 s43, s22, 1
v_mfma_f32_16x16x32_bf16 v[76:79], v[40:43], a[240:243], v[76:79]
ds_read_b128 v[32:35], v13 offset:2048
s_lshl_b32 s42, s43, 16
v_mfma_f32_16x16x32_bf16 v[80:83], v[40:43], a[244:247], v[80:83]
s_waitcnt lgkmcnt(4)
s_lshl_b32 s43, s43, 18
s_cmp_eq_u32 s37, 0
s_cselect_b32 s42, 0x7ff00000, s42
s_cselect_b32 s43, 0x7ff00000, s43
v_mfma_f32_16x16x32_bf16 v[68:71], v[44:47], a[248:251], v[68:71]
ds_read_b128 v[36:39], v12 offset:4096
v_mfma_f32_16x16x32_bf16 v[72:75], v[44:47], a[252:255], v[72:75]
buffer_load_dwordx4 v[88:91], v112, s[12:15], s39 offen offset:0 sc1
v_mfma_f32_16x16x32_bf16 v[76:79], v[48:51], a[248:251], v[76:79]
ds_read_b128 v[40:43], v13 offset:4096
s_mov_b32 s37, 1
v_mfma_f32_16x16x32_bf16 v[80:83], v[48:51], a[252:255], v[80:83]
s_waitcnt lgkmcnt(4)
s_add_u32 s22, s22, 1
s_cmp_ge_u32 s22, s23
s_cbranch_scc0 L_st_491
L_fl1_489:
s_waitcnt lgkmcnt(0)
s_nop 7
s_sub_u32 s38, s22, 1
s_and_b32 s31, s38, 3
s_lshl_b32 s31, s31, 11
s_bfe_u32 s38, s38, 0x10002
s_xor_b32 s38, s38, 1
s_cmp_eq_u32 s37, 0
s_cselect_b32 s31, 0x40000000, s31
s_cselect_b32 s38, 0, s38
v_cvt_pk_bf16_f32 v104, v76, v80
v_cvt_pk_bf16_f32 v105, v77, v81
v_cvt_pk_bf16_f32 v106, v78, v82
v_cvt_pk_bf16_f32 v107, v79, v83
v_and_or_b32 v104, v104, -2, s38
v_and_or_b32 v105, v105, -2, s38
v_and_or_b32 v106, v106, -2, s38
v_and_or_b32 v107, v107, -2, s38
s_add_u32 s29, s45, s31
buffer_store_dwordx4 v[104:107], v112, s[12:15], s29 offen offset:0 sc1
buffer_load_dword v132, v136, s[32:35], s42 offen offset:0
buffer_load_dword v133, v136, s[32:35], s42 offen offset:2048
buffer_load_dword v134, v137, s[32:35], s42 offen offset:0
buffer_load_dword v135, v137, s[32:35], s42 offen offset:2048
s_waitcnt vmcnt(0)
v_xor_b32 v124, s7, v88
v_bitop3_b32 v124, v124, v89, s7 bitop3:0xf6
v_bitop3_b32 v124, v124, v90, s7 bitop3:0xf6
v_bitop3_b32 v124, v124, v91, s7 bitop3:0xf6
v_and_b32 v124, 1, v124
v_cmp_ne_u32 vcc, 0, v124
s_nop 0
s_nop 0
s_nop 0
s_cbranch_vccnz L_rbad_500
L_rok_501:
v_lshlrev_b32 v124, 16, v88
v_and_b32 v125, 0xffff0000, v88
v_and_b32 v124, 0xfffe0000, v124
v_add_f32 v96, v116, v124
v_add_f32 v97, v117, v125
v_lshlrev_b32 v124, 16, v89
v_and_b32 v125, 0xffff0000, v89
v_and_b32 v124, 0xfffe0000, v124
v_add_f32 v98, v118, v124
v_add_f32 v99, v119, v125
v_lshlrev_b32 v124, 16, v90
v_and_b32 v125, 0xffff0000, v90
v_and_b32 v124, 0xfffe0000, v124
v_add_f32 v100, v120, v124
v_add_f32 v101, v121, v125
v_lshlrev_b32 v124, 16, v91
v_and_b32 v125, 0xffff0000, v91
v_and_b32 v124, 0xfffe0000, v124
v_add_f32 v102, v122, v124
v_add_f32 v103, v123, v125
s_waitcnt vmcnt(0)
v_lshlrev_b32 v130, 16, v132
v_and_b32 v131, 0xffff0000, v132
v_mul_f32 v130, v130, v128
v_mul_f32 v131, v131, v129
v_cvt_pk_bf16_f32 v130, 0, v130
v_cvt_pk_bf16_f32 v131, 0, v131
v_add_f32 v96, v96, v130
v_add_f32 v97, v97, v131
buffer_store_dwordx2 v[96:97], v140, s[16:19], s43 offen
v_lshlrev_b32 v130, 16, v133
v_and_b32 v131, 0xffff0000, v133
v_mul_f32 v130, v130, v128
v_mul_f32 v131, v131, v129
v_cvt_pk_bf16_f32 v130, 0, v130
v_cvt_pk_bf16_f32 v131, 0, v131
v_add_f32 v98, v98, v130
v_add_f32 v99, v99, v131
buffer_store_dwordx2 v[98:99], v141, s[16:19], s43 offen
v_lshlrev_b32 v130, 16, v134
v_and_b32 v131, 0xffff0000, v134
v_mul_f32 v130, v130, v128
v_mul_f32 v131, v131, v129
v_cvt_pk_bf16_f32 v130, 0, v130
v_cvt_pk_bf16_f32 v131, 0, v131
v_add_f32 v100, v100, v130
v_add_f32 v101, v101, v131
buffer_store_dwordx2 v[100:101], v142, s[16:19], s43 offen
v_lshlrev_b32 v130, 16, v135
v_and_b32 v131, 0xffff0000, v135
v_mul_f32 v130, v130, v128
v_mul_f32 v131, v131, v129
v_cvt_pk_bf16_f32 v130, 0, v130
v_cvt_pk_bf16_f32 v131, 0, v131
v_add_f32 v102, v102, v130
v_add_f32 v103, v103, v131
buffer_store_dwordx2 v[102:103], v143, s[16:19], s43 offen
v_mov_b32 v116, v68
v_mov_b32 v117, v72
v_mov_b32 v118, v69
v_mov_b32 v119, v73
v_mov_b32 v120, v70
v_mov_b32 v121, v74
v_mov_b32 v122, v71
v_mov_b32 v123, v75
s_mov_b32 s7, s38
s_add_u32 s39, s44, s31
s_sub_u32 s43, s22, 1
s_lshl_b32 s42, s43, 16
s_lshl_b32 s43, s43, 18
s_cmp_eq_u32 s37, 0
s_cselect_b32 s42, 0x7ff00000, s42
s_cselect_b32 s43, 0x7ff00000, s43
buffer_load_dwordx4 v[88:91], v112, s[12:15], s39 offen offset:0 sc1
s_mov_b32 s37, 1
buffer_load_dword v132, v136, s[32:35], s42 offen offset:0
buffer_load_dword v133, v136, s[32:35], s42 offen offset:2048
buffer_load_dword v134, v137, s[32:35], s42 offen offset:0
buffer_load_dword v135, v137, s[32:35], s42 offen offset:2048
s_waitcnt vmcnt(0)
v_xor_b32 v124, s7, v88
v_bitop3_b32 v124, v124, v89, s7 bitop3:0xf6
v_bitop3_b32 v124, v124, v90, s7 bitop3:0xf6
v_bitop3_b32 v124, v124, v91, s7 bitop3:0xf6
v_and_b32 v124, 1, v124
v_cmp_ne_u32 vcc, 0, v124
s_nop 0
s_nop 0
s_nop 0
s_cbranch_vccnz L_rbad_502
L_rok_503:
v_lshlrev_b32 v124, 16, v88
v_and_b32 v125, 0xffff0000, v88
v_and_b32 v124, 0xfffe0000, v124
v_add_f32 v96, v116, v124
v_add_f32 v97, v117, v125
v_lshlrev_b32 v124, 16, v89
v_and_b32 v125, 0xffff0000, v89
v_and_b32 v124, 0xfffe0000, v124
v_add_f32 v98, v118, v124
v_add_f32 v99, v119, v125
v_lshlrev_b32 v124, 16, v90
v_and_b32 v125, 0xffff0000, v90
v_and_b32 v124, 0xfffe0000, v124
v_add_f32 v100, v120, v124
v_add_f32 v101, v121, v125
v_lshlrev_b32 v124, 16, v91
v_and_b32 v125, 0xffff0000, v91
v_and_b32 v124, 0xfffe0000, v124
v_add_f32 v102, v122, v124
v_add_f32 v103, v123, v125
s_waitcnt vmcnt(0)
v_lshlrev_b32 v130, 16, v132
v_and_b32 v131, 0xffff0000, v132
v_mul_f32 v130, v130, v128
v_mul_f32 v131, v131, v129
v_cvt_pk_bf16_f32 v130, 0, v130
v_cvt_pk_bf16_f32 v131, 0, v131
v_add_f32 v96, v96, v130
v_add_f32 v97, v97, v131
buffer_store_dwordx2 v[96:97], v140, s[16:19], s43 offen
v_lshlrev_b32 v130, 16, v133
v_and_b32 v131, 0xffff0000, v133
v_mul_f32 v130, v130, v128
v_mul_f32 v131, v131, v129
v_cvt_pk_bf16_f32 v130, 0, v130
v_cvt_pk_bf16_f32 v131, 0, v131
v_add_f32 v98, v98, v130
v_add_f32 v99, v99, v131
buffer_store_dwordx2 v[98:99], v141, s[16:19], s43 offen
v_lshlrev_b32 v130, 16, v134
v_and_b32 v131, 0xffff0000, v134
v_mul_f32 v130, v130, v128
v_mul_f32 v131, v131, v129
v_cvt_pk_bf16_f32 v130, 0, v130
v_cvt_pk_bf16_f32 v131, 0, v131
v_add_f32 v100, v100, v130
v_add_f32 v101, v101, v131
buffer_store_dwordx2 v[100:101], v142, s[16:19], s43 offen
v_lshlrev_b32 v130, 16, v135
v_and_b32 v131, 0xffff0000, v135
v_mul_f32 v130, v130, v128
v_mul_f32 v131, v131, v129
v_cvt_pk_bf16_f32 v130, 0, v130
v_cvt_pk_bf16_f32 v131, 0, v131
v_add_f32 v102, v102, v130
v_add_f32 v103, v103, v131
buffer_store_dwordx2 v[102:103], v143, s[16:19], s43 offen
s_branch L_ste_490
L_rbad_492:
buffer_load_dwordx4 v[88:91], v112, s[12:15], s39 offen offset:0 sc1
s_add_u32 s36, s36, 1
s_cmp_gt_u32 s36, 0x100000
s_cbranch_scc1 chain_kernel_wend
s_waitcnt vmcnt(0)
v_xor_b32 v124, s7, v88
v_bitop3_b32 v124, v124, v89, s7 bitop3:0xf6
v_bitop3_b32 v124, v124, v90, s7 bitop3:0xf6
v_bitop3_b32 v124, v124, v91, s7 bitop3:0xf6
v_and_b32 v124, 1, v124
v_cmp_ne_u32 vcc, 0, v124
s_cbranch_vccnz L_rbad_492
s_branch L_rok_493
L_gw_495:
buffer_load_dword v87, v4, s[12:15], s51 offen sc1
s_add_u32 s36, s36, 1
s_cmp_gt_u32 s36, 0x100000
s_cbranch_scc1 chain_kernel_wend
s_waitcnt vmcnt(0)
v_readfirstlane_b32 s30, v87
s_cmp_lt_u32 s30, 16
s_cbranch_scc0 L_gok_494
s_sleep 1
s_branch L_gw_495
L_rbad_496:
buffer_load_dwordx4 v[88:91], v112, s[12:15], s39 offen offset:0 sc1
s_add_u32 s36, s36, 1
s_cmp_gt_u32 s36, 0x100000
s_cbranch_scc1 chain_kernel_wend
s_waitcnt vmcnt(0)
v_xor_b32 v124, s7, v88
v_bitop3_b32 v124, v124, v89, s7 bitop3:0xf6
v_bitop3_b32 v124, v124, v90, s7 bitop3:0xf6
v_bitop3_b32 v124, v124, v91, s7 bitop3:0xf6
v_and_b32 v124, 1, v124
v_cmp_ne_u32 vcc, 0, v124
s_cbranch_vccnz L_rbad_496
s_branch L_rok_497
L_gw_499:
buffer_load_dword v87, v4, s[12:15], s51 offen sc1
s_add_u32 s36, s36, 1
s_cmp_gt_u32 s36, 0x100000
s_cbranch_scc1 chain_kernel_wend
s_waitcnt vmcnt(0)
v_readfirstlane_b32 s30, v87
s_cmp_lt_u32 s30, 16
s_cbranch_scc0 L_gok_498
s_sleep 1
s_branch L_gw_499
L_rbad_500:
buffer_load_dwordx4 v[88:91], v112, s[12:15], s39 offen offset:0 sc1
s_add_u32 s36, s36, 1
s_cmp_gt_u32 s36, 0x100000
s_cbranch_scc1 chain_kernel_wend
s_waitcnt vmcnt(0)
v_xor_b32 v124, s7, v88
v_bitop3_b32 v124, v124, v89, s7 bitop3:0xf6
v_bitop3_b32 v124, v124, v90, s7 bitop3:0xf6
v_bitop3_b32 v124, v124, v91, s7 bitop3:0xf6
v_and_b32 v124, 1, v124
v_cmp_ne_u32 vcc, 0, v124
s_cbranch_vccnz L_rbad_500
s_branch L_rok_501
L_rbad_502:
buffer_load_dwordx4 v[88:91], v112, s[12:15], s39 offen offset:0 sc1
s_add_u32 s36, s36, 1
s_cmp_gt_u32 s36, 0x100000
s_cbranch_scc1 chain_kernel_wend
s_waitcnt vmcnt(0)
v_xor_b32 v124, s7, v88
v_bitop3_b32 v124, v124, v89, s7 bitop3:0xf6
v_bitop3_b32 v124, v124, v90, s7 bitop3:0xf6
v_bitop3_b32 v124, v124, v91, s7 bitop3:0xf6
v_and_b32 v124, 1, v124
v_cmp_ne_u32 vcc, 0, v124
s_cbranch_vccnz L_rbad_502
s_branch L_rok_503
L_fl0_488:
s_waitcnt lgkmcnt(0)
s_nop 7
s_sub_u32 s38, s22, 1
s_and_b32 s31, s38, 3
s_lshl_b32 s31, s31, 11
s_bfe_u32 s38, s38, 0x10002
s_xor_b32 s38, s38, 1
s_cmp_eq_u32 s37, 0
s_cselect_b32 s31, 0x40000000, s31
s_cselect_b32 s38, 0, s38
v_cvt_pk_bf16_f32 v104, v60, v64
v_cvt_pk_bf16_f32 v105, v61, v65
v_cvt_pk_bf16_f32 v106, v62, v66
v_cvt_pk_bf16_f32 v107, v63, v67
v_and_or_b32 v104, v104, -2, s38
v_and_or_b32 v105, v105, -2, s38
v_and_or_b32 v106, v106, -2, s38
v_and_or_b32 v107, v107, -2, s38
s_add_u32 s29, s45, s31
buffer_store_dwordx4 v[104:107], v112, s[12:15], s29 offen offset:0 sc1
buffer_load_dword v132, v136, s[32:35], s42 offen offset:0
buffer_load_dword v133, v136, s[32:35], s42 offen offset:2048
buffer_load_dword v134, v137, s[32:35], s42 offen offset:0
buffer_load_dword v135, v137, s[32:35], s42 offen offset:2048
s_waitcnt vmcnt(0)
v_xor_b32 v124, s7, v88
v_bitop3_b32 v124, v124, v89, s7 bitop3:0xf6
v_bitop3_b32 v124, v124, v90, s7 bitop3:0xf6
v_bitop3_b32 v124, v124, v91, s7 bitop3:0xf6
v_and_b32 v124, 1, v124
v_cmp_ne_u32 vcc, 0, v124
s_nop 0
s_nop 0
s_nop 0
s_cbranch_vccnz L_rbad_504
L_rok_505:
v_lshlrev_b32 v124, 16, v88
v_and_b32 v125, 0xffff0000, v88
v_and_b32 v124, 0xfffe0000, v124
v_add_f32 v96, v116, v124
v_add_f32 v97, v117, v125
v_lshlrev_b32 v124, 16, v89
v_and_b32 v125, 0xffff0000, v89
v_and_b32 v124, 0xfffe0000, v124
v_add_f32 v98, v118, v124
v_add_f32 v99, v119, v125
v_lshlrev_b32 v124, 16, v90
v_and_b32 v125, 0xffff0000, v90
v_and_b32 v124, 0xfffe0000, v124
v_add_f32 v100, v120, v124
v_add_f32 v101, v121, v125
v_lshlrev_b32 v124, 16, v91
v_and_b32 v125, 0xffff0000, v91
v_and_b32 v124, 0xfffe0000, v124
v_add_f32 v102, v122, v124
v_add_f32 v103, v123, v125
s_waitcnt vmcnt(0)
v_lshlrev_b32 v130, 16, v132
v_and_b32 v131, 0xffff0000, v132
v_mul_f32 v130, v130, v128
v_mul_f32 v131, v131, v129
v_cvt_pk_bf16_f32 v130, 0, v130
v_cvt_pk_bf16_f32 v131, 0, v131
v_add_f32 v96, v96, v130
v_add_f32 v97, v97, v131
buffer_store_dwordx2 v[96:97], v140, s[16:19], s43 offen
v_lshlrev_b32 v130, 16, v133
v_and_b32 v131, 0xffff0000, v133
v_mul_f32 v130, v130, v128
v_mul_f32 v131, v131, v129
v_cvt_pk_bf16_f32 v130, 0, v130
v_cvt_pk_bf16_f32 v131, 0, v131
v_add_f32 v98, v98, v130
v_add_f32 v99, v99, v131
buffer_store_dwordx2 v[98:99], v141, s[16:19], s43 offen
v_lshlrev_b32 v130, 16, v134
v_and_b32 v131, 0xffff0000, v134
v_mul_f32 v130, v130, v128
v_mul_f32 v131, v131, v129
v_cvt_pk_bf16_f32 v130, 0, v130
v_cvt_pk_bf16_f32 v131, 0, v131
v_add_f32 v100, v100, v130
v_add_f32 v101, v101, v131
buffer_store_dwordx2 v[100:101], v142, s[16:19], s43 offen
v_lshlrev_b32 v130, 16, v135
v_and_b32 v131, 0xffff0000, v135
v_mul_f32 v130, v130, v128
v_mul_f32 v131, v131, v129
v_cvt_pk_bf16_f32 v130, 0, v130
v_cvt_pk_bf16_f32 v131, 0, v131
v_add_f32 v102, v102, v130
v_add_f32 v103, v103, v131
buffer_store_dwordx2 v[102:103], v143, s[16:19], s43 offen
v_mov_b32 v116, v52
v_mov_b32 v117, v56
v_mov_b32 v118, v53
v_mov_b32 v119, v57
v_mov_b32 v120, v54
v_mov_b32 v121, v58
v_mov_b32 v122, v55
v_mov_b32 v123, v59
s_mov_b32 s7, s38
s_add_u32 s39, s44, s31
s_sub_u32 s43, s22, 1
s_lshl_b32 s42, s43, 16
s_lshl_b32 s43, s43, 18
s_cmp_eq_u32 s37, 0
s_cselect_b32 s42, 0x7ff00000, s42
s_cselect_b32 s43, 0x7ff00000, s43
buffer_load_dwordx4 v[88:91], v112, s[12:15], s39 offen offset:0 sc1
s_mov_b32 s37, 1
buffer_load_dword v132, v136, s[32:35], s42 offen offset:0
buffer_load_dword v133, v136, s[32:35], s42 offen offset:2048
buffer_load_dword v134, v137, s[32:35], s42 offen offset:0
buffer_load_dword v135, v137, s[32:35], s42 offen offset:2048
s_waitcnt vmcnt(0)
v_xor_b32 v124, s7, v88
v_bitop3_b32 v124, v124, v89, s7 bitop3:0xf6
v_bitop3_b32 v124, v124, v90, s7 bitop3:0xf6
v_bitop3_b32 v124, v124, v91, s7 bitop3:0xf6
v_and_b32 v124, 1, v124
v_cmp_ne_u32 vcc, 0, v124
s_nop 0
s_nop 0
s_nop 0
s_cbranch_vccnz L_rbad_506
L_rok_507:
v_lshlrev_b32 v124, 16, v88
v_and_b32 v125, 0xffff0000, v88
v_and_b32 v124, 0xfffe0000, v124
v_add_f32 v96, v116, v124
v_add_f32 v97, v117, v125
v_lshlrev_b32 v124, 16, v89
v_and_b32 v125, 0xffff0000, v89
v_and_b32 v124, 0xfffe0000, v124
v_add_f32 v98, v118, v124
v_add_f32 v99, v119, v125
v_lshlrev_b32 v124, 16, v90
v_and_b32 v125, 0xffff0000, v90
v_and_b32 v124, 0xfffe0000, v124
v_add_f32 v100, v120, v124
v_add_f32 v101, v121, v125
v_lshlrev_b32 v124, 16, v91
v_and_b32 v125, 0xffff0000, v91
v_and_b32 v124, 0xfffe0000, v124
v_add_f32 v102, v122, v124
v_add_f32 v103, v123, v125
s_waitcnt vmcnt(0)
v_lshlrev_b32 v130, 16, v132
v_and_b32 v131, 0xffff0000, v132
v_mul_f32 v130, v130, v128
v_mul_f32 v131, v131, v129
v_cvt_pk_bf16_f32 v130, 0, v130
v_cvt_pk_bf16_f32 v131, 0, v131
v_add_f32 v96, v96, v130
v_add_f32 v97, v97, v131
buffer_store_dwordx2 v[96:97], v140, s[16:19], s43 offen
v_lshlrev_b32 v130, 16, v133
v_and_b32 v131, 0xffff0000, v133
v_mul_f32 v130, v130, v128
v_mul_f32 v131, v131, v129
v_cvt_pk_bf16_f32 v130, 0, v130
v_cvt_pk_bf16_f32 v131, 0, v131
v_add_f32 v98, v98, v130
v_add_f32 v99, v99, v131
buffer_store_dwordx2 v[98:99], v141, s[16:19], s43 offen
v_lshlrev_b32 v130, 16, v134
v_and_b32 v131, 0xffff0000, v134
v_mul_f32 v130, v130, v128
v_mul_f32 v131, v131, v129
v_cvt_pk_bf16_f32 v130, 0, v130
v_cvt_pk_bf16_f32 v131, 0, v131
v_add_f32 v100, v100, v130
v_add_f32 v101, v101, v131
buffer_store_dwordx2 v[100:101], v142, s[16:19], s43 offen
v_lshlrev_b32 v130, 16, v135
v_and_b32 v131, 0xffff0000, v135
v_mul_f32 v130, v130, v128
v_mul_f32 v131, v131, v129
v_cvt_pk_bf16_f32 v130, 0, v130
v_cvt_pk_bf16_f32 v131, 0, v131
v_add_f32 v102, v102, v130
v_add_f32 v103, v103, v131
buffer_store_dwordx2 v[102:103], v143, s[16:19], s43 offen
s_branch L_ste_490
L_rbad_504:
buffer_load_dwordx4 v[88:91], v112, s[12:15], s39 offen offset:0 sc1
s_add_u32 s36, s36, 1
s_cmp_gt_u32 s36, 0x100000
s_cbranch_scc1 chain_kernel_wend
s_waitcnt vmcnt(0)
v_xor_b32 v124, s7, v88
v_bitop3_b32 v124, v124, v89, s7 bitop3:0xf6
v_bitop3_b32 v124, v124, v90, s7 bitop3:0xf6
v_bitop3_b32 v124, v124, v91, s7 bitop3:0xf6
v_and_b32 v124, 1, v124
v_cmp_ne_u32 vcc, 0, v124
s_cbranch_vccnz L_rbad_504
s_branch L_rok_505
L_rbad_506:
buffer_load_dwordx4 v[88:91], v112, s[12:15], s39 offen offset:0 sc1
s_add_u32 s36, s36, 1
s_cmp_gt_u32 s36, 0x100000
s_cbranch_scc1 chain_kernel_wend
s_waitcnt vmcnt(0)
v_xor_b32 v124, s7, v88
v_bitop3_b32 v124, v124, v89, s7 bitop3:0xf6
v_bitop3_b32 v124, v124, v90, s7 bitop3:0xf6
v_bitop3_b32 v124, v124, v91, s7 bitop3:0xf6
v_and_b32 v124, 1, v124
v_cmp_ne_u32 vcc, 0, v124
s_cbranch_vccnz L_rbad_506
s_branch L_rok_507
L_ste_490:
L_op_435:
s_mov_b32 s38, s41
s_and_b32 s39, s38, 3
s_lshr_b32 s42, s41, 2
s_or_b32 s25, s42, 4
s_cmp_eq_u32 s40, 0
s_cselect_b32 s42, s25, s42
s_and_b32 s25, s42, 3
s_cmp_eq_u32 s40, 1
s_cselect_b32 s42, s25, s42
s_lshl_b32 s44, s40, 5
s_add_u32 s44, s44, s38
s_lshl_b32 s44, s44, 15
s_lshl_b32 s25, s49, 13
s_add_u32 s44, s44, s25
s_xor_b32 s45, s44, 0x8000
s_add_u32 s45, s45, 0x6900000
s_xor_b32 s46, s44, 0x10000
s_add_u32 s46, s46, 0x6900000
s_xor_b32 s47, s44, 0x18000
s_add_u32 s47, s47, 0x6900000
s_add_u32 s44, s44, 0x6900000
s_lshl_b32 s48, s40, 3
s_lshr_b32 s25, s38, 2
s_add_u32 s48, s48, s25
s_lshl_b32 s94, s48, 8
s_add_u32 s94, s94, 0x590d800
s_lshl_b32 s95, s42, 7
s_add_u32 s95, s95, 0x590d400
s_cmp_eq_u32 s39, 0
s_cselect_b32 s95, s95, 0x40000000
s_cselect_b32 s60, s94, 0x40000000
s_lshl_b32 s48, s48, 7
s_add_u32 s48, s48, 0x590c000
s_mov_b32 s16, s92
s_and_b32 s17, s93, 0xffff
s_mov_b32 s18, 0x800000
s_mov_b32 s19, 0x00020000
s_lshl_b32 s50, s39, 21
s_lshl_b32 s25, s42, 8
s_add_u32 s50, s50, s25
v_mov_b32 v104, 0
v_mov_b32 v105, 0
v_mov_b32 v106, 0
v_mov_b32 v107, 0
v_and_b32 v2, 63, v0
v_lshlrev_b32 v3, 4, v2
v_lshlrev_b32 v112, 3, v2
s_add_u32 s28, s44, 0
buffer_store_dwordx4 v[104:107], v3, s[12:15], s28 offen sc1
s_add_u32 s28, s44, 1024
buffer_store_dwordx4 v[104:107], v3, s[12:15], s28 offen sc1
s_add_u32 s28, s44, 2048
buffer_store_dwordx4 v[104:107], v3, s[12:15], s28 offen sc1
s_add_u32 s28, s44, 3072
buffer_store_dwordx4 v[104:107], v3, s[12:15], s28 offen sc1
s_add_u32 s28, s44, 4096
buffer_store_dwordx4 v[104:107], v3, s[12:15], s28 offen sc1
s_add_u32 s28, s44, 5120
buffer_store_dwordx4 v[104:107], v3, s[12:15], s28 offen sc1
s_add_u32 s28, s44, 6144
buffer_store_dwordx4 v[104:107], v3, s[12:15], s28 offen sc1
s_add_u32 s28, s44, 7168
buffer_store_dwordx4 v[104:107], v3, s[12:15], s28 offen sc1
v_lshrrev_b32 v1, 6, v0
v_lshlrev_b32 v1, 11, v1
v_add_u32 v1, 0x21000, v1
v_add_u32 v113, v1, v3
v_and_b32 v2, 15, v0
v_lshl_add_u32 v1, v2, 2, v1
v_bfe_u32 v2, v0, 4, 2
v_lshl_add_u32 v114, v2, 7, v1
v_and_b32 v1, 15, v0
v_bfe_u32 v2, v0, 4, 2
v_lshrrev_b32 v3, 6, v0
v_lshlrev_b32 v4, 2, v2
v_xor_b32 v4, v4, v1
v_lshlrev_b32 v4, 4, v4
v_lshl_add_u32 v5, v3, 5, v2
s_mov_b32 s25, 2048
v_mul_lo_u32 v5, v5, s25
v_add_u32 v20, v5, v4
v_bfe_u32 v4, v0, 2, 2
v_lshl_add_u32 v5, v2, 3, v4
v_lshlrev_b32 v5, 8, v5
v_xor_b32 v4, v4, v3
v_lshl_add_u32 v5, v4, 6, v5
v_and_b32 v4, 3, v0
v_lshl_add_u32 v5, v4, 3, v5
v_mov_b32 v21, v5
v_add_u32 v22, 32, v21
v_add_u32 v23, 0x10000, v21
v_add_u32 v24, 0x10000, v22
s_lshl_b32 s26, s49, 13
s_mov_b32 s25, s50
s_barrier
s_add_u32 m0, s26, 0
s_add_u32 s27, s25, 0
buffer_load_dwordx4 v20, s[16:19], s27 offen lds
s_add_u32 m0, s26, 1024
s_add_u32 s27, s25, 8192
buffer_load_dwordx4 v20, s[16:19], s27 offen lds
s_add_u32 m0, s26, 2048
s_add_u32 s27, s25, 16384
buffer_load_dwordx4 v20, s[16:19], s27 offen lds
s_add_u32 m0, s26, 3072
s_add_u32 s27, s25, 24576
buffer_load_dwordx4 v20, s[16:19], s27 offen lds
s_add_u32 m0, s26, 4096
s_add_u32 s27, s25, 32768
buffer_load_dwordx4 v20, s[16:19], s27 offen lds
s_add_u32 m0, s26, 5120
s_add_u32 s27, s25, 40960
buffer_load_dwordx4 v20, s[16:19], s27 offen lds
s_add_u32 m0, s26, 6144
s_add_u32 s27, s25, 49152
buffer_load_dwordx4 v20, s[16:19], s27 offen lds
s_add_u32 m0, s26, 7168
s_add_u32 s27, s25, 57344
buffer_load_dwordx4 v20, s[16:19], s27 offen lds
s_add_u32 m0, s26, 32768
s_add_u32 s27, s25, 262144
buffer_load_dwordx4 v20, s[16:19], s27 offen lds
s_add_u32 m0, s26, 33792
s_add_u32 s27, s25, 270336
buffer_load_dwordx4 v20, s[16:19], s27 offen lds
s_add_u32 m0, s26, 34816
s_add_u32 s27, s25, 278528
buffer_load_dwordx4 v20, s[16:19], s27 offen lds
s_add_u32 m0, s26, 35840
s_add_u32 s27, s25, 286720
buffer_load_dwordx4 v20, s[16:19], s27 offen lds
s_add_u32 m0, s26, 36864
s_add_u32 s27, s25, 294912
buffer_load_dwordx4 v20, s[16:19], s27 offen lds
s_add_u32 m0, s26, 37888
s_add_u32 s27, s25, 303104
buffer_load_dwordx4 v20, s[16:19], s27 offen lds
s_add_u32 m0, s26, 38912
s_add_u32 s27, s25, 311296
buffer_load_dwordx4 v20, s[16:19], s27 offen lds
s_add_u32 m0, s26, 39936
s_add_u32 s27, s25, 319488
buffer_load_dwordx4 v20, s[16:19], s27 offen lds
s_add_u32 m0, s26, 65536
s_add_u32 s27, s25, 524288
buffer_load_dwordx4 v20, s[16:19], s27 offen lds
s_add_u32 m0, s26, 66560
s_add_u32 s27, s25, 532480
buffer_load_dwordx4 v20, s[16:19], s27 offen lds
s_add_u32 m0, s26, 67584
s_add_u32 s27, s25, 540672
buffer_load_dwordx4 v20, s[16:19], s27 offen lds
s_add_u32 m0, s26, 68608
s_add_u32 s27, s25, 548864
buffer_load_dwordx4 v20, s[16:19], s27 offen lds
s_add_u32 m0, s26, 69632
s_add_u32 s27, s25, 557056
buffer_load_dwordx4 v20, s[16:19], s27 offen lds
s_add_u32 m0, s26, 70656
s_add_u32 s27, s25, 565248
buffer_load_dwordx4 v20, s[16:19], s27 offen lds
s_add_u32 m0, s26, 71680
s_add_u32 s27, s25, 573440
buffer_load_dwordx4 v20, s[16:19], s27 offen lds
s_add_u32 m0, s26, 72704
s_add_u32 s27, s25, 581632
buffer_load_dwordx4 v20, s[16:19], s27 offen lds
s_add_u32 m0, s26, 98304
s_add_u32 s27, s25, 786432
buffer_load_dwordx4 v20, s[16:19], s27 offen lds
s_add_u32 m0, s26, 99328
s_add_u32 s27, s25, 794624
buffer_load_dwordx4 v20, s[16:19], s27 offen lds
s_add_u32 m0, s26, 100352
s_add_u32 s27, s25, 802816
buffer_load_dwordx4 v20, s[16:19], s27 offen lds
s_add_u32 m0, s26, 101376
s_add_u32 s27, s25, 811008
buffer_load_dwordx4 v20, s[16:19], s27 offen lds
s_add_u32 m0, s26, 102400
s_add_u32 s27, s25, 819200
buffer_load_dwordx4 v20, s[16:19], s27 offen lds
s_add_u32 m0, s26, 103424
s_add_u32 s27, s25, 827392
buffer_load_dwordx4 v20, s[16:19], s27 offen lds
s_add_u32 m0, s26, 104448
s_add_u32 s27, s25, 835584
buffer_load_dwordx4 v20, s[16:19], s27 offen lds
s_add_u32 m0, s26, 105472
s_add_u32 s27, s25, 843776
buffer_load_dwordx4 v20, s[16:19], s27 offen lds
s_waitcnt vmcnt(24)
s_barrier
buffer_atomic_add v84, v85, s[12:15], s48 offen sc1
ds_read_b64_tr_b16 a[0:1], v21 offset:0
ds_read_b64_tr_b16 a[2:3], v21 offset:1024
ds_read_b64_tr_b16 a[4:5], v22 offset:0
ds_read_b64_tr_b16 a[6:7], v22 offset:1024
ds_read_b64_tr_b16 a[8:9], v21 offset:8192
ds_read_b64_tr_b16 a[10:11], v21 offset:9216
ds_read_b64_tr_b16 a[12:13], v22 offset:8192
ds_read_b64_tr_b16 a[14:15], v22 offset:9216
s_waitcnt lgkmcnt(0)
ds_read_b64_tr_b16 a[16:17], v21 offset:16384
ds_read_b64_tr_b16 a[18:19], v21 offset:17408
ds_read_b64_tr_b16 a[20:21], v22 offset:16384
ds_read_b64_tr_b16 a[22:23], v22 offset:17408
ds_read_b64_tr_b16 a[24:25], v21 offset:24576
ds_read_b64_tr_b16 a[26:27], v21 offset:25600
ds_read_b64_tr_b16 a[28:29], v22 offset:24576
ds_read_b64_tr_b16 a[30:31], v22 offset:25600
s_waitcnt lgkmcnt(0)
s_barrier
s_add_u32 m0, s26, 0
s_add_u32 s27, s25, 1048576
buffer_load_dwordx4 v20, s[16:19], s27 offen lds
s_add_u32 m0, s26, 1024
s_add_u32 s27, s25, 1056768
buffer_load_dwordx4 v20, s[16:19], s27 offen lds
s_add_u32 m0, s26, 2048
s_add_u32 s27, s25, 1064960
buffer_load_dwordx4 v20, s[16:19], s27 offen lds
s_add_u32 m0, s26, 3072
s_add_u32 s27, s25, 1073152
buffer_load_dwordx4 v20, s[16:19], s27 offen lds
s_add_u32 m0, s26, 4096
s_add_u32 s27, s25, 1081344
buffer_load_dwordx4 v20, s[16:19], s27 offen lds
s_add_u32 m0, s26, 5120
s_add_u32 s27, s25, 1089536
buffer_load_dwordx4 v20, s[16:19], s27 offen lds
s_add_u32 m0, s26, 6144
s_add_u32 s27, s25, 1097728
buffer_load_dwordx4 v20, s[16:19], s27 offen lds
s_add_u32 m0, s26, 7168
s_add_u32 s27, s25, 1105920
buffer_load_dwordx4 v20, s[16:19], s27 offen lds
s_waitcnt vmcnt(24)
s_barrier
ds_read_b64_tr_b16 a[32:33], v21 offset:32768
ds_read_b64_tr_b16 a[34:35], v21 offset:33792
ds_read_b64_tr_b16 a[36:37], v22 offset:32768
ds_read_b64_tr_b16 a[38:39], v22 offset:33792
ds_read_b64_tr_b16 a[40:41], v21 offset:40960
ds_read_b64_tr_b16 a[42:43], v21 offset:41984
ds_read_b64_tr_b16 a[44:45], v22 offset:40960
ds_read_b64_tr_b16 a[46:47], v22 offset:41984
s_waitcnt lgkmcnt(0)
ds_read_b64_tr_b16 a[48:49], v21 offset:49152
ds_read_b64_tr_b16 a[50:51], v21 offset:50176
ds_read_b64_tr_b16 a[52:53], v22 offset:49152
ds_read_b64_tr_b16 a[54:55], v22 offset:50176
ds_read_b64_tr_b16 a[56:57], v21 offset:57344
ds_read_b64_tr_b16 a[58:59], v21 offset:58368
ds_read_b64_tr_b16 a[60:61], v22 offset:57344
ds_read_b64_tr_b16 a[62:63], v22 offset:58368
s_waitcnt lgkmcnt(0)
s_barrier
s_add_u32 m0, s26, 32768
s_add_u32 s27, s25, 1310720
buffer_load_dwordx4 v20, s[16:19], s27 offen lds
s_add_u32 m0, s26, 33792
s_add_u32 s27, s25, 1318912
buffer_load_dwordx4 v20, s[16:19], s27 offen lds
s_add_u32 m0, s26, 34816
s_add_u32 s27, s25, 1327104
buffer_load_dwordx4 v20, s[16:19], s27 offen lds
s_add_u32 m0, s26, 35840
s_add_u32 s27, s25, 1335296
buffer_load_dwordx4 v20, s[16:19], s27 offen lds
s_add_u32 m0, s26, 36864
s_add_u32 s27, s25, 1343488
buffer_load_dwordx4 v20, s[16:19], s27 offen lds
s_add_u32 m0, s26, 37888
s_add_u32 s27, s25, 1351680
buffer_load_dwordx4 v20, s[16:19], s27 offen lds
s_add_u32 m0, s26, 38912
s_add_u32 s27, s25, 1359872
buffer_load_dwordx4 v20, s[16:19], s27 offen lds
s_add_u32 m0, s26, 39936
s_add_u32 s27, s25, 1368064
buffer_load_dwordx4 v20, s[16:19], s27 offen lds
s_waitcnt vmcnt(24)
s_barrier
ds_read_b64_tr_b16 a[64:65], v23 offset:0
ds_read_b64_tr_b16 a[66:67], v23 offset:1024
ds_read_b64_tr_b16 a[68:69], v24 offset:0
ds_read_b64_tr_b16 a[70:71], v24 offset:1024
ds_read_b64_tr_b16 a[72:73], v23 offset:8192
ds_read_b64_tr_b16 a[74:75], v23 offset:9216
ds_read_b64_tr_b16 a[76:77], v24 offset:8192
ds_read_b64_tr_b16 a[78:79], v24 offset:9216
s_waitcnt lgkmcnt(0)
ds_read_b64_tr_b16 a[80:81], v23 offset:16384
ds_read_b64_tr_b16 a[82:83], v23 offset:17408
ds_read_b64_tr_b16 a[84:85], v24 offset:16384
ds_read_b64_tr_b16 a[86:87], v24 offset:17408
ds_read_b64_tr_b16 a[88:89], v23 offset:24576
ds_read_b64_tr_b16 a[90:91], v23 offset:25600
ds_read_b64_tr_b16 a[92:93], v24 offset:24576
ds_read_b64_tr_b16 a[94:95], v24 offset:25600
s_waitcnt lgkmcnt(0)
s_barrier
s_add_u32 m0, s26, 65536
s_add_u32 s27, s25, 1572864
buffer_load_dwordx4 v20, s[16:19], s27 offen lds
s_add_u32 m0, s26, 66560
s_add_u32 s27, s25, 1581056
buffer_load_dwordx4 v20, s[16:19], s27 offen lds
s_add_u32 m0, s26, 67584
s_add_u32 s27, s25, 1589248
buffer_load_dwordx4 v20, s[16:19], s27 offen lds
s_add_u32 m0, s26, 68608
s_add_u32 s27, s25, 1597440
buffer_load_dwordx4 v20, s[16:19], s27 offen lds
s_add_u32 m0, s26, 69632
s_add_u32 s27, s25, 1605632
buffer_load_dwordx4 v20, s[16:19], s27 offen lds
s_add_u32 m0, s26, 70656
s_add_u32 s27, s25, 1613824
buffer_load_dwordx4 v20, s[16:19], s27 offen lds
s_add_u32 m0, s26, 71680
s_add_u32 s27, s25, 1622016
buffer_load_dwordx4 v20, s[16:19], s27 offen lds
s_add_u32 m0, s26, 72704
s_add_u32 s27, s25, 1630208
buffer_load_dwordx4 v20, s[16:19], s27 offen lds
s_waitcnt vmcnt(24)
s_barrier
v_mov_b32 v131, 3
buffer_atomic_add v131, v85, s[12:15], s95 offen sc0 sc1
ds_read_b64_tr_b16 a[96:97], v23 offset:32768
ds_read_b64_tr_b16 a[98:99], v23 offset:33792
ds_read_b64_tr_b16 a[100:101], v24 offset:32768
ds_read_b64_tr_b16 a[102:103], v24 offset:33792
ds_read_b64_tr_b16 a[104:105], v23 offset:40960
ds_read_b64_tr_b16 a[106:107], v23 offset:41984
ds_read_b64_tr_b16 a[108:109], v24 offset:40960
ds_read_b64_tr_b16 a[110:111], v24 offset:41984
s_waitcnt lgkmcnt(0)
ds_read_b64_tr_b16 a[112:113], v23 offset:49152
ds_read_b64_tr_b16 a[114:115], v23 offset:50176
ds_read_b64_tr_b16 a[116:117], v24 offset:49152
ds_read_b64_tr_b16 a[118:119], v24 offset:50176
ds_read_b64_tr_b16 a[120:121], v23 offset:57344
ds_read_b64_tr_b16 a[122:123], v23 offset:58368
ds_read_b64_tr_b16 a[124:125], v24 offset:57344
ds_read_b64_tr_b16 a[126:127], v24 offset:58368
s_waitcnt lgkmcnt(0)
s_barrier
s_add_u32 m0, s26, 98304
s_add_u32 s27, s25, 1835008
buffer_load_dwordx4 v20, s[16:19], s27 offen lds
s_add_u32 m0, s26, 99328
s_add_u32 s27, s25, 1843200
buffer_load_dwordx4 v20, s[16:19], s27 offen lds
s_add_u32 m0, s26, 100352
s_add_u32 s27, s25, 1851392
buffer_load_dwordx4 v20, s[16:19], s27 offen lds
s_add_u32 m0, s26, 101376
s_add_u32 s27, s25, 1859584
buffer_load_dwordx4 v20, s[16:19], s27 offen lds
s_add_u32 m0, s26, 102400
s_add_u32 s27, s25, 1867776
buffer_load_dwordx4 v20, s[16:19], s27 offen lds
s_add_u32 m0, s26, 103424
s_add_u32 s27, s25, 1875968
buffer_load_dwordx4 v20, s[16:19], s27 offen lds
s_add_u32 m0, s26, 104448
s_add_u32 s27, s25, 1884160
buffer_load_dwordx4 v20, s[16:19], s27 offen lds
s_add_u32 m0, s26, 105472
s_add_u32 s27, s25, 1892352
buffer_load_dwordx4 v20, s[16:19], s27 offen lds
s_waitcnt vmcnt(24)
s_barrier
ds_read_b64_tr_b16 a[128:129], v21 offset:0
ds_read_b64_tr_b16 a[130:131], v21 offset:1024
ds_read_b64_tr_b16 a[132:133], v22 offset:0
ds_read_b64_tr_b16 a[134:135], v22 offset:1024
ds_read_b64_tr_b16 a[136:137], v21 offset:8192
ds_read_b64_tr_b16 a[138:139], v21 offset:9216
ds_read_b64_tr_b16 a[140:141], v22 offset:8192
ds_read_b64_tr_b16 a[142:143], v22 offset:9216
s_waitcnt lgkmcnt(0)
ds_read_b64_tr_b16 a[144:145], v21 offset:16384
ds_read_b64_tr_b16 a[146:147], v21 offset:17408
ds_read_b64_tr_b16 a[148:149], v22 offset:16384
ds_read_b64_tr_b16 a[150:151], v22 offset:17408
ds_read_b64_tr_b16 a[152:153], v21 offset:24576
ds_read_b64_tr_b16 a[154:155], v21 offset:25600
ds_read_b64_tr_b16 a[156:157], v22 offset:24576
ds_read_b64_tr_b16 a[158:159], v22 offset:25600
s_waitcnt lgkmcnt(0)
s_waitcnt vmcnt(16)
s_barrier
ds_read_b64_tr_b16 a[160:161], v21 offset:32768
ds_read_b64_tr_b16 a[162:163], v21 offset:33792
ds_read_b64_tr_b16 a[164:165], v22 offset:32768
ds_read_b64_tr_b16 a[166:167], v22 offset:33792
ds_read_b64_tr_b16 a[168:169], v21 offset:40960
ds_read_b64_tr_b16 a[170:171], v21 offset:41984
ds_read_b64_tr_b16 a[172:173], v22 offset:40960
ds_read_b64_tr_b16 a[174:175], v22 offset:41984
s_waitcnt lgkmcnt(0)
ds_read_b64_tr_b16 a[176:177], v21 offset:49152
ds_read_b64_tr_b16 a[178:179], v21 offset:50176
ds_read_b64_tr_b16 a[180:181], v22 offset:49152
ds_read_b64_tr_b16 a[182:183], v22 offset:50176
ds_read_b64_tr_b16 a[184:185], v21 offset:57344
ds_read_b64_tr_b16 a[186:187], v21 offset:58368
ds_read_b64_tr_b16 a[188:189], v22 offset:57344
ds_read_b64_tr_b16 a[190:191], v22 offset:58368
s_waitcnt lgkmcnt(0)
s_waitcnt vmcnt(8)
s_barrier
ds_read_b64_tr_b16 a[192:193], v23 offset:0
ds_read_b64_tr_b16 a[194:195], v23 offset:1024
ds_read_b64_tr_b16 a[196:197], v24 offset:0
ds_read_b64_tr_b16 a[198:199], v24 offset:1024
ds_read_b64_tr_b16 a[200:201], v23 offset:8192
ds_read_b64_tr_b16 a[202:203], v23 offset:9216
ds_read_b64_tr_b16 a[204:205], v24 offset:8192
ds_read_b64_tr_b16 a[206:207], v24 offset:9216
s_waitcnt lgkmcnt(0)
ds_read_b64_tr_b16 a[208:209], v23 offset:16384
ds_read_b64_tr_b16 a[210:211], v23 offset:17408
ds_read_b64_tr_b16 a[212:213], v24 offset:16384
ds_read_b64_tr_b16 a[214:215], v24 offset:17408
ds_read_b64_tr_b16 a[216:217], v23 offset:24576
ds_read_b64_tr_b16 a[218:219], v23 offset:25600
ds_read_b64_tr_b16 a[220:221], v24 offset:24576
ds_read_b64_tr_b16 a[222:223], v24 offset:25600
s_waitcnt lgkmcnt(0)
s_waitcnt vmcnt(0)
s_barrier
v_add_u32 v88, 1, v131
v_add_u32 v89, 2, v131
v_add_u32 v90, 3, v131
buffer_store_dwordx3 v[88:90], v85, s[12:15], s60 offen sc1
ds_read_b64_tr_b16 a[224:225], v23 offset:32768
ds_read_b64_tr_b16 a[226:227], v23 offset:33792
ds_read_b64_tr_b16 a[228:229], v24 offset:32768
ds_read_b64_tr_b16 a[230:231], v24 offset:33792
ds_read_b64_tr_b16 a[232:233], v23 offset:40960
ds_read_b64_tr_b16 a[234:235], v23 offset:41984
ds_read_b64_tr_b16 a[236:237], v24 offset:40960
ds_read_b64_tr_b16 a[238:239], v24 offset:41984
s_waitcnt lgkmcnt(0)
ds_read_b64_tr_b16 a[240:241], v23 offset:49152
ds_read_b64_tr_b16 a[242:243], v23 offset:50176
ds_read_b64_tr_b16 a[244:245], v24 offset:49152
ds_read_b64_tr_b16 a[246:247], v24 offset:50176
ds_read_b64_tr_b16 a[248:249], v23 offset:57344
ds_read_b64_tr_b16 a[250:251], v23 offset:58368
ds_read_b64_tr_b16 a[252:253], v24 offset:57344
ds_read_b64_tr_b16 a[254:255], v24 offset:58368
s_waitcnt lgkmcnt(0)
v_mov_b32 v2, 0
L_pl_508:
buffer_load_dword v1, v2, s[12:15], s48 offen sc1
s_add_u32 s36, s36, 1
s_cmp_gt_u32 s36, 0x100000
s_cbranch_scc1 chain_kernel_wend
s_waitcnt vmcnt(0)
v_readfirstlane_b32 s26, v1
s_cmp_ge_u32 s26, 4
s_cbranch_scc1 L_plok_509
s_sleep 4
s_branch L_pl_508
L_plok_509:
s_lshl_b32 s25, s42, 9
s_lshl_b32 s26, s49, 7
s_add_u32 s25, s25, s26
s_lshl_b32 s26, s39, 13
s_add_u32 s25, s25, s26
s_add_u32 s25, s25, 4096
v_bfe_u32 v1, v0, 3, 3
v_and_b32 v2, 7, v0
v_lshlrev_b32 v1, 15, v1
v_lshl_add_u32 v1, v2, 4, v1
v_add_u32 v128, s25, v1
s_lshl_b32 s48, s39, 7
s_add_u32 s48, s48, 0x5904000
s_lshl_b32 s50, s39, 18
s_add_u32 s50, s50, 2048
s_mov_b32 s8, s100
s_and_b32 s9, s101, 0xffff
s_mov_b32 s10, 0x10000000
s_mov_b32 s11, 0x00020000
s_mov_b32 s16, s96
s_and_b32 s17, s97, 0xffff
s_mov_b32 s18, 0x1000000
s_mov_b32 s19, 0x00020000
s_lshl_b32 s39, s39, 4
s_lshl_b32 s21, s49, 12
v_and_b32 v1, 63, v0
v_and_b32 v2, 15, v0
v_bfe_u32 v3, v0, 4, 2
v_lshrrev_b32 v4, 6, v0
v_lshlrev_b32 v5, 4, v1
v_lshl_add_u32 v5, v4, 14, v5
v_add_u32 v8, 0, v5
v_add_u32 v9, 1024, v5
v_add_u32 v10, 4096, v5
v_add_u32 v11, 5120, v5
v_lshlrev_b32 v5, 4, v2
v_lshl_add_u32 v5, v3, 9, v5
v_xor_b32 v12, s39, v5
v_xor_b32 v13, 0x100, v12
v_add_u32 v16, 0x10000, v12
v_add_u32 v17, 0x10000, v13
v_and_b32 v130, 63, v0
v_lshlrev_b32 v130, 2, v130
s_mov_b32 s23, 62
s_mov_b32 s3, 1
L_sw_512:
buffer_load_dword v129, v130, s[12:15], s94 offen sc1
s_add_u32 s36, s36, 1
s_cmp_gt_u32 s36, 0x100000
s_cbranch_scc1 chain_kernel_wend
s_waitcnt vmcnt(0)
v_readlane_b32 s28, v129, s3
s_cmp_lg_u32 s28, 0
s_cbranch_scc1 L_sok_511
s_sleep 1
s_branch L_sw_512
L_sok_511:
s_cmp_gt_u32 s28, 64
s_cselect_b32 s3, s3, 64
s_min_u32 s23, s23, s3
s_sub_u32 s61, s23, 1
s_mov_b32 s3, 0
v_readlane_b32 s28, v129, 0
s_cmp_lg_u32 s28, 0
s_cbranch_scc1 L_sok_513
L_sw_514:
buffer_load_dword v129, v130, s[12:15], s94 offen sc1
s_add_u32 s36, s36, 1
s_cmp_gt_u32 s36, 0x100000
s_cbranch_scc1 chain_kernel_wend
s_waitcnt vmcnt(0)
v_readlane_b32 s28, v129, s3
s_cmp_lg_u32 s28, 0
s_cbranch_scc1 L_sok_513
s_sleep 1
s_branch L_sw_514
L_sok_513:
s_cmp_gt_u32 s28, 64
s_cselect_b32 s3, s3, 64
s_min_u32 s23, s23, s3
s_sub_u32 s61, s23, 1
s_cmp_eq_u32 s23, 0
s_cbranch_scc1 L_opdone_510
s_mov_b32 s52, 0
v_mov_b32 v4, 0
s_mov_b32 s22, 0
s_sub_u32 s61, s23, 1
s_mov_b32 s24, s22
s_add_u32 s51, s24, 0
s_min_u32 s51, s51, s61
v_readlane_b32 s51, v129, s51
s_nop 0
s_nop 0
s_sub_u32 s51, s51, 1
s_lshl_b32 s51, s51, 9
s_add_u32 s51, s51, s48
L_gw_516:
buffer_load_dword v87, v4, s[12:15], s51 offen sc1
s_add_u32 s36, s36, 1
s_cmp_gt_u32 s36, 0x100000
s_cbranch_scc1 chain_kernel_wend
s_waitcnt vmcnt(0)
v_readfirstlane_b32 s30, v87
s_cmp_lt_u32 s30, 8
s_cbranch_scc0 L_rgo_515
s_sleep 1
s_branch L_gw_516
L_rgo_515:
s_add_u32 s51, s24, 1
s_min_u32 s51, s51, s61
v_readlane_b32 s51, v129, s51
s_nop 0
s_nop 0
s_sub_u32 s51, s51, 1
s_lshl_b32 s51, s51, 9
s_add_u32 s51, s51, s48
buffer_load_dword v87, v4, s[12:15], s51 offen sc1
s_mov_b32 s37, 0
s_mov_b32 s7, 0
v_mov_b32 v88, 0
v_mov_b32 v89, 0
v_mov_b32 v90, 0
v_mov_b32 v91, 0
v_mov_b32 v92, 0
v_mov_b32 v93, 0
v_mov_b32 v94, 0
v_mov_b32 v95, 0
s_mov_b32 s30, s24
v_readlane_b32 s30, v129, s30
s_nop 0
s_nop 0
s_sub_u32 s30, s30, 1
s_bitcmp1_b32 s30, 1
s_cselect_b32 s53, s54, s55
s_lshl_b32 s30, s30, 20
s_add_u32 s53, s53, s30
s_add_u32 s53, s53, s50
s_mov_b32 s20, s53
s_mov_b32 s39, 0x7ff00000
s_mov_b32 s42, 0x7ff00000
s_mov_b32 s43, 0x7ff00000
s_barrier
s_add_u32 m0, s21, 0
s_nop 0
buffer_load_dwordx4 v8, s[8:11], s20 offen lds
s_add_u32 m0, s21, 1024
s_nop 0
buffer_load_dwordx4 v9, s[8:11], s20 offen lds
s_add_u32 m0, s21, 2048
s_nop 0
buffer_load_dwordx4 v10, s[8:11], s20 offen lds
s_add_u32 m0, s21, 3072
s_nop 0
buffer_load_dwordx4 v11, s[8:11], s20 offen lds
s_add_u32 s20, s20, 65536
s_add_u32 m0, s21, 16384
s_nop 0
buffer_load_dwordx4 v8, s[8:11], s20 offen lds
s_add_u32 m0, s21, 17408
s_nop 0
buffer_load_dwordx4 v9, s[8:11], s20 offen lds
s_add_u32 m0, s21, 18432
s_nop 0
buffer_load_dwordx4 v10, s[8:11], s20 offen lds
s_add_u32 m0, s21, 19456
s_nop 0
buffer_load_dwordx4 v11, s[8:11], s20 offen lds
s_add_u32 s20, s20, 65536
s_add_u32 m0, s21, 32768
s_nop 0
buffer_load_dwordx4 v8, s[8:11], s20 offen lds
s_add_u32 m0, s21, 33792
s_nop 0
buffer_load_dwordx4 v9, s[8:11], s20 offen lds
s_add_u32 m0, s21, 34816
s_nop 0
buffer_load_dwordx4 v10, s[8:11], s20 offen lds
s_add_u32 m0, s21, 35840
s_nop 0
buffer_load_dwordx4 v11, s[8:11], s20 offen lds
s_add_u32 s20, s20, 65536
s_add_u32 m0, s21, 49152
s_nop 0
buffer_load_dwordx4 v8, s[8:11], s20 offen lds
s_waitcnt vmcnt(0)
s_barrier
ds_read_b128 v[20:23], v12 offset:0
ds_read_b128 v[24:27], v13 offset:0
ds_read_b128 v[28:31], v12 offset:2048
ds_read_b128 v[32:35], v13 offset:2048
ds_read_b128 v[36:39], v12 offset:4096
ds_read_b128 v[40:43], v13 offset:4096
s_waitcnt lgkmcnt(4)
L_st_520:
v_mfma_f32_16x16x32_bf16 v[52:55], v[20:23], a[0:3], 0
ds_read_b128 v[44:47], v12 offset:6144
s_add_u32 m0, s21, 50176
s_cmp_lt_u32 s22, 57
s_cselect_b32 s27, 1, 0
s_cselect_b32 s26, 1, 0x80
v_mfma_f32_16x16x32_bf16 v[56:59], v[20:23], a[4:7], 0
buffer_load_dwordx4 v9, s[8:11], s20 offen lds
s_sub_u32 s38, s22, 1
v_mfma_f32_16x16x32_bf16 v[60:63], v[24:27], a[0:3], 0
ds_read_b128 v[48:51], v13 offset:6144
s_and_b32 s31, s38, 3
s_lshl_b32 s31, s31, 11
v_mfma_f32_16x16x32_bf16 v[64:67], v[24:27], a[4:7], 0
s_waitcnt lgkmcnt(4)
s_bfe_u32 s38, s38, 0x10002
v_mfma_f32_16x16x32_bf16 v[52:55], v[28:31], a[8:11], v[52:55]
ds_read_b128 v[20:23], v12 offset:8192
v_mov_b32 v131, s27
s_xor_b32 s38, s38, 1
v_mfma_f32_16x16x32_bf16 v[56:59], v[28:31], a[12:15], v[56:59]
buffer_atomic_add v131, v85, s[12:15], s95 offen sc0 sc1
v_mfma_f32_16x16x32_bf16 v[60:63], v[32:35], a[8:11], v[60:63]
ds_read_b128 v[24:27], v13 offset:8192
s_add_u32 s24, s24, 1
s_min_u32 s24, s24, s61
s_cmp_eq_u32 s37, 0
s_cselect_b32 s31, 0x40000000, s31
s_cselect_b32 s38, 0, s38
v_mfma_f32_16x16x32_bf16 v[64:67], v[32:35], a[12:15], v[64:67]
s_waitcnt lgkmcnt(4)
s_mov_b32 s30, s24
v_readlane_b32 s30, v129, s30
v_mfma_f32_16x16x32_bf16 v[52:55], v[36:39], a[16:19], v[52:55]
ds_read_b128 v[28:31], v12 offset:10240
s_add_u32 m0, s21, 51200
s_nop 0
v_mfma_f32_16x16x32_bf16 v[56:59], v[36:39], a[20:23], v[56:59]
buffer_load_dwordx4 v10, s[8:11], s20 offen lds
v_mfma_f32_16x16x32_bf16 v[60:63], v[40:43], a[16:19], v[60:63]
ds_read_b128 v[32:35], v13 offset:10240
s_nop 0
s_sub_u32 s30, s30, 1
v_mfma_f32_16x16x32_bf16 v[64:67], v[40:43], a[20:23], v[64:67]
s_waitcnt lgkmcnt(4)
s_bitcmp1_b32 s30, 1
s_cselect_b32 s53, s54, s55
v_mfma_f32_16x16x32_bf16 v[52:55], v[44:47], a[24:27], v[52:55]
ds_read_b128 v[36:39], v12 offset:12288
s_lshl_b32 s30, s30, 20
v_cvt_pk_bf16_f32 v104, v69, v73
v_mfma_f32_16x16x32_bf16 v[56:59], v[44:47], a[28:31], v[56:59]
s_add_u32 s53, s53, s30
buffer_load_dword v129, v130, s[12:15], s94 offen sc1
v_mfma_f32_16x16x32_bf16 v[60:63], v[48:51], a[24:27], v[60:63]
ds_read_b128 v[40:43], v13 offset:12288
s_add_u32 s53, s53, s50
s_waitcnt vmcnt(13)
v_cvt_pk_bf16_f32 v105, v77, v81
v_mfma_f32_16x16x32_bf16 v[64:67], v[48:51], a[28:31], v[64:67]
s_waitcnt lgkmcnt(4)
v_readfirstlane_b32 s30, v87
s_nop 0
v_mfma_f32_16x16x32_bf16 v[52:55], v[20:23], a[32:35], v[52:55]
ds_read_b128 v[44:47], v12 offset:14336
s_add_u32 m0, s21, 52224
v_and_or_b32 v104, v104, -2, s38
v_mfma_f32_16x16x32_bf16 v[56:59], v[20:23], a[36:39], v[56:59]
buffer_load_dwordx4 v11, s[8:11], s20 offen lds
s_nop 0
v_mfma_f32_16x16x32_bf16 v[60:63], v[24:27], a[32:35], v[60:63]
ds_read_b128 v[48:51], v13 offset:14336
s_cmp_lt_u32 s30, 8
s_cbranch_scc1 L_gw_526
L_gok_525:
v_mfma_f32_16x16x32_bf16 v[64:67], v[24:27], a[36:39], v[64:67]
s_waitcnt lgkmcnt(4)
v_and_or_b32 v105, v105, -2, s38
s_add_u32 s29, s45, s31
v_mfma_f32_16x16x32_bf16 v[52:55], v[28:31], a[40:43], v[52:55]
s_waitcnt vmcnt(15)
s_barrier
ds_read_b128 v[20:23], v12 offset:16384
v_mfma_f32_16x16x32_bf16 v[56:59], v[28:31], a[44:47], v[56:59]
s_mov_b32 s20, s53
buffer_store_dwordx2 v[104:105], v112, s[12:15], s29 offen offset:0 sc1
v_mfma_f32_16x16x32_bf16 v[60:63], v[32:35], a[40:43], v[60:63]
ds_read_b128 v[24:27], v13 offset:16384
v_cvt_pk_bf16_f32 v106, v70, v74
v_mfma_f32_16x16x32_bf16 v[64:67], v[32:35], a[44:47], v[64:67]
s_waitcnt lgkmcnt(4)
v_cvt_pk_bf16_f32 v107, v78, v82
v_mfma_f32_16x16x32_bf16 v[52:55], v[36:39], a[48:51], v[52:55]
ds_read_b128 v[28:31], v12 offset:18432
s_add_u32 m0, s21, 65536
v_mfma_f32_16x16x32_bf16 v[56:59], v[36:39], a[52:55], v[56:59]
buffer_load_dwordx4 v8, s[8:11], s20 offen lds
v_mfma_f32_16x16x32_bf16 v[60:63], v[40:43], a[48:51], v[60:63]
ds_read_b128 v[32:35], v13 offset:18432
v_and_or_b32 v106, v106, -2, s38
v_mfma_f32_16x16x32_bf16 v[64:67], v[40:43], a[52:55], v[64:67]
s_waitcnt lgkmcnt(4)
v_and_or_b32 v107, v107, -2, s38
v_mfma_f32_16x16x32_bf16 v[52:55], v[44:47], a[56:59], v[52:55]
ds_read_b128 v[36:39], v12 offset:20480
s_add_u32 s29, s46, s31
v_mfma_f32_16x16x32_bf16 v[56:59], v[44:47], a[60:63], v[56:59]
buffer_store_dwordx2 v[106:107], v112, s[12:15], s29 offen offset:512 sc1
v_mfma_f32_16x16x32_bf16 v[60:63], v[48:51], a[56:59], v[60:63]
ds_read_b128 v[40:43], v13 offset:20480
v_cvt_pk_bf16_f32 v108, v71, v75
v_mfma_f32_16x16x32_bf16 v[64:67], v[48:51], a[60:63], v[64:67]
s_waitcnt lgkmcnt(4)
v_cvt_pk_bf16_f32 v109, v79, v83
v_mfma_f32_16x16x32_bf16 v[52:55], v[20:23], a[64:67], v[52:55]
ds_read_b128 v[44:47], v12 offset:22528
s_add_u32 m0, s21, 66560
v_mfma_f32_16x16x32_bf16 v[56:59], v[20:23], a[68:71], v[56:59]
buffer_load_dwordx4 v9, s[8:11], s20 offen lds
v_mfma_f32_16x16x32_bf16 v[60:63], v[24:27], a[64:67], v[60:63]
ds_read_b128 v[48:51], v13 offset:22528
v_and_or_b32 v108, v108, -2, s38
v_mfma_f32_16x16x32_bf16 v[64:67], v[24:27], a[68:71], v[64:67]
s_waitcnt lgkmcnt(4)
v_and_or_b32 v109, v109, -2, s38
v_mfma_f32_16x16x32_bf16 v[52:55], v[28:31], a[72:75], v[52:55]
ds_read_b128 v[20:23], v12 offset:24576
s_add_u32 s29, s47, s31
v_mfma_f32_16x16x32_bf16 v[56:59], v[28:31], a[76:79], v[56:59]
buffer_store_dwordx2 v[108:109], v112, s[12:15], s29 offen offset:1024 sc1
v_mfma_f32_16x16x32_bf16 v[60:63], v[32:35], a[72:75], v[60:63]
ds_read_b128 v[24:27], v13 offset:24576
v_mfma_f32_16x16x32_bf16 v[64:67], v[32:35], a[76:79], v[64:67]
s_waitcnt lgkmcnt(4)
v_mfma_f32_16x16x32_bf16 v[52:55], v[36:39], a[80:83], v[52:55]
ds_read_b128 v[28:31], v12 offset:26624
s_add_u32 m0, s21, 67584
v_mfma_f32_16x16x32_bf16 v[56:59], v[36:39], a[84:87], v[56:59]
buffer_load_dwordx4 v10, s[8:11], s20 offen lds
v_mfma_f32_16x16x32_bf16 v[60:63], v[40:43], a[80:83], v[60:63]
ds_read_b128 v[32:35], v13 offset:26624
v_mfma_f32_16x16x32_bf16 v[64:67], v[40:43], a[84:87], v[64:67]
s_waitcnt lgkmcnt(4)
v_mfma_f32_16x16x32_bf16 v[52:55], v[44:47], a[88:91], v[52:55]
ds_read_b128 v[36:39], v12 offset:28672
v_mfma_f32_16x16x32_bf16 v[56:59], v[44:47], a[92:95], v[56:59]
v_mfma_f32_16x16x32_bf16 v[60:63], v[48:51], a[88:91], v[60:63]
ds_read_b128 v[40:43], v13 offset:28672
v_mfma_f32_16x16x32_bf16 v[64:67], v[48:51], a[92:95], v[64:67]
s_waitcnt lgkmcnt(4)
v_mfma_f32_16x16x32_bf16 v[52:55], v[20:23], a[96:99], v[52:55]
ds_read_b128 v[44:47], v12 offset:30720
s_add_u32 m0, s21, 68608
v_mfma_f32_16x16x32_bf16 v[56:59], v[20:23], a[100:103], v[56:59]
buffer_load_dwordx4 v11, s[8:11], s20 offen lds
v_mfma_f32_16x16x32_bf16 v[60:63], v[24:27], a[96:99], v[60:63]
ds_read_b128 v[48:51], v13 offset:30720
v_mfma_f32_16x16x32_bf16 v[64:67], v[24:27], a[100:103], v[64:67]
s_waitcnt lgkmcnt(4)
v_mfma_f32_16x16x32_bf16 v[52:55], v[28:31], a[104:107], v[52:55]
s_waitcnt vmcnt(15)
s_barrier
ds_read_b128 v[20:23], v12 offset:32768
v_mfma_f32_16x16x32_bf16 v[56:59], v[28:31], a[108:111], v[56:59]
s_add_u32 s20, s20, 65536
v_mfma_f32_16x16x32_bf16 v[60:63], v[32:35], a[104:107], v[60:63]
ds_read_b128 v[24:27], v13 offset:32768
v_mfma_f32_16x16x32_bf16 v[64:67], v[32:35], a[108:111], v[64:67]
s_waitcnt lgkmcnt(4)
v_mfma_f32_16x16x32_bf16 v[52:55], v[36:39], a[112:115], v[52:55]
ds_read_b128 v[28:31], v12 offset:34816
s_add_u32 m0, s21, 81920
s_waitcnt vmcnt(12)
v_xor_b32 v124, s7, v88
v_mfma_f32_16x16x32_bf16 v[56:59], v[36:39], a[116:119], v[56:59]
buffer_load_dwordx4 v8, s[8:11], s20 offen lds
v_bitop3_b32 v124, v124, v89, s7 bitop3:0xf6
v_mfma_f32_16x16x32_bf16 v[60:63], v[40:43], a[112:115], v[60:63]
ds_read_b128 v[32:35], v13 offset:34816
v_bitop3_b32 v124, v124, v90, s7 bitop3:0xf6
v_bitop3_b32 v124, v124, v91, s7 bitop3:0xf6
v_mfma_f32_16x16x32_bf16 v[64:67], v[40:43], a[116:119], v[64:67]
s_waitcnt lgkmcnt(4)
v_bitop3_b32 v124, v124, v92, s7 bitop3:0xf6
v_bitop3_b32 v124, v124, v93, s7 bitop3:0xf6
v_mfma_f32_16x16x32_bf16 v[52:55], v[44:47], a[120:123], v[52:55]
ds_read_b128 v[36:39], v12 offset:36864
s_lshl_b32 s27, s22, 2
v_and_b32 v124, 1, v124
v_cmp_ne_u32 vcc, 0, v124
v_mfma_f32_16x16x32_bf16 v[56:59], v[44:47], a[124:127], v[56:59]
s_add_u32 s3, s22, 2
s_waitcnt vmcnt(9)
s_nop 0
v_mfma_f32_16x16x32_bf16 v[60:63], v[48:51], a[120:123], v[60:63]
ds_read_b128 v[40:43], v13 offset:36864
v_readlane_b32 s28, v129, s3
s_nop 0
s_nop 0
v_mfma_f32_16x16x32_bf16 v[64:67], v[48:51], a[124:127], v[64:67]
s_waitcnt lgkmcnt(4)
s_nop 0
s_cbranch_vccnz L_rbad_521
L_rok_522:
v_mfma_f32_16x16x32_bf16 v[52:55], v[20:23], a[128:131], v[52:55]
ds_read_b128 v[44:47], v12 offset:38912
s_add_u32 m0, s21, 82944
v_mfma_f32_16x16x32_bf16 v[56:59], v[20:23], a[132:135], v[56:59]
buffer_load_dwordx4 v9, s[8:11], s20 offen lds
s_nop 0
v_lshlrev_b32 v124, 16, v88
v_mfma_f32_16x16x32_bf16 v[60:63], v[24:27], a[128:131], v[60:63]
ds_read_b128 v[48:51], v13 offset:38912
s_cmp_eq_u32 s28, 0
s_cbranch_scc1 L_sw_524
L_sok_523:
v_mfma_f32_16x16x32_bf16 v[64:67], v[24:27], a[132:135], v[64:67]
s_waitcnt lgkmcnt(4)
s_add_u32 s27, s27, s60
v_and_b32 v125, 0xffff0000, v88
v_mfma_f32_16x16x32_bf16 v[52:55], v[28:31], a[136:139], v[52:55]
ds_read_b128 v[20:23], v12 offset:40960
s_waitcnt vmcnt(12)
v_and_b32 v124, 0xfffe0000, v124
v_add_f32 v96, v116, v124
v_mfma_f32_16x16x32_bf16 v[56:59], v[28:31], a[140:143], v[56:59]
s_cmp_gt_u32 s28, 64
s_cselect_b32 s3, s3, 64
v_add_f32 v97, v117, v125
v_mfma_f32_16x16x32_bf16 v[60:63], v[32:35], a[136:139], v[60:63]
ds_read_b128 v[24:27], v13 offset:40960
v_add_u32 v131, s26, v131
v_lshlrev_b32 v124, 16, v89
v_and_b32 v125, 0xffff0000, v89
v_mfma_f32_16x16x32_bf16 v[64:67], v[32:35], a[140:143], v[64:67]
s_waitcnt lgkmcnt(4)
s_min_u32 s23, s23, s3
v_and_b32 v124, 0xfffe0000, v124
v_mfma_f32_16x16x32_bf16 v[52:55], v[36:39], a[144:147], v[52:55]
ds_read_b128 v[28:31], v12 offset:43008
s_add_u32 m0, s21, 83968
s_sub_u32 s61, s23, 1
v_add_f32 v98, v118, v124
v_mfma_f32_16x16x32_bf16 v[56:59], v[36:39], a[148:151], v[56:59]
buffer_load_dwordx4 v10, s[8:11], s20 offen lds
v_add_f32 v99, v119, v125
v_mfma_f32_16x16x32_bf16 v[60:63], v[40:43], a[144:147], v[60:63]
ds_read_b128 v[32:35], v13 offset:43008
s_add_u32 s51, s24, 1
v_lshlrev_b32 v124, 16, v90
v_mfma_f32_16x16x32_bf16 v[64:67], v[40:43], a[148:151], v[64:67]
s_waitcnt lgkmcnt(4)
s_min_u32 s51, s51, s61
v_and_b32 v125, 0xffff0000, v90
v_and_b32 v124, 0xfffe0000, v124
v_mfma_f32_16x16x32_bf16 v[52:55], v[44:47], a[152:155], v[52:55]
ds_read_b128 v[36:39], v12 offset:45056
v_readlane_b32 s51, v129, s51
v_add_f32 v96, v96, v124
v_mfma_f32_16x16x32_bf16 v[56:59], v[44:47], a[156:159], v[56:59]
s_nop 0
buffer_store_dword v131, v85, s[12:15], s27 offen offset:12 sc1
v_add_f32 v97, v97, v125
v_mfma_f32_16x16x32_bf16 v[60:63], v[48:51], a[152:155], v[60:63]
ds_read_b128 v[40:43], v13 offset:45056
s_nop 0
v_lshlrev_b32 v124, 16, v91
v_mfma_f32_16x16x32_bf16 v[64:67], v[48:51], a[156:159], v[64:67]
s_waitcnt lgkmcnt(4)
s_sub_u32 s51, s51, 1
v_and_b32 v125, 0xffff0000, v91
v_and_b32 v124, 0xfffe0000, v124
v_mfma_f32_16x16x32_bf16 v[52:55], v[20:23], a[160:163], v[52:55]
ds_read_b128 v[44:47], v12 offset:47104
s_add_u32 m0, s21, 84992
v_add_f32 v98, v98, v124
v_mfma_f32_16x16x32_bf16 v[56:59], v[20:23], a[164:167], v[56:59]
buffer_load_dwordx4 v11, s[8:11], s20 offen lds
s_lshl_b32 s51, s51, 9
v_add_f32 v99, v99, v125
v_mfma_f32_16x16x32_bf16 v[60:63], v[24:27], a[160:163], v[60:63]
ds_read_b128 v[48:51], v13 offset:47104
s_add_u32 s51, s51, s48
v_lshlrev_b32 v124, 16, v92
v_mfma_f32_16x16x32_bf16 v[64:67], v[24:27], a[164:167], v[64:67]
s_waitcnt lgkmcnt(4)
v_and_b32 v125, 0xffff0000, v92
v_and_b32 v124, 0xfffe0000, v124
v_mfma_f32_16x16x32_bf16 v[52:55], v[28:31], a[168:171], v[52:55]
s_waitcnt vmcnt(12)
s_barrier
ds_read_b128 v[20:23], v12 offset:49152
v_add_f32 v96, v96, v124
v_mfma_f32_16x16x32_bf16 v[56:59], v[28:31], a[172:175], v[56:59]
s_add_u32 s20, s20, 65536
buffer_load_dword v87, v4, s[12:15], s51 offen sc1
v_add_f32 v97, v97, v125
v_mfma_f32_16x16x32_bf16 v[60:63], v[32:35], a[168:171], v[60:63]
ds_read_b128 v[24:27], v13 offset:49152
v_lshlrev_b32 v124, 16, v93
v_and_b32 v125, 0xffff0000, v93
v_mfma_f32_16x16x32_bf16 v[64:67], v[32:35], a[172:175], v[64:67]
s_waitcnt lgkmcnt(4)
v_and_b32 v124, 0xfffe0000, v124
v_add_f32 v98, v98, v124
v_mfma_f32_16x16x32_bf16 v[52:55], v[36:39], a[176:179], v[52:55]
ds_read_b128 v[28:31], v12 offset:51200
s_add_u32 m0, s21, 98304
v_add_f32 v99, v99, v125
v_mfma_f32_16x16x32_bf16 v[56:59], v[36:39], a[180:183], v[56:59]
buffer_load_dwordx4 v8, s[8:11], s20 offen lds
ds_write2_b32 v114, v96, v97 offset0:0 offset1:16
v_mfma_f32_16x16x32_bf16 v[60:63], v[40:43], a[176:179], v[60:63]
ds_read_b128 v[32:35], v13 offset:51200
ds_write2_b32 v114, v98, v99 offset0:128 offset1:144
ds_read_b128 v[88:91], v113 offset:0
v_mfma_f32_16x16x32_bf16 v[64:67], v[40:43], a[180:183], v[64:67]
s_waitcnt lgkmcnt(4)
v_mfma_f32_16x16x32_bf16 v[52:55], v[44:47], a[184:187], v[52:55]
ds_read_b128 v[36:39], v12 offset:53248
v_mfma_f32_16x16x32_bf16 v[56:59], v[44:47], a[188:191], v[56:59]
v_mfma_f32_16x16x32_bf16 v[60:63], v[48:51], a[184:187], v[60:63]
ds_read_b128 v[40:43], v13 offset:53248
s_waitcnt lgkmcnt(2)
v_mfma_f32_16x16x32_bf16 v[64:67], v[48:51], a[188:191], v[64:67]
s_waitcnt lgkmcnt(4)
v_cvt_pk_bf16_f32 v96, 0, v88
v_mfma_f32_16x16x32_bf16 v[52:55], v[20:23], a[192:195], v[52:55]
ds_read_b128 v[44:47], v12 offset:55296
s_add_u32 m0, s21, 99328
v_mfma_f32_16x16x32_bf16 v[56:59], v[20:23], a[196:199], v[56:59]
buffer_load_dwordx4 v9, s[8:11], s20 offen lds
v_mfma_f32_16x16x32_bf16 v[60:63], v[24:27], a[192:195], v[60:63]
ds_read_b128 v[48:51], v13 offset:55296
v_cvt_pk_bf16_f32 v97, 0, v89
v_mfma_f32_16x16x32_bf16 v[64:67], v[24:27], a[196:199], v[64:67]
s_waitcnt lgkmcnt(4)
v_cvt_pk_bf16_f32 v98, 0, v90
v_mfma_f32_16x16x32_bf16 v[52:55], v[28:31], a[200:203], v[52:55]
ds_read_b128 v[20:23], v12 offset:57344
v_cvt_pk_bf16_f32 v99, 0, v91
v_mfma_f32_16x16x32_bf16 v[56:59], v[28:31], a[204:207], v[56:59]
buffer_store_dwordx4 v[96:99], v128, s[16:19], s43 offen
v_mfma_f32_16x16x32_bf16 v[60:63], v[32:35], a[200:203], v[60:63]
ds_read_b128 v[24:27], v13 offset:57344
v_mfma_f32_16x16x32_bf16 v[64:67], v[32:35], a[204:207], v[64:67]
s_waitcnt lgkmcnt(4)
v_mfma_f32_16x16x32_bf16 v[52:55], v[36:39], a[208:211], v[52:55]
ds_read_b128 v[28:31], v12 offset:59392
s_add_u32 m0, s21, 100352
v_mov_b32 v116, v68
v_mov_b32 v117, v72
v_mfma_f32_16x16x32_bf16 v[56:59], v[36:39], a[212:215], v[56:59]
buffer_load_dwordx4 v10, s[8:11], s20 offen lds
v_mov_b32 v118, v76
v_mov_b32 v119, v80
v_mfma_f32_16x16x32_bf16 v[60:63], v[40:43], a[208:211], v[60:63]
ds_read_b128 v[32:35], v13 offset:59392
s_mov_b32 s7, s38
s_add_u32 s39, s44, s31
s_sub_u32 s43, s22, 1
v_mfma_f32_16x16x32_bf16 v[64:67], v[40:43], a[212:215], v[64:67]
s_waitcnt lgkmcnt(4)
s_and_b32 s43, s43, 63
v_readlane_b32 s43, v129, s43
s_nop 0
v_mfma_f32_16x16x32_bf16 v[52:55], v[44:47], a[216:219], v[52:55]
ds_read_b128 v[36:39], v12 offset:61440
s_nop 0
s_sub_u32 s43, s43, 1
s_lshl_b32 s43, s43, 18
v_mfma_f32_16x16x32_bf16 v[56:59], v[44:47], a[220:223], v[56:59]
s_cmp_eq_u32 s37, 0
s_cselect_b32 s43, 0x7ff00000, s43
buffer_load_dwordx2 v[88:89], v112, s[12:15], s39 offen offset:0 sc1
v_mfma_f32_16x16x32_bf16 v[60:63], v[48:51], a[216:219], v[60:63]
ds_read_b128 v[40:43], v13 offset:61440
v_mfma_f32_16x16x32_bf16 v[64:67], v[48:51], a[220:223], v[64:67]
s_waitcnt lgkmcnt(4)
v_mfma_f32_16x16x32_bf16 v[52:55], v[20:23], a[224:227], v[52:55]
ds_read_b128 v[44:47], v12 offset:63488
s_add_u32 m0, s21, 101376
v_mfma_f32_16x16x32_bf16 v[56:59], v[20:23], a[228:231], v[56:59]
buffer_load_dwordx4 v11, s[8:11], s20 offen lds
v_mfma_f32_16x16x32_bf16 v[60:63], v[24:27], a[224:227], v[60:63]
ds_read_b128 v[48:51], v13 offset:63488
v_mfma_f32_16x16x32_bf16 v[64:67], v[24:27], a[228:231], v[64:67]
s_waitcnt lgkmcnt(4)
v_mfma_f32_16x16x32_bf16 v[52:55], v[28:31], a[232:235], v[52:55]
s_waitcnt vmcnt(12)
s_barrier
ds_read_b128 v[20:23], v16 offset:0
v_mfma_f32_16x16x32_bf16 v[56:59], v[28:31], a[236:239], v[56:59]
s_add_u32 s20, s20, 65536
buffer_load_dwordx2 v[90:91], v112, s[12:15], s39 offen offset:512 sc1
v_mfma_f32_16x16x32_bf16 v[60:63], v[32:35], a[232:235], v[60:63]
ds_read_b128 v[24:27], v17 offset:0
v_mfma_f32_16x16x32_bf16 v[64:67], v[32:35], a[236:239], v[64:67]
s_waitcnt lgkmcnt(4)
v_mfma_f32_16x16x32_bf16 v[52:55], v[36:39], a[240:243], v[52:55]
ds_read_b128 v[28:31], v16 offset:2048
s_add_u32 m0, s21, 114688
v_mfma_f32_16x16x32_bf16 v[56:59], v[36:39], a[244:247], v[56:59]
buffer_load_dwordx4 v8, s[8:11], s20 offen lds
v_mfma_f32_16x16x32_bf16 v[60:63], v[40:43], a[240:243], v[60:63]
ds_read_b128 v[32:35], v17 offset:2048
v_mfma_f32_16x16x32_bf16 v[64:67], v[40:43], a[244:247], v[64:67]
s_waitcnt lgkmcnt(4)
v_mfma_f32_16x16x32_bf16 v[52:55], v[44:47], a[248:251], v[52:55]
ds_read_b128 v[36:39], v16 offset:4096
v_mfma_f32_16x16x32_bf16 v[56:59], v[44:47], a[252:255], v[56:59]
buffer_load_dwordx2 v[92:93], v112, s[12:15], s39 offen offset:1024 sc1
v_mfma_f32_16x16x32_bf16 v[60:63], v[48:51], a[248:251], v[60:63]
ds_read_b128 v[40:43], v17 offset:4096
s_mov_b32 s37, 1
v_mfma_f32_16x16x32_bf16 v[64:67], v[48:51], a[252:255], v[64:67]
s_waitcnt lgkmcnt(4)
s_add_u32 s22, s22, 1
s_cmp_ge_u32 s22, s23
s_cbranch_scc1 L_fl0_517
v_mfma_f32_16x16x32_bf16 v[68:71], v[20:23], a[0:3], 0
ds_read_b128 v[44:47], v16 offset:6144
s_add_u32 m0, s21, 115712
s_cmp_lt_u32 s22, 57
s_cselect_b32 s27, 1, 0
s_cselect_b32 s26, 1, 0x80
v_mfma_f32_16x16x32_bf16 v[72:75], v[20:23], a[4:7], 0
buffer_load_dwordx4 v9, s[8:11], s20 offen lds
s_sub_u32 s38, s22, 1
v_mfma_f32_16x16x32_bf16 v[76:79], v[24:27], a[0:3], 0
ds_read_b128 v[48:51], v17 offset:6144
s_and_b32 s31, s38, 3
s_lshl_b32 s31, s31, 11
v_mfma_f32_16x16x32_bf16 v[80:83], v[24:27], a[4:7], 0
s_waitcnt lgkmcnt(4)
s_bfe_u32 s38, s38, 0x10002
v_mfma_f32_16x16x32_bf16 v[68:71], v[28:31], a[8:11], v[68:71]
ds_read_b128 v[20:23], v16 offset:8192
v_mov_b32 v131, s27
s_xor_b32 s38, s38, 1
v_mfma_f32_16x16x32_bf16 v[72:75], v[28:31], a[12:15], v[72:75]
buffer_atomic_add v131, v85, s[12:15], s95 offen sc0 sc1
v_mfma_f32_16x16x32_bf16 v[76:79], v[32:35], a[8:11], v[76:79]
ds_read_b128 v[24:27], v17 offset:8192
s_add_u32 s24, s24, 1
s_min_u32 s24, s24, s61
s_cmp_eq_u32 s37, 0
s_cselect_b32 s31, 0x40000000, s31
s_cselect_b32 s38, 0, s38
v_mfma_f32_16x16x32_bf16 v[80:83], v[32:35], a[12:15], v[80:83]
s_waitcnt lgkmcnt(4)
s_mov_b32 s30, s24
v_readlane_b32 s30, v129, s30
v_mfma_f32_16x16x32_bf16 v[68:71], v[36:39], a[16:19], v[68:71]
ds_read_b128 v[28:31], v16 offset:10240
s_add_u32 m0, s21, 116736
s_nop 0
v_mfma_f32_16x16x32_bf16 v[72:75], v[36:39], a[20:23], v[72:75]
buffer_load_dwordx4 v10, s[8:11], s20 offen lds
v_mfma_f32_16x16x32_bf16 v[76:79], v[40:43], a[16:19], v[76:79]
ds_read_b128 v[32:35], v17 offset:10240
s_nop 0
s_sub_u32 s30, s30, 1
v_mfma_f32_16x16x32_bf16 v[80:83], v[40:43], a[20:23], v[80:83]
s_waitcnt lgkmcnt(4)
s_bitcmp1_b32 s30, 1
s_cselect_b32 s53, s54, s55
v_mfma_f32_16x16x32_bf16 v[68:71], v[44:47], a[24:27], v[68:71]
ds_read_b128 v[36:39], v16 offset:12288
s_lshl_b32 s30, s30, 20
v_cvt_pk_bf16_f32 v104, v53, v57
v_mfma_f32_16x16x32_bf16 v[72:75], v[44:47], a[28:31], v[72:75]
s_add_u32 s53, s53, s30
buffer_load_dword v129, v130, s[12:15], s94 offen sc1
v_mfma_f32_16x16x32_bf16 v[76:79], v[48:51], a[24:27], v[76:79]
ds_read_b128 v[40:43], v17 offset:12288
s_add_u32 s53, s53, s50
s_waitcnt vmcnt(13)
v_cvt_pk_bf16_f32 v105, v61, v65
v_mfma_f32_16x16x32_bf16 v[80:83], v[48:51], a[28:31], v[80:83]
s_waitcnt lgkmcnt(4)
v_readfirstlane_b32 s30, v87
s_nop 0
v_mfma_f32_16x16x32_bf16 v[68:71], v[20:23], a[32:35], v[68:71]
ds_read_b128 v[44:47], v16 offset:14336
s_add_u32 m0, s21, 117760
v_and_or_b32 v104, v104, -2, s38
v_mfma_f32_16x16x32_bf16 v[72:75], v[20:23], a[36:39], v[72:75]
buffer_load_dwordx4 v11, s[8:11], s20 offen lds
s_nop 0
v_mfma_f32_16x16x32_bf16 v[76:79], v[24:27], a[32:35], v[76:79]
ds_read_b128 v[48:51], v17 offset:14336
s_cmp_lt_u32 s30, 8
s_cbranch_scc1 L_gw_532
L_gok_531:
v_mfma_f32_16x16x32_bf16 v[80:83], v[24:27], a[36:39], v[80:83]
s_waitcnt lgkmcnt(4)
v_and_or_b32 v105, v105, -2, s38
s_add_u32 s29, s45, s31
v_mfma_f32_16x16x32_bf16 v[68:71], v[28:31], a[40:43], v[68:71]
s_waitcnt vmcnt(15)
s_barrier
ds_read_b128 v[20:23], v16 offset:16384
v_mfma_f32_16x16x32_bf16 v[72:75], v[28:31], a[44:47], v[72:75]
s_mov_b32 s20, s53
buffer_store_dwordx2 v[104:105], v112, s[12:15], s29 offen offset:0 sc1
v_mfma_f32_16x16x32_bf16 v[76:79], v[32:35], a[40:43], v[76:79]
ds_read_b128 v[24:27], v17 offset:16384
v_cvt_pk_bf16_f32 v106, v54, v58
v_mfma_f32_16x16x32_bf16 v[80:83], v[32:35], a[44:47], v[80:83]
s_waitcnt lgkmcnt(4)
v_cvt_pk_bf16_f32 v107, v62, v66
v_mfma_f32_16x16x32_bf16 v[68:71], v[36:39], a[48:51], v[68:71]
ds_read_b128 v[28:31], v16 offset:18432
s_add_u32 m0, s21, 0
v_mfma_f32_16x16x32_bf16 v[72:75], v[36:39], a[52:55], v[72:75]
buffer_load_dwordx4 v8, s[8:11], s20 offen lds
v_mfma_f32_16x16x32_bf16 v[76:79], v[40:43], a[48:51], v[76:79]
ds_read_b128 v[32:35], v17 offset:18432
v_and_or_b32 v106, v106, -2, s38
v_mfma_f32_16x16x32_bf16 v[80:83], v[40:43], a[52:55], v[80:83]
s_waitcnt lgkmcnt(4)
v_and_or_b32 v107, v107, -2, s38
v_mfma_f32_16x16x32_bf16 v[68:71], v[44:47], a[56:59], v[68:71]
ds_read_b128 v[36:39], v16 offset:20480
s_add_u32 s29, s46, s31
v_mfma_f32_16x16x32_bf16 v[72:75], v[44:47], a[60:63], v[72:75]
buffer_store_dwordx2 v[106:107], v112, s[12:15], s29 offen offset:512 sc1
v_mfma_f32_16x16x32_bf16 v[76:79], v[48:51], a[56:59], v[76:79]
ds_read_b128 v[40:43], v17 offset:20480
v_cvt_pk_bf16_f32 v108, v55, v59
v_mfma_f32_16x16x32_bf16 v[80:83], v[48:51], a[60:63], v[80:83]
s_waitcnt lgkmcnt(4)
v_cvt_pk_bf16_f32 v109, v63, v67
v_mfma_f32_16x16x32_bf16 v[68:71], v[20:23], a[64:67], v[68:71]
ds_read_b128 v[44:47], v16 offset:22528
s_add_u32 m0, s21, 1024
v_mfma_f32_16x16x32_bf16 v[72:75], v[20:23], a[68:71], v[72:75]
buffer_load_dwordx4 v9, s[8:11], s20 offen lds
v_mfma_f32_16x16x32_bf16 v[76:79], v[24:27], a[64:67], v[76:79]
ds_read_b128 v[48:51], v17 offset:22528
v_and_or_b32 v108, v108, -2, s38
v_mfma_f32_16x16x32_bf16 v[80:83], v[24:27], a[68:71], v[80:83]
s_waitcnt lgkmcnt(4)
v_and_or_b32 v109, v109, -2, s38
v_mfma_f32_16x16x32_bf16 v[68:71], v[28:31], a[72:75], v[68:71]
ds_read_b128 v[20:23], v16 offset:24576
s_add_u32 s29, s47, s31
v_mfma_f32_16x16x32_bf16 v[72:75], v[28:31], a[76:79], v[72:75]
buffer_store_dwordx2 v[108:109], v112, s[12:15], s29 offen offset:1024 sc1
v_mfma_f32_16x16x32_bf16 v[76:79], v[32:35], a[72:75], v[76:79]
ds_read_b128 v[24:27], v17 offset:24576
v_mfma_f32_16x16x32_bf16 v[80:83], v[32:35], a[76:79], v[80:83]
s_waitcnt lgkmcnt(4)
v_mfma_f32_16x16x32_bf16 v[68:71], v[36:39], a[80:83], v[68:71]
ds_read_b128 v[28:31], v16 offset:26624
s_add_u32 m0, s21, 2048
v_mfma_f32_16x16x32_bf16 v[72:75], v[36:39], a[84:87], v[72:75]
buffer_load_dwordx4 v10, s[8:11], s20 offen lds
v_mfma_f32_16x16x32_bf16 v[76:79], v[40:43], a[80:83], v[76:79]
ds_read_b128 v[32:35], v17 offset:26624
v_mfma_f32_16x16x32_bf16 v[80:83], v[40:43], a[84:87], v[80:83]
s_waitcnt lgkmcnt(4)
v_mfma_f32_16x16x32_bf16 v[68:71], v[44:47], a[88:91], v[68:71]
ds_read_b128 v[36:39], v16 offset:28672
v_mfma_f32_16x16x32_bf16 v[72:75], v[44:47], a[92:95], v[72:75]
v_mfma_f32_16x16x32_bf16 v[76:79], v[48:51], a[88:91], v[76:79]
ds_read_b128 v[40:43], v17 offset:28672
v_mfma_f32_16x16x32_bf16 v[80:83], v[48:51], a[92:95], v[80:83]
s_waitcnt lgkmcnt(4)
v_mfma_f32_16x16x32_bf16 v[68:71], v[20:23], a[96:99], v[68:71]
ds_read_b128 v[44:47], v16 offset:30720
s_add_u32 m0, s21, 3072
v_mfma_f32_16x16x32_bf16 v[72:75], v[20:23], a[100:103], v[72:75]
buffer_load_dwordx4 v11, s[8:11], s20 offen lds
v_mfma_f32_16x16x32_bf16 v[76:79], v[24:27], a[96:99], v[76:79]
ds_read_b128 v[48:51], v17 offset:30720
v_mfma_f32_16x16x32_bf16 v[80:83], v[24:27], a[100:103], v[80:83]
s_waitcnt lgkmcnt(4)
v_mfma_f32_16x16x32_bf16 v[68:71], v[28:31], a[104:107], v[68:71]
s_waitcnt vmcnt(15)
s_barrier
ds_read_b128 v[20:23], v16 offset:32768
v_mfma_f32_16x16x32_bf16 v[72:75], v[28:31], a[108:111], v[72:75]
s_add_u32 s20, s20, 65536
v_mfma_f32_16x16x32_bf16 v[76:79], v[32:35], a[104:107], v[76:79]
ds_read_b128 v[24:27], v17 offset:32768
v_mfma_f32_16x16x32_bf16 v[80:83], v[32:35], a[108:111], v[80:83]
s_waitcnt lgkmcnt(4)
v_mfma_f32_16x16x32_bf16 v[68:71], v[36:39], a[112:115], v[68:71]
ds_read_b128 v[28:31], v16 offset:34816
s_add_u32 m0, s21, 16384
s_waitcnt vmcnt(12)
v_xor_b32 v124, s7, v88
v_mfma_f32_16x16x32_bf16 v[72:75], v[36:39], a[116:119], v[72:75]
buffer_load_dwordx4 v8, s[8:11], s20 offen lds
v_bitop3_b32 v124, v124, v89, s7 bitop3:0xf6
v_mfma_f32_16x16x32_bf16 v[76:79], v[40:43], a[112:115], v[76:79]
ds_read_b128 v[32:35], v17 offset:34816
v_bitop3_b32 v124, v124, v90, s7 bitop3:0xf6
v_bitop3_b32 v124, v124, v91, s7 bitop3:0xf6
v_mfma_f32_16x16x32_bf16 v[80:83], v[40:43], a[116:119], v[80:83]
s_waitcnt lgkmcnt(4)
v_bitop3_b32 v124, v124, v92, s7 bitop3:0xf6
v_bitop3_b32 v124, v124, v93, s7 bitop3:0xf6
v_mfma_f32_16x16x32_bf16 v[68:71], v[44:47], a[120:123], v[68:71]
ds_read_b128 v[36:39], v16 offset:36864
s_lshl_b32 s27, s22, 2
v_and_b32 v124, 1, v124
v_cmp_ne_u32 vcc, 0, v124
v_mfma_f32_16x16x32_bf16 v[72:75], v[44:47], a[124:127], v[72:75]
s_add_u32 s3, s22, 2
s_waitcnt vmcnt(9)
s_nop 0
v_mfma_f32_16x16x32_bf16 v[76:79], v[48:51], a[120:123], v[76:79]
ds_read_b128 v[40:43], v17 offset:36864
v_readlane_b32 s28, v129, s3
s_nop 0
s_nop 0
v_mfma_f32_16x16x32_bf16 v[80:83], v[48:51], a[124:127], v[80:83]
s_waitcnt lgkmcnt(4)
s_nop 0
s_cbranch_vccnz L_rbad_527
L_rok_528:
v_mfma_f32_16x16x32_bf16 v[68:71], v[20:23], a[128:131], v[68:71]
ds_read_b128 v[44:47], v16 offset:38912
s_add_u32 m0, s21, 17408
v_mfma_f32_16x16x32_bf16 v[72:75], v[20:23], a[132:135], v[72:75]
buffer_load_dwordx4 v9, s[8:11], s20 offen lds
s_nop 0
v_lshlrev_b32 v124, 16, v88
v_mfma_f32_16x16x32_bf16 v[76:79], v[24:27], a[128:131], v[76:79]
ds_read_b128 v[48:51], v17 offset:38912
s_cmp_eq_u32 s28, 0
s_cbranch_scc1 L_sw_530
L_sok_529:
v_mfma_f32_16x16x32_bf16 v[80:83], v[24:27], a[132:135], v[80:83]
s_waitcnt lgkmcnt(4)
s_add_u32 s27, s27, s60
v_and_b32 v125, 0xffff0000, v88
v_mfma_f32_16x16x32_bf16 v[68:71], v[28:31], a[136:139], v[68:71]
ds_read_b128 v[20:23], v16 offset:40960
s_waitcnt vmcnt(12)
v_and_b32 v124, 0xfffe0000, v124
v_add_f32 v96, v116, v124
v_mfma_f32_16x16x32_bf16 v[72:75], v[28:31], a[140:143], v[72:75]
s_cmp_gt_u32 s28, 64
s_cselect_b32 s3, s3, 64
v_add_f32 v97, v117, v125
v_mfma_f32_16x16x32_bf16 v[76:79], v[32:35], a[136:139], v[76:79]
ds_read_b128 v[24:27], v17 offset:40960
v_add_u32 v131, s26, v131
v_lshlrev_b32 v124, 16, v89
v_and_b32 v125, 0xffff0000, v89
v_mfma_f32_16x16x32_bf16 v[80:83], v[32:35], a[140:143], v[80:83]
s_waitcnt lgkmcnt(4)
s_min_u32 s23, s23, s3
v_and_b32 v124, 0xfffe0000, v124
v_mfma_f32_16x16x32_bf16 v[68:71], v[36:39], a[144:147], v[68:71]
ds_read_b128 v[28:31], v16 offset:43008
s_add_u32 m0, s21, 18432
s_sub_u32 s61, s23, 1
v_add_f32 v98, v118, v124
v_mfma_f32_16x16x32_bf16 v[72:75], v[36:39], a[148:151], v[72:75]
buffer_load_dwordx4 v10, s[8:11], s20 offen lds
v_add_f32 v99, v119, v125
v_mfma_f32_16x16x32_bf16 v[76:79], v[40:43], a[144:147], v[76:79]
ds_read_b128 v[32:35], v17 offset:43008
s_add_u32 s51, s24, 1
v_lshlrev_b32 v124, 16, v90
v_mfma_f32_16x16x32_bf16 v[80:83], v[40:43], a[148:151], v[80:83]
s_waitcnt lgkmcnt(4)
s_min_u32 s51, s51, s61
v_and_b32 v125, 0xffff0000, v90
v_and_b32 v124, 0xfffe0000, v124
v_mfma_f32_16x16x32_bf16 v[68:71], v[44:47], a[152:155], v[68:71]
ds_read_b128 v[36:39], v16 offset:45056
v_readlane_b32 s51, v129, s51
v_add_f32 v96, v96, v124
v_mfma_f32_16x16x32_bf16 v[72:75], v[44:47], a[156:159], v[72:75]
s_nop 0
buffer_store_dword v131, v85, s[12:15], s27 offen offset:12 sc1
v_add_f32 v97, v97, v125
v_mfma_f32_16x16x32_bf16 v[76:79], v[48:51], a[152:155], v[76:79]
ds_read_b128 v[40:43], v17 offset:45056
s_nop 0
v_lshlrev_b32 v124, 16, v91
v_mfma_f32_16x16x32_bf16 v[80:83], v[48:51], a[156:159], v[80:83]
s_waitcnt lgkmcnt(4)
s_sub_u32 s51, s51, 1
v_and_b32 v125, 0xffff0000, v91
v_and_b32 v124, 0xfffe0000, v124
v_mfma_f32_16x16x32_bf16 v[68:71], v[20:23], a[160:163], v[68:71]
ds_read_b128 v[44:47], v16 offset:47104
s_add_u32 m0, s21, 19456
v_add_f32 v98, v98, v124
v_mfma_f32_16x16x32_bf16 v[72:75], v[20:23], a[164:167], v[72:75]
buffer_load_dwordx4 v11, s[8:11], s20 offen lds
s_lshl_b32 s51, s51, 9
v_add_f32 v99, v99, v125
v_mfma_f32_16x16x32_bf16 v[76:79], v[24:27], a[160:163], v[76:79]
ds_read_b128 v[48:51], v17 offset:47104
s_add_u32 s51, s51, s48
v_lshlrev_b32 v124, 16, v92
v_mfma_f32_16x16x32_bf16 v[80:83], v[24:27], a[164:167], v[80:83]
s_waitcnt lgkmcnt(4)
v_and_b32 v125, 0xffff0000, v92
v_and_b32 v124, 0xfffe0000, v124
v_mfma_f32_16x16x32_bf16 v[68:71], v[28:31], a[168:171], v[68:71]
s_waitcnt vmcnt(12)
s_barrier
ds_read_b128 v[20:23], v16 offset:49152
v_add_f32 v96, v96, v124
v_mfma_f32_16x16x32_bf16 v[72:75], v[28:31], a[172:175], v[72:75]
s_add_u32 s20, s20, 65536
buffer_load_dword v87, v4, s[12:15], s51 offen sc1
v_add_f32 v97, v97, v125
v_mfma_f32_16x16x32_bf16 v[76:79], v[32:35], a[168:171], v[76:79]
ds_read_b128 v[24:27], v17 offset:49152
v_lshlrev_b32 v124, 16, v93
v_and_b32 v125, 0xffff0000, v93
v_mfma_f32_16x16x32_bf16 v[80:83], v[32:35], a[172:175], v[80:83]
s_waitcnt lgkmcnt(4)
v_and_b32 v124, 0xfffe0000, v124
v_add_f32 v98, v98, v124
v_mfma_f32_16x16x32_bf16 v[68:71], v[36:39], a[176:179], v[68:71]
ds_read_b128 v[28:31], v16 offset:51200
s_add_u32 m0, s21, 32768
v_add_f32 v99, v99, v125
v_mfma_f32_16x16x32_bf16 v[72:75], v[36:39], a[180:183], v[72:75]
buffer_load_dwordx4 v8, s[8:11], s20 offen lds
ds_write2_b32 v114, v96, v97 offset0:0 offset1:16
v_mfma_f32_16x16x32_bf16 v[76:79], v[40:43], a[176:179], v[76:79]
ds_read_b128 v[32:35], v17 offset:51200
ds_write2_b32 v114, v98, v99 offset0:128 offset1:144
ds_read_b128 v[88:91], v113 offset:0
v_mfma_f32_16x16x32_bf16 v[80:83], v[40:43], a[180:183], v[80:83]
s_waitcnt lgkmcnt(4)
v_mfma_f32_16x16x32_bf16 v[68:71], v[44:47], a[184:187], v[68:71]
ds_read_b128 v[36:39], v16 offset:53248
v_mfma_f32_16x16x32_bf16 v[72:75], v[44:47], a[188:191], v[72:75]
v_mfma_f32_16x16x32_bf16 v[76:79], v[48:51], a[184:187], v[76:79]
ds_read_b128 v[40:43], v17 offset:53248
s_waitcnt lgkmcnt(2)
v_mfma_f32_16x16x32_bf16 v[80:83], v[48:51], a[188:191], v[80:83]
s_waitcnt lgkmcnt(4)
v_cvt_pk_bf16_f32 v96, 0, v88
v_mfma_f32_16x16x32_bf16 v[68:71], v[20:23], a[192:195], v[68:71]
ds_read_b128 v[44:47], v16 offset:55296
s_add_u32 m0, s21, 33792
v_mfma_f32_16x16x32_bf16 v[72:75], v[20:23], a[196:199], v[72:75]
buffer_load_dwordx4 v9, s[8:11], s20 offen lds
v_mfma_f32_16x16x32_bf16 v[76:79], v[24:27], a[192:195], v[76:79]
ds_read_b128 v[48:51], v17 offset:55296
v_cvt_pk_bf16_f32 v97, 0, v89
v_mfma_f32_16x16x32_bf16 v[80:83], v[24:27], a[196:199], v[80:83]
s_waitcnt lgkmcnt(4)
v_cvt_pk_bf16_f32 v98, 0, v90
v_mfma_f32_16x16x32_bf16 v[68:71], v[28:31], a[200:203], v[68:71]
ds_read_b128 v[20:23], v16 offset:57344
v_cvt_pk_bf16_f32 v99, 0, v91
v_mfma_f32_16x16x32_bf16 v[72:75], v[28:31], a[204:207], v[72:75]
buffer_store_dwordx4 v[96:99], v128, s[16:19], s43 offen
v_mfma_f32_16x16x32_bf16 v[76:79], v[32:35], a[200:203], v[76:79]
ds_read_b128 v[24:27], v17 offset:57344
v_mfma_f32_16x16x32_bf16 v[80:83], v[32:35], a[204:207], v[80:83]
s_waitcnt lgkmcnt(4)
v_mfma_f32_16x16x32_bf16 v[68:71], v[36:39], a[208:211], v[68:71]
ds_read_b128 v[28:31], v16 offset:59392
s_add_u32 m0, s21, 34816
v_mov_b32 v116, v52
v_mov_b32 v117, v56
v_mfma_f32_16x16x32_bf16 v[72:75], v[36:39], a[212:215], v[72:75]
buffer_load_dwordx4 v10, s[8:11], s20 offen lds
v_mov_b32 v118, v60
v_mov_b32 v119, v64
v_mfma_f32_16x16x32_bf16 v[76:79], v[40:43], a[208:211], v[76:79]
ds_read_b128 v[32:35], v17 offset:59392
s_mov_b32 s7, s38
s_add_u32 s39, s44, s31
s_sub_u32 s43, s22, 1
v_mfma_f32_16x16x32_bf16 v[80:83], v[40:43], a[212:215], v[80:83]
s_waitcnt lgkmcnt(4)
s_and_b32 s43, s43, 63
v_readlane_b32 s43, v129, s43
s_nop 0
v_mfma_f32_16x16x32_bf16 v[68:71], v[44:47], a[216:219], v[68:71]
ds_read_b128 v[36:39], v16 offset:61440
s_nop 0
s_sub_u32 s43, s43, 1
s_lshl_b32 s43, s43, 18
v_mfma_f32_16x16x32_bf16 v[72:75], v[44:47], a[220:223], v[72:75]
s_cmp_eq_u32 s37, 0
s_cselect_b32 s43, 0x7ff00000, s43
buffer_load_dwordx2 v[88:89], v112, s[12:15], s39 offen offset:0 sc1
v_mfma_f32_16x16x32_bf16 v[76:79], v[48:51], a[216:219], v[76:79]
ds_read_b128 v[40:43], v17 offset:61440
v_mfma_f32_16x16x32_bf16 v[80:83], v[48:51], a[220:223], v[80:83]
s_waitcnt lgkmcnt(4)
v_mfma_f32_16x16x32_bf16 v[68:71], v[20:23], a[224:227], v[68:71]
ds_read_b128 v[44:47], v16 offset:63488
s_add_u32 m0, s21, 35840
v_mfma_f32_16x16x32_bf16 v[72:75], v[20:23], a[228:231], v[72:75]
buffer_load_dwordx4 v11, s[8:11], s20 offen lds
v_mfma_f32_16x16x32_bf16 v[76:79], v[24:27], a[224:227], v[76:79]
ds_read_b128 v[48:51], v17 offset:63488
v_mfma_f32_16x16x32_bf16 v[80:83], v[24:27], a[228:231], v[80:83]
s_waitcnt lgkmcnt(4)
v_mfma_f32_16x16x32_bf16 v[68:71], v[28:31], a[232:235], v[68:71]
s_waitcnt vmcnt(12)
s_barrier
ds_read_b128 v[20:23], v12 offset:0
v_mfma_f32_16x16x32_bf16 v[72:75], v[28:31], a[236:239], v[72:75]
s_add_u32 s20, s20, 65536
buffer_load_dwordx2 v[90:91], v112, s[12:15], s39 offen offset:512 sc1
v_mfma_f32_16x16x32_bf16 v[76:79], v[32:35], a[232:235], v[76:79]
ds_read_b128 v[24:27], v13 offset:0
v_mfma_f32_16x16x32_bf16 v[80:83], v[32:35], a[236:239], v[80:83]
s_waitcnt lgkmcnt(4)
v_mfma_f32_16x16x32_bf16 v[68:71], v[36:39], a[240:243], v[68:71]
ds_read_b128 v[28:31], v12 offset:2048
s_add_u32 m0, s21, 49152
v_mfma_f32_16x16x32_bf16 v[72:75], v[36:39], a[244:247], v[72:75]
buffer_load_dwordx4 v8, s[8:11], s20 offen lds
v_mfma_f32_16x16x32_bf16 v[76:79], v[40:43], a[240:243], v[76:79]
ds_read_b128 v[32:35], v13 offset:2048
v_mfma_f32_16x16x32_bf16 v[80:83], v[40:43], a[244:247], v[80:83]
s_waitcnt lgkmcnt(4)
v_mfma_f32_16x16x32_bf16 v[68:71], v[44:47], a[248:251], v[68:71]
ds_read_b128 v[36:39], v12 offset:4096
v_mfma_f32_16x16x32_bf16 v[72:75], v[44:47], a[252:255], v[72:75]
buffer_load_dwordx2 v[92:93], v112, s[12:15], s39 offen offset:1024 sc1
v_mfma_f32_16x16x32_bf16 v[76:79], v[48:51], a[248:251], v[76:79]
ds_read_b128 v[40:43], v13 offset:4096
s_mov_b32 s37, 1
v_mfma_f32_16x16x32_bf16 v[80:83], v[48:51], a[252:255], v[80:83]
s_waitcnt lgkmcnt(4)
s_add_u32 s22, s22, 1
s_cmp_ge_u32 s22, s23
s_cbranch_scc0 L_st_520
L_fl1_518:
s_waitcnt lgkmcnt(0)
s_nop 7
s_sub_u32 s38, s22, 1
s_and_b32 s31, s38, 3
s_lshl_b32 s31, s31, 11
s_bfe_u32 s38, s38, 0x10002
s_xor_b32 s38, s38, 1
s_cmp_eq_u32 s37, 0
s_cselect_b32 s31, 0x40000000, s31
s_cselect_b32 s38, 0, s38
v_cvt_pk_bf16_f32 v104, v69, v73
v_cvt_pk_bf16_f32 v105, v77, v81
v_and_or_b32 v104, v104, -2, s38
v_and_or_b32 v105, v105, -2, s38
s_add_u32 s29, s45, s31
buffer_store_dwordx2 v[104:105], v112, s[12:15], s29 offen offset:0 sc1
v_cvt_pk_bf16_f32 v106, v70, v74
v_cvt_pk_bf16_f32 v107, v78, v82
v_and_or_b32 v106, v106, -2, s38
v_and_or_b32 v107, v107, -2, s38
s_add_u32 s29, s46, s31
buffer_store_dwordx2 v[106:107], v112, s[12:15], s29 offen offset:512 sc1
v_cvt_pk_bf16_f32 v108, v71, v75
v_cvt_pk_bf16_f32 v109, v79, v83
v_and_or_b32 v108, v108, -2, s38
v_and_or_b32 v109, v109, -2, s38
s_add_u32 s29, s47, s31
buffer_store_dwordx2 v[108:109], v112, s[12:15], s29 offen offset:1024 sc1
s_waitcnt vmcnt(0)
v_xor_b32 v124, s7, v88
v_bitop3_b32 v124, v124, v89, s7 bitop3:0xf6
v_bitop3_b32 v124, v124, v90, s7 bitop3:0xf6
v_bitop3_b32 v124, v124, v91, s7 bitop3:0xf6
v_bitop3_b32 v124, v124, v92, s7 bitop3:0xf6
v_bitop3_b32 v124, v124, v93, s7 bitop3:0xf6
v_and_b32 v124, 1, v124
v_cmp_ne_u32 vcc, 0, v124
s_nop 0
s_nop 0
s_nop 0
s_cbranch_vccnz L_rbad_533
L_rok_534:
v_lshlrev_b32 v124, 16, v88
v_and_b32 v125, 0xffff0000, v88
v_and_b32 v124, 0xfffe0000, v124
v_add_f32 v96, v116, v124
v_add_f32 v97, v117, v125
v_lshlrev_b32 v124, 16, v89
v_and_b32 v125, 0xffff0000, v89
v_and_b32 v124, 0xfffe0000, v124
v_add_f32 v98, v118, v124
v_add_f32 v99, v119, v125
v_lshlrev_b32 v124, 16, v90
v_and_b32 v125, 0xffff0000, v90
v_and_b32 v124, 0xfffe0000, v124
v_add_f32 v96, v96, v124
v_add_f32 v97, v97, v125
v_lshlrev_b32 v124, 16, v91
v_and_b32 v125, 0xffff0000, v91
v_and_b32 v124, 0xfffe0000, v124
v_add_f32 v98, v98, v124
v_add_f32 v99, v99, v125
v_lshlrev_b32 v124, 16, v92
v_and_b32 v125, 0xffff0000, v92
v_and_b32 v124, 0xfffe0000, v124
v_add_f32 v96, v96, v124
v_add_f32 v97, v97, v125
v_lshlrev_b32 v124, 16, v93
v_and_b32 v125, 0xffff0000, v93
v_and_b32 v124, 0xfffe0000, v124
v_add_f32 v98, v98, v124
v_add_f32 v99, v99, v125
ds_write2_b32 v114, v96, v97 offset0:0 offset1:16
ds_write2_b32 v114, v98, v99 offset0:128 offset1:144
ds_read_b128 v[88:91], v113 offset:0
s_waitcnt lgkmcnt(0)
v_cvt_pk_bf16_f32 v96, 0, v88
v_cvt_pk_bf16_f32 v97, 0, v89
v_cvt_pk_bf16_f32 v98, 0, v90
v_cvt_pk_bf16_f32 v99, 0, v91
buffer_store_dwordx4 v[96:99], v128, s[16:19], s43 offen
v_mov_b32 v116, v68
v_mov_b32 v117, v72
v_mov_b32 v118, v76
v_mov_b32 v119, v80
s_mov_b32 s7, s38
s_add_u32 s39, s44, s31
s_sub_u32 s43, s22, 1
s_and_b32 s43, s43, 63
v_readlane_b32 s43, v129, s43
s_nop 0
s_nop 0
s_sub_u32 s43, s43, 1
s_lshl_b32 s43, s43, 18
s_cmp_eq_u32 s37, 0
s_cselect_b32 s43, 0x7ff00000, s43
buffer_load_dwordx2 v[88:89], v112, s[12:15], s39 offen offset:0 sc1
buffer_load_dwordx2 v[90:91], v112, s[12:15], s39 offen offset:512 sc1
buffer_load_dwordx2 v[92:93], v112, s[12:15], s39 offen offset:1024 sc1
s_mov_b32 s37, 1
s_waitcnt vmcnt(0)
v_xor_b32 v124, s7, v88
v_bitop3_b32 v124, v124, v89, s7 bitop3:0xf6
v_bitop3_b32 v124, v124, v90, s7 bitop3:0xf6
v_bitop3_b32 v124, v124, v91, s7 bitop3:0xf6
v_bitop3_b32 v124, v124, v92, s7 bitop3:0xf6
v_bitop3_b32 v124, v124, v93, s7 bitop3:0xf6
v_and_b32 v124, 1, v124
v_cmp_ne_u32 vcc, 0, v124
s_nop 0
s_nop 0
s_nop 0
s_cbranch_vccnz L_rbad_535
L_rok_536:
v_lshlrev_b32 v124, 16, v88
v_and_b32 v125, 0xffff0000, v88
v_and_b32 v124, 0xfffe0000, v124
v_add_f32 v96, v116, v124
v_add_f32 v97, v117, v125
v_lshlrev_b32 v124, 16, v89
v_and_b32 v125, 0xffff0000, v89
v_and_b32 v124, 0xfffe0000, v124
v_add_f32 v98, v118, v124
v_add_f32 v99, v119, v125
v_lshlrev_b32 v124, 16, v90
v_and_b32 v125, 0xffff0000, v90
v_and_b32 v124, 0xfffe0000, v124
v_add_f32 v96, v96, v124
v_add_f32 v97, v97, v125
v_lshlrev_b32 v124, 16, v91
v_and_b32 v125, 0xffff0000, v91
v_and_b32 v124, 0xfffe0000, v124
v_add_f32 v98, v98, v124
v_add_f32 v99, v99, v125
v_lshlrev_b32 v124, 16, v92
v_and_b32 v125, 0xffff0000, v92
v_and_b32 v124, 0xfffe0000, v124
v_add_f32 v96, v96, v124
v_add_f32 v97, v97, v125
v_lshlrev_b32 v124, 16, v93
v_and_b32 v125, 0xffff0000, v93
v_and_b32 v124, 0xfffe0000, v124
v_add_f32 v98, v98, v124
v_add_f32 v99, v99, v125
ds_write2_b32 v114, v96, v97 offset0:0 offset1:16
ds_write2_b32 v114, v98, v99 offset0:128 offset1:144
ds_read_b128 v[88:91], v113 offset:0
s_waitcnt lgkmcnt(0)
v_cvt_pk_bf16_f32 v96, 0, v88
v_cvt_pk_bf16_f32 v97, 0, v89
v_cvt_pk_bf16_f32 v98, 0, v90
v_cvt_pk_bf16_f32 v99, 0, v91
buffer_store_dwordx4 v[96:99], v128, s[16:19], s43 offen
s_branch L_ste_519
L_rbad_521:
buffer_load_dwordx2 v[88:89], v112, s[12:15], s39 offen offset:0 sc1
buffer_load_dwordx2 v[90:91], v112, s[12:15], s39 offen offset:512 sc1
buffer_load_dwordx2 v[92:93], v112, s[12:15], s39 offen offset:1024 sc1
s_add_u32 s36, s36, 1
s_cmp_gt_u32 s36, 0x100000
s_cbranch_scc1 chain_kernel_wend
s_waitcnt vmcnt(0)
v_xor_b32 v124, s7, v88
v_bitop3_b32 v124, v124, v89, s7 bitop3:0xf6
v_bitop3_b32 v124, v124, v90, s7 bitop3:0xf6
v_bitop3_b32 v124, v124, v91, s7 bitop3:0xf6
v_bitop3_b32 v124, v124, v92, s7 bitop3:0xf6
v_bitop3_b32 v124, v124, v93, s7 bitop3:0xf6
v_and_b32 v124, 1, v124
v_cmp_ne_u32 vcc, 0, v124
s_cbranch_vccnz L_rbad_521
s_branch L_rok_522
L_sw_524:
buffer_load_dword v129, v130, s[12:15], s94 offen sc1
s_add_u32 s36, s36, 1
s_cmp_gt_u32 s36, 0x100000
s_cbranch_scc1 chain_kernel_wend
s_waitcnt vmcnt(0)
v_readlane_b32 s28, v129, s3
s_cmp_lg_u32 s28, 0
s_cbranch_scc1 L_sok_523
s_sleep 1
s_branch L_sw_524
L_gw_526:
buffer_load_dword v87, v4, s[12:15], s51 offen sc1
s_add_u32 s36, s36, 1
s_cmp_gt_u32 s36, 0x100000
s_cbranch_scc1 chain_kernel_wend
s_waitcnt vmcnt(0)
v_readfirstlane_b32 s30, v87
s_cmp_lt_u32 s30, 8
s_cbranch_scc0 L_gok_525
s_sleep 1
s_branch L_gw_526
L_rbad_527:
buffer_load_dwordx2 v[88:89], v112, s[12:15], s39 offen offset:0 sc1
buffer_load_dwordx2 v[90:91], v112, s[12:15], s39 offen offset:512 sc1
buffer_load_dwordx2 v[92:93], v112, s[12:15], s39 offen offset:1024 sc1
s_add_u32 s36, s36, 1
s_cmp_gt_u32 s36, 0x100000
s_cbranch_scc1 chain_kernel_wend
s_waitcnt vmcnt(0)
v_xor_b32 v124, s7, v88
v_bitop3_b32 v124, v124, v89, s7 bitop3:0xf6
v_bitop3_b32 v124, v124, v90, s7 bitop3:0xf6
v_bitop3_b32 v124, v124, v91, s7 bitop3:0xf6
v_bitop3_b32 v124, v124, v92, s7 bitop3:0xf6
v_bitop3_b32 v124, v124, v93, s7 bitop3:0xf6
v_and_b32 v124, 1, v124
v_cmp_ne_u32 vcc, 0, v124
s_cbranch_vccnz L_rbad_527
s_branch L_rok_528
L_sw_530:
buffer_load_dword v129, v130, s[12:15], s94 offen sc1
s_add_u32 s36, s36, 1
s_cmp_gt_u32 s36, 0x100000
s_cbranch_scc1 chain_kernel_wend
s_waitcnt vmcnt(0)
v_readlane_b32 s28, v129, s3
s_cmp_lg_u32 s28, 0
s_cbranch_scc1 L_sok_529
s_sleep 1
s_branch L_sw_530
L_gw_532:
buffer_load_dword v87, v4, s[12:15], s51 offen sc1
s_add_u32 s36, s36, 1
s_cmp_gt_u32 s36, 0x100000
s_cbranch_scc1 chain_kernel_wend
s_waitcnt vmcnt(0)
v_readfirstlane_b32 s30, v87
s_cmp_lt_u32 s30, 8
s_cbranch_scc0 L_gok_531
s_sleep 1
s_branch L_gw_532
L_rbad_533:
buffer_load_dwordx2 v[88:89], v112, s[12:15], s39 offen offset:0 sc1
buffer_load_dwordx2 v[90:91], v112, s[12:15], s39 offen offset:512 sc1
buffer_load_dwordx2 v[92:93], v112, s[12:15], s39 offen offset:1024 sc1
s_add_u32 s36, s36, 1
s_cmp_gt_u32 s36, 0x100000
s_cbranch_scc1 chain_kernel_wend
s_waitcnt vmcnt(0)
v_xor_b32 v124, s7, v88
v_bitop3_b32 v124, v124, v89, s7 bitop3:0xf6
v_bitop3_b32 v124, v124, v90, s7 bitop3:0xf6
v_bitop3_b32 v124, v124, v91, s7 bitop3:0xf6
v_bitop3_b32 v124, v124, v92, s7 bitop3:0xf6
v_bitop3_b32 v124, v124, v93, s7 bitop3:0xf6
v_and_b32 v124, 1, v124
v_cmp_ne_u32 vcc, 0, v124
s_cbranch_vccnz L_rbad_533
s_branch L_rok_534
L_rbad_535:
buffer_load_dwordx2 v[88:89], v112, s[12:15], s39 offen offset:0 sc1
buffer_load_dwordx2 v[90:91], v112, s[12:15], s39 offen offset:512 sc1
buffer_load_dwordx2 v[92:93], v112, s[12:15], s39 offen offset:1024 sc1
s_add_u32 s36, s36, 1
s_cmp_gt_u32 s36, 0x100000
s_cbranch_scc1 chain_kernel_wend
s_waitcnt vmcnt(0)
v_xor_b32 v124, s7, v88
v_bitop3_b32 v124, v124, v89, s7 bitop3:0xf6
v_bitop3_b32 v124, v124, v90, s7 bitop3:0xf6
v_bitop3_b32 v124, v124, v91, s7 bitop3:0xf6
v_bitop3_b32 v124, v124, v92, s7 bitop3:0xf6
v_bitop3_b32 v124, v124, v93, s7 bitop3:0xf6
v_and_b32 v124, 1, v124
v_cmp_ne_u32 vcc, 0, v124
s_cbranch_vccnz L_rbad_535
s_branch L_rok_536
L_fl0_517:
s_waitcnt lgkmcnt(0)
s_nop 7
s_sub_u32 s38, s22, 1
s_and_b32 s31, s38, 3
s_lshl_b32 s31, s31, 11
s_bfe_u32 s38, s38, 0x10002
s_xor_b32 s38, s38, 1
s_cmp_eq_u32 s37, 0
s_cselect_b32 s31, 0x40000000, s31
s_cselect_b32 s38, 0, s38
v_cvt_pk_bf16_f32 v104, v53, v57
v_cvt_pk_bf16_f32 v105, v61, v65
v_and_or_b32 v104, v104, -2, s38
v_and_or_b32 v105, v105, -2, s38
s_add_u32 s29, s45, s31
buffer_store_dwordx2 v[104:105], v112, s[12:15], s29 offen offset:0 sc1
v_cvt_pk_bf16_f32 v106, v54, v58
v_cvt_pk_bf16_f32 v107, v62, v66
v_and_or_b32 v106, v106, -2, s38
v_and_or_b32 v107, v107, -2, s38
s_add_u32 s29, s46, s31
buffer_store_dwordx2 v[106:107], v112, s[12:15], s29 offen offset:512 sc1
v_cvt_pk_bf16_f32 v108, v55, v59
v_cvt_pk_bf16_f32 v109, v63, v67
v_and_or_b32 v108, v108, -2, s38
v_and_or_b32 v109, v109, -2, s38
s_add_u32 s29, s47, s31
buffer_store_dwordx2 v[108:109], v112, s[12:15], s29 offen offset:1024 sc1
s_waitcnt vmcnt(0)
v_xor_b32 v124, s7, v88
v_bitop3_b32 v124, v124, v89, s7 bitop3:0xf6
v_bitop3_b32 v124, v124, v90, s7 bitop3:0xf6
v_bitop3_b32 v124, v124, v91, s7 bitop3:0xf6
v_bitop3_b32 v124, v124, v92, s7 bitop3:0xf6
v_bitop3_b32 v124, v124, v93, s7 bitop3:0xf6
v_and_b32 v124, 1, v124
v_cmp_ne_u32 vcc, 0, v124
s_nop 0
s_nop 0
s_nop 0
s_cbranch_vccnz L_rbad_537
L_rok_538:
v_lshlrev_b32 v124, 16, v88
v_and_b32 v125, 0xffff0000, v88
v_and_b32 v124, 0xfffe0000, v124
v_add_f32 v96, v116, v124
v_add_f32 v97, v117, v125
v_lshlrev_b32 v124, 16, v89
v_and_b32 v125, 0xffff0000, v89
v_and_b32 v124, 0xfffe0000, v124
v_add_f32 v98, v118, v124
v_add_f32 v99, v119, v125
v_lshlrev_b32 v124, 16, v90
v_and_b32 v125, 0xffff0000, v90
v_and_b32 v124, 0xfffe0000, v124
v_add_f32 v96, v96, v124
v_add_f32 v97, v97, v125
v_lshlrev_b32 v124, 16, v91
v_and_b32 v125, 0xffff0000, v91
v_and_b32 v124, 0xfffe0000, v124
v_add_f32 v98, v98, v124
v_add_f32 v99, v99, v125
v_lshlrev_b32 v124, 16, v92
v_and_b32 v125, 0xffff0000, v92
v_and_b32 v124, 0xfffe0000, v124
v_add_f32 v96, v96, v124
v_add_f32 v97, v97, v125
v_lshlrev_b32 v124, 16, v93
v_and_b32 v125, 0xffff0000, v93
v_and_b32 v124, 0xfffe0000, v124
v_add_f32 v98, v98, v124
v_add_f32 v99, v99, v125
ds_write2_b32 v114, v96, v97 offset0:0 offset1:16
ds_write2_b32 v114, v98, v99 offset0:128 offset1:144
ds_read_b128 v[88:91], v113 offset:0
s_waitcnt lgkmcnt(0)
v_cvt_pk_bf16_f32 v96, 0, v88
v_cvt_pk_bf16_f32 v97, 0, v89
v_cvt_pk_bf16_f32 v98, 0, v90
v_cvt_pk_bf16_f32 v99, 0, v91
buffer_store_dwordx4 v[96:99], v128, s[16:19], s43 offen
v_mov_b32 v116, v52
v_mov_b32 v117, v56
v_mov_b32 v118, v60
v_mov_b32 v119, v64
s_mov_b32 s7, s38
s_add_u32 s39, s44, s31
s_sub_u32 s43, s22, 1
s_and_b32 s43, s43, 63
v_readlane_b32 s43, v129, s43
s_nop 0
s_nop 0
s_sub_u32 s43, s43, 1
s_lshl_b32 s43, s43, 18
s_cmp_eq_u32 s37, 0
s_cselect_b32 s43, 0x7ff00000, s43
buffer_load_dwordx2 v[88:89], v112, s[12:15], s39 offen offset:0 sc1
buffer_load_dwordx2 v[90:91], v112, s[12:15], s39 offen offset:512 sc1
buffer_load_dwordx2 v[92:93], v112, s[12:15], s39 offen offset:1024 sc1
s_mov_b32 s37, 1
s_waitcnt vmcnt(0)
v_xor_b32 v124, s7, v88
v_bitop3_b32 v124, v124, v89, s7 bitop3:0xf6
v_bitop3_b32 v124, v124, v90, s7 bitop3:0xf6
v_bitop3_b32 v124, v124, v91, s7 bitop3:0xf6
v_bitop3_b32 v124, v124, v92, s7 bitop3:0xf6
v_bitop3_b32 v124, v124, v93, s7 bitop3:0xf6
v_and_b32 v124, 1, v124
v_cmp_ne_u32 vcc, 0, v124
s_nop 0
s_nop 0
s_nop 0
s_cbranch_vccnz L_rbad_539
L_rok_540:
v_lshlrev_b32 v124, 16, v88
v_and_b32 v125, 0xffff0000, v88
v_and_b32 v124, 0xfffe0000, v124
v_add_f32 v96, v116, v124
v_add_f32 v97, v117, v125
v_lshlrev_b32 v124, 16, v89
v_and_b32 v125, 0xffff0000, v89
v_and_b32 v124, 0xfffe0000, v124
v_add_f32 v98, v118, v124
v_add_f32 v99, v119, v125
v_lshlrev_b32 v124, 16, v90
v_and_b32 v125, 0xffff0000, v90
v_and_b32 v124, 0xfffe0000, v124
v_add_f32 v96, v96, v124
v_add_f32 v97, v97, v125
v_lshlrev_b32 v124, 16, v91
v_and_b32 v125, 0xffff0000, v91
v_and_b32 v124, 0xfffe0000, v124
v_add_f32 v98, v98, v124
v_add_f32 v99, v99, v125
v_lshlrev_b32 v124, 16, v92
v_and_b32 v125, 0xffff0000, v92
v_and_b32 v124, 0xfffe0000, v124
v_add_f32 v96, v96, v124
v_add_f32 v97, v97, v125
v_lshlrev_b32 v124, 16, v93
v_and_b32 v125, 0xffff0000, v93
v_and_b32 v124, 0xfffe0000, v124
v_add_f32 v98, v98, v124
v_add_f32 v99, v99, v125
ds_write2_b32 v114, v96, v97 offset0:0 offset1:16
ds_write2_b32 v114, v98, v99 offset0:128 offset1:144
ds_read_b128 v[88:91], v113 offset:0
s_waitcnt lgkmcnt(0)
v_cvt_pk_bf16_f32 v96, 0, v88
v_cvt_pk_bf16_f32 v97, 0, v89
v_cvt_pk_bf16_f32 v98, 0, v90
v_cvt_pk_bf16_f32 v99, 0, v91
buffer_store_dwordx4 v[96:99], v128, s[16:19], s43 offen
s_branch L_ste_519
L_rbad_537:
buffer_load_dwordx2 v[88:89], v112, s[12:15], s39 offen offset:0 sc1
buffer_load_dwordx2 v[90:91], v112, s[12:15], s39 offen offset:512 sc1
buffer_load_dwordx2 v[92:93], v112, s[12:15], s39 offen offset:1024 sc1
s_add_u32 s36, s36, 1
s_cmp_gt_u32 s36, 0x100000
s_cbranch_scc1 chain_kernel_wend
s_waitcnt vmcnt(0)
v_xor_b32 v124, s7, v88
v_bitop3_b32 v124, v124, v89, s7 bitop3:0xf6
v_bitop3_b32 v124, v124, v90, s7 bitop3:0xf6
v_bitop3_b32 v124, v124, v91, s7 bitop3:0xf6
v_bitop3_b32 v124, v124, v92, s7 bitop3:0xf6
v_bitop3_b32 v124, v124, v93, s7 bitop3:0xf6
v_and_b32 v124, 1, v124
v_cmp_ne_u32 vcc, 0, v124
s_cbranch_vccnz L_rbad_537
s_branch L_rok_538
L_rbad_539:
buffer_load_dwordx2 v[88:89], v112, s[12:15], s39 offen offset:0 sc1
buffer_load_dwordx2 v[90:91], v112, s[12:15], s39 offen offset:512 sc1
buffer_load_dwordx2 v[92:93], v112, s[12:15], s39 offen offset:1024 sc1
s_add_u32 s36, s36, 1
s_cmp_gt_u32 s36, 0x100000
s_cbranch_scc1 chain_kernel_wend
s_waitcnt vmcnt(0)
v_xor_b32 v124, s7, v88
v_bitop3_b32 v124, v124, v89, s7 bitop3:0xf6
v_bitop3_b32 v124, v124, v90, s7 bitop3:0xf6
v_bitop3_b32 v124, v124, v91, s7 bitop3:0xf6
v_bitop3_b32 v124, v124, v92, s7 bitop3:0xf6
v_bitop3_b32 v124, v124, v93, s7 bitop3:0xf6
v_and_b32 v124, 1, v124
v_cmp_ne_u32 vcc, 0, v124
s_cbranch_vccnz L_rbad_539
s_branch L_rok_540
L_ste_519:
L_opdone_510:
chain_kernel_wend:
chain_kernel_end:
s_endpgm
.section .rodata,"a"
.p2align 6
.amdhsa_kernel chain_kernel
  .amdhsa_next_free_vgpr 512
  .amdhsa_next_free_sgpr 102
  .amdhsa_accum_offset 256
  .amdhsa_group_segment_fixed_size 0
  .amdhsa_kernarg_size 152
  .amdhsa_user_sgpr_count 2
  .amdhsa_user_sgpr_kernarg_segment_ptr 1
  .amdhsa_system_sgpr_workgroup_id_x 1
  .amdhsa_float_denorm_mode_32 3
  .amdhsa_float_denorm_mode_16_64 3
.end_amdhsa_kernel
```

```asm
; @launch kernel=chain_kernel grid=(256,1,1) block=(256,1,1) lds=163840
.amdgcn_target "amdgcn-amd-amdhsa--gfx950"
.text
.globl chain_kernel
.p2align 8
.type chain_kernel,@function
chain_kernel:
s_cmp_lt_u32 s2, 256
s_cbranch_scc1 chain_kernel_go
chain_kernel_end0:
s_endpgm
chain_kernel_go:
s_load_dwordx16 s[64:79], s[0:1], 0
s_load_dwordx16 s[80:95], s[0:1], 64
s_load_dwordx4 s[96:99], s[0:1], 128
s_load_dwordx2 s[100:101], s[0:1], 144
s_waitcnt lgkmcnt(0)
s_getpc_b64 s[4:5]
L_pc_1:
s_lshr_b32 s3, s2, 3
s_and_b32 s3, s3, 31
s_lshl_b32 s3, s3, 6
v_and_b32 v14, 63, v0
v_add_u32 v14, s3, v14
v_lshlrev_b32 v14, 6, v14
v_min_u32 v14, chain_kernel_end - L_pc_1, v14
global_load_dword v15, v14, s[4:5]
s_getreg_b32 s16, hwreg(HW_REG_XCC_ID)
s_and_b32 s16, s16, 7
v_lshrrev_b32 v3, 6, v0
s_mov_b32 s12, s98
s_and_b32 s13, s99, 0xffff
s_mov_b32 s14, 0x100
s_mov_b32 s15, 0x00020000
v_readfirstlane_b32 s18, v3
s_lshl_b32 s3, s16, 5
v_mov_b32 v12, 1
v_lshlrev_b32 v13, 8, v0
buffer_atomic_add v12, v13, s[12:15], s3 offen offset:24 sc0 sc1
s_add_u32 s8, s100, 0x5000000
s_addc_u32 s9, s101, 0
s_and_b32 s9, s9, 0xffff
s_mov_b32 s10, 0x180000
s_mov_b32 s11, 0x00020000
s_lshl_b32 s3, s2, 13
v_lshlrev_b32 v1, 4, v0
v_mov_b32 v4, 0xff81ff81
v_mov_b32 v5, 0xff81ff81
v_mov_b32 v6, 0xff81ff81
v_mov_b32 v7, 0xff81ff81
buffer_store_dwordx4 v[4:7], v1, s[8:11], s3 offen sc1
s_add_u32 s3, s3, 4096
buffer_store_dwordx4 v[4:7], v1, s[8:11], s3 offen sc1
s_add_u32 s3, s3, 4096
s_add_u32 s8, s100, 0x8000000
s_addc_u32 s9, s101, 0
s_and_b32 s9, s9, 0xffff
s_mov_b32 s10, 0x4600000
s_mov_b32 s11, 0x00020000
s_add_u32 s4, s8, 0x1fffff
s_and_b32 s4, s4, 0xffe00000
s_sub_u32 s4, s4, s8
s_add_u32 s8, s100, 0x5900000
s_addc_u32 s9, s101, 0
s_and_b32 s9, s9, 0xffff
s_mov_b32 s10, 0x10000
s_mov_b32 s11, 0x00020000
s_lshl_b32 s3, s2, 12
v_mov_b32 v8, 0
v_mov_b32 v9, 0
v_mov_b32 v10, 0
v_mov_b32 v11, 0
buffer_store_dwordx4 v[8:11], v1, s[8:11], s3 offen sc1
s_cmp_lg_u32 s18, 1
s_cbranch_scc1 L_role_2
s_mov_b32 s7, 1
s_cmp_lg_u32 s16, 6
s_cbranch_scc1 L_rolew_3
s_lshr_b32 s6, s2, 7
s_lshl_b32 s6, s6, 8
s_add_u32 s4, s4, s6
s_and_b32 s5, s2, 127
s_lshl_b32 s5, s5, 14
s_add_u32 s5, s5, s4
s_add_u32 s5, s5, 0xc000800
s_add_u32 s12, s100, s5
s_addc_u32 s13, s101, 0
s_mov_b32 s5, 0
s_mov_b32 s6, 0
s_atomic_add s5, s[12:13], 0x0 glc
s_atomic_add s6, s[12:13], 0x2000 glc
s_mov_b32 s24, -1
s_mov_b32 s25, -1
s_waitcnt lgkmcnt(0)
s_mov_b32 s5, 0
s_memtime s[20:21]
s_waitcnt lgkmcnt(0)
s_atomic_add s5, s[12:13], 0x0 glc
s_waitcnt lgkmcnt(0)
s_memtime s[22:23]
s_waitcnt lgkmcnt(0)
s_sub_u32 s22, s22, s20
s_min_u32 s24, s24, s22
s_mov_b32 s5, 0
s_memtime s[20:21]
s_waitcnt lgkmcnt(0)
s_atomic_add s5, s[12:13], 0x2000 glc
s_waitcnt lgkmcnt(0)
s_memtime s[22:23]
s_waitcnt lgkmcnt(0)
s_sub_u32 s22, s22, s20
s_min_u32 s25, s25, s22
s_mov_b32 s6, 0x1000001
s_cmp_gt_u32 s25, s24
s_cselect_b32 s7, 0x10001, s6
s_min_u32 s24, s24, s25
s_cmp_lt_u32 s24, 600
s_cselect_b32 s7, s7, 1
L_rolew_3:
L_role_2:
v_lshlrev_b32 v2, 2, v0
s_waitcnt vmcnt(0)
ds_write_b32 v2, v12 offset:0
s_waitcnt lgkmcnt(0)
s_barrier
v_mov_b32 v2, 0
ds_read_b32 v4, v2 offset:0
s_waitcnt lgkmcnt(0)
v_readfirstlane_b32 s17, v4
s_cmp_lg_u32 s18, 1
s_cbranch_scc1 L_nosig_4
s_cmp_lt_u32 s17, 32
s_cbranch_scc1 L_noovf_5
s_mov_b32 s5, 1
s_atomic_add s5, s[98:99], 0x8 glc
s_waitcnt lgkmcnt(0)
L_noovf_5:
s_atomic_add s7, s[98:99], 0x0
L_nosig_4:
s_cmp_lt_u32 s17, 32
s_cbranch_scc1 L_hasrole_6
s_mov_b32 s12, s98
s_and_b32 s13, s99, 0xffff
s_mov_b32 s14, 0x100
s_mov_b32 s15, 0x00020000
v_and_b32 v1, 7, v0
v_lshlrev_b32 v1, 5, v1
v_mov_b32 v2, 0
s_mov_b32 s3, 0
L_ovw_7:
buffer_load_dword v4, v2, s[12:15], 0 offen sc1
s_add_u32 s3, s3, 1
s_cmp_gt_u32 s3, 0x100000
s_cbranch_scc1 chain_kernel_end0
s_waitcnt vmcnt(0)
v_readfirstlane_b32 s5, v4
s_and_b32 s5, s5, 0xffff
s_cmp_lt_u32 s5, 256
s_cbranch_scc1 L_ovw_7
buffer_load_dword v4, v1, s[12:15], 0 offen offset:24 sc1
s_sub_u32 s17, s17, 32
s_waitcnt vmcnt(0)
v_readlane_b32 s20, v4, 0
v_readlane_b32 s21, v4, 1
v_readlane_b32 s22, v4, 2
v_readlane_b32 s23, v4, 3
v_readlane_b32 s24, v4, 4
v_readlane_b32 s25, v4, 5
v_readlane_b32 s26, v4, 6
v_readlane_b32 s27, v4, 7
s_max_u32 s5, s20, 32
s_sub_u32 s5, s5, 32
s_cmp_gt_u32 s16, 0
s_cselect_b32 s5, s5, 0
s_add_u32 s17, s17, s5
s_max_u32 s5, s21, 32
s_sub_u32 s5, s5, 32
s_cmp_gt_u32 s16, 1
s_cselect_b32 s5, s5, 0
s_add_u32 s17, s17, s5
s_max_u32 s5, s22, 32
s_sub_u32 s5, s5, 32
s_cmp_gt_u32 s16, 2
s_cselect_b32 s5, s5, 0
s_add_u32 s17, s17, s5
s_max_u32 s5, s23, 32
s_sub_u32 s5, s5, 32
s_cmp_gt_u32 s16, 3
s_cselect_b32 s5, s5, 0
s_add_u32 s17, s17, s5
s_max_u32 s5, s24, 32
s_sub_u32 s5, s5, 32
s_cmp_gt_u32 s16, 4
s_cselect_b32 s5, s5, 0
s_add_u32 s17, s17, s5
s_max_u32 s5, s25, 32
s_sub_u32 s5, s5, 32
s_cmp_gt_u32 s16, 5
s_cselect_b32 s5, s5, 0
s_add_u32 s17, s17, s5
s_max_u32 s5, s26, 32
s_sub_u32 s5, s5, 32
s_cmp_gt_u32 s16, 6
s_cselect_b32 s5, s5, 0
s_add_u32 s17, s17, s5
s_min_u32 s5, s20, 32
s_add_u32 s17, s17, s5
s_mov_b32 s16, 0
s_cmp_lt_u32 s17, 32
s_cbranch_scc1 L_hasrole_6
s_sub_u32 s17, s17, 32
s_min_u32 s5, s21, 32
s_add_u32 s17, s17, s5
s_mov_b32 s16, 1
s_cmp_lt_u32 s17, 32
s_cbranch_scc1 L_hasrole_6
s_sub_u32 s17, s17, 32
s_min_u32 s5, s22, 32
s_add_u32 s17, s17, s5
s_mov_b32 s16, 2
s_cmp_lt_u32 s17, 32
s_cbranch_scc1 L_hasrole_6
s_sub_u32 s17, s17, 32
s_min_u32 s5, s23, 32
s_add_u32 s17, s17, s5
s_mov_b32 s16, 3
s_cmp_lt_u32 s17, 32
s_cbranch_scc1 L_hasrole_6
s_sub_u32 s17, s17, 32
s_min_u32 s5, s24, 32
s_add_u32 s17, s17, s5
s_mov_b32 s16, 4
s_cmp_lt_u32 s17, 32
s_cbranch_scc1 L_hasrole_6
s_sub_u32 s17, s17, 32
s_min_u32 s5, s25, 32
s_add_u32 s17, s17, s5
s_mov_b32 s16, 5
s_cmp_lt_u32 s17, 32
s_cbranch_scc1 L_hasrole_6
s_sub_u32 s17, s17, 32
s_min_u32 s5, s26, 32
s_add_u32 s17, s17, s5
s_mov_b32 s16, 6
s_cmp_lt_u32 s17, 32
s_cbranch_scc1 L_hasrole_6
s_sub_u32 s17, s17, 32
s_min_u32 s5, s27, 32
s_add_u32 s17, s17, s5
s_mov_b32 s16, 7
s_cmp_lt_u32 s17, 32
s_cbranch_scc1 L_hasrole_6
s_sub_u32 s17, s17, 32
s_branch chain_kernel_end0
L_hasrole_6:
s_cmp_ge_u32 s16, 4
s_cbranch_scc1 chain_kernel_worker
s_mov_b32 s8, s100
s_and_b32 s9, s101, 0xffff
s_mov_b32 s10, 0x10000000
s_mov_b32 s11, 0x00020000
s_mov_b32 s33, 0
s_mov_b32 s24, 0xff00ff
s_mov_b32 s25, 0xff00ff
s_mov_b32 s26, 0xff00ff00
s_mov_b32 s27, 0xff00ff00
s_mov_b32 s28, 0x0
s_mov_b32 s29, 0xff00ff
s_mov_b32 s48, 0xffffffff
s_mov_b32 s49, 0x0
s_mov_b32 s50, 0xffff
s_mov_b32 s51, 0x0
s_mov_b32 s44, 0x3e0293ee
s_mov_b32 s45, 0x3e0293ee
s_mov_b32 s46, 0x3db504f3
s_mov_b32 s47, 0x3db504f3
s_mov_b32 s34, 0xff81ff81
s_lshl_b32 s36, s16, 14
s_add_u32 s36, s36, 0x5000000
s_lshl_b32 s37, s16, 16
s_add_u32 s37, s37, 0x5040000
v_mov_b32 v36, s34
v_mov_b32 v44, 0x3f803f80
v_mov_b32 v37, s34
v_mov_b32 v45, 0x3f803f80
v_mov_b32 v38, s34
v_mov_b32 v46, 0x3f803f80
v_mov_b32 v39, s34
v_mov_b32 v47, 0x3f803f80
v_and_b32 v250, 63, v0
v_and_b32 v248, 15, v0
v_bfe_u32 v249, v0, 4, 2
v_lshrrev_b32 v251, 6, v0
v_lshlrev_b32 v1, 4, v250
s_lshl_b32 s20, s16, 10
s_lshl_b32 s21, s17, 5
s_add_u32 s20, s20, s21
s_and_b32 s30, s17, 3
v_lshl_add_u32 v252, v251, 12, v1
s_add_u32 s21, s30, 0
s_and_b32 s21, s21, 3
s_lshl_b32 s21, s21, 10
v_add_u32 v2, s21, v252
s_add_u32 s21, s30, 1
s_and_b32 s21, s21, 3
s_lshl_b32 s21, s21, 10
v_add_u32 v3, s21, v252
s_add_u32 s21, s30, 2
s_and_b32 s21, s21, 3
s_lshl_b32 s21, s21, 10
v_add_u32 v4, s21, v252
s_add_u32 s21, s30, 3
s_and_b32 s21, s21, 3
s_lshl_b32 s21, s21, 10
v_add_u32 v5, s21, v252
v_mov_b32 v6, 0x44444444
v_mov_b32 v252, 0xeeeeeeee
v_cndmask_b32 v6, v6, v252, s[26:27]
v_bfe_u32 v252, v250, 1, 3
v_and_b32 v253, 1, v250
v_lshlrev_b32 v33, 11, v252
v_lshl_add_u32 v33, v253, 3, v33
v_lshl_add_u32 v33, v249, 4, v33
s_xor_b32 s22, s17, 8
s_lshl_b32 s21, s22, 6
v_add_u32 v33, s21, v33
v_lshlrev_b32 v8, 3, v250
s_xor_b32 s21, s17, 2
s_lshl_b32 s21, s21, 9
v_add_u32 v28, s21, v8
s_lshl_b32 s22, s22, 9
v_add_u32 v8, s22, v8
v_lshlrev_b32 v11, 4, v248
v_lshl_add_u32 v11, v249, 7, v11
v_add_u32 v11, s21, v11
s_lshr_b32 s22, s17, 2
s_lshl_b32 s22, s22, 13
s_add_u32 s21, s17, 0
s_and_b32 s21, s21, 3
s_lshl_b32 s21, s21, 10
s_add_u32 s21, s21, s22
v_add_u32 v9, s21, v1
s_add_u32 s21, s17, 1
s_and_b32 s21, s21, 3
s_lshl_b32 s21, s21, 10
s_add_u32 s21, s21, s22
v_add_u32 v13, s21, v1
s_add_u32 s21, s17, 2
s_and_b32 s21, s21, 3
s_lshl_b32 s21, s21, 10
s_add_u32 s21, s21, s22
v_add_u32 v14, s21, v1
s_add_u32 s21, s17, 3
s_and_b32 s21, s21, 3
s_lshl_b32 s21, s21, 10
s_add_u32 s21, s21, s22
v_add_u32 v15, s21, v1
s_add_u32 s22, s22, 4096
v_add_u32 v16, s22, v1
s_and_b32 s21, s17, 3
s_lshl_b32 s21, s21, 8
s_add_u32 s21, s21, s22
v_and_b32 v253, 1, v249
v_lshlrev_b32 v10, 4, v248
v_lshl_add_u32 v10, v253, 7, v10
v_add_u32 v10, s21, v10
v_lshl_add_u32 v20, v251, 11, v1
v_lshrrev_b32 v252, 1, v249
v_lshl_add_u32 v252, v251, 1, v252
v_lshlrev_b32 v21, 10, v252
v_lshl_add_u32 v21, v248, 5, v21
v_lshl_add_u32 v21, v253, 4, v21
v_add_u32 v21, 8192, v21
v_lshlrev_b32 v22, 5, v248
v_lshl_add_u32 v22, v249, 3, v22
v_add_u32 v22, 8192, v22
v_lshrrev_b32 v253, 2, v248
v_and_b32 v252, 3, v248
v_lshl_add_u32 v253, v253, 3, v252
v_add_u32 v25, 24576, v1
v_add_u32 v26, 26624, v1
v_lshlrev_b32 v32, 4, v253
v_lshl_add_u32 v29, v249, 9, v32
v_lshl_add_u32 v32, v249, 2, v32
v_add_u32 v32, 33792, v32
s_add_u32 s21, s16, 0
s_and_b32 s21, s21, 3
s_lshl_b32 s21, s21, 18
s_lshr_b32 s22, s17, 1
s_lshl_b32 s22, s22, 14
s_add_u32 s21, s21, s22
s_and_b32 s22, s17, 1
s_lshl_b32 s22, s22, 12
s_add_u32 s23, s21, s22
v_lshl_add_u32 v12, v250, 3, s23
s_add_u32 s21, s16, 1
s_and_b32 s21, s21, 3
s_lshl_b32 s21, s21, 18
s_lshr_b32 s22, s17, 1
s_lshl_b32 s22, s22, 14
s_add_u32 s21, s21, s22
s_and_b32 s22, s17, 1
s_lshl_b32 s22, s22, 12
s_add_u32 s21, s21, s22
v_lshl_add_u32 v17, v250, 3, s21
s_add_u32 s21, s16, 2
s_and_b32 s21, s21, 3
s_lshl_b32 s21, s21, 18
s_lshr_b32 s22, s17, 1
s_lshl_b32 s22, s22, 14
s_add_u32 s21, s21, s22
s_and_b32 s22, s17, 1
s_lshl_b32 s22, s22, 12
s_add_u32 s21, s21, s22
v_lshl_add_u32 v18, v250, 3, s21
s_add_u32 s21, s16, 3
s_and_b32 s21, s21, 3
s_lshl_b32 s21, s21, 18
s_lshr_b32 s22, s17, 1
s_lshl_b32 s22, s22, 14
s_add_u32 s21, s21, s22
s_and_b32 s22, s17, 1
s_lshl_b32 s22, s22, 12
s_add_u32 s21, s21, s22
v_lshl_add_u32 v19, v250, 3, s21
s_xor_b32 s21, s23, 0x4000
v_add_u32 v29, s21, v29
v_add_u32 v31, s21, v1
v_and_b32 v253, 8, v248
v_add_u32 v253, v253, v248
v_lshlrev_b32 v27, 4, v253
v_lshl_add_u32 v27, v249, 9, v27
v_add_u32 v27, s23, v27
v_bfe_u32 v253, v248, 2, 1
v_lshl_add_u32 v252, v252, 1, v253
v_cndmask_b32 v252, v248, v252, s[26:27]
v_lshlrev_b32 v30, 4, v252
v_lshl_add_u32 v30, v249, 7, v30
v_add_u32 v30, s23, v30
v_and_b32 v253, 1, v252
v_lshlrev_b32 v253, 4, v253
v_mov_b32 v254, 0x3f80
v_lshlrev_b32 v254, v253, v254
v_lshrrev_b32 v253, 2, v252
v_xor_b32 v253, v253, v249
v_and_b32 v253, 1, v253
v_bfe_u32 v252, v252, 1, 1
v_lshl_add_u32 v252, v253, 2, v252
v_lshrrev_b32 v253, 3, v248
v_lshl_add_u32 v252, v253, 1, v252
v_cmp_eq_u32 vcc, 0, v252
s_nop 1
v_cndmask_b32 v40, 0, v254, vcc
v_cmp_eq_u32 vcc, 1, v252
s_nop 1
v_cndmask_b32 v41, 0, v254, vcc
v_cmp_eq_u32 vcc, 2, v252
s_nop 1
v_cndmask_b32 v42, 0, v254, vcc
v_cmp_eq_u32 vcc, 3, v252
s_nop 1
v_cndmask_b32 v43, 0, v254, vcc
v_bfe_u32 v248, v0, 4, 2
v_lshlrev_b32 v250, 1, v248
v_bfe_u32 v248, v0, 2, 1
v_add_u32 v250, v250, v248
v_bfe_u32 v248, v0, 3, 1
v_lshl_add_u32 v250, v248, 3, v250
v_lshrrev_b32 v248, 6, v0
v_lshl_add_u32 v250, v248, 8, v250
v_and_b32 v249, 3, v0
v_lshlrev_b32 v251, 13, v250
v_lshl_add_u32 v251, v249, 4, v251
s_lshl_b32 s21, s20, 1
v_add_u32 v251, s21, v251
s_lshl_b32 s21, s16, 10
v_add_u32 v252, s21, v250
v_lshlrev_b32 v252, 11, v252
v_lshl_add_u32 v252, v249, 4, v252
s_xor_b32 s21, s17, 8
s_lshl_b32 s21, s21, 6
v_add_u32 v252, s21, v252
v_bfe_u32 v248, v0, 4, 2
v_lshlrev_b32 v248, 3, v248
v_bfe_u32 v242, v0, 2, 2
v_add_u32 v248, v248, v242
v_lshlrev_b32 v242, 6, v248
v_lshrrev_b32 v248, 6, v0
v_lshl_add_u32 v242, v248, 14, v242
v_lshl_add_u32 v240, v249, 3, v242
v_and_b32 v241, 2, v249
v_lshl_add_u32 v240, v241, 3, v240
v_lshl_add_u32 v242, v249, 4, v242
v_add_u32 v241, 0x10000, v240
v_add_u32 v243, 0x10000, v242
v_lshl_add_u32 v244, v248, 14, v1
v_add_u32 v245, 0x10000, v244
s_lshl_b32 s22, s18, 14
s_add_u32 s22, s22, 32768
s_and_b32 s23, s17, 14
s_cmp_eq_u32 s23, 6
s_cselect_b64 vcc, 0, -1
v_xor_b32 v253, 128, v251
s_mov_b32 s12, s88
s_and_b32 s13, s89, 0xffff
s_mov_b32 s14, 0x800000
s_mov_b32 s15, 0x00020000
s_add_u32 m0, s22, 0
s_add_u32 s23, s30, 0
s_and_b32 s23, s23, 3
s_lshl_b32 s23, s23, 2
s_add_u32 s23, s23, 0
s_mul_i32 s23, s23, 131072
buffer_load_dwordx4 v251, s[12:15], s23 offen lds
s_add_u32 m0, s22, 1024
s_add_u32 s23, s30, 0
s_and_b32 s23, s23, 3
s_lshl_b32 s23, s23, 2
s_add_u32 s23, s23, 1
s_mul_i32 s23, s23, 131072
buffer_load_dwordx4 v251, s[12:15], s23 offen lds
s_add_u32 m0, s22, 2048
s_add_u32 s23, s30, 0
s_and_b32 s23, s23, 3
s_lshl_b32 s23, s23, 2
s_add_u32 s23, s23, 2
s_mul_i32 s23, s23, 131072
buffer_load_dwordx4 v251, s[12:15], s23 offen lds
s_add_u32 m0, s22, 3072
s_add_u32 s23, s30, 0
s_and_b32 s23, s23, 3
s_lshl_b32 s23, s23, 2
s_add_u32 s23, s23, 3
s_mul_i32 s23, s23, 131072
buffer_load_dwordx4 v251, s[12:15], s23 offen lds
s_add_u32 m0, s22, 4096
s_add_u32 s23, s30, 1
s_and_b32 s23, s23, 3
s_lshl_b32 s23, s23, 2
s_add_u32 s23, s23, 0
s_mul_i32 s23, s23, 131072
buffer_load_dwordx4 v251, s[12:15], s23 offen lds
s_add_u32 m0, s22, 5120
s_add_u32 s23, s30, 1
s_and_b32 s23, s23, 3
s_lshl_b32 s23, s23, 2
s_add_u32 s23, s23, 1
s_mul_i32 s23, s23, 131072
buffer_load_dwordx4 v251, s[12:15], s23 offen lds
s_add_u32 m0, s22, 6144
s_add_u32 s23, s30, 1
s_and_b32 s23, s23, 3
s_lshl_b32 s23, s23, 2
s_add_u32 s23, s23, 2
s_mul_i32 s23, s23, 131072
buffer_load_dwordx4 v251, s[12:15], s23 offen lds
s_add_u32 m0, s22, 7168
s_add_u32 s23, s30, 1
s_and_b32 s23, s23, 3
s_lshl_b32 s23, s23, 2
s_add_u32 s23, s23, 3
s_mul_i32 s23, s23, 131072
buffer_load_dwordx4 v251, s[12:15], s23 offen lds
s_add_u32 m0, s22, 8192
s_add_u32 s23, s30, 2
s_and_b32 s23, s23, 3
s_lshl_b32 s23, s23, 2
s_add_u32 s23, s23, 0
s_mul_i32 s23, s23, 131072
buffer_load_dwordx4 v251, s[12:15], s23 offen lds
s_add_u32 m0, s22, 9216
s_add_u32 s23, s30, 2
s_and_b32 s23, s23, 3
s_lshl_b32 s23, s23, 2
s_add_u32 s23, s23, 1
s_mul_i32 s23, s23, 131072
buffer_load_dwordx4 v251, s[12:15], s23 offen lds
s_add_u32 m0, s22, 10240
s_add_u32 s23, s30, 2
s_and_b32 s23, s23, 3
s_lshl_b32 s23, s23, 2
s_add_u32 s23, s23, 2
s_mul_i32 s23, s23, 131072
buffer_load_dwordx4 v251, s[12:15], s23 offen lds
s_add_u32 m0, s22, 11264
s_add_u32 s23, s30, 2
s_and_b32 s23, s23, 3
s_lshl_b32 s23, s23, 2
s_add_u32 s23, s23, 3
s_mul_i32 s23, s23, 131072
buffer_load_dwordx4 v251, s[12:15], s23 offen lds
s_add_u32 m0, s22, 12288
s_add_u32 s23, s30, 3
s_and_b32 s23, s23, 3
s_lshl_b32 s23, s23, 2
s_add_u32 s23, s23, 0
s_mul_i32 s23, s23, 131072
buffer_load_dwordx4 v251, s[12:15], s23 offen lds
s_add_u32 m0, s22, 13312
s_add_u32 s23, s30, 3
s_and_b32 s23, s23, 3
s_lshl_b32 s23, s23, 2
s_add_u32 s23, s23, 1
s_mul_i32 s23, s23, 131072
buffer_load_dwordx4 v251, s[12:15], s23 offen lds
s_add_u32 m0, s22, 14336
s_add_u32 s23, s30, 3
s_and_b32 s23, s23, 3
s_lshl_b32 s23, s23, 2
s_add_u32 s23, s23, 2
s_mul_i32 s23, s23, 131072
buffer_load_dwordx4 v251, s[12:15], s23 offen lds
s_add_u32 m0, s22, 15360
s_add_u32 s23, s30, 3
s_and_b32 s23, s23, 3
s_lshl_b32 s23, s23, 2
s_add_u32 s23, s23, 3
s_mul_i32 s23, s23, 131072
buffer_load_dwordx4 v251, s[12:15], s23 offen lds
s_mov_b32 s12, s90
s_and_b32 s13, s91, 0xffff
s_mov_b32 s14, 0x800000
s_mov_b32 s15, 0x00020000
s_add_u32 m0, s22, 65536
s_add_u32 s23, s30, 0
s_and_b32 s23, s23, 3
s_lshl_b32 s23, s23, 2
s_add_u32 s23, s23, 0
s_mul_i32 s23, s23, 131072
buffer_load_dwordx4 v253, s[12:15], s23 offen lds
s_add_u32 m0, s22, 66560
s_add_u32 s23, s30, 0
s_and_b32 s23, s23, 3
s_lshl_b32 s23, s23, 2
s_add_u32 s23, s23, 1
s_mul_i32 s23, s23, 131072
buffer_load_dwordx4 v253, s[12:15], s23 offen lds
s_add_u32 m0, s22, 67584
s_add_u32 s23, s30, 0
s_and_b32 s23, s23, 3
s_lshl_b32 s23, s23, 2
s_add_u32 s23, s23, 2
s_mul_i32 s23, s23, 131072
buffer_load_dwordx4 v253, s[12:15], s23 offen lds
s_add_u32 m0, s22, 68608
s_add_u32 s23, s30, 0
s_and_b32 s23, s23, 3
s_lshl_b32 s23, s23, 2
s_add_u32 s23, s23, 3
s_mul_i32 s23, s23, 131072
buffer_load_dwordx4 v253, s[12:15], s23 offen lds
s_add_u32 m0, s22, 69632
s_add_u32 s23, s30, 1
s_and_b32 s23, s23, 3
s_lshl_b32 s23, s23, 2
s_add_u32 s23, s23, 0
s_mul_i32 s23, s23, 131072
buffer_load_dwordx4 v253, s[12:15], s23 offen lds
s_add_u32 m0, s22, 70656
s_add_u32 s23, s30, 1
s_and_b32 s23, s23, 3
s_lshl_b32 s23, s23, 2
s_add_u32 s23, s23, 1
s_mul_i32 s23, s23, 131072
buffer_load_dwordx4 v253, s[12:15], s23 offen lds
s_add_u32 m0, s22, 71680
s_add_u32 s23, s30, 1
s_and_b32 s23, s23, 3
s_lshl_b32 s23, s23, 2
s_add_u32 s23, s23, 2
s_mul_i32 s23, s23, 131072
buffer_load_dwordx4 v253, s[12:15], s23 offen lds
s_add_u32 m0, s22, 72704
s_add_u32 s23, s30, 1
s_and_b32 s23, s23, 3
s_lshl_b32 s23, s23, 2
s_add_u32 s23, s23, 3
s_mul_i32 s23, s23, 131072
buffer_load_dwordx4 v253, s[12:15], s23 offen lds
s_add_u32 m0, s22, 73728
s_add_u32 s23, s30, 2
s_and_b32 s23, s23, 3
s_lshl_b32 s23, s23, 2
s_add_u32 s23, s23, 0
s_mul_i32 s23, s23, 131072
buffer_load_dwordx4 v253, s[12:15], s23 offen lds
s_add_u32 m0, s22, 74752
s_add_u32 s23, s30, 2
s_and_b32 s23, s23, 3
s_lshl_b32 s23, s23, 2
s_add_u32 s23, s23, 1
s_mul_i32 s23, s23, 131072
buffer_load_dwordx4 v253, s[12:15], s23 offen lds
s_add_u32 m0, s22, 75776
s_add_u32 s23, s30, 2
s_and_b32 s23, s23, 3
s_lshl_b32 s23, s23, 2
s_add_u32 s23, s23, 2
s_mul_i32 s23, s23, 131072
buffer_load_dwordx4 v253, s[12:15], s23 offen lds
s_add_u32 m0, s22, 76800
s_add_u32 s23, s30, 2
s_and_b32 s23, s23, 3
s_lshl_b32 s23, s23, 2
s_add_u32 s23, s23, 3
s_mul_i32 s23, s23, 131072
buffer_load_dwordx4 v253, s[12:15], s23 offen lds
s_add_u32 m0, s22, 77824
s_add_u32 s23, s30, 3
s_and_b32 s23, s23, 3
s_lshl_b32 s23, s23, 2
s_add_u32 s23, s23, 0
s_mul_i32 s23, s23, 131072
buffer_load_dwordx4 v253, s[12:15], s23 offen lds
s_add_u32 m0, s22, 78848
s_add_u32 s23, s30, 3
s_and_b32 s23, s23, 3
s_lshl_b32 s23, s23, 2
s_add_u32 s23, s23, 1
s_mul_i32 s23, s23, 131072
buffer_load_dwordx4 v253, s[12:15], s23 offen lds
s_add_u32 m0, s22, 79872
s_add_u32 s23, s30, 3
s_and_b32 s23, s23, 3
s_lshl_b32 s23, s23, 2
s_add_u32 s23, s23, 2
s_mul_i32 s23, s23, 131072
buffer_load_dwordx4 v253, s[12:15], s23 offen lds
s_add_u32 m0, s22, 80896
s_add_u32 s23, s30, 3
s_and_b32 s23, s23, 3
s_lshl_b32 s23, s23, 2
s_add_u32 s23, s23, 3
s_mul_i32 s23, s23, 131072
buffer_load_dwordx4 v253, s[12:15], s23 offen lds
s_mov_b32 s12, s86
s_and_b32 s13, s87, 0xffff
s_mov_b32 s14, 0x800000
s_mov_b32 s15, 0x00020000
s_add_u32 s23, s30, 0
s_and_b32 s23, s23, 3
s_lshl_b32 s23, s23, 2
s_add_u32 s23, s23, 0
s_mul_i32 s23, s23, 131072
buffer_load_dwordx4 v[112:115], v251, s[12:15], s23 offen
s_add_u32 s23, s30, 0
s_and_b32 s23, s23, 3
s_lshl_b32 s23, s23, 2
s_add_u32 s23, s23, 1
s_mul_i32 s23, s23, 131072
buffer_load_dwordx4 v[116:119], v251, s[12:15], s23 offen
s_add_u32 s23, s30, 0
s_and_b32 s23, s23, 3
s_lshl_b32 s23, s23, 2
s_add_u32 s23, s23, 2
s_mul_i32 s23, s23, 131072
buffer_load_dwordx4 v[120:123], v251, s[12:15], s23 offen
s_add_u32 s23, s30, 0
s_and_b32 s23, s23, 3
s_lshl_b32 s23, s23, 2
s_add_u32 s23, s23, 3
s_mul_i32 s23, s23, 131072
buffer_load_dwordx4 v[124:127], v251, s[12:15], s23 offen
s_add_u32 s23, s30, 1
s_and_b32 s23, s23, 3
s_lshl_b32 s23, s23, 2
s_add_u32 s23, s23, 0
s_mul_i32 s23, s23, 131072
buffer_load_dwordx4 v[128:131], v251, s[12:15], s23 offen
s_add_u32 s23, s30, 1
s_and_b32 s23, s23, 3
s_lshl_b32 s23, s23, 2
s_add_u32 s23, s23, 1
s_mul_i32 s23, s23, 131072
buffer_load_dwordx4 v[132:135], v251, s[12:15], s23 offen
s_add_u32 s23, s30, 1
s_and_b32 s23, s23, 3
s_lshl_b32 s23, s23, 2
s_add_u32 s23, s23, 2
s_mul_i32 s23, s23, 131072
buffer_load_dwordx4 v[136:139], v251, s[12:15], s23 offen
s_add_u32 s23, s30, 1
s_and_b32 s23, s23, 3
s_lshl_b32 s23, s23, 2
s_add_u32 s23, s23, 3
s_mul_i32 s23, s23, 131072
buffer_load_dwordx4 v[140:143], v251, s[12:15], s23 offen
s_add_u32 s23, s30, 2
s_and_b32 s23, s23, 3
s_lshl_b32 s23, s23, 2
s_add_u32 s23, s23, 0
s_mul_i32 s23, s23, 131072
buffer_load_dwordx4 v[144:147], v251, s[12:15], s23 offen
s_add_u32 s23, s30, 2
s_and_b32 s23, s23, 3
s_lshl_b32 s23, s23, 2
s_add_u32 s23, s23, 1
s_mul_i32 s23, s23, 131072
buffer_load_dwordx4 v[148:151], v251, s[12:15], s23 offen
s_add_u32 s23, s30, 2
s_and_b32 s23, s23, 3
s_lshl_b32 s23, s23, 2
s_add_u32 s23, s23, 2
s_mul_i32 s23, s23, 131072
buffer_load_dwordx4 v[152:155], v251, s[12:15], s23 offen
s_add_u32 s23, s30, 2
s_and_b32 s23, s23, 3
s_lshl_b32 s23, s23, 2
s_add_u32 s23, s23, 3
s_mul_i32 s23, s23, 131072
buffer_load_dwordx4 v[156:159], v251, s[12:15], s23 offen
s_add_u32 s23, s30, 3
s_and_b32 s23, s23, 3
s_lshl_b32 s23, s23, 2
s_add_u32 s23, s23, 0
s_mul_i32 s23, s23, 131072
buffer_load_dwordx4 v[160:163], v251, s[12:15], s23 offen
s_add_u32 s23, s30, 3
s_and_b32 s23, s23, 3
s_lshl_b32 s23, s23, 2
s_add_u32 s23, s23, 1
s_mul_i32 s23, s23, 131072
buffer_load_dwordx4 v[164:167], v251, s[12:15], s23 offen
s_add_u32 s23, s30, 3
s_and_b32 s23, s23, 3
s_lshl_b32 s23, s23, 2
s_add_u32 s23, s23, 2
s_mul_i32 s23, s23, 131072
buffer_load_dwordx4 v[168:171], v251, s[12:15], s23 offen
s_add_u32 s23, s30, 3
s_and_b32 s23, s23, 3
s_lshl_b32 s23, s23, 2
s_add_u32 s23, s23, 3
s_mul_i32 s23, s23, 131072
buffer_load_dwordx4 v[172:175], v251, s[12:15], s23 offen
s_waitcnt vmcnt(32)
s_mov_b32 s12, s92
s_and_b32 s13, s93, 0xffff
s_mov_b32 s14, 0x800000
s_mov_b32 s15, 0x00020000
s_add_u32 s23, s30, 0
s_and_b32 s23, s23, 3
s_lshl_b32 s23, s23, 2
s_add_u32 s23, s23, 0
s_mul_i32 s23, s23, 32768
buffer_load_dwordx4 v[48:51], v252, s[12:15], s23 offen
s_add_u32 s23, s30, 0
s_and_b32 s23, s23, 3
s_lshl_b32 s23, s23, 2
s_add_u32 s23, s23, 1
s_mul_i32 s23, s23, 32768
buffer_load_dwordx4 v[52:55], v252, s[12:15], s23 offen
s_add_u32 s23, s30, 0
s_and_b32 s23, s23, 3
s_lshl_b32 s23, s23, 2
s_add_u32 s23, s23, 2
s_mul_i32 s23, s23, 32768
buffer_load_dwordx4 v[56:59], v252, s[12:15], s23 offen
s_add_u32 s23, s30, 0
s_and_b32 s23, s23, 3
s_lshl_b32 s23, s23, 2
s_add_u32 s23, s23, 3
s_mul_i32 s23, s23, 32768
buffer_load_dwordx4 v[60:63], v252, s[12:15], s23 offen
s_add_u32 s23, s30, 1
s_and_b32 s23, s23, 3
s_lshl_b32 s23, s23, 2
s_add_u32 s23, s23, 0
s_mul_i32 s23, s23, 32768
buffer_load_dwordx4 v[64:67], v252, s[12:15], s23 offen
s_add_u32 s23, s30, 1
s_and_b32 s23, s23, 3
s_lshl_b32 s23, s23, 2
s_add_u32 s23, s23, 1
s_mul_i32 s23, s23, 32768
buffer_load_dwordx4 v[68:71], v252, s[12:15], s23 offen
s_add_u32 s23, s30, 1
s_and_b32 s23, s23, 3
s_lshl_b32 s23, s23, 2
s_add_u32 s23, s23, 2
s_mul_i32 s23, s23, 32768
buffer_load_dwordx4 v[72:75], v252, s[12:15], s23 offen
s_add_u32 s23, s30, 1
s_and_b32 s23, s23, 3
s_lshl_b32 s23, s23, 2
s_add_u32 s23, s23, 3
s_mul_i32 s23, s23, 32768
buffer_load_dwordx4 v[76:79], v252, s[12:15], s23 offen
s_add_u32 s23, s30, 2
s_and_b32 s23, s23, 3
s_lshl_b32 s23, s23, 2
s_add_u32 s23, s23, 0
s_mul_i32 s23, s23, 32768
buffer_load_dwordx4 v[80:83], v252, s[12:15], s23 offen
s_add_u32 s23, s30, 2
s_and_b32 s23, s23, 3
s_lshl_b32 s23, s23, 2
s_add_u32 s23, s23, 1
s_mul_i32 s23, s23, 32768
buffer_load_dwordx4 v[84:87], v252, s[12:15], s23 offen
s_add_u32 s23, s30, 2
s_and_b32 s23, s23, 3
s_lshl_b32 s23, s23, 2
s_add_u32 s23, s23, 2
s_mul_i32 s23, s23, 32768
buffer_load_dwordx4 v[88:91], v252, s[12:15], s23 offen
s_add_u32 s23, s30, 2
s_and_b32 s23, s23, 3
s_lshl_b32 s23, s23, 2
s_add_u32 s23, s23, 3
s_mul_i32 s23, s23, 32768
buffer_load_dwordx4 v[92:95], v252, s[12:15], s23 offen
s_add_u32 s23, s30, 3
s_and_b32 s23, s23, 3
s_lshl_b32 s23, s23, 2
s_add_u32 s23, s23, 0
s_mul_i32 s23, s23, 32768
buffer_load_dwordx4 v[96:99], v252, s[12:15], s23 offen
s_add_u32 s23, s30, 3
s_and_b32 s23, s23, 3
s_lshl_b32 s23, s23, 2
s_add_u32 s23, s23, 1
s_mul_i32 s23, s23, 32768
buffer_load_dwordx4 v[100:103], v252, s[12:15], s23 offen
s_add_u32 s23, s30, 3
s_and_b32 s23, s23, 3
s_lshl_b32 s23, s23, 2
s_add_u32 s23, s23, 2
s_mul_i32 s23, s23, 32768
buffer_load_dwordx4 v[104:107], v252, s[12:15], s23 offen
s_add_u32 s23, s30, 3
s_and_b32 s23, s23, 3
s_lshl_b32 s23, s23, 2
s_add_u32 s23, s23, 3
s_mul_i32 s23, s23, 32768
buffer_load_dwordx4 v[108:111], v252, s[12:15], s23 offen
s_mov_b32 s12, s84
s_and_b32 s13, s85, 0xffff
s_mov_b32 s14, 0x4000
s_mov_b32 s15, 0x00020000
buffer_load_dwordx2 v[200:201], v33, s[12:15], 0 offen
s_mov_b32 s12, s98
s_and_b32 s13, s99, 0xffff
s_mov_b32 s14, 0x100
s_mov_b32 s15, 0x00020000
v_mov_b32 v34, 0
buffer_load_dwordx4 v[204:207], v34, s[12:15], 0 offen sc1
ds_read_b64_tr_b16 a[64:65], v240 offset:32768
ds_read_b64_tr_b16 a[66:67], v240 offset:33024
ds_read_b64_tr_b16 a[68:69], v240 offset:34816
ds_read_b64_tr_b16 a[70:71], v240 offset:35072
ds_read_b64_tr_b16 a[96:97], v240 offset:32784
ds_read_b64_tr_b16 a[98:99], v240 offset:33040
ds_read_b64_tr_b16 a[100:101], v240 offset:34832
ds_read_b64_tr_b16 a[102:103], v240 offset:35088
s_waitcnt lgkmcnt(0)
ds_read_b64_tr_b16 a[72:73], v240 offset:36864
ds_read_b64_tr_b16 a[74:75], v240 offset:37120
ds_read_b64_tr_b16 a[76:77], v240 offset:38912
ds_read_b64_tr_b16 a[78:79], v240 offset:39168
ds_read_b64_tr_b16 a[104:105], v240 offset:36880
ds_read_b64_tr_b16 a[106:107], v240 offset:37136
ds_read_b64_tr_b16 a[108:109], v240 offset:38928
ds_read_b64_tr_b16 a[110:111], v240 offset:39184
s_waitcnt lgkmcnt(0)
ds_read_b64_tr_b16 a[80:81], v240 offset:40960
ds_read_b64_tr_b16 a[82:83], v240 offset:41216
ds_read_b64_tr_b16 a[84:85], v240 offset:43008
ds_read_b64_tr_b16 a[86:87], v240 offset:43264
ds_read_b64_tr_b16 a[112:113], v240 offset:40976
ds_read_b64_tr_b16 a[114:115], v240 offset:41232
ds_read_b64_tr_b16 a[116:117], v240 offset:43024
ds_read_b64_tr_b16 a[118:119], v240 offset:43280
s_waitcnt lgkmcnt(0)
ds_read_b64_tr_b16 a[88:89], v240 offset:45056
ds_read_b64_tr_b16 a[90:91], v240 offset:45312
ds_read_b64_tr_b16 a[92:93], v240 offset:47104
ds_read_b64_tr_b16 a[94:95], v240 offset:47360
ds_read_b64_tr_b16 a[120:121], v240 offset:45072
ds_read_b64_tr_b16 a[122:123], v240 offset:45328
ds_read_b64_tr_b16 a[124:125], v240 offset:47120
ds_read_b64_tr_b16 a[126:127], v240 offset:47376
s_waitcnt lgkmcnt(0)
s_waitcnt vmcnt(34)
ds_read_b64_tr_b16 a[128:129], v243 offset:32768
ds_read_b64_tr_b16 a[130:131], v243 offset:33024
ds_read_b64_tr_b16 a[132:133], v243 offset:34816
ds_read_b64_tr_b16 a[134:135], v243 offset:35072
ds_read_b64_tr_b16 a[160:161], v243 offset:32776
ds_read_b64_tr_b16 a[162:163], v243 offset:33032
ds_read_b64_tr_b16 a[164:165], v243 offset:34824
ds_read_b64_tr_b16 a[166:167], v243 offset:35080
s_waitcnt lgkmcnt(0)
ds_read_b64_tr_b16 a[136:137], v243 offset:36864
ds_read_b64_tr_b16 a[138:139], v243 offset:37120
ds_read_b64_tr_b16 a[140:141], v243 offset:38912
ds_read_b64_tr_b16 a[142:143], v243 offset:39168
ds_read_b64_tr_b16 a[168:169], v243 offset:36872
ds_read_b64_tr_b16 a[170:171], v243 offset:37128
ds_read_b64_tr_b16 a[172:173], v243 offset:38920
ds_read_b64_tr_b16 a[174:175], v243 offset:39176
s_waitcnt lgkmcnt(0)
ds_read_b64_tr_b16 a[144:145], v243 offset:40960
ds_read_b64_tr_b16 a[146:147], v243 offset:41216
ds_read_b64_tr_b16 a[148:149], v243 offset:43008
ds_read_b64_tr_b16 a[150:151], v243 offset:43264
ds_read_b64_tr_b16 a[176:177], v243 offset:40968
ds_read_b64_tr_b16 a[178:179], v243 offset:41224
ds_read_b64_tr_b16 a[180:181], v243 offset:43016
ds_read_b64_tr_b16 a[182:183], v243 offset:43272
s_waitcnt lgkmcnt(0)
ds_read_b64_tr_b16 a[152:153], v243 offset:45056
ds_read_b64_tr_b16 a[154:155], v243 offset:45312
ds_read_b64_tr_b16 a[156:157], v243 offset:47104
ds_read_b64_tr_b16 a[158:159], v243 offset:47360
ds_read_b64_tr_b16 a[184:185], v243 offset:45064
ds_read_b64_tr_b16 a[186:187], v243 offset:45320
ds_read_b64_tr_b16 a[188:189], v243 offset:47112
ds_read_b64_tr_b16 a[190:191], v243 offset:47368
s_waitcnt lgkmcnt(0)
s_waitcnt vmcnt(18)
ds_write_b128 v244, v[112:115] offset:32768
ds_write_b128 v244, v[116:119] offset:33792
ds_write_b128 v244, v[120:123] offset:34816
ds_write_b128 v244, v[124:127] offset:35840
ds_write_b128 v244, v[128:131] offset:36864
ds_write_b128 v244, v[132:135] offset:37888
ds_write_b128 v244, v[136:139] offset:38912
ds_write_b128 v244, v[140:143] offset:39936
ds_write_b128 v244, v[144:147] offset:40960
ds_write_b128 v244, v[148:151] offset:41984
ds_write_b128 v244, v[152:155] offset:43008
ds_write_b128 v244, v[156:159] offset:44032
ds_write_b128 v244, v[160:163] offset:45056
ds_write_b128 v244, v[164:167] offset:46080
ds_write_b128 v244, v[168:171] offset:47104
ds_write_b128 v244, v[172:175] offset:48128
s_waitcnt lgkmcnt(0)
ds_read_b64_tr_b16 a[0:1], v240 offset:32768
ds_read_b64_tr_b16 a[2:3], v240 offset:33024
ds_read_b64_tr_b16 a[4:5], v240 offset:34816
ds_read_b64_tr_b16 a[6:7], v240 offset:35072
ds_read_b64_tr_b16 a[32:33], v240 offset:32784
ds_read_b64_tr_b16 a[34:35], v240 offset:33040
ds_read_b64_tr_b16 a[36:37], v240 offset:34832
ds_read_b64_tr_b16 a[38:39], v240 offset:35088
s_waitcnt lgkmcnt(0)
ds_read_b64_tr_b16 a[8:9], v240 offset:36864
ds_read_b64_tr_b16 a[10:11], v240 offset:37120
ds_read_b64_tr_b16 a[12:13], v240 offset:38912
ds_read_b64_tr_b16 a[14:15], v240 offset:39168
ds_read_b64_tr_b16 a[40:41], v240 offset:36880
ds_read_b64_tr_b16 a[42:43], v240 offset:37136
ds_read_b64_tr_b16 a[44:45], v240 offset:38928
ds_read_b64_tr_b16 a[46:47], v240 offset:39184
s_waitcnt lgkmcnt(0)
ds_read_b64_tr_b16 a[16:17], v240 offset:40960
ds_read_b64_tr_b16 a[18:19], v240 offset:41216
ds_read_b64_tr_b16 a[20:21], v240 offset:43008
ds_read_b64_tr_b16 a[22:23], v240 offset:43264
ds_read_b64_tr_b16 a[48:49], v240 offset:40976
ds_read_b64_tr_b16 a[50:51], v240 offset:41232
ds_read_b64_tr_b16 a[52:53], v240 offset:43024
ds_read_b64_tr_b16 a[54:55], v240 offset:43280
s_waitcnt lgkmcnt(0)
ds_read_b64_tr_b16 a[24:25], v240 offset:45056
ds_read_b64_tr_b16 a[26:27], v240 offset:45312
ds_read_b64_tr_b16 a[28:29], v240 offset:47104
ds_read_b64_tr_b16 a[30:31], v240 offset:47360
ds_read_b64_tr_b16 a[56:57], v240 offset:45072
ds_read_b64_tr_b16 a[58:59], v240 offset:45328
ds_read_b64_tr_b16 a[60:61], v240 offset:47120
ds_read_b64_tr_b16 a[62:63], v240 offset:47376
s_waitcnt lgkmcnt(0)
s_waitcnt vmcnt(0)
ds_write_b128 v245, v[48:51] offset:32768
ds_write_b128 v245, v[52:55] offset:33792
ds_write_b128 v245, v[56:59] offset:34816
ds_write_b128 v245, v[60:63] offset:35840
ds_write_b128 v245, v[64:67] offset:36864
ds_write_b128 v245, v[68:71] offset:37888
ds_write_b128 v245, v[72:75] offset:38912
ds_write_b128 v245, v[76:79] offset:39936
ds_write_b128 v245, v[80:83] offset:40960
ds_write_b128 v245, v[84:87] offset:41984
ds_write_b128 v245, v[88:91] offset:43008
ds_write_b128 v245, v[92:95] offset:44032
ds_write_b128 v245, v[96:99] offset:45056
ds_write_b128 v245, v[100:103] offset:46080
ds_write_b128 v245, v[104:107] offset:47104
ds_write_b128 v245, v[108:111] offset:48128
s_waitcnt lgkmcnt(0)
ds_read_b64_tr_b16 a[192:193], v243 offset:32768
ds_read_b64_tr_b16 a[194:195], v243 offset:33024
ds_read_b64_tr_b16 a[196:197], v243 offset:34816
ds_read_b64_tr_b16 a[198:199], v243 offset:35072
ds_read_b64_tr_b16 a[224:225], v243 offset:32776
ds_read_b64_tr_b16 a[226:227], v243 offset:33032
ds_read_b64_tr_b16 a[228:229], v243 offset:34824
ds_read_b64_tr_b16 a[230:231], v243 offset:35080
s_waitcnt lgkmcnt(0)
ds_read_b64_tr_b16 a[200:201], v243 offset:36864
ds_read_b64_tr_b16 a[202:203], v243 offset:37120
ds_read_b64_tr_b16 a[204:205], v243 offset:38912
ds_read_b64_tr_b16 a[206:207], v243 offset:39168
ds_read_b64_tr_b16 a[232:233], v243 offset:36872
ds_read_b64_tr_b16 a[234:235], v243 offset:37128
ds_read_b64_tr_b16 a[236:237], v243 offset:38920
ds_read_b64_tr_b16 a[238:239], v243 offset:39176
s_waitcnt lgkmcnt(0)
ds_read_b64_tr_b16 a[208:209], v243 offset:40960
ds_read_b64_tr_b16 a[210:211], v243 offset:41216
ds_read_b64_tr_b16 a[212:213], v243 offset:43008
ds_read_b64_tr_b16 a[214:215], v243 offset:43264
ds_read_b64_tr_b16 a[240:241], v243 offset:40968
ds_read_b64_tr_b16 a[242:243], v243 offset:41224
ds_read_b64_tr_b16 a[244:245], v243 offset:43016
ds_read_b64_tr_b16 a[246:247], v243 offset:43272
s_waitcnt lgkmcnt(0)
ds_read_b64_tr_b16 a[216:217], v243 offset:45056
ds_read_b64_tr_b16 a[218:219], v243 offset:45312
ds_read_b64_tr_b16 a[220:221], v243 offset:47104
ds_read_b64_tr_b16 a[222:223], v243 offset:47360
ds_read_b64_tr_b16 a[248:249], v243 offset:45064
ds_read_b64_tr_b16 a[250:251], v243 offset:45320
ds_read_b64_tr_b16 a[252:253], v243 offset:47112
ds_read_b64_tr_b16 a[254:255], v243 offset:47368
s_waitcnt lgkmcnt(0)
v_bfe_u32 v249, v0, 1, 1
v_lshlrev_b32 v249, 4, v249
v_mov_b32 v250, 0x3f80
v_lshlrev_b32 v250, v249, v250
v_bfe_u32 v248, v0, 3, 1
v_bfe_u32 v249, v0, 4, 1
v_xor_b32 v249, v249, v248
v_bfe_u32 v248, v0, 2, 1
v_lshl_add_u32 v248, v249, 2, v248
v_and_b32 v249, 1, v0
v_lshl_add_u32 v248, v249, 1, v248
v_cmp_eq_u32 vcc, 0, v248
s_nop 1
v_cndmask_b32 v252, 0, v250, vcc
v_cmp_eq_u32 vcc, 1, v248
s_nop 1
v_cndmask_b32 v253, 0, v250, vcc
v_cmp_eq_u32 vcc, 2, v248
s_nop 1
v_cndmask_b32 v254, 0, v250, vcc
v_cmp_eq_u32 vcc, 3, v248
s_nop 1
v_cndmask_b32 v255, 0, v250, vcc
v_mov_b32 v64, 0
v_mov_b32 v65, 0
v_mov_b32 v66, 0
v_mov_b32 v67, 0
v_mov_b32 v68, 0
v_mov_b32 v69, 0
v_mov_b32 v70, 0
v_mov_b32 v71, 0
v_mov_b32 v72, 0
v_mov_b32 v73, 0
v_mov_b32 v74, 0
v_mov_b32 v75, 0
v_mov_b32 v76, 0
v_mov_b32 v77, 0
v_mov_b32 v78, 0
v_mov_b32 v79, 0
v_mov_b32 v80, 0
v_mov_b32 v81, 0
v_mov_b32 v82, 0
v_mov_b32 v83, 0
v_mov_b32 v84, 0
v_mov_b32 v85, 0
v_mov_b32 v86, 0
v_mov_b32 v87, 0
v_mov_b32 v145, 0
v_mov_b32 v147, 0
v_mov_b32 v165, 0
s_bitcmp1_b32 s17, 2
s_cbranch_scc1 L_cwarme_9
s_lshr_b32 s20, s17, 3
s_lshl_b32 s20, s20, 2
s_and_b32 s21, s17, 3
s_add_u32 s20, s20, s21
s_lshl_b32 s21, s16, 4
s_add_u32 s20, s20, s21
s_lshl_b32 s20, s20, 12
v_lshlrev_b32 v34, 4, v0
s_mov_b32 s12, s82
s_and_b32 s13, s83, 0xffff
s_mov_b32 s14, 0x400000
s_mov_b32 s15, 0x00020000
s_mov_b32 s56, s64
s_and_b32 s57, s65, 0xffff
s_mov_b32 s58, 0x400000
s_mov_b32 s59, 0x00020000
buffer_load_dwordx4 v[168:171], v34, s[12:15], s20 offen
s_add_u32 s20, s20, 0x40000
buffer_load_dwordx4 v[168:171], v34, s[12:15], s20 offen
s_add_u32 s20, s20, 0x40000
buffer_load_dwordx4 v[168:171], v34, s[12:15], s20 offen
s_add_u32 s20, s20, 0x40000
buffer_load_dwordx4 v[168:171], v34, s[12:15], s20 offen
s_add_u32 s20, s20, 0x40000
buffer_load_dwordx4 v[168:171], v34, s[12:15], s20 offen
s_add_u32 s20, s20, 0x40000
buffer_load_dwordx4 v[168:171], v34, s[12:15], s20 offen
s_add_u32 s20, s20, 0x40000
buffer_load_dwordx4 v[168:171], v34, s[12:15], s20 offen
s_add_u32 s20, s20, 0x40000
buffer_load_dwordx4 v[168:171], v34, s[12:15], s20 offen
s_add_u32 s20, s20, 0x40000
buffer_load_dwordx4 v[168:171], v34, s[12:15], s20 offen
s_add_u32 s20, s20, 0x40000
buffer_load_dwordx4 v[168:171], v34, s[12:15], s20 offen
s_add_u32 s20, s20, 0x40000
buffer_load_dwordx4 v[168:171], v34, s[12:15], s20 offen
s_add_u32 s20, s20, 0x40000
buffer_load_dwordx4 v[168:171], v34, s[12:15], s20 offen
s_add_u32 s20, s20, 0x40000
buffer_load_dwordx4 v[168:171], v34, s[12:15], s20 offen
s_add_u32 s20, s20, 0x40000
buffer_load_dwordx4 v[168:171], v34, s[12:15], s20 offen
s_add_u32 s20, s20, 0x40000
buffer_load_dwordx4 v[168:171], v34, s[12:15], s20 offen
s_add_u32 s20, s20, 0x40000
buffer_load_dwordx4 v[168:171], v34, s[12:15], s20 offen
s_add_u32 s20, s20, 0x40000
L_cwarme_9:
s_mov_b32 s12, s98
s_and_b32 s13, s99, 0xffff
s_mov_b32 s14, 0x100
s_mov_b32 s15, 0x00020000
s_mov_b32 s19, 0
s_mov_b32 s53, 1
s_mov_b32 s43, 24576
s_add_u32 s54, s100, 0x5900000
s_addc_u32 s55, s101, 0
L_iw_10:
v_readfirstlane_b32 s20, v204
v_readfirstlane_b32 s32, v206
s_and_b32 s22, s20, 0xffff
s_cmp_ge_u32 s22, 256
s_cbranch_scc1 L_iok_11
v_mov_b32 v34, 0
buffer_load_dwordx4 v[204:207], v34, s[12:15], 0 offen sc1
s_waitcnt vmcnt(0)
s_add_u32 s33, s33, 1
s_cmp_gt_u32 s33, 0x100000
s_cbranch_scc0 L_iw_10
s_branch chain_kernel_abort
L_iok_11:
s_lshr_b32 s52, s20, 24
s_bfe_u32 s21, s20, 0x80010
s_cmp_gt_u32 s21, s52
s_cselect_b32 s21, 0x2000, 0x0
s_add_u32 s35, s100, 0x1fffff
s_and_b32 s35, s35, 0xffe00000
s_sub_u32 s52, s35, s100
s_add_u32 s35, s52, s21
s_xor_b32 s21, s21, 0x2000
s_add_u32 s52, s52, s21
s_mov_b32 s31, s35
s_cmp_lg_u32 s18, 3
s_cbranch_scc1 L_init3_12
s_lshl_b32 s21, s19, 7
s_add_u32 s21, s21, 0x5900000
v_mov_b32 v34, 0
L_dw_13:
buffer_load_dword v35, v34, s[8:11], s21 offen sc1
s_add_u32 s33, s33, 1
s_cmp_gt_u32 s33, 0x100000
s_waitcnt vmcnt(0)
s_cbranch_scc1 chain_kernel_abort
v_readfirstlane_b32 s20, v35
s_cmp_ge_u32 s20, 64
s_cbranch_scc1 L_dwok_14
s_sleep 2
s_branch L_dw_13
L_dwok_14:
s_add_u32 m0, s43, 0
s_nop 0
buffer_load_dwordx4 v27, s[8:11], s31 offen offset:0 lds
s_add_u32 m0, s43, 896
s_nop 0
buffer_load_dwordx4 v27, s[8:11], s31 offen offset:128 lds
s_add_u32 m0, s43, 0
s_nop 0
buffer_load_dwordx4 v29, s[8:11], s31 offen offset:2048 lds
s_add_u32 m0, s43, 960
s_nop 0
buffer_load_dwordx4 v29, s[8:11], s31 offen offset:2112 lds
s_xor_b32 s43, s43, 4096
s_waitcnt vmcnt(0)
L_init3_12:
s_and_b32 s20, s19, 3
s_lshl_b32 s21, s20, 16
s_add_u32 s38, s36, s21
s_add_u32 s41, s38, 0x140000
s_lshl_b32 s21, s20, 18
s_add_u32 s40, s37, s21
s_add_u32 s42, s31, 0x8000000
s_add_u32 s21, s19, 1
s_bitcmp1_b32 s21, 1
s_cselect_b32 s31, s52, s35
s_lshl_b32 s21, s21, 20
s_add_u32 s31, s31, s21
s_add_u32 s20, s20, 1
s_and_b32 s20, s20, 3
s_lshl_b32 s20, s20, 16
s_add_u32 s39, s36, s20
s_cmp_lg_u32 s18, 0
s_cbranch_scc1 L_init_15
v_cmp_eq_u32 vcc, s34, v200
s_nop 1
v_cndmask_b32 v200, v200, -1, vcc
v_cmp_eq_u32 vcc, s34, v201
s_nop 1
v_cndmask_b32 v201, v201, -1, vcc
buffer_store_dwordx2 v[200:201], v8, s[8:11], s38 offen sc1
s_xor_b32 s43, s43, 4096
s_setprio 3
L_init_15:
s_barrier
s_cmp_lg_u32 s32, 0
s_cbranch_scc1 L_slow_16
L_step_17:
s_nop 15
s_nop 7
L_step_17_nd:
buffer_load_dwordx4 v[48:51], v2, s[8:11], s38 offen sc1
v_mov_b32 v88, 0
v_mov_b32 v89, 0
v_mov_b32 v90, 0
v_mov_b32 v91, 0
v_mov_b32 v92, 0
v_mov_b32 v93, 0
v_mov_b32 v94, 0
v_mov_b32 v95, 0
ds_read_b128 v[116:119], v25
ds_read_b128 v[120:123], v25 offset:1024
v_xor_b32 v25, 0x1000, v25
s_nop 0
buffer_load_dwordx4 v[52:55], v3, s[8:11], s38 offen sc1
s_nop 11
buffer_load_dwordx4 v[56:59], v4, s[8:11], s38 offen sc1
s_nop 11
buffer_load_dwordx4 v[60:63], v5, s[8:11], s38 offen sc1
s_waitcnt vmcnt(3)
v_max3_u32 v7, v48, v49, v50
v_max_u32 v7, v7, v51
v_cmp_eq_u32 vcc, s34, v7
s_cbranch_vccnz L_q_a_24
L_v_a_25:
v_smfmac_f32_16x16x64_bf16 v[64:67], v[48:51], a[0:7], v6
s_waitcnt vmcnt(2)
v_max3_u32 v7, v52, v53, v54
v_max_u32 v7, v7, v55
v_smfmac_f32_16x16x64_bf16 v[68:71], v[48:51], a[64:71], v6
v_cmp_eq_u32 vcc, s34, v7
v_smfmac_f32_16x16x64_bf16 v[72:75], v[48:51], a[32:39], v6
v_smfmac_f32_16x16x64_bf16 v[76:79], v[48:51], a[96:103], v6
s_cbranch_vccnz L_q_a_26
L_v_a_27:
v_smfmac_f32_16x16x64_bf16 v[64:67], v[52:55], a[8:15], v6
s_waitcnt vmcnt(1)
v_max3_u32 v7, v56, v57, v58
v_max_u32 v7, v7, v59
v_smfmac_f32_16x16x64_bf16 v[68:71], v[52:55], a[72:79], v6
v_cmp_eq_u32 vcc, s34, v7
v_smfmac_f32_16x16x64_bf16 v[72:75], v[52:55], a[40:47], v6
v_smfmac_f32_16x16x64_bf16 v[76:79], v[52:55], a[104:111], v6
s_cbranch_vccnz L_q_a_28
L_v_a_29:
v_smfmac_f32_16x16x64_bf16 v[64:67], v[56:59], a[16:23], v6
s_waitcnt vmcnt(0)
v_max3_u32 v7, v60, v61, v62
v_max_u32 v7, v7, v63
v_smfmac_f32_16x16x64_bf16 v[68:71], v[56:59], a[80:87], v6
v_cmp_eq_u32 vcc, s34, v7
v_smfmac_f32_16x16x64_bf16 v[72:75], v[56:59], a[48:55], v6
v_smfmac_f32_16x16x64_bf16 v[76:79], v[56:59], a[112:119], v6
s_cbranch_vccnz L_q_a_30
L_v_a_31:
v_smfmac_f32_16x16x64_bf16 v[64:67], v[60:63], a[24:31], v6
v_smfmac_f32_16x16x64_bf16 v[68:71], v[60:63], a[88:95], v6
v_smfmac_f32_16x16x64_bf16 v[72:75], v[60:63], a[56:63], v6
v_smfmac_f32_16x16x64_bf16 v[76:79], v[60:63], a[120:127], v6
L_gd_a_23:
v_cvt_pk_bf16_f32 v96, v64, v65
v_cvt_pk_bf16_f32 v97, v66, v67
v_cvt_pk_bf16_f32 v98, v68, v69
v_cvt_pk_bf16_f32 v99, v70, v71
s_cmp_lg_u32 s18, 0
v_cvt_pk_bf16_f32 v100, v72, v73
v_mfma_f32_16x16x32_bf16 v[104:107], v[96:99], v[40:43], 0
v_cvt_pk_bf16_f32 v101, v74, v75
v_cvt_pk_bf16_f32 v102, v76, v77
v_cvt_pk_bf16_f32 v103, v78, v79
s_nop 1
v_mfma_f32_16x16x32_bf16 v[108:111], v[100:103], v[40:43], 0
s_cbranch_scc0 L_help1_18_w0
s_nop 0
ds_write_b128 v20, v[104:107]
s_nop 4
ds_write_b128 v20, v[108:111] offset:1024
s_waitcnt lgkmcnt(0)
s_barrier
v_smfmac_f32_16x16x64_bf16 v[80:83], v[48:51], a[128:135], v6
v_smfmac_f32_16x16x64_bf16 v[84:87], v[48:51], a[160:167], v6
v_smfmac_f32_16x16x64_bf16 v[80:83], v[52:55], a[136:143], v6
v_smfmac_f32_16x16x64_bf16 v[84:87], v[52:55], a[168:175], v6
v_smfmac_f32_16x16x64_bf16 v[80:83], v[56:59], a[144:151], v6
v_smfmac_f32_16x16x64_bf16 v[84:87], v[56:59], a[176:183], v6
v_smfmac_f32_16x16x64_bf16 v[80:83], v[60:63], a[152:159], v6
v_smfmac_f32_16x16x64_bf16 v[84:87], v[60:63], a[184:191], v6
s_nop 4
ds_write_b128 v21, v[80:83]
s_nop 1
ds_write_b128 v21, v[84:87] offset:512
s_waitcnt lgkmcnt(0)
L_bar2b_116_2:
s_barrier
s_cmp_eq_u32 s18, 1
s_cbranch_scc1 L_vred_115
L_bar2b_116:
s_waitcnt lgkmcnt(0)
s_barrier
s_cmp_eq_u32 s19, 63
s_cbranch_scc1 L_fin_22
s_cmp_lg_u32 s18, 2
s_cbranch_scc1 L_poe_117
s_sub_u32 s20, s19, 1
s_and_b32 s20, s20, 3
s_lshl_b32 s21, s20, 16
s_add_u32 s21, s21, s36
s_add_u32 s22, s21, 0x140000
s_lshl_b32 s23, s20, 18
s_add_u32 s23, s23, s37
buffer_store_dwordx2 v[36:37], v8, s[8:11], s21 offen
buffer_store_dwordx2 v[36:37], v28, s[8:11], s22 offen
buffer_store_dwordx4 v[36:39], v9, s[8:11], s23 offen
s_mov_b64 exec, s[28:29]
buffer_store_dwordx4 v[36:39], v10, s[8:11], s23 offen
s_mov_b64 exec, -1
L_poe_117:
s_cmp_lg_u32 s18, 3
s_cbranch_scc1 L_bar3_19
s_cmp_ge_u32 s19, 2
s_cbranch_scc1 L_gated_118
s_add_u32 s23, s19, 1
s_lshl_b32 s21, s23, 7
s_add_u32 s21, s21, 0x5900000
v_mov_b32 v34, 0
L_dw_119:
buffer_load_dword v35, v34, s[8:11], s21 offen sc1
s_add_u32 s33, s33, 1
s_cmp_gt_u32 s33, 0x100000
s_waitcnt vmcnt(0)
s_cbranch_scc1 chain_kernel_abort
v_readfirstlane_b32 s20, v35
s_cmp_ge_u32 s20, 64
s_cbranch_scc1 L_dwok_120
s_sleep 2
s_branch L_dw_119
L_dwok_120:
L_gated_118:
s_add_u32 m0, s43, 0
s_nop 0
buffer_load_dwordx4 v27, s[8:11], s31 offen offset:0 lds
s_add_u32 m0, s43, 896
s_nop 0
buffer_load_dwordx4 v27, s[8:11], s31 offen offset:128 lds
s_add_u32 m0, s43, 0
s_nop 0
buffer_load_dwordx4 v29, s[8:11], s31 offen offset:2048 lds
s_add_u32 m0, s43, 960
s_nop 0
buffer_load_dwordx4 v29, s[8:11], s31 offen offset:2112 lds
s_xor_b32 s43, s43, 4096
s_branch L_bar3_19
L_vred_115:
ds_read_b64 v[168:169], v22 offset:0
ds_read_b64 v[170:171], v22 offset:512
ds_read_b64 v[172:173], v22 offset:1024
ds_read_b64 v[174:175], v22 offset:1536
ds_read_b64 v[176:177], v22 offset:2048
ds_read_b64 v[178:179], v22 offset:2560
ds_read_b64 v[180:181], v22 offset:3072
ds_read_b64 v[182:183], v22 offset:3584
ds_read_b64 v[184:185], v22 offset:4096
ds_read_b64 v[186:187], v22 offset:4608
ds_read_b64 v[188:189], v22 offset:5120
ds_read_b64 v[190:191], v22 offset:5632
ds_read_b64 v[192:193], v22 offset:6144
ds_read_b64 v[194:195], v22 offset:6656
ds_read_b64 v[196:197], v22 offset:7168
s_waitcnt lgkmcnt(11)
ds_read_b64 v[198:199], v22 offset:7680
s_waitcnt lgkmcnt(8)
v_pk_add_f32 v[168:169], v[168:169], v[172:173]
v_pk_add_f32 v[170:171], v[170:171], v[174:175]
v_pk_add_f32 v[176:177], v[176:177], v[180:181]
v_pk_add_f32 v[178:179], v[178:179], v[182:183]
v_pk_add_f32 v[168:169], v[168:169], v[176:177]
v_pk_add_f32 v[170:171], v[170:171], v[178:179]
s_waitcnt lgkmcnt(0)
v_pk_add_f32 v[184:185], v[184:185], v[188:189]
v_pk_add_f32 v[186:187], v[186:187], v[190:191]
v_pk_add_f32 v[192:193], v[192:193], v[196:197]
v_pk_add_f32 v[194:195], v[194:195], v[198:199]
v_pk_add_f32 v[168:169], v[168:169], v[184:185]
v_pk_add_f32 v[170:171], v[170:171], v[186:187]
v_pk_add_f32 v[168:169], v[168:169], v[192:193]
v_pk_add_f32 v[170:171], v[170:171], v[194:195]
v_cvt_pk_bf16_f32 v144, v168, v169
v_cvt_pk_bf16_f32 v146, v170, v171
ds_write2_b32 v32, v144, v146 offset0:0 offset1:16
s_branch L_bar2b_116
L_help1_18_w0:
v_smfmac_f32_16x16x64_bf16 v[80:83], v[48:51], a[128:135], v6
v_smfmac_f32_16x16x64_bf16 v[84:87], v[48:51], a[160:167], v6
v_smfmac_f32_16x16x64_bf16 v[80:83], v[52:55], a[136:143], v6
v_smfmac_f32_16x16x64_bf16 v[84:87], v[52:55], a[168:175], v6
v_smfmac_f32_16x16x64_bf16 v[80:83], v[56:59], a[144:151], v6
v_smfmac_f32_16x16x64_bf16 v[84:87], v[56:59], a[176:183], v6
v_smfmac_f32_16x16x64_bf16 v[80:83], v[60:63], a[152:159], v6
v_smfmac_f32_16x16x64_bf16 v[84:87], v[60:63], a[184:191], v6
s_nop 4
ds_write_b128 v21, v[80:83]
s_nop 1
ds_write_b128 v21, v[84:87] offset:512
s_barrier
ds_read_b128 v[168:171], v1 offset:2048
ds_read_b128 v[172:175], v1 offset:3072
ds_read_b128 v[176:179], v1 offset:4096
ds_read_b128 v[180:183], v1 offset:5120
ds_read_b128 v[184:187], v1 offset:6144
ds_read_b128 v[188:191], v1 offset:7168
s_waitcnt lgkmcnt(4)
v_pk_add_f32 v[104:105], v[104:105], v[168:169]
v_pk_add_f32 v[106:107], v[106:107], v[170:171]
v_pk_add_f32 v[108:109], v[108:109], v[172:173]
v_pk_add_f32 v[110:111], v[110:111], v[174:175]
s_waitcnt lgkmcnt(2)
v_pk_add_f32 v[104:105], v[104:105], v[176:177]
v_pk_add_f32 v[106:107], v[106:107], v[178:179]
v_pk_add_f32 v[108:109], v[108:109], v[180:181]
v_pk_add_f32 v[110:111], v[110:111], v[182:183]
s_waitcnt lgkmcnt(0)
v_pk_add_f32 v[104:105], v[104:105], v[184:185]
v_pk_add_f32 v[106:107], v[106:107], v[186:187]
v_pk_add_f32 v[108:109], v[108:109], v[188:189]
v_pk_add_f32 v[110:111], v[110:111], v[190:191]
v_cvt_pk_bf16_f32 v112, v104, v105
v_cvt_pk_bf16_f32 v113, v106, v107
v_cvt_pk_bf16_f32 v114, v108, v109
v_cvt_pk_bf16_f32 v115, v110, v111
s_mov_b64 exec, s[28:29]
s_nop 0
v_mfma_f32_16x16x32_bf16 v[132:135], v[112:115], v[112:115], 0
v_mfma_f32_16x16x32_bf16 v[124:127], v[116:119], v[112:115], 0
v_mfma_f32_16x16x32_bf16 v[128:131], v[120:123], v[112:115], 0
s_nop 3
buffer_store_dwordx4 v[132:135], v10, s[8:11], s40 offen
s_mov_b64 exec, s[24:25]
buffer_store_dwordx4 v[124:127], v9, s[8:11], s40 offen
s_nop 0
buffer_store_dwordx4 v[128:131], v9, s[8:11], s40 offen offset:128
s_mov_b64 exec, -1
ds_write_b128 v1, v[112:115] offset:32768
ds_read_b128 v[136:139], v26 offset:0
ds_read_b128 v[140:143], v26 offset:1024
v_mov_b32_dpp v124, v128 row_shr:8 row_mask:0xf bank_mask:0xc
v_mov_b32_dpp v125, v129 row_shr:8 row_mask:0xf bank_mask:0xc
v_mov_b32_dpp v126, v130 row_shr:8 row_mask:0xf bank_mask:0xc
v_mov_b32_dpp v127, v131 row_shr:8 row_mask:0xf bank_mask:0xc
v_xor_b32 v26, 0x1000, v26
s_cmp_eq_u32 s19, 63
s_cbranch_scc1 L_bar2b_116_2
s_nop 11
buffer_load_dwordx4 v[200:203], v16, s[8:11], s40 offen sc1
buffer_load_dwordx4 v[204:207], v13, s[8:11], s40 offen sc1
buffer_load_dwordx4 v[208:211], v14, s[8:11], s40 offen sc1
buffer_load_dwordx4 v[212:215], v15, s[8:11], s40 offen sc1
s_barrier
s_nop 15
s_nop 13
buffer_load_dwordx4 v[216:219], v16, s[8:11], s40 offen sc1
buffer_load_dwordx4 v[220:223], v13, s[8:11], s40 offen sc1
buffer_load_dwordx4 v[224:227], v14, s[8:11], s40 offen sc1
buffer_load_dwordx4 v[228:231], v15, s[8:11], s40 offen sc1
s_waitcnt vmcnt(7)
v_permlane32_swap_b32 v200, v202
v_permlane32_swap_b32 v201, v203
s_waitcnt vmcnt(6)
v_pk_add_f32 v[154:155], v[200:201], v[202:203]
v_pk_add_f32 v[148:149], v[124:125], v[204:205]
v_pk_add_f32 v[150:151], v[126:127], v[206:207]
v_permlane16_swap_b32 v154, v155
s_waitcnt vmcnt(5)
v_pk_add_f32 v[148:149], v[148:149], v[208:209]
v_pk_add_f32 v[150:151], v[150:151], v[210:211]
v_add_f32 v152, v154, v155
s_waitcnt vmcnt(4)
v_pk_add_f32 v[148:149], v[148:149], v[212:213]
v_pk_add_f32 v[150:151], v[150:151], v[214:215]
v_pk_add_f32 v[154:155], v[148:149], v[150:151]
v_add_f32 v154, v154, v152
v_cmp_u_f32 vcc, v154, v155
v_max3_f32 v154, v148, v149, v150
v_max3_f32 v154, v154, v151, v152
s_nop 1
v_max_f32_dpp v154, v154, v154 row_ror:8 row_mask:0xf bank_mask:0xf
s_cbranch_vccnz L_cf_122
L_chead_124:
v_mov_b32 v156, v154
s_waitcnt lgkmcnt(0)
s_barrier
v_permlane16_swap_b32 v154, v156
v_max_f32 v154, v154, v156
v_mov_b32 v156, v154
ds_read_b32 v144, v32
ds_read_b32 v146, v32 offset:64
v_permlane32_swap_b32 v154, v156
v_max_f32 v154, v154, v156
v_mul_f32 v154, s44, v154
v_fma_f32 v152, v152, s44, -v154
v_exp_f32 v152, v152
v_pk_fma_f32 v[148:149], v[148:149], s[44:45], v[154:155] op_sel_hi:[1,1,0] neg_lo:[0,0,1] neg_hi:[0,0,1]
v_pk_fma_f32 v[150:151], v[150:151], s[44:45], v[154:155] op_sel_hi:[1,1,0] neg_lo:[0,0,1] neg_hi:[0,0,1]
v_mov_b32_dpp v156, v152 row_ror:8 row_mask:0xf bank_mask:0xf
v_exp_f32 v148, v148
v_cvt_pk_bf16_f32 v164, v152, v156
v_exp_f32 v149, v149
v_exp_f32 v150, v150
v_mfma_f32_16x16x16_bf16 v[176:179], v[44:45], v[164:165], 0
v_exp_f32 v151, v151
s_waitcnt lgkmcnt(0)
v_cvt_pk_bf16_f32 v160, v148, v149
v_mfma_f32_16x16x16_bf16 v[168:171], v[144:145], v[164:165], 0
v_cvt_pk_bf16_f32 v161, v150, v151
v_mov_b32_dpp v162, v160 row_ror:8 row_mask:0xf bank_mask:0xf
v_mfma_f32_16x16x16_bf16 v[172:175], v[146:147], v[164:165], 0
v_mov_b32_dpp v163, v161 row_ror:8 row_mask:0xf bank_mask:0xf
s_nop 0
s_mov_b64 exec, s[24:25]
v_mfma_f32_16x16x32_bf16 v[176:179], v[44:47], v[160:163], v[176:179]
v_mfma_f32_16x16x32_bf16 v[168:171], v[136:139], v[160:163], v[168:171]
v_mfma_f32_16x16x32_bf16 v[172:175], v[140:143], v[160:163], v[172:175]
s_nop 3
v_rcp_f32 v176, v176
s_nop 0
v_pk_mul_f32 v[168:169], v[168:169], v[176:177] op_sel_hi:[1,0]
v_pk_mul_f32 v[170:171], v[170:171], v[176:177] op_sel_hi:[1,0]
v_pk_mul_f32 v[172:173], v[172:173], v[176:177] op_sel_hi:[1,0]
v_pk_mul_f32 v[174:175], v[174:175], v[176:177] op_sel_hi:[1,0]
v_cvt_pk_bf16_f32 v180, v168, v169
v_cvt_pk_bf16_f32 v181, v170, v171
v_cvt_pk_bf16_f32 v182, v172, v173
v_cvt_pk_bf16_f32 v183, v174, v175
buffer_store_dwordx4 v[180:183], v11, s[8:11], s41 offen
s_mov_b64 exec, -1
s_barrier
s_nop 15
s_nop 3
s_branch L_bar3_19_e
L_bar3_19:
s_waitcnt lgkmcnt(0)
s_barrier
s_nop 15
s_nop 7
L_bar3_19_e:
buffer_load_dwordx4 v[48:51], v2, s[8:11], s41 offen sc1
v_mov_b32 v64, 0
v_mov_b32 v65, 0
v_mov_b32 v66, 0
v_mov_b32 v67, 0
v_mov_b32 v68, 0
v_mov_b32 v69, 0
v_mov_b32 v70, 0
v_mov_b32 v71, 0
v_mov_b32 v72, 0
v_mov_b32 v73, 0
v_mov_b32 v74, 0
v_mov_b32 v75, 0
buffer_load_dwordx4 v[52:55], v3, s[8:11], s41 offen sc1
v_mov_b32 v76, 0
v_mov_b32 v77, 0
v_mov_b32 v78, 0
v_mov_b32 v79, 0
v_mov_b32 v80, 0
v_mov_b32 v81, 0
v_mov_b32 v82, 0
v_mov_b32 v83, 0
v_mov_b32 v84, 0
v_mov_b32 v85, 0
v_mov_b32 v86, 0
v_mov_b32 v87, 0
buffer_load_dwordx4 v[56:59], v4, s[8:11], s41 offen sc1
s_nop 11
buffer_load_dwordx4 v[60:63], v5, s[8:11], s41 offen sc1
s_waitcnt vmcnt(3)
v_max3_u32 v7, v48, v49, v50
v_max_u32 v7, v7, v51
v_cmp_eq_u32 vcc, s34, v7
s_cbranch_vccnz L_q_e_126
L_v_e_127:
v_smfmac_f32_16x16x64_bf16 v[88:91], v[48:51], a[192:199], v6
s_waitcnt vmcnt(2)
v_max3_u32 v7, v52, v53, v54
v_max_u32 v7, v7, v55
v_cmp_eq_u32 vcc, s34, v7
v_smfmac_f32_16x16x64_bf16 v[92:95], v[48:51], a[224:231], v6
s_cbranch_vccnz L_q_e_128
L_v_e_129:
v_smfmac_f32_16x16x64_bf16 v[88:91], v[52:55], a[200:207], v6
s_waitcnt vmcnt(1)
v_max3_u32 v7, v56, v57, v58
v_max_u32 v7, v7, v59
v_cmp_eq_u32 vcc, s34, v7
v_smfmac_f32_16x16x64_bf16 v[92:95], v[52:55], a[232:239], v6
s_cbranch_vccnz L_q_e_130
L_v_e_131:
v_smfmac_f32_16x16x64_bf16 v[88:91], v[56:59], a[208:215], v6
s_waitcnt vmcnt(0)
v_max3_u32 v7, v60, v61, v62
v_max_u32 v7, v7, v63
v_cmp_eq_u32 vcc, s34, v7
v_smfmac_f32_16x16x64_bf16 v[92:95], v[56:59], a[240:247], v6
s_cbranch_vccnz L_q_e_132
L_v_e_133:
v_smfmac_f32_16x16x64_bf16 v[88:91], v[60:63], a[216:223], v6
v_smfmac_f32_16x16x64_bf16 v[92:95], v[60:63], a[248:255], v6
L_gd_e_125:
s_add_u32 s19, s19, 1
s_cmp_lg_u32 s18, 0
s_nop 2
v_cvt_pk_bf16_f32 v96, v88, v89
v_cvt_pk_bf16_f32 v97, v90, v91
s_nop 0
v_cvt_pk_bf16_f32 v98, v92, v93
v_cvt_pk_bf16_f32 v99, v94, v95
s_nop 1
v_mfma_f32_16x16x32_bf16 v[104:107], v[96:99], v[252:255], 0
s_cbranch_scc1 L_help2_20
s_barrier
ds_read_b128 v[172:175], v1 offset:18432
ds_read_b128 v[176:179], v1 offset:20480
ds_read_b128 v[180:183], v1 offset:22528
s_waitcnt lgkmcnt(2)
v_pk_add_f32 v[168:169], v[104:105], v[172:173]
v_pk_add_f32 v[170:171], v[106:107], v[174:175]
s_waitcnt lgkmcnt(1)
v_pk_add_f32 v[168:169], v[168:169], v[176:177]
v_pk_add_f32 v[170:171], v[170:171], v[178:179]
s_waitcnt lgkmcnt(0)
v_pk_add_f32 v[168:169], v[168:169], v[180:181]
v_pk_add_f32 v[170:171], v[170:171], v[182:183]
v_cvt_pk_bf16_f32 v96, v168, v169
v_cvt_pk_bf16_f32 v97, v170, v171
buffer_store_dwordx2 v[96:97], v12, s[8:11], s42 offen offset:0 sc1
buffer_store_dwordx2 v[96:97], v12, s[8:11], s42 offen offset:512 sc1
s_mov_b32 s22, s42
s_mov_b32 s23, s39
s_and_b32 s20, s19, 3
s_lshl_b32 s21, s20, 16
s_add_u32 s38, s36, s21
s_add_u32 s41, s38, 0x140000
s_lshl_b32 s21, s20, 18
s_add_u32 s40, s37, s21
s_add_u32 s42, s31, 0x8000000
s_add_u32 s21, s19, 1
s_bitcmp1_b32 s21, 1
s_cselect_b32 s31, s52, s35
s_lshl_b32 s21, s21, 20
s_add_u32 s31, s31, s21
s_add_u32 s20, s20, 1
s_and_b32 s20, s20, 3
s_lshl_b32 s20, s20, 16
s_add_u32 s39, s36, s20
s_nop 15
s_nop 15
s_nop 15
buffer_load_dwordx2 v[200:201], v17, s[8:11], s22 offen offset:0 sc1
buffer_load_dwordx2 v[202:203], v18, s[8:11], s22 offen offset:0 sc1
buffer_load_dwordx2 v[204:205], v19, s[8:11], s22 offen offset:0 sc1
s_nop 15
s_nop 15
s_nop 15
s_nop 11
buffer_load_dwordx2 v[212:213], v17, s[8:11], s22 offen offset:512 sc1
buffer_load_dwordx2 v[214:215], v18, s[8:11], s22 offen offset:512 sc1
buffer_load_dwordx2 v[216:217], v19, s[8:11], s22 offen offset:512 sc1
ds_read_b128 v[172:175], v1 offset:33792
s_mov_b64 exec, s[26:27]
s_waitcnt lgkmcnt(1)
buffer_store_dwordx4 v[112:115], v30, s[8:11], s22 offen offset:3072 sc1
s_mov_b64 exec, s[48:49]
s_waitcnt lgkmcnt(0)
buffer_store_dwordx4 v[172:175], v31, s[8:11], s22 offen offset:3584 sc1
s_mov_b64 exec, -1
s_waitcnt vmcnt(7)
v_lshlrev_b32 v100, 16, v200
v_and_b32 v101, 0xffff0000, v200
v_lshlrev_b32 v102, 16, v201
v_and_b32 v103, 0xffff0000, v201
v_pk_add_f32 v[148:149], v[168:169], v[100:101]
v_pk_add_f32 v[150:151], v[170:171], v[102:103]
s_waitcnt vmcnt(6)
v_lshlrev_b32 v100, 16, v202
v_and_b32 v101, 0xffff0000, v202
v_lshlrev_b32 v102, 16, v203
v_and_b32 v103, 0xffff0000, v203
v_pk_add_f32 v[148:149], v[148:149], v[100:101]
v_pk_add_f32 v[150:151], v[150:151], v[102:103]
s_waitcnt vmcnt(5)
v_lshlrev_b32 v100, 16, v204
v_and_b32 v101, 0xffff0000, v204
v_lshlrev_b32 v102, 16, v205
v_and_b32 v103, 0xffff0000, v205
v_pk_add_f32 v[148:149], v[148:149], v[100:101]
v_pk_add_f32 v[150:151], v[150:151], v[102:103]
v_cmp_u_f32 vcc, v148, v150
v_cvt_pk_bf16_f32 v180, v148, v149
v_cvt_pk_bf16_f32 v181, v150, v151
s_cbranch_vccnz L_gf_217
L_gok_218:
buffer_store_dwordx2 v[180:181], v8, s[8:11], s23 offen
s_barrier
s_branch L_step_17
L_help2_20:
s_nop 2
ds_write_b128 v20, v[104:107] offset:16384
s_waitcnt lgkmcnt(0)
s_barrier
s_and_b32 s20, s19, 3
s_lshl_b32 s21, s20, 16
s_add_u32 s38, s36, s21
s_add_u32 s41, s38, 0x140000
s_lshl_b32 s21, s20, 18
s_add_u32 s40, s37, s21
s_add_u32 s42, s31, 0x8000000
s_add_u32 s21, s19, 1
s_bitcmp1_b32 s21, 1
s_cselect_b32 s31, s52, s35
s_lshl_b32 s21, s21, 20
s_add_u32 s31, s31, s21
s_add_u32 s20, s20, 1
s_and_b32 s20, s20, 3
s_lshl_b32 s20, s20, 16
s_add_u32 s39, s36, s20
s_cmp_eq_u32 s18, 3
s_cbranch_scc1 L_w3_221
s_xor_b32 s20, s18, 2
s_or_b32 s20, s20, s16
s_or_b32 s20, s20, s17
s_cbranch_scc1 L_bar4_21
s_cmp_lt_u32 s19, 3
s_cbranch_scc1 L_bar4_21
s_atomic_add s53, s[98:99], 0x4
s_branch L_bar4_21
L_w3_221:
s_or_b32 s20, s16, s17
s_cbranch_scc1 L_bar4_21
s_add_u32 s23, s19, 2
s_min_u32 s23, s23, 63
s_lshl_b32 s21, s23, 7
v_mov_b32 v34, 0
L_dw_222:
s_load_dword s20, s[54:55], s21 glc
s_add_u32 s33, s33, 1
s_cmp_gt_u32 s33, 0x100000
s_waitcnt lgkmcnt(0)
s_cbranch_scc1 chain_kernel_abort
s_cmp_ge_u32 s20, 64
s_cbranch_scc1 L_dwok_223
s_sleep 2
s_branch L_dw_222
L_dwok_223:
L_bar4_21:
s_barrier
s_branch L_step_17
L_fin_22:
s_cmp_lg_u32 s18, 2
s_cbranch_scc1 chain_kernel_done
ds_read_b128 v[168:171], v1 offset:32768
ds_read_b128 v[172:175], v1 offset:33792
s_mov_b64 exec, s[26:27]
s_waitcnt lgkmcnt(1)
buffer_store_dwordx4 v[168:171], v30, s[8:11], s42 offen offset:3072 sc1
s_mov_b64 exec, s[48:49]
s_waitcnt lgkmcnt(0)
buffer_store_dwordx4 v[172:175], v31, s[8:11], s42 offen offset:3584 sc1
s_mov_b64 exec, -1
s_branch chain_kernel_done
L_q_a_30:
buffer_load_dwordx4 v[60:63], v5, s[8:11], s38 offen sc1
s_waitcnt vmcnt(0)
v_max3_u32 v7, v60, v61, v62
v_max_u32 v7, v7, v63
v_cmp_eq_u32 vcc, s34, v7
s_cbranch_vccnz L_q_a_32
s_branch L_v_a_31
L_q_a_32:
buffer_load_dwordx4 v[60:63], v5, s[8:11], s38 offen sc1
s_waitcnt vmcnt(2)
v_max3_u32 v7, v60, v61, v62
v_max_u32 v7, v7, v63
v_cmp_eq_u32 vcc, s34, v7
s_cbranch_vccz L_ok_a_33
s_add_u32 s33, s33, 1
s_cmp_gt_u32 s33, 0x100000
s_cbranch_scc0 L_q_a_32
s_branch chain_kernel_abort
L_ok_a_33:
v_smfmac_f32_16x16x64_bf16 v[64:67], v[60:63], a[24:31], v6
v_smfmac_f32_16x16x64_bf16 v[68:71], v[60:63], a[88:95], v6
v_smfmac_f32_16x16x64_bf16 v[72:75], v[60:63], a[56:63], v6
v_smfmac_f32_16x16x64_bf16 v[76:79], v[60:63], a[120:127], v6
s_branch L_gd_a_23
L_q_a_28:
buffer_load_dwordx4 v[56:59], v4, s[8:11], s38 offen sc1
s_waitcnt vmcnt(1)
v_max3_u32 v7, v60, v61, v62
v_max_u32 v7, v7, v63
v_cmp_eq_u32 vcc, s34, v7
s_cbranch_vccnz L_q_a_34
L_v_a_35:
v_smfmac_f32_16x16x64_bf16 v[64:67], v[60:63], a[24:31], v6
s_waitcnt vmcnt(0)
v_max3_u32 v7, v56, v57, v58
v_max_u32 v7, v7, v59
v_smfmac_f32_16x16x64_bf16 v[68:71], v[60:63], a[88:95], v6
v_cmp_eq_u32 vcc, s34, v7
v_smfmac_f32_16x16x64_bf16 v[72:75], v[60:63], a[56:63], v6
v_smfmac_f32_16x16x64_bf16 v[76:79], v[60:63], a[120:127], v6
s_cbranch_vccnz L_q_a_36
L_v_a_37:
v_smfmac_f32_16x16x64_bf16 v[64:67], v[56:59], a[16:23], v6
v_smfmac_f32_16x16x64_bf16 v[68:71], v[56:59], a[80:87], v6
v_smfmac_f32_16x16x64_bf16 v[72:75], v[56:59], a[48:55], v6
v_smfmac_f32_16x16x64_bf16 v[76:79], v[56:59], a[112:119], v6
s_branch L_gd_a_23
L_q_a_36:
buffer_load_dwordx4 v[56:59], v4, s[8:11], s38 offen sc1
s_waitcnt vmcnt(2)
v_max3_u32 v7, v56, v57, v58
v_max_u32 v7, v7, v59
v_cmp_eq_u32 vcc, s34, v7
s_cbranch_vccz L_ok_a_38
s_add_u32 s33, s33, 1
s_cmp_gt_u32 s33, 0x100000
s_cbranch_scc0 L_q_a_36
s_branch chain_kernel_abort
L_ok_a_38:
v_smfmac_f32_16x16x64_bf16 v[64:67], v[56:59], a[16:23], v6
v_smfmac_f32_16x16x64_bf16 v[68:71], v[56:59], a[80:87], v6
v_smfmac_f32_16x16x64_bf16 v[72:75], v[56:59], a[48:55], v6
v_smfmac_f32_16x16x64_bf16 v[76:79], v[56:59], a[112:119], v6
s_branch L_gd_a_23
L_q_a_34:
buffer_load_dwordx4 v[60:63], v5, s[8:11], s38 offen sc1
s_waitcnt vmcnt(1)
v_max3_u32 v7, v56, v57, v58
v_max_u32 v7, v7, v59
v_cmp_eq_u32 vcc, s34, v7
s_cbranch_vccnz L_q_a_39
L_v_a_40:
v_smfmac_f32_16x16x64_bf16 v[64:67], v[56:59], a[16:23], v6
s_waitcnt vmcnt(0)
v_max3_u32 v7, v60, v61, v62
v_max_u32 v7, v7, v63
v_smfmac_f32_16x16x64_bf16 v[68:71], v[56:59], a[80:87], v6
v_cmp_eq_u32 vcc, s34, v7
v_smfmac_f32_16x16x64_bf16 v[72:75], v[56:59], a[48:55], v6
v_smfmac_f32_16x16x64_bf16 v[76:79], v[56:59], a[112:119], v6
s_cbranch_vccnz L_q_a_32
s_branch L_v_a_31
L_q_a_39:
buffer_load_dwordx4 v[56:59], v4, s[8:11], s38 offen sc1
s_waitcnt vmcnt(2)
v_max3_u32 v7, v60, v61, v62
v_max_u32 v7, v7, v63
v_cmp_eq_u32 vcc, s34, v7
s_cbranch_vccz L_ok_a_41
buffer_load_dwordx4 v[60:63], v5, s[8:11], s38 offen sc1
s_waitcnt vmcnt(2)
v_max3_u32 v7, v56, v57, v58
v_max_u32 v7, v7, v59
v_cmp_eq_u32 vcc, s34, v7
s_cbranch_vccz L_ok_a_42
s_add_u32 s33, s33, 1
s_cmp_gt_u32 s33, 0x100000
s_cbranch_scc0 L_q_a_39
s_branch chain_kernel_abort
L_ok_a_41:
v_smfmac_f32_16x16x64_bf16 v[64:67], v[60:63], a[24:31], v6
v_smfmac_f32_16x16x64_bf16 v[68:71], v[60:63], a[88:95], v6
v_smfmac_f32_16x16x64_bf16 v[72:75], v[60:63], a[56:63], v6
v_smfmac_f32_16x16x64_bf16 v[76:79], v[60:63], a[120:127], v6
s_branch L_q_a_36
L_ok_a_42:
v_smfmac_f32_16x16x64_bf16 v[64:67], v[56:59], a[16:23], v6
v_smfmac_f32_16x16x64_bf16 v[68:71], v[56:59], a[80:87], v6
v_smfmac_f32_16x16x64_bf16 v[72:75], v[56:59], a[48:55], v6
v_smfmac_f32_16x16x64_bf16 v[76:79], v[56:59], a[112:119], v6
s_branch L_q_a_32
L_q_a_26:
buffer_load_dwordx4 v[52:55], v3, s[8:11], s38 offen sc1
s_waitcnt vmcnt(2)
v_max3_u32 v7, v56, v57, v58
v_max_u32 v7, v7, v59
v_cmp_eq_u32 vcc, s34, v7
s_cbranch_vccnz L_q_a_43
L_v_a_44:
v_smfmac_f32_16x16x64_bf16 v[64:67], v[56:59], a[16:23], v6
s_waitcnt vmcnt(1)
v_max3_u32 v7, v60, v61, v62
v_max_u32 v7, v7, v63
v_smfmac_f32_16x16x64_bf16 v[68:71], v[56:59], a[80:87], v6
v_cmp_eq_u32 vcc, s34, v7
v_smfmac_f32_16x16x64_bf16 v[72:75], v[56:59], a[48:55], v6
v_smfmac_f32_16x16x64_bf16 v[76:79], v[56:59], a[112:119], v6
s_cbranch_vccnz L_q_a_45
L_v_a_46:
v_smfmac_f32_16x16x64_bf16 v[64:67], v[60:63], a[24:31], v6
s_waitcnt vmcnt(0)
v_max3_u32 v7, v52, v53, v54
v_max_u32 v7, v7, v55
v_smfmac_f32_16x16x64_bf16 v[68:71], v[60:63], a[88:95], v6
v_cmp_eq_u32 vcc, s34, v7
v_smfmac_f32_16x16x64_bf16 v[72:75], v[60:63], a[56:63], v6
v_smfmac_f32_16x16x64_bf16 v[76:79], v[60:63], a[120:127], v6
s_cbranch_vccnz L_q_a_47
L_v_a_48:
v_smfmac_f32_16x16x64_bf16 v[64:67], v[52:55], a[8:15], v6
v_smfmac_f32_16x16x64_bf16 v[68:71], v[52:55], a[72:79], v6
v_smfmac_f32_16x16x64_bf16 v[72:75], v[52:55], a[40:47], v6
v_smfmac_f32_16x16x64_bf16 v[76:79], v[52:55], a[104:111], v6
s_branch L_gd_a_23
L_q_a_47:
buffer_load_dwordx4 v[52:55], v3, s[8:11], s38 offen sc1
s_waitcnt vmcnt(2)
v_max3_u32 v7, v52, v53, v54
v_max_u32 v7, v7, v55
v_cmp_eq_u32 vcc, s34, v7
s_cbranch_vccz L_ok_a_49
s_add_u32 s33, s33, 1
s_cmp_gt_u32 s33, 0x100000
s_cbranch_scc0 L_q_a_47
s_branch chain_kernel_abort
L_ok_a_49:
v_smfmac_f32_16x16x64_bf16 v[64:67], v[52:55], a[8:15], v6
v_smfmac_f32_16x16x64_bf16 v[68:71], v[52:55], a[72:79], v6
v_smfmac_f32_16x16x64_bf16 v[72:75], v[52:55], a[40:47], v6
v_smfmac_f32_16x16x64_bf16 v[76:79], v[52:55], a[104:111], v6
s_branch L_gd_a_23
L_q_a_45:
buffer_load_dwordx4 v[60:63], v5, s[8:11], s38 offen sc1
s_waitcnt vmcnt(1)
v_max3_u32 v7, v52, v53, v54
v_max_u32 v7, v7, v55
v_cmp_eq_u32 vcc, s34, v7
s_cbranch_vccnz L_q_a_50
L_v_a_51:
v_smfmac_f32_16x16x64_bf16 v[64:67], v[52:55], a[8:15], v6
s_waitcnt vmcnt(0)
v_max3_u32 v7, v60, v61, v62
v_max_u32 v7, v7, v63
v_smfmac_f32_16x16x64_bf16 v[68:71], v[52:55], a[72:79], v6
v_cmp_eq_u32 vcc, s34, v7
v_smfmac_f32_16x16x64_bf16 v[72:75], v[52:55], a[40:47], v6
v_smfmac_f32_16x16x64_bf16 v[76:79], v[52:55], a[104:111], v6
s_cbranch_vccnz L_q_a_32
s_branch L_v_a_31
L_q_a_50:
buffer_load_dwordx4 v[52:55], v3, s[8:11], s38 offen sc1
s_waitcnt vmcnt(2)
v_max3_u32 v7, v60, v61, v62
v_max_u32 v7, v7, v63
v_cmp_eq_u32 vcc, s34, v7
s_cbranch_vccz L_ok_a_52
buffer_load_dwordx4 v[60:63], v5, s[8:11], s38 offen sc1
s_waitcnt vmcnt(2)
v_max3_u32 v7, v52, v53, v54
v_max_u32 v7, v7, v55
v_cmp_eq_u32 vcc, s34, v7
s_cbranch_vccz L_ok_a_53
s_add_u32 s33, s33, 1
s_cmp_gt_u32 s33, 0x100000
s_cbranch_scc0 L_q_a_50
s_branch chain_kernel_abort
L_ok_a_52:
v_smfmac_f32_16x16x64_bf16 v[64:67], v[60:63], a[24:31], v6
v_smfmac_f32_16x16x64_bf16 v[68:71], v[60:63], a[88:95], v6
v_smfmac_f32_16x16x64_bf16 v[72:75], v[60:63], a[56:63], v6
v_smfmac_f32_16x16x64_bf16 v[76:79], v[60:63], a[120:127], v6
s_branch L_q_a_47
L_ok_a_53:
v_smfmac_f32_16x16x64_bf16 v[64:67], v[52:55], a[8:15], v6
v_smfmac_f32_16x16x64_bf16 v[68:71], v[52:55], a[72:79], v6
v_smfmac_f32_16x16x64_bf16 v[72:75], v[52:55], a[40:47], v6
v_smfmac_f32_16x16x64_bf16 v[76:79], v[52:55], a[104:111], v6
s_branch L_q_a_32
L_q_a_43:
buffer_load_dwordx4 v[56:59], v4, s[8:11], s38 offen sc1
s_waitcnt vmcnt(2)
v_max3_u32 v7, v60, v61, v62
v_max_u32 v7, v7, v63
v_cmp_eq_u32 vcc, s34, v7
s_cbranch_vccnz L_q_a_54
L_v_a_55:
v_smfmac_f32_16x16x64_bf16 v[64:67], v[60:63], a[24:31], v6
s_waitcnt vmcnt(1)
v_max3_u32 v7, v52, v53, v54
v_max_u32 v7, v7, v55
v_smfmac_f32_16x16x64_bf16 v[68:71], v[60:63], a[88:95], v6
v_cmp_eq_u32 vcc, s34, v7
v_smfmac_f32_16x16x64_bf16 v[72:75], v[60:63], a[56:63], v6
v_smfmac_f32_16x16x64_bf16 v[76:79], v[60:63], a[120:127], v6
s_cbranch_vccnz L_q_a_56
L_v_a_57:
v_smfmac_f32_16x16x64_bf16 v[64:67], v[52:55], a[8:15], v6
s_waitcnt vmcnt(0)
v_max3_u32 v7, v56, v57, v58
v_max_u32 v7, v7, v59
v_smfmac_f32_16x16x64_bf16 v[68:71], v[52:55], a[72:79], v6
v_cmp_eq_u32 vcc, s34, v7
v_smfmac_f32_16x16x64_bf16 v[72:75], v[52:55], a[40:47], v6
v_smfmac_f32_16x16x64_bf16 v[76:79], v[52:55], a[104:111], v6
s_cbranch_vccnz L_q_a_36
s_branch L_v_a_37
L_q_a_56:
buffer_load_dwordx4 v[52:55], v3, s[8:11], s38 offen sc1
s_waitcnt vmcnt(2)
v_max3_u32 v7, v56, v57, v58
v_max_u32 v7, v7, v59
v_cmp_eq_u32 vcc, s34, v7
s_cbranch_vccz L_ok_a_58
buffer_load_dwordx4 v[56:59], v4, s[8:11], s38 offen sc1
s_waitcnt vmcnt(2)
v_max3_u32 v7, v52, v53, v54
v_max_u32 v7, v7, v55
v_cmp_eq_u32 vcc, s34, v7
s_cbranch_vccz L_ok_a_59
s_add_u32 s33, s33, 1
s_cmp_gt_u32 s33, 0x100000
s_cbranch_scc0 L_q_a_56
s_branch chain_kernel_abort
L_ok_a_58:
v_smfmac_f32_16x16x64_bf16 v[64:67], v[56:59], a[16:23], v6
v_smfmac_f32_16x16x64_bf16 v[68:71], v[56:59], a[80:87], v6
v_smfmac_f32_16x16x64_bf16 v[72:75], v[56:59], a[48:55], v6
v_smfmac_f32_16x16x64_bf16 v[76:79], v[56:59], a[112:119], v6
s_branch L_q_a_47
L_ok_a_59:
v_smfmac_f32_16x16x64_bf16 v[64:67], v[52:55], a[8:15], v6
v_smfmac_f32_16x16x64_bf16 v[68:71], v[52:55], a[72:79], v6
v_smfmac_f32_16x16x64_bf16 v[72:75], v[52:55], a[40:47], v6
v_smfmac_f32_16x16x64_bf16 v[76:79], v[52:55], a[104:111], v6
s_branch L_q_a_36
L_q_a_54:
buffer_load_dwordx4 v[60:63], v5, s[8:11], s38 offen sc1
s_waitcnt vmcnt(2)
v_max3_u32 v7, v52, v53, v54
v_max_u32 v7, v7, v55
v_cmp_eq_u32 vcc, s34, v7
s_cbranch_vccnz L_q_a_60
L_v_a_61:
v_smfmac_f32_16x16x64_bf16 v[64:67], v[52:55], a[8:15], v6
s_waitcnt vmcnt(1)
v_max3_u32 v7, v56, v57, v58
v_max_u32 v7, v7, v59
v_smfmac_f32_16x16x64_bf16 v[68:71], v[52:55], a[72:79], v6
v_cmp_eq_u32 vcc, s34, v7
v_smfmac_f32_16x16x64_bf16 v[72:75], v[52:55], a[40:47], v6
v_smfmac_f32_16x16x64_bf16 v[76:79], v[52:55], a[104:111], v6
s_cbranch_vccnz L_q_a_39
s_branch L_v_a_40
L_q_a_60:
buffer_load_dwordx4 v[52:55], v3, s[8:11], s38 offen sc1
s_waitcnt vmcnt(2)
v_max3_u32 v7, v56, v57, v58
v_max_u32 v7, v7, v59
v_cmp_eq_u32 vcc, s34, v7
s_cbranch_vccz L_ok_a_62
buffer_load_dwordx4 v[56:59], v4, s[8:11], s38 offen sc1
s_waitcnt vmcnt(2)
v_max3_u32 v7, v60, v61, v62
v_max_u32 v7, v7, v63
v_cmp_eq_u32 vcc, s34, v7
s_cbranch_vccz L_ok_a_63
buffer_load_dwordx4 v[60:63], v5, s[8:11], s38 offen sc1
s_waitcnt vmcnt(2)
v_max3_u32 v7, v52, v53, v54
v_max_u32 v7, v7, v55
v_cmp_eq_u32 vcc, s34, v7
s_cbranch_vccz L_ok_a_64
s_add_u32 s33, s33, 1
s_cmp_gt_u32 s33, 0x100000
s_cbranch_scc0 L_q_a_60
s_branch chain_kernel_abort
L_ok_a_62:
v_smfmac_f32_16x16x64_bf16 v[64:67], v[56:59], a[16:23], v6
v_smfmac_f32_16x16x64_bf16 v[68:71], v[56:59], a[80:87], v6
v_smfmac_f32_16x16x64_bf16 v[72:75], v[56:59], a[48:55], v6
v_smfmac_f32_16x16x64_bf16 v[76:79], v[56:59], a[112:119], v6
s_branch L_q_a_50
L_ok_a_63:
v_smfmac_f32_16x16x64_bf16 v[64:67], v[60:63], a[24:31], v6
v_smfmac_f32_16x16x64_bf16 v[68:71], v[60:63], a[88:95], v6
v_smfmac_f32_16x16x64_bf16 v[72:75], v[60:63], a[56:63], v6
v_smfmac_f32_16x16x64_bf16 v[76:79], v[60:63], a[120:127], v6
s_branch L_q_a_56
L_ok_a_64:
v_smfmac_f32_16x16x64_bf16 v[64:67], v[52:55], a[8:15], v6
v_smfmac_f32_16x16x64_bf16 v[68:71], v[52:55], a[72:79], v6
v_smfmac_f32_16x16x64_bf16 v[72:75], v[52:55], a[40:47], v6
v_smfmac_f32_16x16x64_bf16 v[76:79], v[52:55], a[104:111], v6
s_branch L_q_a_39
L_q_a_24:
buffer_load_dwordx4 v[48:51], v2, s[8:11], s38 offen sc1
s_waitcnt vmcnt(3)
v_max3_u32 v7, v52, v53, v54
v_max_u32 v7, v7, v55
v_cmp_eq_u32 vcc, s34, v7
s_cbranch_vccnz L_q_a_65
L_v_a_66:
v_smfmac_f32_16x16x64_bf16 v[64:67], v[52:55], a[8:15], v6
s_waitcnt vmcnt(2)
v_max3_u32 v7, v56, v57, v58
v_max_u32 v7, v7, v59
v_smfmac_f32_16x16x64_bf16 v[68:71], v[52:55], a[72:79], v6
v_cmp_eq_u32 vcc, s34, v7
v_smfmac_f32_16x16x64_bf16 v[72:75], v[52:55], a[40:47], v6
v_smfmac_f32_16x16x64_bf16 v[76:79], v[52:55], a[104:111], v6
s_cbranch_vccnz L_q_a_67
L_v_a_68:
v_smfmac_f32_16x16x64_bf16 v[64:67], v[56:59], a[16:23], v6
s_waitcnt vmcnt(1)
v_max3_u32 v7, v60, v61, v62
v_max_u32 v7, v7, v63
v_smfmac_f32_16x16x64_bf16 v[68:71], v[56:59], a[80:87], v6
v_cmp_eq_u32 vcc, s34, v7
v_smfmac_f32_16x16x64_bf16 v[72:75], v[56:59], a[48:55], v6
v_smfmac_f32_16x16x64_bf16 v[76:79], v[56:59], a[112:119], v6
s_cbranch_vccnz L_q_a_69
L_v_a_70:
v_smfmac_f32_16x16x64_bf16 v[64:67], v[60:63], a[24:31], v6
s_waitcnt vmcnt(0)
v_max3_u32 v7, v48, v49, v50
v_max_u32 v7, v7, v51
v_smfmac_f32_16x16x64_bf16 v[68:71], v[60:63], a[88:95], v6
v_cmp_eq_u32 vcc, s34, v7
v_smfmac_f32_16x16x64_bf16 v[72:75], v[60:63], a[56:63], v6
v_smfmac_f32_16x16x64_bf16 v[76:79], v[60:63], a[120:127], v6
s_cbranch_vccnz L_q_a_71
L_v_a_72:
v_smfmac_f32_16x16x64_bf16 v[64:67], v[48:51], a[0:7], v6
v_smfmac_f32_16x16x64_bf16 v[68:71], v[48:51], a[64:71], v6
v_smfmac_f32_16x16x64_bf16 v[72:75], v[48:51], a[32:39], v6
v_smfmac_f32_16x16x64_bf16 v[76:79], v[48:51], a[96:103], v6
s_branch L_gd_a_23
L_q_a_71:
buffer_load_dwordx4 v[48:51], v2, s[8:11], s38 offen sc1
s_waitcnt vmcnt(2)
v_max3_u32 v7, v48, v49, v50
v_max_u32 v7, v7, v51
v_cmp_eq_u32 vcc, s34, v7
s_cbranch_vccz L_ok_a_73
s_add_u32 s33, s33, 1
s_cmp_gt_u32 s33, 0x100000
s_cbranch_scc0 L_q_a_71
s_branch chain_kernel_abort
L_ok_a_73:
v_smfmac_f32_16x16x64_bf16 v[64:67], v[48:51], a[0:7], v6
v_smfmac_f32_16x16x64_bf16 v[68:71], v[48:51], a[64:71], v6
v_smfmac_f32_16x16x64_bf16 v[72:75], v[48:51], a[32:39], v6
v_smfmac_f32_16x16x64_bf16 v[76:79], v[48:51], a[96:103], v6
s_branch L_gd_a_23
L_q_a_69:
buffer_load_dwordx4 v[60:63], v5, s[8:11], s38 offen sc1
s_waitcnt vmcnt(1)
v_max3_u32 v7, v48, v49, v50
v_max_u32 v7, v7, v51
v_cmp_eq_u32 vcc, s34, v7
s_cbranch_vccnz L_q_a_74
L_v_a_75:
v_smfmac_f32_16x16x64_bf16 v[64:67], v[48:51], a[0:7], v6
s_waitcnt vmcnt(0)
v_max3_u32 v7, v60, v61, v62
v_max_u32 v7, v7, v63
v_smfmac_f32_16x16x64_bf16 v[68:71], v[48:51], a[64:71], v6
v_cmp_eq_u32 vcc, s34, v7
v_smfmac_f32_16x16x64_bf16 v[72:75], v[48:51], a[32:39], v6
v_smfmac_f32_16x16x64_bf16 v[76:79], v[48:51], a[96:103], v6
s_cbranch_vccnz L_q_a_32
s_branch L_v_a_31
L_q_a_74:
buffer_load_dwordx4 v[48:51], v2, s[8:11], s38 offen sc1
s_waitcnt vmcnt(2)
v_max3_u32 v7, v60, v61, v62
v_max_u32 v7, v7, v63
v_cmp_eq_u32 vcc, s34, v7
s_cbranch_vccz L_ok_a_76
buffer_load_dwordx4 v[60:63], v5, s[8:11], s38 offen sc1
s_waitcnt vmcnt(2)
v_max3_u32 v7, v48, v49, v50
v_max_u32 v7, v7, v51
v_cmp_eq_u32 vcc, s34, v7
s_cbranch_vccz L_ok_a_77
s_add_u32 s33, s33, 1
s_cmp_gt_u32 s33, 0x100000
s_cbranch_scc0 L_q_a_74
s_branch chain_kernel_abort
L_ok_a_76:
v_smfmac_f32_16x16x64_bf16 v[64:67], v[60:63], a[24:31], v6
v_smfmac_f32_16x16x64_bf16 v[68:71], v[60:63], a[88:95], v6
v_smfmac_f32_16x16x64_bf16 v[72:75], v[60:63], a[56:63], v6
v_smfmac_f32_16x16x64_bf16 v[76:79], v[60:63], a[120:127], v6
s_branch L_q_a_71
L_ok_a_77:
v_smfmac_f32_16x16x64_bf16 v[64:67], v[48:51], a[0:7], v6
v_smfmac_f32_16x16x64_bf16 v[68:71], v[48:51], a[64:71], v6
v_smfmac_f32_16x16x64_bf16 v[72:75], v[48:51], a[32:39], v6
v_smfmac_f32_16x16x64_bf16 v[76:79], v[48:51], a[96:103], v6
s_branch L_q_a_32
L_q_a_67:
buffer_load_dwordx4 v[56:59], v4, s[8:11], s38 offen sc1
s_waitcnt vmcnt(2)
v_max3_u32 v7, v60, v61, v62
v_max_u32 v7, v7, v63
v_cmp_eq_u32 vcc, s34, v7
s_cbranch_vccnz L_q_a_78
L_v_a_79:
v_smfmac_f32_16x16x64_bf16 v[64:67], v[60:63], a[24:31], v6
s_waitcnt vmcnt(1)
v_max3_u32 v7, v48, v49, v50
v_max_u32 v7, v7, v51
v_smfmac_f32_16x16x64_bf16 v[68:71], v[60:63], a[88:95], v6
v_cmp_eq_u32 vcc, s34, v7
v_smfmac_f32_16x16x64_bf16 v[72:75], v[60:63], a[56:63], v6
v_smfmac_f32_16x16x64_bf16 v[76:79], v[60:63], a[120:127], v6
s_cbranch_vccnz L_q_a_80
L_v_a_81:
v_smfmac_f32_16x16x64_bf16 v[64:67], v[48:51], a[0:7], v6
s_waitcnt vmcnt(0)
v_max3_u32 v7, v56, v57, v58
v_max_u32 v7, v7, v59
v_smfmac_f32_16x16x64_bf16 v[68:71], v[48:51], a[64:71], v6
v_cmp_eq_u32 vcc, s34, v7
v_smfmac_f32_16x16x64_bf16 v[72:75], v[48:51], a[32:39], v6
v_smfmac_f32_16x16x64_bf16 v[76:79], v[48:51], a[96:103], v6
s_cbranch_vccnz L_q_a_36
s_branch L_v_a_37
L_q_a_80:
buffer_load_dwordx4 v[48:51], v2, s[8:11], s38 offen sc1
s_waitcnt vmcnt(2)
v_max3_u32 v7, v56, v57, v58
v_max_u32 v7, v7, v59
v_cmp_eq_u32 vcc, s34, v7
s_cbranch_vccz L_ok_a_82
buffer_load_dwordx4 v[56:59], v4, s[8:11], s38 offen sc1
s_waitcnt vmcnt(2)
v_max3_u32 v7, v48, v49, v50
v_max_u32 v7, v7, v51
v_cmp_eq_u32 vcc, s34, v7
s_cbranch_vccz L_ok_a_83
s_add_u32 s33, s33, 1
s_cmp_gt_u32 s33, 0x100000
s_cbranch_scc0 L_q_a_80
s_branch chain_kernel_abort
L_ok_a_82:
v_smfmac_f32_16x16x64_bf16 v[64:67], v[56:59], a[16:23], v6
v_smfmac_f32_16x16x64_bf16 v[68:71], v[56:59], a[80:87], v6
v_smfmac_f32_16x16x64_bf16 v[72:75], v[56:59], a[48:55], v6
v_smfmac_f32_16x16x64_bf16 v[76:79], v[56:59], a[112:119], v6
s_branch L_q_a_71
L_ok_a_83:
v_smfmac_f32_16x16x64_bf16 v[64:67], v[48:51], a[0:7], v6
v_smfmac_f32_16x16x64_bf16 v[68:71], v[48:51], a[64:71], v6
v_smfmac_f32_16x16x64_bf16 v[72:75], v[48:51], a[32:39], v6
v_smfmac_f32_16x16x64_bf16 v[76:79], v[48:51], a[96:103], v6
s_branch L_q_a_36
L_q_a_78:
buffer_load_dwordx4 v[60:63], v5, s[8:11], s38 offen sc1
s_waitcnt vmcnt(2)
v_max3_u32 v7, v48, v49, v50
v_max_u32 v7, v7, v51
v_cmp_eq_u32 vcc, s34, v7
s_cbranch_vccnz L_q_a_84
L_v_a_85:
v_smfmac_f32_16x16x64_bf16 v[64:67], v[48:51], a[0:7], v6
s_waitcnt vmcnt(1)
v_max3_u32 v7, v56, v57, v58
v_max_u32 v7, v7, v59
v_smfmac_f32_16x16x64_bf16 v[68:71], v[48:51], a[64:71], v6
v_cmp_eq_u32 vcc, s34, v7
v_smfmac_f32_16x16x64_bf16 v[72:75], v[48:51], a[32:39], v6
v_smfmac_f32_16x16x64_bf16 v[76:79], v[48:51], a[96:103], v6
s_cbranch_vccnz L_q_a_39
s_branch L_v_a_40
L_q_a_84:
buffer_load_dwordx4 v[48:51], v2, s[8:11], s38 offen sc1
s_waitcnt vmcnt(2)
v_max3_u32 v7, v56, v57, v58
v_max_u32 v7, v7, v59
v_cmp_eq_u32 vcc, s34, v7
s_cbranch_vccz L_ok_a_86
buffer_load_dwordx4 v[56:59], v4, s[8:11], s38 offen sc1
s_waitcnt vmcnt(2)
v_max3_u32 v7, v60, v61, v62
v_max_u32 v7, v7, v63
v_cmp_eq_u32 vcc, s34, v7
s_cbranch_vccz L_ok_a_87
buffer_load_dwordx4 v[60:63], v5, s[8:11], s38 offen sc1
s_waitcnt vmcnt(2)
v_max3_u32 v7, v48, v49, v50
v_max_u32 v7, v7, v51
v_cmp_eq_u32 vcc, s34, v7
s_cbranch_vccz L_ok_a_88
s_add_u32 s33, s33, 1
s_cmp_gt_u32 s33, 0x100000
s_cbranch_scc0 L_q_a_84
s_branch chain_kernel_abort
L_ok_a_86:
v_smfmac_f32_16x16x64_bf16 v[64:67], v[56:59], a[16:23], v6
v_smfmac_f32_16x16x64_bf16 v[68:71], v[56:59], a[80:87], v6
v_smfmac_f32_16x16x64_bf16 v[72:75], v[56:59], a[48:55], v6
v_smfmac_f32_16x16x64_bf16 v[76:79], v[56:59], a[112:119], v6
s_branch L_q_a_74
L_ok_a_87:
v_smfmac_f32_16x16x64_bf16 v[64:67], v[60:63], a[24:31], v6
v_smfmac_f32_16x16x64_bf16 v[68:71], v[60:63], a[88:95], v6
v_smfmac_f32_16x16x64_bf16 v[72:75], v[60:63], a[56:63], v6
v_smfmac_f32_16x16x64_bf16 v[76:79], v[60:63], a[120:127], v6
s_branch L_q_a_80
L_ok_a_88:
v_smfmac_f32_16x16x64_bf16 v[64:67], v[48:51], a[0:7], v6
v_smfmac_f32_16x16x64_bf16 v[68:71], v[48:51], a[64:71], v6
v_smfmac_f32_16x16x64_bf16 v[72:75], v[48:51], a[32:39], v6
v_smfmac_f32_16x16x64_bf16 v[76:79], v[48:51], a[96:103], v6
s_branch L_q_a_39
L_q_a_65:
buffer_load_dwordx4 v[52:55], v3, s[8:11], s38 offen sc1
s_waitcnt vmcnt(3)
v_max3_u32 v7, v56, v57, v58
v_max_u32 v7, v7, v59
v_cmp_eq_u32 vcc, s34, v7
s_cbranch_vccnz L_q_a_89
L_v_a_90:
v_smfmac_f32_16x16x64_bf16 v[64:67], v[56:59], a[16:23], v6
s_waitcnt vmcnt(2)
v_max3_u32 v7, v60, v61, v62
v_max_u32 v7, v7, v63
v_smfmac_f32_16x16x64_bf16 v[68:71], v[56:59], a[80:87], v6
v_cmp_eq_u32 vcc, s34, v7
v_smfmac_f32_16x16x64_bf16 v[72:75], v[56:59], a[48:55], v6
v_smfmac_f32_16x16x64_bf16 v[76:79], v[56:59], a[112:119], v6
s_cbranch_vccnz L_q_a_91
L_v_a_92:
v_smfmac_f32_16x16x64_bf16 v[64:67], v[60:63], a[24:31], v6
s_waitcnt vmcnt(1)
v_max3_u32 v7, v48, v49, v50
v_max_u32 v7, v7, v51
v_smfmac_f32_16x16x64_bf16 v[68:71], v[60:63], a[88:95], v6
v_cmp_eq_u32 vcc, s34, v7
v_smfmac_f32_16x16x64_bf16 v[72:75], v[60:63], a[56:63], v6
v_smfmac_f32_16x16x64_bf16 v[76:79], v[60:63], a[120:127], v6
s_cbranch_vccnz L_q_a_93
L_v_a_94:
v_smfmac_f32_16x16x64_bf16 v[64:67], v[48:51], a[0:7], v6
s_waitcnt vmcnt(0)
v_max3_u32 v7, v52, v53, v54
v_max_u32 v7, v7, v55
v_smfmac_f32_16x16x64_bf16 v[68:71], v[48:51], a[64:71], v6
v_cmp_eq_u32 vcc, s34, v7
v_smfmac_f32_16x16x64_bf16 v[72:75], v[48:51], a[32:39], v6
v_smfmac_f32_16x16x64_bf16 v[76:79], v[48:51], a[96:103], v6
s_cbranch_vccnz L_q_a_47
s_branch L_v_a_48
L_q_a_93:
buffer_load_dwordx4 v[48:51], v2, s[8:11], s38 offen sc1
s_waitcnt vmcnt(2)
v_max3_u32 v7, v52, v53, v54
v_max_u32 v7, v7, v55
v_cmp_eq_u32 vcc, s34, v7
s_cbranch_vccz L_ok_a_95
buffer_load_dwordx4 v[52:55], v3, s[8:11], s38 offen sc1
s_waitcnt vmcnt(2)
v_max3_u32 v7, v48, v49, v50
v_max_u32 v7, v7, v51
v_cmp_eq_u32 vcc, s34, v7
s_cbranch_vccz L_ok_a_96
s_add_u32 s33, s33, 1
s_cmp_gt_u32 s33, 0x100000
s_cbranch_scc0 L_q_a_93
s_branch chain_kernel_abort
L_ok_a_95:
v_smfmac_f32_16x16x64_bf16 v[64:67], v[52:55], a[8:15], v6
v_smfmac_f32_16x16x64_bf16 v[68:71], v[52:55], a[72:79], v6
v_smfmac_f32_16x16x64_bf16 v[72:75], v[52:55], a[40:47], v6
v_smfmac_f32_16x16x64_bf16 v[76:79], v[52:55], a[104:111], v6
s_branch L_q_a_71
L_ok_a_96:
v_smfmac_f32_16x16x64_bf16 v[64:67], v[48:51], a[0:7], v6
v_smfmac_f32_16x16x64_bf16 v[68:71], v[48:51], a[64:71], v6
v_smfmac_f32_16x16x64_bf16 v[72:75], v[48:51], a[32:39], v6
v_smfmac_f32_16x16x64_bf16 v[76:79], v[48:51], a[96:103], v6
s_branch L_q_a_47
L_q_a_91:
buffer_load_dwordx4 v[60:63], v5, s[8:11], s38 offen sc1
s_waitcnt vmcnt(2)
v_max3_u32 v7, v48, v49, v50
v_max_u32 v7, v7, v51
v_cmp_eq_u32 vcc, s34, v7
s_cbranch_vccnz L_q_a_97
L_v_a_98:
v_smfmac_f32_16x16x64_bf16 v[64:67], v[48:51], a[0:7], v6
s_waitcnt vmcnt(1)
v_max3_u32 v7, v52, v53, v54
v_max_u32 v7, v7, v55
v_smfmac_f32_16x16x64_bf16 v[68:71], v[48:51], a[64:71], v6
v_cmp_eq_u32 vcc, s34, v7
v_smfmac_f32_16x16x64_bf16 v[72:75], v[48:51], a[32:39], v6
v_smfmac_f32_16x16x64_bf16 v[76:79], v[48:51], a[96:103], v6
s_cbranch_vccnz L_q_a_50
s_branch L_v_a_51
L_q_a_97:
buffer_load_dwordx4 v[48:51], v2, s[8:11], s38 offen sc1
s_waitcnt vmcnt(2)
v_max3_u32 v7, v52, v53, v54
v_max_u32 v7, v7, v55
v_cmp_eq_u32 vcc, s34, v7
s_cbranch_vccz L_ok_a_99
buffer_load_dwordx4 v[52:55], v3, s[8:11], s38 offen sc1
s_waitcnt vmcnt(2)
v_max3_u32 v7, v60, v61, v62
v_max_u32 v7, v7, v63
v_cmp_eq_u32 vcc, s34, v7
s_cbranch_vccz L_ok_a_100
buffer_load_dwordx4 v[60:63], v5, s[8:11], s38 offen sc1
s_waitcnt vmcnt(2)
v_max3_u32 v7, v48, v49, v50
v_max_u32 v7, v7, v51
v_cmp_eq_u32 vcc, s34, v7
s_cbranch_vccz L_ok_a_101
s_add_u32 s33, s33, 1
s_cmp_gt_u32 s33, 0x100000
s_cbranch_scc0 L_q_a_97
s_branch chain_kernel_abort
L_ok_a_99:
v_smfmac_f32_16x16x64_bf16 v[64:67], v[52:55], a[8:15], v6
v_smfmac_f32_16x16x64_bf16 v[68:71], v[52:55], a[72:79], v6
v_smfmac_f32_16x16x64_bf16 v[72:75], v[52:55], a[40:47], v6
v_smfmac_f32_16x16x64_bf16 v[76:79], v[52:55], a[104:111], v6
s_branch L_q_a_74
L_ok_a_100:
v_smfmac_f32_16x16x64_bf16 v[64:67], v[60:63], a[24:31], v6
v_smfmac_f32_16x16x64_bf16 v[68:71], v[60:63], a[88:95], v6
v_smfmac_f32_16x16x64_bf16 v[72:75], v[60:63], a[56:63], v6
v_smfmac_f32_16x16x64_bf16 v[76:79], v[60:63], a[120:127], v6
s_branch L_q_a_93
L_ok_a_101:
v_smfmac_f32_16x16x64_bf16 v[64:67], v[48:51], a[0:7], v6
v_smfmac_f32_16x16x64_bf16 v[68:71], v[48:51], a[64:71], v6
v_smfmac_f32_16x16x64_bf16 v[72:75], v[48:51], a[32:39], v6
v_smfmac_f32_16x16x64_bf16 v[76:79], v[48:51], a[96:103], v6
s_branch L_q_a_50
L_q_a_89:
buffer_load_dwordx4 v[56:59], v4, s[8:11], s38 offen sc1
s_waitcnt vmcnt(3)
v_max3_u32 v7, v60, v61, v62
v_max_u32 v7, v7, v63
v_cmp_eq_u32 vcc, s34, v7
s_cbranch_vccnz L_q_a_102
L_v_a_103:
v_smfmac_f32_16x16x64_bf16 v[64:67], v[60:63], a[24:31], v6
s_waitcnt vmcnt(2)
v_max3_u32 v7, v48, v49, v50
v_max_u32 v7, v7, v51
v_smfmac_f32_16x16x64_bf16 v[68:71], v[60:63], a[88:95], v6
v_cmp_eq_u32 vcc, s34, v7
v_smfmac_f32_16x16x64_bf16 v[72:75], v[60:63], a[56:63], v6
v_smfmac_f32_16x16x64_bf16 v[76:79], v[60:63], a[120:127], v6
s_cbranch_vccnz L_q_a_104
L_v_a_105:
v_smfmac_f32_16x16x64_bf16 v[64:67], v[48:51], a[0:7], v6
s_waitcnt vmcnt(1)
v_max3_u32 v7, v52, v53, v54
v_max_u32 v7, v7, v55
v_smfmac_f32_16x16x64_bf16 v[68:71], v[48:51], a[64:71], v6
v_cmp_eq_u32 vcc, s34, v7
v_smfmac_f32_16x16x64_bf16 v[72:75], v[48:51], a[32:39], v6
v_smfmac_f32_16x16x64_bf16 v[76:79], v[48:51], a[96:103], v6
s_cbranch_vccnz L_q_a_56
s_branch L_v_a_57
L_q_a_104:
buffer_load_dwordx4 v[48:51], v2, s[8:11], s38 offen sc1
s_waitcnt vmcnt(2)
v_max3_u32 v7, v52, v53, v54
v_max_u32 v7, v7, v55
v_cmp_eq_u32 vcc, s34, v7
s_cbranch_vccz L_ok_a_106
buffer_load_dwordx4 v[52:55], v3, s[8:11], s38 offen sc1
s_waitcnt vmcnt(2)
v_max3_u32 v7, v56, v57, v58
v_max_u32 v7, v7, v59
v_cmp_eq_u32 vcc, s34, v7
s_cbranch_vccz L_ok_a_107
buffer_load_dwordx4 v[56:59], v4, s[8:11], s38 offen sc1
s_waitcnt vmcnt(2)
v_max3_u32 v7, v48, v49, v50
v_max_u32 v7, v7, v51
v_cmp_eq_u32 vcc, s34, v7
s_cbranch_vccz L_ok_a_108
s_add_u32 s33, s33, 1
s_cmp_gt_u32 s33, 0x100000
s_cbranch_scc0 L_q_a_104
s_branch chain_kernel_abort
L_ok_a_106:
v_smfmac_f32_16x16x64_bf16 v[64:67], v[52:55], a[8:15], v6
v_smfmac_f32_16x16x64_bf16 v[68:71], v[52:55], a[72:79], v6
v_smfmac_f32_16x16x64_bf16 v[72:75], v[52:55], a[40:47], v6
v_smfmac_f32_16x16x64_bf16 v[76:79], v[52:55], a[104:111], v6
s_branch L_q_a_80
L_ok_a_107:
v_smfmac_f32_16x16x64_bf16 v[64:67], v[56:59], a[16:23], v6
v_smfmac_f32_16x16x64_bf16 v[68:71], v[56:59], a[80:87], v6
v_smfmac_f32_16x16x64_bf16 v[72:75], v[56:59], a[48:55], v6
v_smfmac_f32_16x16x64_bf16 v[76:79], v[56:59], a[112:119], v6
s_branch L_q_a_93
L_ok_a_108:
v_smfmac_f32_16x16x64_bf16 v[64:67], v[48:51], a[0:7], v6
v_smfmac_f32_16x16x64_bf16 v[68:71], v[48:51], a[64:71], v6
v_smfmac_f32_16x16x64_bf16 v[72:75], v[48:51], a[32:39], v6
v_smfmac_f32_16x16x64_bf16 v[76:79], v[48:51], a[96:103], v6
s_branch L_q_a_56
L_q_a_102:
buffer_load_dwordx4 v[60:63], v5, s[8:11], s38 offen sc1
s_waitcnt vmcnt(3)
v_max3_u32 v7, v48, v49, v50
v_max_u32 v7, v7, v51
v_cmp_eq_u32 vcc, s34, v7
s_cbranch_vccnz L_q_a_109
L_v_a_110:
v_smfmac_f32_16x16x64_bf16 v[64:67], v[48:51], a[0:7], v6
s_waitcnt vmcnt(2)
v_max3_u32 v7, v52, v53, v54
v_max_u32 v7, v7, v55
v_smfmac_f32_16x16x64_bf16 v[68:71], v[48:51], a[64:71], v6
v_cmp_eq_u32 vcc, s34, v7
v_smfmac_f32_16x16x64_bf16 v[72:75], v[48:51], a[32:39], v6
v_smfmac_f32_16x16x64_bf16 v[76:79], v[48:51], a[96:103], v6
s_cbranch_vccnz L_q_a_60
s_branch L_v_a_61
L_q_a_109:
buffer_load_dwordx4 v[48:51], v2, s[8:11], s38 offen sc1
s_waitcnt vmcnt(2)
v_max3_u32 v7, v52, v53, v54
v_max_u32 v7, v7, v55
v_cmp_eq_u32 vcc, s34, v7
s_cbranch_vccz L_ok_a_111
buffer_load_dwordx4 v[52:55], v3, s[8:11], s38 offen sc1
s_waitcnt vmcnt(2)
v_max3_u32 v7, v56, v57, v58
v_max_u32 v7, v7, v59
v_cmp_eq_u32 vcc, s34, v7
s_cbranch_vccz L_ok_a_112
buffer_load_dwordx4 v[56:59], v4, s[8:11], s38 offen sc1
s_waitcnt vmcnt(2)
v_max3_u32 v7, v60, v61, v62
v_max_u32 v7, v7, v63
v_cmp_eq_u32 vcc, s34, v7
s_cbranch_vccz L_ok_a_113
buffer_load_dwordx4 v[60:63], v5, s[8:11], s38 offen sc1
s_waitcnt vmcnt(2)
v_max3_u32 v7, v48, v49, v50
v_max_u32 v7, v7, v51
v_cmp_eq_u32 vcc, s34, v7
s_cbranch_vccz L_ok_a_114
s_add_u32 s33, s33, 1
s_cmp_gt_u32 s33, 0x100000
s_cbranch_scc0 L_q_a_109
s_branch chain_kernel_abort
L_ok_a_111:
v_smfmac_f32_16x16x64_bf16 v[64:67], v[52:55], a[8:15], v6
v_smfmac_f32_16x16x64_bf16 v[68:71], v[52:55], a[72:79], v6
v_smfmac_f32_16x16x64_bf16 v[72:75], v[52:55], a[40:47], v6
v_smfmac_f32_16x16x64_bf16 v[76:79], v[52:55], a[104:111], v6
s_branch L_q_a_84
L_ok_a_112:
v_smfmac_f32_16x16x64_bf16 v[64:67], v[56:59], a[16:23], v6
v_smfmac_f32_16x16x64_bf16 v[68:71], v[56:59], a[80:87], v6
v_smfmac_f32_16x16x64_bf16 v[72:75], v[56:59], a[48:55], v6
v_smfmac_f32_16x16x64_bf16 v[76:79], v[56:59], a[112:119], v6
s_branch L_q_a_97
L_ok_a_113:
v_smfmac_f32_16x16x64_bf16 v[64:67], v[60:63], a[24:31], v6
v_smfmac_f32_16x16x64_bf16 v[68:71], v[60:63], a[88:95], v6
v_smfmac_f32_16x16x64_bf16 v[72:75], v[60:63], a[56:63], v6
v_smfmac_f32_16x16x64_bf16 v[76:79], v[60:63], a[120:127], v6
s_branch L_q_a_104
L_ok_a_114:
v_smfmac_f32_16x16x64_bf16 v[64:67], v[48:51], a[0:7], v6
v_smfmac_f32_16x16x64_bf16 v[68:71], v[48:51], a[64:71], v6
v_smfmac_f32_16x16x64_bf16 v[72:75], v[48:51], a[32:39], v6
v_smfmac_f32_16x16x64_bf16 v[76:79], v[48:51], a[96:103], v6
s_branch L_q_a_60
L_cf_122:
L_rt_123:
buffer_load_dwordx4 v[200:203], v16, s[8:11], s40 offen sc1
buffer_load_dwordx4 v[204:207], v13, s[8:11], s40 offen sc1
buffer_load_dwordx4 v[208:211], v14, s[8:11], s40 offen sc1
buffer_load_dwordx4 v[212:215], v15, s[8:11], s40 offen sc1
s_waitcnt vmcnt(7)
v_permlane32_swap_b32 v216, v218
v_permlane32_swap_b32 v217, v219
s_waitcnt vmcnt(6)
v_pk_add_f32 v[154:155], v[216:217], v[218:219]
v_pk_add_f32 v[148:149], v[124:125], v[220:221]
v_pk_add_f32 v[150:151], v[126:127], v[222:223]
v_permlane16_swap_b32 v154, v155
s_waitcnt vmcnt(5)
v_pk_add_f32 v[148:149], v[148:149], v[224:225]
v_pk_add_f32 v[150:151], v[150:151], v[226:227]
v_add_f32 v152, v154, v155
s_waitcnt vmcnt(4)
v_pk_add_f32 v[148:149], v[148:149], v[228:229]
v_pk_add_f32 v[150:151], v[150:151], v[230:231]
v_pk_add_f32 v[154:155], v[148:149], v[150:151]
v_add_f32 v154, v154, v152
v_cmp_u_f32 vcc, v154, v155
s_cbranch_vccz L_cok_121
buffer_load_dwordx4 v[216:219], v16, s[8:11], s40 offen sc1
buffer_load_dwordx4 v[220:223], v13, s[8:11], s40 offen sc1
buffer_load_dwordx4 v[224:227], v14, s[8:11], s40 offen sc1
buffer_load_dwordx4 v[228:231], v15, s[8:11], s40 offen sc1
s_waitcnt vmcnt(7)
v_permlane32_swap_b32 v200, v202
v_permlane32_swap_b32 v201, v203
s_waitcnt vmcnt(6)
v_pk_add_f32 v[154:155], v[200:201], v[202:203]
v_pk_add_f32 v[148:149], v[124:125], v[204:205]
v_pk_add_f32 v[150:151], v[126:127], v[206:207]
v_permlane16_swap_b32 v154, v155
s_waitcnt vmcnt(5)
v_pk_add_f32 v[148:149], v[148:149], v[208:209]
v_pk_add_f32 v[150:151], v[150:151], v[210:211]
v_add_f32 v152, v154, v155
s_waitcnt vmcnt(4)
v_pk_add_f32 v[148:149], v[148:149], v[212:213]
v_pk_add_f32 v[150:151], v[150:151], v[214:215]
v_pk_add_f32 v[154:155], v[148:149], v[150:151]
v_add_f32 v154, v154, v152
v_cmp_u_f32 vcc, v154, v155
s_cbranch_vccz L_cok_121
s_add_u32 s33, s33, 1
s_cmp_gt_u32 s33, 0x100000
s_cbranch_scc1 chain_kernel_abort
s_and_b32 s20, s33, 63
s_cbranch_scc1 L_rt_123
v_cmp_eq_u32 vcc, s34, v200
v_cmp_eq_u32 s[20:21], s34, v201
s_or_b64 vcc, vcc, s[20:21]
v_cmp_eq_u32 s[20:21], s34, v202
s_or_b64 vcc, vcc, s[20:21]
v_cmp_eq_u32 s[20:21], s34, v203
s_or_b64 vcc, vcc, s[20:21]
v_cmp_eq_u32 s[20:21], s34, v204
s_or_b64 vcc, vcc, s[20:21]
v_cmp_eq_u32 s[20:21], s34, v205
s_or_b64 vcc, vcc, s[20:21]
v_cmp_eq_u32 s[20:21], s34, v206
s_or_b64 vcc, vcc, s[20:21]
v_cmp_eq_u32 s[20:21], s34, v207
s_or_b64 vcc, vcc, s[20:21]
v_cmp_eq_u32 s[20:21], s34, v208
s_or_b64 vcc, vcc, s[20:21]
v_cmp_eq_u32 s[20:21], s34, v209
s_or_b64 vcc, vcc, s[20:21]
v_cmp_eq_u32 s[20:21], s34, v210
s_or_b64 vcc, vcc, s[20:21]
v_cmp_eq_u32 s[20:21], s34, v211
s_or_b64 vcc, vcc, s[20:21]
v_cmp_eq_u32 s[20:21], s34, v212
s_or_b64 vcc, vcc, s[20:21]
v_cmp_eq_u32 s[20:21], s34, v213
s_or_b64 vcc, vcc, s[20:21]
v_cmp_eq_u32 s[20:21], s34, v214
s_or_b64 vcc, vcc, s[20:21]
v_cmp_eq_u32 s[20:21], s34, v215
s_or_b64 vcc, vcc, s[20:21]
s_cbranch_vccnz L_rt_123
s_branch L_cok_121
L_cok_121:
v_max3_f32 v154, v148, v149, v150
v_max3_f32 v154, v154, v151, v152
s_nop 1
v_max_f32_dpp v154, v154, v154 row_ror:8 row_mask:0xf bank_mask:0xf
s_branch L_chead_124
L_q_e_132:
buffer_load_dwordx4 v[60:63], v5, s[8:11], s41 offen sc1
s_waitcnt vmcnt(0)
v_max3_u32 v7, v60, v61, v62
v_max_u32 v7, v7, v63
v_cmp_eq_u32 vcc, s34, v7
s_cbranch_vccnz L_q_e_134
s_branch L_v_e_133
L_q_e_134:
buffer_load_dwordx4 v[60:63], v5, s[8:11], s41 offen sc1
s_waitcnt vmcnt(2)
v_max3_u32 v7, v60, v61, v62
v_max_u32 v7, v7, v63
v_cmp_eq_u32 vcc, s34, v7
s_cbranch_vccz L_ok_e_135
s_add_u32 s33, s33, 1
s_cmp_gt_u32 s33, 0x100000
s_cbranch_scc0 L_q_e_134
s_branch chain_kernel_abort
L_ok_e_135:
v_smfmac_f32_16x16x64_bf16 v[88:91], v[60:63], a[216:223], v6
v_smfmac_f32_16x16x64_bf16 v[92:95], v[60:63], a[248:255], v6
s_branch L_gd_e_125
L_q_e_130:
buffer_load_dwordx4 v[56:59], v4, s[8:11], s41 offen sc1
s_waitcnt vmcnt(1)
v_max3_u32 v7, v60, v61, v62
v_max_u32 v7, v7, v63
v_cmp_eq_u32 vcc, s34, v7
s_cbranch_vccnz L_q_e_136
L_v_e_137:
v_smfmac_f32_16x16x64_bf16 v[88:91], v[60:63], a[216:223], v6
s_waitcnt vmcnt(0)
v_max3_u32 v7, v56, v57, v58
v_max_u32 v7, v7, v59
v_cmp_eq_u32 vcc, s34, v7
v_smfmac_f32_16x16x64_bf16 v[92:95], v[60:63], a[248:255], v6
s_cbranch_vccnz L_q_e_138
L_v_e_139:
v_smfmac_f32_16x16x64_bf16 v[88:91], v[56:59], a[208:215], v6
v_smfmac_f32_16x16x64_bf16 v[92:95], v[56:59], a[240:247], v6
s_branch L_gd_e_125
L_q_e_138:
buffer_load_dwordx4 v[56:59], v4, s[8:11], s41 offen sc1
s_waitcnt vmcnt(2)
v_max3_u32 v7, v56, v57, v58
v_max_u32 v7, v7, v59
v_cmp_eq_u32 vcc, s34, v7
s_cbranch_vccz L_ok_e_140
s_add_u32 s33, s33, 1
s_cmp_gt_u32 s33, 0x100000
s_cbranch_scc0 L_q_e_138
s_branch chain_kernel_abort
L_ok_e_140:
v_smfmac_f32_16x16x64_bf16 v[88:91], v[56:59], a[208:215], v6
v_smfmac_f32_16x16x64_bf16 v[92:95], v[56:59], a[240:247], v6
s_branch L_gd_e_125
L_q_e_136:
buffer_load_dwordx4 v[60:63], v5, s[8:11], s41 offen sc1
s_waitcnt vmcnt(1)
v_max3_u32 v7, v56, v57, v58
v_max_u32 v7, v7, v59
v_cmp_eq_u32 vcc, s34, v7
s_cbranch_vccnz L_q_e_141
L_v_e_142:
v_smfmac_f32_16x16x64_bf16 v[88:91], v[56:59], a[208:215], v6
s_waitcnt vmcnt(0)
v_max3_u32 v7, v60, v61, v62
v_max_u32 v7, v7, v63
v_cmp_eq_u32 vcc, s34, v7
v_smfmac_f32_16x16x64_bf16 v[92:95], v[56:59], a[240:247], v6
s_cbranch_vccnz L_q_e_134
s_branch L_v_e_133
L_q_e_141:
buffer_load_dwordx4 v[56:59], v4, s[8:11], s41 offen sc1
s_waitcnt vmcnt(2)
v_max3_u32 v7, v60, v61, v62
v_max_u32 v7, v7, v63
v_cmp_eq_u32 vcc, s34, v7
s_cbranch_vccz L_ok_e_143
buffer_load_dwordx4 v[60:63], v5, s[8:11], s41 offen sc1
s_waitcnt vmcnt(2)
v_max3_u32 v7, v56, v57, v58
v_max_u32 v7, v7, v59
v_cmp_eq_u32 vcc, s34, v7
s_cbranch_vccz L_ok_e_144
s_add_u32 s33, s33, 1
s_cmp_gt_u32 s33, 0x100000
s_cbranch_scc0 L_q_e_141
s_branch chain_kernel_abort
L_ok_e_143:
v_smfmac_f32_16x16x64_bf16 v[88:91], v[60:63], a[216:223], v6
v_smfmac_f32_16x16x64_bf16 v[92:95], v[60:63], a[248:255], v6
s_branch L_q_e_138
L_ok_e_144:
v_smfmac_f32_16x16x64_bf16 v[88:91], v[56:59], a[208:215], v6
v_smfmac_f32_16x16x64_bf16 v[92:95], v[56:59], a[240:247], v6
s_branch L_q_e_134
L_q_e_128:
buffer_load_dwordx4 v[52:55], v3, s[8:11], s41 offen sc1
s_waitcnt vmcnt(2)
v_max3_u32 v7, v56, v57, v58
v_max_u32 v7, v7, v59
v_cmp_eq_u32 vcc, s34, v7
s_cbranch_vccnz L_q_e_145
L_v_e_146:
v_smfmac_f32_16x16x64_bf16 v[88:91], v[56:59], a[208:215], v6
s_waitcnt vmcnt(1)
v_max3_u32 v7, v60, v61, v62
v_max_u32 v7, v7, v63
v_cmp_eq_u32 vcc, s34, v7
v_smfmac_f32_16x16x64_bf16 v[92:95], v[56:59], a[240:247], v6
s_cbranch_vccnz L_q_e_147
L_v_e_148:
v_smfmac_f32_16x16x64_bf16 v[88:91], v[60:63], a[216:223], v6
s_waitcnt vmcnt(0)
v_max3_u32 v7, v52, v53, v54
v_max_u32 v7, v7, v55
v_cmp_eq_u32 vcc, s34, v7
v_smfmac_f32_16x16x64_bf16 v[92:95], v[60:63], a[248:255], v6
s_cbranch_vccnz L_q_e_149
L_v_e_150:
v_smfmac_f32_16x16x64_bf16 v[88:91], v[52:55], a[200:207], v6
v_smfmac_f32_16x16x64_bf16 v[92:95], v[52:55], a[232:239], v6
s_branch L_gd_e_125
L_q_e_149:
buffer_load_dwordx4 v[52:55], v3, s[8:11], s41 offen sc1
s_waitcnt vmcnt(2)
v_max3_u32 v7, v52, v53, v54
v_max_u32 v7, v7, v55
v_cmp_eq_u32 vcc, s34, v7
s_cbranch_vccz L_ok_e_151
s_add_u32 s33, s33, 1
s_cmp_gt_u32 s33, 0x100000
s_cbranch_scc0 L_q_e_149
s_branch chain_kernel_abort
L_ok_e_151:
v_smfmac_f32_16x16x64_bf16 v[88:91], v[52:55], a[200:207], v6
v_smfmac_f32_16x16x64_bf16 v[92:95], v[52:55], a[232:239], v6
s_branch L_gd_e_125
L_q_e_147:
buffer_load_dwordx4 v[60:63], v5, s[8:11], s41 offen sc1
s_waitcnt vmcnt(1)
v_max3_u32 v7, v52, v53, v54
v_max_u32 v7, v7, v55
v_cmp_eq_u32 vcc, s34, v7
s_cbranch_vccnz L_q_e_152
L_v_e_153:
v_smfmac_f32_16x16x64_bf16 v[88:91], v[52:55], a[200:207], v6
s_waitcnt vmcnt(0)
v_max3_u32 v7, v60, v61, v62
v_max_u32 v7, v7, v63
v_cmp_eq_u32 vcc, s34, v7
v_smfmac_f32_16x16x64_bf16 v[92:95], v[52:55], a[232:239], v6
s_cbranch_vccnz L_q_e_134
s_branch L_v_e_133
L_q_e_152:
buffer_load_dwordx4 v[52:55], v3, s[8:11], s41 offen sc1
s_waitcnt vmcnt(2)
v_max3_u32 v7, v60, v61, v62
v_max_u32 v7, v7, v63
v_cmp_eq_u32 vcc, s34, v7
s_cbranch_vccz L_ok_e_154
buffer_load_dwordx4 v[60:63], v5, s[8:11], s41 offen sc1
s_waitcnt vmcnt(2)
v_max3_u32 v7, v52, v53, v54
v_max_u32 v7, v7, v55
v_cmp_eq_u32 vcc, s34, v7
s_cbranch_vccz L_ok_e_155
s_add_u32 s33, s33, 1
s_cmp_gt_u32 s33, 0x100000
s_cbranch_scc0 L_q_e_152
s_branch chain_kernel_abort
L_ok_e_154:
v_smfmac_f32_16x16x64_bf16 v[88:91], v[60:63], a[216:223], v6
v_smfmac_f32_16x16x64_bf16 v[92:95], v[60:63], a[248:255], v6
s_branch L_q_e_149
L_ok_e_155:
v_smfmac_f32_16x16x64_bf16 v[88:91], v[52:55], a[200:207], v6
v_smfmac_f32_16x16x64_bf16 v[92:95], v[52:55], a[232:239], v6
s_branch L_q_e_134
L_q_e_145:
buffer_load_dwordx4 v[56:59], v4, s[8:11], s41 offen sc1
s_waitcnt vmcnt(2)
v_max3_u32 v7, v60, v61, v62
v_max_u32 v7, v7, v63
v_cmp_eq_u32 vcc, s34, v7
s_cbranch_vccnz L_q_e_156
L_v_e_157:
v_smfmac_f32_16x16x64_bf16 v[88:91], v[60:63], a[216:223], v6
s_waitcnt vmcnt(1)
v_max3_u32 v7, v52, v53, v54
v_max_u32 v7, v7, v55
v_cmp_eq_u32 vcc, s34, v7
v_smfmac_f32_16x16x64_bf16 v[92:95], v[60:63], a[248:255], v6
s_cbranch_vccnz L_q_e_158
L_v_e_159:
v_smfmac_f32_16x16x64_bf16 v[88:91], v[52:55], a[200:207], v6
s_waitcnt vmcnt(0)
v_max3_u32 v7, v56, v57, v58
v_max_u32 v7, v7, v59
v_cmp_eq_u32 vcc, s34, v7
v_smfmac_f32_16x16x64_bf16 v[92:95], v[52:55], a[232:239], v6
s_cbranch_vccnz L_q_e_138
s_branch L_v_e_139
L_q_e_158:
buffer_load_dwordx4 v[52:55], v3, s[8:11], s41 offen sc1
s_waitcnt vmcnt(2)
v_max3_u32 v7, v56, v57, v58
v_max_u32 v7, v7, v59
v_cmp_eq_u32 vcc, s34, v7
s_cbranch_vccz L_ok_e_160
buffer_load_dwordx4 v[56:59], v4, s[8:11], s41 offen sc1
s_waitcnt vmcnt(2)
v_max3_u32 v7, v52, v53, v54
v_max_u32 v7, v7, v55
v_cmp_eq_u32 vcc, s34, v7
s_cbranch_vccz L_ok_e_161
s_add_u32 s33, s33, 1
s_cmp_gt_u32 s33, 0x100000
s_cbranch_scc0 L_q_e_158
s_branch chain_kernel_abort
L_ok_e_160:
v_smfmac_f32_16x16x64_bf16 v[88:91], v[56:59], a[208:215], v6
v_smfmac_f32_16x16x64_bf16 v[92:95], v[56:59], a[240:247], v6
s_branch L_q_e_149
L_ok_e_161:
v_smfmac_f32_16x16x64_bf16 v[88:91], v[52:55], a[200:207], v6
v_smfmac_f32_16x16x64_bf16 v[92:95], v[52:55], a[232:239], v6
s_branch L_q_e_138
L_q_e_156:
buffer_load_dwordx4 v[60:63], v5, s[8:11], s41 offen sc1
s_waitcnt vmcnt(2)
v_max3_u32 v7, v52, v53, v54
v_max_u32 v7, v7, v55
v_cmp_eq_u32 vcc, s34, v7
s_cbranch_vccnz L_q_e_162
L_v_e_163:
v_smfmac_f32_16x16x64_bf16 v[88:91], v[52:55], a[200:207], v6
s_waitcnt vmcnt(1)
v_max3_u32 v7, v56, v57, v58
v_max_u32 v7, v7, v59
v_cmp_eq_u32 vcc, s34, v7
v_smfmac_f32_16x16x64_bf16 v[92:95], v[52:55], a[232:239], v6
s_cbranch_vccnz L_q_e_141
s_branch L_v_e_142
L_q_e_162:
buffer_load_dwordx4 v[52:55], v3, s[8:11], s41 offen sc1
s_waitcnt vmcnt(2)
v_max3_u32 v7, v56, v57, v58
v_max_u32 v7, v7, v59
v_cmp_eq_u32 vcc, s34, v7
s_cbranch_vccz L_ok_e_164
buffer_load_dwordx4 v[56:59], v4, s[8:11], s41 offen sc1
s_waitcnt vmcnt(2)
v_max3_u32 v7, v60, v61, v62
v_max_u32 v7, v7, v63
v_cmp_eq_u32 vcc, s34, v7
s_cbranch_vccz L_ok_e_165
buffer_load_dwordx4 v[60:63], v5, s[8:11], s41 offen sc1
s_waitcnt vmcnt(2)
v_max3_u32 v7, v52, v53, v54
v_max_u32 v7, v7, v55
v_cmp_eq_u32 vcc, s34, v7
s_cbranch_vccz L_ok_e_166
s_add_u32 s33, s33, 1
s_cmp_gt_u32 s33, 0x100000
s_cbranch_scc0 L_q_e_162
s_branch chain_kernel_abort
L_ok_e_164:
v_smfmac_f32_16x16x64_bf16 v[88:91], v[56:59], a[208:215], v6
v_smfmac_f32_16x16x64_bf16 v[92:95], v[56:59], a[240:247], v6
s_branch L_q_e_152
L_ok_e_165:
v_smfmac_f32_16x16x64_bf16 v[88:91], v[60:63], a[216:223], v6
v_smfmac_f32_16x16x64_bf16 v[92:95], v[60:63], a[248:255], v6
s_branch L_q_e_158
L_ok_e_166:
v_smfmac_f32_16x16x64_bf16 v[88:91], v[52:55], a[200:207], v6
v_smfmac_f32_16x16x64_bf16 v[92:95], v[52:55], a[232:239], v6
s_branch L_q_e_141
L_q_e_126:
buffer_load_dwordx4 v[48:51], v2, s[8:11], s41 offen sc1
s_waitcnt vmcnt(3)
v_max3_u32 v7, v52, v53, v54
v_max_u32 v7, v7, v55
v_cmp_eq_u32 vcc, s34, v7
s_cbranch_vccnz L_q_e_167
L_v_e_168:
v_smfmac_f32_16x16x64_bf16 v[88:91], v[52:55], a[200:207], v6
s_waitcnt vmcnt(2)
v_max3_u32 v7, v56, v57, v58
v_max_u32 v7, v7, v59
v_cmp_eq_u32 vcc, s34, v7
v_smfmac_f32_16x16x64_bf16 v[92:95], v[52:55], a[232:239], v6
s_cbranch_vccnz L_q_e_169
L_v_e_170:
v_smfmac_f32_16x16x64_bf16 v[88:91], v[56:59], a[208:215], v6
s_waitcnt vmcnt(1)
v_max3_u32 v7, v60, v61, v62
v_max_u32 v7, v7, v63
v_cmp_eq_u32 vcc, s34, v7
v_smfmac_f32_16x16x64_bf16 v[92:95], v[56:59], a[240:247], v6
s_cbranch_vccnz L_q_e_171
L_v_e_172:
v_smfmac_f32_16x16x64_bf16 v[88:91], v[60:63], a[216:223], v6
s_waitcnt vmcnt(0)
v_max3_u32 v7, v48, v49, v50
v_max_u32 v7, v7, v51
v_cmp_eq_u32 vcc, s34, v7
v_smfmac_f32_16x16x64_bf16 v[92:95], v[60:63], a[248:255], v6
s_cbranch_vccnz L_q_e_173
L_v_e_174:
v_smfmac_f32_16x16x64_bf16 v[88:91], v[48:51], a[192:199], v6
v_smfmac_f32_16x16x64_bf16 v[92:95], v[48:51], a[224:231], v6
s_branch L_gd_e_125
L_q_e_173:
buffer_load_dwordx4 v[48:51], v2, s[8:11], s41 offen sc1
s_waitcnt vmcnt(2)
v_max3_u32 v7, v48, v49, v50
v_max_u32 v7, v7, v51
v_cmp_eq_u32 vcc, s34, v7
s_cbranch_vccz L_ok_e_175
s_add_u32 s33, s33, 1
s_cmp_gt_u32 s33, 0x100000
s_cbranch_scc0 L_q_e_173
s_branch chain_kernel_abort
L_ok_e_175:
v_smfmac_f32_16x16x64_bf16 v[88:91], v[48:51], a[192:199], v6
v_smfmac_f32_16x16x64_bf16 v[92:95], v[48:51], a[224:231], v6
s_branch L_gd_e_125
L_q_e_171:
buffer_load_dwordx4 v[60:63], v5, s[8:11], s41 offen sc1
s_waitcnt vmcnt(1)
v_max3_u32 v7, v48, v49, v50
v_max_u32 v7, v7, v51
v_cmp_eq_u32 vcc, s34, v7
s_cbranch_vccnz L_q_e_176
L_v_e_177:
v_smfmac_f32_16x16x64_bf16 v[88:91], v[48:51], a[192:199], v6
s_waitcnt vmcnt(0)
v_max3_u32 v7, v60, v61, v62
v_max_u32 v7, v7, v63
v_cmp_eq_u32 vcc, s34, v7
v_smfmac_f32_16x16x64_bf16 v[92:95], v[48:51], a[224:231], v6
s_cbranch_vccnz L_q_e_134
s_branch L_v_e_133
L_q_e_176:
buffer_load_dwordx4 v[48:51], v2, s[8:11], s41 offen sc1
s_waitcnt vmcnt(2)
v_max3_u32 v7, v60, v61, v62
v_max_u32 v7, v7, v63
v_cmp_eq_u32 vcc, s34, v7
s_cbranch_vccz L_ok_e_178
buffer_load_dwordx4 v[60:63], v5, s[8:11], s41 offen sc1
s_waitcnt vmcnt(2)
v_max3_u32 v7, v48, v49, v50
v_max_u32 v7, v7, v51
v_cmp_eq_u32 vcc, s34, v7
s_cbranch_vccz L_ok_e_179
s_add_u32 s33, s33, 1
s_cmp_gt_u32 s33, 0x100000
s_cbranch_scc0 L_q_e_176
s_branch chain_kernel_abort
L_ok_e_178:
v_smfmac_f32_16x16x64_bf16 v[88:91], v[60:63], a[216:223], v6
v_smfmac_f32_16x16x64_bf16 v[92:95], v[60:63], a[248:255], v6
s_branch L_q_e_173
L_ok_e_179:
v_smfmac_f32_16x16x64_bf16 v[88:91], v[48:51], a[192:199], v6
v_smfmac_f32_16x16x64_bf16 v[92:95], v[48:51], a[224:231], v6
s_branch L_q_e_134
L_q_e_169:
buffer_load_dwordx4 v[56:59], v4, s[8:11], s41 offen sc1
s_waitcnt vmcnt(2)
v_max3_u32 v7, v60, v61, v62
v_max_u32 v7, v7, v63
v_cmp_eq_u32 vcc, s34, v7
s_cbranch_vccnz L_q_e_180
L_v_e_181:
v_smfmac_f32_16x16x64_bf16 v[88:91], v[60:63], a[216:223], v6
s_waitcnt vmcnt(1)
v_max3_u32 v7, v48, v49, v50
v_max_u32 v7, v7, v51
v_cmp_eq_u32 vcc, s34, v7
v_smfmac_f32_16x16x64_bf16 v[92:95], v[60:63], a[248:255], v6
s_cbranch_vccnz L_q_e_182
L_v_e_183:
v_smfmac_f32_16x16x64_bf16 v[88:91], v[48:51], a[192:199], v6
s_waitcnt vmcnt(0)
v_max3_u32 v7, v56, v57, v58
v_max_u32 v7, v7, v59
v_cmp_eq_u32 vcc, s34, v7
v_smfmac_f32_16x16x64_bf16 v[92:95], v[48:51], a[224:231], v6
s_cbranch_vccnz L_q_e_138
s_branch L_v_e_139
L_q_e_182:
buffer_load_dwordx4 v[48:51], v2, s[8:11], s41 offen sc1
s_waitcnt vmcnt(2)
v_max3_u32 v7, v56, v57, v58
v_max_u32 v7, v7, v59
v_cmp_eq_u32 vcc, s34, v7
s_cbranch_vccz L_ok_e_184
buffer_load_dwordx4 v[56:59], v4, s[8:11], s41 offen sc1
s_waitcnt vmcnt(2)
v_max3_u32 v7, v48, v49, v50
v_max_u32 v7, v7, v51
v_cmp_eq_u32 vcc, s34, v7
s_cbranch_vccz L_ok_e_185
s_add_u32 s33, s33, 1
s_cmp_gt_u32 s33, 0x100000
s_cbranch_scc0 L_q_e_182
s_branch chain_kernel_abort
L_ok_e_184:
v_smfmac_f32_16x16x64_bf16 v[88:91], v[56:59], a[208:215], v6
v_smfmac_f32_16x16x64_bf16 v[92:95], v[56:59], a[240:247], v6
s_branch L_q_e_173
L_ok_e_185:
v_smfmac_f32_16x16x64_bf16 v[88:91], v[48:51], a[192:199], v6
v_smfmac_f32_16x16x64_bf16 v[92:95], v[48:51], a[224:231], v6
s_branch L_q_e_138
L_q_e_180:
buffer_load_dwordx4 v[60:63], v5, s[8:11], s41 offen sc1
s_waitcnt vmcnt(2)
v_max3_u32 v7, v48, v49, v50
v_max_u32 v7, v7, v51
v_cmp_eq_u32 vcc, s34, v7
s_cbranch_vccnz L_q_e_186
L_v_e_187:
v_smfmac_f32_16x16x64_bf16 v[88:91], v[48:51], a[192:199], v6
s_waitcnt vmcnt(1)
v_max3_u32 v7, v56, v57, v58
v_max_u32 v7, v7, v59
v_cmp_eq_u32 vcc, s34, v7
v_smfmac_f32_16x16x64_bf16 v[92:95], v[48:51], a[224:231], v6
s_cbranch_vccnz L_q_e_141
s_branch L_v_e_142
L_q_e_186:
buffer_load_dwordx4 v[48:51], v2, s[8:11], s41 offen sc1
s_waitcnt vmcnt(2)
v_max3_u32 v7, v56, v57, v58
v_max_u32 v7, v7, v59
v_cmp_eq_u32 vcc, s34, v7
s_cbranch_vccz L_ok_e_188
buffer_load_dwordx4 v[56:59], v4, s[8:11], s41 offen sc1
s_waitcnt vmcnt(2)
v_max3_u32 v7, v60, v61, v62
v_max_u32 v7, v7, v63
v_cmp_eq_u32 vcc, s34, v7
s_cbranch_vccz L_ok_e_189
buffer_load_dwordx4 v[60:63], v5, s[8:11], s41 offen sc1
s_waitcnt vmcnt(2)
v_max3_u32 v7, v48, v49, v50
v_max_u32 v7, v7, v51
v_cmp_eq_u32 vcc, s34, v7
s_cbranch_vccz L_ok_e_190
s_add_u32 s33, s33, 1
s_cmp_gt_u32 s33, 0x100000
s_cbranch_scc0 L_q_e_186
s_branch chain_kernel_abort
L_ok_e_188:
v_smfmac_f32_16x16x64_bf16 v[88:91], v[56:59], a[208:215], v6
v_smfmac_f32_16x16x64_bf16 v[92:95], v[56:59], a[240:247], v6
s_branch L_q_e_176
L_ok_e_189:
v_smfmac_f32_16x16x64_bf16 v[88:91], v[60:63], a[216:223], v6
v_smfmac_f32_16x16x64_bf16 v[92:95], v[60:63], a[248:255], v6
s_branch L_q_e_182
L_ok_e_190:
v_smfmac_f32_16x16x64_bf16 v[88:91], v[48:51], a[192:199], v6
v_smfmac_f32_16x16x64_bf16 v[92:95], v[48:51], a[224:231], v6
s_branch L_q_e_141
L_q_e_167:
buffer_load_dwordx4 v[52:55], v3, s[8:11], s41 offen sc1
s_waitcnt vmcnt(3)
v_max3_u32 v7, v56, v57, v58
v_max_u32 v7, v7, v59
v_cmp_eq_u32 vcc, s34, v7
s_cbranch_vccnz L_q_e_191
L_v_e_192:
v_smfmac_f32_16x16x64_bf16 v[88:91], v[56:59], a[208:215], v6
s_waitcnt vmcnt(2)
v_max3_u32 v7, v60, v61, v62
v_max_u32 v7, v7, v63
v_cmp_eq_u32 vcc, s34, v7
v_smfmac_f32_16x16x64_bf16 v[92:95], v[56:59], a[240:247], v6
s_cbranch_vccnz L_q_e_193
L_v_e_194:
v_smfmac_f32_16x16x64_bf16 v[88:91], v[60:63], a[216:223], v6
s_waitcnt vmcnt(1)
v_max3_u32 v7, v48, v49, v50
v_max_u32 v7, v7, v51
v_cmp_eq_u32 vcc, s34, v7
v_smfmac_f32_16x16x64_bf16 v[92:95], v[60:63], a[248:255], v6
s_cbranch_vccnz L_q_e_195
L_v_e_196:
v_smfmac_f32_16x16x64_bf16 v[88:91], v[48:51], a[192:199], v6
s_waitcnt vmcnt(0)
v_max3_u32 v7, v52, v53, v54
v_max_u32 v7, v7, v55
v_cmp_eq_u32 vcc, s34, v7
v_smfmac_f32_16x16x64_bf16 v[92:95], v[48:51], a[224:231], v6
s_cbranch_vccnz L_q_e_149
s_branch L_v_e_150
L_q_e_195:
buffer_load_dwordx4 v[48:51], v2, s[8:11], s41 offen sc1
s_waitcnt vmcnt(2)
v_max3_u32 v7, v52, v53, v54
v_max_u32 v7, v7, v55
v_cmp_eq_u32 vcc, s34, v7
s_cbranch_vccz L_ok_e_197
buffer_load_dwordx4 v[52:55], v3, s[8:11], s41 offen sc1
s_waitcnt vmcnt(2)
v_max3_u32 v7, v48, v49, v50
v_max_u32 v7, v7, v51
v_cmp_eq_u32 vcc, s34, v7
s_cbranch_vccz L_ok_e_198
s_add_u32 s33, s33, 1
s_cmp_gt_u32 s33, 0x100000
s_cbranch_scc0 L_q_e_195
s_branch chain_kernel_abort
L_ok_e_197:
v_smfmac_f32_16x16x64_bf16 v[88:91], v[52:55], a[200:207], v6
v_smfmac_f32_16x16x64_bf16 v[92:95], v[52:55], a[232:239], v6
s_branch L_q_e_173
L_ok_e_198:
v_smfmac_f32_16x16x64_bf16 v[88:91], v[48:51], a[192:199], v6
v_smfmac_f32_16x16x64_bf16 v[92:95], v[48:51], a[224:231], v6
s_branch L_q_e_149
L_q_e_193:
buffer_load_dwordx4 v[60:63], v5, s[8:11], s41 offen sc1
s_waitcnt vmcnt(2)
v_max3_u32 v7, v48, v49, v50
v_max_u32 v7, v7, v51
v_cmp_eq_u32 vcc, s34, v7
s_cbranch_vccnz L_q_e_199
L_v_e_200:
v_smfmac_f32_16x16x64_bf16 v[88:91], v[48:51], a[192:199], v6
s_waitcnt vmcnt(1)
v_max3_u32 v7, v52, v53, v54
v_max_u32 v7, v7, v55
v_cmp_eq_u32 vcc, s34, v7
v_smfmac_f32_16x16x64_bf16 v[92:95], v[48:51], a[224:231], v6
s_cbranch_vccnz L_q_e_152
s_branch L_v_e_153
L_q_e_199:
buffer_load_dwordx4 v[48:51], v2, s[8:11], s41 offen sc1
s_waitcnt vmcnt(2)
v_max3_u32 v7, v52, v53, v54
v_max_u32 v7, v7, v55
v_cmp_eq_u32 vcc, s34, v7
s_cbranch_vccz L_ok_e_201
buffer_load_dwordx4 v[52:55], v3, s[8:11], s41 offen sc1
s_waitcnt vmcnt(2)
v_max3_u32 v7, v60, v61, v62
v_max_u32 v7, v7, v63
v_cmp_eq_u32 vcc, s34, v7
s_cbranch_vccz L_ok_e_202
buffer_load_dwordx4 v[60:63], v5, s[8:11], s41 offen sc1
s_waitcnt vmcnt(2)
v_max3_u32 v7, v48, v49, v50
v_max_u32 v7, v7, v51
v_cmp_eq_u32 vcc, s34, v7
s_cbranch_vccz L_ok_e_203
s_add_u32 s33, s33, 1
s_cmp_gt_u32 s33, 0x100000
s_cbranch_scc0 L_q_e_199
s_branch chain_kernel_abort
L_ok_e_201:
v_smfmac_f32_16x16x64_bf16 v[88:91], v[52:55], a[200:207], v6
v_smfmac_f32_16x16x64_bf16 v[92:95], v[52:55], a[232:239], v6
s_branch L_q_e_176
L_ok_e_202:
v_smfmac_f32_16x16x64_bf16 v[88:91], v[60:63], a[216:223], v6
v_smfmac_f32_16x16x64_bf16 v[92:95], v[60:63], a[248:255], v6
s_branch L_q_e_195
L_ok_e_203:
v_smfmac_f32_16x16x64_bf16 v[88:91], v[48:51], a[192:199], v6
v_smfmac_f32_16x16x64_bf16 v[92:95], v[48:51], a[224:231], v6
s_branch L_q_e_152
L_q_e_191:
buffer_load_dwordx4 v[56:59], v4, s[8:11], s41 offen sc1
s_waitcnt vmcnt(3)
v_max3_u32 v7, v60, v61, v62
v_max_u32 v7, v7, v63
v_cmp_eq_u32 vcc, s34, v7
s_cbranch_vccnz L_q_e_204
L_v_e_205:
v_smfmac_f32_16x16x64_bf16 v[88:91], v[60:63], a[216:223], v6
s_waitcnt vmcnt(2)
v_max3_u32 v7, v48, v49, v50
v_max_u32 v7, v7, v51
v_cmp_eq_u32 vcc, s34, v7
v_smfmac_f32_16x16x64_bf16 v[92:95], v[60:63], a[248:255], v6
s_cbranch_vccnz L_q_e_206
L_v_e_207:
v_smfmac_f32_16x16x64_bf16 v[88:91], v[48:51], a[192:199], v6
s_waitcnt vmcnt(1)
v_max3_u32 v7, v52, v53, v54
v_max_u32 v7, v7, v55
v_cmp_eq_u32 vcc, s34, v7
v_smfmac_f32_16x16x64_bf16 v[92:95], v[48:51], a[224:231], v6
s_cbranch_vccnz L_q_e_158
s_branch L_v_e_159
L_q_e_206:
buffer_load_dwordx4 v[48:51], v2, s[8:11], s41 offen sc1
s_waitcnt vmcnt(2)
v_max3_u32 v7, v52, v53, v54
v_max_u32 v7, v7, v55
v_cmp_eq_u32 vcc, s34, v7
s_cbranch_vccz L_ok_e_208
buffer_load_dwordx4 v[52:55], v3, s[8:11], s41 offen sc1
s_waitcnt vmcnt(2)
v_max3_u32 v7, v56, v57, v58
v_max_u32 v7, v7, v59
v_cmp_eq_u32 vcc, s34, v7
s_cbranch_vccz L_ok_e_209
buffer_load_dwordx4 v[56:59], v4, s[8:11], s41 offen sc1
s_waitcnt vmcnt(2)
v_max3_u32 v7, v48, v49, v50
v_max_u32 v7, v7, v51
v_cmp_eq_u32 vcc, s34, v7
s_cbranch_vccz L_ok_e_210
s_add_u32 s33, s33, 1
s_cmp_gt_u32 s33, 0x100000
s_cbranch_scc0 L_q_e_206
s_branch chain_kernel_abort
L_ok_e_208:
v_smfmac_f32_16x16x64_bf16 v[88:91], v[52:55], a[200:207], v6
v_smfmac_f32_16x16x64_bf16 v[92:95], v[52:55], a[232:239], v6
s_branch L_q_e_182
L_ok_e_209:
v_smfmac_f32_16x16x64_bf16 v[88:91], v[56:59], a[208:215], v6
v_smfmac_f32_16x16x64_bf16 v[92:95], v[56:59], a[240:247], v6
s_branch L_q_e_195
L_ok_e_210:
v_smfmac_f32_16x16x64_bf16 v[88:91], v[48:51], a[192:199], v6
v_smfmac_f32_16x16x64_bf16 v[92:95], v[48:51], a[224:231], v6
s_branch L_q_e_158
L_q_e_204:
buffer_load_dwordx4 v[60:63], v5, s[8:11], s41 offen sc1
s_waitcnt vmcnt(3)
v_max3_u32 v7, v48, v49, v50
v_max_u32 v7, v7, v51
v_cmp_eq_u32 vcc, s34, v7
s_cbranch_vccnz L_q_e_211
L_v_e_212:
v_smfmac_f32_16x16x64_bf16 v[88:91], v[48:51], a[192:199], v6
s_waitcnt vmcnt(2)
v_max3_u32 v7, v52, v53, v54
v_max_u32 v7, v7, v55
v_cmp_eq_u32 vcc, s34, v7
v_smfmac_f32_16x16x64_bf16 v[92:95], v[48:51], a[224:231], v6
s_cbranch_vccnz L_q_e_162
s_branch L_v_e_163
L_q_e_211:
buffer_load_dwordx4 v[48:51], v2, s[8:11], s41 offen sc1
s_waitcnt vmcnt(2)
v_max3_u32 v7, v52, v53, v54
v_max_u32 v7, v7, v55
v_cmp_eq_u32 vcc, s34, v7
s_cbranch_vccz L_ok_e_213
buffer_load_dwordx4 v[52:55], v3, s[8:11], s41 offen sc1
s_waitcnt vmcnt(2)
v_max3_u32 v7, v56, v57, v58
v_max_u32 v7, v7, v59
v_cmp_eq_u32 vcc, s34, v7
s_cbranch_vccz L_ok_e_214
buffer_load_dwordx4 v[56:59], v4, s[8:11], s41 offen sc1
s_waitcnt vmcnt(2)
v_max3_u32 v7, v60, v61, v62
v_max_u32 v7, v7, v63
v_cmp_eq_u32 vcc, s34, v7
s_cbranch_vccz L_ok_e_215
buffer_load_dwordx4 v[60:63], v5, s[8:11], s41 offen sc1
s_waitcnt vmcnt(2)
v_max3_u32 v7, v48, v49, v50
v_max_u32 v7, v7, v51
v_cmp_eq_u32 vcc, s34, v7
s_cbranch_vccz L_ok_e_216
s_add_u32 s33, s33, 1
s_cmp_gt_u32 s33, 0x100000
s_cbranch_scc0 L_q_e_211
s_branch chain_kernel_abort
L_ok_e_213:
v_smfmac_f32_16x16x64_bf16 v[88:91], v[52:55], a[200:207], v6
v_smfmac_f32_16x16x64_bf16 v[92:95], v[52:55], a[232:239], v6
s_branch L_q_e_186
L_ok_e_214:
v_smfmac_f32_16x16x64_bf16 v[88:91], v[56:59], a[208:215], v6
v_smfmac_f32_16x16x64_bf16 v[92:95], v[56:59], a[240:247], v6
s_branch L_q_e_199
L_ok_e_215:
v_smfmac_f32_16x16x64_bf16 v[88:91], v[60:63], a[216:223], v6
v_smfmac_f32_16x16x64_bf16 v[92:95], v[60:63], a[248:255], v6
s_branch L_q_e_206
L_ok_e_216:
v_smfmac_f32_16x16x64_bf16 v[88:91], v[48:51], a[192:199], v6
v_smfmac_f32_16x16x64_bf16 v[92:95], v[48:51], a[224:231], v6
s_branch L_q_e_162
L_gf_217:
s_waitcnt vmcnt(4)
v_lshlrev_b32 v100, 16, v212
v_and_b32 v101, 0xffff0000, v212
v_lshlrev_b32 v102, 16, v213
v_and_b32 v103, 0xffff0000, v213
v_pk_add_f32 v[148:149], v[168:169], v[100:101]
v_pk_add_f32 v[150:151], v[170:171], v[102:103]
s_waitcnt vmcnt(3)
v_lshlrev_b32 v100, 16, v214
v_and_b32 v101, 0xffff0000, v214
v_lshlrev_b32 v102, 16, v215
v_and_b32 v103, 0xffff0000, v215
v_pk_add_f32 v[148:149], v[148:149], v[100:101]
v_pk_add_f32 v[150:151], v[150:151], v[102:103]
s_waitcnt vmcnt(2)
v_lshlrev_b32 v100, 16, v216
v_and_b32 v101, 0xffff0000, v216
v_lshlrev_b32 v102, 16, v217
v_and_b32 v103, 0xffff0000, v217
v_pk_add_f32 v[148:149], v[148:149], v[100:101]
v_pk_add_f32 v[150:151], v[150:151], v[102:103]
v_cmp_u_f32 vcc, v148, v150
v_cvt_pk_bf16_f32 v180, v148, v149
v_cvt_pk_bf16_f32 v181, v150, v151
s_cbranch_vccz L_gok_218
buffer_load_dwordx2 v[212:213], v17, s[8:11], s22 offen offset:512 sc1
buffer_load_dwordx2 v[214:215], v18, s[8:11], s22 offen offset:512 sc1
buffer_load_dwordx2 v[216:217], v19, s[8:11], s22 offen offset:512 sc1
s_nop 11
L_rt_220:
buffer_load_dwordx2 v[200:201], v17, s[8:11], s22 offen offset:0 sc1
buffer_load_dwordx2 v[202:203], v18, s[8:11], s22 offen offset:0 sc1
buffer_load_dwordx2 v[204:205], v19, s[8:11], s22 offen offset:0 sc1
s_waitcnt vmcnt(5)
v_lshlrev_b32 v100, 16, v212
v_and_b32 v101, 0xffff0000, v212
v_lshlrev_b32 v102, 16, v213
v_and_b32 v103, 0xffff0000, v213
v_pk_add_f32 v[148:149], v[168:169], v[100:101]
v_pk_add_f32 v[150:151], v[170:171], v[102:103]
s_waitcnt vmcnt(4)
v_lshlrev_b32 v100, 16, v214
v_and_b32 v101, 0xffff0000, v214
v_lshlrev_b32 v102, 16, v215
v_and_b32 v103, 0xffff0000, v215
v_pk_add_f32 v[148:149], v[148:149], v[100:101]
v_pk_add_f32 v[150:151], v[150:151], v[102:103]
s_waitcnt vmcnt(3)
v_lshlrev_b32 v100, 16, v216
v_and_b32 v101, 0xffff0000, v216
v_lshlrev_b32 v102, 16, v217
v_and_b32 v103, 0xffff0000, v217
v_pk_add_f32 v[148:149], v[148:149], v[100:101]
v_pk_add_f32 v[150:151], v[150:151], v[102:103]
v_cmp_u_f32 vcc, v148, v150
v_cvt_pk_bf16_f32 v180, v148, v149
v_cvt_pk_bf16_f32 v181, v150, v151
s_cbranch_vccz L_gok_218
buffer_load_dwordx2 v[212:213], v17, s[8:11], s22 offen offset:512 sc1
buffer_load_dwordx2 v[214:215], v18, s[8:11], s22 offen offset:512 sc1
buffer_load_dwordx2 v[216:217], v19, s[8:11], s22 offen offset:512 sc1
s_waitcnt vmcnt(5)
v_lshlrev_b32 v100, 16, v200
v_and_b32 v101, 0xffff0000, v200
v_lshlrev_b32 v102, 16, v201
v_and_b32 v103, 0xffff0000, v201
v_pk_add_f32 v[148:149], v[168:169], v[100:101]
v_pk_add_f32 v[150:151], v[170:171], v[102:103]
s_waitcnt vmcnt(4)
v_lshlrev_b32 v100, 16, v202
v_and_b32 v101, 0xffff0000, v202
v_lshlrev_b32 v102, 16, v203
v_and_b32 v103, 0xffff0000, v203
v_pk_add_f32 v[148:149], v[148:149], v[100:101]
v_pk_add_f32 v[150:151], v[150:151], v[102:103]
s_waitcnt vmcnt(3)
v_lshlrev_b32 v100, 16, v204
v_and_b32 v101, 0xffff0000, v204
v_lshlrev_b32 v102, 16, v205
v_and_b32 v103, 0xffff0000, v205
v_pk_add_f32 v[148:149], v[148:149], v[100:101]
v_pk_add_f32 v[150:151], v[150:151], v[102:103]
v_cmp_u_f32 vcc, v148, v150
v_cvt_pk_bf16_f32 v180, v148, v149
v_cvt_pk_bf16_f32 v181, v150, v151
s_cbranch_vccz L_gok_218
s_add_u32 s33, s33, 1
s_cmp_gt_u32 s33, 0x100000
s_cbranch_scc1 chain_kernel_abort
s_and_b32 s20, s33, 63
s_cbranch_scc1 L_rt_220
v_cmp_eq_u32 vcc, s34, v200
v_cmp_eq_u32 s[20:21], s34, v201
s_or_b64 vcc, vcc, s[20:21]
v_cmp_eq_u32 s[20:21], s34, v202
s_or_b64 vcc, vcc, s[20:21]
v_cmp_eq_u32 s[20:21], s34, v203
s_or_b64 vcc, vcc, s[20:21]
v_cmp_eq_u32 s[20:21], s34, v204
s_or_b64 vcc, vcc, s[20:21]
v_cmp_eq_u32 s[20:21], s34, v205
s_or_b64 vcc, vcc, s[20:21]
s_cbranch_vccnz L_rt_220
s_branch L_gok_218
L_slow_16:
L_step_224:
s_nop 15
s_nop 7
L_step_224_nd:
buffer_load_dwordx4 v[48:51], v2, s[8:11], s38 offen sc1
v_mov_b32 v88, 0
v_mov_b32 v89, 0
v_mov_b32 v90, 0
v_mov_b32 v91, 0
v_mov_b32 v92, 0
v_mov_b32 v93, 0
v_mov_b32 v94, 0
v_mov_b32 v95, 0
ds_read_b128 v[116:119], v25
ds_read_b128 v[120:123], v25 offset:1024
v_xor_b32 v25, 0x1000, v25
s_nop 0
buffer_load_dwordx4 v[52:55], v3, s[8:11], s38 offen sc1
s_nop 11
buffer_load_dwordx4 v[56:59], v4, s[8:11], s38 offen sc1
s_nop 11
buffer_load_dwordx4 v[60:63], v5, s[8:11], s38 offen sc1
s_waitcnt vmcnt(3)
v_max3_u32 v7, v48, v49, v50
v_max_u32 v7, v7, v51
v_cmp_eq_u32 vcc, s34, v7
s_cbranch_vccnz L_q_a_231
L_v_a_232:
v_smfmac_f32_16x16x64_bf16 v[64:67], v[48:51], a[0:7], v6
s_waitcnt vmcnt(2)
v_max3_u32 v7, v52, v53, v54
v_max_u32 v7, v7, v55
v_smfmac_f32_16x16x64_bf16 v[68:71], v[48:51], a[64:71], v6
v_cmp_eq_u32 vcc, s34, v7
v_smfmac_f32_16x16x64_bf16 v[72:75], v[48:51], a[32:39], v6
v_smfmac_f32_16x16x64_bf16 v[76:79], v[48:51], a[96:103], v6
s_cbranch_vccnz L_q_a_233
L_v_a_234:
v_smfmac_f32_16x16x64_bf16 v[64:67], v[52:55], a[8:15], v6
s_waitcnt vmcnt(1)
v_max3_u32 v7, v56, v57, v58
v_max_u32 v7, v7, v59
v_smfmac_f32_16x16x64_bf16 v[68:71], v[52:55], a[72:79], v6
v_cmp_eq_u32 vcc, s34, v7
v_smfmac_f32_16x16x64_bf16 v[72:75], v[52:55], a[40:47], v6
v_smfmac_f32_16x16x64_bf16 v[76:79], v[52:55], a[104:111], v6
s_cbranch_vccnz L_q_a_235
L_v_a_236:
v_smfmac_f32_16x16x64_bf16 v[64:67], v[56:59], a[16:23], v6
s_waitcnt vmcnt(0)
v_max3_u32 v7, v60, v61, v62
v_max_u32 v7, v7, v63
v_smfmac_f32_16x16x64_bf16 v[68:71], v[56:59], a[80:87], v6
v_cmp_eq_u32 vcc, s34, v7
v_smfmac_f32_16x16x64_bf16 v[72:75], v[56:59], a[48:55], v6
v_smfmac_f32_16x16x64_bf16 v[76:79], v[56:59], a[112:119], v6
s_cbranch_vccnz L_q_a_237
L_v_a_238:
v_smfmac_f32_16x16x64_bf16 v[64:67], v[60:63], a[24:31], v6
v_smfmac_f32_16x16x64_bf16 v[68:71], v[60:63], a[88:95], v6
v_smfmac_f32_16x16x64_bf16 v[72:75], v[60:63], a[56:63], v6
v_smfmac_f32_16x16x64_bf16 v[76:79], v[60:63], a[120:127], v6
L_gd_a_230:
v_cvt_pk_bf16_f32 v96, v64, v65
v_cvt_pk_bf16_f32 v97, v66, v67
v_cvt_pk_bf16_f32 v98, v68, v69
v_cvt_pk_bf16_f32 v99, v70, v71
s_cmp_lg_u32 s18, 0
v_cvt_pk_bf16_f32 v100, v72, v73
v_mfma_f32_16x16x32_bf16 v[104:107], v[96:99], v[40:43], 0
v_cvt_pk_bf16_f32 v101, v74, v75
v_cvt_pk_bf16_f32 v102, v76, v77
v_cvt_pk_bf16_f32 v103, v78, v79
s_nop 1
v_mfma_f32_16x16x32_bf16 v[108:111], v[100:103], v[40:43], 0
s_cbranch_scc0 L_help1_225_w0
s_nop 0
ds_write_b128 v20, v[104:107]
s_nop 4
ds_write_b128 v20, v[108:111] offset:1024
s_waitcnt lgkmcnt(0)
s_barrier
v_smfmac_f32_16x16x64_bf16 v[80:83], v[48:51], a[128:135], v6
v_smfmac_f32_16x16x64_bf16 v[84:87], v[48:51], a[160:167], v6
v_smfmac_f32_16x16x64_bf16 v[80:83], v[52:55], a[136:143], v6
v_smfmac_f32_16x16x64_bf16 v[84:87], v[52:55], a[168:175], v6
v_smfmac_f32_16x16x64_bf16 v[80:83], v[56:59], a[144:151], v6
v_smfmac_f32_16x16x64_bf16 v[84:87], v[56:59], a[176:183], v6
v_smfmac_f32_16x16x64_bf16 v[80:83], v[60:63], a[152:159], v6
v_smfmac_f32_16x16x64_bf16 v[84:87], v[60:63], a[184:191], v6
s_nop 4
ds_write_b128 v21, v[80:83]
s_nop 1
ds_write_b128 v21, v[84:87] offset:512
s_waitcnt lgkmcnt(0)
L_bar2b_323_2:
s_barrier
s_cmp_eq_u32 s18, 1
s_cbranch_scc1 L_vred_322
L_bar2b_323:
s_waitcnt lgkmcnt(0)
s_barrier
s_cmp_eq_u32 s19, 63
s_cbranch_scc1 L_fin_229
s_cmp_lg_u32 s18, 2
s_cbranch_scc1 L_poe_324
s_sub_u32 s20, s19, 1
s_and_b32 s20, s20, 3
s_lshl_b32 s21, s20, 16
s_add_u32 s21, s21, s36
s_add_u32 s22, s21, 0x140000
s_lshl_b32 s23, s20, 18
s_add_u32 s23, s23, s37
buffer_store_dwordx2 v[36:37], v8, s[8:11], s21 offen sc1
buffer_store_dwordx2 v[36:37], v28, s[8:11], s22 offen sc1
buffer_store_dwordx4 v[36:39], v9, s[8:11], s23 offen sc1
s_mov_b64 exec, s[28:29]
buffer_store_dwordx4 v[36:39], v10, s[8:11], s23 offen sc1
s_mov_b64 exec, -1
L_poe_324:
s_cmp_lg_u32 s18, 3
s_cbranch_scc1 L_bar3_226
s_cmp_ge_u32 s19, 2
s_cbranch_scc1 L_gated_325
s_add_u32 s23, s19, 1
s_lshl_b32 s21, s23, 7
s_add_u32 s21, s21, 0x5900000
v_mov_b32 v34, 0
L_dw_326:
buffer_load_dword v35, v34, s[8:11], s21 offen sc1
s_add_u32 s33, s33, 1
s_cmp_gt_u32 s33, 0x100000
s_waitcnt vmcnt(0)
s_cbranch_scc1 chain_kernel_abort
v_readfirstlane_b32 s20, v35
s_cmp_ge_u32 s20, 64
s_cbranch_scc1 L_dwok_327
s_sleep 2
s_branch L_dw_326
L_dwok_327:
L_gated_325:
s_add_u32 m0, s43, 0
s_nop 0
buffer_load_dwordx4 v27, s[8:11], s31 offen offset:0 lds
s_add_u32 m0, s43, 896
s_nop 0
buffer_load_dwordx4 v27, s[8:11], s31 offen offset:128 lds
s_add_u32 m0, s43, 0
s_nop 0
buffer_load_dwordx4 v29, s[8:11], s31 offen offset:2048 lds
s_add_u32 m0, s43, 960
s_nop 0
buffer_load_dwordx4 v29, s[8:11], s31 offen offset:2112 lds
s_xor_b32 s43, s43, 4096
s_branch L_bar3_226
L_vred_322:
ds_read_b64 v[168:169], v22 offset:0
ds_read_b64 v[170:171], v22 offset:512
ds_read_b64 v[172:173], v22 offset:1024
ds_read_b64 v[174:175], v22 offset:1536
ds_read_b64 v[176:177], v22 offset:2048
ds_read_b64 v[178:179], v22 offset:2560
ds_read_b64 v[180:181], v22 offset:3072
ds_read_b64 v[182:183], v22 offset:3584
ds_read_b64 v[184:185], v22 offset:4096
ds_read_b64 v[186:187], v22 offset:4608
ds_read_b64 v[188:189], v22 offset:5120
ds_read_b64 v[190:191], v22 offset:5632
ds_read_b64 v[192:193], v22 offset:6144
ds_read_b64 v[194:195], v22 offset:6656
ds_read_b64 v[196:197], v22 offset:7168
s_waitcnt lgkmcnt(11)
ds_read_b64 v[198:199], v22 offset:7680
s_waitcnt lgkmcnt(8)
v_pk_add_f32 v[168:169], v[168:169], v[172:173]
v_pk_add_f32 v[170:171], v[170:171], v[174:175]
v_pk_add_f32 v[176:177], v[176:177], v[180:181]
v_pk_add_f32 v[178:179], v[178:179], v[182:183]
v_pk_add_f32 v[168:169], v[168:169], v[176:177]
v_pk_add_f32 v[170:171], v[170:171], v[178:179]
s_waitcnt lgkmcnt(0)
v_pk_add_f32 v[184:185], v[184:185], v[188:189]
v_pk_add_f32 v[186:187], v[186:187], v[190:191]
v_pk_add_f32 v[192:193], v[192:193], v[196:197]
v_pk_add_f32 v[194:195], v[194:195], v[198:199]
v_pk_add_f32 v[168:169], v[168:169], v[184:185]
v_pk_add_f32 v[170:171], v[170:171], v[186:187]
v_pk_add_f32 v[168:169], v[168:169], v[192:193]
v_pk_add_f32 v[170:171], v[170:171], v[194:195]
v_cvt_pk_bf16_f32 v144, v168, v169
v_cvt_pk_bf16_f32 v146, v170, v171
ds_write2_b32 v32, v144, v146 offset0:0 offset1:16
s_branch L_bar2b_323
L_help1_225_w0:
v_smfmac_f32_16x16x64_bf16 v[80:83], v[48:51], a[128:135], v6
v_smfmac_f32_16x16x64_bf16 v[84:87], v[48:51], a[160:167], v6
v_smfmac_f32_16x16x64_bf16 v[80:83], v[52:55], a[136:143], v6
v_smfmac_f32_16x16x64_bf16 v[84:87], v[52:55], a[168:175], v6
v_smfmac_f32_16x16x64_bf16 v[80:83], v[56:59], a[144:151], v6
v_smfmac_f32_16x16x64_bf16 v[84:87], v[56:59], a[176:183], v6
v_smfmac_f32_16x16x64_bf16 v[80:83], v[60:63], a[152:159], v6
v_smfmac_f32_16x16x64_bf16 v[84:87], v[60:63], a[184:191], v6
s_nop 4
ds_write_b128 v21, v[80:83]
s_nop 1
ds_write_b128 v21, v[84:87] offset:512
s_barrier
ds_read_b128 v[168:171], v1 offset:2048
ds_read_b128 v[172:175], v1 offset:3072
ds_read_b128 v[176:179], v1 offset:4096
ds_read_b128 v[180:183], v1 offset:5120
ds_read_b128 v[184:187], v1 offset:6144
ds_read_b128 v[188:191], v1 offset:7168
s_waitcnt lgkmcnt(4)
v_pk_add_f32 v[104:105], v[104:105], v[168:169]
v_pk_add_f32 v[106:107], v[106:107], v[170:171]
v_pk_add_f32 v[108:109], v[108:109], v[172:173]
v_pk_add_f32 v[110:111], v[110:111], v[174:175]
s_waitcnt lgkmcnt(2)
v_pk_add_f32 v[104:105], v[104:105], v[176:177]
v_pk_add_f32 v[106:107], v[106:107], v[178:179]
v_pk_add_f32 v[108:109], v[108:109], v[180:181]
v_pk_add_f32 v[110:111], v[110:111], v[182:183]
s_waitcnt lgkmcnt(0)
v_pk_add_f32 v[104:105], v[104:105], v[184:185]
v_pk_add_f32 v[106:107], v[106:107], v[186:187]
v_pk_add_f32 v[108:109], v[108:109], v[188:189]
v_pk_add_f32 v[110:111], v[110:111], v[190:191]
v_cvt_pk_bf16_f32 v112, v104, v105
v_cvt_pk_bf16_f32 v113, v106, v107
v_cvt_pk_bf16_f32 v114, v108, v109
v_cvt_pk_bf16_f32 v115, v110, v111
s_mov_b64 exec, s[28:29]
s_nop 0
v_mfma_f32_16x16x32_bf16 v[132:135], v[112:115], v[112:115], 0
v_mfma_f32_16x16x32_bf16 v[124:127], v[116:119], v[112:115], 0
v_mfma_f32_16x16x32_bf16 v[128:131], v[120:123], v[112:115], 0
s_nop 3
buffer_store_dwordx4 v[132:135], v10, s[8:11], s40 offen sc1
s_mov_b64 exec, s[24:25]
buffer_store_dwordx4 v[124:127], v9, s[8:11], s40 offen sc1
s_nop 0
buffer_store_dwordx4 v[128:131], v9, s[8:11], s40 offen offset:128 sc1
s_mov_b64 exec, -1
ds_write_b128 v1, v[112:115] offset:32768
ds_read_b128 v[136:139], v26 offset:0
ds_read_b128 v[140:143], v26 offset:1024
v_mov_b32_dpp v124, v128 row_shr:8 row_mask:0xf bank_mask:0xc
v_mov_b32_dpp v125, v129 row_shr:8 row_mask:0xf bank_mask:0xc
v_mov_b32_dpp v126, v130 row_shr:8 row_mask:0xf bank_mask:0xc
v_mov_b32_dpp v127, v131 row_shr:8 row_mask:0xf bank_mask:0xc
v_xor_b32 v26, 0x1000, v26
s_cmp_eq_u32 s19, 63
s_cbranch_scc1 L_bar2b_323_2
s_nop 11
buffer_load_dwordx4 v[200:203], v16, s[8:11], s40 offen sc1
buffer_load_dwordx4 v[204:207], v13, s[8:11], s40 offen sc1
buffer_load_dwordx4 v[208:211], v14, s[8:11], s40 offen sc1
buffer_load_dwordx4 v[212:215], v15, s[8:11], s40 offen sc1
s_barrier
s_nop 15
s_nop 13
buffer_load_dwordx4 v[216:219], v16, s[8:11], s40 offen sc1
buffer_load_dwordx4 v[220:223], v13, s[8:11], s40 offen sc1
buffer_load_dwordx4 v[224:227], v14, s[8:11], s40 offen sc1
buffer_load_dwordx4 v[228:231], v15, s[8:11], s40 offen sc1
s_waitcnt vmcnt(7)
v_permlane32_swap_b32 v200, v202
v_permlane32_swap_b32 v201, v203
s_waitcnt vmcnt(6)
v_pk_add_f32 v[154:155], v[200:201], v[202:203]
v_pk_add_f32 v[148:149], v[124:125], v[204:205]
v_pk_add_f32 v[150:151], v[126:127], v[206:207]
v_permlane16_swap_b32 v154, v155
s_waitcnt vmcnt(5)
v_pk_add_f32 v[148:149], v[148:149], v[208:209]
v_pk_add_f32 v[150:151], v[150:151], v[210:211]
v_add_f32 v152, v154, v155
s_waitcnt vmcnt(4)
v_pk_add_f32 v[148:149], v[148:149], v[212:213]
v_pk_add_f32 v[150:151], v[150:151], v[214:215]
v_pk_add_f32 v[154:155], v[148:149], v[150:151]
v_add_f32 v154, v154, v152
v_cmp_u_f32 vcc, v154, v155
v_max3_f32 v154, v148, v149, v150
v_max3_f32 v154, v154, v151, v152
s_nop 1
v_max_f32_dpp v154, v154, v154 row_ror:8 row_mask:0xf bank_mask:0xf
s_cbranch_vccnz L_cf_329
L_chead_331:
v_mov_b32 v156, v154
s_waitcnt lgkmcnt(0)
s_barrier
v_permlane16_swap_b32 v154, v156
v_max_f32 v154, v154, v156
v_mov_b32 v156, v154
ds_read_b32 v144, v32
ds_read_b32 v146, v32 offset:64
v_permlane32_swap_b32 v154, v156
v_max_f32 v154, v154, v156
v_mul_f32 v154, s44, v154
v_fma_f32 v152, v152, s44, -v154
v_exp_f32 v152, v152
v_pk_fma_f32 v[148:149], v[148:149], s[44:45], v[154:155] op_sel_hi:[1,1,0] neg_lo:[0,0,1] neg_hi:[0,0,1]
v_pk_fma_f32 v[150:151], v[150:151], s[44:45], v[154:155] op_sel_hi:[1,1,0] neg_lo:[0,0,1] neg_hi:[0,0,1]
v_mov_b32_dpp v156, v152 row_ror:8 row_mask:0xf bank_mask:0xf
v_exp_f32 v148, v148
v_cvt_pk_bf16_f32 v164, v152, v156
v_exp_f32 v149, v149
v_exp_f32 v150, v150
v_mfma_f32_16x16x16_bf16 v[176:179], v[44:45], v[164:165], 0
v_exp_f32 v151, v151
s_waitcnt lgkmcnt(0)
v_cvt_pk_bf16_f32 v160, v148, v149
v_mfma_f32_16x16x16_bf16 v[168:171], v[144:145], v[164:165], 0
v_cvt_pk_bf16_f32 v161, v150, v151
v_mov_b32_dpp v162, v160 row_ror:8 row_mask:0xf bank_mask:0xf
v_mfma_f32_16x16x16_bf16 v[172:175], v[146:147], v[164:165], 0
v_mov_b32_dpp v163, v161 row_ror:8 row_mask:0xf bank_mask:0xf
s_nop 0
s_mov_b64 exec, s[24:25]
v_mfma_f32_16x16x32_bf16 v[176:179], v[44:47], v[160:163], v[176:179]
v_mfma_f32_16x16x32_bf16 v[168:171], v[136:139], v[160:163], v[168:171]
v_mfma_f32_16x16x32_bf16 v[172:175], v[140:143], v[160:163], v[172:175]
s_nop 3
v_rcp_f32 v176, v176
s_nop 0
v_pk_mul_f32 v[168:169], v[168:169], v[176:177] op_sel_hi:[1,0]
v_pk_mul_f32 v[170:171], v[170:171], v[176:177] op_sel_hi:[1,0]
v_pk_mul_f32 v[172:173], v[172:173], v[176:177] op_sel_hi:[1,0]
v_pk_mul_f32 v[174:175], v[174:175], v[176:177] op_sel_hi:[1,0]
v_cvt_pk_bf16_f32 v180, v168, v169
v_cvt_pk_bf16_f32 v181, v170, v171
v_cvt_pk_bf16_f32 v182, v172, v173
v_cvt_pk_bf16_f32 v183, v174, v175
buffer_store_dwordx4 v[180:183], v11, s[8:11], s41 offen sc1
s_mov_b64 exec, -1
s_barrier
s_nop 15
s_nop 3
s_branch L_bar3_226_e
L_bar3_226:
s_waitcnt lgkmcnt(0)
s_barrier
s_nop 15
s_nop 7
L_bar3_226_e:
buffer_load_dwordx4 v[48:51], v2, s[8:11], s41 offen sc1
v_mov_b32 v64, 0
v_mov_b32 v65, 0
v_mov_b32 v66, 0
v_mov_b32 v67, 0
v_mov_b32 v68, 0
v_mov_b32 v69, 0
v_mov_b32 v70, 0
v_mov_b32 v71, 0
v_mov_b32 v72, 0
v_mov_b32 v73, 0
v_mov_b32 v74, 0
v_mov_b32 v75, 0
buffer_load_dwordx4 v[52:55], v3, s[8:11], s41 offen sc1
v_mov_b32 v76, 0
v_mov_b32 v77, 0
v_mov_b32 v78, 0
v_mov_b32 v79, 0
v_mov_b32 v80, 0
v_mov_b32 v81, 0
v_mov_b32 v82, 0
v_mov_b32 v83, 0
v_mov_b32 v84, 0
v_mov_b32 v85, 0
v_mov_b32 v86, 0
v_mov_b32 v87, 0
buffer_load_dwordx4 v[56:59], v4, s[8:11], s41 offen sc1
s_nop 11
buffer_load_dwordx4 v[60:63], v5, s[8:11], s41 offen sc1
s_waitcnt vmcnt(3)
v_max3_u32 v7, v48, v49, v50
v_max_u32 v7, v7, v51
v_cmp_eq_u32 vcc, s34, v7
s_cbranch_vccnz L_q_e_333
L_v_e_334:
v_smfmac_f32_16x16x64_bf16 v[88:91], v[48:51], a[192:199], v6
s_waitcnt vmcnt(2)
v_max3_u32 v7, v52, v53, v54
v_max_u32 v7, v7, v55
v_cmp_eq_u32 vcc, s34, v7
v_smfmac_f32_16x16x64_bf16 v[92:95], v[48:51], a[224:231], v6
s_cbranch_vccnz L_q_e_335
L_v_e_336:
v_smfmac_f32_16x16x64_bf16 v[88:91], v[52:55], a[200:207], v6
s_waitcnt vmcnt(1)
v_max3_u32 v7, v56, v57, v58
v_max_u32 v7, v7, v59
v_cmp_eq_u32 vcc, s34, v7
v_smfmac_f32_16x16x64_bf16 v[92:95], v[52:55], a[232:239], v6
s_cbranch_vccnz L_q_e_337
L_v_e_338:
v_smfmac_f32_16x16x64_bf16 v[88:91], v[56:59], a[208:215], v6
s_waitcnt vmcnt(0)
v_max3_u32 v7, v60, v61, v62
v_max_u32 v7, v7, v63
v_cmp_eq_u32 vcc, s34, v7
v_smfmac_f32_16x16x64_bf16 v[92:95], v[56:59], a[240:247], v6
s_cbranch_vccnz L_q_e_339
L_v_e_340:
v_smfmac_f32_16x16x64_bf16 v[88:91], v[60:63], a[216:223], v6
v_smfmac_f32_16x16x64_bf16 v[92:95], v[60:63], a[248:255], v6
L_gd_e_332:
s_add_u32 s19, s19, 1
s_cmp_lg_u32 s18, 0
s_nop 2
v_cvt_pk_bf16_f32 v96, v88, v89
v_cvt_pk_bf16_f32 v97, v90, v91
s_nop 0
v_cvt_pk_bf16_f32 v98, v92, v93
v_cvt_pk_bf16_f32 v99, v94, v95
s_nop 1
v_mfma_f32_16x16x32_bf16 v[104:107], v[96:99], v[252:255], 0
s_cbranch_scc1 L_help2_227
s_barrier
ds_read_b128 v[172:175], v1 offset:18432
ds_read_b128 v[176:179], v1 offset:20480
ds_read_b128 v[180:183], v1 offset:22528
s_waitcnt lgkmcnt(2)
v_pk_add_f32 v[168:169], v[104:105], v[172:173]
v_pk_add_f32 v[170:171], v[106:107], v[174:175]
s_waitcnt lgkmcnt(1)
v_pk_add_f32 v[168:169], v[168:169], v[176:177]
v_pk_add_f32 v[170:171], v[170:171], v[178:179]
s_waitcnt lgkmcnt(0)
v_pk_add_f32 v[168:169], v[168:169], v[180:181]
v_pk_add_f32 v[170:171], v[170:171], v[182:183]
v_cvt_pk_bf16_f32 v96, v168, v169
v_cvt_pk_bf16_f32 v97, v170, v171
buffer_store_dwordx2 v[96:97], v12, s[8:11], s42 offen offset:0 sc1
buffer_store_dwordx2 v[96:97], v12, s[8:11], s42 offen offset:512 sc1
s_mov_b32 s22, s42
s_mov_b32 s23, s39
s_and_b32 s20, s19, 3
s_lshl_b32 s21, s20, 16
s_add_u32 s38, s36, s21
s_add_u32 s41, s38, 0x140000
s_lshl_b32 s21, s20, 18
s_add_u32 s40, s37, s21
s_add_u32 s42, s31, 0x8000000
s_add_u32 s21, s19, 1
s_bitcmp1_b32 s21, 1
s_cselect_b32 s31, s52, s35
s_lshl_b32 s21, s21, 20
s_add_u32 s31, s31, s21
s_add_u32 s20, s20, 1
s_and_b32 s20, s20, 3
s_lshl_b32 s20, s20, 16
s_add_u32 s39, s36, s20
s_nop 15
s_nop 15
s_nop 15
buffer_load_dwordx2 v[200:201], v17, s[8:11], s22 offen offset:0 sc1
buffer_load_dwordx2 v[202:203], v18, s[8:11], s22 offen offset:0 sc1
buffer_load_dwordx2 v[204:205], v19, s[8:11], s22 offen offset:0 sc1
s_nop 15
s_nop 15
s_nop 15
s_nop 11
buffer_load_dwordx2 v[212:213], v17, s[8:11], s22 offen offset:512 sc1
buffer_load_dwordx2 v[214:215], v18, s[8:11], s22 offen offset:512 sc1
buffer_load_dwordx2 v[216:217], v19, s[8:11], s22 offen offset:512 sc1
ds_read_b128 v[172:175], v1 offset:33792
s_mov_b64 exec, s[26:27]
s_waitcnt lgkmcnt(1)
buffer_store_dwordx4 v[112:115], v30, s[8:11], s22 offen offset:3072 sc1
s_mov_b64 exec, s[48:49]
s_waitcnt lgkmcnt(0)
buffer_store_dwordx4 v[172:175], v31, s[8:11], s22 offen offset:3584 sc1
s_mov_b64 exec, -1
s_waitcnt vmcnt(7)
v_lshlrev_b32 v100, 16, v200
v_and_b32 v101, 0xffff0000, v200
v_lshlrev_b32 v102, 16, v201
v_and_b32 v103, 0xffff0000, v201
v_pk_add_f32 v[148:149], v[168:169], v[100:101]
v_pk_add_f32 v[150:151], v[170:171], v[102:103]
s_waitcnt vmcnt(6)
v_lshlrev_b32 v100, 16, v202
v_and_b32 v101, 0xffff0000, v202
v_lshlrev_b32 v102, 16, v203
v_and_b32 v103, 0xffff0000, v203
v_pk_add_f32 v[148:149], v[148:149], v[100:101]
v_pk_add_f32 v[150:151], v[150:151], v[102:103]
s_waitcnt vmcnt(5)
v_lshlrev_b32 v100, 16, v204
v_and_b32 v101, 0xffff0000, v204
v_lshlrev_b32 v102, 16, v205
v_and_b32 v103, 0xffff0000, v205
v_pk_add_f32 v[148:149], v[148:149], v[100:101]
v_pk_add_f32 v[150:151], v[150:151], v[102:103]
v_cmp_u_f32 vcc, v148, v150
v_cvt_pk_bf16_f32 v180, v148, v149
v_cvt_pk_bf16_f32 v181, v150, v151
s_cbranch_vccnz L_gf_424
L_gok_425:
buffer_store_dwordx2 v[180:181], v8, s[8:11], s23 offen sc1
s_barrier
s_branch L_step_224
L_help2_227:
s_nop 2
ds_write_b128 v20, v[104:107] offset:16384
s_waitcnt lgkmcnt(0)
s_barrier
s_and_b32 s20, s19, 3
s_lshl_b32 s21, s20, 16
s_add_u32 s38, s36, s21
s_add_u32 s41, s38, 0x140000
s_lshl_b32 s21, s20, 18
s_add_u32 s40, s37, s21
s_add_u32 s42, s31, 0x8000000
s_add_u32 s21, s19, 1
s_bitcmp1_b32 s21, 1
s_cselect_b32 s31, s52, s35
s_lshl_b32 s21, s21, 20
s_add_u32 s31, s31, s21
s_add_u32 s20, s20, 1
s_and_b32 s20, s20, 3
s_lshl_b32 s20, s20, 16
s_add_u32 s39, s36, s20
s_cmp_eq_u32 s18, 3
s_cbranch_scc1 L_w3_428
s_xor_b32 s20, s18, 2
s_or_b32 s20, s20, s16
s_or_b32 s20, s20, s17
s_cbranch_scc1 L_bar4_228
s_cmp_lt_u32 s19, 3
s_cbranch_scc1 L_bar4_228
s_atomic_add s53, s[98:99], 0x4
s_branch L_bar4_228
L_w3_428:
s_or_b32 s20, s16, s17
s_cbranch_scc1 L_bar4_228
s_add_u32 s23, s19, 2
s_min_u32 s23, s23, 63
s_lshl_b32 s21, s23, 7
v_mov_b32 v34, 0
L_dw_429:
s_load_dword s20, s[54:55], s21 glc
s_add_u32 s33, s33, 1
s_cmp_gt_u32 s33, 0x100000
s_waitcnt lgkmcnt(0)
s_cbranch_scc1 chain_kernel_abort
s_cmp_ge_u32 s20, 64
s_cbranch_scc1 L_dwok_430
s_sleep 2
s_branch L_dw_429
L_dwok_430:
L_bar4_228:
s_barrier
s_branch L_step_224
L_fin_229:
s_cmp_lg_u32 s18, 2
s_cbranch_scc1 chain_kernel_done
ds_read_b128 v[168:171], v1 offset:32768
ds_read_b128 v[172:175], v1 offset:33792
s_mov_b64 exec, s[26:27]
s_waitcnt lgkmcnt(1)
buffer_store_dwordx4 v[168:171], v30, s[8:11], s42 offen offset:3072 sc1
s_mov_b64 exec, s[48:49]
s_waitcnt lgkmcnt(0)
buffer_store_dwordx4 v[172:175], v31, s[8:11], s42 offen offset:3584 sc1
s_mov_b64 exec, -1
s_branch chain_kernel_done
L_q_a_237:
buffer_load_dwordx4 v[60:63], v5, s[8:11], s38 offen sc1
s_waitcnt vmcnt(0)
v_max3_u32 v7, v60, v61, v62
v_max_u32 v7, v7, v63
v_cmp_eq_u32 vcc, s34, v7
s_cbranch_vccnz L_q_a_239
s_branch L_v_a_238
L_q_a_239:
buffer_load_dwordx4 v[60:63], v5, s[8:11], s38 offen sc1
s_waitcnt vmcnt(2)
v_max3_u32 v7, v60, v61, v62
v_max_u32 v7, v7, v63
v_cmp_eq_u32 vcc, s34, v7
s_cbranch_vccz L_ok_a_240
s_add_u32 s33, s33, 1
s_cmp_gt_u32 s33, 0x100000
s_cbranch_scc0 L_q_a_239
s_branch chain_kernel_abort
L_ok_a_240:
v_smfmac_f32_16x16x64_bf16 v[64:67], v[60:63], a[24:31], v6
v_smfmac_f32_16x16x64_bf16 v[68:71], v[60:63], a[88:95], v6
v_smfmac_f32_16x16x64_bf16 v[72:75], v[60:63], a[56:63], v6
v_smfmac_f32_16x16x64_bf16 v[76:79], v[60:63], a[120:127], v6
s_branch L_gd_a_230
L_q_a_235:
buffer_load_dwordx4 v[56:59], v4, s[8:11], s38 offen sc1
s_waitcnt vmcnt(1)
v_max3_u32 v7, v60, v61, v62
v_max_u32 v7, v7, v63
v_cmp_eq_u32 vcc, s34, v7
s_cbranch_vccnz L_q_a_241
L_v_a_242:
v_smfmac_f32_16x16x64_bf16 v[64:67], v[60:63], a[24:31], v6
s_waitcnt vmcnt(0)
v_max3_u32 v7, v56, v57, v58
v_max_u32 v7, v7, v59
v_smfmac_f32_16x16x64_bf16 v[68:71], v[60:63], a[88:95], v6
v_cmp_eq_u32 vcc, s34, v7
v_smfmac_f32_16x16x64_bf16 v[72:75], v[60:63], a[56:63], v6
v_smfmac_f32_16x16x64_bf16 v[76:79], v[60:63], a[120:127], v6
s_cbranch_vccnz L_q_a_243
L_v_a_244:
v_smfmac_f32_16x16x64_bf16 v[64:67], v[56:59], a[16:23], v6
v_smfmac_f32_16x16x64_bf16 v[68:71], v[56:59], a[80:87], v6
v_smfmac_f32_16x16x64_bf16 v[72:75], v[56:59], a[48:55], v6
v_smfmac_f32_16x16x64_bf16 v[76:79], v[56:59], a[112:119], v6
s_branch L_gd_a_230
L_q_a_243:
buffer_load_dwordx4 v[56:59], v4, s[8:11], s38 offen sc1
s_waitcnt vmcnt(2)
v_max3_u32 v7, v56, v57, v58
v_max_u32 v7, v7, v59
v_cmp_eq_u32 vcc, s34, v7
s_cbranch_vccz L_ok_a_245
s_add_u32 s33, s33, 1
s_cmp_gt_u32 s33, 0x100000
s_cbranch_scc0 L_q_a_243
s_branch chain_kernel_abort
L_ok_a_245:
v_smfmac_f32_16x16x64_bf16 v[64:67], v[56:59], a[16:23], v6
v_smfmac_f32_16x16x64_bf16 v[68:71], v[56:59], a[80:87], v6
v_smfmac_f32_16x16x64_bf16 v[72:75], v[56:59], a[48:55], v6
v_smfmac_f32_16x16x64_bf16 v[76:79], v[56:59], a[112:119], v6
s_branch L_gd_a_230
L_q_a_241:
buffer_load_dwordx4 v[60:63], v5, s[8:11], s38 offen sc1
s_waitcnt vmcnt(1)
v_max3_u32 v7, v56, v57, v58
v_max_u32 v7, v7, v59
v_cmp_eq_u32 vcc, s34, v7
s_cbranch_vccnz L_q_a_246
L_v_a_247:
v_smfmac_f32_16x16x64_bf16 v[64:67], v[56:59], a[16:23], v6
s_waitcnt vmcnt(0)
v_max3_u32 v7, v60, v61, v62
v_max_u32 v7, v7, v63
v_smfmac_f32_16x16x64_bf16 v[68:71], v[56:59], a[80:87], v6
v_cmp_eq_u32 vcc, s34, v7
v_smfmac_f32_16x16x64_bf16 v[72:75], v[56:59], a[48:55], v6
v_smfmac_f32_16x16x64_bf16 v[76:79], v[56:59], a[112:119], v6
s_cbranch_vccnz L_q_a_239
s_branch L_v_a_238
L_q_a_246:
buffer_load_dwordx4 v[56:59], v4, s[8:11], s38 offen sc1
s_waitcnt vmcnt(2)
v_max3_u32 v7, v60, v61, v62
v_max_u32 v7, v7, v63
v_cmp_eq_u32 vcc, s34, v7
s_cbranch_vccz L_ok_a_248
buffer_load_dwordx4 v[60:63], v5, s[8:11], s38 offen sc1
s_waitcnt vmcnt(2)
v_max3_u32 v7, v56, v57, v58
v_max_u32 v7, v7, v59
v_cmp_eq_u32 vcc, s34, v7
s_cbranch_vccz L_ok_a_249
s_add_u32 s33, s33, 1
s_cmp_gt_u32 s33, 0x100000
s_cbranch_scc0 L_q_a_246
s_branch chain_kernel_abort
L_ok_a_248:
v_smfmac_f32_16x16x64_bf16 v[64:67], v[60:63], a[24:31], v6
v_smfmac_f32_16x16x64_bf16 v[68:71], v[60:63], a[88:95], v6
v_smfmac_f32_16x16x64_bf16 v[72:75], v[60:63], a[56:63], v6
v_smfmac_f32_16x16x64_bf16 v[76:79], v[60:63], a[120:127], v6
s_branch L_q_a_243
L_ok_a_249:
v_smfmac_f32_16x16x64_bf16 v[64:67], v[56:59], a[16:23], v6
v_smfmac_f32_16x16x64_bf16 v[68:71], v[56:59], a[80:87], v6
v_smfmac_f32_16x16x64_bf16 v[72:75], v[56:59], a[48:55], v6
v_smfmac_f32_16x16x64_bf16 v[76:79], v[56:59], a[112:119], v6
s_branch L_q_a_239
L_q_a_233:
buffer_load_dwordx4 v[52:55], v3, s[8:11], s38 offen sc1
s_waitcnt vmcnt(2)
v_max3_u32 v7, v56, v57, v58
v_max_u32 v7, v7, v59
v_cmp_eq_u32 vcc, s34, v7
s_cbranch_vccnz L_q_a_250
L_v_a_251:
v_smfmac_f32_16x16x64_bf16 v[64:67], v[56:59], a[16:23], v6
s_waitcnt vmcnt(1)
v_max3_u32 v7, v60, v61, v62
v_max_u32 v7, v7, v63
v_smfmac_f32_16x16x64_bf16 v[68:71], v[56:59], a[80:87], v6
v_cmp_eq_u32 vcc, s34, v7
v_smfmac_f32_16x16x64_bf16 v[72:75], v[56:59], a[48:55], v6
v_smfmac_f32_16x16x64_bf16 v[76:79], v[56:59], a[112:119], v6
s_cbranch_vccnz L_q_a_252
L_v_a_253:
v_smfmac_f32_16x16x64_bf16 v[64:67], v[60:63], a[24:31], v6
s_waitcnt vmcnt(0)
v_max3_u32 v7, v52, v53, v54
v_max_u32 v7, v7, v55
v_smfmac_f32_16x16x64_bf16 v[68:71], v[60:63], a[88:95], v6
v_cmp_eq_u32 vcc, s34, v7
v_smfmac_f32_16x16x64_bf16 v[72:75], v[60:63], a[56:63], v6
v_smfmac_f32_16x16x64_bf16 v[76:79], v[60:63], a[120:127], v6
s_cbranch_vccnz L_q_a_254
L_v_a_255:
v_smfmac_f32_16x16x64_bf16 v[64:67], v[52:55], a[8:15], v6
v_smfmac_f32_16x16x64_bf16 v[68:71], v[52:55], a[72:79], v6
v_smfmac_f32_16x16x64_bf16 v[72:75], v[52:55], a[40:47], v6
v_smfmac_f32_16x16x64_bf16 v[76:79], v[52:55], a[104:111], v6
s_branch L_gd_a_230
L_q_a_254:
buffer_load_dwordx4 v[52:55], v3, s[8:11], s38 offen sc1
s_waitcnt vmcnt(2)
v_max3_u32 v7, v52, v53, v54
v_max_u32 v7, v7, v55
v_cmp_eq_u32 vcc, s34, v7
s_cbranch_vccz L_ok_a_256
s_add_u32 s33, s33, 1
s_cmp_gt_u32 s33, 0x100000
s_cbranch_scc0 L_q_a_254
s_branch chain_kernel_abort
L_ok_a_256:
v_smfmac_f32_16x16x64_bf16 v[64:67], v[52:55], a[8:15], v6
v_smfmac_f32_16x16x64_bf16 v[68:71], v[52:55], a[72:79], v6
v_smfmac_f32_16x16x64_bf16 v[72:75], v[52:55], a[40:47], v6
v_smfmac_f32_16x16x64_bf16 v[76:79], v[52:55], a[104:111], v6
s_branch L_gd_a_230
L_q_a_252:
buffer_load_dwordx4 v[60:63], v5, s[8:11], s38 offen sc1
s_waitcnt vmcnt(1)
v_max3_u32 v7, v52, v53, v54
v_max_u32 v7, v7, v55
v_cmp_eq_u32 vcc, s34, v7
s_cbranch_vccnz L_q_a_257
L_v_a_258:
v_smfmac_f32_16x16x64_bf16 v[64:67], v[52:55], a[8:15], v6
s_waitcnt vmcnt(0)
v_max3_u32 v7, v60, v61, v62
v_max_u32 v7, v7, v63
v_smfmac_f32_16x16x64_bf16 v[68:71], v[52:55], a[72:79], v6
v_cmp_eq_u32 vcc, s34, v7
v_smfmac_f32_16x16x64_bf16 v[72:75], v[52:55], a[40:47], v6
v_smfmac_f32_16x16x64_bf16 v[76:79], v[52:55], a[104:111], v6
s_cbranch_vccnz L_q_a_239
s_branch L_v_a_238
L_q_a_257:
buffer_load_dwordx4 v[52:55], v3, s[8:11], s38 offen sc1
s_waitcnt vmcnt(2)
v_max3_u32 v7, v60, v61, v62
v_max_u32 v7, v7, v63
v_cmp_eq_u32 vcc, s34, v7
s_cbranch_vccz L_ok_a_259
buffer_load_dwordx4 v[60:63], v5, s[8:11], s38 offen sc1
s_waitcnt vmcnt(2)
v_max3_u32 v7, v52, v53, v54
v_max_u32 v7, v7, v55
v_cmp_eq_u32 vcc, s34, v7
s_cbranch_vccz L_ok_a_260
s_add_u32 s33, s33, 1
s_cmp_gt_u32 s33, 0x100000
s_cbranch_scc0 L_q_a_257
s_branch chain_kernel_abort
L_ok_a_259:
v_smfmac_f32_16x16x64_bf16 v[64:67], v[60:63], a[24:31], v6
v_smfmac_f32_16x16x64_bf16 v[68:71], v[60:63], a[88:95], v6
v_smfmac_f32_16x16x64_bf16 v[72:75], v[60:63], a[56:63], v6
v_smfmac_f32_16x16x64_bf16 v[76:79], v[60:63], a[120:127], v6
s_branch L_q_a_254
L_ok_a_260:
v_smfmac_f32_16x16x64_bf16 v[64:67], v[52:55], a[8:15], v6
v_smfmac_f32_16x16x64_bf16 v[68:71], v[52:55], a[72:79], v6
v_smfmac_f32_16x16x64_bf16 v[72:75], v[52:55], a[40:47], v6
v_smfmac_f32_16x16x64_bf16 v[76:79], v[52:55], a[104:111], v6
s_branch L_q_a_239
L_q_a_250:
buffer_load_dwordx4 v[56:59], v4, s[8:11], s38 offen sc1
s_waitcnt vmcnt(2)
v_max3_u32 v7, v60, v61, v62
v_max_u32 v7, v7, v63
v_cmp_eq_u32 vcc, s34, v7
s_cbranch_vccnz L_q_a_261
L_v_a_262:
v_smfmac_f32_16x16x64_bf16 v[64:67], v[60:63], a[24:31], v6
s_waitcnt vmcnt(1)
v_max3_u32 v7, v52, v53, v54
v_max_u32 v7, v7, v55
v_smfmac_f32_16x16x64_bf16 v[68:71], v[60:63], a[88:95], v6
v_cmp_eq_u32 vcc, s34, v7
v_smfmac_f32_16x16x64_bf16 v[72:75], v[60:63], a[56:63], v6
v_smfmac_f32_16x16x64_bf16 v[76:79], v[60:63], a[120:127], v6
s_cbranch_vccnz L_q_a_263
L_v_a_264:
v_smfmac_f32_16x16x64_bf16 v[64:67], v[52:55], a[8:15], v6
s_waitcnt vmcnt(0)
v_max3_u32 v7, v56, v57, v58
v_max_u32 v7, v7, v59
v_smfmac_f32_16x16x64_bf16 v[68:71], v[52:55], a[72:79], v6
v_cmp_eq_u32 vcc, s34, v7
v_smfmac_f32_16x16x64_bf16 v[72:75], v[52:55], a[40:47], v6
v_smfmac_f32_16x16x64_bf16 v[76:79], v[52:55], a[104:111], v6
s_cbranch_vccnz L_q_a_243
s_branch L_v_a_244
L_q_a_263:
buffer_load_dwordx4 v[52:55], v3, s[8:11], s38 offen sc1
s_waitcnt vmcnt(2)
v_max3_u32 v7, v56, v57, v58
v_max_u32 v7, v7, v59
v_cmp_eq_u32 vcc, s34, v7
s_cbranch_vccz L_ok_a_265
buffer_load_dwordx4 v[56:59], v4, s[8:11], s38 offen sc1
s_waitcnt vmcnt(2)
v_max3_u32 v7, v52, v53, v54
v_max_u32 v7, v7, v55
v_cmp_eq_u32 vcc, s34, v7
s_cbranch_vccz L_ok_a_266
s_add_u32 s33, s33, 1
s_cmp_gt_u32 s33, 0x100000
s_cbranch_scc0 L_q_a_263
s_branch chain_kernel_abort
L_ok_a_265:
v_smfmac_f32_16x16x64_bf16 v[64:67], v[56:59], a[16:23], v6
v_smfmac_f32_16x16x64_bf16 v[68:71], v[56:59], a[80:87], v6
v_smfmac_f32_16x16x64_bf16 v[72:75], v[56:59], a[48:55], v6
v_smfmac_f32_16x16x64_bf16 v[76:79], v[56:59], a[112:119], v6
s_branch L_q_a_254
L_ok_a_266:
v_smfmac_f32_16x16x64_bf16 v[64:67], v[52:55], a[8:15], v6
v_smfmac_f32_16x16x64_bf16 v[68:71], v[52:55], a[72:79], v6
v_smfmac_f32_16x16x64_bf16 v[72:75], v[52:55], a[40:47], v6
v_smfmac_f32_16x16x64_bf16 v[76:79], v[52:55], a[104:111], v6
s_branch L_q_a_243
L_q_a_261:
buffer_load_dwordx4 v[60:63], v5, s[8:11], s38 offen sc1
s_waitcnt vmcnt(2)
v_max3_u32 v7, v52, v53, v54
v_max_u32 v7, v7, v55
v_cmp_eq_u32 vcc, s34, v7
s_cbranch_vccnz L_q_a_267
L_v_a_268:
v_smfmac_f32_16x16x64_bf16 v[64:67], v[52:55], a[8:15], v6
s_waitcnt vmcnt(1)
v_max3_u32 v7, v56, v57, v58
v_max_u32 v7, v7, v59
v_smfmac_f32_16x16x64_bf16 v[68:71], v[52:55], a[72:79], v6
v_cmp_eq_u32 vcc, s34, v7
v_smfmac_f32_16x16x64_bf16 v[72:75], v[52:55], a[40:47], v6
v_smfmac_f32_16x16x64_bf16 v[76:79], v[52:55], a[104:111], v6
s_cbranch_vccnz L_q_a_246
s_branch L_v_a_247
L_q_a_267:
buffer_load_dwordx4 v[52:55], v3, s[8:11], s38 offen sc1
s_waitcnt vmcnt(2)
v_max3_u32 v7, v56, v57, v58
v_max_u32 v7, v7, v59
v_cmp_eq_u32 vcc, s34, v7
s_cbranch_vccz L_ok_a_269
buffer_load_dwordx4 v[56:59], v4, s[8:11], s38 offen sc1
s_waitcnt vmcnt(2)
v_max3_u32 v7, v60, v61, v62
v_max_u32 v7, v7, v63
v_cmp_eq_u32 vcc, s34, v7
s_cbranch_vccz L_ok_a_270
buffer_load_dwordx4 v[60:63], v5, s[8:11], s38 offen sc1
s_waitcnt vmcnt(2)
v_max3_u32 v7, v52, v53, v54
v_max_u32 v7, v7, v55
v_cmp_eq_u32 vcc, s34, v7
s_cbranch_vccz L_ok_a_271
s_add_u32 s33, s33, 1
s_cmp_gt_u32 s33, 0x100000
s_cbranch_scc0 L_q_a_267
s_branch chain_kernel_abort
L_ok_a_269:
v_smfmac_f32_16x16x64_bf16 v[64:67], v[56:59], a[16:23], v6
v_smfmac_f32_16x16x64_bf16 v[68:71], v[56:59], a[80:87], v6
v_smfmac_f32_16x16x64_bf16 v[72:75], v[56:59], a[48:55], v6
v_smfmac_f32_16x16x64_bf16 v[76:79], v[56:59], a[112:119], v6
s_branch L_q_a_257
L_ok_a_270:
v_smfmac_f32_16x16x64_bf16 v[64:67], v[60:63], a[24:31], v6
v_smfmac_f32_16x16x64_bf16 v[68:71], v[60:63], a[88:95], v6
v_smfmac_f32_16x16x64_bf16 v[72:75], v[60:63], a[56:63], v6
v_smfmac_f32_16x16x64_bf16 v[76:79], v[60:63], a[120:127], v6
s_branch L_q_a_263
L_ok_a_271:
v_smfmac_f32_16x16x64_bf16 v[64:67], v[52:55], a[8:15], v6
v_smfmac_f32_16x16x64_bf16 v[68:71], v[52:55], a[72:79], v6
v_smfmac_f32_16x16x64_bf16 v[72:75], v[52:55], a[40:47], v6
v_smfmac_f32_16x16x64_bf16 v[76:79], v[52:55], a[104:111], v6
s_branch L_q_a_246
L_q_a_231:
buffer_load_dwordx4 v[48:51], v2, s[8:11], s38 offen sc1
s_waitcnt vmcnt(3)
v_max3_u32 v7, v52, v53, v54
v_max_u32 v7, v7, v55
v_cmp_eq_u32 vcc, s34, v7
s_cbranch_vccnz L_q_a_272
L_v_a_273:
v_smfmac_f32_16x16x64_bf16 v[64:67], v[52:55], a[8:15], v6
s_waitcnt vmcnt(2)
v_max3_u32 v7, v56, v57, v58
v_max_u32 v7, v7, v59
v_smfmac_f32_16x16x64_bf16 v[68:71], v[52:55], a[72:79], v6
v_cmp_eq_u32 vcc, s34, v7
v_smfmac_f32_16x16x64_bf16 v[72:75], v[52:55], a[40:47], v6
v_smfmac_f32_16x16x64_bf16 v[76:79], v[52:55], a[104:111], v6
s_cbranch_vccnz L_q_a_274
L_v_a_275:
v_smfmac_f32_16x16x64_bf16 v[64:67], v[56:59], a[16:23], v6
s_waitcnt vmcnt(1)
v_max3_u32 v7, v60, v61, v62
v_max_u32 v7, v7, v63
v_smfmac_f32_16x16x64_bf16 v[68:71], v[56:59], a[80:87], v6
v_cmp_eq_u32 vcc, s34, v7
v_smfmac_f32_16x16x64_bf16 v[72:75], v[56:59], a[48:55], v6
v_smfmac_f32_16x16x64_bf16 v[76:79], v[56:59], a[112:119], v6
s_cbranch_vccnz L_q_a_276
L_v_a_277:
v_smfmac_f32_16x16x64_bf16 v[64:67], v[60:63], a[24:31], v6
s_waitcnt vmcnt(0)
v_max3_u32 v7, v48, v49, v50
v_max_u32 v7, v7, v51
v_smfmac_f32_16x16x64_bf16 v[68:71], v[60:63], a[88:95], v6
v_cmp_eq_u32 vcc, s34, v7
v_smfmac_f32_16x16x64_bf16 v[72:75], v[60:63], a[56:63], v6
v_smfmac_f32_16x16x64_bf16 v[76:79], v[60:63], a[120:127], v6
s_cbranch_vccnz L_q_a_278
L_v_a_279:
v_smfmac_f32_16x16x64_bf16 v[64:67], v[48:51], a[0:7], v6
v_smfmac_f32_16x16x64_bf16 v[68:71], v[48:51], a[64:71], v6
v_smfmac_f32_16x16x64_bf16 v[72:75], v[48:51], a[32:39], v6
v_smfmac_f32_16x16x64_bf16 v[76:79], v[48:51], a[96:103], v6
s_branch L_gd_a_230
L_q_a_278:
buffer_load_dwordx4 v[48:51], v2, s[8:11], s38 offen sc1
s_waitcnt vmcnt(2)
v_max3_u32 v7, v48, v49, v50
v_max_u32 v7, v7, v51
v_cmp_eq_u32 vcc, s34, v7
s_cbranch_vccz L_ok_a_280
s_add_u32 s33, s33, 1
s_cmp_gt_u32 s33, 0x100000
s_cbranch_scc0 L_q_a_278
s_branch chain_kernel_abort
L_ok_a_280:
v_smfmac_f32_16x16x64_bf16 v[64:67], v[48:51], a[0:7], v6
v_smfmac_f32_16x16x64_bf16 v[68:71], v[48:51], a[64:71], v6
v_smfmac_f32_16x16x64_bf16 v[72:75], v[48:51], a[32:39], v6
v_smfmac_f32_16x16x64_bf16 v[76:79], v[48:51], a[96:103], v6
s_branch L_gd_a_230
L_q_a_276:
buffer_load_dwordx4 v[60:63], v5, s[8:11], s38 offen sc1
s_waitcnt vmcnt(1)
v_max3_u32 v7, v48, v49, v50
v_max_u32 v7, v7, v51
v_cmp_eq_u32 vcc, s34, v7
s_cbranch_vccnz L_q_a_281
L_v_a_282:
v_smfmac_f32_16x16x64_bf16 v[64:67], v[48:51], a[0:7], v6
s_waitcnt vmcnt(0)
v_max3_u32 v7, v60, v61, v62
v_max_u32 v7, v7, v63
v_smfmac_f32_16x16x64_bf16 v[68:71], v[48:51], a[64:71], v6
v_cmp_eq_u32 vcc, s34, v7
v_smfmac_f32_16x16x64_bf16 v[72:75], v[48:51], a[32:39], v6
v_smfmac_f32_16x16x64_bf16 v[76:79], v[48:51], a[96:103], v6
s_cbranch_vccnz L_q_a_239
s_branch L_v_a_238
L_q_a_281:
buffer_load_dwordx4 v[48:51], v2, s[8:11], s38 offen sc1
s_waitcnt vmcnt(2)
v_max3_u32 v7, v60, v61, v62
v_max_u32 v7, v7, v63
v_cmp_eq_u32 vcc, s34, v7
s_cbranch_vccz L_ok_a_283
buffer_load_dwordx4 v[60:63], v5, s[8:11], s38 offen sc1
s_waitcnt vmcnt(2)
v_max3_u32 v7, v48, v49, v50
v_max_u32 v7, v7, v51
v_cmp_eq_u32 vcc, s34, v7
s_cbranch_vccz L_ok_a_284
s_add_u32 s33, s33, 1
s_cmp_gt_u32 s33, 0x100000
s_cbranch_scc0 L_q_a_281
s_branch chain_kernel_abort
L_ok_a_283:
v_smfmac_f32_16x16x64_bf16 v[64:67], v[60:63], a[24:31], v6
v_smfmac_f32_16x16x64_bf16 v[68:71], v[60:63], a[88:95], v6
v_smfmac_f32_16x16x64_bf16 v[72:75], v[60:63], a[56:63], v6
v_smfmac_f32_16x16x64_bf16 v[76:79], v[60:63], a[120:127], v6
s_branch L_q_a_278
L_ok_a_284:
v_smfmac_f32_16x16x64_bf16 v[64:67], v[48:51], a[0:7], v6
v_smfmac_f32_16x16x64_bf16 v[68:71], v[48:51], a[64:71], v6
v_smfmac_f32_16x16x64_bf16 v[72:75], v[48:51], a[32:39], v6
v_smfmac_f32_16x16x64_bf16 v[76:79], v[48:51], a[96:103], v6
s_branch L_q_a_239
L_q_a_274:
buffer_load_dwordx4 v[56:59], v4, s[8:11], s38 offen sc1
s_waitcnt vmcnt(2)
v_max3_u32 v7, v60, v61, v62
v_max_u32 v7, v7, v63
v_cmp_eq_u32 vcc, s34, v7
s_cbranch_vccnz L_q_a_285
L_v_a_286:
v_smfmac_f32_16x16x64_bf16 v[64:67], v[60:63], a[24:31], v6
s_waitcnt vmcnt(1)
v_max3_u32 v7, v48, v49, v50
v_max_u32 v7, v7, v51
v_smfmac_f32_16x16x64_bf16 v[68:71], v[60:63], a[88:95], v6
v_cmp_eq_u32 vcc, s34, v7
v_smfmac_f32_16x16x64_bf16 v[72:75], v[60:63], a[56:63], v6
v_smfmac_f32_16x16x64_bf16 v[76:79], v[60:63], a[120:127], v6
s_cbranch_vccnz L_q_a_287
L_v_a_288:
v_smfmac_f32_16x16x64_bf16 v[64:67], v[48:51], a[0:7], v6
s_waitcnt vmcnt(0)
v_max3_u32 v7, v56, v57, v58
v_max_u32 v7, v7, v59
v_smfmac_f32_16x16x64_bf16 v[68:71], v[48:51], a[64:71], v6
v_cmp_eq_u32 vcc, s34, v7
v_smfmac_f32_16x16x64_bf16 v[72:75], v[48:51], a[32:39], v6
v_smfmac_f32_16x16x64_bf16 v[76:79], v[48:51], a[96:103], v6
s_cbranch_vccnz L_q_a_243
s_branch L_v_a_244
L_q_a_287:
buffer_load_dwordx4 v[48:51], v2, s[8:11], s38 offen sc1
s_waitcnt vmcnt(2)
v_max3_u32 v7, v56, v57, v58
v_max_u32 v7, v7, v59
v_cmp_eq_u32 vcc, s34, v7
s_cbranch_vccz L_ok_a_289
buffer_load_dwordx4 v[56:59], v4, s[8:11], s38 offen sc1
s_waitcnt vmcnt(2)
v_max3_u32 v7, v48, v49, v50
v_max_u32 v7, v7, v51
v_cmp_eq_u32 vcc, s34, v7
s_cbranch_vccz L_ok_a_290
s_add_u32 s33, s33, 1
s_cmp_gt_u32 s33, 0x100000
s_cbranch_scc0 L_q_a_287
s_branch chain_kernel_abort
L_ok_a_289:
v_smfmac_f32_16x16x64_bf16 v[64:67], v[56:59], a[16:23], v6
v_smfmac_f32_16x16x64_bf16 v[68:71], v[56:59], a[80:87], v6
v_smfmac_f32_16x16x64_bf16 v[72:75], v[56:59], a[48:55], v6
v_smfmac_f32_16x16x64_bf16 v[76:79], v[56:59], a[112:119], v6
s_branch L_q_a_278
L_ok_a_290:
v_smfmac_f32_16x16x64_bf16 v[64:67], v[48:51], a[0:7], v6
v_smfmac_f32_16x16x64_bf16 v[68:71], v[48:51], a[64:71], v6
v_smfmac_f32_16x16x64_bf16 v[72:75], v[48:51], a[32:39], v6
v_smfmac_f32_16x16x64_bf16 v[76:79], v[48:51], a[96:103], v6
s_branch L_q_a_243
L_q_a_285:
buffer_load_dwordx4 v[60:63], v5, s[8:11], s38 offen sc1
s_waitcnt vmcnt(2)
v_max3_u32 v7, v48, v49, v50
v_max_u32 v7, v7, v51
v_cmp_eq_u32 vcc, s34, v7
s_cbranch_vccnz L_q_a_291
L_v_a_292:
v_smfmac_f32_16x16x64_bf16 v[64:67], v[48:51], a[0:7], v6
s_waitcnt vmcnt(1)
v_max3_u32 v7, v56, v57, v58
v_max_u32 v7, v7, v59
v_smfmac_f32_16x16x64_bf16 v[68:71], v[48:51], a[64:71], v6
v_cmp_eq_u32 vcc, s34, v7
v_smfmac_f32_16x16x64_bf16 v[72:75], v[48:51], a[32:39], v6
v_smfmac_f32_16x16x64_bf16 v[76:79], v[48:51], a[96:103], v6
s_cbranch_vccnz L_q_a_246
s_branch L_v_a_247
L_q_a_291:
buffer_load_dwordx4 v[48:51], v2, s[8:11], s38 offen sc1
s_waitcnt vmcnt(2)
v_max3_u32 v7, v56, v57, v58
v_max_u32 v7, v7, v59
v_cmp_eq_u32 vcc, s34, v7
s_cbranch_vccz L_ok_a_293
buffer_load_dwordx4 v[56:59], v4, s[8:11], s38 offen sc1
s_waitcnt vmcnt(2)
v_max3_u32 v7, v60, v61, v62
v_max_u32 v7, v7, v63
v_cmp_eq_u32 vcc, s34, v7
s_cbranch_vccz L_ok_a_294
buffer_load_dwordx4 v[60:63], v5, s[8:11], s38 offen sc1
s_waitcnt vmcnt(2)
v_max3_u32 v7, v48, v49, v50
v_max_u32 v7, v7, v51
v_cmp_eq_u32 vcc, s34, v7
s_cbranch_vccz L_ok_a_295
s_add_u32 s33, s33, 1
s_cmp_gt_u32 s33, 0x100000
s_cbranch_scc0 L_q_a_291
s_branch chain_kernel_abort
L_ok_a_293:
v_smfmac_f32_16x16x64_bf16 v[64:67], v[56:59], a[16:23], v6
v_smfmac_f32_16x16x64_bf16 v[68:71], v[56:59], a[80:87], v6
v_smfmac_f32_16x16x64_bf16 v[72:75], v[56:59], a[48:55], v6
v_smfmac_f32_16x16x64_bf16 v[76:79], v[56:59], a[112:119], v6
s_branch L_q_a_281
L_ok_a_294:
v_smfmac_f32_16x16x64_bf16 v[64:67], v[60:63], a[24:31], v6
v_smfmac_f32_16x16x64_bf16 v[68:71], v[60:63], a[88:95], v6
v_smfmac_f32_16x16x64_bf16 v[72:75], v[60:63], a[56:63], v6
v_smfmac_f32_16x16x64_bf16 v[76:79], v[60:63], a[120:127], v6
s_branch L_q_a_287
L_ok_a_295:
v_smfmac_f32_16x16x64_bf16 v[64:67], v[48:51], a[0:7], v6
v_smfmac_f32_16x16x64_bf16 v[68:71], v[48:51], a[64:71], v6
v_smfmac_f32_16x16x64_bf16 v[72:75], v[48:51], a[32:39], v6
v_smfmac_f32_16x16x64_bf16 v[76:79], v[48:51], a[96:103], v6
s_branch L_q_a_246
L_q_a_272:
buffer_load_dwordx4 v[52:55], v3, s[8:11], s38 offen sc1
s_waitcnt vmcnt(3)
v_max3_u32 v7, v56, v57, v58
v_max_u32 v7, v7, v59
v_cmp_eq_u32 vcc, s34, v7
s_cbranch_vccnz L_q_a_296
L_v_a_297:
v_smfmac_f32_16x16x64_bf16 v[64:67], v[56:59], a[16:23], v6
s_waitcnt vmcnt(2)
v_max3_u32 v7, v60, v61, v62
v_max_u32 v7, v7, v63
v_smfmac_f32_16x16x64_bf16 v[68:71], v[56:59], a[80:87], v6
v_cmp_eq_u32 vcc, s34, v7
v_smfmac_f32_16x16x64_bf16 v[72:75], v[56:59], a[48:55], v6
v_smfmac_f32_16x16x64_bf16 v[76:79], v[56:59], a[112:119], v6
s_cbranch_vccnz L_q_a_298
L_v_a_299:
v_smfmac_f32_16x16x64_bf16 v[64:67], v[60:63], a[24:31], v6
s_waitcnt vmcnt(1)
v_max3_u32 v7, v48, v49, v50
v_max_u32 v7, v7, v51
v_smfmac_f32_16x16x64_bf16 v[68:71], v[60:63], a[88:95], v6
v_cmp_eq_u32 vcc, s34, v7
v_smfmac_f32_16x16x64_bf16 v[72:75], v[60:63], a[56:63], v6
v_smfmac_f32_16x16x64_bf16 v[76:79], v[60:63], a[120:127], v6
s_cbranch_vccnz L_q_a_300
L_v_a_301:
v_smfmac_f32_16x16x64_bf16 v[64:67], v[48:51], a[0:7], v6
s_waitcnt vmcnt(0)
v_max3_u32 v7, v52, v53, v54
v_max_u32 v7, v7, v55
v_smfmac_f32_16x16x64_bf16 v[68:71], v[48:51], a[64:71], v6
v_cmp_eq_u32 vcc, s34, v7
v_smfmac_f32_16x16x64_bf16 v[72:75], v[48:51], a[32:39], v6
v_smfmac_f32_16x16x64_bf16 v[76:79], v[48:51], a[96:103], v6
s_cbranch_vccnz L_q_a_254
s_branch L_v_a_255
L_q_a_300:
buffer_load_dwordx4 v[48:51], v2, s[8:11], s38 offen sc1
s_waitcnt vmcnt(2)
v_max3_u32 v7, v52, v53, v54
v_max_u32 v7, v7, v55
v_cmp_eq_u32 vcc, s34, v7
s_cbranch_vccz L_ok_a_302
buffer_load_dwordx4 v[52:55], v3, s[8:11], s38 offen sc1
s_waitcnt vmcnt(2)
v_max3_u32 v7, v48, v49, v50
v_max_u32 v7, v7, v51
v_cmp_eq_u32 vcc, s34, v7
s_cbranch_vccz L_ok_a_303
s_add_u32 s33, s33, 1
s_cmp_gt_u32 s33, 0x100000
s_cbranch_scc0 L_q_a_300
s_branch chain_kernel_abort
L_ok_a_302:
v_smfmac_f32_16x16x64_bf16 v[64:67], v[52:55], a[8:15], v6
v_smfmac_f32_16x16x64_bf16 v[68:71], v[52:55], a[72:79], v6
v_smfmac_f32_16x16x64_bf16 v[72:75], v[52:55], a[40:47], v6
v_smfmac_f32_16x16x64_bf16 v[76:79], v[52:55], a[104:111], v6
s_branch L_q_a_278
L_ok_a_303:
v_smfmac_f32_16x16x64_bf16 v[64:67], v[48:51], a[0:7], v6
v_smfmac_f32_16x16x64_bf16 v[68:71], v[48:51], a[64:71], v6
v_smfmac_f32_16x16x64_bf16 v[72:75], v[48:51], a[32:39], v6
v_smfmac_f32_16x16x64_bf16 v[76:79], v[48:51], a[96:103], v6
s_branch L_q_a_254
L_q_a_298:
buffer_load_dwordx4 v[60:63], v5, s[8:11], s38 offen sc1
s_waitcnt vmcnt(2)
v_max3_u32 v7, v48, v49, v50
v_max_u32 v7, v7, v51
v_cmp_eq_u32 vcc, s34, v7
s_cbranch_vccnz L_q_a_304
L_v_a_305:
v_smfmac_f32_16x16x64_bf16 v[64:67], v[48:51], a[0:7], v6
s_waitcnt vmcnt(1)
v_max3_u32 v7, v52, v53, v54
v_max_u32 v7, v7, v55
v_smfmac_f32_16x16x64_bf16 v[68:71], v[48:51], a[64:71], v6
v_cmp_eq_u32 vcc, s34, v7
v_smfmac_f32_16x16x64_bf16 v[72:75], v[48:51], a[32:39], v6
v_smfmac_f32_16x16x64_bf16 v[76:79], v[48:51], a[96:103], v6
s_cbranch_vccnz L_q_a_257
s_branch L_v_a_258
L_q_a_304:
buffer_load_dwordx4 v[48:51], v2, s[8:11], s38 offen sc1
s_waitcnt vmcnt(2)
v_max3_u32 v7, v52, v53, v54
v_max_u32 v7, v7, v55
v_cmp_eq_u32 vcc, s34, v7
s_cbranch_vccz L_ok_a_306
buffer_load_dwordx4 v[52:55], v3, s[8:11], s38 offen sc1
s_waitcnt vmcnt(2)
v_max3_u32 v7, v60, v61, v62
v_max_u32 v7, v7, v63
v_cmp_eq_u32 vcc, s34, v7
s_cbranch_vccz L_ok_a_307
buffer_load_dwordx4 v[60:63], v5, s[8:11], s38 offen sc1
s_waitcnt vmcnt(2)
v_max3_u32 v7, v48, v49, v50
v_max_u32 v7, v7, v51
v_cmp_eq_u32 vcc, s34, v7
s_cbranch_vccz L_ok_a_308
s_add_u32 s33, s33, 1
s_cmp_gt_u32 s33, 0x100000
s_cbranch_scc0 L_q_a_304
s_branch chain_kernel_abort
L_ok_a_306:
v_smfmac_f32_16x16x64_bf16 v[64:67], v[52:55], a[8:15], v6
v_smfmac_f32_16x16x64_bf16 v[68:71], v[52:55], a[72:79], v6
v_smfmac_f32_16x16x64_bf16 v[72:75], v[52:55], a[40:47], v6
v_smfmac_f32_16x16x64_bf16 v[76:79], v[52:55], a[104:111], v6
s_branch L_q_a_281
L_ok_a_307:
v_smfmac_f32_16x16x64_bf16 v[64:67], v[60:63], a[24:31], v6
v_smfmac_f32_16x16x64_bf16 v[68:71], v[60:63], a[88:95], v6
v_smfmac_f32_16x16x64_bf16 v[72:75], v[60:63], a[56:63], v6
v_smfmac_f32_16x16x64_bf16 v[76:79], v[60:63], a[120:127], v6
s_branch L_q_a_300
L_ok_a_308:
v_smfmac_f32_16x16x64_bf16 v[64:67], v[48:51], a[0:7], v6
v_smfmac_f32_16x16x64_bf16 v[68:71], v[48:51], a[64:71], v6
v_smfmac_f32_16x16x64_bf16 v[72:75], v[48:51], a[32:39], v6
v_smfmac_f32_16x16x64_bf16 v[76:79], v[48:51], a[96:103], v6
s_branch L_q_a_257
L_q_a_296:
buffer_load_dwordx4 v[56:59], v4, s[8:11], s38 offen sc1
s_waitcnt vmcnt(3)
v_max3_u32 v7, v60, v61, v62
v_max_u32 v7, v7, v63
v_cmp_eq_u32 vcc, s34, v7
s_cbranch_vccnz L_q_a_309
L_v_a_310:
v_smfmac_f32_16x16x64_bf16 v[64:67], v[60:63], a[24:31], v6
s_waitcnt vmcnt(2)
v_max3_u32 v7, v48, v49, v50
v_max_u32 v7, v7, v51
v_smfmac_f32_16x16x64_bf16 v[68:71], v[60:63], a[88:95], v6
v_cmp_eq_u32 vcc, s34, v7
v_smfmac_f32_16x16x64_bf16 v[72:75], v[60:63], a[56:63], v6
v_smfmac_f32_16x16x64_bf16 v[76:79], v[60:63], a[120:127], v6
s_cbranch_vccnz L_q_a_311
L_v_a_312:
v_smfmac_f32_16x16x64_bf16 v[64:67], v[48:51], a[0:7], v6
s_waitcnt vmcnt(1)
v_max3_u32 v7, v52, v53, v54
v_max_u32 v7, v7, v55
v_smfmac_f32_16x16x64_bf16 v[68:71], v[48:51], a[64:71], v6
v_cmp_eq_u32 vcc, s34, v7
v_smfmac_f32_16x16x64_bf16 v[72:75], v[48:51], a[32:39], v6
v_smfmac_f32_16x16x64_bf16 v[76:79], v[48:51], a[96:103], v6
s_cbranch_vccnz L_q_a_263
s_branch L_v_a_264
L_q_a_311:
buffer_load_dwordx4 v[48:51], v2, s[8:11], s38 offen sc1
s_waitcnt vmcnt(2)
v_max3_u32 v7, v52, v53, v54
v_max_u32 v7, v7, v55
v_cmp_eq_u32 vcc, s34, v7
s_cbranch_vccz L_ok_a_313
buffer_load_dwordx4 v[52:55], v3, s[8:11], s38 offen sc1
s_waitcnt vmcnt(2)
v_max3_u32 v7, v56, v57, v58
v_max_u32 v7, v7, v59
v_cmp_eq_u32 vcc, s34, v7
s_cbranch_vccz L_ok_a_314
buffer_load_dwordx4 v[56:59], v4, s[8:11], s38 offen sc1
s_waitcnt vmcnt(2)
v_max3_u32 v7, v48, v49, v50
v_max_u32 v7, v7, v51
v_cmp_eq_u32 vcc, s34, v7
s_cbranch_vccz L_ok_a_315
s_add_u32 s33, s33, 1
s_cmp_gt_u32 s33, 0x100000
s_cbranch_scc0 L_q_a_311
s_branch chain_kernel_abort
L_ok_a_313:
v_smfmac_f32_16x16x64_bf16 v[64:67], v[52:55], a[8:15], v6
v_smfmac_f32_16x16x64_bf16 v[68:71], v[52:55], a[72:79], v6
v_smfmac_f32_16x16x64_bf16 v[72:75], v[52:55], a[40:47], v6
v_smfmac_f32_16x16x64_bf16 v[76:79], v[52:55], a[104:111], v6
s_branch L_q_a_287
L_ok_a_314:
v_smfmac_f32_16x16x64_bf16 v[64:67], v[56:59], a[16:23], v6
v_smfmac_f32_16x16x64_bf16 v[68:71], v[56:59], a[80:87], v6
v_smfmac_f32_16x16x64_bf16 v[72:75], v[56:59], a[48:55], v6
v_smfmac_f32_16x16x64_bf16 v[76:79], v[56:59], a[112:119], v6
s_branch L_q_a_300
L_ok_a_315:
v_smfmac_f32_16x16x64_bf16 v[64:67], v[48:51], a[0:7], v6
v_smfmac_f32_16x16x64_bf16 v[68:71], v[48:51], a[64:71], v6
v_smfmac_f32_16x16x64_bf16 v[72:75], v[48:51], a[32:39], v6
v_smfmac_f32_16x16x64_bf16 v[76:79], v[48:51], a[96:103], v6
s_branch L_q_a_263
L_q_a_309:
buffer_load_dwordx4 v[60:63], v5, s[8:11], s38 offen sc1
s_waitcnt vmcnt(3)
v_max3_u32 v7, v48, v49, v50
v_max_u32 v7, v7, v51
v_cmp_eq_u32 vcc, s34, v7
s_cbranch_vccnz L_q_a_316
L_v_a_317:
v_smfmac_f32_16x16x64_bf16 v[64:67], v[48:51], a[0:7], v6
s_waitcnt vmcnt(2)
v_max3_u32 v7, v52, v53, v54
v_max_u32 v7, v7, v55
v_smfmac_f32_16x16x64_bf16 v[68:71], v[48:51], a[64:71], v6
v_cmp_eq_u32 vcc, s34, v7
v_smfmac_f32_16x16x64_bf16 v[72:75], v[48:51], a[32:39], v6
v_smfmac_f32_16x16x64_bf16 v[76:79], v[48:51], a[96:103], v6
s_cbranch_vccnz L_q_a_267
s_branch L_v_a_268
L_q_a_316:
buffer_load_dwordx4 v[48:51], v2, s[8:11], s38 offen sc1
s_waitcnt vmcnt(2)
v_max3_u32 v7, v52, v53, v54
v_max_u32 v7, v7, v55
v_cmp_eq_u32 vcc, s34, v7
s_cbranch_vccz L_ok_a_318
buffer_load_dwordx4 v[52:55], v3, s[8:11], s38 offen sc1
s_waitcnt vmcnt(2)
v_max3_u32 v7, v56, v57, v58
v_max_u32 v7, v7, v59
v_cmp_eq_u32 vcc, s34, v7
s_cbranch_vccz L_ok_a_319
buffer_load_dwordx4 v[56:59], v4, s[8:11], s38 offen sc1
s_waitcnt vmcnt(2)
v_max3_u32 v7, v60, v61, v62
v_max_u32 v7, v7, v63
v_cmp_eq_u32 vcc, s34, v7
s_cbranch_vccz L_ok_a_320
buffer_load_dwordx4 v[60:63], v5, s[8:11], s38 offen sc1
s_waitcnt vmcnt(2)
v_max3_u32 v7, v48, v49, v50
v_max_u32 v7, v7, v51
v_cmp_eq_u32 vcc, s34, v7
s_cbranch_vccz L_ok_a_321
s_add_u32 s33, s33, 1
s_cmp_gt_u32 s33, 0x100000
s_cbranch_scc0 L_q_a_316
s_branch chain_kernel_abort
L_ok_a_318:
v_smfmac_f32_16x16x64_bf16 v[64:67], v[52:55], a[8:15], v6
v_smfmac_f32_16x16x64_bf16 v[68:71], v[52:55], a[72:79], v6
v_smfmac_f32_16x16x64_bf16 v[72:75], v[52:55], a[40:47], v6
v_smfmac_f32_16x16x64_bf16 v[76:79], v[52:55], a[104:111], v6
s_branch L_q_a_291
L_ok_a_319:
v_smfmac_f32_16x16x64_bf16 v[64:67], v[56:59], a[16:23], v6
v_smfmac_f32_16x16x64_bf16 v[68:71], v[56:59], a[80:87], v6
v_smfmac_f32_16x16x64_bf16 v[72:75], v[56:59], a[48:55], v6
v_smfmac_f32_16x16x64_bf16 v[76:79], v[56:59], a[112:119], v6
s_branch L_q_a_304
L_ok_a_320:
v_smfmac_f32_16x16x64_bf16 v[64:67], v[60:63], a[24:31], v6
v_smfmac_f32_16x16x64_bf16 v[68:71], v[60:63], a[88:95], v6
v_smfmac_f32_16x16x64_bf16 v[72:75], v[60:63], a[56:63], v6
v_smfmac_f32_16x16x64_bf16 v[76:79], v[60:63], a[120:127], v6
s_branch L_q_a_311
L_ok_a_321:
v_smfmac_f32_16x16x64_bf16 v[64:67], v[48:51], a[0:7], v6
v_smfmac_f32_16x16x64_bf16 v[68:71], v[48:51], a[64:71], v6
v_smfmac_f32_16x16x64_bf16 v[72:75], v[48:51], a[32:39], v6
v_smfmac_f32_16x16x64_bf16 v[76:79], v[48:51], a[96:103], v6
s_branch L_q_a_267
L_cf_329:
L_rt_330:
buffer_load_dwordx4 v[200:203], v16, s[8:11], s40 offen sc1
buffer_load_dwordx4 v[204:207], v13, s[8:11], s40 offen sc1
buffer_load_dwordx4 v[208:211], v14, s[8:11], s40 offen sc1
buffer_load_dwordx4 v[212:215], v15, s[8:11], s40 offen sc1
s_waitcnt vmcnt(7)
v_permlane32_swap_b32 v216, v218
v_permlane32_swap_b32 v217, v219
s_waitcnt vmcnt(6)
v_pk_add_f32 v[154:155], v[216:217], v[218:219]
v_pk_add_f32 v[148:149], v[124:125], v[220:221]
v_pk_add_f32 v[150:151], v[126:127], v[222:223]
v_permlane16_swap_b32 v154, v155
s_waitcnt vmcnt(5)
v_pk_add_f32 v[148:149], v[148:149], v[224:225]
v_pk_add_f32 v[150:151], v[150:151], v[226:227]
v_add_f32 v152, v154, v155
s_waitcnt vmcnt(4)
v_pk_add_f32 v[148:149], v[148:149], v[228:229]
v_pk_add_f32 v[150:151], v[150:151], v[230:231]
v_pk_add_f32 v[154:155], v[148:149], v[150:151]
v_add_f32 v154, v154, v152
v_cmp_u_f32 vcc, v154, v155
s_cbranch_vccz L_cok_328
buffer_load_dwordx4 v[216:219], v16, s[8:11], s40 offen sc1
buffer_load_dwordx4 v[220:223], v13, s[8:11], s40 offen sc1
buffer_load_dwordx4 v[224:227], v14, s[8:11], s40 offen sc1
buffer_load_dwordx4 v[228:231], v15, s[8:11], s40 offen sc1
s_waitcnt vmcnt(7)
v_permlane32_swap_b32 v200, v202
v_permlane32_swap_b32 v201, v203
s_waitcnt vmcnt(6)
v_pk_add_f32 v[154:155], v[200:201], v[202:203]
v_pk_add_f32 v[148:149], v[124:125], v[204:205]
v_pk_add_f32 v[150:151], v[126:127], v[206:207]
v_permlane16_swap_b32 v154, v155
s_waitcnt vmcnt(5)
v_pk_add_f32 v[148:149], v[148:149], v[208:209]
v_pk_add_f32 v[150:151], v[150:151], v[210:211]
v_add_f32 v152, v154, v155
s_waitcnt vmcnt(4)
v_pk_add_f32 v[148:149], v[148:149], v[212:213]
v_pk_add_f32 v[150:151], v[150:151], v[214:215]
v_pk_add_f32 v[154:155], v[148:149], v[150:151]
v_add_f32 v154, v154, v152
v_cmp_u_f32 vcc, v154, v155
s_cbranch_vccz L_cok_328
s_add_u32 s33, s33, 1
s_cmp_gt_u32 s33, 0x100000
s_cbranch_scc1 chain_kernel_abort
s_and_b32 s20, s33, 63
s_cbranch_scc1 L_rt_330
v_cmp_eq_u32 vcc, s34, v200
v_cmp_eq_u32 s[20:21], s34, v201
s_or_b64 vcc, vcc, s[20:21]
v_cmp_eq_u32 s[20:21], s34, v202
s_or_b64 vcc, vcc, s[20:21]
v_cmp_eq_u32 s[20:21], s34, v203
s_or_b64 vcc, vcc, s[20:21]
v_cmp_eq_u32 s[20:21], s34, v204
s_or_b64 vcc, vcc, s[20:21]
v_cmp_eq_u32 s[20:21], s34, v205
s_or_b64 vcc, vcc, s[20:21]
v_cmp_eq_u32 s[20:21], s34, v206
s_or_b64 vcc, vcc, s[20:21]
v_cmp_eq_u32 s[20:21], s34, v207
s_or_b64 vcc, vcc, s[20:21]
v_cmp_eq_u32 s[20:21], s34, v208
s_or_b64 vcc, vcc, s[20:21]
v_cmp_eq_u32 s[20:21], s34, v209
s_or_b64 vcc, vcc, s[20:21]
v_cmp_eq_u32 s[20:21], s34, v210
s_or_b64 vcc, vcc, s[20:21]
v_cmp_eq_u32 s[20:21], s34, v211
s_or_b64 vcc, vcc, s[20:21]
v_cmp_eq_u32 s[20:21], s34, v212
s_or_b64 vcc, vcc, s[20:21]
v_cmp_eq_u32 s[20:21], s34, v213
s_or_b64 vcc, vcc, s[20:21]
v_cmp_eq_u32 s[20:21], s34, v214
s_or_b64 vcc, vcc, s[20:21]
v_cmp_eq_u32 s[20:21], s34, v215
s_or_b64 vcc, vcc, s[20:21]
s_cbranch_vccnz L_rt_330
s_branch L_cok_328
L_cok_328:
v_max3_f32 v154, v148, v149, v150
v_max3_f32 v154, v154, v151, v152
s_nop 1
v_max_f32_dpp v154, v154, v154 row_ror:8 row_mask:0xf bank_mask:0xf
s_branch L_chead_331
L_q_e_339:
buffer_load_dwordx4 v[60:63], v5, s[8:11], s41 offen sc1
s_waitcnt vmcnt(0)
v_max3_u32 v7, v60, v61, v62
v_max_u32 v7, v7, v63
v_cmp_eq_u32 vcc, s34, v7
s_cbranch_vccnz L_q_e_341
s_branch L_v_e_340
L_q_e_341:
buffer_load_dwordx4 v[60:63], v5, s[8:11], s41 offen sc1
s_waitcnt vmcnt(2)
v_max3_u32 v7, v60, v61, v62
v_max_u32 v7, v7, v63
v_cmp_eq_u32 vcc, s34, v7
s_cbranch_vccz L_ok_e_342
s_add_u32 s33, s33, 1
s_cmp_gt_u32 s33, 0x100000
s_cbranch_scc0 L_q_e_341
s_branch chain_kernel_abort
L_ok_e_342:
v_smfmac_f32_16x16x64_bf16 v[88:91], v[60:63], a[216:223], v6
v_smfmac_f32_16x16x64_bf16 v[92:95], v[60:63], a[248:255], v6
s_branch L_gd_e_332
L_q_e_337:
buffer_load_dwordx4 v[56:59], v4, s[8:11], s41 offen sc1
s_waitcnt vmcnt(1)
v_max3_u32 v7, v60, v61, v62
v_max_u32 v7, v7, v63
v_cmp_eq_u32 vcc, s34, v7
s_cbranch_vccnz L_q_e_343
L_v_e_344:
v_smfmac_f32_16x16x64_bf16 v[88:91], v[60:63], a[216:223], v6
s_waitcnt vmcnt(0)
v_max3_u32 v7, v56, v57, v58
v_max_u32 v7, v7, v59
v_cmp_eq_u32 vcc, s34, v7
v_smfmac_f32_16x16x64_bf16 v[92:95], v[60:63], a[248:255], v6
s_cbranch_vccnz L_q_e_345
L_v_e_346:
v_smfmac_f32_16x16x64_bf16 v[88:91], v[56:59], a[208:215], v6
v_smfmac_f32_16x16x64_bf16 v[92:95], v[56:59], a[240:247], v6
s_branch L_gd_e_332
L_q_e_345:
buffer_load_dwordx4 v[56:59], v4, s[8:11], s41 offen sc1
s_waitcnt vmcnt(2)
v_max3_u32 v7, v56, v57, v58
v_max_u32 v7, v7, v59
v_cmp_eq_u32 vcc, s34, v7
s_cbranch_vccz L_ok_e_347
s_add_u32 s33, s33, 1
s_cmp_gt_u32 s33, 0x100000
s_cbranch_scc0 L_q_e_345
s_branch chain_kernel_abort
L_ok_e_347:
v_smfmac_f32_16x16x64_bf16 v[88:91], v[56:59], a[208:215], v6
v_smfmac_f32_16x16x64_bf16 v[92:95], v[56:59], a[240:247], v6
s_branch L_gd_e_332
L_q_e_343:
buffer_load_dwordx4 v[60:63], v5, s[8:11], s41 offen sc1
s_waitcnt vmcnt(1)
v_max3_u32 v7, v56, v57, v58
v_max_u32 v7, v7, v59
v_cmp_eq_u32 vcc, s34, v7
s_cbranch_vccnz L_q_e_348
L_v_e_349:
v_smfmac_f32_16x16x64_bf16 v[88:91], v[56:59], a[208:215], v6
s_waitcnt vmcnt(0)
v_max3_u32 v7, v60, v61, v62
v_max_u32 v7, v7, v63
v_cmp_eq_u32 vcc, s34, v7
v_smfmac_f32_16x16x64_bf16 v[92:95], v[56:59], a[240:247], v6
s_cbranch_vccnz L_q_e_341
s_branch L_v_e_340
L_q_e_348:
buffer_load_dwordx4 v[56:59], v4, s[8:11], s41 offen sc1
s_waitcnt vmcnt(2)
v_max3_u32 v7, v60, v61, v62
v_max_u32 v7, v7, v63
v_cmp_eq_u32 vcc, s34, v7
s_cbranch_vccz L_ok_e_350
buffer_load_dwordx4 v[60:63], v5, s[8:11], s41 offen sc1
s_waitcnt vmcnt(2)
v_max3_u32 v7, v56, v57, v58
v_max_u32 v7, v7, v59
v_cmp_eq_u32 vcc, s34, v7
s_cbranch_vccz L_ok_e_351
s_add_u32 s33, s33, 1
s_cmp_gt_u32 s33, 0x100000
s_cbranch_scc0 L_q_e_348
s_branch chain_kernel_abort
L_ok_e_350:
v_smfmac_f32_16x16x64_bf16 v[88:91], v[60:63], a[216:223], v6
v_smfmac_f32_16x16x64_bf16 v[92:95], v[60:63], a[248:255], v6
s_branch L_q_e_345
L_ok_e_351:
v_smfmac_f32_16x16x64_bf16 v[88:91], v[56:59], a[208:215], v6
v_smfmac_f32_16x16x64_bf16 v[92:95], v[56:59], a[240:247], v6
s_branch L_q_e_341
L_q_e_335:
buffer_load_dwordx4 v[52:55], v3, s[8:11], s41 offen sc1
s_waitcnt vmcnt(2)
v_max3_u32 v7, v56, v57, v58
v_max_u32 v7, v7, v59
v_cmp_eq_u32 vcc, s34, v7
s_cbranch_vccnz L_q_e_352
L_v_e_353:
v_smfmac_f32_16x16x64_bf16 v[88:91], v[56:59], a[208:215], v6
s_waitcnt vmcnt(1)
v_max3_u32 v7, v60, v61, v62
v_max_u32 v7, v7, v63
v_cmp_eq_u32 vcc, s34, v7
v_smfmac_f32_16x16x64_bf16 v[92:95], v[56:59], a[240:247], v6
s_cbranch_vccnz L_q_e_354
L_v_e_355:
v_smfmac_f32_16x16x64_bf16 v[88:91], v[60:63], a[216:223], v6
s_waitcnt vmcnt(0)
v_max3_u32 v7, v52, v53, v54
v_max_u32 v7, v7, v55
v_cmp_eq_u32 vcc, s34, v7
v_smfmac_f32_16x16x64_bf16 v[92:95], v[60:63], a[248:255], v6
s_cbranch_vccnz L_q_e_356
L_v_e_357:
v_smfmac_f32_16x16x64_bf16 v[88:91], v[52:55], a[200:207], v6
v_smfmac_f32_16x16x64_bf16 v[92:95], v[52:55], a[232:239], v6
s_branch L_gd_e_332
L_q_e_356:
buffer_load_dwordx4 v[52:55], v3, s[8:11], s41 offen sc1
s_waitcnt vmcnt(2)
v_max3_u32 v7, v52, v53, v54
v_max_u32 v7, v7, v55
v_cmp_eq_u32 vcc, s34, v7
s_cbranch_vccz L_ok_e_358
s_add_u32 s33, s33, 1
s_cmp_gt_u32 s33, 0x100000
s_cbranch_scc0 L_q_e_356
s_branch chain_kernel_abort
L_ok_e_358:
v_smfmac_f32_16x16x64_bf16 v[88:91], v[52:55], a[200:207], v6
v_smfmac_f32_16x16x64_bf16 v[92:95], v[52:55], a[232:239], v6
s_branch L_gd_e_332
L_q_e_354:
buffer_load_dwordx4 v[60:63], v5, s[8:11], s41 offen sc1
s_waitcnt vmcnt(1)
v_max3_u32 v7, v52, v53, v54
v_max_u32 v7, v7, v55
v_cmp_eq_u32 vcc, s34, v7
s_cbranch_vccnz L_q_e_359
L_v_e_360:
v_smfmac_f32_16x16x64_bf16 v[88:91], v[52:55], a[200:207], v6
s_waitcnt vmcnt(0)
v_max3_u32 v7, v60, v61, v62
v_max_u32 v7, v7, v63
v_cmp_eq_u32 vcc, s34, v7
v_smfmac_f32_16x16x64_bf16 v[92:95], v[52:55], a[232:239], v6
s_cbranch_vccnz L_q_e_341
s_branch L_v_e_340
L_q_e_359:
buffer_load_dwordx4 v[52:55], v3, s[8:11], s41 offen sc1
s_waitcnt vmcnt(2)
v_max3_u32 v7, v60, v61, v62
v_max_u32 v7, v7, v63
v_cmp_eq_u32 vcc, s34, v7
s_cbranch_vccz L_ok_e_361
buffer_load_dwordx4 v[60:63], v5, s[8:11], s41 offen sc1
s_waitcnt vmcnt(2)
v_max3_u32 v7, v52, v53, v54
v_max_u32 v7, v7, v55
v_cmp_eq_u32 vcc, s34, v7
s_cbranch_vccz L_ok_e_362
s_add_u32 s33, s33, 1
s_cmp_gt_u32 s33, 0x100000
s_cbranch_scc0 L_q_e_359
s_branch chain_kernel_abort
L_ok_e_361:
v_smfmac_f32_16x16x64_bf16 v[88:91], v[60:63], a[216:223], v6
v_smfmac_f32_16x16x64_bf16 v[92:95], v[60:63], a[248:255], v6
s_branch L_q_e_356
L_ok_e_362:
v_smfmac_f32_16x16x64_bf16 v[88:91], v[52:55], a[200:207], v6
v_smfmac_f32_16x16x64_bf16 v[92:95], v[52:55], a[232:239], v6
s_branch L_q_e_341
L_q_e_352:
buffer_load_dwordx4 v[56:59], v4, s[8:11], s41 offen sc1
s_waitcnt vmcnt(2)
v_max3_u32 v7, v60, v61, v62
v_max_u32 v7, v7, v63
v_cmp_eq_u32 vcc, s34, v7
s_cbranch_vccnz L_q_e_363
L_v_e_364:
v_smfmac_f32_16x16x64_bf16 v[88:91], v[60:63], a[216:223], v6
s_waitcnt vmcnt(1)
v_max3_u32 v7, v52, v53, v54
v_max_u32 v7, v7, v55
v_cmp_eq_u32 vcc, s34, v7
v_smfmac_f32_16x16x64_bf16 v[92:95], v[60:63], a[248:255], v6
s_cbranch_vccnz L_q_e_365
L_v_e_366:
v_smfmac_f32_16x16x64_bf16 v[88:91], v[52:55], a[200:207], v6
s_waitcnt vmcnt(0)
v_max3_u32 v7, v56, v57, v58
v_max_u32 v7, v7, v59
v_cmp_eq_u32 vcc, s34, v7
v_smfmac_f32_16x16x64_bf16 v[92:95], v[52:55], a[232:239], v6
s_cbranch_vccnz L_q_e_345
s_branch L_v_e_346
L_q_e_365:
buffer_load_dwordx4 v[52:55], v3, s[8:11], s41 offen sc1
s_waitcnt vmcnt(2)
v_max3_u32 v7, v56, v57, v58
v_max_u32 v7, v7, v59
v_cmp_eq_u32 vcc, s34, v7
s_cbranch_vccz L_ok_e_367
buffer_load_dwordx4 v[56:59], v4, s[8:11], s41 offen sc1
s_waitcnt vmcnt(2)
v_max3_u32 v7, v52, v53, v54
v_max_u32 v7, v7, v55
v_cmp_eq_u32 vcc, s34, v7
s_cbranch_vccz L_ok_e_368
s_add_u32 s33, s33, 1
s_cmp_gt_u32 s33, 0x100000
s_cbranch_scc0 L_q_e_365
s_branch chain_kernel_abort
L_ok_e_367:
v_smfmac_f32_16x16x64_bf16 v[88:91], v[56:59], a[208:215], v6
v_smfmac_f32_16x16x64_bf16 v[92:95], v[56:59], a[240:247], v6
s_branch L_q_e_356
L_ok_e_368:
v_smfmac_f32_16x16x64_bf16 v[88:91], v[52:55], a[200:207], v6
v_smfmac_f32_16x16x64_bf16 v[92:95], v[52:55], a[232:239], v6
s_branch L_q_e_345
L_q_e_363:
buffer_load_dwordx4 v[60:63], v5, s[8:11], s41 offen sc1
s_waitcnt vmcnt(2)
v_max3_u32 v7, v52, v53, v54
v_max_u32 v7, v7, v55
v_cmp_eq_u32 vcc, s34, v7
s_cbranch_vccnz L_q_e_369
L_v_e_370:
v_smfmac_f32_16x16x64_bf16 v[88:91], v[52:55], a[200:207], v6
s_waitcnt vmcnt(1)
v_max3_u32 v7, v56, v57, v58
v_max_u32 v7, v7, v59
v_cmp_eq_u32 vcc, s34, v7
v_smfmac_f32_16x16x64_bf16 v[92:95], v[52:55], a[232:239], v6
s_cbranch_vccnz L_q_e_348
s_branch L_v_e_349
L_q_e_369:
buffer_load_dwordx4 v[52:55], v3, s[8:11], s41 offen sc1
s_waitcnt vmcnt(2)
v_max3_u32 v7, v56, v57, v58
v_max_u32 v7, v7, v59
v_cmp_eq_u32 vcc, s34, v7
s_cbranch_vccz L_ok_e_371
buffer_load_dwordx4 v[56:59], v4, s[8:11], s41 offen sc1
s_waitcnt vmcnt(2)
v_max3_u32 v7, v60, v61, v62
v_max_u32 v7, v7, v63
v_cmp_eq_u32 vcc, s34, v7
s_cbranch_vccz L_ok_e_372
buffer_load_dwordx4 v[60:63], v5, s[8:11], s41 offen sc1
s_waitcnt vmcnt(2)
v_max3_u32 v7, v52, v53, v54
v_max_u32 v7, v7, v55
v_cmp_eq_u32 vcc, s34, v7
s_cbranch_vccz L_ok_e_373
s_add_u32 s33, s33, 1
s_cmp_gt_u32 s33, 0x100000
s_cbranch_scc0 L_q_e_369
s_branch chain_kernel_abort
L_ok_e_371:
v_smfmac_f32_16x16x64_bf16 v[88:91], v[56:59], a[208:215], v6
v_smfmac_f32_16x16x64_bf16 v[92:95], v[56:59], a[240:247], v6
s_branch L_q_e_359
L_ok_e_372:
v_smfmac_f32_16x16x64_bf16 v[88:91], v[60:63], a[216:223], v6
v_smfmac_f32_16x16x64_bf16 v[92:95], v[60:63], a[248:255], v6
s_branch L_q_e_365
L_ok_e_373:
v_smfmac_f32_16x16x64_bf16 v[88:91], v[52:55], a[200:207], v6
v_smfmac_f32_16x16x64_bf16 v[92:95], v[52:55], a[232:239], v6
s_branch L_q_e_348
L_q_e_333:
buffer_load_dwordx4 v[48:51], v2, s[8:11], s41 offen sc1
s_waitcnt vmcnt(3)
v_max3_u32 v7, v52, v53, v54
v_max_u32 v7, v7, v55
v_cmp_eq_u32 vcc, s34, v7
s_cbranch_vccnz L_q_e_374
L_v_e_375:
v_smfmac_f32_16x16x64_bf16 v[88:91], v[52:55], a[200:207], v6
s_waitcnt vmcnt(2)
v_max3_u32 v7, v56, v57, v58
v_max_u32 v7, v7, v59
v_cmp_eq_u32 vcc, s34, v7
v_smfmac_f32_16x16x64_bf16 v[92:95], v[52:55], a[232:239], v6
s_cbranch_vccnz L_q_e_376
L_v_e_377:
v_smfmac_f32_16x16x64_bf16 v[88:91], v[56:59], a[208:215], v6
s_waitcnt vmcnt(1)
v_max3_u32 v7, v60, v61, v62
v_max_u32 v7, v7, v63
v_cmp_eq_u32 vcc, s34, v7
v_smfmac_f32_16x16x64_bf16 v[92:95], v[56:59], a[240:247], v6
s_cbranch_vccnz L_q_e_378
L_v_e_379:
v_smfmac_f32_16x16x64_bf16 v[88:91], v[60:63], a[216:223], v6
s_waitcnt vmcnt(0)
v_max3_u32 v7, v48, v49, v50
v_max_u32 v7, v7, v51
v_cmp_eq_u32 vcc, s34, v7
v_smfmac_f32_16x16x64_bf16 v[92:95], v[60:63], a[248:255], v6
s_cbranch_vccnz L_q_e_380
L_v_e_381:
v_smfmac_f32_16x16x64_bf16 v[88:91], v[48:51], a[192:199], v6
v_smfmac_f32_16x16x64_bf16 v[92:95], v[48:51], a[224:231], v6
s_branch L_gd_e_332
L_q_e_380:
buffer_load_dwordx4 v[48:51], v2, s[8:11], s41 offen sc1
s_waitcnt vmcnt(2)
v_max3_u32 v7, v48, v49, v50
v_max_u32 v7, v7, v51
v_cmp_eq_u32 vcc, s34, v7
s_cbranch_vccz L_ok_e_382
s_add_u32 s33, s33, 1
s_cmp_gt_u32 s33, 0x100000
s_cbranch_scc0 L_q_e_380
s_branch chain_kernel_abort
L_ok_e_382:
v_smfmac_f32_16x16x64_bf16 v[88:91], v[48:51], a[192:199], v6
v_smfmac_f32_16x16x64_bf16 v[92:95], v[48:51], a[224:231], v6
s_branch L_gd_e_332
L_q_e_378:
buffer_load_dwordx4 v[60:63], v5, s[8:11], s41 offen sc1
s_waitcnt vmcnt(1)
v_max3_u32 v7, v48, v49, v50
v_max_u32 v7, v7, v51
v_cmp_eq_u32 vcc, s34, v7
s_cbranch_vccnz L_q_e_383
L_v_e_384:
v_smfmac_f32_16x16x64_bf16 v[88:91], v[48:51], a[192:199], v6
s_waitcnt vmcnt(0)
v_max3_u32 v7, v60, v61, v62
v_max_u32 v7, v7, v63
v_cmp_eq_u32 vcc, s34, v7
v_smfmac_f32_16x16x64_bf16 v[92:95], v[48:51], a[224:231], v6
s_cbranch_vccnz L_q_e_341
s_branch L_v_e_340
L_q_e_383:
buffer_load_dwordx4 v[48:51], v2, s[8:11], s41 offen sc1
s_waitcnt vmcnt(2)
v_max3_u32 v7, v60, v61, v62
v_max_u32 v7, v7, v63
v_cmp_eq_u32 vcc, s34, v7
s_cbranch_vccz L_ok_e_385
buffer_load_dwordx4 v[60:63], v5, s[8:11], s41 offen sc1
s_waitcnt vmcnt(2)
v_max3_u32 v7, v48, v49, v50
v_max_u32 v7, v7, v51
v_cmp_eq_u32 vcc, s34, v7
s_cbranch_vccz L_ok_e_386
s_add_u32 s33, s33, 1
s_cmp_gt_u32 s33, 0x100000
s_cbranch_scc0 L_q_e_383
s_branch chain_kernel_abort
L_ok_e_385:
v_smfmac_f32_16x16x64_bf16 v[88:91], v[60:63], a[216:223], v6
v_smfmac_f32_16x16x64_bf16 v[92:95], v[60:63], a[248:255], v6
s_branch L_q_e_380
L_ok_e_386:
v_smfmac_f32_16x16x64_bf16 v[88:91], v[48:51], a[192:199], v6
v_smfmac_f32_16x16x64_bf16 v[92:95], v[48:51], a[224:231], v6
s_branch L_q_e_341
L_q_e_376:
buffer_load_dwordx4 v[56:59], v4, s[8:11], s41 offen sc1
s_waitcnt vmcnt(2)
v_max3_u32 v7, v60, v61, v62
v_max_u32 v7, v7, v63
v_cmp_eq_u32 vcc, s34, v7
s_cbranch_vccnz L_q_e_387
L_v_e_388:
v_smfmac_f32_16x16x64_bf16 v[88:91], v[60:63], a[216:223], v6
s_waitcnt vmcnt(1)
v_max3_u32 v7, v48, v49, v50
v_max_u32 v7, v7, v51
v_cmp_eq_u32 vcc, s34, v7
v_smfmac_f32_16x16x64_bf16 v[92:95], v[60:63], a[248:255], v6
s_cbranch_vccnz L_q_e_389
L_v_e_390:
v_smfmac_f32_16x16x64_bf16 v[88:91], v[48:51], a[192:199], v6
s_waitcnt vmcnt(0)
v_max3_u32 v7, v56, v57, v58
v_max_u32 v7, v7, v59
v_cmp_eq_u32 vcc, s34, v7
v_smfmac_f32_16x16x64_bf16 v[92:95], v[48:51], a[224:231], v6
s_cbranch_vccnz L_q_e_345
s_branch L_v_e_346
L_q_e_389:
buffer_load_dwordx4 v[48:51], v2, s[8:11], s41 offen sc1
s_waitcnt vmcnt(2)
v_max3_u32 v7, v56, v57, v58
v_max_u32 v7, v7, v59
v_cmp_eq_u32 vcc, s34, v7
s_cbranch_vccz L_ok_e_391
buffer_load_dwordx4 v[56:59], v4, s[8:11], s41 offen sc1
s_waitcnt vmcnt(2)
v_max3_u32 v7, v48, v49, v50
v_max_u32 v7, v7, v51
v_cmp_eq_u32 vcc, s34, v7
s_cbranch_vccz L_ok_e_392
s_add_u32 s33, s33, 1
s_cmp_gt_u32 s33, 0x100000
s_cbranch_scc0 L_q_e_389
s_branch chain_kernel_abort
L_ok_e_391:
v_smfmac_f32_16x16x64_bf16 v[88:91], v[56:59], a[208:215], v6
v_smfmac_f32_16x16x64_bf16 v[92:95], v[56:59], a[240:247], v6
s_branch L_q_e_380
L_ok_e_392:
v_smfmac_f32_16x16x64_bf16 v[88:91], v[48:51], a[192:199], v6
v_smfmac_f32_16x16x64_bf16 v[92:95], v[48:51], a[224:231], v6
s_branch L_q_e_345
L_q_e_387:
buffer_load_dwordx4 v[60:63], v5, s[8:11], s41 offen sc1
s_waitcnt vmcnt(2)
v_max3_u32 v7, v48, v49, v50
v_max_u32 v7, v7, v51
v_cmp_eq_u32 vcc, s34, v7
s_cbranch_vccnz L_q_e_393
L_v_e_394:
v_smfmac_f32_16x16x64_bf16 v[88:91], v[48:51], a[192:199], v6
s_waitcnt vmcnt(1)
v_max3_u32 v7, v56, v57, v58
v_max_u32 v7, v7, v59
v_cmp_eq_u32 vcc, s34, v7
v_smfmac_f32_16x16x64_bf16 v[92:95], v[48:51], a[224:231], v6
s_cbranch_vccnz L_q_e_348
s_branch L_v_e_349
L_q_e_393:
buffer_load_dwordx4 v[48:51], v2, s[8:11], s41 offen sc1
s_waitcnt vmcnt(2)
v_max3_u32 v7, v56, v57, v58
v_max_u32 v7, v7, v59
v_cmp_eq_u32 vcc, s34, v7
s_cbranch_vccz L_ok_e_395
buffer_load_dwordx4 v[56:59], v4, s[8:11], s41 offen sc1
s_waitcnt vmcnt(2)
v_max3_u32 v7, v60, v61, v62
v_max_u32 v7, v7, v63
v_cmp_eq_u32 vcc, s34, v7
s_cbranch_vccz L_ok_e_396
buffer_load_dwordx4 v[60:63], v5, s[8:11], s41 offen sc1
s_waitcnt vmcnt(2)
v_max3_u32 v7, v48, v49, v50
v_max_u32 v7, v7, v51
v_cmp_eq_u32 vcc, s34, v7
s_cbranch_vccz L_ok_e_397
s_add_u32 s33, s33, 1
s_cmp_gt_u32 s33, 0x100000
s_cbranch_scc0 L_q_e_393
s_branch chain_kernel_abort
L_ok_e_395:
v_smfmac_f32_16x16x64_bf16 v[88:91], v[56:59], a[208:215], v6
v_smfmac_f32_16x16x64_bf16 v[92:95], v[56:59], a[240:247], v6
s_branch L_q_e_383
L_ok_e_396:
v_smfmac_f32_16x16x64_bf16 v[88:91], v[60:63], a[216:223], v6
v_smfmac_f32_16x16x64_bf16 v[92:95], v[60:63], a[248:255], v6
s_branch L_q_e_389
L_ok_e_397:
v_smfmac_f32_16x16x64_bf16 v[88:91], v[48:51], a[192:199], v6
v_smfmac_f32_16x16x64_bf16 v[92:95], v[48:51], a[224:231], v6
s_branch L_q_e_348
L_q_e_374:
buffer_load_dwordx4 v[52:55], v3, s[8:11], s41 offen sc1
s_waitcnt vmcnt(3)
v_max3_u32 v7, v56, v57, v58
v_max_u32 v7, v7, v59
v_cmp_eq_u32 vcc, s34, v7
s_cbranch_vccnz L_q_e_398
L_v_e_399:
v_smfmac_f32_16x16x64_bf16 v[88:91], v[56:59], a[208:215], v6
s_waitcnt vmcnt(2)
v_max3_u32 v7, v60, v61, v62
v_max_u32 v7, v7, v63
v_cmp_eq_u32 vcc, s34, v7
v_smfmac_f32_16x16x64_bf16 v[92:95], v[56:59], a[240:247], v6
s_cbranch_vccnz L_q_e_400
L_v_e_401:
v_smfmac_f32_16x16x64_bf16 v[88:91], v[60:63], a[216:223], v6
s_waitcnt vmcnt(1)
v_max3_u32 v7, v48, v49, v50
v_max_u32 v7, v7, v51
v_cmp_eq_u32 vcc, s34, v7
v_smfmac_f32_16x16x64_bf16 v[92:95], v[60:63], a[248:255], v6
s_cbranch_vccnz L_q_e_402
L_v_e_403:
v_smfmac_f32_16x16x64_bf16 v[88:91], v[48:51], a[192:199], v6
s_waitcnt vmcnt(0)
v_max3_u32 v7, v52, v53, v54
v_max_u32 v7, v7, v55
v_cmp_eq_u32 vcc, s34, v7
v_smfmac_f32_16x16x64_bf16 v[92:95], v[48:51], a[224:231], v6
s_cbranch_vccnz L_q_e_356
s_branch L_v_e_357
L_q_e_402:
buffer_load_dwordx4 v[48:51], v2, s[8:11], s41 offen sc1
s_waitcnt vmcnt(2)
v_max3_u32 v7, v52, v53, v54
v_max_u32 v7, v7, v55
v_cmp_eq_u32 vcc, s34, v7
s_cbranch_vccz L_ok_e_404
buffer_load_dwordx4 v[52:55], v3, s[8:11], s41 offen sc1
s_waitcnt vmcnt(2)
v_max3_u32 v7, v48, v49, v50
v_max_u32 v7, v7, v51
v_cmp_eq_u32 vcc, s34, v7
s_cbranch_vccz L_ok_e_405
s_add_u32 s33, s33, 1
s_cmp_gt_u32 s33, 0x100000
s_cbranch_scc0 L_q_e_402
s_branch chain_kernel_abort
L_ok_e_404:
v_smfmac_f32_16x16x64_bf16 v[88:91], v[52:55], a[200:207], v6
v_smfmac_f32_16x16x64_bf16 v[92:95], v[52:55], a[232:239], v6
s_branch L_q_e_380
L_ok_e_405:
v_smfmac_f32_16x16x64_bf16 v[88:91], v[48:51], a[192:199], v6
v_smfmac_f32_16x16x64_bf16 v[92:95], v[48:51], a[224:231], v6
s_branch L_q_e_356
L_q_e_400:
buffer_load_dwordx4 v[60:63], v5, s[8:11], s41 offen sc1
s_waitcnt vmcnt(2)
v_max3_u32 v7, v48, v49, v50
v_max_u32 v7, v7, v51
v_cmp_eq_u32 vcc, s34, v7
s_cbranch_vccnz L_q_e_406
L_v_e_407:
v_smfmac_f32_16x16x64_bf16 v[88:91], v[48:51], a[192:199], v6
s_waitcnt vmcnt(1)
v_max3_u32 v7, v52, v53, v54
v_max_u32 v7, v7, v55
v_cmp_eq_u32 vcc, s34, v7
v_smfmac_f32_16x16x64_bf16 v[92:95], v[48:51], a[224:231], v6
s_cbranch_vccnz L_q_e_359
s_branch L_v_e_360
L_q_e_406:
buffer_load_dwordx4 v[48:51], v2, s[8:11], s41 offen sc1
s_waitcnt vmcnt(2)
v_max3_u32 v7, v52, v53, v54
v_max_u32 v7, v7, v55
v_cmp_eq_u32 vcc, s34, v7
s_cbranch_vccz L_ok_e_408
buffer_load_dwordx4 v[52:55], v3, s[8:11], s41 offen sc1
s_waitcnt vmcnt(2)
v_max3_u32 v7, v60, v61, v62
v_max_u32 v7, v7, v63
v_cmp_eq_u32 vcc, s34, v7
s_cbranch_vccz L_ok_e_409
buffer_load_dwordx4 v[60:63], v5, s[8:11], s41 offen sc1
s_waitcnt vmcnt(2)
v_max3_u32 v7, v48, v49, v50
v_max_u32 v7, v7, v51
v_cmp_eq_u32 vcc, s34, v7
s_cbranch_vccz L_ok_e_410
s_add_u32 s33, s33, 1
s_cmp_gt_u32 s33, 0x100000
s_cbranch_scc0 L_q_e_406
s_branch chain_kernel_abort
L_ok_e_408:
v_smfmac_f32_16x16x64_bf16 v[88:91], v[52:55], a[200:207], v6
v_smfmac_f32_16x16x64_bf16 v[92:95], v[52:55], a[232:239], v6
s_branch L_q_e_383
L_ok_e_409:
v_smfmac_f32_16x16x64_bf16 v[88:91], v[60:63], a[216:223], v6
v_smfmac_f32_16x16x64_bf16 v[92:95], v[60:63], a[248:255], v6
s_branch L_q_e_402
L_ok_e_410:
v_smfmac_f32_16x16x64_bf16 v[88:91], v[48:51], a[192:199], v6
v_smfmac_f32_16x16x64_bf16 v[92:95], v[48:51], a[224:231], v6
s_branch L_q_e_359
L_q_e_398:
buffer_load_dwordx4 v[56:59], v4, s[8:11], s41 offen sc1
s_waitcnt vmcnt(3)
v_max3_u32 v7, v60, v61, v62
v_max_u32 v7, v7, v63
v_cmp_eq_u32 vcc, s34, v7
s_cbranch_vccnz L_q_e_411
L_v_e_412:
v_smfmac_f32_16x16x64_bf16 v[88:91], v[60:63], a[216:223], v6
s_waitcnt vmcnt(2)
v_max3_u32 v7, v48, v49, v50
v_max_u32 v7, v7, v51
v_cmp_eq_u32 vcc, s34, v7
v_smfmac_f32_16x16x64_bf16 v[92:95], v[60:63], a[248:255], v6
s_cbranch_vccnz L_q_e_413
L_v_e_414:
v_smfmac_f32_16x16x64_bf16 v[88:91], v[48:51], a[192:199], v6
s_waitcnt vmcnt(1)
v_max3_u32 v7, v52, v53, v54
v_max_u32 v7, v7, v55
v_cmp_eq_u32 vcc, s34, v7
v_smfmac_f32_16x16x64_bf16 v[92:95], v[48:51], a[224:231], v6
s_cbranch_vccnz L_q_e_365
s_branch L_v_e_366
L_q_e_413:
buffer_load_dwordx4 v[48:51], v2, s[8:11], s41 offen sc1
s_waitcnt vmcnt(2)
v_max3_u32 v7, v52, v53, v54
v_max_u32 v7, v7, v55
v_cmp_eq_u32 vcc, s34, v7
s_cbranch_vccz L_ok_e_415
buffer_load_dwordx4 v[52:55], v3, s[8:11], s41 offen sc1
s_waitcnt vmcnt(2)
v_max3_u32 v7, v56, v57, v58
v_max_u32 v7, v7, v59
v_cmp_eq_u32 vcc, s34, v7
s_cbranch_vccz L_ok_e_416
buffer_load_dwordx4 v[56:59], v4, s[8:11], s41 offen sc1
s_waitcnt vmcnt(2)
v_max3_u32 v7, v48, v49, v50
v_max_u32 v7, v7, v51
v_cmp_eq_u32 vcc, s34, v7
s_cbranch_vccz L_ok_e_417
s_add_u32 s33, s33, 1
s_cmp_gt_u32 s33, 0x100000
s_cbranch_scc0 L_q_e_413
s_branch chain_kernel_abort
L_ok_e_415:
v_smfmac_f32_16x16x64_bf16 v[88:91], v[52:55], a[200:207], v6
v_smfmac_f32_16x16x64_bf16 v[92:95], v[52:55], a[232:239], v6
s_branch L_q_e_389
L_ok_e_416:
v_smfmac_f32_16x16x64_bf16 v[88:91], v[56:59], a[208:215], v6
v_smfmac_f32_16x16x64_bf16 v[92:95], v[56:59], a[240:247], v6
s_branch L_q_e_402
L_ok_e_417:
v_smfmac_f32_16x16x64_bf16 v[88:91], v[48:51], a[192:199], v6
v_smfmac_f32_16x16x64_bf16 v[92:95], v[48:51], a[224:231], v6
s_branch L_q_e_365
L_q_e_411:
buffer_load_dwordx4 v[60:63], v5, s[8:11], s41 offen sc1
s_waitcnt vmcnt(3)
v_max3_u32 v7, v48, v49, v50
v_max_u32 v7, v7, v51
v_cmp_eq_u32 vcc, s34, v7
s_cbranch_vccnz L_q_e_418
L_v_e_419:
v_smfmac_f32_16x16x64_bf16 v[88:91], v[48:51], a[192:199], v6
s_waitcnt vmcnt(2)
v_max3_u32 v7, v52, v53, v54
v_max_u32 v7, v7, v55
v_cmp_eq_u32 vcc, s34, v7
v_smfmac_f32_16x16x64_bf16 v[92:95], v[48:51], a[224:231], v6
s_cbranch_vccnz L_q_e_369
s_branch L_v_e_370
L_q_e_418:
buffer_load_dwordx4 v[48:51], v2, s[8:11], s41 offen sc1
s_waitcnt vmcnt(2)
v_max3_u32 v7, v52, v53, v54
v_max_u32 v7, v7, v55
v_cmp_eq_u32 vcc, s34, v7
s_cbranch_vccz L_ok_e_420
buffer_load_dwordx4 v[52:55], v3, s[8:11], s41 offen sc1
s_waitcnt vmcnt(2)
v_max3_u32 v7, v56, v57, v58
v_max_u32 v7, v7, v59
v_cmp_eq_u32 vcc, s34, v7
s_cbranch_vccz L_ok_e_421
buffer_load_dwordx4 v[56:59], v4, s[8:11], s41 offen sc1
s_waitcnt vmcnt(2)
v_max3_u32 v7, v60, v61, v62
v_max_u32 v7, v7, v63
v_cmp_eq_u32 vcc, s34, v7
s_cbranch_vccz L_ok_e_422
buffer_load_dwordx4 v[60:63], v5, s[8:11], s41 offen sc1
s_waitcnt vmcnt(2)
v_max3_u32 v7, v48, v49, v50
v_max_u32 v7, v7, v51
v_cmp_eq_u32 vcc, s34, v7
s_cbranch_vccz L_ok_e_423
s_add_u32 s33, s33, 1
s_cmp_gt_u32 s33, 0x100000
s_cbranch_scc0 L_q_e_418
s_branch chain_kernel_abort
L_ok_e_420:
v_smfmac_f32_16x16x64_bf16 v[88:91], v[52:55], a[200:207], v6
v_smfmac_f32_16x16x64_bf16 v[92:95], v[52:55], a[232:239], v6
s_branch L_q_e_393
L_ok_e_421:
v_smfmac_f32_16x16x64_bf16 v[88:91], v[56:59], a[208:215], v6
v_smfmac_f32_16x16x64_bf16 v[92:95], v[56:59], a[240:247], v6
s_branch L_q_e_406
L_ok_e_422:
v_smfmac_f32_16x16x64_bf16 v[88:91], v[60:63], a[216:223], v6
v_smfmac_f32_16x16x64_bf16 v[92:95], v[60:63], a[248:255], v6
s_branch L_q_e_413
L_ok_e_423:
v_smfmac_f32_16x16x64_bf16 v[88:91], v[48:51], a[192:199], v6
v_smfmac_f32_16x16x64_bf16 v[92:95], v[48:51], a[224:231], v6
s_branch L_q_e_369
L_gf_424:
s_waitcnt vmcnt(4)
v_lshlrev_b32 v100, 16, v212
v_and_b32 v101, 0xffff0000, v212
v_lshlrev_b32 v102, 16, v213
v_and_b32 v103, 0xffff0000, v213
v_pk_add_f32 v[148:149], v[168:169], v[100:101]
v_pk_add_f32 v[150:151], v[170:171], v[102:103]
s_waitcnt vmcnt(3)
v_lshlrev_b32 v100, 16, v214
v_and_b32 v101, 0xffff0000, v214
v_lshlrev_b32 v102, 16, v215
v_and_b32 v103, 0xffff0000, v215
v_pk_add_f32 v[148:149], v[148:149], v[100:101]
v_pk_add_f32 v[150:151], v[150:151], v[102:103]
s_waitcnt vmcnt(2)
v_lshlrev_b32 v100, 16, v216
v_and_b32 v101, 0xffff0000, v216
v_lshlrev_b32 v102, 16, v217
v_and_b32 v103, 0xffff0000, v217
v_pk_add_f32 v[148:149], v[148:149], v[100:101]
v_pk_add_f32 v[150:151], v[150:151], v[102:103]
v_cmp_u_f32 vcc, v148, v150
v_cvt_pk_bf16_f32 v180, v148, v149
v_cvt_pk_bf16_f32 v181, v150, v151
s_cbranch_vccz L_gok_425
buffer_load_dwordx2 v[212:213], v17, s[8:11], s22 offen offset:512 sc1
buffer_load_dwordx2 v[214:215], v18, s[8:11], s22 offen offset:512 sc1
buffer_load_dwordx2 v[216:217], v19, s[8:11], s22 offen offset:512 sc1
s_nop 11
L_rt_427:
buffer_load_dwordx2 v[200:201], v17, s[8:11], s22 offen offset:0 sc1
buffer_load_dwordx2 v[202:203], v18, s[8:11], s22 offen offset:0 sc1
buffer_load_dwordx2 v[204:205], v19, s[8:11], s22 offen offset:0 sc1
s_waitcnt vmcnt(5)
v_lshlrev_b32 v100, 16, v212
v_and_b32 v101, 0xffff0000, v212
v_lshlrev_b32 v102, 16, v213
v_and_b32 v103, 0xffff0000, v213
v_pk_add_f32 v[148:149], v[168:169], v[100:101]
v_pk_add_f32 v[150:151], v[170:171], v[102:103]
s_waitcnt vmcnt(4)
v_lshlrev_b32 v100, 16, v214
v_and_b32 v101, 0xffff0000, v214
v_lshlrev_b32 v102, 16, v215
v_and_b32 v103, 0xffff0000, v215
v_pk_add_f32 v[148:149], v[148:149], v[100:101]
v_pk_add_f32 v[150:151], v[150:151], v[102:103]
s_waitcnt vmcnt(3)
v_lshlrev_b32 v100, 16, v216
v_and_b32 v101, 0xffff0000, v216
v_lshlrev_b32 v102, 16, v217
v_and_b32 v103, 0xffff0000, v217
v_pk_add_f32 v[148:149], v[148:149], v[100:101]
v_pk_add_f32 v[150:151], v[150:151], v[102:103]
v_cmp_u_f32 vcc, v148, v150
v_cvt_pk_bf16_f32 v180, v148, v149
v_cvt_pk_bf16_f32 v181, v150, v151
s_cbranch_vccz L_gok_425
buffer_load_dwordx2 v[212:213], v17, s[8:11], s22 offen offset:512 sc1
buffer_load_dwordx2 v[214:215], v18, s[8:11], s22 offen offset:512 sc1
buffer_load_dwordx2 v[216:217], v19, s[8:11], s22 offen offset:512 sc1
s_waitcnt vmcnt(5)
v_lshlrev_b32 v100, 16, v200
v_and_b32 v101, 0xffff0000, v200
v_lshlrev_b32 v102, 16, v201
v_and_b32 v103, 0xffff0000, v201
v_pk_add_f32 v[148:149], v[168:169], v[100:101]
v_pk_add_f32 v[150:151], v[170:171], v[102:103]
s_waitcnt vmcnt(4)
v_lshlrev_b32 v100, 16, v202
v_and_b32 v101, 0xffff0000, v202
v_lshlrev_b32 v102, 16, v203
v_and_b32 v103, 0xffff0000, v203
v_pk_add_f32 v[148:149], v[148:149], v[100:101]
v_pk_add_f32 v[150:151], v[150:151], v[102:103]
s_waitcnt vmcnt(3)
v_lshlrev_b32 v100, 16, v204
v_and_b32 v101, 0xffff0000, v204
v_lshlrev_b32 v102, 16, v205
v_and_b32 v103, 0xffff0000, v205
v_pk_add_f32 v[148:149], v[148:149], v[100:101]
v_pk_add_f32 v[150:151], v[150:151], v[102:103]
v_cmp_u_f32 vcc, v148, v150
v_cvt_pk_bf16_f32 v180, v148, v149
v_cvt_pk_bf16_f32 v181, v150, v151
s_cbranch_vccz L_gok_425
s_add_u32 s33, s33, 1
s_cmp_gt_u32 s33, 0x100000
s_cbranch_scc1 chain_kernel_abort
s_and_b32 s20, s33, 63
s_cbranch_scc1 L_rt_427
v_cmp_eq_u32 vcc, s34, v200
v_cmp_eq_u32 s[20:21], s34, v201
s_or_b64 vcc, vcc, s[20:21]
v_cmp_eq_u32 s[20:21], s34, v202
s_or_b64 vcc, vcc, s[20:21]
v_cmp_eq_u32 s[20:21], s34, v203
s_or_b64 vcc, vcc, s[20:21]
v_cmp_eq_u32 s[20:21], s34, v204
s_or_b64 vcc, vcc, s[20:21]
v_cmp_eq_u32 s[20:21], s34, v205
s_or_b64 vcc, vcc, s[20:21]
s_cbranch_vccnz L_rt_427
s_branch L_gok_425
chain_kernel_abort:
s_mov_b64 exec, 1
v_mov_b32 v1, s19
v_or_b32 v1, 0xdead0000, v1
v_mov_b32 v2, 124
buffer_store_dword v1, v2, s[12:15], 0 offen
s_endpgm
chain_kernel_done:
s_mov_b64 exec, -1
s_setprio 0
v_bfe_u32 v13, v0, 3, 2
v_lshlrev_b32 v13, 9, v13
v_and_b32 v14, 7, v0
v_lshl_add_u32 v13, v14, 4, v13
v_bfe_u32 v14, v0, 5, 1
v_lshl_add_u32 v13, v14, 11, v13
s_lshl_b32 s20, s16, 2
s_add_u32 s20, s20, s18
s_lshl_b32 s20, s20, 16
s_add_u32 s21, s30, 0
s_and_b32 s21, s21, 3
s_lshl_b32 s21, s21, 14
s_add_u32 s21, s21, s20
v_add_u32 v2, s21, v13
s_add_u32 s21, s30, 1
s_and_b32 s21, s21, 3
s_lshl_b32 s21, s21, 14
s_add_u32 s21, s21, s20
v_add_u32 v3, s21, v13
s_add_u32 s21, s30, 2
s_and_b32 s21, s21, 3
s_lshl_b32 s21, s21, 14
s_add_u32 s21, s21, s20
v_add_u32 v4, s21, v13
s_add_u32 s21, s30, 3
s_and_b32 s21, s21, 3
s_lshl_b32 s21, s21, 14
s_add_u32 s21, s21, s20
v_add_u32 v5, s21, v13
s_sub_u32 s20, s18, s16
s_lshl_b32 s21, s20, 18
s_sub_u32 s20, 0, s20
s_and_b32 s20, s20, 3
s_lshl_b32 s20, s20, 9
s_add_u32 s20, s20, s21
v_add_u32 v8, s20, v12
v_bfe_u32 v13, v0, 1, 3
v_lshlrev_b32 v9, 13, v13
v_bfe_u32 v13, v0, 4, 2
v_lshl_add_u32 v9, v13, 5, v9
v_and_b32 v13, 1, v0
v_lshl_add_u32 v9, v13, 4, v9
s_xor_b32 s20, s17, 8
s_lshl_b32 s20, s20, 7
s_lshl_b32 s21, s16, 16
s_add_u32 s20, s20, s21
s_add_u32 s20, s20, 4096
v_add_u32 v9, s20, v9
v_lshlrev_b32 v10, 4, v0
v_add_u32 v10, 0x10000, v10
s_lshl_b32 s20, s18, 12
s_add_u32 s20, s20, 0x10000
v_add_u32 v11, s20, v1
s_xor_b32 s20, s18, s17
s_xor_b32 s20, s20, 0
s_and_b32 s20, s20, 3
s_lshl_b32 s21, s20, 7
v_add_u32 v216, s21, v2
v_add_u32 v217, s21, v3
v_add_u32 v218, s21, v4
v_add_u32 v219, s21, v5
s_lshl_b32 s21, s20, 12
v_add_u32 v232, s21, v10
s_xor_b32 s20, s18, s17
s_xor_b32 s20, s20, 1
s_and_b32 s20, s20, 3
s_lshl_b32 s21, s20, 7
v_add_u32 v220, s21, v2
v_add_u32 v221, s21, v3
v_add_u32 v222, s21, v4
v_add_u32 v223, s21, v5
s_lshl_b32 s21, s20, 12
v_add_u32 v233, s21, v10
s_xor_b32 s20, s18, s17
s_xor_b32 s20, s20, 2
s_and_b32 s20, s20, 3
s_lshl_b32 s21, s20, 7
v_add_u32 v224, s21, v2
v_add_u32 v225, s21, v3
v_add_u32 v226, s21, v4
v_add_u32 v227, s21, v5
s_lshl_b32 s21, s20, 12
v_add_u32 v234, s21, v10
s_xor_b32 s20, s18, s17
s_xor_b32 s20, s20, 3
s_and_b32 s20, s20, 3
s_lshl_b32 s21, s20, 7
v_add_u32 v228, s21, v2
v_add_u32 v229, s21, v3
v_add_u32 v230, s21, v4
v_add_u32 v231, s21, v5
s_lshl_b32 s21, s20, 12
v_add_u32 v235, s21, v10
s_lshl_b32 s20, s16, 18
s_lshr_b32 s21, s17, 1
s_lshl_b32 s21, s21, 14
s_add_u32 s20, s20, s21
s_and_b32 s21, s17, 1
s_lshl_b32 s21, s21, 11
s_add_u32 s20, s20, s21
s_lshl_b32 s21, s18, 9
s_add_u32 s20, s20, s21
v_and_b32 v15, 7, v0
v_lshl_add_u32 v15, v15, 6, s20
s_mov_b32 s56, s96
s_and_b32 s57, s97, 0xffff
s_mov_b32 s58, 0x1000000
s_mov_b32 s59, 0x00020000
v_mov_b32 v34, 0
s_lshl_b32 s31, s16, 7
s_mov_b32 s19, 62
s_mov_b32 s40, 0x40000000
s_mov_b32 s41, 0x40000000
L_fp_431:
s_lshl_b32 s21, s19, 9
s_add_u32 s21, s21, s31
s_add_u32 s21, s21, 0x5904000
s_bitcmp1_b32 s19, 1
s_cselect_b32 s38, s52, s35
s_cselect_b32 s39, s35, s52
s_lshl_b32 s20, s19, 20
s_add_u32 s39, s39, s20
s_add_u32 s38, s38, s20
s_add_u32 s38, s38, 0x8000000
v_mov_b32 v112, 0
v_mov_b32 v113, 0
v_mov_b32 v114, 0
v_mov_b32 v115, 0
v_mov_b32 v116, 0
v_mov_b32 v117, 0
v_mov_b32 v118, 0
v_mov_b32 v119, 0
v_mov_b32 v120, 0
v_mov_b32 v121, 0
v_mov_b32 v122, 0
v_mov_b32 v123, 0
v_mov_b32 v124, 0
v_mov_b32 v125, 0
v_mov_b32 v126, 0
v_mov_b32 v127, 0
v_mov_b32 v128, 0
v_mov_b32 v129, 0
v_mov_b32 v130, 0
v_mov_b32 v131, 0
v_mov_b32 v132, 0
v_mov_b32 v133, 0
v_mov_b32 v134, 0
v_mov_b32 v135, 0
v_mov_b32 v136, 0
v_mov_b32 v137, 0
v_mov_b32 v138, 0
v_mov_b32 v139, 0
v_mov_b32 v140, 0
v_mov_b32 v141, 0
v_mov_b32 v142, 0
v_mov_b32 v143, 0
s_cmp_lt_u32 s19, 62
s_cbranch_scc1 L_fgo_437
L_fw_436:
buffer_load_dword v35, v34, s[8:11], s21 offen sc1
s_add_u32 s33, s33, 1
s_cmp_gt_u32 s33, 0x100000
s_cbranch_scc1 chain_kernel_abort
s_waitcnt vmcnt(0)
v_readfirstlane_b32 s20, v35
s_cmp_ge_u32 s20, 8
s_cbranch_scc0 L_fw_436
buffer_load_dword v14, v15, s[8:11], s39 offen offset:2048
L_fgo_437:
buffer_load_dwordx4 v[48:51], v216, s[8:11], s39 offen offset:2048
buffer_load_dwordx4 v[52:55], v217, s[8:11], s39 offen offset:2048
buffer_load_dwordx4 v[56:59], v218, s[8:11], s39 offen offset:2048
buffer_load_dwordx4 v[60:63], v219, s[8:11], s39 offen offset:2048
buffer_load_dwordx4 v[64:67], v220, s[8:11], s39 offen offset:2048
buffer_load_dwordx4 v[68:71], v221, s[8:11], s39 offen offset:2048
buffer_load_dwordx4 v[72:75], v222, s[8:11], s39 offen offset:2048
buffer_load_dwordx4 v[76:79], v223, s[8:11], s39 offen offset:2048
buffer_load_dwordx4 v[80:83], v224, s[8:11], s39 offen offset:2048
buffer_load_dwordx4 v[84:87], v225, s[8:11], s39 offen offset:2048
buffer_load_dwordx4 v[88:91], v226, s[8:11], s39 offen offset:2048
buffer_load_dwordx4 v[92:95], v227, s[8:11], s39 offen offset:2048
buffer_load_dwordx4 v[96:99], v228, s[8:11], s39 offen offset:2048
buffer_load_dwordx4 v[100:103], v229, s[8:11], s39 offen offset:2048
buffer_load_dwordx4 v[104:107], v230, s[8:11], s39 offen offset:2048
buffer_load_dwordx4 v[108:111], v231, s[8:11], s39 offen offset:2048
buffer_load_dwordx2 v[168:169], v12, s[8:11], s40 offen offset:1024 sc1
buffer_load_dwordx2 v[170:171], v12, s[8:11], s40 offen offset:1536 sc1
buffer_load_dwordx2 v[172:173], v12, s[8:11], s40 offen offset:2048 sc1
s_waitcnt vmcnt(18)
v_smfmac_f32_16x16x64_bf16 v[112:115], v[48:51], a[192:199], v6
v_smfmac_f32_16x16x64_bf16 v[116:119], v[48:51], a[224:231], v6
s_waitcnt vmcnt(17)
v_smfmac_f32_16x16x64_bf16 v[112:115], v[52:55], a[200:207], v6
v_smfmac_f32_16x16x64_bf16 v[116:119], v[52:55], a[232:239], v6
s_waitcnt vmcnt(16)
v_smfmac_f32_16x16x64_bf16 v[112:115], v[56:59], a[208:215], v6
v_smfmac_f32_16x16x64_bf16 v[116:119], v[56:59], a[240:247], v6
s_waitcnt vmcnt(15)
v_smfmac_f32_16x16x64_bf16 v[112:115], v[60:63], a[216:223], v6
v_smfmac_f32_16x16x64_bf16 v[116:119], v[60:63], a[248:255], v6
s_waitcnt vmcnt(14)
v_smfmac_f32_16x16x64_bf16 v[120:123], v[64:67], a[192:199], v6
v_smfmac_f32_16x16x64_bf16 v[124:127], v[64:67], a[224:231], v6
s_waitcnt vmcnt(13)
v_smfmac_f32_16x16x64_bf16 v[120:123], v[68:71], a[200:207], v6
v_smfmac_f32_16x16x64_bf16 v[124:127], v[68:71], a[232:239], v6
v_cvt_pk_bf16_f32 v144, v112, v113
v_cvt_pk_bf16_f32 v145, v114, v115
v_cvt_pk_bf16_f32 v146, v116, v117
v_cvt_pk_bf16_f32 v147, v118, v119
s_nop 1
v_mfma_f32_16x16x32_bf16 v[200:203], v[144:147], v[252:255], 0
s_waitcnt vmcnt(12)
v_smfmac_f32_16x16x64_bf16 v[120:123], v[72:75], a[208:215], v6
v_smfmac_f32_16x16x64_bf16 v[124:127], v[72:75], a[240:247], v6
s_waitcnt vmcnt(11)
v_smfmac_f32_16x16x64_bf16 v[120:123], v[76:79], a[216:223], v6
v_smfmac_f32_16x16x64_bf16 v[124:127], v[76:79], a[248:255], v6
ds_write_b128 v232, v[200:203]
s_waitcnt vmcnt(10)
v_smfmac_f32_16x16x64_bf16 v[128:131], v[80:83], a[192:199], v6
v_smfmac_f32_16x16x64_bf16 v[132:135], v[80:83], a[224:231], v6
s_waitcnt vmcnt(9)
v_smfmac_f32_16x16x64_bf16 v[128:131], v[84:87], a[200:207], v6
v_smfmac_f32_16x16x64_bf16 v[132:135], v[84:87], a[232:239], v6
v_cvt_pk_bf16_f32 v148, v120, v121
v_cvt_pk_bf16_f32 v149, v122, v123
v_cvt_pk_bf16_f32 v150, v124, v125
v_cvt_pk_bf16_f32 v151, v126, v127
s_nop 1
v_mfma_f32_16x16x32_bf16 v[204:207], v[148:151], v[252:255], 0
s_waitcnt vmcnt(8)
v_smfmac_f32_16x16x64_bf16 v[128:131], v[88:91], a[208:215], v6
v_smfmac_f32_16x16x64_bf16 v[132:135], v[88:91], a[240:247], v6
s_waitcnt vmcnt(7)
v_smfmac_f32_16x16x64_bf16 v[128:131], v[92:95], a[216:223], v6
v_smfmac_f32_16x16x64_bf16 v[132:135], v[92:95], a[248:255], v6
ds_write_b128 v233, v[204:207]
s_waitcnt vmcnt(6)
v_smfmac_f32_16x16x64_bf16 v[136:139], v[96:99], a[192:199], v6
v_smfmac_f32_16x16x64_bf16 v[140:143], v[96:99], a[224:231], v6
s_waitcnt vmcnt(5)
v_smfmac_f32_16x16x64_bf16 v[136:139], v[100:103], a[200:207], v6
v_smfmac_f32_16x16x64_bf16 v[140:143], v[100:103], a[232:239], v6
v_cvt_pk_bf16_f32 v152, v128, v129
v_cvt_pk_bf16_f32 v153, v130, v131
v_cvt_pk_bf16_f32 v154, v132, v133
v_cvt_pk_bf16_f32 v155, v134, v135
s_nop 1
v_mfma_f32_16x16x32_bf16 v[208:211], v[152:155], v[252:255], 0
s_waitcnt vmcnt(4)
v_smfmac_f32_16x16x64_bf16 v[136:139], v[104:107], a[208:215], v6
v_smfmac_f32_16x16x64_bf16 v[140:143], v[104:107], a[240:247], v6
s_waitcnt vmcnt(3)
v_smfmac_f32_16x16x64_bf16 v[136:139], v[108:111], a[216:223], v6
v_smfmac_f32_16x16x64_bf16 v[140:143], v[108:111], a[248:255], v6
ds_write_b128 v234, v[208:211]
s_nop 6
v_cvt_pk_bf16_f32 v156, v136, v137
v_cvt_pk_bf16_f32 v157, v138, v139
v_cvt_pk_bf16_f32 v158, v140, v141
v_cvt_pk_bf16_f32 v159, v142, v143
s_nop 1
v_mfma_f32_16x16x32_bf16 v[212:215], v[156:159], v[252:255], 0
s_nop 7
ds_write_b128 v235, v[212:215]
s_waitcnt lgkmcnt(0)
s_barrier
ds_read_b128 v[200:203], v11 offset:0
ds_read_b128 v[204:207], v11 offset:1024
ds_read_b128 v[208:211], v11 offset:2048
ds_read_b128 v[212:215], v11 offset:3072
v_xor_b32 v232, 0x4000, v232
v_xor_b32 v233, 0x4000, v233
v_xor_b32 v234, 0x4000, v234
v_xor_b32 v235, 0x4000, v235
v_xor_b32 v11, 0x4000, v11
s_cmp_eq_u32 s18, s16
s_cselect_b32 s22, 0x40000000, s38
s_waitcnt lgkmcnt(2)
v_pk_add_f32 v[160:161], v[200:201], v[204:205]
v_pk_add_f32 v[162:163], v[202:203], v[206:207]
s_waitcnt lgkmcnt(0)
v_pk_add_f32 v[208:209], v[208:209], v[212:213]
v_pk_add_f32 v[210:211], v[210:211], v[214:215]
v_pk_add_f32 v[160:161], v[160:161], v[208:209]
v_pk_add_f32 v[162:163], v[162:163], v[210:211]
v_cvt_pk_bf16_f32 v200, v160, v161
v_cvt_pk_bf16_f32 v201, v162, v163
buffer_store_dwordx2 v[200:201], v8, s[8:11], s22 offen offset:512 sc1
s_cbranch_scc0 L_fskip_433
s_waitcnt vmcnt(1)
s_branch L_fhave_438
L_ffin_432:
s_nop 15
s_nop 15
s_nop 15
s_nop 15
L_frt_434:
buffer_load_dwordx2 v[168:169], v12, s[8:11], s40 offen offset:1024 sc1
buffer_load_dwordx2 v[170:171], v12, s[8:11], s40 offen offset:1536 sc1
buffer_load_dwordx2 v[172:173], v12, s[8:11], s40 offen offset:2048 sc1
s_add_u32 s33, s33, 1
s_cmp_gt_u32 s33, 0x100000
s_cbranch_scc1 chain_kernel_abort
s_waitcnt vmcnt(0)
L_fhave_438:
v_max3_u32 v7, v168, v169, v170
v_max3_u32 v7, v7, v171, v172
v_max_u32 v7, v7, v173
v_cmp_eq_u32 vcc, s34, v7
s_cbranch_vccnz L_frt_434
v_lshlrev_b32 v176, 16, v168
v_and_b32 v177, 0xffff0000, v168
v_lshlrev_b32 v178, 16, v169
v_and_b32 v179, 0xffff0000, v169
v_pk_add_f32 v[164:165], v[164:165], v[176:177]
v_pk_add_f32 v[166:167], v[166:167], v[178:179]
v_lshlrev_b32 v176, 16, v170
v_and_b32 v177, 0xffff0000, v170
v_lshlrev_b32 v178, 16, v171
v_and_b32 v179, 0xffff0000, v171
v_pk_add_f32 v[164:165], v[164:165], v[176:177]
v_pk_add_f32 v[166:167], v[166:167], v[178:179]
v_lshlrev_b32 v176, 16, v172
v_and_b32 v177, 0xffff0000, v172
v_lshlrev_b32 v178, 16, v173
v_and_b32 v179, 0xffff0000, v173
v_pk_add_f32 v[164:165], v[164:165], v[176:177]
v_pk_add_f32 v[166:167], v[166:167], v[178:179]
v_cvt_pk_bf16_f32 v176, 0, v164
v_cvt_pk_bf16_f32 v177, 0, v165
v_cvt_pk_bf16_f32 v178, 0, v166
v_cvt_pk_bf16_f32 v179, 0, v167
buffer_store_dwordx4 v[176:179], v9, s[56:59], s41 offen
v_mov_b32 v164, v160
v_mov_b32 v165, v161
v_mov_b32 v166, v162
v_mov_b32 v167, v163
s_mov_b32 s40, s38
s_lshl_b32 s41, s19, 18
s_add_u32 s19, s19, 1
s_cmp_lt_u32 s19, 64
s_cbranch_scc1 L_fp_431
s_cmp_eq_u32 s19, 64
s_cbranch_scc1 L_ffin_432
s_branch L_fend_435
L_fskip_433:
s_add_u32 s19, s19, 1
s_cmp_lt_u32 s19, 64
s_cbranch_scc1 L_fp_431
L_fend_435:
s_endpgm
chain_kernel_worker:
s_sub_u32 s40, s16, 4
s_lshl_b32 s40, s40, 2
s_lshr_b32 s40, 0x3210, s40
s_and_b32 s40, s40, 3
s_mov_b32 s41, s17
s_mov_b32 s49, s18
s_mov_b32 s12, s100
s_and_b32 s13, s101, 0xffff
s_mov_b32 s14, 0x10000000
s_mov_b32 s15, 0x00020000
s_mov_b32 s36, 0
v_mov_b32 v84, 1
v_min_u32 v85, 1, v0
v_lshlrev_b32 v85, 30, v85
s_cmp_eq_u32 s40, 3
s_cbranch_scc1 L_g1_441
s_mov_b32 s25, s40
s_cmp_eq_u32 s25, 1
s_cselect_b32 s16, s90, s88
s_cselect_b32 s17, s91, s89
s_cmp_eq_u32 s25, 2
s_cselect_b32 s16, s86, s16
s_cselect_b32 s17, s87, s17
s_and_b32 s17, s17, 0xffff
s_mov_b32 s18, 0x800000
s_mov_b32 s19, 0x00020000
s_mov_b32 s46, s41
s_lshl_b32 s44, s46, 8
s_mov_b32 s8, s82
s_and_b32 s9, s83, 0xffff
s_mov_b32 s10, 0x400000
s_mov_b32 s11, 0x00020000
v_lshlrev_b32 v1, 4, v0
s_lshl_b32 s25, s41, 12
buffer_load_dwordx4 v[52:55], v1, s[8:11], s25 offen
s_add_u32 s25, s25, 131072
buffer_load_dwordx4 v[52:55], v1, s[8:11], s25 offen
s_add_u32 s25, s25, 131072
v_and_b32 v1, 15, v0
v_bfe_u32 v2, v0, 4, 2
v_lshrrev_b32 v3, 6, v0
v_lshlrev_b32 v4, 2, v2
v_xor_b32 v4, v4, v1
v_lshlrev_b32 v4, 4, v4
v_lshl_add_u32 v5, v3, 5, v2
s_mov_b32 s25, 8192
v_mul_lo_u32 v5, v5, s25
v_add_u32 v20, v5, v4
v_bfe_u32 v4, v0, 2, 2
v_lshl_add_u32 v5, v2, 3, v4
v_lshlrev_b32 v5, 8, v5
v_xor_b32 v4, v4, v3
v_lshl_add_u32 v5, v4, 6, v5
v_and_b32 v4, 3, v0
v_lshl_add_u32 v5, v4, 3, v5
v_and_b32 v4, 2, v4
v_lshl_add_u32 v21, v4, 3, v5
v_add_u32 v22, 16, v21
v_add_u32 v23, 0x10000, v21
v_add_u32 v24, 0x10000, v22
s_lshl_b32 s26, s49, 13
s_mov_b32 s25, s44
s_barrier
s_add_u32 m0, s26, 0
s_add_u32 s27, s25, 0
buffer_load_dwordx4 v20, s[16:19], s27 offen lds
s_add_u32 m0, s26, 1024
s_add_u32 s27, s25, 32768
buffer_load_dwordx4 v20, s[16:19], s27 offen lds
s_add_u32 m0, s26, 2048
s_add_u32 s27, s25, 65536
buffer_load_dwordx4 v20, s[16:19], s27 offen lds
s_add_u32 m0, s26, 3072
s_add_u32 s27, s25, 98304
buffer_load_dwordx4 v20, s[16:19], s27 offen lds
s_add_u32 m0, s26, 4096
s_add_u32 s27, s25, 131072
buffer_load_dwordx4 v20, s[16:19], s27 offen lds
s_add_u32 m0, s26, 5120
s_add_u32 s27, s25, 163840
buffer_load_dwordx4 v20, s[16:19], s27 offen lds
s_add_u32 m0, s26, 6144
s_add_u32 s27, s25, 196608
buffer_load_dwordx4 v20, s[16:19], s27 offen lds
s_add_u32 m0, s26, 7168
s_add_u32 s27, s25, 229376
buffer_load_dwordx4 v20, s[16:19], s27 offen lds
s_add_u32 m0, s26, 32768
s_add_u32 s27, s25, 1048576
buffer_load_dwordx4 v20, s[16:19], s27 offen lds
s_add_u32 m0, s26, 33792
s_add_u32 s27, s25, 1081344
buffer_load_dwordx4 v20, s[16:19], s27 offen lds
s_add_u32 m0, s26, 34816
s_add_u32 s27, s25, 1114112
buffer_load_dwordx4 v20, s[16:19], s27 offen lds
s_add_u32 m0, s26, 35840
s_add_u32 s27, s25, 1146880
buffer_load_dwordx4 v20, s[16:19], s27 offen lds
s_add_u32 m0, s26, 36864
s_add_u32 s27, s25, 1179648
buffer_load_dwordx4 v20, s[16:19], s27 offen lds
s_add_u32 m0, s26, 37888
s_add_u32 s27, s25, 1212416
buffer_load_dwordx4 v20, s[16:19], s27 offen lds
s_add_u32 m0, s26, 38912
s_add_u32 s27, s25, 1245184
buffer_load_dwordx4 v20, s[16:19], s27 offen lds
s_add_u32 m0, s26, 39936
s_add_u32 s27, s25, 1277952
buffer_load_dwordx4 v20, s[16:19], s27 offen lds
s_add_u32 m0, s26, 65536
s_add_u32 s27, s25, 2097152
buffer_load_dwordx4 v20, s[16:19], s27 offen lds
s_add_u32 m0, s26, 66560
s_add_u32 s27, s25, 2129920
buffer_load_dwordx4 v20, s[16:19], s27 offen lds
s_add_u32 m0, s26, 67584
s_add_u32 s27, s25, 2162688
buffer_load_dwordx4 v20, s[16:19], s27 offen lds
s_add_u32 m0, s26, 68608
s_add_u32 s27, s25, 2195456
buffer_load_dwordx4 v20, s[16:19], s27 offen lds
s_add_u32 m0, s26, 69632
s_add_u32 s27, s25, 2228224
buffer_load_dwordx4 v20, s[16:19], s27 offen lds
s_add_u32 m0, s26, 70656
s_add_u32 s27, s25, 2260992
buffer_load_dwordx4 v20, s[16:19], s27 offen lds
s_add_u32 m0, s26, 71680
s_add_u32 s27, s25, 2293760
buffer_load_dwordx4 v20, s[16:19], s27 offen lds
s_add_u32 m0, s26, 72704
s_add_u32 s27, s25, 2326528
buffer_load_dwordx4 v20, s[16:19], s27 offen lds
s_add_u32 m0, s26, 98304
s_add_u32 s27, s25, 3145728
buffer_load_dwordx4 v20, s[16:19], s27 offen lds
s_add_u32 m0, s26, 99328
s_add_u32 s27, s25, 3178496
buffer_load_dwordx4 v20, s[16:19], s27 offen lds
s_add_u32 m0, s26, 100352
s_add_u32 s27, s25, 3211264
buffer_load_dwordx4 v20, s[16:19], s27 offen lds
s_add_u32 m0, s26, 101376
s_add_u32 s27, s25, 3244032
buffer_load_dwordx4 v20, s[16:19], s27 offen lds
s_add_u32 m0, s26, 102400
s_add_u32 s27, s25, 3276800
buffer_load_dwordx4 v20, s[16:19], s27 offen lds
s_add_u32 m0, s26, 103424
s_add_u32 s27, s25, 3309568
buffer_load_dwordx4 v20, s[16:19], s27 offen lds
s_add_u32 m0, s26, 104448
s_add_u32 s27, s25, 3342336
buffer_load_dwordx4 v20, s[16:19], s27 offen lds
s_add_u32 m0, s26, 105472
s_add_u32 s27, s25, 3375104
buffer_load_dwordx4 v20, s[16:19], s27 offen lds
s_waitcnt vmcnt(24)
s_barrier
ds_read_b64_tr_b16 a[0:1], v21 offset:0
ds_read_b64_tr_b16 a[2:3], v21 offset:1024
ds_read_b64_tr_b16 a[4:5], v22 offset:0
ds_read_b64_tr_b16 a[6:7], v22 offset:1024
ds_read_b64_tr_b16 a[8:9], v21 offset:8192
ds_read_b64_tr_b16 a[10:11], v21 offset:9216
ds_read_b64_tr_b16 a[12:13], v22 offset:8192
ds_read_b64_tr_b16 a[14:15], v22 offset:9216
s_waitcnt lgkmcnt(0)
ds_read_b64_tr_b16 a[16:17], v21 offset:16384
ds_read_b64_tr_b16 a[18:19], v21 offset:17408
ds_read_b64_tr_b16 a[20:21], v22 offset:16384
ds_read_b64_tr_b16 a[22:23], v22 offset:17408
ds_read_b64_tr_b16 a[24:25], v21 offset:24576
ds_read_b64_tr_b16 a[26:27], v21 offset:25600
ds_read_b64_tr_b16 a[28:29], v22 offset:24576
ds_read_b64_tr_b16 a[30:31], v22 offset:25600
s_waitcnt lgkmcnt(0)
s_barrier
s_add_u32 m0, s26, 0
s_add_u32 s27, s25, 4194304
buffer_load_dwordx4 v20, s[16:19], s27 offen lds
s_add_u32 m0, s26, 1024
s_add_u32 s27, s25, 4227072
buffer_load_dwordx4 v20, s[16:19], s27 offen lds
s_add_u32 m0, s26, 2048
s_add_u32 s27, s25, 4259840
buffer_load_dwordx4 v20, s[16:19], s27 offen lds
s_add_u32 m0, s26, 3072
s_add_u32 s27, s25, 4292608
buffer_load_dwordx4 v20, s[16:19], s27 offen lds
s_add_u32 m0, s26, 4096
s_add_u32 s27, s25, 4325376
buffer_load_dwordx4 v20, s[16:19], s27 offen lds
s_add_u32 m0, s26, 5120
s_add_u32 s27, s25, 4358144
buffer_load_dwordx4 v20, s[16:19], s27 offen lds
s_add_u32 m0, s26, 6144
s_add_u32 s27, s25, 4390912
buffer_load_dwordx4 v20, s[16:19], s27 offen lds
s_add_u32 m0, s26, 7168
s_add_u32 s27, s25, 4423680
buffer_load_dwordx4 v20, s[16:19], s27 offen lds
s_waitcnt vmcnt(24)
s_barrier
ds_read_b64_tr_b16 a[32:33], v21 offset:32768
ds_read_b64_tr_b16 a[34:35], v21 offset:33792
ds_read_b64_tr_b16 a[36:37], v22 offset:32768
ds_read_b64_tr_b16 a[38:39], v22 offset:33792
ds_read_b64_tr_b16 a[40:41], v21 offset:40960
ds_read_b64_tr_b16 a[42:43], v21 offset:41984
ds_read_b64_tr_b16 a[44:45], v22 offset:40960
ds_read_b64_tr_b16 a[46:47], v22 offset:41984
s_waitcnt lgkmcnt(0)
ds_read_b64_tr_b16 a[48:49], v21 offset:49152
ds_read_b64_tr_b16 a[50:51], v21 offset:50176
ds_read_b64_tr_b16 a[52:53], v22 offset:49152
ds_read_b64_tr_b16 a[54:55], v22 offset:50176
ds_read_b64_tr_b16 a[56:57], v21 offset:57344
ds_read_b64_tr_b16 a[58:59], v21 offset:58368
ds_read_b64_tr_b16 a[60:61], v22 offset:57344
ds_read_b64_tr_b16 a[62:63], v22 offset:58368
s_waitcnt lgkmcnt(0)
s_barrier
s_add_u32 m0, s26, 32768
s_add_u32 s27, s25, 5242880
buffer_load_dwordx4 v20, s[16:19], s27 offen lds
s_add_u32 m0, s26, 33792
s_add_u32 s27, s25, 5275648
buffer_load_dwordx4 v20, s[16:19], s27 offen lds
s_add_u32 m0, s26, 34816
s_add_u32 s27, s25, 5308416
buffer_load_dwordx4 v20, s[16:19], s27 offen lds
s_add_u32 m0, s26, 35840
s_add_u32 s27, s25, 5341184
buffer_load_dwordx4 v20, s[16:19], s27 offen lds
s_add_u32 m0, s26, 36864
s_add_u32 s27, s25, 5373952
buffer_load_dwordx4 v20, s[16:19], s27 offen lds
s_add_u32 m0, s26, 37888
s_add_u32 s27, s25, 5406720
buffer_load_dwordx4 v20, s[16:19], s27 offen lds
s_add_u32 m0, s26, 38912
s_add_u32 s27, s25, 5439488
buffer_load_dwordx4 v20, s[16:19], s27 offen lds
s_add_u32 m0, s26, 39936
s_add_u32 s27, s25, 5472256
buffer_load_dwordx4 v20, s[16:19], s27 offen lds
s_waitcnt vmcnt(24)
s_barrier
ds_read_b64_tr_b16 a[64:65], v23 offset:0
ds_read_b64_tr_b16 a[66:67], v23 offset:1024
ds_read_b64_tr_b16 a[68:69], v24 offset:0
ds_read_b64_tr_b16 a[70:71], v24 offset:1024
ds_read_b64_tr_b16 a[72:73], v23 offset:8192
ds_read_b64_tr_b16 a[74:75], v23 offset:9216
ds_read_b64_tr_b16 a[76:77], v24 offset:8192
ds_read_b64_tr_b16 a[78:79], v24 offset:9216
s_waitcnt lgkmcnt(0)
ds_read_b64_tr_b16 a[80:81], v23 offset:16384
ds_read_b64_tr_b16 a[82:83], v23 offset:17408
ds_read_b64_tr_b16 a[84:85], v24 offset:16384
ds_read_b64_tr_b16 a[86:87], v24 offset:17408
ds_read_b64_tr_b16 a[88:89], v23 offset:24576
ds_read_b64_tr_b16 a[90:91], v23 offset:25600
ds_read_b64_tr_b16 a[92:93], v24 offset:24576
ds_read_b64_tr_b16 a[94:95], v24 offset:25600
s_waitcnt lgkmcnt(0)
s_barrier
s_add_u32 m0, s26, 65536
s_add_u32 s27, s25, 6291456
buffer_load_dwordx4 v20, s[16:19], s27 offen lds
s_add_u32 m0, s26, 66560
s_add_u32 s27, s25, 6324224
buffer_load_dwordx4 v20, s[16:19], s27 offen lds
s_add_u32 m0, s26, 67584
s_add_u32 s27, s25, 6356992
buffer_load_dwordx4 v20, s[16:19], s27 offen lds
s_add_u32 m0, s26, 68608
s_add_u32 s27, s25, 6389760
buffer_load_dwordx4 v20, s[16:19], s27 offen lds
s_add_u32 m0, s26, 69632
s_add_u32 s27, s25, 6422528
buffer_load_dwordx4 v20, s[16:19], s27 offen lds
s_add_u32 m0, s26, 70656
s_add_u32 s27, s25, 6455296
buffer_load_dwordx4 v20, s[16:19], s27 offen lds
s_add_u32 m0, s26, 71680
s_add_u32 s27, s25, 6488064
buffer_load_dwordx4 v20, s[16:19], s27 offen lds
s_add_u32 m0, s26, 72704
s_add_u32 s27, s25, 6520832
buffer_load_dwordx4 v20, s[16:19], s27 offen lds
s_waitcnt vmcnt(24)
s_barrier
ds_read_b64_tr_b16 a[96:97], v23 offset:32768
ds_read_b64_tr_b16 a[98:99], v23 offset:33792
ds_read_b64_tr_b16 a[100:101], v24 offset:32768
ds_read_b64_tr_b16 a[102:103], v24 offset:33792
ds_read_b64_tr_b16 a[104:105], v23 offset:40960
ds_read_b64_tr_b16 a[106:107], v23 offset:41984
ds_read_b64_tr_b16 a[108:109], v24 offset:40960
ds_read_b64_tr_b16 a[110:111], v24 offset:41984
s_waitcnt lgkmcnt(0)
ds_read_b64_tr_b16 a[112:113], v23 offset:49152
ds_read_b64_tr_b16 a[114:115], v23 offset:50176
ds_read_b64_tr_b16 a[116:117], v24 offset:49152
ds_read_b64_tr_b16 a[118:119], v24 offset:50176
ds_read_b64_tr_b16 a[120:121], v23 offset:57344
ds_read_b64_tr_b16 a[122:123], v23 offset:58368
ds_read_b64_tr_b16 a[124:125], v24 offset:57344
ds_read_b64_tr_b16 a[126:127], v24 offset:58368
s_waitcnt lgkmcnt(0)
s_barrier
s_add_u32 m0, s26, 98304
s_add_u32 s27, s25, 7340032
buffer_load_dwordx4 v20, s[16:19], s27 offen lds
s_add_u32 m0, s26, 99328
s_add_u32 s27, s25, 7372800
buffer_load_dwordx4 v20, s[16:19], s27 offen lds
s_add_u32 m0, s26, 100352
s_add_u32 s27, s25, 7405568
buffer_load_dwordx4 v20, s[16:19], s27 offen lds
s_add_u32 m0, s26, 101376
s_add_u32 s27, s25, 7438336
buffer_load_dwordx4 v20, s[16:19], s27 offen lds
s_add_u32 m0, s26, 102400
s_add_u32 s27, s25, 7471104
buffer_load_dwordx4 v20, s[16:19], s27 offen lds
s_add_u32 m0, s26, 103424
s_add_u32 s27, s25, 7503872
buffer_load_dwordx4 v20, s[16:19], s27 offen lds
s_add_u32 m0, s26, 104448
s_add_u32 s27, s25, 7536640
buffer_load_dwordx4 v20, s[16:19], s27 offen lds
s_add_u32 m0, s26, 105472
s_add_u32 s27, s25, 7569408
buffer_load_dwordx4 v20, s[16:19], s27 offen lds
s_waitcnt vmcnt(24)
s_barrier
ds_read_b64_tr_b16 a[128:129], v21 offset:0
ds_read_b64_tr_b16 a[130:131], v21 offset:1024
ds_read_b64_tr_b16 a[132:133], v22 offset:0
ds_read_b64_tr_b16 a[134:135], v22 offset:1024
ds_read_b64_tr_b16 a[136:137], v21 offset:8192
ds_read_b64_tr_b16 a[138:139], v21 offset:9216
ds_read_b64_tr_b16 a[140:141], v22 offset:8192
ds_read_b64_tr_b16 a[142:143], v22 offset:9216
s_waitcnt lgkmcnt(0)
ds_read_b64_tr_b16 a[144:145], v21 offset:16384
ds_read_b64_tr_b16 a[146:147], v21 offset:17408
ds_read_b64_tr_b16 a[148:149], v22 offset:16384
ds_read_b64_tr_b16 a[150:151], v22 offset:17408
ds_read_b64_tr_b16 a[152:153], v21 offset:24576
ds_read_b64_tr_b16 a[154:155], v21 offset:25600
ds_read_b64_tr_b16 a[156:157], v22 offset:24576
ds_read_b64_tr_b16 a[158:159], v22 offset:25600
s_waitcnt lgkmcnt(0)
s_waitcnt vmcnt(16)
s_barrier
ds_read_b64_tr_b16 a[160:161], v21 offset:32768
ds_read_b64_tr_b16 a[162:163], v21 offset:33792
ds_read_b64_tr_b16 a[164:165], v22 offset:32768
ds_read_b64_tr_b16 a[166:167], v22 offset:33792
ds_read_b64_tr_b16 a[168:169], v21 offset:40960
ds_read_b64_tr_b16 a[170:171], v21 offset:41984
ds_read_b64_tr_b16 a[172:173], v22 offset:40960
ds_read_b64_tr_b16 a[174:175], v22 offset:41984
s_waitcnt lgkmcnt(0)
ds_read_b64_tr_b16 a[176:177], v21 offset:49152
ds_read_b64_tr_b16 a[178:179], v21 offset:50176
ds_read_b64_tr_b16 a[180:181], v22 offset:49152
ds_read_b64_tr_b16 a[182:183], v22 offset:50176
ds_read_b64_tr_b16 a[184:185], v21 offset:57344
ds_read_b64_tr_b16 a[186:187], v21 offset:58368
ds_read_b64_tr_b16 a[188:189], v22 offset:57344
ds_read_b64_tr_b16 a[190:191], v22 offset:58368
s_waitcnt lgkmcnt(0)
s_waitcnt vmcnt(8)
s_barrier
ds_read_b64_tr_b16 a[192:193], v23 offset:0
ds_read_b64_tr_b16 a[194:195], v23 offset:1024
ds_read_b64_tr_b16 a[196:197], v24 offset:0
ds_read_b64_tr_b16 a[198:199], v24 offset:1024
ds_read_b64_tr_b16 a[200:201], v23 offset:8192
ds_read_b64_tr_b16 a[202:203], v23 offset:9216
ds_read_b64_tr_b16 a[204:205], v24 offset:8192
ds_read_b64_tr_b16 a[206:207], v24 offset:9216
s_waitcnt lgkmcnt(0)
ds_read_b64_tr_b16 a[208:209], v23 offset:16384
ds_read_b64_tr_b16 a[210:211], v23 offset:17408
ds_read_b64_tr_b16 a[212:213], v24 offset:16384
ds_read_b64_tr_b16 a[214:215], v24 offset:17408
ds_read_b64_tr_b16 a[216:217], v23 offset:24576
ds_read_b64_tr_b16 a[218:219], v23 offset:25600
ds_read_b64_tr_b16 a[220:221], v24 offset:24576
ds_read_b64_tr_b16 a[222:223], v24 offset:25600
s_waitcnt lgkmcnt(0)
s_waitcnt vmcnt(0)
s_barrier
ds_read_b64_tr_b16 a[224:225], v23 offset:32768
ds_read_b64_tr_b16 a[226:227], v23 offset:33792
ds_read_b64_tr_b16 a[228:229], v24 offset:32768
ds_read_b64_tr_b16 a[230:231], v24 offset:33792
ds_read_b64_tr_b16 a[232:233], v23 offset:40960
ds_read_b64_tr_b16 a[234:235], v23 offset:41984
ds_read_b64_tr_b16 a[236:237], v24 offset:40960
ds_read_b64_tr_b16 a[238:239], v24 offset:41984
s_waitcnt lgkmcnt(0)
ds_read_b64_tr_b16 a[240:241], v23 offset:49152
ds_read_b64_tr_b16 a[242:243], v23 offset:50176
ds_read_b64_tr_b16 a[244:245], v24 offset:49152
ds_read_b64_tr_b16 a[246:247], v24 offset:50176
ds_read_b64_tr_b16 a[248:249], v23 offset:57344
ds_read_b64_tr_b16 a[250:251], v23 offset:58368
ds_read_b64_tr_b16 a[252:253], v24 offset:57344
ds_read_b64_tr_b16 a[254:255], v24 offset:58368
s_waitcnt lgkmcnt(0)
s_lshl_b32 s21, s49, 12
v_and_b32 v1, 63, v0
v_and_b32 v2, 15, v0
v_bfe_u32 v3, v0, 4, 2
v_lshrrev_b32 v4, 6, v0
v_lshrrev_b32 v5, 5, v1
v_lshl_add_u32 v5, v4, 3, v5
v_add_u32 v5, 0, v5
v_and_b32 v6, 7, v5
v_lshrrev_b32 v7, 4, v5
v_lshl_add_u32 v6, v7, 3, v6
v_and_b32 v7, 31, v1
v_xor_b32 v6, v6, v7
v_lshlrev_b32 v6, 4, v6
v_lshl_add_u32 v8, v5, 11, v6
v_lshrrev_b32 v5, 5, v1
v_lshl_add_u32 v5, v4, 3, v5
v_add_u32 v5, 2, v5
v_and_b32 v6, 7, v5
v_lshrrev_b32 v7, 4, v5
v_lshl_add_u32 v6, v7, 3, v6
v_and_b32 v7, 31, v1
v_xor_b32 v6, v6, v7
v_lshlrev_b32 v6, 4, v6
v_lshl_add_u32 v9, v5, 11, v6
v_lshrrev_b32 v5, 5, v1
v_lshl_add_u32 v5, v4, 3, v5
v_add_u32 v5, 4, v5
v_and_b32 v6, 7, v5
v_lshrrev_b32 v7, 4, v5
v_lshl_add_u32 v6, v7, 3, v6
v_and_b32 v7, 31, v1
v_xor_b32 v6, v6, v7
v_lshlrev_b32 v6, 4, v6
v_lshl_add_u32 v10, v5, 11, v6
v_lshrrev_b32 v5, 5, v1
v_lshl_add_u32 v5, v4, 3, v5
v_add_u32 v5, 6, v5
v_and_b32 v6, 7, v5
v_lshrrev_b32 v7, 4, v5
v_lshl_add_u32 v6, v7, 3, v6
v_and_b32 v7, 31, v1
v_xor_b32 v6, v6, v7
v_lshlrev_b32 v6, 4, v6
v_lshl_add_u32 v11, v5, 11, v6
v_and_b32 v5, 8, v2
v_add_u32 v5, v5, v2
v_add_u32 v6, 0, v3
v_xor_b32 v6, v6, v2
v_lshlrev_b32 v6, 4, v6
v_lshl_add_u32 v12, v5, 9, v6
v_add_u32 v6, 4, v3
v_xor_b32 v6, v6, v2
v_lshlrev_b32 v6, 4, v6
v_lshl_add_u32 v13, v5, 9, v6
v_add_u32 v6, 8, v3
v_xor_b32 v6, v6, v2
v_lshlrev_b32 v6, 4, v6
v_lshl_add_u32 v14, v5, 9, v6
v_add_u32 v6, 12, v3
v_xor_b32 v6, v6, v2
v_lshlrev_b32 v6, 4, v6
v_lshl_add_u32 v15, v5, 9, v6
v_add_u32 v16, 0x10000, v12
v_add_u32 v17, 0x10000, v13
v_add_u32 v18, 0x10000, v14
v_add_u32 v19, 0x10000, v15
v_lshlrev_b32 v86, 4, v5
v_lshl_add_u32 v86, v3, 9, v86
s_lshl_b32 s44, s46, 15
s_lshr_b32 s25, s49, 1
s_lshl_b32 s25, s25, 14
s_add_u32 s44, s44, s25
s_and_b32 s25, s49, 1
s_lshl_b32 s25, s25, 12
s_add_u32 s44, s44, s25
s_mov_b32 s22, 0
s_mov_b32 s24, 0
s_mov_b32 s20, 0
s_mov_b32 s37, 0
s_mov_b32 s23, 64
s_mov_b32 s32, s98
s_and_b32 s33, s99, 0xffff
s_mov_b32 s34, 0x100
s_mov_b32 s35, 0x00020000
s_mov_b32 s25, 0
v_mov_b32 v2, 0
L_pl_444:
buffer_load_dword v1, v2, s[32:35], s25 offen sc1
s_add_u32 s36, s36, 1
s_cmp_gt_u32 s36, 0x100000
s_cbranch_scc1 chain_kernel_wend
s_waitcnt vmcnt(0)
v_readfirstlane_b32 s26, v1
s_and_b32 s27, s26, 0xffff
s_cmp_ge_u32 s27, 256
s_cbranch_scc1 L_plok_445
s_sleep 4
s_branch L_pl_444
L_plok_445:
s_lshr_b32 s55, s26, 24
s_bfe_u32 s25, s26, 0x80010
s_cmp_gt_u32 s25, s55
s_cselect_b32 s25, 0x2000, 0x0
s_add_u32 s54, s100, 0x1fffff
s_and_b32 s54, s54, 0xffe00000
s_sub_u32 s55, s54, s100
s_add_u32 s54, s55, s25
s_xor_b32 s25, s25, 0x2000
s_add_u32 s55, s55, s25
s_cmp_eq_u32 s40, 2
s_cbranch_scc1 L_q_440
s_cmp_eq_u32 s40, 1
s_cbranch_scc1 L_v_439
v_mov_b32 v96, 0xff81ff81
v_mov_b32 v97, 0xff81ff81
v_mov_b32 v98, 0xff81ff81
v_mov_b32 v99, 0xff81ff81
v_and_b32 v100, 63, v0
v_lshlrev_b32 v101, 3, v100
v_lshlrev_b32 v100, 4, v100
s_barrier
s_add_u32 m0, s21, 0
s_nop 0
buffer_load_dwordx4 v8, s[8:11], s20 offen lds
s_add_u32 m0, s21, 1024
s_nop 0
buffer_load_dwordx4 v9, s[8:11], s20 offen lds
s_add_u32 m0, s21, 2048
s_nop 0
buffer_load_dwordx4 v10, s[8:11], s20 offen lds
s_add_u32 m0, s21, 3072
s_nop 0
buffer_load_dwordx4 v11, s[8:11], s20 offen lds
s_add_u32 s20, s20, 512
s_add_u32 m0, s21, 16384
s_nop 0
buffer_load_dwordx4 v8, s[8:11], s20 offen lds
s_add_u32 m0, s21, 17408
s_nop 0
buffer_load_dwordx4 v9, s[8:11], s20 offen lds
s_add_u32 m0, s21, 18432
s_nop 0
buffer_load_dwordx4 v10, s[8:11], s20 offen lds
s_add_u32 m0, s21, 19456
s_nop 0
buffer_load_dwordx4 v11, s[8:11], s20 offen lds
s_add_u32 s20, s20, 512
s_add_u32 m0, s21, 32768
s_nop 0
buffer_load_dwordx4 v8, s[8:11], s20 offen lds
s_add_u32 m0, s21, 33792
s_nop 0
buffer_load_dwordx4 v9, s[8:11], s20 offen lds
s_add_u32 m0, s21, 34816
s_nop 0
buffer_load_dwordx4 v10, s[8:11], s20 offen lds
s_add_u32 m0, s21, 35840
s_nop 0
buffer_load_dwordx4 v11, s[8:11], s20 offen lds
s_add_u32 s20, s20, 512
s_add_u32 m0, s21, 49152
s_nop 0
buffer_load_dwordx4 v8, s[8:11], s20 offen lds
s_add_u32 m0, s21, 50176
s_nop 0
buffer_load_dwordx4 v9, s[8:11], s20 offen lds
s_add_u32 m0, s21, 51200
s_nop 0
buffer_load_dwordx4 v10, s[8:11], s20 offen lds
s_add_u32 m0, s21, 52224
s_nop 0
buffer_load_dwordx4 v11, s[8:11], s20 offen lds
s_add_u32 s24, s24, 1
s_min_u32 s24, s24, 63
s_lshl_b32 s53, s24, 16
s_mov_b32 s20, s53
s_add_u32 m0, s21, 65536
s_nop 0
buffer_load_dwordx4 v8, s[8:11], s20 offen lds
s_add_u32 m0, s21, 66560
s_nop 0
buffer_load_dwordx4 v9, s[8:11], s20 offen lds
s_add_u32 m0, s21, 67584
s_nop 0
buffer_load_dwordx4 v10, s[8:11], s20 offen lds
s_add_u32 m0, s21, 68608
s_nop 0
buffer_load_dwordx4 v11, s[8:11], s20 offen lds
s_add_u32 s20, s20, 512
s_add_u32 m0, s21, 81920
s_nop 0
buffer_load_dwordx4 v8, s[8:11], s20 offen lds
s_add_u32 m0, s21, 82944
s_nop 0
buffer_load_dwordx4 v9, s[8:11], s20 offen lds
s_add_u32 m0, s21, 83968
s_nop 0
buffer_load_dwordx4 v10, s[8:11], s20 offen lds
s_add_u32 m0, s21, 84992
s_nop 0
buffer_load_dwordx4 v11, s[8:11], s20 offen lds
s_add_u32 s20, s20, 512
s_add_u32 m0, s21, 98304
s_nop 0
buffer_load_dwordx4 v8, s[8:11], s20 offen lds
s_waitcnt vmcnt(21)
s_barrier
ds_read_b128 v[20:23], v12 offset:0
ds_read_b128 v[24:27], v12 offset:4096
ds_read_b128 v[28:31], v13 offset:0
ds_read_b128 v[32:35], v13 offset:4096
ds_read_b128 v[36:39], v14 offset:0
ds_read_b128 v[40:43], v14 offset:4096
s_waitcnt lgkmcnt(4)
L_st_449:
v_mfma_f32_16x16x32_bf16 v[52:55], a[0:3], v[20:23], 0
ds_read_b128 v[44:47], v15 offset:0
s_add_u32 m0, s21, 99328
v_mfma_f32_16x16x32_bf16 v[56:59], a[4:7], v[20:23], 0
buffer_load_dwordx4 v9, s[8:11], s20 offen lds
v_mfma_f32_16x16x32_bf16 v[60:63], a[0:3], v[24:27], 0
ds_read_b128 v[48:51], v15 offset:4096
s_sub_u32 s39, s22, 1
v_mfma_f32_16x16x32_bf16 v[64:67], a[4:7], v[24:27], 0
s_waitcnt lgkmcnt(4)
s_bitcmp1_b32 s39, 1
s_cselect_b32 s38, s55, s54
v_mfma_f32_16x16x32_bf16 v[52:55], a[8:11], v[28:31], v[52:55]
ds_read_b128 v[20:23], v12 offset:256
v_mfma_f32_16x16x32_bf16 v[56:59], a[12:15], v[28:31], v[56:59]
s_add_u32 s38, s38, s44
v_mfma_f32_16x16x32_bf16 v[60:63], a[8:11], v[32:35], v[60:63]
ds_read_b128 v[24:27], v12 offset:4352
s_lshl_b32 s42, s39, 20
v_mfma_f32_16x16x32_bf16 v[64:67], a[12:15], v[32:35], v[64:67]
s_waitcnt lgkmcnt(4)
v_mfma_f32_16x16x32_bf16 v[52:55], a[16:19], v[36:39], v[52:55]
ds_read_b128 v[28:31], v13 offset:256
s_add_u32 m0, s21, 100352
v_mfma_f32_16x16x32_bf16 v[56:59], a[20:23], v[36:39], v[56:59]
buffer_load_dwordx4 v10, s[8:11], s20 offen lds
v_mfma_f32_16x16x32_bf16 v[60:63], a[16:19], v[40:43], v[60:63]
ds_read_b128 v[32:35], v13 offset:4352
s_add_u32 s38, s38, s42
v_mfma_f32_16x16x32_bf16 v[64:67], a[20:23], v[40:43], v[64:67]
s_waitcnt lgkmcnt(4)
s_lshl_b32 s39, s39, 7
v_mfma_f32_16x16x32_bf16 v[52:55], a[24:27], v[44:47], v[52:55]
ds_read_b128 v[36:39], v14 offset:256
v_mfma_f32_16x16x32_bf16 v[56:59], a[28:31], v[44:47], v[56:59]
s_add_u32 s39, s39, 0x5900000
s_cmp_eq_u32 s37, 0
s_cselect_b32 s38, 0x7ff00000, s38
s_cselect_b32 s39, 0x7ff00000, s39
v_mfma_f32_16x16x32_bf16 v[60:63], a[24:27], v[48:51], v[60:63]
ds_read_b128 v[40:43], v14 offset:4352
v_mfma_f32_16x16x32_bf16 v[64:67], a[28:31], v[48:51], v[64:67]
s_waitcnt lgkmcnt(4)
v_mfma_f32_16x16x32_bf16 v[52:55], a[32:35], v[20:23], v[52:55]
ds_read_b128 v[44:47], v15 offset:256
s_add_u32 m0, s21, 101376
v_mfma_f32_16x16x32_bf16 v[56:59], a[36:39], v[20:23], v[56:59]
buffer_load_dwordx4 v11, s[8:11], s20 offen lds
v_mfma_f32_16x16x32_bf16 v[60:63], a[32:35], v[24:27], v[60:63]
ds_read_b128 v[48:51], v15 offset:4352
v_mfma_f32_16x16x32_bf16 v[64:67], a[36:39], v[24:27], v[64:67]
s_waitcnt lgkmcnt(4)
v_mfma_f32_16x16x32_bf16 v[52:55], a[40:43], v[28:31], v[52:55]
s_waitcnt vmcnt(20)
s_barrier
ds_read_b128 v[20:23], v12 offset:16384
v_mfma_f32_16x16x32_bf16 v[56:59], a[44:47], v[28:31], v[56:59]
s_add_u32 s20, s20, 512
v_cvt_pk_bf16_f32 v88, v68, v69
v_mfma_f32_16x16x32_bf16 v[60:63], a[40:43], v[32:35], v[60:63]
ds_read_b128 v[24:27], v12 offset:20480
v_cvt_pk_bf16_f32 v89, v70, v71
v_mfma_f32_16x16x32_bf16 v[64:67], a[44:47], v[32:35], v[64:67]
s_waitcnt lgkmcnt(4)
v_mfma_f32_16x16x32_bf16 v[52:55], a[48:51], v[36:39], v[52:55]
ds_read_b128 v[28:31], v13 offset:16384
s_add_u32 m0, s21, 114688
v_mfma_f32_16x16x32_bf16 v[56:59], a[52:55], v[36:39], v[56:59]
buffer_load_dwordx4 v8, s[8:11], s20 offen lds
v_mfma_f32_16x16x32_bf16 v[60:63], a[48:51], v[40:43], v[60:63]
ds_read_b128 v[32:35], v13 offset:20480
v_cvt_pk_bf16_f32 v90, v72, v73
v_mfma_f32_16x16x32_bf16 v[64:67], a[52:55], v[40:43], v[64:67]
s_waitcnt lgkmcnt(4)
v_cvt_pk_bf16_f32 v91, v74, v75
v_mfma_f32_16x16x32_bf16 v[52:55], a[56:59], v[44:47], v[52:55]
ds_read_b128 v[36:39], v14 offset:16384
v_mfma_f32_16x16x32_bf16 v[56:59], a[60:63], v[44:47], v[56:59]
buffer_store_dwordx4 v[88:91], v86, s[12:15], s38 offen offset:0 sc1
v_mfma_f32_16x16x32_bf16 v[60:63], a[56:59], v[48:51], v[60:63]
ds_read_b128 v[40:43], v14 offset:20480
v_cvt_pk_bf16_f32 v92, v76, v77
v_mfma_f32_16x16x32_bf16 v[64:67], a[60:63], v[48:51], v[64:67]
s_waitcnt lgkmcnt(4)
v_cvt_pk_bf16_f32 v93, v78, v79
v_mfma_f32_16x16x32_bf16 v[52:55], a[64:67], v[20:23], v[52:55]
ds_read_b128 v[44:47], v15 offset:16384
s_add_u32 m0, s21, 115712
v_mfma_f32_16x16x32_bf16 v[56:59], a[68:71], v[20:23], v[56:59]
buffer_load_dwordx4 v9, s[8:11], s20 offen lds
v_mfma_f32_16x16x32_bf16 v[60:63], a[64:67], v[24:27], v[60:63]
ds_read_b128 v[48:51], v15 offset:20480
v_cvt_pk_bf16_f32 v94, v80, v81
v_mfma_f32_16x16x32_bf16 v[64:67], a[68:71], v[24:27], v[64:67]
s_waitcnt lgkmcnt(4)
v_cvt_pk_bf16_f32 v95, v82, v83
v_mfma_f32_16x16x32_bf16 v[52:55], a[72:75], v[28:31], v[52:55]
ds_read_b128 v[20:23], v12 offset:16640
v_mfma_f32_16x16x32_bf16 v[56:59], a[76:79], v[28:31], v[56:59]
buffer_store_dwordx4 v[92:95], v86, s[12:15], s38 offen offset:128 sc1
v_mfma_f32_16x16x32_bf16 v[60:63], a[72:75], v[32:35], v[60:63]
ds_read_b128 v[24:27], v12 offset:20736
s_add_u32 s24, s24, 1
v_mfma_f32_16x16x32_bf16 v[64:67], a[76:79], v[32:35], v[64:67]
s_waitcnt lgkmcnt(4)
s_add_u32 s42, s38, 0x8000000
v_mfma_f32_16x16x32_bf16 v[52:55], a[80:83], v[36:39], v[52:55]
ds_read_b128 v[28:31], v13 offset:16640
s_add_u32 m0, s21, 116736
v_mfma_f32_16x16x32_bf16 v[56:59], a[84:87], v[36:39], v[56:59]
buffer_load_dwordx4 v10, s[8:11], s20 offen lds
v_mfma_f32_16x16x32_bf16 v[60:63], a[80:83], v[40:43], v[60:63]
ds_read_b128 v[32:35], v13 offset:20736
s_cmp_le_u32 s22, 52
s_cbranch_scc1 L_nokm_450
buffer_store_dwordx4 v[96:99], v100, s[12:15], s42 offen offset:3072 sc1
buffer_store_dwordx4 v[96:99], v100, s[12:15], s42 offen offset:1024 sc1
buffer_store_dwordx4 v[96:99], v100, s[12:15], s42 offen offset:2048 sc1
L_nokm_450:
v_mfma_f32_16x16x32_bf16 v[64:67], a[84:87], v[40:43], v[64:67]
s_waitcnt lgkmcnt(4)
s_min_u32 s24, s24, 63
v_mfma_f32_16x16x32_bf16 v[52:55], a[88:91], v[44:47], v[52:55]
ds_read_b128 v[36:39], v14 offset:16640
v_mfma_f32_16x16x32_bf16 v[56:59], a[92:95], v[44:47], v[56:59]
v_mfma_f32_16x16x32_bf16 v[60:63], a[88:91], v[48:51], v[60:63]
ds_read_b128 v[40:43], v14 offset:20736
s_lshl_b32 s53, s24, 16
v_mfma_f32_16x16x32_bf16 v[64:67], a[92:95], v[48:51], v[64:67]
s_waitcnt lgkmcnt(4)
v_mfma_f32_16x16x32_bf16 v[52:55], a[96:99], v[20:23], v[52:55]
ds_read_b128 v[44:47], v15 offset:16640
s_add_u32 m0, s21, 117760
v_mfma_f32_16x16x32_bf16 v[56:59], a[100:103], v[20:23], v[56:59]
buffer_load_dwordx4 v11, s[8:11], s20 offen lds
v_mfma_f32_16x16x32_bf16 v[60:63], a[96:99], v[24:27], v[60:63]
ds_read_b128 v[48:51], v15 offset:20736
v_mfma_f32_16x16x32_bf16 v[64:67], a[100:103], v[24:27], v[64:67]
s_waitcnt lgkmcnt(4)
v_mfma_f32_16x16x32_bf16 v[52:55], a[104:107], v[28:31], v[52:55]
s_waitcnt vmcnt(20)
s_barrier
ds_read_b128 v[20:23], v12 offset:32768
v_mfma_f32_16x16x32_bf16 v[56:59], a[108:111], v[28:31], v[56:59]
s_mov_b32 s20, s53
buffer_store_dwordx2 v[96:97], v101, s[12:15], s42 offen offset:0 sc1
v_mfma_f32_16x16x32_bf16 v[60:63], a[104:107], v[32:35], v[60:63]
ds_read_b128 v[24:27], v12 offset:36864
v_mfma_f32_16x16x32_bf16 v[64:67], a[108:111], v[32:35], v[64:67]
s_waitcnt lgkmcnt(4)
v_mfma_f32_16x16x32_bf16 v[52:55], a[112:115], v[36:39], v[52:55]
ds_read_b128 v[28:31], v13 offset:32768
s_add_u32 m0, s21, 0
v_mfma_f32_16x16x32_bf16 v[56:59], a[116:119], v[36:39], v[56:59]
buffer_load_dwordx4 v8, s[8:11], s20 offen lds
v_mfma_f32_16x16x32_bf16 v[60:63], a[112:115], v[40:43], v[60:63]
ds_read_b128 v[32:35], v13 offset:36864
v_mfma_f32_16x16x32_bf16 v[64:67], a[116:119], v[40:43], v[64:67]
s_waitcnt lgkmcnt(4)
v_mfma_f32_16x16x32_bf16 v[52:55], a[120:123], v[44:47], v[52:55]
ds_read_b128 v[36:39], v14 offset:32768
v_mfma_f32_16x16x32_bf16 v[56:59], a[124:127], v[44:47], v[56:59]
v_mfma_f32_16x16x32_bf16 v[60:63], a[120:123], v[48:51], v[60:63]
ds_read_b128 v[40:43], v14 offset:36864
v_mfma_f32_16x16x32_bf16 v[64:67], a[124:127], v[48:51], v[64:67]
s_waitcnt lgkmcnt(4)
v_mfma_f32_16x16x32_bf16 v[52:55], a[128:131], v[20:23], v[52:55]
ds_read_b128 v[44:47], v15 offset:32768
s_add_u32 m0, s21, 1024
v_mfma_f32_16x16x32_bf16 v[56:59], a[132:135], v[20:23], v[56:59]
buffer_load_dwordx4 v9, s[8:11], s20 offen lds
v_mfma_f32_16x16x32_bf16 v[60:63], a[128:131], v[24:27], v[60:63]
ds_read_b128 v[48:51], v15 offset:36864
v_mfma_f32_16x16x32_bf16 v[64:67], a[132:135], v[24:27], v[64:67]
s_waitcnt lgkmcnt(4)
v_mfma_f32_16x16x32_bf16 v[52:55], a[136:139], v[28:31], v[52:55]
ds_read_b128 v[20:23], v12 offset:33024
v_mfma_f32_16x16x32_bf16 v[56:59], a[140:143], v[28:31], v[56:59]
v_mfma_f32_16x16x32_bf16 v[60:63], a[136:139], v[32:35], v[60:63]
ds_read_b128 v[24:27], v12 offset:37120
v_mfma_f32_16x16x32_bf16 v[64:67], a[140:143], v[32:35], v[64:67]
s_waitcnt lgkmcnt(4)
v_mfma_f32_16x16x32_bf16 v[52:55], a[144:147], v[36:39], v[52:55]
ds_read_b128 v[28:31], v13 offset:33024
s_add_u32 m0, s21, 2048
v_mfma_f32_16x16x32_bf16 v[56:59], a[148:151], v[36:39], v[56:59]
buffer_load_dwordx4 v10, s[8:11], s20 offen lds
v_mfma_f32_16x16x32_bf16 v[60:63], a[144:147], v[40:43], v[60:63]
ds_read_b128 v[32:35], v13 offset:37120
v_mfma_f32_16x16x32_bf16 v[64:67], a[148:151], v[40:43], v[64:67]
s_waitcnt lgkmcnt(4)
v_mfma_f32_16x16x32_bf16 v[52:55], a[152:155], v[44:47], v[52:55]
ds_read_b128 v[36:39], v14 offset:33024
v_mfma_f32_16x16x32_bf16 v[56:59], a[156:159], v[44:47], v[56:59]
v_mfma_f32_16x16x32_bf16 v[60:63], a[152:155], v[48:51], v[60:63]
ds_read_b128 v[40:43], v14 offset:37120
v_mfma_f32_16x16x32_bf16 v[64:67], a[156:159], v[48:51], v[64:67]
s_waitcnt lgkmcnt(4)
v_mfma_f32_16x16x32_bf16 v[52:55], a[160:163], v[20:23], v[52:55]
ds_read_b128 v[44:47], v15 offset:33024
s_add_u32 m0, s21, 3072
v_mfma_f32_16x16x32_bf16 v[56:59], a[164:167], v[20:23], v[56:59]
buffer_load_dwordx4 v11, s[8:11], s20 offen lds
v_mfma_f32_16x16x32_bf16 v[60:63], a[160:163], v[24:27], v[60:63]
ds_read_b128 v[48:51], v15 offset:37120
v_mfma_f32_16x16x32_bf16 v[64:67], a[164:167], v[24:27], v[64:67]
s_waitcnt lgkmcnt(4)
v_mfma_f32_16x16x32_bf16 v[52:55], a[168:171], v[28:31], v[52:55]
s_waitcnt vmcnt(20)
s_barrier
ds_read_b128 v[20:23], v12 offset:49152
v_mfma_f32_16x16x32_bf16 v[56:59], a[172:175], v[28:31], v[56:59]
s_add_u32 s20, s20, 512
v_mfma_f32_16x16x32_bf16 v[60:63], a[168:171], v[32:35], v[60:63]
ds_read_b128 v[24:27], v12 offset:53248
v_mfma_f32_16x16x32_bf16 v[64:67], a[172:175], v[32:35], v[64:67]
s_waitcnt lgkmcnt(4)
v_mfma_f32_16x16x32_bf16 v[52:55], a[176:179], v[36:39], v[52:55]
ds_read_b128 v[28:31], v13 offset:49152
s_add_u32 m0, s21, 16384
v_mfma_f32_16x16x32_bf16 v[56:59], a[180:183], v[36:39], v[56:59]
buffer_load_dwordx4 v8, s[8:11], s20 offen lds
v_mfma_f32_16x16x32_bf16 v[60:63], a[176:179], v[40:43], v[60:63]
ds_read_b128 v[32:35], v13 offset:53248
v_mfma_f32_16x16x32_bf16 v[64:67], a[180:183], v[40:43], v[64:67]
s_waitcnt lgkmcnt(4)
v_mfma_f32_16x16x32_bf16 v[52:55], a[184:187], v[44:47], v[52:55]
ds_read_b128 v[36:39], v14 offset:49152
v_mfma_f32_16x16x32_bf16 v[56:59], a[188:191], v[44:47], v[56:59]
v_mfma_f32_16x16x32_bf16 v[60:63], a[184:187], v[48:51], v[60:63]
ds_read_b128 v[40:43], v14 offset:53248
v_mfma_f32_16x16x32_bf16 v[64:67], a[188:191], v[48:51], v[64:67]
s_waitcnt lgkmcnt(4)
v_mfma_f32_16x16x32_bf16 v[52:55], a[192:195], v[20:23], v[52:55]
ds_read_b128 v[44:47], v15 offset:49152
s_add_u32 m0, s21, 17408
v_mfma_f32_16x16x32_bf16 v[56:59], a[196:199], v[20:23], v[56:59]
buffer_load_dwordx4 v9, s[8:11], s20 offen lds
v_mfma_f32_16x16x32_bf16 v[60:63], a[192:195], v[24:27], v[60:63]
ds_read_b128 v[48:51], v15 offset:53248
v_mfma_f32_16x16x32_bf16 v[64:67], a[196:199], v[24:27], v[64:67]
s_waitcnt lgkmcnt(4)
v_mfma_f32_16x16x32_bf16 v[52:55], a[200:203], v[28:31], v[52:55]
ds_read_b128 v[20:23], v12 offset:49408
v_mfma_f32_16x16x32_bf16 v[56:59], a[204:207], v[28:31], v[56:59]
v_mfma_f32_16x16x32_bf16 v[60:63], a[200:203], v[32:35], v[60:63]
ds_read_b128 v[24:27], v12 offset:53504
v_mfma_f32_16x16x32_bf16 v[64:67], a[204:207], v[32:35], v[64:67]
s_waitcnt lgkmcnt(4)
v_mfma_f32_16x16x32_bf16 v[52:55], a[208:211], v[36:39], v[52:55]
ds_read_b128 v[28:31], v13 offset:49408
s_add_u32 m0, s21, 18432
v_mfma_f32_16x16x32_bf16 v[56:59], a[212:215], v[36:39], v[56:59]
buffer_load_dwordx4 v10, s[8:11], s20 offen lds
v_mfma_f32_16x16x32_bf16 v[60:63], a[208:211], v[40:43], v[60:63]
ds_read_b128 v[32:35], v13 offset:53504
v_mfma_f32_16x16x32_bf16 v[64:67], a[212:215], v[40:43], v[64:67]
s_waitcnt lgkmcnt(4)
v_mfma_f32_16x16x32_bf16 v[52:55], a[216:219], v[44:47], v[52:55]
ds_read_b128 v[36:39], v14 offset:49408
v_mfma_f32_16x16x32_bf16 v[56:59], a[220:223], v[44:47], v[56:59]
v_mfma_f32_16x16x32_bf16 v[60:63], a[216:219], v[48:51], v[60:63]
ds_read_b128 v[40:43], v14 offset:53504
v_mfma_f32_16x16x32_bf16 v[64:67], a[220:223], v[48:51], v[64:67]
s_waitcnt lgkmcnt(4)
v_mfma_f32_16x16x32_bf16 v[52:55], a[224:227], v[20:23], v[52:55]
ds_read_b128 v[44:47], v15 offset:49408
s_add_u32 m0, s21, 19456
v_mfma_f32_16x16x32_bf16 v[56:59], a[228:231], v[20:23], v[56:59]
buffer_load_dwordx4 v11, s[8:11], s20 offen lds
v_mfma_f32_16x16x32_bf16 v[60:63], a[224:227], v[24:27], v[60:63]
ds_read_b128 v[48:51], v15 offset:53504
v_mfma_f32_16x16x32_bf16 v[64:67], a[228:231], v[24:27], v[64:67]
s_waitcnt lgkmcnt(4)
v_mfma_f32_16x16x32_bf16 v[52:55], a[232:235], v[28:31], v[52:55]
s_waitcnt vmcnt(8)
s_barrier
ds_read_b128 v[20:23], v16 offset:0
v_mfma_f32_16x16x32_bf16 v[56:59], a[236:239], v[28:31], v[56:59]
s_add_u32 s20, s20, 512
buffer_atomic_add v84, v85, s[12:15], s39 offen sc1
v_mfma_f32_16x16x32_bf16 v[60:63], a[232:235], v[32:35], v[60:63]
ds_read_b128 v[24:27], v16 offset:4096
s_mov_b32 s37, 1
v_mfma_f32_16x16x32_bf16 v[64:67], a[236:239], v[32:35], v[64:67]
s_waitcnt lgkmcnt(4)
v_mfma_f32_16x16x32_bf16 v[52:55], a[240:243], v[36:39], v[52:55]
ds_read_b128 v[28:31], v17 offset:0
s_add_u32 m0, s21, 32768
v_mfma_f32_16x16x32_bf16 v[56:59], a[244:247], v[36:39], v[56:59]
buffer_load_dwordx4 v8, s[8:11], s20 offen lds
v_mfma_f32_16x16x32_bf16 v[60:63], a[240:243], v[40:43], v[60:63]
ds_read_b128 v[32:35], v17 offset:4096
v_mfma_f32_16x16x32_bf16 v[64:67], a[244:247], v[40:43], v[64:67]
s_waitcnt lgkmcnt(4)
v_mfma_f32_16x16x32_bf16 v[52:55], a[248:251], v[44:47], v[52:55]
ds_read_b128 v[36:39], v18 offset:0
v_mfma_f32_16x16x32_bf16 v[56:59], a[252:255], v[44:47], v[56:59]
v_mfma_f32_16x16x32_bf16 v[60:63], a[248:251], v[48:51], v[60:63]
ds_read_b128 v[40:43], v18 offset:4096
v_mfma_f32_16x16x32_bf16 v[64:67], a[252:255], v[48:51], v[64:67]
s_waitcnt lgkmcnt(4)
s_add_u32 s22, s22, 1
s_cmp_ge_u32 s22, s23
s_cbranch_scc1 L_fl0_446
v_mfma_f32_16x16x32_bf16 v[68:71], a[0:3], v[20:23], 0
ds_read_b128 v[44:47], v19 offset:0
s_add_u32 m0, s21, 33792
v_mfma_f32_16x16x32_bf16 v[72:75], a[4:7], v[20:23], 0
buffer_load_dwordx4 v9, s[8:11], s20 offen lds
v_mfma_f32_16x16x32_bf16 v[76:79], a[0:3], v[24:27], 0
ds_read_b128 v[48:51], v19 offset:4096
s_sub_u32 s39, s22, 1
v_mfma_f32_16x16x32_bf16 v[80:83], a[4:7], v[24:27], 0
s_waitcnt lgkmcnt(4)
s_bitcmp1_b32 s39, 1
s_cselect_b32 s38, s55, s54
v_mfma_f32_16x16x32_bf16 v[68:71], a[8:11], v[28:31], v[68:71]
ds_read_b128 v[20:23], v16 offset:256
v_mfma_f32_16x16x32_bf16 v[72:75], a[12:15], v[28:31], v[72:75]
s_add_u32 s38, s38, s44
v_mfma_f32_16x16x32_bf16 v[76:79], a[8:11], v[32:35], v[76:79]
ds_read_b128 v[24:27], v16 offset:4352
s_lshl_b32 s42, s39, 20
v_mfma_f32_16x16x32_bf16 v[80:83], a[12:15], v[32:35], v[80:83]
s_waitcnt lgkmcnt(4)
v_mfma_f32_16x16x32_bf16 v[68:71], a[16:19], v[36:39], v[68:71]
ds_read_b128 v[28:31], v17 offset:256
s_add_u32 m0, s21, 34816
v_mfma_f32_16x16x32_bf16 v[72:75], a[20:23], v[36:39], v[72:75]
buffer_load_dwordx4 v10, s[8:11], s20 offen lds
v_mfma_f32_16x16x32_bf16 v[76:79], a[16:19], v[40:43], v[76:79]
ds_read_b128 v[32:35], v17 offset:4352
s_add_u32 s38, s38, s42
v_mfma_f32_16x16x32_bf16 v[80:83], a[20:23], v[40:43], v[80:83]
s_waitcnt lgkmcnt(4)
s_lshl_b32 s39, s39, 7
v_mfma_f32_16x16x32_bf16 v[68:71], a[24:27], v[44:47], v[68:71]
ds_read_b128 v[36:39], v18 offset:256
v_mfma_f32_16x16x32_bf16 v[72:75], a[28:31], v[44:47], v[72:75]
s_add_u32 s39, s39, 0x5900000
s_cmp_eq_u32 s37, 0
s_cselect_b32 s38, 0x7ff00000, s38
s_cselect_b32 s39, 0x7ff00000, s39
v_mfma_f32_16x16x32_bf16 v[76:79], a[24:27], v[48:51], v[76:79]
ds_read_b128 v[40:43], v18 offset:4352
v_mfma_f32_16x16x32_bf16 v[80:83], a[28:31], v[48:51], v[80:83]
s_waitcnt lgkmcnt(4)
v_mfma_f32_16x16x32_bf16 v[68:71], a[32:35], v[20:23], v[68:71]
ds_read_b128 v[44:47], v19 offset:256
s_add_u32 m0, s21, 35840
v_mfma_f32_16x16x32_bf16 v[72:75], a[36:39], v[20:23], v[72:75]
buffer_load_dwordx4 v11, s[8:11], s20 offen lds
v_mfma_f32_16x16x32_bf16 v[76:79], a[32:35], v[24:27], v[76:79]
ds_read_b128 v[48:51], v19 offset:4352
v_mfma_f32_16x16x32_bf16 v[80:83], a[36:39], v[24:27], v[80:83]
s_waitcnt lgkmcnt(4)
v_mfma_f32_16x16x32_bf16 v[68:71], a[40:43], v[28:31], v[68:71]
s_waitcnt vmcnt(20)
s_barrier
ds_read_b128 v[20:23], v16 offset:16384
v_mfma_f32_16x16x32_bf16 v[72:75], a[44:47], v[28:31], v[72:75]
s_add_u32 s20, s20, 512
v_cvt_pk_bf16_f32 v88, v52, v53
v_mfma_f32_16x16x32_bf16 v[76:79], a[40:43], v[32:35], v[76:79]
ds_read_b128 v[24:27], v16 offset:20480
v_cvt_pk_bf16_f32 v89, v54, v55
v_mfma_f32_16x16x32_bf16 v[80:83], a[44:47], v[32:35], v[80:83]
s_waitcnt lgkmcnt(4)
v_mfma_f32_16x16x32_bf16 v[68:71], a[48:51], v[36:39], v[68:71]
ds_read_b128 v[28:31], v17 offset:16384
s_add_u32 m0, s21, 49152
v_mfma_f32_16x16x32_bf16 v[72:75], a[52:55], v[36:39], v[72:75]
buffer_load_dwordx4 v8, s[8:11], s20 offen lds
v_mfma_f32_16x16x32_bf16 v[76:79], a[48:51], v[40:43], v[76:79]
ds_read_b128 v[32:35], v17 offset:20480
v_cvt_pk_bf16_f32 v90, v56, v57
v_mfma_f32_16x16x32_bf16 v[80:83], a[52:55], v[40:43], v[80:83]
s_waitcnt lgkmcnt(4)
v_cvt_pk_bf16_f32 v91, v58, v59
v_mfma_f32_16x16x32_bf16 v[68:71], a[56:59], v[44:47], v[68:71]
ds_read_b128 v[36:39], v18 offset:16384
v_mfma_f32_16x16x32_bf16 v[72:75], a[60:63], v[44:47], v[72:75]
buffer_store_dwordx4 v[88:91], v86, s[12:15], s38 offen offset:0 sc1
v_mfma_f32_16x16x32_bf16 v[76:79], a[56:59], v[48:51], v[76:79]
ds_read_b128 v[40:43], v18 offset:20480
v_cvt_pk_bf16_f32 v92, v60, v61
v_mfma_f32_16x16x32_bf16 v[80:83], a[60:63], v[48:51], v[80:83]
s_waitcnt lgkmcnt(4)
v_cvt_pk_bf16_f32 v93, v62, v63
v_mfma_f32_16x16x32_bf16 v[68:71], a[64:67], v[20:23], v[68:71]
ds_read_b128 v[44:47], v19 offset:16384
s_add_u32 m0, s21, 50176
v_mfma_f32_16x16x32_bf16 v[72:75], a[68:71], v[20:23], v[72:75]
buffer_load_dwordx4 v9, s[8:11], s20 offen lds
v_mfma_f32_16x16x32_bf16 v[76:79], a[64:67], v[24:27], v[76:79]
ds_read_b128 v[48:51], v19 offset:20480
v_cvt_pk_bf16_f32 v94, v64, v65
v_mfma_f32_16x16x32_bf16 v[80:83], a[68:71], v[24:27], v[80:83]
s_waitcnt lgkmcnt(4)
v_cvt_pk_bf16_f32 v95, v66, v67
v_mfma_f32_16x16x32_bf16 v[68:71], a[72:75], v[28:31], v[68:71]
ds_read_b128 v[20:23], v16 offset:16640
v_mfma_f32_16x16x32_bf16 v[72:75], a[76:79], v[28:31], v[72:75]
buffer_store_dwordx4 v[92:95], v86, s[12:15], s38 offen offset:128 sc1
v_mfma_f32_16x16x32_bf16 v[76:79], a[72:75], v[32:35], v[76:79]
ds_read_b128 v[24:27], v16 offset:20736
s_add_u32 s24, s24, 1
v_mfma_f32_16x16x32_bf16 v[80:83], a[76:79], v[32:35], v[80:83]
s_waitcnt lgkmcnt(4)
s_add_u32 s42, s38, 0x8000000
v_mfma_f32_16x16x32_bf16 v[68:71], a[80:83], v[36:39], v[68:71]
ds_read_b128 v[28:31], v17 offset:16640
s_add_u32 m0, s21, 51200
v_mfma_f32_16x16x32_bf16 v[72:75], a[84:87], v[36:39], v[72:75]
buffer_load_dwordx4 v10, s[8:11], s20 offen lds
v_mfma_f32_16x16x32_bf16 v[76:79], a[80:83], v[40:43], v[76:79]
ds_read_b128 v[32:35], v17 offset:20736
s_cmp_le_u32 s22, 52
s_cbranch_scc1 L_nokm_451
buffer_store_dwordx4 v[96:99], v100, s[12:15], s42 offen offset:3072 sc1
buffer_store_dwordx4 v[96:99], v100, s[12:15], s42 offen offset:1024 sc1
buffer_store_dwordx4 v[96:99], v100, s[12:15], s42 offen offset:2048 sc1
L_nokm_451:
v_mfma_f32_16x16x32_bf16 v[80:83], a[84:87], v[40:43], v[80:83]
s_waitcnt lgkmcnt(4)
s_min_u32 s24, s24, 63
v_mfma_f32_16x16x32_bf16 v[68:71], a[88:91], v[44:47], v[68:71]
ds_read_b128 v[36:39], v18 offset:16640
v_mfma_f32_16x16x32_bf16 v[72:75], a[92:95], v[44:47], v[72:75]
v_mfma_f32_16x16x32_bf16 v[76:79], a[88:91], v[48:51], v[76:79]
ds_read_b128 v[40:43], v18 offset:20736
s_lshl_b32 s53, s24, 16
v_mfma_f32_16x16x32_bf16 v[80:83], a[92:95], v[48:51], v[80:83]
s_waitcnt lgkmcnt(4)
v_mfma_f32_16x16x32_bf16 v[68:71], a[96:99], v[20:23], v[68:71]
ds_read_b128 v[44:47], v19 offset:16640
s_add_u32 m0, s21, 52224
v_mfma_f32_16x16x32_bf16 v[72:75], a[100:103], v[20:23], v[72:75]
buffer_load_dwordx4 v11, s[8:11], s20 offen lds
v_mfma_f32_16x16x32_bf16 v[76:79], a[96:99], v[24:27], v[76:79]
ds_read_b128 v[48:51], v19 offset:20736
v_mfma_f32_16x16x32_bf16 v[80:83], a[100:103], v[24:27], v[80:83]
s_waitcnt lgkmcnt(4)
v_mfma_f32_16x16x32_bf16 v[68:71], a[104:107], v[28:31], v[68:71]
s_waitcnt vmcnt(20)
s_barrier
ds_read_b128 v[20:23], v16 offset:32768
v_mfma_f32_16x16x32_bf16 v[72:75], a[108:111], v[28:31], v[72:75]
s_mov_b32 s20, s53
buffer_store_dwordx2 v[96:97], v101, s[12:15], s42 offen offset:0 sc1
v_mfma_f32_16x16x32_bf16 v[76:79], a[104:107], v[32:35], v[76:79]
ds_read_b128 v[24:27], v16 offset:36864
v_mfma_f32_16x16x32_bf16 v[80:83], a[108:111], v[32:35], v[80:83]
s_waitcnt lgkmcnt(4)
v_mfma_f32_16x16x32_bf16 v[68:71], a[112:115], v[36:39], v[68:71]
ds_read_b128 v[28:31], v17 offset:32768
s_add_u32 m0, s21, 65536
v_mfma_f32_16x16x32_bf16 v[72:75], a[116:119], v[36:39], v[72:75]
buffer_load_dwordx4 v8, s[8:11], s20 offen lds
v_mfma_f32_16x16x32_bf16 v[76:79], a[112:115], v[40:43], v[76:79]
ds_read_b128 v[32:35], v17 offset:36864
v_mfma_f32_16x16x32_bf16 v[80:83], a[116:119], v[40:43], v[80:83]
s_waitcnt lgkmcnt(4)
v_mfma_f32_16x16x32_bf16 v[68:71], a[120:123], v[44:47], v[68:71]
ds_read_b128 v[36:39], v18 offset:32768
v_mfma_f32_16x16x32_bf16 v[72:75], a[124:127], v[44:47], v[72:75]
v_mfma_f32_16x16x32_bf16 v[76:79], a[120:123], v[48:51], v[76:79]
ds_read_b128 v[40:43], v18 offset:36864
v_mfma_f32_16x16x32_bf16 v[80:83], a[124:127], v[48:51], v[80:83]
s_waitcnt lgkmcnt(4)
v_mfma_f32_16x16x32_bf16 v[68:71], a[128:131], v[20:23], v[68:71]
ds_read_b128 v[44:47], v19 offset:32768
s_add_u32 m0, s21, 66560
v_mfma_f32_16x16x32_bf16 v[72:75], a[132:135], v[20:23], v[72:75]
buffer_load_dwordx4 v9, s[8:11], s20 offen lds
v_mfma_f32_16x16x32_bf16 v[76:79], a[128:131], v[24:27], v[76:79]
ds_read_b128 v[48:51], v19 offset:36864
v_mfma_f32_16x16x32_bf16 v[80:83], a[132:135], v[24:27], v[80:83]
s_waitcnt lgkmcnt(4)
v_mfma_f32_16x16x32_bf16 v[68:71], a[136:139], v[28:31], v[68:71]
ds_read_b128 v[20:23], v16 offset:33024
v_mfma_f32_16x16x32_bf16 v[72:75], a[140:143], v[28:31], v[72:75]
v_mfma_f32_16x16x32_bf16 v[76:79], a[136:139], v[32:35], v[76:79]
ds_read_b128 v[24:27], v16 offset:37120
v_mfma_f32_16x16x32_bf16 v[80:83], a[140:143], v[32:35], v[80:83]
s_waitcnt lgkmcnt(4)
v_mfma_f32_16x16x32_bf16 v[68:71], a[144:147], v[36:39], v[68:71]
ds_read_b128 v[28:31], v17 offset:33024
s_add_u32 m0, s21, 67584
v_mfma_f32_16x16x32_bf16 v[72:75], a[148:151], v[36:39], v[72:75]
buffer_load_dwordx4 v10, s[8:11], s20 offen lds
v_mfma_f32_16x16x32_bf16 v[76:79], a[144:147], v[40:43], v[76:79]
ds_read_b128 v[32:35], v17 offset:37120
v_mfma_f32_16x16x32_bf16 v[80:83], a[148:151], v[40:43], v[80:83]
s_waitcnt lgkmcnt(4)
v_mfma_f32_16x16x32_bf16 v[68:71], a[152:155], v[44:47], v[68:71]
ds_read_b128 v[36:39], v18 offset:33024
v_mfma_f32_16x16x32_bf16 v[72:75], a[156:159], v[44:47], v[72:75]
v_mfma_f32_16x16x32_bf16 v[76:79], a[152:155], v[48:51], v[76:79]
ds_read_b128 v[40:43], v18 offset:37120
v_mfma_f32_16x16x32_bf16 v[80:83], a[156:159], v[48:51], v[80:83]
s_waitcnt lgkmcnt(4)
v_mfma_f32_16x16x32_bf16 v[68:71], a[160:163], v[20:23], v[68:71]
ds_read_b128 v[44:47], v19 offset:33024
s_add_u32 m0, s21, 68608
v_mfma_f32_16x16x32_bf16 v[72:75], a[164:167], v[20:23], v[72:75]
buffer_load_dwordx4 v11, s[8:11], s20 offen lds
v_mfma_f32_16x16x32_bf16 v[76:79], a[160:163], v[24:27], v[76:79]
ds_read_b128 v[48:51], v19 offset:37120
v_mfma_f32_16x16x32_bf16 v[80:83], a[164:167], v[24:27], v[80:83]
s_waitcnt lgkmcnt(4)
v_mfma_f32_16x16x32_bf16 v[68:71], a[168:171], v[28:31], v[68:71]
s_waitcnt vmcnt(20)
s_barrier
ds_read_b128 v[20:23], v16 offset:49152
v_mfma_f32_16x16x32_bf16 v[72:75], a[172:175], v[28:31], v[72:75]
s_add_u32 s20, s20, 512
v_mfma_f32_16x16x32_bf16 v[76:79], a[168:171], v[32:35], v[76:79]
ds_read_b128 v[24:27], v16 offset:53248
v_mfma_f32_16x16x32_bf16 v[80:83], a[172:175], v[32:35], v[80:83]
s_waitcnt lgkmcnt(4)
v_mfma_f32_16x16x32_bf16 v[68:71], a[176:179], v[36:39], v[68:71]
ds_read_b128 v[28:31], v17 offset:49152
s_add_u32 m0, s21, 81920
v_mfma_f32_16x16x32_bf16 v[72:75], a[180:183], v[36:39], v[72:75]
buffer_load_dwordx4 v8, s[8:11], s20 offen lds
v_mfma_f32_16x16x32_bf16 v[76:79], a[176:179], v[40:43], v[76:79]
ds_read_b128 v[32:35], v17 offset:53248
v_mfma_f32_16x16x32_bf16 v[80:83], a[180:183], v[40:43], v[80:83]
s_waitcnt lgkmcnt(4)
v_mfma_f32_16x16x32_bf16 v[68:71], a[184:187], v[44:47], v[68:71]
ds_read_b128 v[36:39], v18 offset:49152
v_mfma_f32_16x16x32_bf16 v[72:75], a[188:191], v[44:47], v[72:75]
v_mfma_f32_16x16x32_bf16 v[76:79], a[184:187], v[48:51], v[76:79]
ds_read_b128 v[40:43], v18 offset:53248
v_mfma_f32_16x16x32_bf16 v[80:83], a[188:191], v[48:51], v[80:83]
s_waitcnt lgkmcnt(4)
v_mfma_f32_16x16x32_bf16 v[68:71], a[192:195], v[20:23], v[68:71]
ds_read_b128 v[44:47], v19 offset:49152
s_add_u32 m0, s21, 82944
v_mfma_f32_16x16x32_bf16 v[72:75], a[196:199], v[20:23], v[72:75]
buffer_load_dwordx4 v9, s[8:11], s20 offen lds
v_mfma_f32_16x16x32_bf16 v[76:79], a[192:195], v[24:27], v[76:79]
ds_read_b128 v[48:51], v19 offset:53248
v_mfma_f32_16x16x32_bf16 v[80:83], a[196:199], v[24:27], v[80:83]
s_waitcnt lgkmcnt(4)
v_mfma_f32_16x16x32_bf16 v[68:71], a[200:203], v[28:31], v[68:71]
ds_read_b128 v[20:23], v16 offset:49408
v_mfma_f32_16x16x32_bf16 v[72:75], a[204:207], v[28:31], v[72:75]
v_mfma_f32_16x16x32_bf16 v[76:79], a[200:203], v[32:35], v[76:79]
ds_read_b128 v[24:27], v16 offset:53504
v_mfma_f32_16x16x32_bf16 v[80:83], a[204:207], v[32:35], v[80:83]
s_waitcnt lgkmcnt(4)
v_mfma_f32_16x16x32_bf16 v[68:71], a[208:211], v[36:39], v[68:71]
ds_read_b128 v[28:31], v17 offset:49408
s_add_u32 m0, s21, 83968
v_mfma_f32_16x16x32_bf16 v[72:75], a[212:215], v[36:39], v[72:75]
buffer_load_dwordx4 v10, s[8:11], s20 offen lds
v_mfma_f32_16x16x32_bf16 v[76:79], a[208:211], v[40:43], v[76:79]
ds_read_b128 v[32:35], v17 offset:53504
v_mfma_f32_16x16x32_bf16 v[80:83], a[212:215], v[40:43], v[80:83]
s_waitcnt lgkmcnt(4)
v_mfma_f32_16x16x32_bf16 v[68:71], a[216:219], v[44:47], v[68:71]
ds_read_b128 v[36:39], v18 offset:49408
v_mfma_f32_16x16x32_bf16 v[72:75], a[220:223], v[44:47], v[72:75]
v_mfma_f32_16x16x32_bf16 v[76:79], a[216:219], v[48:51], v[76:79]
ds_read_b128 v[40:43], v18 offset:53504
v_mfma_f32_16x16x32_bf16 v[80:83], a[220:223], v[48:51], v[80:83]
s_waitcnt lgkmcnt(4)
v_mfma_f32_16x16x32_bf16 v[68:71], a[224:227], v[20:23], v[68:71]
ds_read_b128 v[44:47], v19 offset:49408
s_add_u32 m0, s21, 84992
v_mfma_f32_16x16x32_bf16 v[72:75], a[228:231], v[20:23], v[72:75]
buffer_load_dwordx4 v11, s[8:11], s20 offen lds
v_mfma_f32_16x16x32_bf16 v[76:79], a[224:227], v[24:27], v[76:79]
ds_read_b128 v[48:51], v19 offset:53504
v_mfma_f32_16x16x32_bf16 v[80:83], a[228:231], v[24:27], v[80:83]
s_waitcnt lgkmcnt(4)
v_mfma_f32_16x16x32_bf16 v[68:71], a[232:235], v[28:31], v[68:71]
s_waitcnt vmcnt(8)
s_barrier
ds_read_b128 v[20:23], v12 offset:0
v_mfma_f32_16x16x32_bf16 v[72:75], a[236:239], v[28:31], v[72:75]
s_add_u32 s20, s20, 512
buffer_atomic_add v84, v85, s[12:15], s39 offen sc1
v_mfma_f32_16x16x32_bf16 v[76:79], a[232:235], v[32:35], v[76:79]
ds_read_b128 v[24:27], v12 offset:4096
s_mov_b32 s37, 1
v_mfma_f32_16x16x32_bf16 v[80:83], a[236:239], v[32:35], v[80:83]
s_waitcnt lgkmcnt(4)
v_mfma_f32_16x16x32_bf16 v[68:71], a[240:243], v[36:39], v[68:71]
ds_read_b128 v[28:31], v13 offset:0
s_add_u32 m0, s21, 98304
v_mfma_f32_16x16x32_bf16 v[72:75], a[244:247], v[36:39], v[72:75]
buffer_load_dwordx4 v8, s[8:11], s20 offen lds
v_mfma_f32_16x16x32_bf16 v[76:79], a[240:243], v[40:43], v[76:79]
ds_read_b128 v[32:35], v13 offset:4096
v_mfma_f32_16x16x32_bf16 v[80:83], a[244:247], v[40:43], v[80:83]
s_waitcnt lgkmcnt(4)
v_mfma_f32_16x16x32_bf16 v[68:71], a[248:251], v[44:47], v[68:71]
ds_read_b128 v[36:39], v14 offset:0
v_mfma_f32_16x16x32_bf16 v[72:75], a[252:255], v[44:47], v[72:75]
v_mfma_f32_16x16x32_bf16 v[76:79], a[248:251], v[48:51], v[76:79]
ds_read_b128 v[40:43], v14 offset:4096
v_mfma_f32_16x16x32_bf16 v[80:83], a[252:255], v[48:51], v[80:83]
s_waitcnt lgkmcnt(4)
s_add_u32 s22, s22, 1
s_cmp_ge_u32 s22, s23
s_cbranch_scc0 L_st_449
L_fl1_447:
s_waitcnt lgkmcnt(0)
s_nop 7
s_sub_u32 s39, s22, 1
s_bitcmp1_b32 s39, 1
s_cselect_b32 s38, s55, s54
s_add_u32 s38, s38, s44
s_lshl_b32 s42, s39, 20
s_add_u32 s38, s38, s42
s_lshl_b32 s39, s39, 7
s_add_u32 s39, s39, 0x5900000
s_cmp_eq_u32 s37, 0
s_cselect_b32 s38, 0x7ff00000, s38
s_cselect_b32 s39, 0x7ff00000, s39
v_cvt_pk_bf16_f32 v88, v68, v69
v_cvt_pk_bf16_f32 v89, v70, v71
v_cvt_pk_bf16_f32 v90, v72, v73
v_cvt_pk_bf16_f32 v91, v74, v75
buffer_store_dwordx4 v[88:91], v86, s[12:15], s38 offen offset:0 sc1
v_cvt_pk_bf16_f32 v92, v76, v77
v_cvt_pk_bf16_f32 v93, v78, v79
v_cvt_pk_bf16_f32 v94, v80, v81
v_cvt_pk_bf16_f32 v95, v82, v83
buffer_store_dwordx4 v[92:95], v86, s[12:15], s38 offen offset:128 sc1
s_add_u32 s42, s38, 0x8000000
s_cmp_le_u32 s22, 52
s_cbranch_scc1 L_nokm_452
buffer_store_dwordx4 v[96:99], v100, s[12:15], s42 offen offset:3072 sc1
buffer_store_dwordx4 v[96:99], v100, s[12:15], s42 offen offset:1024 sc1
buffer_store_dwordx4 v[96:99], v100, s[12:15], s42 offen offset:2048 sc1
L_nokm_452:
buffer_store_dwordx2 v[96:97], v101, s[12:15], s42 offen offset:0 sc1
s_waitcnt vmcnt(0)
s_barrier
buffer_atomic_add v84, v85, s[12:15], s39 offen sc1
s_mov_b32 s37, 1
s_branch L_ste_448
L_fl0_446:
s_waitcnt lgkmcnt(0)
s_nop 7
s_sub_u32 s39, s22, 1
s_bitcmp1_b32 s39, 1
s_cselect_b32 s38, s55, s54
s_add_u32 s38, s38, s44
s_lshl_b32 s42, s39, 20
s_add_u32 s38, s38, s42
s_lshl_b32 s39, s39, 7
s_add_u32 s39, s39, 0x5900000
s_cmp_eq_u32 s37, 0
s_cselect_b32 s38, 0x7ff00000, s38
s_cselect_b32 s39, 0x7ff00000, s39
v_cvt_pk_bf16_f32 v88, v52, v53
v_cvt_pk_bf16_f32 v89, v54, v55
v_cvt_pk_bf16_f32 v90, v56, v57
v_cvt_pk_bf16_f32 v91, v58, v59
buffer_store_dwordx4 v[88:91], v86, s[12:15], s38 offen offset:0 sc1
v_cvt_pk_bf16_f32 v92, v60, v61
v_cvt_pk_bf16_f32 v93, v62, v63
v_cvt_pk_bf16_f32 v94, v64, v65
v_cvt_pk_bf16_f32 v95, v66, v67
buffer_store_dwordx4 v[92:95], v86, s[12:15], s38 offen offset:128 sc1
s_add_u32 s42, s38, 0x8000000
s_cmp_le_u32 s22, 52
s_cbranch_scc1 L_nokm_453
buffer_store_dwordx4 v[96:99], v100, s[12:15], s42 offen offset:3072 sc1
buffer_store_dwordx4 v[96:99], v100, s[12:15], s42 offen offset:1024 sc1
buffer_store_dwordx4 v[96:99], v100, s[12:15], s42 offen offset:2048 sc1
L_nokm_453:
buffer_store_dwordx2 v[96:97], v101, s[12:15], s42 offen offset:0 sc1
s_waitcnt vmcnt(0)
s_barrier
buffer_atomic_add v84, v85, s[12:15], s39 offen sc1
s_mov_b32 s37, 1
L_ste_448:
s_branch L_op_443
L_v_439:
v_mov_b32 v96, 0xff81ff81
v_mov_b32 v97, 0xff81ff81
v_mov_b32 v98, 0xff81ff81
v_mov_b32 v99, 0xff81ff81
v_and_b32 v100, 63, v0
v_lshlrev_b32 v101, 3, v100
v_lshlrev_b32 v100, 4, v100
s_barrier
s_add_u32 m0, s21, 0
s_nop 0
buffer_load_dwordx4 v8, s[8:11], s20 offen lds
s_add_u32 m0, s21, 1024
s_nop 0
buffer_load_dwordx4 v9, s[8:11], s20 offen lds
s_add_u32 m0, s21, 2048
s_nop 0
buffer_load_dwordx4 v10, s[8:11], s20 offen lds
s_add_u32 m0, s21, 3072
s_nop 0
buffer_load_dwordx4 v11, s[8:11], s20 offen lds
s_add_u32 s20, s20, 512
s_add_u32 m0, s21, 16384
s_nop 0
buffer_load_dwordx4 v8, s[8:11], s20 offen lds
s_add_u32 m0, s21, 17408
s_nop 0
buffer_load_dwordx4 v9, s[8:11], s20 offen lds
s_add_u32 m0, s21, 18432
s_nop 0
buffer_load_dwordx4 v10, s[8:11], s20 offen lds
s_add_u32 m0, s21, 19456
s_nop 0
buffer_load_dwordx4 v11, s[8:11], s20 offen lds
s_add_u32 s20, s20, 512
s_add_u32 m0, s21, 32768
s_nop 0
buffer_load_dwordx4 v8, s[8:11], s20 offen lds
s_add_u32 m0, s21, 33792
s_nop 0
buffer_load_dwordx4 v9, s[8:11], s20 offen lds
s_add_u32 m0, s21, 34816
s_nop 0
buffer_load_dwordx4 v10, s[8:11], s20 offen lds
s_add_u32 m0, s21, 35840
s_nop 0
buffer_load_dwordx4 v11, s[8:11], s20 offen lds
s_add_u32 s20, s20, 512
s_add_u32 m0, s21, 49152
s_nop 0
buffer_load_dwordx4 v8, s[8:11], s20 offen lds
s_add_u32 m0, s21, 50176
s_nop 0
buffer_load_dwordx4 v9, s[8:11], s20 offen lds
s_add_u32 m0, s21, 51200
s_nop 0
buffer_load_dwordx4 v10, s[8:11], s20 offen lds
s_add_u32 m0, s21, 52224
s_nop 0
buffer_load_dwordx4 v11, s[8:11], s20 offen lds
s_add_u32 s24, s24, 1
s_min_u32 s24, s24, 63
s_lshl_b32 s53, s24, 16
s_mov_b32 s20, s53
s_add_u32 m0, s21, 65536
s_nop 0
buffer_load_dwordx4 v8, s[8:11], s20 offen lds
s_add_u32 m0, s21, 66560
s_nop 0
buffer_load_dwordx4 v9, s[8:11], s20 offen lds
s_add_u32 m0, s21, 67584
s_nop 0
buffer_load_dwordx4 v10, s[8:11], s20 offen lds
s_add_u32 m0, s21, 68608
s_nop 0
buffer_load_dwordx4 v11, s[8:11], s20 offen lds
s_add_u32 s20, s20, 512
s_add_u32 m0, s21, 81920
s_nop 0
buffer_load_dwordx4 v8, s[8:11], s20 offen lds
s_add_u32 m0, s21, 82944
s_nop 0
buffer_load_dwordx4 v9, s[8:11], s20 offen lds
s_add_u32 m0, s21, 83968
s_nop 0
buffer_load_dwordx4 v10, s[8:11], s20 offen lds
s_add_u32 m0, s21, 84992
s_nop 0
buffer_load_dwordx4 v11, s[8:11], s20 offen lds
s_add_u32 s20, s20, 512
s_add_u32 m0, s21, 98304
s_nop 0
buffer_load_dwordx4 v8, s[8:11], s20 offen lds
s_waitcnt vmcnt(21)
s_barrier
ds_read_b128 v[20:23], v12 offset:0
ds_read_b128 v[24:27], v12 offset:4096
ds_read_b128 v[28:31], v13 offset:0
ds_read_b128 v[32:35], v13 offset:4096
ds_read_b128 v[36:39], v14 offset:0
ds_read_b128 v[40:43], v14 offset:4096
s_waitcnt lgkmcnt(4)
L_st_457:
v_mfma_f32_16x16x32_bf16 v[52:55], v[20:23], a[0:3], 0
ds_read_b128 v[44:47], v15 offset:0
s_add_u32 m0, s21, 99328
v_mfma_f32_16x16x32_bf16 v[56:59], v[20:23], a[4:7], 0
buffer_load_dwordx4 v9, s[8:11], s20 offen lds
v_mfma_f32_16x16x32_bf16 v[60:63], v[24:27], a[0:3], 0
ds_read_b128 v[48:51], v15 offset:4096
s_sub_u32 s39, s22, 1
v_mfma_f32_16x16x32_bf16 v[64:67], v[24:27], a[4:7], 0
s_waitcnt lgkmcnt(4)
s_bitcmp1_b32 s39, 1
s_cselect_b32 s38, s55, s54
v_mfma_f32_16x16x32_bf16 v[52:55], v[28:31], a[8:11], v[52:55]
ds_read_b128 v[20:23], v12 offset:256
v_mfma_f32_16x16x32_bf16 v[56:59], v[28:31], a[12:15], v[56:59]
v_mfma_f32_16x16x32_bf16 v[60:63], v[32:35], a[8:11], v[60:63]
ds_read_b128 v[24:27], v12 offset:4352
s_add_u32 s38, s38, s44
v_mfma_f32_16x16x32_bf16 v[64:67], v[32:35], a[12:15], v[64:67]
s_waitcnt lgkmcnt(4)
v_mfma_f32_16x16x32_bf16 v[52:55], v[36:39], a[16:19], v[52:55]
ds_read_b128 v[28:31], v13 offset:256
s_add_u32 m0, s21, 100352
v_mfma_f32_16x16x32_bf16 v[56:59], v[36:39], a[20:23], v[56:59]
buffer_load_dwordx4 v10, s[8:11], s20 offen lds
v_mfma_f32_16x16x32_bf16 v[60:63], v[40:43], a[16:19], v[60:63]
ds_read_b128 v[32:35], v13 offset:4352
s_lshl_b32 s42, s39, 20
v_mfma_f32_16x16x32_bf16 v[64:67], v[40:43], a[20:23], v[64:67]
s_waitcnt lgkmcnt(4)
v_mfma_f32_16x16x32_bf16 v[52:55], v[44:47], a[24:27], v[52:55]
ds_read_b128 v[36:39], v14 offset:256
s_add_u32 s38, s38, s42
v_mfma_f32_16x16x32_bf16 v[56:59], v[44:47], a[28:31], v[56:59]
s_lshl_b32 s39, s39, 7
v_mfma_f32_16x16x32_bf16 v[60:63], v[48:51], a[24:27], v[60:63]
ds_read_b128 v[40:43], v14 offset:4352
v_mfma_f32_16x16x32_bf16 v[64:67], v[48:51], a[28:31], v[64:67]
s_waitcnt lgkmcnt(4)
s_add_u32 s39, s39, 0x5900000
v_mfma_f32_16x16x32_bf16 v[52:55], v[20:23], a[32:35], v[52:55]
ds_read_b128 v[44:47], v15 offset:256
s_add_u32 m0, s21, 101376
v_mfma_f32_16x16x32_bf16 v[56:59], v[20:23], a[36:39], v[56:59]
buffer_load_dwordx4 v11, s[8:11], s20 offen lds
v_mfma_f32_16x16x32_bf16 v[60:63], v[24:27], a[32:35], v[60:63]
ds_read_b128 v[48:51], v15 offset:4352
v_mfma_f32_16x16x32_bf16 v[64:67], v[24:27], a[36:39], v[64:67]
s_waitcnt lgkmcnt(4)
s_cmp_eq_u32 s37, 0
s_cselect_b32 s38, 0x7ff00000, s38
s_cselect_b32 s39, 0x7ff00000, s39
v_mfma_f32_16x16x32_bf16 v[52:55], v[28:31], a[40:43], v[52:55]
s_waitcnt vmcnt(20)
s_barrier
ds_read_b128 v[20:23], v12 offset:16384
v_mfma_f32_16x16x32_bf16 v[56:59], v[28:31], a[44:47], v[56:59]
s_add_u32 s20, s20, 512
v_mfma_f32_16x16x32_bf16 v[60:63], v[32:35], a[40:43], v[60:63]
ds_read_b128 v[24:27], v12 offset:20480
v_mfma_f32_16x16x32_bf16 v[64:67], v[32:35], a[44:47], v[64:67]
s_waitcnt lgkmcnt(4)
v_mfma_f32_16x16x32_bf16 v[52:55], v[36:39], a[48:51], v[52:55]
ds_read_b128 v[28:31], v13 offset:16384
s_add_u32 m0, s21, 114688
v_mfma_f32_16x16x32_bf16 v[56:59], v[36:39], a[52:55], v[56:59]
buffer_load_dwordx4 v8, s[8:11], s20 offen lds
v_mfma_f32_16x16x32_bf16 v[60:63], v[40:43], a[48:51], v[60:63]
ds_read_b128 v[32:35], v13 offset:20480
v_mfma_f32_16x16x32_bf16 v[64:67], v[40:43], a[52:55], v[64:67]
s_waitcnt lgkmcnt(4)
v_mfma_f32_16x16x32_bf16 v[52:55], v[44:47], a[56:59], v[52:55]
ds_read_b128 v[36:39], v14 offset:16384
v_cvt_pk_bf16_f32 v88, v68, v69
v_mfma_f32_16x16x32_bf16 v[56:59], v[44:47], a[60:63], v[56:59]
v_cvt_pk_bf16_f32 v89, v70, v71
v_mfma_f32_16x16x32_bf16 v[60:63], v[48:51], a[56:59], v[60:63]
ds_read_b128 v[40:43], v14 offset:20480
v_mfma_f32_16x16x32_bf16 v[64:67], v[48:51], a[60:63], v[64:67]
s_waitcnt lgkmcnt(4)
v_cvt_pk_bf16_f32 v90, v76, v77
v_mfma_f32_16x16x32_bf16 v[52:55], v[20:23], a[64:67], v[52:55]
ds_read_b128 v[44:47], v15 offset:16384
s_add_u32 m0, s21, 115712
v_mfma_f32_16x16x32_bf16 v[56:59], v[20:23], a[68:71], v[56:59]
buffer_load_dwordx4 v9, s[8:11], s20 offen lds
v_mfma_f32_16x16x32_bf16 v[60:63], v[24:27], a[64:67], v[60:63]
ds_read_b128 v[48:51], v15 offset:20480
v_mfma_f32_16x16x32_bf16 v[64:67], v[24:27], a[68:71], v[64:67]
s_waitcnt lgkmcnt(4)
v_cvt_pk_bf16_f32 v91, v78, v79
v_mfma_f32_16x16x32_bf16 v[52:55], v[28:31], a[72:75], v[52:55]
ds_read_b128 v[20:23], v12 offset:16640
v_mfma_f32_16x16x32_bf16 v[56:59], v[28:31], a[76:79], v[56:59]
buffer_store_dwordx4 v[88:91], v86, s[12:15], s38 offen offset:2048 sc1
v_cvt_pk_bf16_f32 v92, v72, v73
v_mfma_f32_16x16x32_bf16 v[60:63], v[32:35], a[72:75], v[60:63]
ds_read_b128 v[24:27], v12 offset:20736
s_add_u32 s24, s24, 1
v_mfma_f32_16x16x32_bf16 v[64:67], v[32:35], a[76:79], v[64:67]
s_waitcnt lgkmcnt(4)
v_cvt_pk_bf16_f32 v93, v74, v75
v_mfma_f32_16x16x32_bf16 v[52:55], v[36:39], a[80:83], v[52:55]
ds_read_b128 v[28:31], v13 offset:16640
s_add_u32 m0, s21, 116736
v_mfma_f32_16x16x32_bf16 v[56:59], v[36:39], a[84:87], v[56:59]
buffer_load_dwordx4 v10, s[8:11], s20 offen lds
v_mfma_f32_16x16x32_bf16 v[60:63], v[40:43], a[80:83], v[60:63]
ds_read_b128 v[32:35], v13 offset:20736
v_cvt_pk_bf16_f32 v94, v80, v81
v_mfma_f32_16x16x32_bf16 v[64:67], v[40:43], a[84:87], v[64:67]
s_waitcnt lgkmcnt(4)
s_min_u32 s24, s24, 63
v_mfma_f32_16x16x32_bf16 v[52:55], v[44:47], a[88:91], v[52:55]
ds_read_b128 v[36:39], v14 offset:16640
v_cvt_pk_bf16_f32 v95, v82, v83
v_mfma_f32_16x16x32_bf16 v[56:59], v[44:47], a[92:95], v[56:59]
buffer_store_dwordx4 v[92:95], v86, s[12:15], s38 offen offset:2176 sc1
v_mfma_f32_16x16x32_bf16 v[60:63], v[48:51], a[88:91], v[60:63]
ds_read_b128 v[40:43], v14 offset:20736
s_add_u32 s42, s38, 0x8000000
v_mfma_f32_16x16x32_bf16 v[64:67], v[48:51], a[92:95], v[64:67]
s_waitcnt lgkmcnt(4)
s_lshl_b32 s53, s24, 16
v_mfma_f32_16x16x32_bf16 v[52:55], v[20:23], a[96:99], v[52:55]
ds_read_b128 v[44:47], v15 offset:16640
s_add_u32 m0, s21, 117760
v_mfma_f32_16x16x32_bf16 v[56:59], v[20:23], a[100:103], v[56:59]
buffer_load_dwordx4 v11, s[8:11], s20 offen lds
v_mfma_f32_16x16x32_bf16 v[60:63], v[24:27], a[96:99], v[60:63]
ds_read_b128 v[48:51], v15 offset:20736
v_mfma_f32_16x16x32_bf16 v[64:67], v[24:27], a[100:103], v[64:67]
s_waitcnt lgkmcnt(4)
v_mfma_f32_16x16x32_bf16 v[52:55], v[28:31], a[104:107], v[52:55]
s_waitcnt vmcnt(20)
s_barrier
ds_read_b128 v[20:23], v12 offset:32768
v_mfma_f32_16x16x32_bf16 v[56:59], v[28:31], a[108:111], v[56:59]
s_mov_b32 s20, s53
buffer_store_dwordx2 v[96:97], v101, s[12:15], s42 offen offset:512 sc1
v_mfma_f32_16x16x32_bf16 v[60:63], v[32:35], a[104:107], v[60:63]
ds_read_b128 v[24:27], v12 offset:36864
v_mfma_f32_16x16x32_bf16 v[64:67], v[32:35], a[108:111], v[64:67]
s_waitcnt lgkmcnt(4)
v_mfma_f32_16x16x32_bf16 v[52:55], v[36:39], a[112:115], v[52:55]
ds_read_b128 v[28:31], v13 offset:32768
s_add_u32 m0, s21, 0
v_mfma_f32_16x16x32_bf16 v[56:59], v[36:39], a[116:119], v[56:59]
buffer_load_dwordx4 v8, s[8:11], s20 offen lds
v_mfma_f32_16x16x32_bf16 v[60:63], v[40:43], a[112:115], v[60:63]
ds_read_b128 v[32:35], v13 offset:36864
v_mfma_f32_16x16x32_bf16 v[64:67], v[40:43], a[116:119], v[64:67]
s_waitcnt lgkmcnt(4)
v_mfma_f32_16x16x32_bf16 v[52:55], v[44:47], a[120:123], v[52:55]
ds_read_b128 v[36:39], v14 offset:32768
v_mfma_f32_16x16x32_bf16 v[56:59], v[44:47], a[124:127], v[56:59]
v_mfma_f32_16x16x32_bf16 v[60:63], v[48:51], a[120:123], v[60:63]
ds_read_b128 v[40:43], v14 offset:36864
v_mfma_f32_16x16x32_bf16 v[64:67], v[48:51], a[124:127], v[64:67]
s_waitcnt lgkmcnt(4)
v_mfma_f32_16x16x32_bf16 v[52:55], v[20:23], a[128:131], v[52:55]
ds_read_b128 v[44:47], v15 offset:32768
s_add_u32 m0, s21, 1024
v_mfma_f32_16x16x32_bf16 v[56:59], v[20:23], a[132:135], v[56:59]
buffer_load_dwordx4 v9, s[8:11], s20 offen lds
v_mfma_f32_16x16x32_bf16 v[60:63], v[24:27], a[128:131], v[60:63]
ds_read_b128 v[48:51], v15 offset:36864
v_mfma_f32_16x16x32_bf16 v[64:67], v[24:27], a[132:135], v[64:67]
s_waitcnt lgkmcnt(4)
v_mfma_f32_16x16x32_bf16 v[52:55], v[28:31], a[136:139], v[52:55]
ds_read_b128 v[20:23], v12 offset:33024
v_mfma_f32_16x16x32_bf16 v[56:59], v[28:31], a[140:143], v[56:59]
v_mfma_f32_16x16x32_bf16 v[60:63], v[32:35], a[136:139], v[60:63]
ds_read_b128 v[24:27], v12 offset:37120
v_mfma_f32_16x16x32_bf16 v[64:67], v[32:35], a[140:143], v[64:67]
s_waitcnt lgkmcnt(4)
v_mfma_f32_16x16x32_bf16 v[52:55], v[36:39], a[144:147], v[52:55]
ds_read_b128 v[28:31], v13 offset:33024
s_add_u32 m0, s21, 2048
v_mfma_f32_16x16x32_bf16 v[56:59], v[36:39], a[148:151], v[56:59]
buffer_load_dwordx4 v10, s[8:11], s20 offen lds
v_mfma_f32_16x16x32_bf16 v[60:63], v[40:43], a[144:147], v[60:63]
ds_read_b128 v[32:35], v13 offset:37120
v_mfma_f32_16x16x32_bf16 v[64:67], v[40:43], a[148:151], v[64:67]
s_waitcnt lgkmcnt(4)
v_mfma_f32_16x16x32_bf16 v[52:55], v[44:47], a[152:155], v[52:55]
ds_read_b128 v[36:39], v14 offset:33024
v_mfma_f32_16x16x32_bf16 v[56:59], v[44:47], a[156:159], v[56:59]
v_mfma_f32_16x16x32_bf16 v[60:63], v[48:51], a[152:155], v[60:63]
ds_read_b128 v[40:43], v14 offset:37120
v_mfma_f32_16x16x32_bf16 v[64:67], v[48:51], a[156:159], v[64:67]
s_waitcnt lgkmcnt(4)
v_mfma_f32_16x16x32_bf16 v[52:55], v[20:23], a[160:163], v[52:55]
ds_read_b128 v[44:47], v15 offset:33024
s_add_u32 m0, s21, 3072
v_mfma_f32_16x16x32_bf16 v[56:59], v[20:23], a[164:167], v[56:59]
buffer_load_dwordx4 v11, s[8:11], s20 offen lds
v_mfma_f32_16x16x32_bf16 v[60:63], v[24:27], a[160:163], v[60:63]
ds_read_b128 v[48:51], v15 offset:37120
v_mfma_f32_16x16x32_bf16 v[64:67], v[24:27], a[164:167], v[64:67]
s_waitcnt lgkmcnt(4)
v_mfma_f32_16x16x32_bf16 v[52:55], v[28:31], a[168:171], v[52:55]
s_waitcnt vmcnt(20)
s_barrier
ds_read_b128 v[20:23], v12 offset:49152
v_mfma_f32_16x16x32_bf16 v[56:59], v[28:31], a[172:175], v[56:59]
s_add_u32 s20, s20, 512
v_mfma_f32_16x16x32_bf16 v[60:63], v[32:35], a[168:171], v[60:63]
ds_read_b128 v[24:27], v12 offset:53248
v_mfma_f32_16x16x32_bf16 v[64:67], v[32:35], a[172:175], v[64:67]
s_waitcnt lgkmcnt(4)
v_mfma_f32_16x16x32_bf16 v[52:55], v[36:39], a[176:179], v[52:55]
ds_read_b128 v[28:31], v13 offset:49152
s_add_u32 m0, s21, 16384
v_mfma_f32_16x16x32_bf16 v[56:59], v[36:39], a[180:183], v[56:59]
buffer_load_dwordx4 v8, s[8:11], s20 offen lds
v_mfma_f32_16x16x32_bf16 v[60:63], v[40:43], a[176:179], v[60:63]
ds_read_b128 v[32:35], v13 offset:53248
v_mfma_f32_16x16x32_bf16 v[64:67], v[40:43], a[180:183], v[64:67]
s_waitcnt lgkmcnt(4)
v_mfma_f32_16x16x32_bf16 v[52:55], v[44:47], a[184:187], v[52:55]
ds_read_b128 v[36:39], v14 offset:49152
v_mfma_f32_16x16x32_bf16 v[56:59], v[44:47], a[188:191], v[56:59]
v_mfma_f32_16x16x32_bf16 v[60:63], v[48:51], a[184:187], v[60:63]
ds_read_b128 v[40:43], v14 offset:53248
v_mfma_f32_16x16x32_bf16 v[64:67], v[48:51], a[188:191], v[64:67]
s_waitcnt lgkmcnt(4)
v_mfma_f32_16x16x32_bf16 v[52:55], v[20:23], a[192:195], v[52:55]
ds_read_b128 v[44:47], v15 offset:49152
s_add_u32 m0, s21, 17408
v_mfma_f32_16x16x32_bf16 v[56:59], v[20:23], a[196:199], v[56:59]
buffer_load_dwordx4 v9, s[8:11], s20 offen lds
v_mfma_f32_16x16x32_bf16 v[60:63], v[24:27], a[192:195], v[60:63]
ds_read_b128 v[48:51], v15 offset:53248
v_mfma_f32_16x16x32_bf16 v[64:67], v[24:27], a[196:199], v[64:67]
s_waitcnt lgkmcnt(4)
v_mfma_f32_16x16x32_bf16 v[52:55], v[28:31], a[200:203], v[52:55]
ds_read_b128 v[20:23], v12 offset:49408
v_mfma_f32_16x16x32_bf16 v[56:59], v[28:31], a[204:207], v[56:59]
v_mfma_f32_16x16x32_bf16 v[60:63], v[32:35], a[200:203], v[60:63]
ds_read_b128 v[24:27], v12 offset:53504
v_mfma_f32_16x16x32_bf16 v[64:67], v[32:35], a[204:207], v[64:67]
s_waitcnt lgkmcnt(4)
v_mfma_f32_16x16x32_bf16 v[52:55], v[36:39], a[208:211], v[52:55]
ds_read_b128 v[28:31], v13 offset:49408
s_add_u32 m0, s21, 18432
v_mfma_f32_16x16x32_bf16 v[56:59], v[36:39], a[212:215], v[56:59]
buffer_load_dwordx4 v10, s[8:11], s20 offen lds
v_mfma_f32_16x16x32_bf16 v[60:63], v[40:43], a[208:211], v[60:63]
ds_read_b128 v[32:35], v13 offset:53504
v_mfma_f32_16x16x32_bf16 v[64:67], v[40:43], a[212:215], v[64:67]
s_waitcnt lgkmcnt(4)
v_mfma_f32_16x16x32_bf16 v[52:55], v[44:47], a[216:219], v[52:55]
ds_read_b128 v[36:39], v14 offset:49408
v_mfma_f32_16x16x32_bf16 v[56:59], v[44:47], a[220:223], v[56:59]
v_mfma_f32_16x16x32_bf16 v[60:63], v[48:51], a[216:219], v[60:63]
ds_read_b128 v[40:43], v14 offset:53504
v_mfma_f32_16x16x32_bf16 v[64:67], v[48:51], a[220:223], v[64:67]
s_waitcnt lgkmcnt(4)
v_mfma_f32_16x16x32_bf16 v[52:55], v[20:23], a[224:227], v[52:55]
ds_read_b128 v[44:47], v15 offset:49408
s_add_u32 m0, s21, 19456
v_mfma_f32_16x16x32_bf16 v[56:59], v[20:23], a[228:231], v[56:59]
buffer_load_dwordx4 v11, s[8:11], s20 offen lds
v_mfma_f32_16x16x32_bf16 v[60:63], v[24:27], a[224:227], v[60:63]
ds_read_b128 v[48:51], v15 offset:53504
v_mfma_f32_16x16x32_bf16 v[64:67], v[24:27], a[228:231], v[64:67]
s_waitcnt lgkmcnt(4)
v_mfma_f32_16x16x32_bf16 v[52:55], v[28:31], a[232:235], v[52:55]
s_waitcnt vmcnt(8)
s_barrier
ds_read_b128 v[20:23], v16 offset:0
v_mfma_f32_16x16x32_bf16 v[56:59], v[28:31], a[236:239], v[56:59]
s_add_u32 s20, s20, 512
buffer_atomic_add v84, v85, s[12:15], s39 offen sc1
v_mfma_f32_16x16x32_bf16 v[60:63], v[32:35], a[232:235], v[60:63]
ds_read_b128 v[24:27], v16 offset:4096
s_mov_b32 s37, 1
v_mfma_f32_16x16x32_bf16 v[64:67], v[32:35], a[236:239], v[64:67]
s_waitcnt lgkmcnt(4)
v_mfma_f32_16x16x32_bf16 v[52:55], v[36:39], a[240:243], v[52:55]
ds_read_b128 v[28:31], v17 offset:0
s_add_u32 m0, s21, 32768
v_mfma_f32_16x16x32_bf16 v[56:59], v[36:39], a[244:247], v[56:59]
buffer_load_dwordx4 v8, s[8:11], s20 offen lds
v_mfma_f32_16x16x32_bf16 v[60:63], v[40:43], a[240:243], v[60:63]
ds_read_b128 v[32:35], v17 offset:4096
v_mfma_f32_16x16x32_bf16 v[64:67], v[40:43], a[244:247], v[64:67]
s_waitcnt lgkmcnt(4)
v_mfma_f32_16x16x32_bf16 v[52:55], v[44:47], a[248:251], v[52:55]
ds_read_b128 v[36:39], v18 offset:0
v_mfma_f32_16x16x32_bf16 v[56:59], v[44:47], a[252:255], v[56:59]
v_mfma_f32_16x16x32_bf16 v[60:63], v[48:51], a[248:251], v[60:63]
ds_read_b128 v[40:43], v18 offset:4096
v_mfma_f32_16x16x32_bf16 v[64:67], v[48:51], a[252:255], v[64:67]
s_waitcnt lgkmcnt(4)
s_add_u32 s22, s22, 1
s_cmp_ge_u32 s22, s23
s_cbranch_scc1 L_fl0_454
v_mfma_f32_16x16x32_bf16 v[68:71], v[20:23], a[0:3], 0
ds_read_b128 v[44:47], v19 offset:0
s_add_u32 m0, s21, 33792
v_mfma_f32_16x16x32_bf16 v[72:75], v[20:23], a[4:7], 0
buffer_load_dwordx4 v9, s[8:11], s20 offen lds
v_mfma_f32_16x16x32_bf16 v[76:79], v[24:27], a[0:3], 0
ds_read_b128 v[48:51], v19 offset:4096
s_sub_u32 s39, s22, 1
v_mfma_f32_16x16x32_bf16 v[80:83], v[24:27], a[4:7], 0
s_waitcnt lgkmcnt(4)
s_bitcmp1_b32 s39, 1
s_cselect_b32 s38, s55, s54
v_mfma_f32_16x16x32_bf16 v[68:71], v[28:31], a[8:11], v[68:71]
ds_read_b128 v[20:23], v16 offset:256
v_mfma_f32_16x16x32_bf16 v[72:75], v[28:31], a[12:15], v[72:75]
v_mfma_f32_16x16x32_bf16 v[76:79], v[32:35], a[8:11], v[76:79]
ds_read_b128 v[24:27], v16 offset:4352
s_add_u32 s38, s38, s44
v_mfma_f32_16x16x32_bf16 v[80:83], v[32:35], a[12:15], v[80:83]
s_waitcnt lgkmcnt(4)
v_mfma_f32_16x16x32_bf16 v[68:71], v[36:39], a[16:19], v[68:71]
ds_read_b128 v[28:31], v17 offset:256
s_add_u32 m0, s21, 34816
v_mfma_f32_16x16x32_bf16 v[72:75], v[36:39], a[20:23], v[72:75]
buffer_load_dwordx4 v10, s[8:11], s20 offen lds
v_mfma_f32_16x16x32_bf16 v[76:79], v[40:43], a[16:19], v[76:79]
ds_read_b128 v[32:35], v17 offset:4352
s_lshl_b32 s42, s39, 20
v_mfma_f32_16x16x32_bf16 v[80:83], v[40:43], a[20:23], v[80:83]
s_waitcnt lgkmcnt(4)
v_mfma_f32_16x16x32_bf16 v[68:71], v[44:47], a[24:27], v[68:71]
ds_read_b128 v[36:39], v18 offset:256
s_add_u32 s38, s38, s42
v_mfma_f32_16x16x32_bf16 v[72:75], v[44:47], a[28:31], v[72:75]
s_lshl_b32 s39, s39, 7
v_mfma_f32_16x16x32_bf16 v[76:79], v[48:51], a[24:27], v[76:79]
ds_read_b128 v[40:43], v18 offset:4352
v_mfma_f32_16x16x32_bf16 v[80:83], v[48:51], a[28:31], v[80:83]
s_waitcnt lgkmcnt(4)
s_add_u32 s39, s39, 0x5900000
v_mfma_f32_16x16x32_bf16 v[68:71], v[20:23], a[32:35], v[68:71]
ds_read_b128 v[44:47], v19 offset:256
s_add_u32 m0, s21, 35840
v_mfma_f32_16x16x32_bf16 v[72:75], v[20:23], a[36:39], v[72:75]
buffer_load_dwordx4 v11, s[8:11], s20 offen lds
v_mfma_f32_16x16x32_bf16 v[76:79], v[24:27], a[32:35], v[76:79]
ds_read_b128 v[48:51], v19 offset:4352
v_mfma_f32_16x16x32_bf16 v[80:83], v[24:27], a[36:39], v[80:83]
s_waitcnt lgkmcnt(4)
s_cmp_eq_u32 s37, 0
s_cselect_b32 s38, 0x7ff00000, s38
s_cselect_b32 s39, 0x7ff00000, s39
v_mfma_f32_16x16x32_bf16 v[68:71], v[28:31], a[40:43], v[68:71]
s_waitcnt vmcnt(20)
s_barrier
ds_read_b128 v[20:23], v16 offset:16384
v_mfma_f32_16x16x32_bf16 v[72:75], v[28:31], a[44:47], v[72:75]
s_add_u32 s20, s20, 512
v_mfma_f32_16x16x32_bf16 v[76:79], v[32:35], a[40:43], v[76:79]
ds_read_b128 v[24:27], v16 offset:20480
v_mfma_f32_16x16x32_bf16 v[80:83], v[32:35], a[44:47], v[80:83]
s_waitcnt lgkmcnt(4)
v_mfma_f32_16x16x32_bf16 v[68:71], v[36:39], a[48:51], v[68:71]
ds_read_b128 v[28:31], v17 offset:16384
s_add_u32 m0, s21, 49152
v_mfma_f32_16x16x32_bf16 v[72:75], v[36:39], a[52:55], v[72:75]
buffer_load_dwordx4 v8, s[8:11], s20 offen lds
v_mfma_f32_16x16x32_bf16 v[76:79], v[40:43], a[48:51], v[76:79]
ds_read_b128 v[32:35], v17 offset:20480
v_mfma_f32_16x16x32_bf16 v[80:83], v[40:43], a[52:55], v[80:83]
s_waitcnt lgkmcnt(4)
v_mfma_f32_16x16x32_bf16 v[68:71], v[44:47], a[56:59], v[68:71]
ds_read_b128 v[36:39], v18 offset:16384
v_cvt_pk_bf16_f32 v88, v52, v53
v_mfma_f32_16x16x32_bf16 v[72:75], v[44:47], a[60:63], v[72:75]
v_cvt_pk_bf16_f32 v89, v54, v55
v_mfma_f32_16x16x32_bf16 v[76:79], v[48:51], a[56:59], v[76:79]
ds_read_b128 v[40:43], v18 offset:20480
v_mfma_f32_16x16x32_bf16 v[80:83], v[48:51], a[60:63], v[80:83]
s_waitcnt lgkmcnt(4)
v_cvt_pk_bf16_f32 v90, v60, v61
v_mfma_f32_16x16x32_bf16 v[68:71], v[20:23], a[64:67], v[68:71]
ds_read_b128 v[44:47], v19 offset:16384
s_add_u32 m0, s21, 50176
v_mfma_f32_16x16x32_bf16 v[72:75], v[20:23], a[68:71], v[72:75]
buffer_load_dwordx4 v9, s[8:11], s20 offen lds
v_mfma_f32_16x16x32_bf16 v[76:79], v[24:27], a[64:67], v[76:79]
ds_read_b128 v[48:51], v19 offset:20480
v_mfma_f32_16x16x32_bf16 v[80:83], v[24:27], a[68:71], v[80:83]
s_waitcnt lgkmcnt(4)
v_cvt_pk_bf16_f32 v91, v62, v63
v_mfma_f32_16x16x32_bf16 v[68:71], v[28:31], a[72:75], v[68:71]
ds_read_b128 v[20:23], v16 offset:16640
v_mfma_f32_16x16x32_bf16 v[72:75], v[28:31], a[76:79], v[72:75]
buffer_store_dwordx4 v[88:91], v86, s[12:15], s38 offen offset:2048 sc1
v_cvt_pk_bf16_f32 v92, v56, v57
v_mfma_f32_16x16x32_bf16 v[76:79], v[32:35], a[72:75], v[76:79]
ds_read_b128 v[24:27], v16 offset:20736
s_add_u32 s24, s24, 1
v_mfma_f32_16x16x32_bf16 v[80:83], v[32:35], a[76:79], v[80:83]
s_waitcnt lgkmcnt(4)
v_cvt_pk_bf16_f32 v93, v58, v59
v_mfma_f32_16x16x32_bf16 v[68:71], v[36:39], a[80:83], v[68:71]
ds_read_b128 v[28:31], v17 offset:16640
s_add_u32 m0, s21, 51200
v_mfma_f32_16x16x32_bf16 v[72:75], v[36:39], a[84:87], v[72:75]
buffer_load_dwordx4 v10, s[8:11], s20 offen lds
v_mfma_f32_16x16x32_bf16 v[76:79], v[40:43], a[80:83], v[76:79]
ds_read_b128 v[32:35], v17 offset:20736
v_cvt_pk_bf16_f32 v94, v64, v65
v_mfma_f32_16x16x32_bf16 v[80:83], v[40:43], a[84:87], v[80:83]
s_waitcnt lgkmcnt(4)
s_min_u32 s24, s24, 63
v_mfma_f32_16x16x32_bf16 v[68:71], v[44:47], a[88:91], v[68:71]
ds_read_b128 v[36:39], v18 offset:16640
v_cvt_pk_bf16_f32 v95, v66, v67
v_mfma_f32_16x16x32_bf16 v[72:75], v[44:47], a[92:95], v[72:75]
buffer_store_dwordx4 v[92:95], v86, s[12:15], s38 offen offset:2176 sc1
v_mfma_f32_16x16x32_bf16 v[76:79], v[48:51], a[88:91], v[76:79]
ds_read_b128 v[40:43], v18 offset:20736
s_add_u32 s42, s38, 0x8000000
v_mfma_f32_16x16x32_bf16 v[80:83], v[48:51], a[92:95], v[80:83]
s_waitcnt lgkmcnt(4)
s_lshl_b32 s53, s24, 16
v_mfma_f32_16x16x32_bf16 v[68:71], v[20:23], a[96:99], v[68:71]
ds_read_b128 v[44:47], v19 offset:16640
s_add_u32 m0, s21, 52224
v_mfma_f32_16x16x32_bf16 v[72:75], v[20:23], a[100:103], v[72:75]
buffer_load_dwordx4 v11, s[8:11], s20 offen lds
v_mfma_f32_16x16x32_bf16 v[76:79], v[24:27], a[96:99], v[76:79]
ds_read_b128 v[48:51], v19 offset:20736
v_mfma_f32_16x16x32_bf16 v[80:83], v[24:27], a[100:103], v[80:83]
s_waitcnt lgkmcnt(4)
v_mfma_f32_16x16x32_bf16 v[68:71], v[28:31], a[104:107], v[68:71]
s_waitcnt vmcnt(20)
s_barrier
ds_read_b128 v[20:23], v16 offset:32768
v_mfma_f32_16x16x32_bf16 v[72:75], v[28:31], a[108:111], v[72:75]
s_mov_b32 s20, s53
buffer_store_dwordx2 v[96:97], v101, s[12:15], s42 offen offset:512 sc1
v_mfma_f32_16x16x32_bf16 v[76:79], v[32:35], a[104:107], v[76:79]
ds_read_b128 v[24:27], v16 offset:36864
v_mfma_f32_16x16x32_bf16 v[80:83], v[32:35], a[108:111], v[80:83]
s_waitcnt lgkmcnt(4)
v_mfma_f32_16x16x32_bf16 v[68:71], v[36:39], a[112:115], v[68:71]
ds_read_b128 v[28:31], v17 offset:32768
s_add_u32 m0, s21, 65536
v_mfma_f32_16x16x32_bf16 v[72:75], v[36:39], a[116:119], v[72:75]
buffer_load_dwordx4 v8, s[8:11], s20 offen lds
v_mfma_f32_16x16x32_bf16 v[76:79], v[40:43], a[112:115], v[76:79]
ds_read_b128 v[32:35], v17 offset:36864
v_mfma_f32_16x16x32_bf16 v[80:83], v[40:43], a[116:119], v[80:83]
s_waitcnt lgkmcnt(4)
v_mfma_f32_16x16x32_bf16 v[68:71], v[44:47], a[120:123], v[68:71]
ds_read_b128 v[36:39], v18 offset:32768
v_mfma_f32_16x16x32_bf16 v[72:75], v[44:47], a[124:127], v[72:75]
v_mfma_f32_16x16x32_bf16 v[76:79], v[48:51], a[120:123], v[76:79]
ds_read_b128 v[40:43], v18 offset:36864
v_mfma_f32_16x16x32_bf16 v[80:83], v[48:51], a[124:127], v[80:83]
s_waitcnt lgkmcnt(4)
v_mfma_f32_16x16x32_bf16 v[68:71], v[20:23], a[128:131], v[68:71]
ds_read_b128 v[44:47], v19 offset:32768
s_add_u32 m0, s21, 66560
v_mfma_f32_16x16x32_bf16 v[72:75], v[20:23], a[132:135], v[72:75]
buffer_load_dwordx4 v9, s[8:11], s20 offen lds
v_mfma_f32_16x16x32_bf16 v[76:79], v[24:27], a[128:131], v[76:79]
ds_read_b128 v[48:51], v19 offset:36864
v_mfma_f32_16x16x32_bf16 v[80:83], v[24:27], a[132:135], v[80:83]
s_waitcnt lgkmcnt(4)
v_mfma_f32_16x16x32_bf16 v[68:71], v[28:31], a[136:139], v[68:71]
ds_read_b128 v[20:23], v16 offset:33024
v_mfma_f32_16x16x32_bf16 v[72:75], v[28:31], a[140:143], v[72:75]
v_mfma_f32_16x16x32_bf16 v[76:79], v[32:35], a[136:139], v[76:79]
ds_read_b128 v[24:27], v16 offset:37120
v_mfma_f32_16x16x32_bf16 v[80:83], v[32:35], a[140:143], v[80:83]
s_waitcnt lgkmcnt(4)
v_mfma_f32_16x16x32_bf16 v[68:71], v[36:39], a[144:147], v[68:71]
ds_read_b128 v[28:31], v17 offset:33024
s_add_u32 m0, s21, 67584
v_mfma_f32_16x16x32_bf16 v[72:75], v[36:39], a[148:151], v[72:75]
buffer_load_dwordx4 v10, s[8:11], s20 offen lds
v_mfma_f32_16x16x32_bf16 v[76:79], v[40:43], a[144:147], v[76:79]
ds_read_b128 v[32:35], v17 offset:37120
v_mfma_f32_16x16x32_bf16 v[80:83], v[40:43], a[148:151], v[80:83]
s_waitcnt lgkmcnt(4)
v_mfma_f32_16x16x32_bf16 v[68:71], v[44:47], a[152:155], v[68:71]
ds_read_b128 v[36:39], v18 offset:33024
v_mfma_f32_16x16x32_bf16 v[72:75], v[44:47], a[156:159], v[72:75]
v_mfma_f32_16x16x32_bf16 v[76:79], v[48:51], a[152:155], v[76:79]
ds_read_b128 v[40:43], v18 offset:37120
v_mfma_f32_16x16x32_bf16 v[80:83], v[48:51], a[156:159], v[80:83]
s_waitcnt lgkmcnt(4)
v_mfma_f32_16x16x32_bf16 v[68:71], v[20:23], a[160:163], v[68:71]
ds_read_b128 v[44:47], v19 offset:33024
s_add_u32 m0, s21, 68608
v_mfma_f32_16x16x32_bf16 v[72:75], v[20:23], a[164:167], v[72:75]
buffer_load_dwordx4 v11, s[8:11], s20 offen lds
v_mfma_f32_16x16x32_bf16 v[76:79], v[24:27], a[160:163], v[76:79]
ds_read_b128 v[48:51], v19 offset:37120
v_mfma_f32_16x16x32_bf16 v[80:83], v[24:27], a[164:167], v[80:83]
s_waitcnt lgkmcnt(4)
v_mfma_f32_16x16x32_bf16 v[68:71], v[28:31], a[168:171], v[68:71]
s_waitcnt vmcnt(20)
s_barrier
ds_read_b128 v[20:23], v16 offset:49152
v_mfma_f32_16x16x32_bf16 v[72:75], v[28:31], a[172:175], v[72:75]
s_add_u32 s20, s20, 512
v_mfma_f32_16x16x32_bf16 v[76:79], v[32:35], a[168:171], v[76:79]
ds_read_b128 v[24:27], v16 offset:53248
v_mfma_f32_16x16x32_bf16 v[80:83], v[32:35], a[172:175], v[80:83]
s_waitcnt lgkmcnt(4)
v_mfma_f32_16x16x32_bf16 v[68:71], v[36:39], a[176:179], v[68:71]
ds_read_b128 v[28:31], v17 offset:49152
s_add_u32 m0, s21, 81920
v_mfma_f32_16x16x32_bf16 v[72:75], v[36:39], a[180:183], v[72:75]
buffer_load_dwordx4 v8, s[8:11], s20 offen lds
v_mfma_f32_16x16x32_bf16 v[76:79], v[40:43], a[176:179], v[76:79]
ds_read_b128 v[32:35], v17 offset:53248
v_mfma_f32_16x16x32_bf16 v[80:83], v[40:43], a[180:183], v[80:83]
s_waitcnt lgkmcnt(4)
v_mfma_f32_16x16x32_bf16 v[68:71], v[44:47], a[184:187], v[68:71]
ds_read_b128 v[36:39], v18 offset:49152
v_mfma_f32_16x16x32_bf16 v[72:75], v[44:47], a[188:191], v[72:75]
v_mfma_f32_16x16x32_bf16 v[76:79], v[48:51], a[184:187], v[76:79]
ds_read_b128 v[40:43], v18 offset:53248
v_mfma_f32_16x16x32_bf16 v[80:83], v[48:51], a[188:191], v[80:83]
s_waitcnt lgkmcnt(4)
v_mfma_f32_16x16x32_bf16 v[68:71], v[20:23], a[192:195], v[68:71]
ds_read_b128 v[44:47], v19 offset:49152
s_add_u32 m0, s21, 82944
v_mfma_f32_16x16x32_bf16 v[72:75], v[20:23], a[196:199], v[72:75]
buffer_load_dwordx4 v9, s[8:11], s20 offen lds
v_mfma_f32_16x16x32_bf16 v[76:79], v[24:27], a[192:195], v[76:79]
ds_read_b128 v[48:51], v19 offset:53248
v_mfma_f32_16x16x32_bf16 v[80:83], v[24:27], a[196:199], v[80:83]
s_waitcnt lgkmcnt(4)
v_mfma_f32_16x16x32_bf16 v[68:71], v[28:31], a[200:203], v[68:71]
ds_read_b128 v[20:23], v16 offset:49408
v_mfma_f32_16x16x32_bf16 v[72:75], v[28:31], a[204:207], v[72:75]
v_mfma_f32_16x16x32_bf16 v[76:79], v[32:35], a[200:203], v[76:79]
ds_read_b128 v[24:27], v16 offset:53504
v_mfma_f32_16x16x32_bf16 v[80:83], v[32:35], a[204:207], v[80:83]
s_waitcnt lgkmcnt(4)
v_mfma_f32_16x16x32_bf16 v[68:71], v[36:39], a[208:211], v[68:71]
ds_read_b128 v[28:31], v17 offset:49408
s_add_u32 m0, s21, 83968
v_mfma_f32_16x16x32_bf16 v[72:75], v[36:39], a[212:215], v[72:75]
buffer_load_dwordx4 v10, s[8:11], s20 offen lds
v_mfma_f32_16x16x32_bf16 v[76:79], v[40:43], a[208:211], v[76:79]
ds_read_b128 v[32:35], v17 offset:53504
v_mfma_f32_16x16x32_bf16 v[80:83], v[40:43], a[212:215], v[80:83]
s_waitcnt lgkmcnt(4)
v_mfma_f32_16x16x32_bf16 v[68:71], v[44:47], a[216:219], v[68:71]
ds_read_b128 v[36:39], v18 offset:49408
v_mfma_f32_16x16x32_bf16 v[72:75], v[44:47], a[220:223], v[72:75]
v_mfma_f32_16x16x32_bf16 v[76:79], v[48:51], a[216:219], v[76:79]
ds_read_b128 v[40:43], v18 offset:53504
v_mfma_f32_16x16x32_bf16 v[80:83], v[48:51], a[220:223], v[80:83]
s_waitcnt lgkmcnt(4)
v_mfma_f32_16x16x32_bf16 v[68:71], v[20:23], a[224:227], v[68:71]
ds_read_b128 v[44:47], v19 offset:49408
s_add_u32 m0, s21, 84992
v_mfma_f32_16x16x32_bf16 v[72:75], v[20:23], a[228:231], v[72:75]
buffer_load_dwordx4 v11, s[8:11], s20 offen lds
v_mfma_f32_16x16x32_bf16 v[76:79], v[24:27], a[224:227], v[76:79]
ds_read_b128 v[48:51], v19 offset:53504
v_mfma_f32_16x16x32_bf16 v[80:83], v[24:27], a[228:231], v[80:83]
s_waitcnt lgkmcnt(4)
v_mfma_f32_16x16x32_bf16 v[68:71], v[28:31], a[232:235], v[68:71]
s_waitcnt vmcnt(8)
s_barrier
ds_read_b128 v[20:23], v12 offset:0
v_mfma_f32_16x16x32_bf16 v[72:75], v[28:31], a[236:239], v[72:75]
s_add_u32 s20, s20, 512
buffer_atomic_add v84, v85, s[12:15], s39 offen sc1
v_mfma_f32_16x16x32_bf16 v[76:79], v[32:35], a[232:235], v[76:79]
ds_read_b128 v[24:27], v12 offset:4096
s_mov_b32 s37, 1
v_mfma_f32_16x16x32_bf16 v[80:83], v[32:35], a[236:239], v[80:83]
s_waitcnt lgkmcnt(4)
v_mfma_f32_16x16x32_bf16 v[68:71], v[36:39], a[240:243], v[68:71]
ds_read_b128 v[28:31], v13 offset:0
s_add_u32 m0, s21, 98304
v_mfma_f32_16x16x32_bf16 v[72:75], v[36:39], a[244:247], v[72:75]
buffer_load_dwordx4 v8, s[8:11], s20 offen lds
v_mfma_f32_16x16x32_bf16 v[76:79], v[40:43], a[240:243], v[76:79]
ds_read_b128 v[32:35], v13 offset:4096
v_mfma_f32_16x16x32_bf16 v[80:83], v[40:43], a[244:247], v[80:83]
s_waitcnt lgkmcnt(4)
v_mfma_f32_16x16x32_bf16 v[68:71], v[44:47], a[248:251], v[68:71]
ds_read_b128 v[36:39], v14 offset:0
v_mfma_f32_16x16x32_bf16 v[72:75], v[44:47], a[252:255], v[72:75]
v_mfma_f32_16x16x32_bf16 v[76:79], v[48:51], a[248:251], v[76:79]
ds_read_b128 v[40:43], v14 offset:4096
v_mfma_f32_16x16x32_bf16 v[80:83], v[48:51], a[252:255], v[80:83]
s_waitcnt lgkmcnt(4)
s_add_u32 s22, s22, 1
s_cmp_ge_u32 s22, s23
s_cbranch_scc0 L_st_457
L_fl1_455:
s_waitcnt lgkmcnt(0)
s_nop 7
s_sub_u32 s39, s22, 1
s_bitcmp1_b32 s39, 1
s_cselect_b32 s38, s55, s54
s_add_u32 s38, s38, s44
s_lshl_b32 s42, s39, 20
s_add_u32 s38, s38, s42
s_lshl_b32 s39, s39, 7
s_add_u32 s39, s39, 0x5900000
s_cmp_eq_u32 s37, 0
s_cselect_b32 s38, 0x7ff00000, s38
s_cselect_b32 s39, 0x7ff00000, s39
v_cvt_pk_bf16_f32 v88, v68, v69
v_cvt_pk_bf16_f32 v89, v70, v71
v_cvt_pk_bf16_f32 v90, v76, v77
v_cvt_pk_bf16_f32 v91, v78, v79
buffer_store_dwordx4 v[88:91], v86, s[12:15], s38 offen offset:2048 sc1
v_cvt_pk_bf16_f32 v92, v72, v73
v_cvt_pk_bf16_f32 v93, v74, v75
v_cvt_pk_bf16_f32 v94, v80, v81
v_cvt_pk_bf16_f32 v95, v82, v83
buffer_store_dwordx4 v[92:95], v86, s[12:15], s38 offen offset:2176 sc1
s_add_u32 s42, s38, 0x8000000
buffer_store_dwordx2 v[96:97], v101, s[12:15], s42 offen offset:512 sc1
s_waitcnt vmcnt(0)
s_barrier
buffer_atomic_add v84, v85, s[12:15], s39 offen sc1
s_mov_b32 s37, 1
s_branch L_ste_456
L_fl0_454:
s_waitcnt lgkmcnt(0)
s_nop 7
s_sub_u32 s39, s22, 1
s_bitcmp1_b32 s39, 1
s_cselect_b32 s38, s55, s54
s_add_u32 s38, s38, s44
s_lshl_b32 s42, s39, 20
s_add_u32 s38, s38, s42
s_lshl_b32 s39, s39, 7
s_add_u32 s39, s39, 0x5900000
s_cmp_eq_u32 s37, 0
s_cselect_b32 s38, 0x7ff00000, s38
s_cselect_b32 s39, 0x7ff00000, s39
v_cvt_pk_bf16_f32 v88, v52, v53
v_cvt_pk_bf16_f32 v89, v54, v55
v_cvt_pk_bf16_f32 v90, v60, v61
v_cvt_pk_bf16_f32 v91, v62, v63
buffer_store_dwordx4 v[88:91], v86, s[12:15], s38 offen offset:2048 sc1
v_cvt_pk_bf16_f32 v92, v56, v57
v_cvt_pk_bf16_f32 v93, v58, v59
v_cvt_pk_bf16_f32 v94, v64, v65
v_cvt_pk_bf16_f32 v95, v66, v67
buffer_store_dwordx4 v[92:95], v86, s[12:15], s38 offen offset:2176 sc1
s_add_u32 s42, s38, 0x8000000
buffer_store_dwordx2 v[96:97], v101, s[12:15], s42 offen offset:512 sc1
s_waitcnt vmcnt(0)
s_barrier
buffer_atomic_add v84, v85, s[12:15], s39 offen sc1
s_mov_b32 s37, 1
L_ste_456:
s_branch L_op_443
L_q_440:
v_and_b32 v1, 31, v0
v_bfe_u32 v2, v0, 5, 1
v_and_b32 v96, 63, v0
v_lshlrev_b32 v96, 4, v96
v_and_b32 v4, 7, v1
v_lshlrev_b32 v4, 4, v4
s_lshl_b32 s7, s49, 12
s_add_u32 s7, s7, 0x21000
v_lshl_add_u32 v97, v2, 7, v4
v_add_u32 v97, s7, v97
v_bfe_u32 v5, v1, 2, 1
v_lshlrev_b32 v5, 4, v5
v_lshrrev_b32 v6, 3, v1
v_lshl_add_u32 v5, v6, 2, v5
v_and_b32 v6, 3, v1
v_add_u32 v5, v5, v6
v_lshlrev_b32 v5, 4, v5
v_lshl_add_u32 v98, v2, 9, v5
v_lshl_add_u32 v99, v2, 3, v5
v_add_u32 v99, s7, v99
v_lshlrev_b32 v4, 4, v1
v_lshl_add_u32 v100, v2, 10, v4
v_and_b32 v85, 63, v0
v_min_u32 v85, 1, v85
v_lshlrev_b32 v85, 30, v85
v_lshlrev_b32 v4, 2, v2
v_sub_u32 v4, v1, v4
v_mov_b32 v5, 0xff800000
v_cmp_gt_i32 vcc, 0, v4
s_nop 1
v_cndmask_b32 v240, 0, v5, vcc
v_cmp_gt_i32 vcc, 1, v4
s_nop 1
v_cndmask_b32 v241, 0, v5, vcc
v_cmp_gt_i32 vcc, 2, v4
s_nop 1
v_cndmask_b32 v242, 0, v5, vcc
v_cmp_gt_i32 vcc, 3, v4
s_nop 1
v_cndmask_b32 v243, 0, v5, vcc
v_cmp_gt_i32 vcc, 8, v4
s_nop 1
v_cndmask_b32 v244, 0, v5, vcc
v_cmp_gt_i32 vcc, 9, v4
s_nop 1
v_cndmask_b32 v245, 0, v5, vcc
v_cmp_gt_i32 vcc, 10, v4
s_nop 1
v_cndmask_b32 v246, 0, v5, vcc
v_cmp_gt_i32 vcc, 11, v4
s_nop 1
v_cndmask_b32 v247, 0, v5, vcc
v_cmp_gt_i32 vcc, 16, v4
s_nop 1
v_cndmask_b32 v248, 0, v5, vcc
v_cmp_gt_i32 vcc, 17, v4
s_nop 1
v_cndmask_b32 v249, 0, v5, vcc
v_cmp_gt_i32 vcc, 18, v4
s_nop 1
v_cndmask_b32 v250, 0, v5, vcc
v_cmp_gt_i32 vcc, 19, v4
s_nop 1
v_cndmask_b32 v251, 0, v5, vcc
v_cmp_gt_i32 vcc, 24, v4
s_nop 1
v_cndmask_b32 v252, 0, v5, vcc
v_cmp_gt_i32 vcc, 25, v4
s_nop 1
v_cndmask_b32 v253, 0, v5, vcc
v_cmp_gt_i32 vcc, 26, v4
s_nop 1
v_cndmask_b32 v254, 0, v5, vcc
v_cmp_gt_i32 vcc, 27, v4
s_nop 1
v_cndmask_b32 v255, 0, v5, vcc
s_and_b32 s25, s49, 1
s_lshl_b32 s25, s25, 11
s_add_u32 s44, s44, s25
s_mov_b32 s47, 0
v_mov_b32 v102, 0x20000
v_lshl_add_u32 v101, v0, 2, v102
v_mov_b32 v103, 4
v_mov_b32 v87, 0
s_mov_b32 s45, 0
s_barrier
s_add_u32 m0, s21, 0
s_nop 0
buffer_load_dwordx4 v8, s[8:11], s20 offen lds
s_add_u32 m0, s21, 1024
s_nop 0
buffer_load_dwordx4 v9, s[8:11], s20 offen lds
s_add_u32 m0, s21, 2048
s_nop 0
buffer_load_dwordx4 v10, s[8:11], s20 offen lds
s_add_u32 m0, s21, 3072
s_nop 0
buffer_load_dwordx4 v11, s[8:11], s20 offen lds
s_add_u32 s20, s20, 512
s_add_u32 m0, s21, 16384
s_nop 0
buffer_load_dwordx4 v8, s[8:11], s20 offen lds
s_add_u32 m0, s21, 17408
s_nop 0
buffer_load_dwordx4 v9, s[8:11], s20 offen lds
s_add_u32 m0, s21, 18432
s_nop 0
buffer_load_dwordx4 v10, s[8:11], s20 offen lds
s_add_u32 m0, s21, 19456
s_nop 0
buffer_load_dwordx4 v11, s[8:11], s20 offen lds
s_add_u32 s20, s20, 512
s_add_u32 m0, s21, 32768
s_nop 0
buffer_load_dwordx4 v8, s[8:11], s20 offen lds
s_add_u32 m0, s21, 33792
s_nop 0
buffer_load_dwordx4 v9, s[8:11], s20 offen lds
s_add_u32 m0, s21, 34816
s_nop 0
buffer_load_dwordx4 v10, s[8:11], s20 offen lds
s_add_u32 m0, s21, 35840
s_nop 0
buffer_load_dwordx4 v11, s[8:11], s20 offen lds
s_add_u32 s20, s20, 512
s_add_u32 m0, s21, 49152
s_nop 0
buffer_load_dwordx4 v8, s[8:11], s20 offen lds
s_add_u32 m0, s21, 50176
s_nop 0
buffer_load_dwordx4 v9, s[8:11], s20 offen lds
s_add_u32 m0, s21, 51200
s_nop 0
buffer_load_dwordx4 v10, s[8:11], s20 offen lds
s_add_u32 m0, s21, 52224
s_nop 0
buffer_load_dwordx4 v11, s[8:11], s20 offen lds
s_add_u32 s24, s24, 1
s_min_u32 s24, s24, 63
s_lshl_b32 s53, s24, 16
s_mov_b32 s20, s53
s_add_u32 m0, s21, 65536
s_nop 0
buffer_load_dwordx4 v8, s[8:11], s20 offen lds
s_add_u32 m0, s21, 66560
s_nop 0
buffer_load_dwordx4 v9, s[8:11], s20 offen lds
s_add_u32 m0, s21, 67584
s_nop 0
buffer_load_dwordx4 v10, s[8:11], s20 offen lds
s_add_u32 m0, s21, 68608
s_nop 0
buffer_load_dwordx4 v11, s[8:11], s20 offen lds
s_add_u32 s20, s20, 512
s_add_u32 m0, s21, 81920
s_nop 0
buffer_load_dwordx4 v8, s[8:11], s20 offen lds
s_add_u32 m0, s21, 82944
s_nop 0
buffer_load_dwordx4 v9, s[8:11], s20 offen lds
s_add_u32 m0, s21, 83968
s_nop 0
buffer_load_dwordx4 v10, s[8:11], s20 offen lds
s_add_u32 m0, s21, 84992
s_nop 0
buffer_load_dwordx4 v11, s[8:11], s20 offen lds
s_add_u32 s20, s20, 512
s_add_u32 m0, s21, 98304
s_nop 0
buffer_load_dwordx4 v8, s[8:11], s20 offen lds
s_waitcnt vmcnt(0)
s_barrier
ds_read_b128 v[20:23], v12 offset:0
ds_read_b128 v[24:27], v12 offset:4096
ds_read_b128 v[28:31], v13 offset:0
ds_read_b128 v[32:35], v13 offset:4096
ds_read_b128 v[36:39], v14 offset:0
ds_read_b128 v[40:43], v14 offset:4096
s_waitcnt lgkmcnt(4)
L_st_467:
v_mfma_f32_16x16x32_bf16 v[52:55], a[0:3], v[20:23], 0
ds_read_b128 v[44:47], v15 offset:0
s_add_u32 m0, s21, 99328
s_sub_u32 s39, s22, 1
v_mfma_f32_16x16x32_bf16 v[56:59], a[4:7], v[20:23], 0
buffer_load_dwordx4 v9, s[8:11], s20 offen lds
v_mfma_f32_16x16x32_bf16 v[60:63], a[0:3], v[24:27], 0
ds_read_b128 v[48:51], v15 offset:4096
s_bitcmp1_b32 s39, 1
s_cselect_b32 s38, s54, s55
v_mfma_f32_16x16x32_bf16 v[64:67], a[4:7], v[24:27], 0
s_waitcnt lgkmcnt(4)
v_mfma_f32_16x16x32_bf16 v[52:55], a[8:11], v[28:31], v[52:55]
ds_read_b128 v[20:23], v12 offset:256
s_add_u32 s38, s38, s44
s_waitcnt vmcnt(5)
v_mfma_f32_16x16x32_bf16 v[56:59], a[12:15], v[28:31], v[56:59]
s_lshl_b32 s42, s39, 20
s_add_u32 s38, s38, s42
ds_write_b32 v101, v87
v_mfma_f32_16x16x32_bf16 v[60:63], a[8:11], v[32:35], v[60:63]
ds_read_b128 v[24:27], v12 offset:4352
s_cmp_eq_u32 s37, 0
s_cselect_b32 s38, 0x7ff00000, s38
v_mfma_f32_16x16x32_bf16 v[64:67], a[12:15], v[32:35], v[64:67]
s_waitcnt lgkmcnt(4)
v_mfma_f32_16x16x32_bf16 v[52:55], a[16:19], v[36:39], v[52:55]
ds_read_b128 v[28:31], v13 offset:256
s_add_u32 m0, s21, 100352
v_mfma_f32_16x16x32_bf16 v[56:59], a[20:23], v[36:39], v[56:59]
buffer_load_dwordx4 v10, s[8:11], s20 offen lds
s_mov_b32 s37, 1
v_mfma_f32_16x16x32_bf16 v[60:63], a[16:19], v[40:43], v[60:63]
ds_read_b128 v[32:35], v13 offset:4352
v_cvt_pk_bf16_f32 v88, v68, v69
v_mfma_f32_16x16x32_bf16 v[64:67], a[20:23], v[40:43], v[64:67]
s_waitcnt lgkmcnt(4)
v_cvt_pk_bf16_f32 v89, v70, v71
v_mfma_f32_16x16x32_bf16 v[52:55], a[24:27], v[44:47], v[52:55]
ds_read_b128 v[36:39], v14 offset:256
v_cvt_pk_bf16_f32 v90, v72, v73
v_mfma_f32_16x16x32_bf16 v[56:59], a[28:31], v[44:47], v[56:59]
v_cvt_pk_bf16_f32 v91, v74, v75
v_mfma_f32_16x16x32_bf16 v[60:63], a[24:27], v[48:51], v[60:63]
ds_read_b128 v[40:43], v14 offset:4352
buffer_store_dwordx4 v[88:91], v86, s[12:15], s38 offen offset:0
v_mfma_f32_16x16x32_bf16 v[64:67], a[28:31], v[48:51], v[64:67]
s_waitcnt lgkmcnt(4)
v_cvt_pk_bf16_f32 v92, v76, v77
v_cvt_pk_bf16_f32 v93, v78, v79
v_mfma_f32_16x16x32_bf16 v[52:55], a[32:35], v[20:23], v[52:55]
ds_read_b128 v[44:47], v15 offset:256
s_add_u32 m0, s21, 101376
v_mfma_f32_16x16x32_bf16 v[56:59], a[36:39], v[20:23], v[56:59]
buffer_load_dwordx4 v11, s[8:11], s20 offen lds
v_cvt_pk_bf16_f32 v94, v80, v81
v_mfma_f32_16x16x32_bf16 v[60:63], a[32:35], v[24:27], v[60:63]
ds_read_b128 v[48:51], v15 offset:4352
v_cvt_pk_bf16_f32 v95, v82, v83
v_mfma_f32_16x16x32_bf16 v[64:67], a[36:39], v[24:27], v[64:67]
s_waitcnt lgkmcnt(4)
buffer_store_dwordx4 v[92:95], v86, s[12:15], s38 offen offset:128
v_mfma_f32_16x16x32_bf16 v[52:55], a[40:43], v[28:31], v[52:55]
s_waitcnt vmcnt(25)
s_barrier
ds_read_b128 v[20:23], v12 offset:16384
v_mfma_f32_16x16x32_bf16 v[56:59], a[44:47], v[28:31], v[56:59]
s_add_u32 s20, s20, 512
v_mfma_f32_16x16x32_bf16 v[60:63], a[40:43], v[32:35], v[60:63]
ds_read_b128 v[24:27], v12 offset:20480
ds_read_b32 v87, v102
v_mfma_f32_16x16x32_bf16 v[64:67], a[44:47], v[32:35], v[64:67]
s_waitcnt lgkmcnt(4)
v_mfma_f32_16x16x32_bf16 v[52:55], a[48:51], v[36:39], v[52:55]
ds_read_b128 v[28:31], v13 offset:16384
s_add_u32 m0, s21, 114688
v_mfma_f32_16x16x32_bf16 v[56:59], a[52:55], v[36:39], v[56:59]
buffer_load_dwordx4 v8, s[8:11], s20 offen lds
v_mfma_f32_16x16x32_bf16 v[60:63], a[48:51], v[40:43], v[60:63]
ds_read_b128 v[32:35], v13 offset:20480
v_mfma_f32_16x16x32_bf16 v[64:67], a[52:55], v[40:43], v[64:67]
s_waitcnt lgkmcnt(4)
v_mfma_f32_16x16x32_bf16 v[52:55], a[56:59], v[44:47], v[52:55]
ds_read_b128 v[36:39], v14 offset:16384
v_mfma_f32_16x16x32_bf16 v[56:59], a[60:63], v[44:47], v[56:59]
v_mfma_f32_16x16x32_bf16 v[60:63], a[56:59], v[48:51], v[60:63]
ds_read_b128 v[40:43], v14 offset:20480
v_mfma_f32_16x16x32_bf16 v[64:67], a[60:63], v[48:51], v[64:67]
s_waitcnt lgkmcnt(4)
v_mfma_f32_16x16x32_bf16 v[52:55], a[64:67], v[20:23], v[52:55]
ds_read_b128 v[44:47], v15 offset:16384
s_add_u32 m0, s21, 115712
v_mfma_f32_16x16x32_bf16 v[56:59], a[68:71], v[20:23], v[56:59]
buffer_load_dwordx4 v9, s[8:11], s20 offen lds
v_mfma_f32_16x16x32_bf16 v[60:63], a[64:67], v[24:27], v[60:63]
ds_read_b128 v[48:51], v15 offset:20480
s_branch L_anext_459
L_attr_460:
v_mfma_f32_16x16x32_bf16 v[64:67], a[68:71], v[24:27], v[64:67]
s_waitcnt lgkmcnt(4)
v_mfma_f32_16x16x32_bf16 v[52:55], a[72:75], v[28:31], v[52:55]
ds_read_b128 v[20:23], v12 offset:16640
v_mfma_f32_16x16x32_bf16 v[56:59], a[76:79], v[28:31], v[56:59]
v_mfma_f32_16x16x32_bf16 v[60:63], a[72:75], v[32:35], v[60:63]
ds_read_b128 v[24:27], v12 offset:20736
s_add_u32 s24, s24, 1
v_mfma_f32_16x16x32_bf16 v[64:67], a[76:79], v[32:35], v[64:67]
s_waitcnt lgkmcnt(4)
v_mfma_f32_16x16x32_bf16 v[52:55], a[80:83], v[36:39], v[52:55]
ds_read_b128 v[28:31], v13 offset:16640
s_add_u32 m0, s21, 116736
v_mfma_f32_16x16x32_bf16 v[56:59], a[84:87], v[36:39], v[56:59]
buffer_load_dwordx4 v10, s[8:11], s20 offen lds
v_mfma_f32_16x16x32_bf16 v[60:63], a[80:83], v[40:43], v[60:63]
ds_read_b128 v[32:35], v13 offset:20736
v_mfma_f32_16x16x32_bf16 v[64:67], a[84:87], v[40:43], v[64:67]
s_waitcnt lgkmcnt(4)
s_min_u32 s24, s24, 63
v_mfma_f32_16x16x32_bf16 v[52:55], a[88:91], v[44:47], v[52:55]
ds_read_b128 v[36:39], v14 offset:16640
v_mfma_f32_16x16x32_bf16 v[56:59], a[92:95], v[44:47], v[56:59]
v_mfma_f32_16x16x32_bf16 v[60:63], a[88:91], v[48:51], v[60:63]
ds_read_b128 v[40:43], v14 offset:20736
s_lshl_b32 s53, s24, 16
v_mfma_f32_16x16x32_bf16 v[64:67], a[92:95], v[48:51], v[64:67]
s_waitcnt lgkmcnt(4)
v_mfma_f32_16x16x32_bf16 v[52:55], a[96:99], v[20:23], v[52:55]
ds_read_b128 v[44:47], v15 offset:16640
s_add_u32 m0, s21, 117760
v_mfma_f32_16x16x32_bf16 v[56:59], a[100:103], v[20:23], v[56:59]
buffer_load_dwordx4 v11, s[8:11], s20 offen lds
v_mfma_f32_16x16x32_bf16 v[60:63], a[96:99], v[24:27], v[60:63]
ds_read_b128 v[48:51], v15 offset:20736
v_mfma_f32_16x16x32_bf16 v[64:67], a[100:103], v[24:27], v[64:67]
s_waitcnt lgkmcnt(4)
v_mfma_f32_16x16x32_bf16 v[52:55], a[104:107], v[28:31], v[52:55]
s_waitcnt vmcnt(24)
s_barrier
ds_read_b128 v[20:23], v12 offset:32768
v_mfma_f32_16x16x32_bf16 v[56:59], a[108:111], v[28:31], v[56:59]
s_mov_b32 s20, s53
v_mfma_f32_16x16x32_bf16 v[60:63], a[104:107], v[32:35], v[60:63]
ds_read_b128 v[24:27], v12 offset:36864
v_mfma_f32_16x16x32_bf16 v[64:67], a[108:111], v[32:35], v[64:67]
s_waitcnt lgkmcnt(4)
v_mfma_f32_16x16x32_bf16 v[52:55], a[112:115], v[36:39], v[52:55]
ds_read_b128 v[28:31], v13 offset:32768
s_add_u32 m0, s21, 0
v_mfma_f32_16x16x32_bf16 v[56:59], a[116:119], v[36:39], v[56:59]
buffer_load_dwordx4 v8, s[8:11], s20 offen lds
v_mfma_f32_16x16x32_bf16 v[60:63], a[112:115], v[40:43], v[60:63]
ds_read_b128 v[32:35], v13 offset:36864
v_mfma_f32_16x16x32_bf16 v[64:67], a[116:119], v[40:43], v[64:67]
s_waitcnt lgkmcnt(4)
v_mfma_f32_16x16x32_bf16 v[52:55], a[120:123], v[44:47], v[52:55]
ds_read_b128 v[36:39], v14 offset:32768
v_mfma_f32_16x16x32_bf16 v[56:59], a[124:127], v[44:47], v[56:59]
v_mfma_f32_16x16x32_bf16 v[60:63], a[120:123], v[48:51], v[60:63]
ds_read_b128 v[40:43], v14 offset:36864
v_mfma_f32_16x16x32_bf16 v[64:67], a[124:127], v[48:51], v[64:67]
s_waitcnt lgkmcnt(4)
v_mfma_f32_16x16x32_bf16 v[52:55], a[128:131], v[20:23], v[52:55]
ds_read_b128 v[44:47], v15 offset:32768
s_add_u32 m0, s21, 1024
v_mfma_f32_16x16x32_bf16 v[56:59], a[132:135], v[20:23], v[56:59]
buffer_load_dwordx4 v9, s[8:11], s20 offen lds
v_mfma_f32_16x16x32_bf16 v[60:63], a[128:131], v[24:27], v[60:63]
ds_read_b128 v[48:51], v15 offset:36864
v_mfma_f32_16x16x32_bf16 v[64:67], a[132:135], v[24:27], v[64:67]
s_waitcnt lgkmcnt(4)
v_mfma_f32_16x16x32_bf16 v[52:55], a[136:139], v[28:31], v[52:55]
ds_read_b128 v[20:23], v12 offset:33024
v_mfma_f32_16x16x32_bf16 v[56:59], a[140:143], v[28:31], v[56:59]
v_mfma_f32_16x16x32_bf16 v[60:63], a[136:139], v[32:35], v[60:63]
ds_read_b128 v[24:27], v12 offset:37120
v_mfma_f32_16x16x32_bf16 v[64:67], a[140:143], v[32:35], v[64:67]
s_waitcnt lgkmcnt(4)
v_mfma_f32_16x16x32_bf16 v[52:55], a[144:147], v[36:39], v[52:55]
ds_read_b128 v[28:31], v13 offset:33024
s_add_u32 m0, s21, 2048
v_mfma_f32_16x16x32_bf16 v[56:59], a[148:151], v[36:39], v[56:59]
buffer_load_dwordx4 v10, s[8:11], s20 offen lds
v_mfma_f32_16x16x32_bf16 v[60:63], a[144:147], v[40:43], v[60:63]
ds_read_b128 v[32:35], v13 offset:37120
v_mfma_f32_16x16x32_bf16 v[64:67], a[148:151], v[40:43], v[64:67]
s_waitcnt lgkmcnt(4)
v_mfma_f32_16x16x32_bf16 v[52:55], a[152:155], v[44:47], v[52:55]
ds_read_b128 v[36:39], v14 offset:33024
v_mfma_f32_16x16x32_bf16 v[56:59], a[156:159], v[44:47], v[56:59]
v_mfma_f32_16x16x32_bf16 v[60:63], a[152:155], v[48:51], v[60:63]
ds_read_b128 v[40:43], v14 offset:37120
v_mfma_f32_16x16x32_bf16 v[64:67], a[156:159], v[48:51], v[64:67]
s_waitcnt lgkmcnt(4)
v_mfma_f32_16x16x32_bf16 v[52:55], a[160:163], v[20:23], v[52:55]
ds_read_b128 v[44:47], v15 offset:33024
s_add_u32 m0, s21, 3072
v_mfma_f32_16x16x32_bf16 v[56:59], a[164:167], v[20:23], v[56:59]
buffer_load_dwordx4 v11, s[8:11], s20 offen lds
v_mfma_f32_16x16x32_bf16 v[60:63], a[160:163], v[24:27], v[60:63]
ds_read_b128 v[48:51], v15 offset:37120
v_mfma_f32_16x16x32_bf16 v[64:67], a[164:167], v[24:27], v[64:67]
s_waitcnt lgkmcnt(4)
v_mfma_f32_16x16x32_bf16 v[52:55], a[168:171], v[28:31], v[52:55]
s_waitcnt vmcnt(23)
s_barrier
ds_read_b128 v[20:23], v12 offset:49152
v_mfma_f32_16x16x32_bf16 v[56:59], a[172:175], v[28:31], v[56:59]
s_add_u32 s20, s20, 512
v_mfma_f32_16x16x32_bf16 v[60:63], a[168:171], v[32:35], v[60:63]
ds_read_b128 v[24:27], v12 offset:53248
v_mfma_f32_16x16x32_bf16 v[64:67], a[172:175], v[32:35], v[64:67]
s_waitcnt lgkmcnt(4)
v_mfma_f32_16x16x32_bf16 v[52:55], a[176:179], v[36:39], v[52:55]
ds_read_b128 v[28:31], v13 offset:49152
s_add_u32 m0, s21, 16384
v_mfma_f32_16x16x32_bf16 v[56:59], a[180:183], v[36:39], v[56:59]
buffer_load_dwordx4 v8, s[8:11], s20 offen lds
v_mfma_f32_16x16x32_bf16 v[60:63], a[176:179], v[40:43], v[60:63]
ds_read_b128 v[32:35], v13 offset:53248
v_mfma_f32_16x16x32_bf16 v[64:67], a[180:183], v[40:43], v[64:67]
s_waitcnt lgkmcnt(4)
v_mfma_f32_16x16x32_bf16 v[52:55], a[184:187], v[44:47], v[52:55]
ds_read_b128 v[36:39], v14 offset:49152
v_mfma_f32_16x16x32_bf16 v[56:59], a[188:191], v[44:47], v[56:59]
v_mfma_f32_16x16x32_bf16 v[60:63], a[184:187], v[48:51], v[60:63]
ds_read_b128 v[40:43], v14 offset:53248
v_mfma_f32_16x16x32_bf16 v[64:67], a[188:191], v[48:51], v[64:67]
s_waitcnt lgkmcnt(4)
v_mfma_f32_16x16x32_bf16 v[52:55], a[192:195], v[20:23], v[52:55]
ds_read_b128 v[44:47], v15 offset:49152
s_add_u32 m0, s21, 17408
v_mfma_f32_16x16x32_bf16 v[56:59], a[196:199], v[20:23], v[56:59]
buffer_load_dwordx4 v9, s[8:11], s20 offen lds
v_mfma_f32_16x16x32_bf16 v[60:63], a[192:195], v[24:27], v[60:63]
ds_read_b128 v[48:51], v15 offset:53248
v_mfma_f32_16x16x32_bf16 v[64:67], a[196:199], v[24:27], v[64:67]
s_waitcnt lgkmcnt(4)
v_mfma_f32_16x16x32_bf16 v[52:55], a[200:203], v[28:31], v[52:55]
ds_read_b128 v[20:23], v12 offset:49408
v_mfma_f32_16x16x32_bf16 v[56:59], a[204:207], v[28:31], v[56:59]
v_mfma_f32_16x16x32_bf16 v[60:63], a[200:203], v[32:35], v[60:63]
ds_read_b128 v[24:27], v12 offset:53504
v_mfma_f32_16x16x32_bf16 v[64:67], a[204:207], v[32:35], v[64:67]
s_waitcnt lgkmcnt(4)
v_mfma_f32_16x16x32_bf16 v[52:55], a[208:211], v[36:39], v[52:55]
ds_read_b128 v[28:31], v13 offset:49408
s_add_u32 m0, s21, 18432
v_mfma_f32_16x16x32_bf16 v[56:59], a[212:215], v[36:39], v[56:59]
buffer_load_dwordx4 v10, s[8:11], s20 offen lds
v_mfma_f32_16x16x32_bf16 v[60:63], a[208:211], v[40:43], v[60:63]
ds_read_b128 v[32:35], v13 offset:53504
v_mfma_f32_16x16x32_bf16 v[64:67], a[212:215], v[40:43], v[64:67]
s_waitcnt lgkmcnt(4)
v_mfma_f32_16x16x32_bf16 v[52:55], a[216:219], v[44:47], v[52:55]
ds_read_b128 v[36:39], v14 offset:49408
v_mfma_f32_16x16x32_bf16 v[56:59], a[220:223], v[44:47], v[56:59]
v_mfma_f32_16x16x32_bf16 v[60:63], a[216:219], v[48:51], v[60:63]
ds_read_b128 v[40:43], v14 offset:53504
v_mfma_f32_16x16x32_bf16 v[64:67], a[220:223], v[48:51], v[64:67]
s_waitcnt lgkmcnt(4)
v_mfma_f32_16x16x32_bf16 v[52:55], a[224:227], v[20:23], v[52:55]
ds_read_b128 v[44:47], v15 offset:49408
s_add_u32 m0, s21, 19456
v_mfma_f32_16x16x32_bf16 v[56:59], a[228:231], v[20:23], v[56:59]
buffer_load_dwordx4 v11, s[8:11], s20 offen lds
v_mfma_f32_16x16x32_bf16 v[60:63], a[224:227], v[24:27], v[60:63]
ds_read_b128 v[48:51], v15 offset:53504
v_mfma_f32_16x16x32_bf16 v[64:67], a[228:231], v[24:27], v[64:67]
s_waitcnt lgkmcnt(4)
v_mfma_f32_16x16x32_bf16 v[52:55], a[232:235], v[28:31], v[52:55]
s_waitcnt vmcnt(23)
s_barrier
ds_read_b128 v[20:23], v16 offset:0
v_mfma_f32_16x16x32_bf16 v[56:59], a[236:239], v[28:31], v[56:59]
s_add_u32 s20, s20, 512
v_mfma_f32_16x16x32_bf16 v[60:63], a[232:235], v[32:35], v[60:63]
ds_read_b128 v[24:27], v16 offset:4096
v_mfma_f32_16x16x32_bf16 v[64:67], a[236:239], v[32:35], v[64:67]
s_waitcnt lgkmcnt(4)
v_mfma_f32_16x16x32_bf16 v[52:55], a[240:243], v[36:39], v[52:55]
ds_read_b128 v[28:31], v17 offset:0
s_add_u32 m0, s21, 32768
v_mfma_f32_16x16x32_bf16 v[56:59], a[244:247], v[36:39], v[56:59]
buffer_load_dwordx4 v8, s[8:11], s20 offen lds
v_mfma_f32_16x16x32_bf16 v[60:63], a[240:243], v[40:43], v[60:63]
ds_read_b128 v[32:35], v17 offset:4096
v_mfma_f32_16x16x32_bf16 v[64:67], a[244:247], v[40:43], v[64:67]
s_waitcnt lgkmcnt(4)
v_mfma_f32_16x16x32_bf16 v[52:55], a[248:251], v[44:47], v[52:55]
ds_read_b128 v[36:39], v18 offset:0
v_mfma_f32_16x16x32_bf16 v[56:59], a[252:255], v[44:47], v[56:59]
v_mfma_f32_16x16x32_bf16 v[60:63], a[248:251], v[48:51], v[60:63]
ds_read_b128 v[40:43], v18 offset:4096
v_mfma_f32_16x16x32_bf16 v[64:67], a[252:255], v[48:51], v[64:67]
s_waitcnt lgkmcnt(4)
s_add_u32 s22, s22, 1
s_cmp_ge_u32 s22, s23
s_cbranch_scc1 L_fl0_464
v_mfma_f32_16x16x32_bf16 v[68:71], a[0:3], v[20:23], 0
ds_read_b128 v[44:47], v19 offset:0
s_add_u32 m0, s21, 33792
s_sub_u32 s39, s22, 1
v_mfma_f32_16x16x32_bf16 v[72:75], a[4:7], v[20:23], 0
buffer_load_dwordx4 v9, s[8:11], s20 offen lds
v_mfma_f32_16x16x32_bf16 v[76:79], a[0:3], v[24:27], 0
ds_read_b128 v[48:51], v19 offset:4096
s_bitcmp1_b32 s39, 1
s_cselect_b32 s38, s54, s55
v_mfma_f32_16x16x32_bf16 v[80:83], a[4:7], v[24:27], 0
s_waitcnt lgkmcnt(4)
v_mfma_f32_16x16x32_bf16 v[68:71], a[8:11], v[28:31], v[68:71]
ds_read_b128 v[20:23], v16 offset:256
s_add_u32 s38, s38, s44
v_mfma_f32_16x16x32_bf16 v[72:75], a[12:15], v[28:31], v[72:75]
s_lshl_b32 s42, s39, 20
s_add_u32 s38, s38, s42
v_mfma_f32_16x16x32_bf16 v[76:79], a[8:11], v[32:35], v[76:79]
ds_read_b128 v[24:27], v16 offset:4352
s_cmp_eq_u32 s37, 0
s_cselect_b32 s38, 0x7ff00000, s38
v_mfma_f32_16x16x32_bf16 v[80:83], a[12:15], v[32:35], v[80:83]
s_waitcnt lgkmcnt(4)
v_mfma_f32_16x16x32_bf16 v[68:71], a[16:19], v[36:39], v[68:71]
ds_read_b128 v[28:31], v17 offset:256
s_add_u32 m0, s21, 34816
v_mfma_f32_16x16x32_bf16 v[72:75], a[20:23], v[36:39], v[72:75]
buffer_load_dwordx4 v10, s[8:11], s20 offen lds
s_mov_b32 s37, 1
v_mfma_f32_16x16x32_bf16 v[76:79], a[16:19], v[40:43], v[76:79]
ds_read_b128 v[32:35], v17 offset:4352
v_cvt_pk_bf16_f32 v88, v52, v53
v_mfma_f32_16x16x32_bf16 v[80:83], a[20:23], v[40:43], v[80:83]
s_waitcnt lgkmcnt(4)
v_cvt_pk_bf16_f32 v89, v54, v55
v_mfma_f32_16x16x32_bf16 v[68:71], a[24:27], v[44:47], v[68:71]
ds_read_b128 v[36:39], v18 offset:256
v_cvt_pk_bf16_f32 v90, v56, v57
v_mfma_f32_16x16x32_bf16 v[72:75], a[28:31], v[44:47], v[72:75]
v_cvt_pk_bf16_f32 v91, v58, v59
v_mfma_f32_16x16x32_bf16 v[76:79], a[24:27], v[48:51], v[76:79]
ds_read_b128 v[40:43], v18 offset:4352
buffer_store_dwordx4 v[88:91], v86, s[12:15], s38 offen offset:0
v_mfma_f32_16x16x32_bf16 v[80:83], a[28:31], v[48:51], v[80:83]
s_waitcnt lgkmcnt(4)
v_cvt_pk_bf16_f32 v92, v60, v61
v_cvt_pk_bf16_f32 v93, v62, v63
v_mfma_f32_16x16x32_bf16 v[68:71], a[32:35], v[20:23], v[68:71]
ds_read_b128 v[44:47], v19 offset:256
s_add_u32 m0, s21, 35840
v_mfma_f32_16x16x32_bf16 v[72:75], a[36:39], v[20:23], v[72:75]
buffer_load_dwordx4 v11, s[8:11], s20 offen lds
v_cvt_pk_bf16_f32 v94, v64, v65
v_mfma_f32_16x16x32_bf16 v[76:79], a[32:35], v[24:27], v[76:79]
ds_read_b128 v[48:51], v19 offset:4352
v_cvt_pk_bf16_f32 v95, v66, v67
v_mfma_f32_16x16x32_bf16 v[80:83], a[36:39], v[24:27], v[80:83]
s_waitcnt lgkmcnt(4)
buffer_store_dwordx4 v[92:95], v86, s[12:15], s38 offen offset:128
v_mfma_f32_16x16x32_bf16 v[68:71], a[40:43], v[28:31], v[68:71]
s_waitcnt vmcnt(24)
s_barrier
ds_read_b128 v[20:23], v16 offset:16384
v_mfma_f32_16x16x32_bf16 v[72:75], a[44:47], v[28:31], v[72:75]
s_add_u32 s20, s20, 512
v_mfma_f32_16x16x32_bf16 v[76:79], a[40:43], v[32:35], v[76:79]
ds_read_b128 v[24:27], v16 offset:20480
v_mfma_f32_16x16x32_bf16 v[80:83], a[44:47], v[32:35], v[80:83]
s_waitcnt lgkmcnt(4)
v_mfma_f32_16x16x32_bf16 v[68:71], a[48:51], v[36:39], v[68:71]
ds_read_b128 v[28:31], v17 offset:16384
s_add_u32 m0, s21, 49152
v_mfma_f32_16x16x32_bf16 v[72:75], a[52:55], v[36:39], v[72:75]
buffer_load_dwordx4 v8, s[8:11], s20 offen lds
v_mfma_f32_16x16x32_bf16 v[76:79], a[48:51], v[40:43], v[76:79]
ds_read_b128 v[32:35], v17 offset:20480
v_mfma_f32_16x16x32_bf16 v[80:83], a[52:55], v[40:43], v[80:83]
s_waitcnt lgkmcnt(4)
v_mfma_f32_16x16x32_bf16 v[68:71], a[56:59], v[44:47], v[68:71]
ds_read_b128 v[36:39], v18 offset:16384
v_mfma_f32_16x16x32_bf16 v[72:75], a[60:63], v[44:47], v[72:75]
v_mfma_f32_16x16x32_bf16 v[76:79], a[56:59], v[48:51], v[76:79]
ds_read_b128 v[40:43], v18 offset:20480
v_mfma_f32_16x16x32_bf16 v[80:83], a[60:63], v[48:51], v[80:83]
s_waitcnt lgkmcnt(4)
v_mfma_f32_16x16x32_bf16 v[68:71], a[64:67], v[20:23], v[68:71]
ds_read_b128 v[44:47], v19 offset:16384
s_add_u32 m0, s21, 50176
v_mfma_f32_16x16x32_bf16 v[72:75], a[68:71], v[20:23], v[72:75]
buffer_load_dwordx4 v9, s[8:11], s20 offen lds
v_mfma_f32_16x16x32_bf16 v[76:79], a[64:67], v[24:27], v[76:79]
ds_read_b128 v[48:51], v19 offset:20480
v_mfma_f32_16x16x32_bf16 v[80:83], a[68:71], v[24:27], v[80:83]
s_waitcnt lgkmcnt(4)
v_mfma_f32_16x16x32_bf16 v[68:71], a[72:75], v[28:31], v[68:71]
ds_read_b128 v[20:23], v16 offset:16640
v_mfma_f32_16x16x32_bf16 v[72:75], a[76:79], v[28:31], v[72:75]
v_mfma_f32_16x16x32_bf16 v[76:79], a[72:75], v[32:35], v[76:79]
ds_read_b128 v[24:27], v16 offset:20736
s_add_u32 s24, s24, 1
v_mfma_f32_16x16x32_bf16 v[80:83], a[76:79], v[32:35], v[80:83]
s_waitcnt lgkmcnt(4)
v_mfma_f32_16x16x32_bf16 v[68:71], a[80:83], v[36:39], v[68:71]
ds_read_b128 v[28:31], v17 offset:16640
s_add_u32 m0, s21, 51200
v_mfma_f32_16x16x32_bf16 v[72:75], a[84:87], v[36:39], v[72:75]
buffer_load_dwordx4 v10, s[8:11], s20 offen lds
v_mfma_f32_16x16x32_bf16 v[76:79], a[80:83], v[40:43], v[76:79]
ds_read_b128 v[32:35], v17 offset:20736
v_mfma_f32_16x16x32_bf16 v[80:83], a[84:87], v[40:43], v[80:83]
s_waitcnt lgkmcnt(4)
s_min_u32 s24, s24, 63
v_mfma_f32_16x16x32_bf16 v[68:71], a[88:91], v[44:47], v[68:71]
ds_read_b128 v[36:39], v18 offset:16640
v_mfma_f32_16x16x32_bf16 v[72:75], a[92:95], v[44:47], v[72:75]
v_mfma_f32_16x16x32_bf16 v[76:79], a[88:91], v[48:51], v[76:79]
ds_read_b128 v[40:43], v18 offset:20736
s_lshl_b32 s53, s24, 16
v_mfma_f32_16x16x32_bf16 v[80:83], a[92:95], v[48:51], v[80:83]
s_waitcnt lgkmcnt(4)
v_mfma_f32_16x16x32_bf16 v[68:71], a[96:99], v[20:23], v[68:71]
ds_read_b128 v[44:47], v19 offset:16640
s_add_u32 m0, s21, 52224
v_mfma_f32_16x16x32_bf16 v[72:75], a[100:103], v[20:23], v[72:75]
buffer_load_dwordx4 v11, s[8:11], s20 offen lds
v_mfma_f32_16x16x32_bf16 v[76:79], a[96:99], v[24:27], v[76:79]
ds_read_b128 v[48:51], v19 offset:20736
v_mfma_f32_16x16x32_bf16 v[80:83], a[100:103], v[24:27], v[80:83]
s_waitcnt lgkmcnt(4)
v_mfma_f32_16x16x32_bf16 v[68:71], a[104:107], v[28:31], v[68:71]
s_waitcnt vmcnt(23)
s_barrier
ds_read_b128 v[20:23], v16 offset:32768
v_mfma_f32_16x16x32_bf16 v[72:75], a[108:111], v[28:31], v[72:75]
s_mov_b32 s20, s53
v_mfma_f32_16x16x32_bf16 v[76:79], a[104:107], v[32:35], v[76:79]
ds_read_b128 v[24:27], v16 offset:36864
v_mfma_f32_16x16x32_bf16 v[80:83], a[108:111], v[32:35], v[80:83]
s_waitcnt lgkmcnt(4)
v_mfma_f32_16x16x32_bf16 v[68:71], a[112:115], v[36:39], v[68:71]
ds_read_b128 v[28:31], v17 offset:32768
s_add_u32 m0, s21, 65536
v_mfma_f32_16x16x32_bf16 v[72:75], a[116:119], v[36:39], v[72:75]
buffer_load_dwordx4 v8, s[8:11], s20 offen lds
v_mfma_f32_16x16x32_bf16 v[76:79], a[112:115], v[40:43], v[76:79]
ds_read_b128 v[32:35], v17 offset:36864
v_mfma_f32_16x16x32_bf16 v[80:83], a[116:119], v[40:43], v[80:83]
s_waitcnt lgkmcnt(4)
v_mfma_f32_16x16x32_bf16 v[68:71], a[120:123], v[44:47], v[68:71]
ds_read_b128 v[36:39], v18 offset:32768
v_mfma_f32_16x16x32_bf16 v[72:75], a[124:127], v[44:47], v[72:75]
v_mfma_f32_16x16x32_bf16 v[76:79], a[120:123], v[48:51], v[76:79]
ds_read_b128 v[40:43], v18 offset:36864
v_mfma_f32_16x16x32_bf16 v[80:83], a[124:127], v[48:51], v[80:83]
s_waitcnt lgkmcnt(4)
v_mfma_f32_16x16x32_bf16 v[68:71], a[128:131], v[20:23], v[68:71]
ds_read_b128 v[44:47], v19 offset:32768
s_add_u32 m0, s21, 66560
v_mfma_f32_16x16x32_bf16 v[72:75], a[132:135], v[20:23], v[72:75]
buffer_load_dwordx4 v9, s[8:11], s20 offen lds
v_mfma_f32_16x16x32_bf16 v[76:79], a[128:131], v[24:27], v[76:79]
ds_read_b128 v[48:51], v19 offset:36864
v_mfma_f32_16x16x32_bf16 v[80:83], a[132:135], v[24:27], v[80:83]
s_waitcnt lgkmcnt(4)
v_mfma_f32_16x16x32_bf16 v[68:71], a[136:139], v[28:31], v[68:71]
ds_read_b128 v[20:23], v16 offset:33024
v_mfma_f32_16x16x32_bf16 v[72:75], a[140:143], v[28:31], v[72:75]
v_mfma_f32_16x16x32_bf16 v[76:79], a[136:139], v[32:35], v[76:79]
ds_read_b128 v[24:27], v16 offset:37120
v_mfma_f32_16x16x32_bf16 v[80:83], a[140:143], v[32:35], v[80:83]
s_waitcnt lgkmcnt(4)
v_mfma_f32_16x16x32_bf16 v[68:71], a[144:147], v[36:39], v[68:71]
ds_read_b128 v[28:31], v17 offset:33024
s_add_u32 m0, s21, 67584
v_mfma_f32_16x16x32_bf16 v[72:75], a[148:151], v[36:39], v[72:75]
buffer_load_dwordx4 v10, s[8:11], s20 offen lds
v_mfma_f32_16x16x32_bf16 v[76:79], a[144:147], v[40:43], v[76:79]
ds_read_b128 v[32:35], v17 offset:37120
v_mfma_f32_16x16x32_bf16 v[80:83], a[148:151], v[40:43], v[80:83]
s_waitcnt lgkmcnt(4)
v_mfma_f32_16x16x32_bf16 v[68:71], a[152:155], v[44:47], v[68:71]
ds_read_b128 v[36:39], v18 offset:33024
v_mfma_f32_16x16x32_bf16 v[72:75], a[156:159], v[44:47], v[72:75]
v_mfma_f32_16x16x32_bf16 v[76:79], a[152:155], v[48:51], v[76:79]
ds_read_b128 v[40:43], v18 offset:37120
v_mfma_f32_16x16x32_bf16 v[80:83], a[156:159], v[48:51], v[80:83]
s_waitcnt lgkmcnt(4)
v_mfma_f32_16x16x32_bf16 v[68:71], a[160:163], v[20:23], v[68:71]
ds_read_b128 v[44:47], v19 offset:33024
s_add_u32 m0, s21, 68608
v_mfma_f32_16x16x32_bf16 v[72:75], a[164:167], v[20:23], v[72:75]
buffer_load_dwordx4 v11, s[8:11], s20 offen lds
v_mfma_f32_16x16x32_bf16 v[76:79], a[160:163], v[24:27], v[76:79]
ds_read_b128 v[48:51], v19 offset:37120
v_mfma_f32_16x16x32_bf16 v[80:83], a[164:167], v[24:27], v[80:83]
s_waitcnt lgkmcnt(4)
v_mfma_f32_16x16x32_bf16 v[68:71], a[168:171], v[28:31], v[68:71]
s_waitcnt vmcnt(22)
s_barrier
ds_read_b128 v[20:23], v16 offset:49152
v_mfma_f32_16x16x32_bf16 v[72:75], a[172:175], v[28:31], v[72:75]
s_add_u32 s20, s20, 512
v_mfma_f32_16x16x32_bf16 v[76:79], a[168:171], v[32:35], v[76:79]
ds_read_b128 v[24:27], v16 offset:53248
v_mfma_f32_16x16x32_bf16 v[80:83], a[172:175], v[32:35], v[80:83]
s_waitcnt lgkmcnt(4)
v_mfma_f32_16x16x32_bf16 v[68:71], a[176:179], v[36:39], v[68:71]
ds_read_b128 v[28:31], v17 offset:49152
s_add_u32 m0, s21, 81920
v_mfma_f32_16x16x32_bf16 v[72:75], a[180:183], v[36:39], v[72:75]
buffer_load_dwordx4 v8, s[8:11], s20 offen lds
v_mfma_f32_16x16x32_bf16 v[76:79], a[176:179], v[40:43], v[76:79]
ds_read_b128 v[32:35], v17 offset:53248
v_mfma_f32_16x16x32_bf16 v[80:83], a[180:183], v[40:43], v[80:83]
s_waitcnt lgkmcnt(4)
buffer_load_dword v87, v103, s[32:35], 0 offen sc1
v_mfma_f32_16x16x32_bf16 v[68:71], a[184:187], v[44:47], v[68:71]
ds_read_b128 v[36:39], v18 offset:49152
v_mfma_f32_16x16x32_bf16 v[72:75], a[188:191], v[44:47], v[72:75]
v_mfma_f32_16x16x32_bf16 v[76:79], a[184:187], v[48:51], v[76:79]
ds_read_b128 v[40:43], v18 offset:53248
v_mfma_f32_16x16x32_bf16 v[80:83], a[188:191], v[48:51], v[80:83]
s_waitcnt lgkmcnt(4)
v_mfma_f32_16x16x32_bf16 v[68:71], a[192:195], v[20:23], v[68:71]
ds_read_b128 v[44:47], v19 offset:49152
s_add_u32 m0, s21, 82944
v_mfma_f32_16x16x32_bf16 v[72:75], a[196:199], v[20:23], v[72:75]
buffer_load_dwordx4 v9, s[8:11], s20 offen lds
v_mfma_f32_16x16x32_bf16 v[76:79], a[192:195], v[24:27], v[76:79]
ds_read_b128 v[48:51], v19 offset:53248
v_mfma_f32_16x16x32_bf16 v[80:83], a[196:199], v[24:27], v[80:83]
s_waitcnt lgkmcnt(4)
v_mfma_f32_16x16x32_bf16 v[68:71], a[200:203], v[28:31], v[68:71]
ds_read_b128 v[20:23], v16 offset:49408
v_mfma_f32_16x16x32_bf16 v[72:75], a[204:207], v[28:31], v[72:75]
v_mfma_f32_16x16x32_bf16 v[76:79], a[200:203], v[32:35], v[76:79]
ds_read_b128 v[24:27], v16 offset:53504
v_mfma_f32_16x16x32_bf16 v[80:83], a[204:207], v[32:35], v[80:83]
s_waitcnt lgkmcnt(4)
v_mfma_f32_16x16x32_bf16 v[68:71], a[208:211], v[36:39], v[68:71]
ds_read_b128 v[28:31], v17 offset:49408
s_add_u32 m0, s21, 83968
v_mfma_f32_16x16x32_bf16 v[72:75], a[212:215], v[36:39], v[72:75]
buffer_load_dwordx4 v10, s[8:11], s20 offen lds
v_mfma_f32_16x16x32_bf16 v[76:79], a[208:211], v[40:43], v[76:79]
ds_read_b128 v[32:35], v17 offset:53504
v_mfma_f32_16x16x32_bf16 v[80:83], a[212:215], v[40:43], v[80:83]
s_waitcnt lgkmcnt(4)
v_mfma_f32_16x16x32_bf16 v[68:71], a[216:219], v[44:47], v[68:71]
ds_read_b128 v[36:39], v18 offset:49408
v_mfma_f32_16x16x32_bf16 v[72:75], a[220:223], v[44:47], v[72:75]
v_mfma_f32_16x16x32_bf16 v[76:79], a[216:219], v[48:51], v[76:79]
ds_read_b128 v[40:43], v18 offset:53504
v_mfma_f32_16x16x32_bf16 v[80:83], a[220:223], v[48:51], v[80:83]
s_waitcnt lgkmcnt(4)
v_mfma_f32_16x16x32_bf16 v[68:71], a[224:227], v[20:23], v[68:71]
ds_read_b128 v[44:47], v19 offset:49408
s_add_u32 m0, s21, 84992
v_mfma_f32_16x16x32_bf16 v[72:75], a[228:231], v[20:23], v[72:75]
buffer_load_dwordx4 v11, s[8:11], s20 offen lds
v_mfma_f32_16x16x32_bf16 v[76:79], a[224:227], v[24:27], v[76:79]
ds_read_b128 v[48:51], v19 offset:53504
v_mfma_f32_16x16x32_bf16 v[80:83], a[228:231], v[24:27], v[80:83]
s_waitcnt lgkmcnt(4)
v_mfma_f32_16x16x32_bf16 v[68:71], a[232:235], v[28:31], v[68:71]
s_waitcnt vmcnt(23)
s_barrier
ds_read_b128 v[20:23], v12 offset:0
v_mfma_f32_16x16x32_bf16 v[72:75], a[236:239], v[28:31], v[72:75]
s_add_u32 s20, s20, 512
v_mfma_f32_16x16x32_bf16 v[76:79], a[232:235], v[32:35], v[76:79]
ds_read_b128 v[24:27], v12 offset:4096
v_mfma_f32_16x16x32_bf16 v[80:83], a[236:239], v[32:35], v[80:83]
s_waitcnt lgkmcnt(4)
v_mfma_f32_16x16x32_bf16 v[68:71], a[240:243], v[36:39], v[68:71]
ds_read_b128 v[28:31], v13 offset:0
s_add_u32 m0, s21, 98304
v_mfma_f32_16x16x32_bf16 v[72:75], a[244:247], v[36:39], v[72:75]
buffer_load_dwordx4 v8, s[8:11], s20 offen lds
v_mfma_f32_16x16x32_bf16 v[76:79], a[240:243], v[40:43], v[76:79]
ds_read_b128 v[32:35], v13 offset:4096
v_mfma_f32_16x16x32_bf16 v[80:83], a[244:247], v[40:43], v[80:83]
s_waitcnt lgkmcnt(4)
v_mfma_f32_16x16x32_bf16 v[68:71], a[248:251], v[44:47], v[68:71]
ds_read_b128 v[36:39], v14 offset:0
v_mfma_f32_16x16x32_bf16 v[72:75], a[252:255], v[44:47], v[72:75]
v_mfma_f32_16x16x32_bf16 v[76:79], a[248:251], v[48:51], v[76:79]
ds_read_b128 v[40:43], v14 offset:4096
v_mfma_f32_16x16x32_bf16 v[80:83], a[252:255], v[48:51], v[80:83]
s_waitcnt lgkmcnt(4)
s_add_u32 s22, s22, 1
s_cmp_ge_u32 s22, s23
s_cbranch_scc0 L_st_467
s_branch L_fl1_465
L_st_468:
v_mfma_f32_16x16x32_bf16 v[52:55], a[0:3], v[20:23], 0
ds_read_b128 v[44:47], v15 offset:0
s_add_u32 m0, s21, 99328
s_sub_u32 s39, s22, 1
v_mfma_f32_16x16x32_bf16 v[56:59], a[4:7], v[20:23], 0
buffer_load_dwordx4 v9, s[8:11], s20 offen lds
v_mfma_f32_16x16x32_bf16 v[60:63], a[0:3], v[24:27], 0
ds_read_b128 v[48:51], v15 offset:4096
s_bitcmp1_b32 s39, 1
s_cselect_b32 s38, s54, s55
v_mfma_f32_16x16x32_bf16 v[64:67], a[4:7], v[24:27], 0
s_waitcnt lgkmcnt(4)
v_mfma_f32_16x16x32_bf16 v[52:55], a[8:11], v[28:31], v[52:55]
ds_read_b128 v[20:23], v12 offset:256
s_add_u32 s38, s38, s44
s_waitcnt vmcnt(5)
v_mfma_f32_16x16x32_bf16 v[56:59], a[12:15], v[28:31], v[56:59]
s_lshl_b32 s42, s39, 20
s_add_u32 s38, s38, s42
ds_write_b32 v101, v87
v_mfma_f32_16x16x32_bf16 v[60:63], a[8:11], v[32:35], v[60:63]
ds_read_b128 v[24:27], v12 offset:4352
s_cmp_eq_u32 s37, 0
s_cselect_b32 s38, 0x7ff00000, s38
v_mfma_f32_16x16x32_bf16 v[64:67], a[12:15], v[32:35], v[64:67]
s_waitcnt lgkmcnt(4)
v_mfma_f32_16x16x32_bf16 v[52:55], a[16:19], v[36:39], v[52:55]
ds_read_b128 v[28:31], v13 offset:256
s_add_u32 m0, s21, 100352
v_mfma_f32_16x16x32_bf16 v[56:59], a[20:23], v[36:39], v[56:59]
buffer_load_dwordx4 v10, s[8:11], s20 offen lds
s_mov_b32 s37, 1
v_mfma_f32_16x16x32_bf16 v[60:63], a[16:19], v[40:43], v[60:63]
ds_read_b128 v[32:35], v13 offset:4352
v_cvt_pk_bf16_f32 v88, v68, v69
v_mfma_f32_16x16x32_bf16 v[64:67], a[20:23], v[40:43], v[64:67]
s_waitcnt lgkmcnt(4)
v_cvt_pk_bf16_f32 v89, v70, v71
v_mfma_f32_16x16x32_bf16 v[52:55], a[24:27], v[44:47], v[52:55]
ds_read_b128 v[36:39], v14 offset:256
v_cvt_pk_bf16_f32 v90, v72, v73
v_mfma_f32_16x16x32_bf16 v[56:59], a[28:31], v[44:47], v[56:59]
v_cvt_pk_bf16_f32 v91, v74, v75
v_mfma_f32_16x16x32_bf16 v[60:63], a[24:27], v[48:51], v[60:63]
ds_read_b128 v[40:43], v14 offset:4352
buffer_store_dwordx4 v[88:91], v86, s[12:15], s38 offen offset:0
v_mfma_f32_16x16x32_bf16 v[64:67], a[28:31], v[48:51], v[64:67]
s_waitcnt lgkmcnt(4)
v_cvt_pk_bf16_f32 v92, v76, v77
v_cvt_pk_bf16_f32 v93, v78, v79
v_mfma_f32_16x16x32_bf16 v[52:55], a[32:35], v[20:23], v[52:55]
ds_read_b128 v[44:47], v15 offset:256
s_add_u32 m0, s21, 101376
v_mfma_f32_16x16x32_bf16 v[56:59], a[36:39], v[20:23], v[56:59]
buffer_load_dwordx4 v11, s[8:11], s20 offen lds
v_cvt_pk_bf16_f32 v94, v80, v81
v_mfma_f32_16x16x32_bf16 v[60:63], a[32:35], v[24:27], v[60:63]
ds_read_b128 v[48:51], v15 offset:4352
v_cvt_pk_bf16_f32 v95, v82, v83
v_mfma_f32_16x16x32_bf16 v[64:67], a[36:39], v[24:27], v[64:67]
s_waitcnt lgkmcnt(4)
buffer_store_dwordx4 v[92:95], v86, s[12:15], s38 offen offset:128
v_mfma_f32_16x16x32_bf16 v[52:55], a[40:43], v[28:31], v[52:55]
s_waitcnt vmcnt(40)
s_barrier
ds_read_b128 v[20:23], v12 offset:16384
v_mfma_f32_16x16x32_bf16 v[56:59], a[44:47], v[28:31], v[56:59]
s_add_u32 s20, s20, 512
v_mfma_f32_16x16x32_bf16 v[60:63], a[40:43], v[32:35], v[60:63]
ds_read_b128 v[24:27], v12 offset:20480
ds_read_b32 v87, v102
v_mfma_f32_16x16x32_bf16 v[64:67], a[44:47], v[32:35], v[64:67]
s_waitcnt lgkmcnt(4)
v_mfma_f32_16x16x32_bf16 v[52:55], a[48:51], v[36:39], v[52:55]
ds_read_b128 v[28:31], v13 offset:16384
s_add_u32 m0, s21, 114688
v_mfma_f32_16x16x32_bf16 v[56:59], a[52:55], v[36:39], v[56:59]
buffer_load_dwordx4 v8, s[8:11], s20 offen lds
v_mfma_f32_16x16x32_bf16 v[60:63], a[48:51], v[40:43], v[60:63]
ds_read_b128 v[32:35], v13 offset:20480
v_mfma_f32_16x16x32_bf16 v[64:67], a[52:55], v[40:43], v[64:67]
s_waitcnt lgkmcnt(4)
v_mfma_f32_16x16x32_bf16 v[52:55], a[56:59], v[44:47], v[52:55]
ds_read_b128 v[36:39], v14 offset:16384
v_mfma_f32_16x16x32_bf16 v[56:59], a[60:63], v[44:47], v[56:59]
v_mfma_f32_16x16x32_bf16 v[60:63], a[56:59], v[48:51], v[60:63]
ds_read_b128 v[40:43], v14 offset:20480
v_mfma_f32_16x16x32_bf16 v[64:67], a[60:63], v[48:51], v[64:67]
s_waitcnt lgkmcnt(4)
v_mfma_f32_16x16x32_bf16 v[52:55], a[64:67], v[20:23], v[52:55]
ds_read_b128 v[44:47], v15 offset:16384
s_add_u32 m0, s21, 115712
v_mfma_f32_16x16x32_bf16 v[56:59], a[68:71], v[20:23], v[56:59]
buffer_load_dwordx4 v9, s[8:11], s20 offen lds
v_mfma_f32_16x16x32_bf16 v[60:63], a[64:67], v[24:27], v[60:63]
ds_read_b128 v[48:51], v15 offset:20480
s_waitcnt vmcnt(13)
s_branch L_att_458
L_attr_461:
v_mfma_f32_16x16x32_bf16 v[64:67], a[68:71], v[24:27], v[64:67]
s_waitcnt lgkmcnt(4)
s_add_u32 s43, s50, 0
buffer_load_dwordx4 v[136:139], v96, s[12:15], s43 offen offset:0
v_mfma_f32_16x16x32_bf16 v[52:55], a[72:75], v[28:31], v[52:55]
ds_read_b128 v[20:23], v12 offset:16640
v_mfma_f32_16x16x32_bf16 v[56:59], a[76:79], v[28:31], v[56:59]
v_mfma_f32_16x16x32_bf16 v[60:63], a[72:75], v[32:35], v[60:63]
ds_read_b128 v[24:27], v12 offset:20736
s_add_u32 s24, s24, 1
v_mfma_f32_16x16x32_bf16 v[64:67], a[76:79], v[32:35], v[64:67]
s_waitcnt lgkmcnt(4)
v_mfma_f32_16x16x32_bf16 v[52:55], a[80:83], v[36:39], v[52:55]
ds_read_b128 v[28:31], v13 offset:16640
s_add_u32 m0, s21, 116736
v_mfma_f32_16x16x32_bf16 v[56:59], a[84:87], v[36:39], v[56:59]
buffer_load_dwordx4 v10, s[8:11], s20 offen lds
v_mfma_f32_16x16x32_bf16 v[60:63], a[80:83], v[40:43], v[60:63]
ds_read_b128 v[32:35], v13 offset:20736
v_mfma_f32_16x16x32_bf16 v[64:67], a[84:87], v[40:43], v[64:67]
s_waitcnt lgkmcnt(4)
s_add_u32 s43, s50, 0
buffer_load_dwordx4 v[140:143], v96, s[12:15], s43 offen offset:1024
v_mfma_f32_16x16x32_bf16 v[52:55], a[88:91], v[44:47], v[52:55]
ds_read_b128 v[36:39], v14 offset:16640
s_min_u32 s24, s24, 63
v_mfma_f32_16x16x32_bf16 v[56:59], a[92:95], v[44:47], v[56:59]
v_mfma_f32_16x16x32_bf16 v[60:63], a[88:91], v[48:51], v[60:63]
ds_read_b128 v[40:43], v14 offset:20736
s_add_u32 s43, s48, 0
buffer_load_dwordx4 v[104:107], v96, s[12:15], s43 offen offset:0
v_mfma_f32_16x16x32_bf16 v[64:67], a[92:95], v[48:51], v[64:67]
s_waitcnt lgkmcnt(4)
s_lshl_b32 s53, s24, 16
v_mfma_f32_16x16x32_bf16 v[52:55], a[96:99], v[20:23], v[52:55]
ds_read_b128 v[44:47], v15 offset:16640
s_add_u32 m0, s21, 117760
v_mfma_f32_16x16x32_bf16 v[56:59], a[100:103], v[20:23], v[56:59]
buffer_load_dwordx4 v11, s[8:11], s20 offen lds
v_mfma_f32_16x16x32_bf16 v[60:63], a[96:99], v[24:27], v[60:63]
ds_read_b128 v[48:51], v15 offset:20736
v_mfma_f32_16x16x32_bf16 v[64:67], a[100:103], v[24:27], v[64:67]
s_waitcnt lgkmcnt(4)
v_mfma_f32_16x16x32_bf16 v[52:55], a[104:107], v[28:31], v[52:55]
s_waitcnt vmcnt(27)
s_barrier
ds_read_b128 v[20:23], v12 offset:32768
v_mfma_f32_16x16x32_bf16 v[56:59], a[108:111], v[28:31], v[56:59]
s_mov_b32 s20, s53
v_mfma_f32_16x16x32_bf16 v[60:63], a[104:107], v[32:35], v[60:63]
ds_read_b128 v[24:27], v12 offset:36864
s_add_u32 s43, s48, 0
buffer_load_dwordx4 v[108:111], v96, s[12:15], s43 offen offset:1024
v_mfma_f32_16x16x32_bf16 v[64:67], a[108:111], v[32:35], v[64:67]
s_waitcnt lgkmcnt(4)
v_mfma_f32_16x16x32_bf16 v[52:55], a[112:115], v[36:39], v[52:55]
ds_read_b128 v[28:31], v13 offset:32768
s_add_u32 m0, s21, 0
v_mfma_f32_16x16x32_bf16 v[56:59], a[116:119], v[36:39], v[56:59]
buffer_load_dwordx4 v8, s[8:11], s20 offen lds
v_mfma_f32_16x16x32_bf16 v[60:63], a[112:115], v[40:43], v[60:63]
ds_read_b128 v[32:35], v13 offset:36864
v_mfma_f32_16x16x32_bf16 v[64:67], a[116:119], v[40:43], v[64:67]
s_waitcnt lgkmcnt(4)
s_add_u32 s43, s50, 4096
buffer_load_dwordx4 v[144:147], v96, s[12:15], s43 offen offset:2048
v_mfma_f32_16x16x32_bf16 v[52:55], a[120:123], v[44:47], v[52:55]
ds_read_b128 v[36:39], v14 offset:32768
v_mfma_f32_16x16x32_bf16 v[56:59], a[124:127], v[44:47], v[56:59]
v_mfma_f32_16x16x32_bf16 v[60:63], a[120:123], v[48:51], v[60:63]
ds_read_b128 v[40:43], v14 offset:36864
v_mfma_f32_16x16x32_bf16 v[64:67], a[124:127], v[48:51], v[64:67]
s_waitcnt lgkmcnt(4)
v_mfma_f32_16x16x32_bf16 v[52:55], a[128:131], v[20:23], v[52:55]
ds_read_b128 v[44:47], v15 offset:32768
s_add_u32 m0, s21, 1024
v_mfma_f32_16x16x32_bf16 v[56:59], a[132:135], v[20:23], v[56:59]
buffer_load_dwordx4 v9, s[8:11], s20 offen lds
v_mfma_f32_16x16x32_bf16 v[60:63], a[128:131], v[24:27], v[60:63]
ds_read_b128 v[48:51], v15 offset:36864
v_mfma_f32_16x16x32_bf16 v[64:67], a[132:135], v[24:27], v[64:67]
s_waitcnt lgkmcnt(4)
s_add_u32 s43, s50, 4096
buffer_load_dwordx4 v[148:151], v96, s[12:15], s43 offen offset:3072
v_mfma_f32_16x16x32_bf16 v[52:55], a[136:139], v[28:31], v[52:55]
ds_read_b128 v[20:23], v12 offset:33024
v_mfma_f32_16x16x32_bf16 v[56:59], a[140:143], v[28:31], v[56:59]
v_mfma_f32_16x16x32_bf16 v[60:63], a[136:139], v[32:35], v[60:63]
ds_read_b128 v[24:27], v12 offset:37120
s_add_u32 s43, s48, 4096
buffer_load_dwordx4 v[112:115], v96, s[12:15], s43 offen offset:0
v_mfma_f32_16x16x32_bf16 v[64:67], a[140:143], v[32:35], v[64:67]
s_waitcnt lgkmcnt(4)
v_mfma_f32_16x16x32_bf16 v[52:55], a[144:147], v[36:39], v[52:55]
ds_read_b128 v[28:31], v13 offset:33024
s_add_u32 m0, s21, 2048
v_mfma_f32_16x16x32_bf16 v[56:59], a[148:151], v[36:39], v[56:59]
buffer_load_dwordx4 v10, s[8:11], s20 offen lds
v_mfma_f32_16x16x32_bf16 v[60:63], a[144:147], v[40:43], v[60:63]
ds_read_b128 v[32:35], v13 offset:37120
v_mfma_f32_16x16x32_bf16 v[64:67], a[148:151], v[40:43], v[64:67]
s_waitcnt lgkmcnt(4)
v_mfma_f32_16x16x32_bf16 v[52:55], a[152:155], v[44:47], v[52:55]
ds_read_b128 v[36:39], v14 offset:33024
v_mfma_f32_16x16x32_bf16 v[56:59], a[156:159], v[44:47], v[56:59]
v_mfma_f32_16x16x32_bf16 v[60:63], a[152:155], v[48:51], v[60:63]
ds_read_b128 v[40:43], v14 offset:37120
s_add_u32 s43, s48, 4096
buffer_load_dwordx4 v[116:119], v96, s[12:15], s43 offen offset:1024
v_mfma_f32_16x16x32_bf16 v[64:67], a[156:159], v[48:51], v[64:67]
s_waitcnt lgkmcnt(4)
v_mfma_f32_16x16x32_bf16 v[52:55], a[160:163], v[20:23], v[52:55]
ds_read_b128 v[44:47], v15 offset:33024
s_add_u32 m0, s21, 3072
v_mfma_f32_16x16x32_bf16 v[56:59], a[164:167], v[20:23], v[56:59]
buffer_load_dwordx4 v11, s[8:11], s20 offen lds
v_mfma_f32_16x16x32_bf16 v[60:63], a[160:163], v[24:27], v[60:63]
ds_read_b128 v[48:51], v15 offset:37120
v_mfma_f32_16x16x32_bf16 v[64:67], a[164:167], v[24:27], v[64:67]
s_waitcnt lgkmcnt(4)
s_add_u32 s43, s50, 16384
buffer_load_dwordx4 v[152:155], v96, s[12:15], s43 offen offset:0
v_mfma_f32_16x16x32_bf16 v[52:55], a[168:171], v[28:31], v[52:55]
s_waitcnt vmcnt(32)
s_barrier
ds_read_b128 v[20:23], v12 offset:49152
v_mfma_f32_16x16x32_bf16 v[56:59], a[172:175], v[28:31], v[56:59]
s_add_u32 s20, s20, 512
v_mfma_f32_16x16x32_bf16 v[60:63], a[168:171], v[32:35], v[60:63]
ds_read_b128 v[24:27], v12 offset:53248
v_mfma_f32_16x16x32_bf16 v[64:67], a[172:175], v[32:35], v[64:67]
s_waitcnt lgkmcnt(4)
v_mfma_f32_16x16x32_bf16 v[52:55], a[176:179], v[36:39], v[52:55]
ds_read_b128 v[28:31], v13 offset:49152
s_add_u32 m0, s21, 16384
v_mfma_f32_16x16x32_bf16 v[56:59], a[180:183], v[36:39], v[56:59]
buffer_load_dwordx4 v8, s[8:11], s20 offen lds
v_mfma_f32_16x16x32_bf16 v[60:63], a[176:179], v[40:43], v[60:63]
ds_read_b128 v[32:35], v13 offset:53248
v_mfma_f32_16x16x32_bf16 v[64:67], a[180:183], v[40:43], v[64:67]
s_waitcnt lgkmcnt(4)
s_add_u32 s43, s50, 16384
buffer_load_dwordx4 v[156:159], v96, s[12:15], s43 offen offset:1024
v_mfma_f32_16x16x32_bf16 v[52:55], a[184:187], v[44:47], v[52:55]
ds_read_b128 v[36:39], v14 offset:49152
v_mfma_f32_16x16x32_bf16 v[56:59], a[188:191], v[44:47], v[56:59]
v_mfma_f32_16x16x32_bf16 v[60:63], a[184:187], v[48:51], v[60:63]
ds_read_b128 v[40:43], v14 offset:53248
s_add_u32 s43, s48, 16384
buffer_load_dwordx4 v[120:123], v96, s[12:15], s43 offen offset:0
v_mfma_f32_16x16x32_bf16 v[64:67], a[188:191], v[48:51], v[64:67]
s_waitcnt lgkmcnt(4)
v_mfma_f32_16x16x32_bf16 v[52:55], a[192:195], v[20:23], v[52:55]
ds_read_b128 v[44:47], v15 offset:49152
s_add_u32 m0, s21, 17408
v_mfma_f32_16x16x32_bf16 v[56:59], a[196:199], v[20:23], v[56:59]
buffer_load_dwordx4 v9, s[8:11], s20 offen lds
v_mfma_f32_16x16x32_bf16 v[60:63], a[192:195], v[24:27], v[60:63]
ds_read_b128 v[48:51], v15 offset:53248
v_mfma_f32_16x16x32_bf16 v[64:67], a[196:199], v[24:27], v[64:67]
s_waitcnt lgkmcnt(4)
v_mfma_f32_16x16x32_bf16 v[52:55], a[200:203], v[28:31], v[52:55]
ds_read_b128 v[20:23], v12 offset:49408
v_mfma_f32_16x16x32_bf16 v[56:59], a[204:207], v[28:31], v[56:59]
v_mfma_f32_16x16x32_bf16 v[60:63], a[200:203], v[32:35], v[60:63]
ds_read_b128 v[24:27], v12 offset:53504
s_add_u32 s43, s48, 16384
buffer_load_dwordx4 v[124:127], v96, s[12:15], s43 offen offset:1024
v_mfma_f32_16x16x32_bf16 v[64:67], a[204:207], v[32:35], v[64:67]
s_waitcnt lgkmcnt(4)
v_mfma_f32_16x16x32_bf16 v[52:55], a[208:211], v[36:39], v[52:55]
ds_read_b128 v[28:31], v13 offset:49408
s_add_u32 m0, s21, 18432
v_mfma_f32_16x16x32_bf16 v[56:59], a[212:215], v[36:39], v[56:59]
buffer_load_dwordx4 v10, s[8:11], s20 offen lds
v_mfma_f32_16x16x32_bf16 v[60:63], a[208:211], v[40:43], v[60:63]
ds_read_b128 v[32:35], v13 offset:53504
v_mfma_f32_16x16x32_bf16 v[64:67], a[212:215], v[40:43], v[64:67]
s_waitcnt lgkmcnt(4)
s_add_u32 s43, s50, 20480
buffer_load_dwordx4 v[160:163], v96, s[12:15], s43 offen offset:2048
v_mfma_f32_16x16x32_bf16 v[52:55], a[216:219], v[44:47], v[52:55]
ds_read_b128 v[36:39], v14 offset:49408
v_mfma_f32_16x16x32_bf16 v[56:59], a[220:223], v[44:47], v[56:59]
v_mfma_f32_16x16x32_bf16 v[60:63], a[216:219], v[48:51], v[60:63]
ds_read_b128 v[40:43], v14 offset:53504
v_mfma_f32_16x16x32_bf16 v[64:67], a[220:223], v[48:51], v[64:67]
s_waitcnt lgkmcnt(4)
v_mfma_f32_16x16x32_bf16 v[52:55], a[224:227], v[20:23], v[52:55]
ds_read_b128 v[44:47], v15 offset:49408
s_add_u32 m0, s21, 19456
v_mfma_f32_16x16x32_bf16 v[56:59], a[228:231], v[20:23], v[56:59]
buffer_load_dwordx4 v11, s[8:11], s20 offen lds
v_mfma_f32_16x16x32_bf16 v[60:63], a[224:227], v[24:27], v[60:63]
ds_read_b128 v[48:51], v15 offset:53504
v_mfma_f32_16x16x32_bf16 v[64:67], a[228:231], v[24:27], v[64:67]
s_waitcnt lgkmcnt(4)
s_add_u32 s43, s50, 20480
buffer_load_dwordx4 v[164:167], v96, s[12:15], s43 offen offset:3072
v_mfma_f32_16x16x32_bf16 v[52:55], a[232:235], v[28:31], v[52:55]
s_waitcnt vmcnt(37)
s_barrier
ds_read_b128 v[20:23], v16 offset:0
v_mfma_f32_16x16x32_bf16 v[56:59], a[236:239], v[28:31], v[56:59]
s_add_u32 s20, s20, 512
v_mfma_f32_16x16x32_bf16 v[60:63], a[232:235], v[32:35], v[60:63]
ds_read_b128 v[24:27], v16 offset:4096
s_add_u32 s43, s48, 20480
buffer_load_dwordx4 v[128:131], v96, s[12:15], s43 offen offset:0
v_mfma_f32_16x16x32_bf16 v[64:67], a[236:239], v[32:35], v[64:67]
s_waitcnt lgkmcnt(4)
v_mfma_f32_16x16x32_bf16 v[52:55], a[240:243], v[36:39], v[52:55]
ds_read_b128 v[28:31], v17 offset:0
s_add_u32 m0, s21, 32768
v_mfma_f32_16x16x32_bf16 v[56:59], a[244:247], v[36:39], v[56:59]
buffer_load_dwordx4 v8, s[8:11], s20 offen lds
v_mfma_f32_16x16x32_bf16 v[60:63], a[240:243], v[40:43], v[60:63]
ds_read_b128 v[32:35], v17 offset:4096
v_mfma_f32_16x16x32_bf16 v[64:67], a[244:247], v[40:43], v[64:67]
s_waitcnt lgkmcnt(4)
v_mfma_f32_16x16x32_bf16 v[52:55], a[248:251], v[44:47], v[52:55]
ds_read_b128 v[36:39], v18 offset:0
v_mfma_f32_16x16x32_bf16 v[56:59], a[252:255], v[44:47], v[56:59]
v_mfma_f32_16x16x32_bf16 v[60:63], a[248:251], v[48:51], v[60:63]
ds_read_b128 v[40:43], v18 offset:4096
v_mfma_f32_16x16x32_bf16 v[64:67], a[252:255], v[48:51], v[64:67]
s_waitcnt lgkmcnt(4)
s_add_u32 s22, s22, 1
s_cmp_ge_u32 s22, s23
s_cbranch_scc1 L_fl0_464
v_mfma_f32_16x16x32_bf16 v[68:71], a[0:3], v[20:23], 0
ds_read_b128 v[44:47], v19 offset:0
s_add_u32 m0, s21, 33792
s_sub_u32 s39, s22, 1
v_mfma_f32_16x16x32_bf16 v[72:75], a[4:7], v[20:23], 0
buffer_load_dwordx4 v9, s[8:11], s20 offen lds
s_bitcmp1_b32 s39, 1
s_cselect_b32 s38, s54, s55
v_mfma_f32_16x16x32_bf16 v[76:79], a[0:3], v[24:27], 0
ds_read_b128 v[48:51], v19 offset:4096
v_mfma_f32_16x16x32_bf16 v[80:83], a[4:7], v[24:27], 0
s_waitcnt lgkmcnt(4)
s_add_u32 s43, s48, 20480
buffer_load_dwordx4 v[132:135], v96, s[12:15], s43 offen offset:1024
v_mfma_f32_16x16x32_bf16 v[68:71], a[8:11], v[28:31], v[68:71]
ds_read_b128 v[20:23], v16 offset:256
s_add_u32 s38, s38, s44
v_mfma_f32_16x16x32_bf16 v[72:75], a[12:15], v[28:31], v[72:75]
s_lshl_b32 s42, s39, 20
s_add_u32 s38, s38, s42
v_mfma_f32_16x16x32_bf16 v[76:79], a[8:11], v[32:35], v[76:79]
ds_read_b128 v[24:27], v16 offset:4352
s_add_u32 s43, s48, 0
buffer_load_dwordx4 v[168:171], v98, s[12:15], s43 offen offset:2048
v_mfma_f32_16x16x32_bf16 v[80:83], a[12:15], v[32:35], v[80:83]
s_waitcnt lgkmcnt(4)
s_cmp_eq_u32 s37, 0
s_cselect_b32 s38, 0x7ff00000, s38
v_mfma_f32_16x16x32_bf16 v[68:71], a[16:19], v[36:39], v[68:71]
ds_read_b128 v[28:31], v17 offset:256
s_add_u32 m0, s21, 34816
v_mfma_f32_16x16x32_bf16 v[72:75], a[20:23], v[36:39], v[72:75]
buffer_load_dwordx4 v10, s[8:11], s20 offen lds
s_mov_b32 s37, 1
v_mfma_f32_16x16x32_bf16 v[76:79], a[16:19], v[40:43], v[76:79]
ds_read_b128 v[32:35], v17 offset:4352
v_cvt_pk_bf16_f32 v88, v52, v53
v_mfma_f32_16x16x32_bf16 v[80:83], a[20:23], v[40:43], v[80:83]
s_waitcnt lgkmcnt(4)
s_add_u32 s43, s48, 0
buffer_load_dwordx4 v[172:175], v98, s[12:15], s43 offen offset:3072
v_mfma_f32_16x16x32_bf16 v[68:71], a[24:27], v[44:47], v[68:71]
ds_read_b128 v[36:39], v18 offset:256
v_cvt_pk_bf16_f32 v89, v54, v55
v_cvt_pk_bf16_f32 v90, v56, v57
v_mfma_f32_16x16x32_bf16 v[72:75], a[28:31], v[44:47], v[72:75]
v_cvt_pk_bf16_f32 v91, v58, v59
v_mfma_f32_16x16x32_bf16 v[76:79], a[24:27], v[48:51], v[76:79]
ds_read_b128 v[40:43], v18 offset:4352
buffer_store_dwordx4 v[88:91], v86, s[12:15], s38 offen offset:0
v_mfma_f32_16x16x32_bf16 v[80:83], a[28:31], v[48:51], v[80:83]
s_waitcnt lgkmcnt(4)
v_cvt_pk_bf16_f32 v92, v60, v61
v_cvt_pk_bf16_f32 v93, v62, v63
v_mfma_f32_16x16x32_bf16 v[68:71], a[32:35], v[20:23], v[68:71]
ds_read_b128 v[44:47], v19 offset:256
s_add_u32 m0, s21, 35840
v_mfma_f32_16x16x32_bf16 v[72:75], a[36:39], v[20:23], v[72:75]
buffer_load_dwordx4 v11, s[8:11], s20 offen lds
v_cvt_pk_bf16_f32 v94, v64, v65
v_mfma_f32_16x16x32_bf16 v[76:79], a[32:35], v[24:27], v[76:79]
ds_read_b128 v[48:51], v19 offset:4352
v_cvt_pk_bf16_f32 v95, v66, v67
v_mfma_f32_16x16x32_bf16 v[80:83], a[36:39], v[24:27], v[80:83]
s_waitcnt lgkmcnt(4)
buffer_store_dwordx4 v[92:95], v86, s[12:15], s38 offen offset:128
v_mfma_f32_16x16x32_bf16 v[68:71], a[40:43], v[28:31], v[68:71]
s_waitcnt vmcnt(42)
s_barrier
ds_read_b128 v[20:23], v16 offset:16384
v_mfma_f32_16x16x32_bf16 v[72:75], a[44:47], v[28:31], v[72:75]
s_add_u32 s20, s20, 512
v_mfma_f32_16x16x32_bf16 v[76:79], a[40:43], v[32:35], v[76:79]
ds_read_b128 v[24:27], v16 offset:20480
s_add_u32 s43, s48, 4096
buffer_load_dwordx4 v[176:179], v98, s[12:15], s43 offen offset:2048
v_mfma_f32_16x16x32_bf16 v[80:83], a[44:47], v[32:35], v[80:83]
s_waitcnt lgkmcnt(4)
v_mfma_f32_16x16x32_bf16 v[68:71], a[48:51], v[36:39], v[68:71]
ds_read_b128 v[28:31], v17 offset:16384
s_add_u32 m0, s21, 49152
v_mfma_f32_16x16x32_bf16 v[72:75], a[52:55], v[36:39], v[72:75]
buffer_load_dwordx4 v8, s[8:11], s20 offen lds
v_mfma_f32_16x16x32_bf16 v[76:79], a[48:51], v[40:43], v[76:79]
ds_read_b128 v[32:35], v17 offset:20480
v_mfma_f32_16x16x32_bf16 v[80:83], a[52:55], v[40:43], v[80:83]
s_waitcnt lgkmcnt(4)
s_add_u32 s43, s48, 4096
buffer_load_dwordx4 v[180:183], v98, s[12:15], s43 offen offset:3072
v_mfma_f32_16x16x32_bf16 v[68:71], a[56:59], v[44:47], v[68:71]
ds_read_b128 v[36:39], v18 offset:16384
v_mfma_f32_16x16x32_bf16 v[72:75], a[60:63], v[44:47], v[72:75]
v_mfma_f32_16x16x32_bf16 v[76:79], a[56:59], v[48:51], v[76:79]
ds_read_b128 v[40:43], v18 offset:20480
s_add_u32 s43, s48, 16384
buffer_load_dwordx4 v[184:187], v98, s[12:15], s43 offen offset:2048
v_mfma_f32_16x16x32_bf16 v[80:83], a[60:63], v[48:51], v[80:83]
s_waitcnt lgkmcnt(4)
v_mfma_f32_16x16x32_bf16 v[68:71], a[64:67], v[20:23], v[68:71]
ds_read_b128 v[44:47], v19 offset:16384
s_add_u32 m0, s21, 50176
v_mfma_f32_16x16x32_bf16 v[72:75], a[68:71], v[20:23], v[72:75]
buffer_load_dwordx4 v9, s[8:11], s20 offen lds
v_mfma_f32_16x16x32_bf16 v[76:79], a[64:67], v[24:27], v[76:79]
ds_read_b128 v[48:51], v19 offset:20480
v_mfma_f32_16x16x32_bf16 v[80:83], a[68:71], v[24:27], v[80:83]
s_waitcnt lgkmcnt(4)
s_add_u32 s43, s48, 16384
buffer_load_dwordx4 v[188:191], v98, s[12:15], s43 offen offset:3072
v_mfma_f32_16x16x32_bf16 v[68:71], a[72:75], v[28:31], v[68:71]
ds_read_b128 v[20:23], v16 offset:16640
v_mfma_f32_16x16x32_bf16 v[72:75], a[76:79], v[28:31], v[72:75]
v_mfma_f32_16x16x32_bf16 v[76:79], a[72:75], v[32:35], v[76:79]
ds_read_b128 v[24:27], v16 offset:20736
s_add_u32 s24, s24, 1
v_mfma_f32_16x16x32_bf16 v[80:83], a[76:79], v[32:35], v[80:83]
s_waitcnt lgkmcnt(4)
v_mfma_f32_16x16x32_bf16 v[68:71], a[80:83], v[36:39], v[68:71]
ds_read_b128 v[28:31], v17 offset:16640
s_add_u32 m0, s21, 51200
v_mfma_f32_16x16x32_bf16 v[72:75], a[84:87], v[36:39], v[72:75]
buffer_load_dwordx4 v10, s[8:11], s20 offen lds
v_mfma_f32_16x16x32_bf16 v[76:79], a[80:83], v[40:43], v[76:79]
ds_read_b128 v[32:35], v17 offset:20736
v_mfma_f32_16x16x32_bf16 v[80:83], a[84:87], v[40:43], v[80:83]
s_waitcnt lgkmcnt(4)
s_add_u32 s43, s48, 20480
buffer_load_dwordx4 v[192:195], v98, s[12:15], s43 offen offset:2048
v_mfma_f32_16x16x32_bf16 v[68:71], a[88:91], v[44:47], v[68:71]
ds_read_b128 v[36:39], v18 offset:16640
s_min_u32 s24, s24, 63
v_mfma_f32_16x16x32_bf16 v[72:75], a[92:95], v[44:47], v[72:75]
v_mfma_f32_16x16x32_bf16 v[76:79], a[88:91], v[48:51], v[76:79]
ds_read_b128 v[40:43], v18 offset:20736
s_add_u32 s43, s48, 20480
buffer_load_dwordx4 v[196:199], v98, s[12:15], s43 offen offset:3072
v_mfma_f32_16x16x32_bf16 v[80:83], a[92:95], v[48:51], v[80:83]
s_waitcnt lgkmcnt(4)
s_lshl_b32 s53, s24, 16
v_mfma_f32_16x16x32_bf16 v[68:71], a[96:99], v[20:23], v[68:71]
ds_read_b128 v[44:47], v19 offset:16640
s_add_u32 m0, s21, 52224
v_mfma_f32_16x16x32_bf16 v[72:75], a[100:103], v[20:23], v[72:75]
buffer_load_dwordx4 v11, s[8:11], s20 offen lds
v_mfma_f32_16x16x32_bf16 v[76:79], a[96:99], v[24:27], v[76:79]
ds_read_b128 v[48:51], v19 offset:20736
v_mfma_f32_16x16x32_bf16 v[80:83], a[100:103], v[24:27], v[80:83]
s_waitcnt lgkmcnt(4)
v_mfma_f32_16x16x32_bf16 v[68:71], a[104:107], v[28:31], v[68:71]
s_waitcnt vmcnt(47)
s_barrier
ds_read_b128 v[20:23], v16 offset:32768
v_mfma_f32_16x16x32_bf16 v[72:75], a[108:111], v[28:31], v[72:75]
s_mov_b32 s20, s53
v_mfma_f32_16x16x32_bf16 v[76:79], a[104:107], v[32:35], v[76:79]
ds_read_b128 v[24:27], v16 offset:36864
s_add_u32 m0, s7, 0
s_add_u32 s43, s48, 0x8000c00
buffer_load_dwordx4 v96, s[12:15], s43 offen sc1 lds
v_mfma_f32_16x16x32_bf16 v[80:83], a[108:111], v[32:35], v[80:83]
s_waitcnt lgkmcnt(4)
v_mfma_f32_16x16x32_bf16 v[68:71], a[112:115], v[36:39], v[68:71]
ds_read_b128 v[28:31], v17 offset:32768
s_add_u32 m0, s21, 65536
v_mfma_f32_16x16x32_bf16 v[72:75], a[116:119], v[36:39], v[72:75]
buffer_load_dwordx4 v8, s[8:11], s20 offen lds
v_mfma_f32_16x16x32_bf16 v[76:79], a[112:115], v[40:43], v[76:79]
ds_read_b128 v[32:35], v17 offset:36864
v_mfma_f32_16x16x32_bf16 v[80:83], a[116:119], v[40:43], v[80:83]
s_waitcnt lgkmcnt(4)
v_mfma_f32_16x16x32_bf16 v[68:71], a[120:123], v[44:47], v[68:71]
ds_read_b128 v[36:39], v18 offset:32768
v_mfma_f32_16x16x32_bf16 v[72:75], a[124:127], v[44:47], v[72:75]
v_mfma_f32_16x16x32_bf16 v[76:79], a[120:123], v[48:51], v[76:79]
ds_read_b128 v[40:43], v18 offset:36864
s_add_u32 m0, s7, 1024
s_add_u32 s43, s48, 0x8001c00
buffer_load_dwordx4 v96, s[12:15], s43 offen sc1 lds
v_mfma_f32_16x16x32_bf16 v[80:83], a[124:127], v[48:51], v[80:83]
s_waitcnt lgkmcnt(4)
v_mfma_f32_16x16x32_bf16 v[68:71], a[128:131], v[20:23], v[68:71]
ds_read_b128 v[44:47], v19 offset:32768
s_add_u32 m0, s21, 66560
v_mfma_f32_16x16x32_bf16 v[72:75], a[132:135], v[20:23], v[72:75]
buffer_load_dwordx4 v9, s[8:11], s20 offen lds
v_mfma_f32_16x16x32_bf16 v[76:79], a[128:131], v[24:27], v[76:79]
ds_read_b128 v[48:51], v19 offset:36864
v_mfma_f32_16x16x32_bf16 v[80:83], a[132:135], v[24:27], v[80:83]
s_waitcnt lgkmcnt(4)
v_mfma_f32_16x16x32_bf16 v[68:71], a[136:139], v[28:31], v[68:71]
ds_read_b128 v[20:23], v16 offset:33024
v_mfma_f32_16x16x32_bf16 v[72:75], a[140:143], v[28:31], v[72:75]
v_mfma_f32_16x16x32_bf16 v[76:79], a[136:139], v[32:35], v[76:79]
ds_read_b128 v[24:27], v16 offset:37120
s_add_u32 m0, s7, 2048
s_add_u32 s43, s48, 0x8004c00
buffer_load_dwordx4 v96, s[12:15], s43 offen sc1 lds
v_mfma_f32_16x16x32_bf16 v[80:83], a[140:143], v[32:35], v[80:83]
s_waitcnt lgkmcnt(4)
v_mfma_f32_16x16x32_bf16 v[68:71], a[144:147], v[36:39], v[68:71]
ds_read_b128 v[28:31], v17 offset:33024
s_add_u32 m0, s21, 67584
v_mfma_f32_16x16x32_bf16 v[72:75], a[148:151], v[36:39], v[72:75]
buffer_load_dwordx4 v10, s[8:11], s20 offen lds
v_mfma_f32_16x16x32_bf16 v[76:79], a[144:147], v[40:43], v[76:79]
ds_read_b128 v[32:35], v17 offset:37120
v_mfma_f32_16x16x32_bf16 v[80:83], a[148:151], v[40:43], v[80:83]
s_waitcnt lgkmcnt(4)
v_mfma_f32_16x16x32_bf16 v[68:71], a[152:155], v[44:47], v[68:71]
ds_read_b128 v[36:39], v18 offset:33024
v_mfma_f32_16x16x32_bf16 v[72:75], a[156:159], v[44:47], v[72:75]
v_mfma_f32_16x16x32_bf16 v[76:79], a[152:155], v[48:51], v[76:79]
ds_read_b128 v[40:43], v18 offset:37120
v_mfma_f32_16x16x32_bf16 v[80:83], a[156:159], v[48:51], v[80:83]
s_waitcnt lgkmcnt(4)
v_mfma_f32_16x16x32_bf16 v[68:71], a[160:163], v[20:23], v[68:71]
ds_read_b128 v[44:47], v19 offset:33024
s_add_u32 m0, s21, 68608
v_mfma_f32_16x16x32_bf16 v[72:75], a[164:167], v[20:23], v[72:75]
buffer_load_dwordx4 v11, s[8:11], s20 offen lds
v_mfma_f32_16x16x32_bf16 v[76:79], a[160:163], v[24:27], v[76:79]
ds_read_b128 v[48:51], v19 offset:37120
v_mfma_f32_16x16x32_bf16 v[80:83], a[164:167], v[24:27], v[80:83]
s_waitcnt lgkmcnt(4)
s_add_u32 m0, s7, 3072
s_add_u32 s43, s48, 0x8005c00
buffer_load_dwordx4 v96, s[12:15], s43 offen sc1 lds
v_mfma_f32_16x16x32_bf16 v[68:71], a[168:171], v[28:31], v[68:71]
s_waitcnt vmcnt(47)
s_barrier
ds_read_b128 v[20:23], v16 offset:49152
v_mfma_f32_16x16x32_bf16 v[72:75], a[172:175], v[28:31], v[72:75]
s_add_u32 s20, s20, 512
v_mfma_f32_16x16x32_bf16 v[76:79], a[168:171], v[32:35], v[76:79]
ds_read_b128 v[24:27], v16 offset:53248
v_mfma_f32_16x16x32_bf16 v[80:83], a[172:175], v[32:35], v[80:83]
s_waitcnt lgkmcnt(4)
v_mfma_f32_16x16x32_bf16 v[68:71], a[176:179], v[36:39], v[68:71]
ds_read_b128 v[28:31], v17 offset:49152
s_add_u32 m0, s21, 81920
v_mfma_f32_16x16x32_bf16 v[72:75], a[180:183], v[36:39], v[72:75]
buffer_load_dwordx4 v8, s[8:11], s20 offen lds
v_mfma_f32_16x16x32_bf16 v[76:79], a[176:179], v[40:43], v[76:79]
ds_read_b128 v[32:35], v17 offset:53248
v_mfma_f32_16x16x32_bf16 v[80:83], a[180:183], v[40:43], v[80:83]
s_waitcnt lgkmcnt(4)
buffer_load_dword v87, v103, s[32:35], 0 offen sc1
v_mfma_f32_16x16x32_bf16 v[68:71], a[184:187], v[44:47], v[68:71]
ds_read_b128 v[36:39], v18 offset:49152
v_mfma_f32_16x16x32_bf16 v[72:75], a[188:191], v[44:47], v[72:75]
v_mfma_f32_16x16x32_bf16 v[76:79], a[184:187], v[48:51], v[76:79]
ds_read_b128 v[40:43], v18 offset:53248
v_mfma_f32_16x16x32_bf16 v[80:83], a[188:191], v[48:51], v[80:83]
s_waitcnt lgkmcnt(4)
v_mfma_f32_16x16x32_bf16 v[68:71], a[192:195], v[20:23], v[68:71]
ds_read_b128 v[44:47], v19 offset:49152
s_add_u32 m0, s21, 82944
v_mfma_f32_16x16x32_bf16 v[72:75], a[196:199], v[20:23], v[72:75]
buffer_load_dwordx4 v9, s[8:11], s20 offen lds
v_mfma_f32_16x16x32_bf16 v[76:79], a[192:195], v[24:27], v[76:79]
ds_read_b128 v[48:51], v19 offset:53248
v_mfma_f32_16x16x32_bf16 v[80:83], a[196:199], v[24:27], v[80:83]
s_waitcnt lgkmcnt(4)
v_mfma_f32_16x16x32_bf16 v[68:71], a[200:203], v[28:31], v[68:71]
ds_read_b128 v[20:23], v16 offset:49408
v_mfma_f32_16x16x32_bf16 v[72:75], a[204:207], v[28:31], v[72:75]
v_mfma_f32_16x16x32_bf16 v[76:79], a[200:203], v[32:35], v[76:79]
ds_read_b128 v[24:27], v16 offset:53504
v_mfma_f32_16x16x32_bf16 v[80:83], a[204:207], v[32:35], v[80:83]
s_waitcnt lgkmcnt(4)
v_mfma_f32_16x16x32_bf16 v[68:71], a[208:211], v[36:39], v[68:71]
ds_read_b128 v[28:31], v17 offset:49408
s_add_u32 m0, s21, 83968
v_mfma_f32_16x16x32_bf16 v[72:75], a[212:215], v[36:39], v[72:75]
buffer_load_dwordx4 v10, s[8:11], s20 offen lds
v_mfma_f32_16x16x32_bf16 v[76:79], a[208:211], v[40:43], v[76:79]
ds_read_b128 v[32:35], v17 offset:53504
v_mfma_f32_16x16x32_bf16 v[80:83], a[212:215], v[40:43], v[80:83]
s_waitcnt lgkmcnt(4)
v_mfma_f32_16x16x32_bf16 v[68:71], a[216:219], v[44:47], v[68:71]
ds_read_b128 v[36:39], v18 offset:49408
v_mfma_f32_16x16x32_bf16 v[72:75], a[220:223], v[44:47], v[72:75]
v_mfma_f32_16x16x32_bf16 v[76:79], a[216:219], v[48:51], v[76:79]
ds_read_b128 v[40:43], v18 offset:53504
v_mfma_f32_16x16x32_bf16 v[80:83], a[220:223], v[48:51], v[80:83]
s_waitcnt lgkmcnt(4)
v_mfma_f32_16x16x32_bf16 v[68:71], a[224:227], v[20:23], v[68:71]
ds_read_b128 v[44:47], v19 offset:49408
s_add_u32 m0, s21, 84992
v_mfma_f32_16x16x32_bf16 v[72:75], a[228:231], v[20:23], v[72:75]
buffer_load_dwordx4 v11, s[8:11], s20 offen lds
v_mfma_f32_16x16x32_bf16 v[76:79], a[224:227], v[24:27], v[76:79]
ds_read_b128 v[48:51], v19 offset:53504
v_mfma_f32_16x16x32_bf16 v[80:83], a[228:231], v[24:27], v[80:83]
s_waitcnt lgkmcnt(4)
v_mfma_f32_16x16x32_bf16 v[68:71], a[232:235], v[28:31], v[68:71]
s_waitcnt vmcnt(43)
s_barrier
ds_read_b128 v[20:23], v12 offset:0
v_mfma_f32_16x16x32_bf16 v[72:75], a[236:239], v[28:31], v[72:75]
s_add_u32 s20, s20, 512
v_mfma_f32_16x16x32_bf16 v[76:79], a[232:235], v[32:35], v[76:79]
ds_read_b128 v[24:27], v12 offset:4096
v_mfma_f32_16x16x32_bf16 v[80:83], a[236:239], v[32:35], v[80:83]
s_waitcnt lgkmcnt(4)
v_mfma_f32_16x16x32_bf16 v[68:71], a[240:243], v[36:39], v[68:71]
ds_read_b128 v[28:31], v13 offset:0
s_add_u32 m0, s21, 98304
v_mfma_f32_16x16x32_bf16 v[72:75], a[244:247], v[36:39], v[72:75]
buffer_load_dwordx4 v8, s[8:11], s20 offen lds
v_mfma_f32_16x16x32_bf16 v[76:79], a[240:243], v[40:43], v[76:79]
ds_read_b128 v[32:35], v13 offset:4096
v_mfma_f32_16x16x32_bf16 v[80:83], a[244:247], v[40:43], v[80:83]
s_waitcnt lgkmcnt(4)
v_mfma_f32_16x16x32_bf16 v[68:71], a[248:251], v[44:47], v[68:71]
ds_read_b128 v[36:39], v14 offset:0
v_mfma_f32_16x16x32_bf16 v[72:75], a[252:255], v[44:47], v[72:75]
v_mfma_f32_16x16x32_bf16 v[76:79], a[248:251], v[48:51], v[76:79]
ds_read_b128 v[40:43], v14 offset:4096
v_mfma_f32_16x16x32_bf16 v[80:83], a[252:255], v[48:51], v[80:83]
s_waitcnt lgkmcnt(4)
s_add_u32 s22, s22, 1
s_cmp_ge_u32 s22, s23
s_cbranch_scc0 L_st_468
s_branch L_fl1_465
L_st_469:
v_mfma_f32_16x16x32_bf16 v[52:55], a[0:3], v[20:23], 0
ds_read_b128 v[44:47], v15 offset:0
s_add_u32 m0, s21, 99328
s_sub_u32 s39, s22, 1
v_mfma_f32_16x16x32_bf16 v[56:59], a[4:7], v[20:23], 0
buffer_load_dwordx4 v9, s[8:11], s20 offen lds
v_mfma_f32_16x16x32_bf16 v[60:63], a[0:3], v[24:27], 0
ds_read_b128 v[48:51], v15 offset:4096
s_bitcmp1_b32 s39, 1
s_cselect_b32 s38, s54, s55
v_mfma_f32_16x16x32_bf16 v[64:67], a[4:7], v[24:27], 0
s_waitcnt lgkmcnt(4)
v_mfma_f32_16x16x32_bf16 v[52:55], a[8:11], v[28:31], v[52:55]
ds_read_b128 v[20:23], v12 offset:256
s_add_u32 s38, s38, s44
s_waitcnt vmcnt(5)
v_mfma_f32_16x16x32_bf16 v[56:59], a[12:15], v[28:31], v[56:59]
s_lshl_b32 s42, s39, 20
s_add_u32 s38, s38, s42
ds_write_b32 v101, v87
v_mfma_f32_16x16x32_bf16 v[60:63], a[8:11], v[32:35], v[60:63]
ds_read_b128 v[24:27], v12 offset:4352
s_cmp_eq_u32 s37, 0
s_cselect_b32 s38, 0x7ff00000, s38
v_mfma_f32_16x16x32_bf16 v[64:67], a[12:15], v[32:35], v[64:67]
s_waitcnt lgkmcnt(4)
v_mfma_f32_16x16x32_bf16 v[52:55], a[16:19], v[36:39], v[52:55]
ds_read_b128 v[28:31], v13 offset:256
s_add_u32 m0, s21, 100352
v_mfma_f32_16x16x32_bf16 v[56:59], a[20:23], v[36:39], v[56:59]
buffer_load_dwordx4 v10, s[8:11], s20 offen lds
s_mov_b32 s37, 1
v_mfma_f32_16x16x32_bf16 v[60:63], a[16:19], v[40:43], v[60:63]
ds_read_b128 v[32:35], v13 offset:4352
v_cvt_pk_bf16_f32 v88, v68, v69
v_mfma_f32_16x16x32_bf16 v[64:67], a[20:23], v[40:43], v[64:67]
s_waitcnt lgkmcnt(4)
v_cvt_pk_bf16_f32 v89, v70, v71
v_mfma_f32_16x16x32_bf16 v[52:55], a[24:27], v[44:47], v[52:55]
ds_read_b128 v[36:39], v14 offset:256
v_cvt_pk_bf16_f32 v90, v72, v73
v_mfma_f32_16x16x32_bf16 v[56:59], a[28:31], v[44:47], v[56:59]
v_cvt_pk_bf16_f32 v91, v74, v75
v_mfma_f32_16x16x32_bf16 v[60:63], a[24:27], v[48:51], v[60:63]
ds_read_b128 v[40:43], v14 offset:4352
buffer_store_dwordx4 v[88:91], v86, s[12:15], s38 offen offset:0
v_mfma_f32_16x16x32_bf16 v[64:67], a[28:31], v[48:51], v[64:67]
s_waitcnt lgkmcnt(4)
v_cvt_pk_bf16_f32 v92, v76, v77
v_cvt_pk_bf16_f32 v93, v78, v79
v_mfma_f32_16x16x32_bf16 v[52:55], a[32:35], v[20:23], v[52:55]
ds_read_b128 v[44:47], v15 offset:256
s_add_u32 m0, s21, 101376
v_mfma_f32_16x16x32_bf16 v[56:59], a[36:39], v[20:23], v[56:59]
buffer_load_dwordx4 v11, s[8:11], s20 offen lds
v_cvt_pk_bf16_f32 v94, v80, v81
v_mfma_f32_16x16x32_bf16 v[60:63], a[32:35], v[24:27], v[60:63]
ds_read_b128 v[48:51], v15 offset:4352
v_cvt_pk_bf16_f32 v95, v82, v83
v_mfma_f32_16x16x32_bf16 v[64:67], a[36:39], v[24:27], v[64:67]
s_waitcnt lgkmcnt(4)
buffer_store_dwordx4 v[92:95], v86, s[12:15], s38 offen offset:128
v_mfma_f32_16x16x32_bf16 v[52:55], a[40:43], v[28:31], v[52:55]
s_waitcnt vmcnt(27)
s_barrier
ds_read_b128 v[20:23], v12 offset:16384
v_mfma_f32_16x16x32_bf16 v[56:59], a[44:47], v[28:31], v[56:59]
s_add_u32 s20, s20, 512
v_mfma_f32_16x16x32_bf16 v[60:63], a[40:43], v[32:35], v[60:63]
ds_read_b128 v[24:27], v12 offset:20480
ds_read_b32 v87, v102
v_mfma_f32_16x16x32_bf16 v[64:67], a[44:47], v[32:35], v[64:67]
s_waitcnt lgkmcnt(4)
v_mfma_f32_16x16x32_bf16 v[52:55], a[48:51], v[36:39], v[52:55]
ds_read_b128 v[28:31], v13 offset:16384
s_add_u32 m0, s21, 114688
v_mfma_f32_16x16x32_bf16 v[56:59], a[52:55], v[36:39], v[56:59]
buffer_load_dwordx4 v8, s[8:11], s20 offen lds
v_mfma_f32_16x16x32_bf16 v[60:63], a[48:51], v[40:43], v[60:63]
ds_read_b128 v[32:35], v13 offset:20480
v_mfma_f32_16x16x32_bf16 v[64:67], a[52:55], v[40:43], v[64:67]
s_waitcnt lgkmcnt(4)
v_mfma_f32_16x16x32_bf16 v[52:55], a[56:59], v[44:47], v[52:55]
ds_read_b128 v[36:39], v14 offset:16384
v_mfma_f32_16x16x32_bf16 v[56:59], a[60:63], v[44:47], v[56:59]
v_mfma_f32_16x16x32_bf16 v[60:63], a[56:59], v[48:51], v[60:63]
ds_read_b128 v[40:43], v14 offset:20480
v_mfma_f32_16x16x32_bf16 v[64:67], a[60:63], v[48:51], v[64:67]
s_waitcnt lgkmcnt(4)
v_mfma_f32_16x16x32_bf16 v[52:55], a[64:67], v[20:23], v[52:55]
ds_read_b128 v[44:47], v15 offset:16384
s_add_u32 m0, s21, 115712
v_mfma_f32_16x16x32_bf16 v[56:59], a[68:71], v[20:23], v[56:59]
buffer_load_dwordx4 v9, s[8:11], s20 offen lds
v_mfma_f32_16x16x32_bf16 v[60:63], a[64:67], v[24:27], v[60:63]
ds_read_b128 v[48:51], v15 offset:20480
s_branch L_anext_459
L_attr_462:
v_mfma_f32_16x16x32_bf16 v[64:67], a[68:71], v[24:27], v[64:67]
s_waitcnt lgkmcnt(4)
s_add_u32 s43, s94, 0
buffer_store_dwordx4 v[168:171], v100, s[12:15], s43 offen offset:2048 sc1
v_mfma_f32_16x16x32_bf16 v[52:55], a[72:75], v[28:31], v[52:55]
ds_read_b128 v[20:23], v12 offset:16640
v_mfma_f32_16x16x32_bf16 v[56:59], a[76:79], v[28:31], v[56:59]
v_mfma_f32_16x16x32_bf16 v[60:63], a[72:75], v[32:35], v[60:63]
ds_read_b128 v[24:27], v12 offset:20736
s_add_u32 s24, s24, 1
v_mfma_f32_16x16x32_bf16 v[64:67], a[76:79], v[32:35], v[64:67]
s_waitcnt lgkmcnt(4)
v_mfma_f32_16x16x32_bf16 v[52:55], a[80:83], v[36:39], v[52:55]
ds_read_b128 v[28:31], v13 offset:16640
s_add_u32 m0, s21, 116736
v_mfma_f32_16x16x32_bf16 v[56:59], a[84:87], v[36:39], v[56:59]
buffer_load_dwordx4 v10, s[8:11], s20 offen lds
v_mfma_f32_16x16x32_bf16 v[60:63], a[80:83], v[40:43], v[60:63]
ds_read_b128 v[32:35], v13 offset:20736
v_mfma_f32_16x16x32_bf16 v[64:67], a[84:87], v[40:43], v[64:67]
s_waitcnt lgkmcnt(4)
s_min_u32 s24, s24, 63
v_mfma_f32_16x16x32_bf16 v[52:55], a[88:91], v[44:47], v[52:55]
ds_read_b128 v[36:39], v14 offset:16640
v_mfma_f32_16x16x32_bf16 v[56:59], a[92:95], v[44:47], v[56:59]
s_lshl_b32 s53, s24, 16
v_mfma_f32_16x16x32_bf16 v[60:63], a[88:91], v[48:51], v[60:63]
ds_read_b128 v[40:43], v14 offset:20736
s_add_u32 s43, s94, 0
buffer_store_dwordx4 v[172:175], v100, s[12:15], s43 offen offset:2560 sc1
v_mfma_f32_16x16x32_bf16 v[64:67], a[92:95], v[48:51], v[64:67]
s_waitcnt lgkmcnt(4)
v_mfma_f32_16x16x32_bf16 v[52:55], a[96:99], v[20:23], v[52:55]
ds_read_b128 v[44:47], v15 offset:16640
s_add_u32 m0, s21, 117760
v_mfma_f32_16x16x32_bf16 v[56:59], a[100:103], v[20:23], v[56:59]
buffer_load_dwordx4 v11, s[8:11], s20 offen lds
v_mfma_f32_16x16x32_bf16 v[60:63], a[96:99], v[24:27], v[60:63]
ds_read_b128 v[48:51], v15 offset:20736
v_mfma_f32_16x16x32_bf16 v[64:67], a[100:103], v[24:27], v[64:67]
s_waitcnt lgkmcnt(4)
v_mfma_f32_16x16x32_bf16 v[52:55], a[104:107], v[28:31], v[52:55]
s_waitcnt vmcnt(26)
s_barrier
ds_read_b128 v[20:23], v12 offset:32768
v_mfma_f32_16x16x32_bf16 v[56:59], a[108:111], v[28:31], v[56:59]
s_mov_b32 s20, s53
v_mfma_f32_16x16x32_bf16 v[60:63], a[104:107], v[32:35], v[60:63]
ds_read_b128 v[24:27], v12 offset:36864
v_mfma_f32_16x16x32_bf16 v[64:67], a[108:111], v[32:35], v[64:67]
s_waitcnt lgkmcnt(4)
v_mfma_f32_16x16x32_bf16 v[52:55], a[112:115], v[36:39], v[52:55]
ds_read_b128 v[28:31], v13 offset:32768
s_add_u32 m0, s21, 0
v_mfma_f32_16x16x32_bf16 v[56:59], a[116:119], v[36:39], v[56:59]
buffer_load_dwordx4 v8, s[8:11], s20 offen lds
v_mfma_f32_16x16x32_bf16 v[60:63], a[112:115], v[40:43], v[60:63]
ds_read_b128 v[32:35], v13 offset:36864
v_mfma_f32_16x16x32_bf16 v[64:67], a[116:119], v[40:43], v[64:67]
s_waitcnt lgkmcnt(4)
s_add_u32 s43, s94, 4096
buffer_store_dwordx4 v[176:179], v100, s[12:15], s43 offen offset:0 sc1
v_mfma_f32_16x16x32_bf16 v[52:55], a[120:123], v[44:47], v[52:55]
ds_read_b128 v[36:39], v14 offset:32768
v_mfma_f32_16x16x32_bf16 v[56:59], a[124:127], v[44:47], v[56:59]
v_mfma_f32_16x16x32_bf16 v[60:63], a[120:123], v[48:51], v[60:63]
ds_read_b128 v[40:43], v14 offset:36864
v_mfma_f32_16x16x32_bf16 v[64:67], a[124:127], v[48:51], v[64:67]
s_waitcnt lgkmcnt(4)
v_mfma_f32_16x16x32_bf16 v[52:55], a[128:131], v[20:23], v[52:55]
ds_read_b128 v[44:47], v15 offset:32768
s_add_u32 m0, s21, 1024
v_mfma_f32_16x16x32_bf16 v[56:59], a[132:135], v[20:23], v[56:59]
buffer_load_dwordx4 v9, s[8:11], s20 offen lds
v_mfma_f32_16x16x32_bf16 v[60:63], a[128:131], v[24:27], v[60:63]
ds_read_b128 v[48:51], v15 offset:36864
v_mfma_f32_16x16x32_bf16 v[64:67], a[132:135], v[24:27], v[64:67]
s_waitcnt lgkmcnt(4)
v_mfma_f32_16x16x32_bf16 v[52:55], a[136:139], v[28:31], v[52:55]
ds_read_b128 v[20:23], v12 offset:33024
v_mfma_f32_16x16x32_bf16 v[56:59], a[140:143], v[28:31], v[56:59]
v_mfma_f32_16x16x32_bf16 v[60:63], a[136:139], v[32:35], v[60:63]
ds_read_b128 v[24:27], v12 offset:37120
s_add_u32 s43, s94, 4096
buffer_store_dwordx4 v[180:183], v100, s[12:15], s43 offen offset:512 sc1
v_mfma_f32_16x16x32_bf16 v[64:67], a[140:143], v[32:35], v[64:67]
s_waitcnt lgkmcnt(4)
v_mfma_f32_16x16x32_bf16 v[52:55], a[144:147], v[36:39], v[52:55]
ds_read_b128 v[28:31], v13 offset:33024
s_add_u32 m0, s21, 2048
v_mfma_f32_16x16x32_bf16 v[56:59], a[148:151], v[36:39], v[56:59]
buffer_load_dwordx4 v10, s[8:11], s20 offen lds
v_mfma_f32_16x16x32_bf16 v[60:63], a[144:147], v[40:43], v[60:63]
ds_read_b128 v[32:35], v13 offset:37120
v_mfma_f32_16x16x32_bf16 v[64:67], a[148:151], v[40:43], v[64:67]
s_waitcnt lgkmcnt(4)
v_mfma_f32_16x16x32_bf16 v[52:55], a[152:155], v[44:47], v[52:55]
ds_read_b128 v[36:39], v14 offset:33024
v_mfma_f32_16x16x32_bf16 v[56:59], a[156:159], v[44:47], v[56:59]
v_mfma_f32_16x16x32_bf16 v[60:63], a[152:155], v[48:51], v[60:63]
ds_read_b128 v[40:43], v14 offset:37120
v_mfma_f32_16x16x32_bf16 v[64:67], a[156:159], v[48:51], v[64:67]
s_waitcnt lgkmcnt(4)
v_mfma_f32_16x16x32_bf16 v[52:55], a[160:163], v[20:23], v[52:55]
ds_read_b128 v[44:47], v15 offset:33024
s_add_u32 m0, s21, 3072
v_mfma_f32_16x16x32_bf16 v[56:59], a[164:167], v[20:23], v[56:59]
buffer_load_dwordx4 v11, s[8:11], s20 offen lds
v_mfma_f32_16x16x32_bf16 v[60:63], a[160:163], v[24:27], v[60:63]
ds_read_b128 v[48:51], v15 offset:37120
v_mfma_f32_16x16x32_bf16 v[64:67], a[164:167], v[24:27], v[64:67]
s_waitcnt lgkmcnt(4)
s_add_u32 s43, s94, 16384
buffer_store_dwordx4 v[184:187], v100, s[12:15], s43 offen offset:2048 sc1
v_mfma_f32_16x16x32_bf16 v[52:55], a[168:171], v[28:31], v[52:55]
s_waitcnt vmcnt(28)
s_barrier
ds_read_b128 v[20:23], v12 offset:49152
v_mfma_f32_16x16x32_bf16 v[56:59], a[172:175], v[28:31], v[56:59]
s_add_u32 s20, s20, 512
v_mfma_f32_16x16x32_bf16 v[60:63], a[168:171], v[32:35], v[60:63]
ds_read_b128 v[24:27], v12 offset:53248
v_mfma_f32_16x16x32_bf16 v[64:67], a[172:175], v[32:35], v[64:67]
s_waitcnt lgkmcnt(4)
v_mfma_f32_16x16x32_bf16 v[52:55], a[176:179], v[36:39], v[52:55]
ds_read_b128 v[28:31], v13 offset:49152
s_add_u32 m0, s21, 16384
v_mfma_f32_16x16x32_bf16 v[56:59], a[180:183], v[36:39], v[56:59]
buffer_load_dwordx4 v8, s[8:11], s20 offen lds
v_mfma_f32_16x16x32_bf16 v[60:63], a[176:179], v[40:43], v[60:63]
ds_read_b128 v[32:35], v13 offset:53248
v_mfma_f32_16x16x32_bf16 v[64:67], a[180:183], v[40:43], v[64:67]
s_waitcnt lgkmcnt(4)
s_add_u32 s43, s94, 16384
buffer_store_dwordx4 v[188:191], v100, s[12:15], s43 offen offset:2560 sc1
v_mfma_f32_16x16x32_bf16 v[52:55], a[184:187], v[44:47], v[52:55]
ds_read_b128 v[36:39], v14 offset:49152
v_mfma_f32_16x16x32_bf16 v[56:59], a[188:191], v[44:47], v[56:59]
v_mfma_f32_16x16x32_bf16 v[60:63], a[184:187], v[48:51], v[60:63]
ds_read_b128 v[40:43], v14 offset:53248
v_mfma_f32_16x16x32_bf16 v[64:67], a[188:191], v[48:51], v[64:67]
s_waitcnt lgkmcnt(4)
v_mfma_f32_16x16x32_bf16 v[52:55], a[192:195], v[20:23], v[52:55]
ds_read_b128 v[44:47], v15 offset:49152
s_add_u32 m0, s21, 17408
v_mfma_f32_16x16x32_bf16 v[56:59], a[196:199], v[20:23], v[56:59]
buffer_load_dwordx4 v9, s[8:11], s20 offen lds
v_mfma_f32_16x16x32_bf16 v[60:63], a[192:195], v[24:27], v[60:63]
ds_read_b128 v[48:51], v15 offset:53248
v_mfma_f32_16x16x32_bf16 v[64:67], a[196:199], v[24:27], v[64:67]
s_waitcnt lgkmcnt(4)
v_mfma_f32_16x16x32_bf16 v[52:55], a[200:203], v[28:31], v[52:55]
ds_read_b128 v[20:23], v12 offset:49408
v_mfma_f32_16x16x32_bf16 v[56:59], a[204:207], v[28:31], v[56:59]
v_mfma_f32_16x16x32_bf16 v[60:63], a[200:203], v[32:35], v[60:63]
ds_read_b128 v[24:27], v12 offset:53504
s_add_u32 s43, s94, 20480
buffer_store_dwordx4 v[192:195], v100, s[12:15], s43 offen offset:0 sc1
v_mfma_f32_16x16x32_bf16 v[64:67], a[204:207], v[32:35], v[64:67]
s_waitcnt lgkmcnt(4)
v_mfma_f32_16x16x32_bf16 v[52:55], a[208:211], v[36:39], v[52:55]
ds_read_b128 v[28:31], v13 offset:49408
s_add_u32 m0, s21, 18432
v_mfma_f32_16x16x32_bf16 v[56:59], a[212:215], v[36:39], v[56:59]
buffer_load_dwordx4 v10, s[8:11], s20 offen lds
v_mfma_f32_16x16x32_bf16 v[60:63], a[208:211], v[40:43], v[60:63]
ds_read_b128 v[32:35], v13 offset:53504
v_mfma_f32_16x16x32_bf16 v[64:67], a[212:215], v[40:43], v[64:67]
s_waitcnt lgkmcnt(4)
v_mfma_f32_16x16x32_bf16 v[52:55], a[216:219], v[44:47], v[52:55]
ds_read_b128 v[36:39], v14 offset:49408
v_mfma_f32_16x16x32_bf16 v[56:59], a[220:223], v[44:47], v[56:59]
v_mfma_f32_16x16x32_bf16 v[60:63], a[216:219], v[48:51], v[60:63]
ds_read_b128 v[40:43], v14 offset:53504
v_mfma_f32_16x16x32_bf16 v[64:67], a[220:223], v[48:51], v[64:67]
s_waitcnt lgkmcnt(4)
v_mfma_f32_16x16x32_bf16 v[52:55], a[224:227], v[20:23], v[52:55]
ds_read_b128 v[44:47], v15 offset:49408
s_add_u32 m0, s21, 19456
v_mfma_f32_16x16x32_bf16 v[56:59], a[228:231], v[20:23], v[56:59]
buffer_load_dwordx4 v11, s[8:11], s20 offen lds
v_mfma_f32_16x16x32_bf16 v[60:63], a[224:227], v[24:27], v[60:63]
ds_read_b128 v[48:51], v15 offset:53504
v_mfma_f32_16x16x32_bf16 v[64:67], a[228:231], v[24:27], v[64:67]
s_waitcnt lgkmcnt(4)
s_add_u32 s43, s94, 20480
buffer_store_dwordx4 v[196:199], v100, s[12:15], s43 offen offset:512 sc1
v_mfma_f32_16x16x32_bf16 v[52:55], a[232:235], v[28:31], v[52:55]
s_waitcnt vmcnt(31)
s_barrier
ds_read_b128 v[20:23], v16 offset:0
v_mfma_f32_16x16x32_bf16 v[56:59], a[236:239], v[28:31], v[56:59]
s_add_u32 s20, s20, 512
v_mfma_f32_16x16x32_bf16 v[60:63], a[232:235], v[32:35], v[60:63]
ds_read_b128 v[24:27], v16 offset:4096
v_mfma_f32_16x16x32_bf16 v[64:67], a[236:239], v[32:35], v[64:67]
s_waitcnt lgkmcnt(4)
v_mfma_f32_16x16x32_bf16 v[52:55], a[240:243], v[36:39], v[52:55]
ds_read_b128 v[28:31], v17 offset:0
s_add_u32 m0, s21, 32768
v_mfma_f32_16x16x32_bf16 v[56:59], a[244:247], v[36:39], v[56:59]
buffer_load_dwordx4 v8, s[8:11], s20 offen lds
v_mfma_f32_16x16x32_bf16 v[60:63], a[240:243], v[40:43], v[60:63]
ds_read_b128 v[32:35], v17 offset:4096
v_mfma_f32_16x16x32_bf16 v[64:67], a[244:247], v[40:43], v[64:67]
s_waitcnt lgkmcnt(4)
v_mfma_f32_16x16x32_bf16 v[52:55], a[248:251], v[44:47], v[52:55]
ds_read_b128 v[36:39], v18 offset:0
v_mfma_f32_16x16x32_bf16 v[56:59], a[252:255], v[44:47], v[56:59]
v_mfma_f32_16x16x32_bf16 v[60:63], a[248:251], v[48:51], v[60:63]
ds_read_b128 v[40:43], v18 offset:4096
v_mfma_f32_16x16x32_bf16 v[64:67], a[252:255], v[48:51], v[64:67]
s_waitcnt lgkmcnt(4)
s_add_u32 s22, s22, 1
s_cmp_ge_u32 s22, s23
s_cbranch_scc1 L_fl0_464
v_mfma_f32_16x16x32_bf16 v[68:71], a[0:3], v[20:23], 0
ds_read_b128 v[44:47], v19 offset:0
s_add_u32 m0, s21, 33792
s_sub_u32 s39, s22, 1
v_mfma_f32_16x16x32_bf16 v[72:75], a[4:7], v[20:23], 0
buffer_load_dwordx4 v9, s[8:11], s20 offen lds
v_mfma_f32_16x16x32_bf16 v[76:79], a[0:3], v[24:27], 0
ds_read_b128 v[48:51], v19 offset:4096
s_bitcmp1_b32 s39, 1
s_cselect_b32 s38, s54, s55
v_mfma_f32_16x16x32_bf16 v[80:83], a[4:7], v[24:27], 0
s_waitcnt lgkmcnt(4)
v_mfma_f32_16x16x32_bf16 v[68:71], a[8:11], v[28:31], v[68:71]
ds_read_b128 v[20:23], v16 offset:256
s_add_u32 s38, s38, s44
v_mfma_f32_16x16x32_bf16 v[72:75], a[12:15], v[28:31], v[72:75]
s_lshl_b32 s42, s39, 20
s_add_u32 s38, s38, s42
v_mfma_f32_16x16x32_bf16 v[76:79], a[8:11], v[32:35], v[76:79]
ds_read_b128 v[24:27], v16 offset:4352
s_cmp_eq_u32 s37, 0
s_cselect_b32 s38, 0x7ff00000, s38
v_mfma_f32_16x16x32_bf16 v[80:83], a[12:15], v[32:35], v[80:83]
s_waitcnt lgkmcnt(4)
v_mfma_f32_16x16x32_bf16 v[68:71], a[16:19], v[36:39], v[68:71]
ds_read_b128 v[28:31], v17 offset:256
s_add_u32 m0, s21, 34816
v_mfma_f32_16x16x32_bf16 v[72:75], a[20:23], v[36:39], v[72:75]
buffer_load_dwordx4 v10, s[8:11], s20 offen lds
s_mov_b32 s37, 1
v_mfma_f32_16x16x32_bf16 v[76:79], a[16:19], v[40:43], v[76:79]
ds_read_b128 v[32:35], v17 offset:4352
v_cvt_pk_bf16_f32 v88, v52, v53
v_mfma_f32_16x16x32_bf16 v[80:83], a[20:23], v[40:43], v[80:83]
s_waitcnt lgkmcnt(4)
v_cvt_pk_bf16_f32 v89, v54, v55
v_mfma_f32_16x16x32_bf16 v[68:71], a[24:27], v[44:47], v[68:71]
ds_read_b128 v[36:39], v18 offset:256
v_cvt_pk_bf16_f32 v90, v56, v57
v_mfma_f32_16x16x32_bf16 v[72:75], a[28:31], v[44:47], v[72:75]
v_cvt_pk_bf16_f32 v91, v58, v59
v_mfma_f32_16x16x32_bf16 v[76:79], a[24:27], v[48:51], v[76:79]
ds_read_b128 v[40:43], v18 offset:4352
buffer_store_dwordx4 v[88:91], v86, s[12:15], s38 offen offset:0
v_mfma_f32_16x16x32_bf16 v[80:83], a[28:31], v[48:51], v[80:83]
s_waitcnt lgkmcnt(4)
v_cvt_pk_bf16_f32 v92, v60, v61
v_cvt_pk_bf16_f32 v93, v62, v63
v_mfma_f32_16x16x32_bf16 v[68:71], a[32:35], v[20:23], v[68:71]
ds_read_b128 v[44:47], v19 offset:256
s_add_u32 m0, s21, 35840
v_mfma_f32_16x16x32_bf16 v[72:75], a[36:39], v[20:23], v[72:75]
buffer_load_dwordx4 v11, s[8:11], s20 offen lds
v_cvt_pk_bf16_f32 v94, v64, v65
v_mfma_f32_16x16x32_bf16 v[76:79], a[32:35], v[24:27], v[76:79]
ds_read_b128 v[48:51], v19 offset:4352
v_cvt_pk_bf16_f32 v95, v66, v67
v_mfma_f32_16x16x32_bf16 v[80:83], a[36:39], v[24:27], v[80:83]
s_waitcnt lgkmcnt(4)
buffer_store_dwordx4 v[92:95], v86, s[12:15], s38 offen offset:128
v_mfma_f32_16x16x32_bf16 v[68:71], a[40:43], v[28:31], v[68:71]
s_waitcnt vmcnt(32)
s_barrier
ds_read_b128 v[20:23], v16 offset:16384
v_mfma_f32_16x16x32_bf16 v[72:75], a[44:47], v[28:31], v[72:75]
s_add_u32 s20, s20, 512
v_mfma_f32_16x16x32_bf16 v[76:79], a[40:43], v[32:35], v[76:79]
ds_read_b128 v[24:27], v16 offset:20480
v_mfma_f32_16x16x32_bf16 v[80:83], a[44:47], v[32:35], v[80:83]
s_waitcnt lgkmcnt(4)
v_mfma_f32_16x16x32_bf16 v[68:71], a[48:51], v[36:39], v[68:71]
ds_read_b128 v[28:31], v17 offset:16384
s_add_u32 m0, s21, 49152
v_mfma_f32_16x16x32_bf16 v[72:75], a[52:55], v[36:39], v[72:75]
buffer_load_dwordx4 v8, s[8:11], s20 offen lds
v_mfma_f32_16x16x32_bf16 v[76:79], a[48:51], v[40:43], v[76:79]
ds_read_b128 v[32:35], v17 offset:20480
v_mfma_f32_16x16x32_bf16 v[80:83], a[52:55], v[40:43], v[80:83]
s_waitcnt lgkmcnt(4)
v_mfma_f32_16x16x32_bf16 v[68:71], a[56:59], v[44:47], v[68:71]
ds_read_b128 v[36:39], v18 offset:16384
v_mfma_f32_16x16x32_bf16 v[72:75], a[60:63], v[44:47], v[72:75]
v_mfma_f32_16x16x32_bf16 v[76:79], a[56:59], v[48:51], v[76:79]
ds_read_b128 v[40:43], v18 offset:20480
v_mfma_f32_16x16x32_bf16 v[80:83], a[60:63], v[48:51], v[80:83]
s_waitcnt lgkmcnt(4)
v_mfma_f32_16x16x32_bf16 v[68:71], a[64:67], v[20:23], v[68:71]
ds_read_b128 v[44:47], v19 offset:16384
s_add_u32 m0, s21, 50176
v_mfma_f32_16x16x32_bf16 v[72:75], a[68:71], v[20:23], v[72:75]
buffer_load_dwordx4 v9, s[8:11], s20 offen lds
v_mfma_f32_16x16x32_bf16 v[76:79], a[64:67], v[24:27], v[76:79]
ds_read_b128 v[48:51], v19 offset:20480
v_mfma_f32_16x16x32_bf16 v[80:83], a[68:71], v[24:27], v[80:83]
s_waitcnt lgkmcnt(4)
v_mfma_f32_16x16x32_bf16 v[68:71], a[72:75], v[28:31], v[68:71]
ds_read_b128 v[20:23], v16 offset:16640
v_mfma_f32_16x16x32_bf16 v[72:75], a[76:79], v[28:31], v[72:75]
v_mfma_f32_16x16x32_bf16 v[76:79], a[72:75], v[32:35], v[76:79]
ds_read_b128 v[24:27], v16 offset:20736
s_add_u32 s24, s24, 1
v_mfma_f32_16x16x32_bf16 v[80:83], a[76:79], v[32:35], v[80:83]
s_waitcnt lgkmcnt(4)
v_mfma_f32_16x16x32_bf16 v[68:71], a[80:83], v[36:39], v[68:71]
ds_read_b128 v[28:31], v17 offset:16640
s_add_u32 m0, s21, 51200
v_mfma_f32_16x16x32_bf16 v[72:75], a[84:87], v[36:39], v[72:75]
buffer_load_dwordx4 v10, s[8:11], s20 offen lds
v_mfma_f32_16x16x32_bf16 v[76:79], a[80:83], v[40:43], v[76:79]
ds_read_b128 v[32:35], v17 offset:20736
v_mfma_f32_16x16x32_bf16 v[80:83], a[84:87], v[40:43], v[80:83]
s_waitcnt lgkmcnt(4)
s_min_u32 s24, s24, 63
v_mfma_f32_16x16x32_bf16 v[68:71], a[88:91], v[44:47], v[68:71]
ds_read_b128 v[36:39], v18 offset:16640
v_mfma_f32_16x16x32_bf16 v[72:75], a[92:95], v[44:47], v[72:75]
v_mfma_f32_16x16x32_bf16 v[76:79], a[88:91], v[48:51], v[76:79]
ds_read_b128 v[40:43], v18 offset:20736
s_lshl_b32 s53, s24, 16
v_mfma_f32_16x16x32_bf16 v[80:83], a[92:95], v[48:51], v[80:83]
s_waitcnt lgkmcnt(4)
v_mfma_f32_16x16x32_bf16 v[68:71], a[96:99], v[20:23], v[68:71]
ds_read_b128 v[44:47], v19 offset:16640
s_add_u32 m0, s21, 52224
v_mfma_f32_16x16x32_bf16 v[72:75], a[100:103], v[20:23], v[72:75]
buffer_load_dwordx4 v11, s[8:11], s20 offen lds
v_mfma_f32_16x16x32_bf16 v[76:79], a[96:99], v[24:27], v[76:79]
ds_read_b128 v[48:51], v19 offset:20736
s_waitcnt vmcnt(10)
v_mfma_f32_16x16x32_bf16 v[80:83], a[100:103], v[24:27], v[80:83]
s_waitcnt lgkmcnt(4)
v_mfma_f32_16x16x32_bf16 v[68:71], a[104:107], v[28:31], v[68:71]
s_waitcnt vmcnt(31)
s_barrier
ds_read_b128 v[20:23], v16 offset:32768
v_mfma_f32_16x16x32_bf16 v[72:75], a[108:111], v[28:31], v[72:75]
s_mov_b32 s20, s53
v_mfma_f32_16x16x32_bf16 v[76:79], a[104:107], v[32:35], v[76:79]
ds_read_b128 v[24:27], v16 offset:36864
buffer_atomic_add v84, v85, s[12:15], s51 offen sc1
v_mfma_f32_16x16x32_bf16 v[80:83], a[108:111], v[32:35], v[80:83]
s_waitcnt lgkmcnt(4)
v_mfma_f32_16x16x32_bf16 v[68:71], a[112:115], v[36:39], v[68:71]
ds_read_b128 v[28:31], v17 offset:32768
s_add_u32 m0, s21, 65536
v_mfma_f32_16x16x32_bf16 v[72:75], a[116:119], v[36:39], v[72:75]
buffer_load_dwordx4 v8, s[8:11], s20 offen lds
v_mfma_f32_16x16x32_bf16 v[76:79], a[112:115], v[40:43], v[76:79]
ds_read_b128 v[32:35], v17 offset:36864
v_mfma_f32_16x16x32_bf16 v[80:83], a[116:119], v[40:43], v[80:83]
s_waitcnt lgkmcnt(4)
v_mfma_f32_16x16x32_bf16 v[68:71], a[120:123], v[44:47], v[68:71]
ds_read_b128 v[36:39], v18 offset:32768
v_mfma_f32_16x16x32_bf16 v[72:75], a[124:127], v[44:47], v[72:75]
v_mfma_f32_16x16x32_bf16 v[76:79], a[120:123], v[48:51], v[76:79]
ds_read_b128 v[40:43], v18 offset:36864
v_mfma_f32_16x16x32_bf16 v[80:83], a[124:127], v[48:51], v[80:83]
s_waitcnt lgkmcnt(4)
v_mfma_f32_16x16x32_bf16 v[68:71], a[128:131], v[20:23], v[68:71]
ds_read_b128 v[44:47], v19 offset:32768
s_add_u32 m0, s21, 66560
v_mfma_f32_16x16x32_bf16 v[72:75], a[132:135], v[20:23], v[72:75]
buffer_load_dwordx4 v9, s[8:11], s20 offen lds
v_mfma_f32_16x16x32_bf16 v[76:79], a[128:131], v[24:27], v[76:79]
ds_read_b128 v[48:51], v19 offset:36864
v_mfma_f32_16x16x32_bf16 v[80:83], a[132:135], v[24:27], v[80:83]
s_waitcnt lgkmcnt(4)
v_mfma_f32_16x16x32_bf16 v[68:71], a[136:139], v[28:31], v[68:71]
ds_read_b128 v[20:23], v16 offset:33024
v_mfma_f32_16x16x32_bf16 v[72:75], a[140:143], v[28:31], v[72:75]
v_mfma_f32_16x16x32_bf16 v[76:79], a[136:139], v[32:35], v[76:79]
ds_read_b128 v[24:27], v16 offset:37120
v_mfma_f32_16x16x32_bf16 v[80:83], a[140:143], v[32:35], v[80:83]
s_waitcnt lgkmcnt(4)
v_mfma_f32_16x16x32_bf16 v[68:71], a[144:147], v[36:39], v[68:71]
ds_read_b128 v[28:31], v17 offset:33024
s_add_u32 m0, s21, 67584
v_mfma_f32_16x16x32_bf16 v[72:75], a[148:151], v[36:39], v[72:75]
buffer_load_dwordx4 v10, s[8:11], s20 offen lds
v_mfma_f32_16x16x32_bf16 v[76:79], a[144:147], v[40:43], v[76:79]
ds_read_b128 v[32:35], v17 offset:37120
v_mfma_f32_16x16x32_bf16 v[80:83], a[148:151], v[40:43], v[80:83]
s_waitcnt lgkmcnt(4)
v_mfma_f32_16x16x32_bf16 v[68:71], a[152:155], v[44:47], v[68:71]
ds_read_b128 v[36:39], v18 offset:33024
v_mfma_f32_16x16x32_bf16 v[72:75], a[156:159], v[44:47], v[72:75]
v_mfma_f32_16x16x32_bf16 v[76:79], a[152:155], v[48:51], v[76:79]
ds_read_b128 v[40:43], v18 offset:37120
v_mfma_f32_16x16x32_bf16 v[80:83], a[156:159], v[48:51], v[80:83]
s_waitcnt lgkmcnt(4)
v_mfma_f32_16x16x32_bf16 v[68:71], a[160:163], v[20:23], v[68:71]
ds_read_b128 v[44:47], v19 offset:33024
s_add_u32 m0, s21, 68608
v_mfma_f32_16x16x32_bf16 v[72:75], a[164:167], v[20:23], v[72:75]
buffer_load_dwordx4 v11, s[8:11], s20 offen lds
v_mfma_f32_16x16x32_bf16 v[76:79], a[160:163], v[24:27], v[76:79]
ds_read_b128 v[48:51], v19 offset:37120
v_mfma_f32_16x16x32_bf16 v[80:83], a[164:167], v[24:27], v[80:83]
s_waitcnt lgkmcnt(4)
v_mfma_f32_16x16x32_bf16 v[68:71], a[168:171], v[28:31], v[68:71]
s_waitcnt vmcnt(29)
s_barrier
ds_read_b128 v[20:23], v16 offset:49152
v_mfma_f32_16x16x32_bf16 v[72:75], a[172:175], v[28:31], v[72:75]
s_add_u32 s20, s20, 512
v_mfma_f32_16x16x32_bf16 v[76:79], a[168:171], v[32:35], v[76:79]
ds_read_b128 v[24:27], v16 offset:53248
v_mfma_f32_16x16x32_bf16 v[80:83], a[172:175], v[32:35], v[80:83]
s_waitcnt lgkmcnt(4)
v_mfma_f32_16x16x32_bf16 v[68:71], a[176:179], v[36:39], v[68:71]
ds_read_b128 v[28:31], v17 offset:49152
s_add_u32 m0, s21, 81920
v_mfma_f32_16x16x32_bf16 v[72:75], a[180:183], v[36:39], v[72:75]
buffer_load_dwordx4 v8, s[8:11], s20 offen lds
v_mfma_f32_16x16x32_bf16 v[76:79], a[176:179], v[40:43], v[76:79]
ds_read_b128 v[32:35], v17 offset:53248
v_mfma_f32_16x16x32_bf16 v[80:83], a[180:183], v[40:43], v[80:83]
s_waitcnt lgkmcnt(4)
buffer_load_dword v87, v103, s[32:35], 0 offen sc1
v_mfma_f32_16x16x32_bf16 v[68:71], a[184:187], v[44:47], v[68:71]
ds_read_b128 v[36:39], v18 offset:49152
v_mfma_f32_16x16x32_bf16 v[72:75], a[188:191], v[44:47], v[72:75]
v_mfma_f32_16x16x32_bf16 v[76:79], a[184:187], v[48:51], v[76:79]
ds_read_b128 v[40:43], v18 offset:53248
v_mfma_f32_16x16x32_bf16 v[80:83], a[188:191], v[48:51], v[80:83]
s_waitcnt lgkmcnt(4)
v_mfma_f32_16x16x32_bf16 v[68:71], a[192:195], v[20:23], v[68:71]
ds_read_b128 v[44:47], v19 offset:49152
s_add_u32 m0, s21, 82944
v_mfma_f32_16x16x32_bf16 v[72:75], a[196:199], v[20:23], v[72:75]
buffer_load_dwordx4 v9, s[8:11], s20 offen lds
v_mfma_f32_16x16x32_bf16 v[76:79], a[192:195], v[24:27], v[76:79]
ds_read_b128 v[48:51], v19 offset:53248
v_mfma_f32_16x16x32_bf16 v[80:83], a[196:199], v[24:27], v[80:83]
s_waitcnt lgkmcnt(4)
v_mfma_f32_16x16x32_bf16 v[68:71], a[200:203], v[28:31], v[68:71]
ds_read_b128 v[20:23], v16 offset:49408
v_mfma_f32_16x16x32_bf16 v[72:75], a[204:207], v[28:31], v[72:75]
v_mfma_f32_16x16x32_bf16 v[76:79], a[200:203], v[32:35], v[76:79]
ds_read_b128 v[24:27], v16 offset:53504
v_mfma_f32_16x16x32_bf16 v[80:83], a[204:207], v[32:35], v[80:83]
s_waitcnt lgkmcnt(4)
v_mfma_f32_16x16x32_bf16 v[68:71], a[208:211], v[36:39], v[68:71]
ds_read_b128 v[28:31], v17 offset:49408
s_add_u32 m0, s21, 83968
v_mfma_f32_16x16x32_bf16 v[72:75], a[212:215], v[36:39], v[72:75]
buffer_load_dwordx4 v10, s[8:11], s20 offen lds
v_mfma_f32_16x16x32_bf16 v[76:79], a[208:211], v[40:43], v[76:79]
ds_read_b128 v[32:35], v17 offset:53504
v_mfma_f32_16x16x32_bf16 v[80:83], a[212:215], v[40:43], v[80:83]
s_waitcnt lgkmcnt(4)
v_mfma_f32_16x16x32_bf16 v[68:71], a[216:219], v[44:47], v[68:71]
ds_read_b128 v[36:39], v18 offset:49408
v_mfma_f32_16x16x32_bf16 v[72:75], a[220:223], v[44:47], v[72:75]
v_mfma_f32_16x16x32_bf16 v[76:79], a[216:219], v[48:51], v[76:79]
ds_read_b128 v[40:43], v18 offset:53504
v_mfma_f32_16x16x32_bf16 v[80:83], a[220:223], v[48:51], v[80:83]
s_waitcnt lgkmcnt(4)
v_mfma_f32_16x16x32_bf16 v[68:71], a[224:227], v[20:23], v[68:71]
ds_read_b128 v[44:47], v19 offset:49408
s_add_u32 m0, s21, 84992
v_mfma_f32_16x16x32_bf16 v[72:75], a[228:231], v[20:23], v[72:75]
buffer_load_dwordx4 v11, s[8:11], s20 offen lds
v_mfma_f32_16x16x32_bf16 v[76:79], a[224:227], v[24:27], v[76:79]
ds_read_b128 v[48:51], v19 offset:53504
v_mfma_f32_16x16x32_bf16 v[80:83], a[228:231], v[24:27], v[80:83]
s_waitcnt lgkmcnt(4)
v_mfma_f32_16x16x32_bf16 v[68:71], a[232:235], v[28:31], v[68:71]
s_waitcnt vmcnt(28)
s_barrier
ds_read_b128 v[20:23], v12 offset:0
v_mfma_f32_16x16x32_bf16 v[72:75], a[236:239], v[28:31], v[72:75]
s_add_u32 s20, s20, 512
v_mfma_f32_16x16x32_bf16 v[76:79], a[232:235], v[32:35], v[76:79]
ds_read_b128 v[24:27], v12 offset:4096
v_mfma_f32_16x16x32_bf16 v[80:83], a[236:239], v[32:35], v[80:83]
s_waitcnt lgkmcnt(4)
v_mfma_f32_16x16x32_bf16 v[68:71], a[240:243], v[36:39], v[68:71]
ds_read_b128 v[28:31], v13 offset:0
s_add_u32 m0, s21, 98304
v_mfma_f32_16x16x32_bf16 v[72:75], a[244:247], v[36:39], v[72:75]
buffer_load_dwordx4 v8, s[8:11], s20 offen lds
v_mfma_f32_16x16x32_bf16 v[76:79], a[240:243], v[40:43], v[76:79]
ds_read_b128 v[32:35], v13 offset:4096
v_mfma_f32_16x16x32_bf16 v[80:83], a[244:247], v[40:43], v[80:83]
s_waitcnt lgkmcnt(4)
v_mfma_f32_16x16x32_bf16 v[68:71], a[248:251], v[44:47], v[68:71]
ds_read_b128 v[36:39], v14 offset:0
v_mfma_f32_16x16x32_bf16 v[72:75], a[252:255], v[44:47], v[72:75]
v_mfma_f32_16x16x32_bf16 v[76:79], a[248:251], v[48:51], v[76:79]
ds_read_b128 v[40:43], v14 offset:4096
v_mfma_f32_16x16x32_bf16 v[80:83], a[252:255], v[48:51], v[80:83]
s_waitcnt lgkmcnt(4)
s_add_u32 s22, s22, 1
s_cmp_ge_u32 s22, s23
s_cbranch_scc0 L_st_469
s_branch L_fl1_465
L_st_470:
v_mfma_f32_16x16x32_bf16 v[52:55], a[0:3], v[20:23], 0
ds_read_b128 v[44:47], v15 offset:0
s_add_u32 m0, s21, 99328
s_sub_u32 s39, s22, 1
v_mfma_f32_16x16x32_bf16 v[56:59], a[4:7], v[20:23], 0
buffer_load_dwordx4 v9, s[8:11], s20 offen lds
v_mfma_f32_16x16x32_bf16 v[60:63], a[0:3], v[24:27], 0
ds_read_b128 v[48:51], v15 offset:4096
s_bitcmp1_b32 s39, 1
s_cselect_b32 s38, s54, s55
v_mfma_f32_16x16x32_bf16 v[64:67], a[4:7], v[24:27], 0
s_waitcnt lgkmcnt(4)
v_mfma_f32_16x16x32_bf16 v[52:55], a[8:11], v[28:31], v[52:55]
ds_read_b128 v[20:23], v12 offset:256
s_add_u32 s38, s38, s44
s_waitcnt vmcnt(5)
v_mfma_f32_16x16x32_bf16 v[56:59], a[12:15], v[28:31], v[56:59]
s_lshl_b32 s42, s39, 20
s_add_u32 s38, s38, s42
ds_write_b32 v101, v87
v_mfma_f32_16x16x32_bf16 v[60:63], a[8:11], v[32:35], v[60:63]
ds_read_b128 v[24:27], v12 offset:4352
s_cmp_eq_u32 s37, 0
s_cselect_b32 s38, 0x7ff00000, s38
v_mfma_f32_16x16x32_bf16 v[64:67], a[12:15], v[32:35], v[64:67]
s_waitcnt lgkmcnt(4)
v_mfma_f32_16x16x32_bf16 v[52:55], a[16:19], v[36:39], v[52:55]
ds_read_b128 v[28:31], v13 offset:256
s_add_u32 m0, s21, 100352
v_mfma_f32_16x16x32_bf16 v[56:59], a[20:23], v[36:39], v[56:59]
buffer_load_dwordx4 v10, s[8:11], s20 offen lds
s_mov_b32 s37, 1
v_mfma_f32_16x16x32_bf16 v[60:63], a[16:19], v[40:43], v[60:63]
ds_read_b128 v[32:35], v13 offset:4352
v_cvt_pk_bf16_f32 v88, v68, v69
v_mfma_f32_16x16x32_bf16 v[64:67], a[20:23], v[40:43], v[64:67]
s_waitcnt lgkmcnt(4)
v_cvt_pk_bf16_f32 v89, v70, v71
v_mfma_f32_16x16x32_bf16 v[52:55], a[24:27], v[44:47], v[52:55]
ds_read_b128 v[36:39], v14 offset:256
v_cvt_pk_bf16_f32 v90, v72, v73
v_mfma_f32_16x16x32_bf16 v[56:59], a[28:31], v[44:47], v[56:59]
v_cvt_pk_bf16_f32 v91, v74, v75
v_mfma_f32_16x16x32_bf16 v[60:63], a[24:27], v[48:51], v[60:63]
ds_read_b128 v[40:43], v14 offset:4352
buffer_store_dwordx4 v[88:91], v86, s[12:15], s38 offen offset:0
v_mfma_f32_16x16x32_bf16 v[64:67], a[28:31], v[48:51], v[64:67]
s_waitcnt lgkmcnt(4)
v_cvt_pk_bf16_f32 v92, v76, v77
v_cvt_pk_bf16_f32 v93, v78, v79
v_mfma_f32_16x16x32_bf16 v[52:55], a[32:35], v[20:23], v[52:55]
ds_read_b128 v[44:47], v15 offset:256
s_add_u32 m0, s21, 101376
v_mfma_f32_16x16x32_bf16 v[56:59], a[36:39], v[20:23], v[56:59]
buffer_load_dwordx4 v11, s[8:11], s20 offen lds
v_cvt_pk_bf16_f32 v94, v80, v81
v_mfma_f32_16x16x32_bf16 v[60:63], a[32:35], v[24:27], v[60:63]
ds_read_b128 v[48:51], v15 offset:4352
v_cvt_pk_bf16_f32 v95, v82, v83
v_mfma_f32_16x16x32_bf16 v[64:67], a[36:39], v[24:27], v[64:67]
s_waitcnt lgkmcnt(4)
buffer_store_dwordx4 v[92:95], v86, s[12:15], s38 offen offset:128
v_mfma_f32_16x16x32_bf16 v[52:55], a[40:43], v[28:31], v[52:55]
s_waitcnt vmcnt(44)
s_barrier
ds_read_b128 v[20:23], v12 offset:16384
v_mfma_f32_16x16x32_bf16 v[56:59], a[44:47], v[28:31], v[56:59]
s_add_u32 s20, s20, 512
v_mfma_f32_16x16x32_bf16 v[60:63], a[40:43], v[32:35], v[60:63]
ds_read_b128 v[24:27], v12 offset:20480
ds_read_b32 v87, v102
v_mfma_f32_16x16x32_bf16 v[64:67], a[44:47], v[32:35], v[64:67]
s_waitcnt lgkmcnt(4)
v_mfma_f32_16x16x32_bf16 v[52:55], a[48:51], v[36:39], v[52:55]
ds_read_b128 v[28:31], v13 offset:16384
s_add_u32 m0, s21, 114688
v_mfma_f32_16x16x32_bf16 v[56:59], a[52:55], v[36:39], v[56:59]
buffer_load_dwordx4 v8, s[8:11], s20 offen lds
v_mfma_f32_16x16x32_bf16 v[60:63], a[48:51], v[40:43], v[60:63]
ds_read_b128 v[32:35], v13 offset:20480
v_mfma_f32_16x16x32_bf16 v[64:67], a[52:55], v[40:43], v[64:67]
s_waitcnt lgkmcnt(4)
v_mfma_f32_16x16x32_bf16 v[52:55], a[56:59], v[44:47], v[52:55]
ds_read_b128 v[36:39], v14 offset:16384
v_mfma_f32_16x16x32_bf16 v[56:59], a[60:63], v[44:47], v[56:59]
v_mfma_f32_16x16x32_bf16 v[60:63], a[56:59], v[48:51], v[60:63]
ds_read_b128 v[40:43], v14 offset:20480
v_mfma_f32_16x16x32_bf16 v[64:67], a[60:63], v[48:51], v[64:67]
s_waitcnt lgkmcnt(4)
v_mfma_f32_16x16x32_bf16 v[52:55], a[64:67], v[20:23], v[52:55]
ds_read_b128 v[44:47], v15 offset:16384
s_add_u32 m0, s21, 115712
v_mfma_f32_16x16x32_bf16 v[56:59], a[68:71], v[20:23], v[56:59]
buffer_load_dwordx4 v9, s[8:11], s20 offen lds
v_mfma_f32_16x16x32_bf16 v[60:63], a[64:67], v[24:27], v[60:63]
ds_read_b128 v[48:51], v15 offset:20480
s_waitcnt vmcnt(13)
s_branch L_att_458
L_attr_463:
v_mfma_f32_16x16x32_bf16 v[64:67], a[68:71], v[24:27], v[64:67]
s_waitcnt lgkmcnt(4)
s_add_u32 s43, s94, 0
buffer_store_dwordx4 v[168:171], v100, s[12:15], s43 offen offset:2048 sc1
v_mfma_f32_16x16x32_bf16 v[52:55], a[72:75], v[28:31], v[52:55]
ds_read_b128 v[20:23], v12 offset:16640
v_mfma_f32_16x16x32_bf16 v[56:59], a[76:79], v[28:31], v[56:59]
v_mfma_f32_16x16x32_bf16 v[60:63], a[72:75], v[32:35], v[60:63]
ds_read_b128 v[24:27], v12 offset:20736
s_add_u32 s43, s50, 0
buffer_load_dwordx4 v[136:139], v96, s[12:15], s43 offen offset:0
v_mfma_f32_16x16x32_bf16 v[64:67], a[76:79], v[32:35], v[64:67]
s_waitcnt lgkmcnt(4)
s_add_u32 s24, s24, 1
v_mfma_f32_16x16x32_bf16 v[52:55], a[80:83], v[36:39], v[52:55]
ds_read_b128 v[28:31], v13 offset:16640
s_add_u32 m0, s21, 116736
v_mfma_f32_16x16x32_bf16 v[56:59], a[84:87], v[36:39], v[56:59]
buffer_load_dwordx4 v10, s[8:11], s20 offen lds
v_mfma_f32_16x16x32_bf16 v[60:63], a[80:83], v[40:43], v[60:63]
ds_read_b128 v[32:35], v13 offset:20736
v_mfma_f32_16x16x32_bf16 v[64:67], a[84:87], v[40:43], v[64:67]
s_waitcnt lgkmcnt(4)
s_add_u32 s43, s50, 0
buffer_load_dwordx4 v[140:143], v96, s[12:15], s43 offen offset:1024
v_mfma_f32_16x16x32_bf16 v[52:55], a[88:91], v[44:47], v[52:55]
ds_read_b128 v[36:39], v14 offset:16640
s_min_u32 s24, s24, 63
v_mfma_f32_16x16x32_bf16 v[56:59], a[92:95], v[44:47], v[56:59]
s_lshl_b32 s53, s24, 16
v_mfma_f32_16x16x32_bf16 v[60:63], a[88:91], v[48:51], v[60:63]
ds_read_b128 v[40:43], v14 offset:20736
s_add_u32 s43, s94, 0
buffer_store_dwordx4 v[172:175], v100, s[12:15], s43 offen offset:2560 sc1
v_mfma_f32_16x16x32_bf16 v[64:67], a[92:95], v[48:51], v[64:67]
s_waitcnt lgkmcnt(4)
v_mfma_f32_16x16x32_bf16 v[52:55], a[96:99], v[20:23], v[52:55]
ds_read_b128 v[44:47], v15 offset:16640
s_add_u32 m0, s21, 117760
v_mfma_f32_16x16x32_bf16 v[56:59], a[100:103], v[20:23], v[56:59]
buffer_load_dwordx4 v11, s[8:11], s20 offen lds
v_mfma_f32_16x16x32_bf16 v[60:63], a[96:99], v[24:27], v[60:63]
ds_read_b128 v[48:51], v15 offset:20736
v_mfma_f32_16x16x32_bf16 v[64:67], a[100:103], v[24:27], v[64:67]
s_waitcnt lgkmcnt(4)
s_add_u32 s43, s48, 0
buffer_load_dwordx4 v[104:107], v96, s[12:15], s43 offen offset:0
v_mfma_f32_16x16x32_bf16 v[52:55], a[104:107], v[28:31], v[52:55]
s_waitcnt vmcnt(29)
s_barrier
ds_read_b128 v[20:23], v12 offset:32768
v_mfma_f32_16x16x32_bf16 v[56:59], a[108:111], v[28:31], v[56:59]
s_mov_b32 s20, s53
v_mfma_f32_16x16x32_bf16 v[60:63], a[104:107], v[32:35], v[60:63]
ds_read_b128 v[24:27], v12 offset:36864
s_add_u32 s43, s48, 0
buffer_load_dwordx4 v[108:111], v96, s[12:15], s43 offen offset:1024
v_mfma_f32_16x16x32_bf16 v[64:67], a[108:111], v[32:35], v[64:67]
s_waitcnt lgkmcnt(4)
v_mfma_f32_16x16x32_bf16 v[52:55], a[112:115], v[36:39], v[52:55]
ds_read_b128 v[28:31], v13 offset:32768
s_add_u32 m0, s21, 0
v_mfma_f32_16x16x32_bf16 v[56:59], a[116:119], v[36:39], v[56:59]
buffer_load_dwordx4 v8, s[8:11], s20 offen lds
v_mfma_f32_16x16x32_bf16 v[60:63], a[112:115], v[40:43], v[60:63]
ds_read_b128 v[32:35], v13 offset:36864
v_mfma_f32_16x16x32_bf16 v[64:67], a[116:119], v[40:43], v[64:67]
s_waitcnt lgkmcnt(4)
s_add_u32 s43, s94, 4096
buffer_store_dwordx4 v[176:179], v100, s[12:15], s43 offen offset:0 sc1
v_mfma_f32_16x16x32_bf16 v[52:55], a[120:123], v[44:47], v[52:55]
ds_read_b128 v[36:39], v14 offset:32768
v_mfma_f32_16x16x32_bf16 v[56:59], a[124:127], v[44:47], v[56:59]
v_mfma_f32_16x16x32_bf16 v[60:63], a[120:123], v[48:51], v[60:63]
ds_read_b128 v[40:43], v14 offset:36864
v_mfma_f32_16x16x32_bf16 v[64:67], a[124:127], v[48:51], v[64:67]
s_waitcnt lgkmcnt(4)
v_mfma_f32_16x16x32_bf16 v[52:55], a[128:131], v[20:23], v[52:55]
ds_read_b128 v[44:47], v15 offset:32768
s_add_u32 m0, s21, 1024
v_mfma_f32_16x16x32_bf16 v[56:59], a[132:135], v[20:23], v[56:59]
buffer_load_dwordx4 v9, s[8:11], s20 offen lds
v_mfma_f32_16x16x32_bf16 v[60:63], a[128:131], v[24:27], v[60:63]
ds_read_b128 v[48:51], v15 offset:36864
v_mfma_f32_16x16x32_bf16 v[64:67], a[132:135], v[24:27], v[64:67]
s_waitcnt lgkmcnt(4)
s_add_u32 s43, s50, 4096
buffer_load_dwordx4 v[144:147], v96, s[12:15], s43 offen offset:2048
v_mfma_f32_16x16x32_bf16 v[52:55], a[136:139], v[28:31], v[52:55]
ds_read_b128 v[20:23], v12 offset:33024
v_mfma_f32_16x16x32_bf16 v[56:59], a[140:143], v[28:31], v[56:59]
v_mfma_f32_16x16x32_bf16 v[60:63], a[136:139], v[32:35], v[60:63]
ds_read_b128 v[24:27], v12 offset:37120
s_add_u32 s43, s94, 4096
buffer_store_dwordx4 v[180:183], v100, s[12:15], s43 offen offset:512 sc1
v_mfma_f32_16x16x32_bf16 v[64:67], a[140:143], v[32:35], v[64:67]
s_waitcnt lgkmcnt(4)
v_mfma_f32_16x16x32_bf16 v[52:55], a[144:147], v[36:39], v[52:55]
ds_read_b128 v[28:31], v13 offset:33024
s_add_u32 m0, s21, 2048
v_mfma_f32_16x16x32_bf16 v[56:59], a[148:151], v[36:39], v[56:59]
buffer_load_dwordx4 v10, s[8:11], s20 offen lds
v_mfma_f32_16x16x32_bf16 v[60:63], a[144:147], v[40:43], v[60:63]
ds_read_b128 v[32:35], v13 offset:37120
v_mfma_f32_16x16x32_bf16 v[64:67], a[148:151], v[40:43], v[64:67]
s_waitcnt lgkmcnt(4)
s_add_u32 s43, s50, 4096
buffer_load_dwordx4 v[148:151], v96, s[12:15], s43 offen offset:3072
v_mfma_f32_16x16x32_bf16 v[52:55], a[152:155], v[44:47], v[52:55]
ds_read_b128 v[36:39], v14 offset:33024
v_mfma_f32_16x16x32_bf16 v[56:59], a[156:159], v[44:47], v[56:59]
v_mfma_f32_16x16x32_bf16 v[60:63], a[152:155], v[48:51], v[60:63]
ds_read_b128 v[40:43], v14 offset:37120
s_add_u32 s43, s48, 4096
buffer_load_dwordx4 v[112:115], v96, s[12:15], s43 offen offset:0
v_mfma_f32_16x16x32_bf16 v[64:67], a[156:159], v[48:51], v[64:67]
s_waitcnt lgkmcnt(4)
v_mfma_f32_16x16x32_bf16 v[52:55], a[160:163], v[20:23], v[52:55]
ds_read_b128 v[44:47], v15 offset:33024
s_add_u32 m0, s21, 3072
v_mfma_f32_16x16x32_bf16 v[56:59], a[164:167], v[20:23], v[56:59]
buffer_load_dwordx4 v11, s[8:11], s20 offen lds
v_mfma_f32_16x16x32_bf16 v[60:63], a[160:163], v[24:27], v[60:63]
ds_read_b128 v[48:51], v15 offset:37120
v_mfma_f32_16x16x32_bf16 v[64:67], a[164:167], v[24:27], v[64:67]
s_waitcnt lgkmcnt(4)
s_add_u32 s43, s94, 16384
buffer_store_dwordx4 v[184:187], v100, s[12:15], s43 offen offset:2048 sc1
v_mfma_f32_16x16x32_bf16 v[52:55], a[168:171], v[28:31], v[52:55]
s_waitcnt vmcnt(35)
s_barrier
ds_read_b128 v[20:23], v12 offset:49152
v_mfma_f32_16x16x32_bf16 v[56:59], a[172:175], v[28:31], v[56:59]
s_add_u32 s20, s20, 512
v_mfma_f32_16x16x32_bf16 v[60:63], a[168:171], v[32:35], v[60:63]
ds_read_b128 v[24:27], v12 offset:53248
s_add_u32 s43, s48, 4096
buffer_load_dwordx4 v[116:119], v96, s[12:15], s43 offen offset:1024
v_mfma_f32_16x16x32_bf16 v[64:67], a[172:175], v[32:35], v[64:67]
s_waitcnt lgkmcnt(4)
v_mfma_f32_16x16x32_bf16 v[52:55], a[176:179], v[36:39], v[52:55]
ds_read_b128 v[28:31], v13 offset:49152
s_add_u32 m0, s21, 16384
v_mfma_f32_16x16x32_bf16 v[56:59], a[180:183], v[36:39], v[56:59]
buffer_load_dwordx4 v8, s[8:11], s20 offen lds
v_mfma_f32_16x16x32_bf16 v[60:63], a[176:179], v[40:43], v[60:63]
ds_read_b128 v[32:35], v13 offset:53248
v_mfma_f32_16x16x32_bf16 v[64:67], a[180:183], v[40:43], v[64:67]
s_waitcnt lgkmcnt(4)
s_add_u32 s43, s94, 16384
buffer_store_dwordx4 v[188:191], v100, s[12:15], s43 offen offset:2560 sc1
v_mfma_f32_16x16x32_bf16 v[52:55], a[184:187], v[44:47], v[52:55]
ds_read_b128 v[36:39], v14 offset:49152
v_mfma_f32_16x16x32_bf16 v[56:59], a[188:191], v[44:47], v[56:59]
v_mfma_f32_16x16x32_bf16 v[60:63], a[184:187], v[48:51], v[60:63]
ds_read_b128 v[40:43], v14 offset:53248
s_add_u32 s43, s50, 16384
buffer_load_dwordx4 v[152:155], v96, s[12:15], s43 offen offset:0
v_mfma_f32_16x16x32_bf16 v[64:67], a[188:191], v[48:51], v[64:67]
s_waitcnt lgkmcnt(4)
v_mfma_f32_16x16x32_bf16 v[52:55], a[192:195], v[20:23], v[52:55]
ds_read_b128 v[44:47], v15 offset:49152
s_add_u32 m0, s21, 17408
v_mfma_f32_16x16x32_bf16 v[56:59], a[196:199], v[20:23], v[56:59]
buffer_load_dwordx4 v9, s[8:11], s20 offen lds
v_mfma_f32_16x16x32_bf16 v[60:63], a[192:195], v[24:27], v[60:63]
ds_read_b128 v[48:51], v15 offset:53248
v_mfma_f32_16x16x32_bf16 v[64:67], a[196:199], v[24:27], v[64:67]
s_waitcnt lgkmcnt(4)
v_mfma_f32_16x16x32_bf16 v[52:55], a[200:203], v[28:31], v[52:55]
ds_read_b128 v[20:23], v12 offset:49408
v_mfma_f32_16x16x32_bf16 v[56:59], a[204:207], v[28:31], v[56:59]
v_mfma_f32_16x16x32_bf16 v[60:63], a[200:203], v[32:35], v[60:63]
ds_read_b128 v[24:27], v12 offset:53504
s_add_u32 s43, s94, 20480
buffer_store_dwordx4 v[192:195], v100, s[12:15], s43 offen offset:0 sc1
v_mfma_f32_16x16x32_bf16 v[64:67], a[204:207], v[32:35], v[64:67]
s_waitcnt lgkmcnt(4)
v_mfma_f32_16x16x32_bf16 v[52:55], a[208:211], v[36:39], v[52:55]
ds_read_b128 v[28:31], v13 offset:49408
s_add_u32 m0, s21, 18432
v_mfma_f32_16x16x32_bf16 v[56:59], a[212:215], v[36:39], v[56:59]
buffer_load_dwordx4 v10, s[8:11], s20 offen lds
v_mfma_f32_16x16x32_bf16 v[60:63], a[208:211], v[40:43], v[60:63]
ds_read_b128 v[32:35], v13 offset:53504
v_mfma_f32_16x16x32_bf16 v[64:67], a[212:215], v[40:43], v[64:67]
s_waitcnt lgkmcnt(4)
s_add_u32 s43, s50, 16384
buffer_load_dwordx4 v[156:159], v96, s[12:15], s43 offen offset:1024
v_mfma_f32_16x16x32_bf16 v[52:55], a[216:219], v[44:47], v[52:55]
ds_read_b128 v[36:39], v14 offset:49408
v_mfma_f32_16x16x32_bf16 v[56:59], a[220:223], v[44:47], v[56:59]
v_mfma_f32_16x16x32_bf16 v[60:63], a[216:219], v[48:51], v[60:63]
ds_read_b128 v[40:43], v14 offset:53504
s_add_u32 s43, s48, 16384
buffer_load_dwordx4 v[120:123], v96, s[12:15], s43 offen offset:0
v_mfma_f32_16x16x32_bf16 v[64:67], a[220:223], v[48:51], v[64:67]
s_waitcnt lgkmcnt(4)
v_mfma_f32_16x16x32_bf16 v[52:55], a[224:227], v[20:23], v[52:55]
ds_read_b128 v[44:47], v15 offset:49408
s_add_u32 m0, s21, 19456
v_mfma_f32_16x16x32_bf16 v[56:59], a[228:231], v[20:23], v[56:59]
buffer_load_dwordx4 v11, s[8:11], s20 offen lds
v_mfma_f32_16x16x32_bf16 v[60:63], a[224:227], v[24:27], v[60:63]
ds_read_b128 v[48:51], v15 offset:53504
v_mfma_f32_16x16x32_bf16 v[64:67], a[228:231], v[24:27], v[64:67]
s_waitcnt lgkmcnt(4)
s_add_u32 s43, s94, 20480
buffer_store_dwordx4 v[196:199], v100, s[12:15], s43 offen offset:512 sc1
v_mfma_f32_16x16x32_bf16 v[52:55], a[232:235], v[28:31], v[52:55]
s_waitcnt vmcnt(42)
s_barrier
ds_read_b128 v[20:23], v16 offset:0
v_mfma_f32_16x16x32_bf16 v[56:59], a[236:239], v[28:31], v[56:59]
s_add_u32 s20, s20, 512
v_mfma_f32_16x16x32_bf16 v[60:63], a[232:235], v[32:35], v[60:63]
ds_read_b128 v[24:27], v16 offset:4096
s_add_u32 s43, s48, 16384
buffer_load_dwordx4 v[124:127], v96, s[12:15], s43 offen offset:1024
v_mfma_f32_16x16x32_bf16 v[64:67], a[236:239], v[32:35], v[64:67]
s_waitcnt lgkmcnt(4)
v_mfma_f32_16x16x32_bf16 v[52:55], a[240:243], v[36:39], v[52:55]
ds_read_b128 v[28:31], v17 offset:0
s_add_u32 m0, s21, 32768
v_mfma_f32_16x16x32_bf16 v[56:59], a[244:247], v[36:39], v[56:59]
buffer_load_dwordx4 v8, s[8:11], s20 offen lds
v_mfma_f32_16x16x32_bf16 v[60:63], a[240:243], v[40:43], v[60:63]
ds_read_b128 v[32:35], v17 offset:4096
v_mfma_f32_16x16x32_bf16 v[64:67], a[244:247], v[40:43], v[64:67]
s_waitcnt lgkmcnt(4)
v_mfma_f32_16x16x32_bf16 v[52:55], a[248:251], v[44:47], v[52:55]
ds_read_b128 v[36:39], v18 offset:0
v_mfma_f32_16x16x32_bf16 v[56:59], a[252:255], v[44:47], v[56:59]
v_mfma_f32_16x16x32_bf16 v[60:63], a[248:251], v[48:51], v[60:63]
ds_read_b128 v[40:43], v18 offset:4096
v_mfma_f32_16x16x32_bf16 v[64:67], a[252:255], v[48:51], v[64:67]
s_waitcnt lgkmcnt(4)
s_add_u32 s22, s22, 1
s_cmp_ge_u32 s22, s23
s_cbranch_scc1 L_fl0_464
v_mfma_f32_16x16x32_bf16 v[68:71], a[0:3], v[20:23], 0
ds_read_b128 v[44:47], v19 offset:0
s_add_u32 m0, s21, 33792
s_sub_u32 s39, s22, 1
v_mfma_f32_16x16x32_bf16 v[72:75], a[4:7], v[20:23], 0
buffer_load_dwordx4 v9, s[8:11], s20 offen lds
s_bitcmp1_b32 s39, 1
s_cselect_b32 s38, s54, s55
v_mfma_f32_16x16x32_bf16 v[76:79], a[0:3], v[24:27], 0
ds_read_b128 v[48:51], v19 offset:4096
v_mfma_f32_16x16x32_bf16 v[80:83], a[4:7], v[24:27], 0
s_waitcnt lgkmcnt(4)
s_add_u32 s43, s50, 20480
buffer_load_dwordx4 v[160:163], v96, s[12:15], s43 offen offset:2048
v_mfma_f32_16x16x32_bf16 v[68:71], a[8:11], v[28:31], v[68:71]
ds_read_b128 v[20:23], v16 offset:256
s_add_u32 s38, s38, s44
v_mfma_f32_16x16x32_bf16 v[72:75], a[12:15], v[28:31], v[72:75]
s_lshl_b32 s42, s39, 20
s_add_u32 s38, s38, s42
v_mfma_f32_16x16x32_bf16 v[76:79], a[8:11], v[32:35], v[76:79]
ds_read_b128 v[24:27], v16 offset:4352
s_add_u32 s43, s50, 20480
buffer_load_dwordx4 v[164:167], v96, s[12:15], s43 offen offset:3072
v_mfma_f32_16x16x32_bf16 v[80:83], a[12:15], v[32:35], v[80:83]
s_waitcnt lgkmcnt(4)
s_cmp_eq_u32 s37, 0
s_cselect_b32 s38, 0x7ff00000, s38
v_mfma_f32_16x16x32_bf16 v[68:71], a[16:19], v[36:39], v[68:71]
ds_read_b128 v[28:31], v17 offset:256
s_add_u32 m0, s21, 34816
v_mfma_f32_16x16x32_bf16 v[72:75], a[20:23], v[36:39], v[72:75]
buffer_load_dwordx4 v10, s[8:11], s20 offen lds
s_mov_b32 s37, 1
v_mfma_f32_16x16x32_bf16 v[76:79], a[16:19], v[40:43], v[76:79]
ds_read_b128 v[32:35], v17 offset:4352
v_cvt_pk_bf16_f32 v88, v52, v53
v_mfma_f32_16x16x32_bf16 v[80:83], a[20:23], v[40:43], v[80:83]
s_waitcnt lgkmcnt(4)
s_add_u32 s43, s48, 20480
buffer_load_dwordx4 v[128:131], v96, s[12:15], s43 offen offset:0
v_mfma_f32_16x16x32_bf16 v[68:71], a[24:27], v[44:47], v[68:71]
ds_read_b128 v[36:39], v18 offset:256
v_cvt_pk_bf16_f32 v89, v54, v55
v_cvt_pk_bf16_f32 v90, v56, v57
v_mfma_f32_16x16x32_bf16 v[72:75], a[28:31], v[44:47], v[72:75]
v_cvt_pk_bf16_f32 v91, v58, v59
v_mfma_f32_16x16x32_bf16 v[76:79], a[24:27], v[48:51], v[76:79]
ds_read_b128 v[40:43], v18 offset:4352
buffer_store_dwordx4 v[88:91], v86, s[12:15], s38 offen offset:0
v_mfma_f32_16x16x32_bf16 v[80:83], a[28:31], v[48:51], v[80:83]
s_waitcnt lgkmcnt(4)
v_cvt_pk_bf16_f32 v92, v60, v61
v_cvt_pk_bf16_f32 v93, v62, v63
v_mfma_f32_16x16x32_bf16 v[68:71], a[32:35], v[20:23], v[68:71]
ds_read_b128 v[44:47], v19 offset:256
s_add_u32 m0, s21, 35840
v_mfma_f32_16x16x32_bf16 v[72:75], a[36:39], v[20:23], v[72:75]
buffer_load_dwordx4 v11, s[8:11], s20 offen lds
v_cvt_pk_bf16_f32 v94, v64, v65
v_mfma_f32_16x16x32_bf16 v[76:79], a[32:35], v[24:27], v[76:79]
ds_read_b128 v[48:51], v19 offset:4352
v_cvt_pk_bf16_f32 v95, v66, v67
v_mfma_f32_16x16x32_bf16 v[80:83], a[36:39], v[24:27], v[80:83]
s_waitcnt lgkmcnt(4)
buffer_store_dwordx4 v[92:95], v86, s[12:15], s38 offen offset:128
v_mfma_f32_16x16x32_bf16 v[68:71], a[40:43], v[28:31], v[68:71]
s_waitcnt vmcnt(47)
s_barrier
ds_read_b128 v[20:23], v16 offset:16384
v_mfma_f32_16x16x32_bf16 v[72:75], a[44:47], v[28:31], v[72:75]
s_add_u32 s20, s20, 512
v_mfma_f32_16x16x32_bf16 v[76:79], a[40:43], v[32:35], v[76:79]
ds_read_b128 v[24:27], v16 offset:20480
s_add_u32 s43, s48, 20480
buffer_load_dwordx4 v[132:135], v96, s[12:15], s43 offen offset:1024
v_mfma_f32_16x16x32_bf16 v[80:83], a[44:47], v[32:35], v[80:83]
s_waitcnt lgkmcnt(4)
v_mfma_f32_16x16x32_bf16 v[68:71], a[48:51], v[36:39], v[68:71]
ds_read_b128 v[28:31], v17 offset:16384
s_add_u32 m0, s21, 49152
v_mfma_f32_16x16x32_bf16 v[72:75], a[52:55], v[36:39], v[72:75]
buffer_load_dwordx4 v8, s[8:11], s20 offen lds
v_mfma_f32_16x16x32_bf16 v[76:79], a[48:51], v[40:43], v[76:79]
ds_read_b128 v[32:35], v17 offset:20480
v_mfma_f32_16x16x32_bf16 v[80:83], a[52:55], v[40:43], v[80:83]
s_waitcnt lgkmcnt(4)
s_add_u32 s43, s48, 0
buffer_load_dwordx4 v[168:171], v98, s[12:15], s43 offen offset:2048
v_mfma_f32_16x16x32_bf16 v[68:71], a[56:59], v[44:47], v[68:71]
ds_read_b128 v[36:39], v18 offset:16384
v_mfma_f32_16x16x32_bf16 v[72:75], a[60:63], v[44:47], v[72:75]
v_mfma_f32_16x16x32_bf16 v[76:79], a[56:59], v[48:51], v[76:79]
ds_read_b128 v[40:43], v18 offset:20480
s_add_u32 s43, s48, 0
buffer_load_dwordx4 v[172:175], v98, s[12:15], s43 offen offset:3072
v_mfma_f32_16x16x32_bf16 v[80:83], a[60:63], v[48:51], v[80:83]
s_waitcnt lgkmcnt(4)
v_mfma_f32_16x16x32_bf16 v[68:71], a[64:67], v[20:23], v[68:71]
ds_read_b128 v[44:47], v19 offset:16384
s_add_u32 m0, s21, 50176
v_mfma_f32_16x16x32_bf16 v[72:75], a[68:71], v[20:23], v[72:75]
buffer_load_dwordx4 v9, s[8:11], s20 offen lds
v_mfma_f32_16x16x32_bf16 v[76:79], a[64:67], v[24:27], v[76:79]
ds_read_b128 v[48:51], v19 offset:20480
v_mfma_f32_16x16x32_bf16 v[80:83], a[68:71], v[24:27], v[80:83]
s_waitcnt lgkmcnt(4)
s_add_u32 s43, s48, 4096
buffer_load_dwordx4 v[176:179], v98, s[12:15], s43 offen offset:2048
v_mfma_f32_16x16x32_bf16 v[68:71], a[72:75], v[28:31], v[68:71]
ds_read_b128 v[20:23], v16 offset:16640
v_mfma_f32_16x16x32_bf16 v[72:75], a[76:79], v[28:31], v[72:75]
v_mfma_f32_16x16x32_bf16 v[76:79], a[72:75], v[32:35], v[76:79]
ds_read_b128 v[24:27], v16 offset:20736
s_add_u32 s43, s48, 4096
buffer_load_dwordx4 v[180:183], v98, s[12:15], s43 offen offset:3072
v_mfma_f32_16x16x32_bf16 v[80:83], a[76:79], v[32:35], v[80:83]
s_waitcnt lgkmcnt(4)
s_add_u32 s24, s24, 1
v_mfma_f32_16x16x32_bf16 v[68:71], a[80:83], v[36:39], v[68:71]
ds_read_b128 v[28:31], v17 offset:16640
s_add_u32 m0, s21, 51200
v_mfma_f32_16x16x32_bf16 v[72:75], a[84:87], v[36:39], v[72:75]
buffer_load_dwordx4 v10, s[8:11], s20 offen lds
v_mfma_f32_16x16x32_bf16 v[76:79], a[80:83], v[40:43], v[76:79]
ds_read_b128 v[32:35], v17 offset:20736
v_mfma_f32_16x16x32_bf16 v[80:83], a[84:87], v[40:43], v[80:83]
s_waitcnt lgkmcnt(4)
s_add_u32 s43, s48, 16384
buffer_load_dwordx4 v[184:187], v98, s[12:15], s43 offen offset:2048
v_mfma_f32_16x16x32_bf16 v[68:71], a[88:91], v[44:47], v[68:71]
ds_read_b128 v[36:39], v18 offset:16640
s_min_u32 s24, s24, 63
v_mfma_f32_16x16x32_bf16 v[72:75], a[92:95], v[44:47], v[72:75]
s_lshl_b32 s53, s24, 16
v_mfma_f32_16x16x32_bf16 v[76:79], a[88:91], v[48:51], v[76:79]
ds_read_b128 v[40:43], v18 offset:20736
s_add_u32 s43, s48, 16384
buffer_load_dwordx4 v[188:191], v98, s[12:15], s43 offen offset:3072
v_mfma_f32_16x16x32_bf16 v[80:83], a[92:95], v[48:51], v[80:83]
s_waitcnt lgkmcnt(4)
v_mfma_f32_16x16x32_bf16 v[68:71], a[96:99], v[20:23], v[68:71]
ds_read_b128 v[44:47], v19 offset:16640
s_add_u32 m0, s21, 52224
v_mfma_f32_16x16x32_bf16 v[72:75], a[100:103], v[20:23], v[72:75]
buffer_load_dwordx4 v11, s[8:11], s20 offen lds
v_mfma_f32_16x16x32_bf16 v[76:79], a[96:99], v[24:27], v[76:79]
ds_read_b128 v[48:51], v19 offset:20736
s_waitcnt vmcnt(21)
v_mfma_f32_16x16x32_bf16 v[80:83], a[100:103], v[24:27], v[80:83]
s_waitcnt lgkmcnt(4)
s_add_u32 s43, s48, 20480
buffer_load_dwordx4 v[192:195], v98, s[12:15], s43 offen offset:2048
v_mfma_f32_16x16x32_bf16 v[68:71], a[104:107], v[28:31], v[68:71]
s_waitcnt vmcnt(54)
s_barrier
ds_read_b128 v[20:23], v16 offset:32768
v_mfma_f32_16x16x32_bf16 v[72:75], a[108:111], v[28:31], v[72:75]
s_mov_b32 s20, s53
v_mfma_f32_16x16x32_bf16 v[76:79], a[104:107], v[32:35], v[76:79]
ds_read_b128 v[24:27], v16 offset:36864
buffer_atomic_add v84, v85, s[12:15], s51 offen sc1
v_mfma_f32_16x16x32_bf16 v[80:83], a[108:111], v[32:35], v[80:83]
s_waitcnt lgkmcnt(4)
v_mfma_f32_16x16x32_bf16 v[68:71], a[112:115], v[36:39], v[68:71]
ds_read_b128 v[28:31], v17 offset:32768
s_add_u32 m0, s21, 65536
v_mfma_f32_16x16x32_bf16 v[72:75], a[116:119], v[36:39], v[72:75]
buffer_load_dwordx4 v8, s[8:11], s20 offen lds
v_mfma_f32_16x16x32_bf16 v[76:79], a[112:115], v[40:43], v[76:79]
ds_read_b128 v[32:35], v17 offset:36864
v_mfma_f32_16x16x32_bf16 v[80:83], a[116:119], v[40:43], v[80:83]
s_waitcnt lgkmcnt(4)
s_add_u32 s43, s48, 20480
buffer_load_dwordx4 v[196:199], v98, s[12:15], s43 offen offset:3072
v_mfma_f32_16x16x32_bf16 v[68:71], a[120:123], v[44:47], v[68:71]
ds_read_b128 v[36:39], v18 offset:32768
v_mfma_f32_16x16x32_bf16 v[72:75], a[124:127], v[44:47], v[72:75]
v_mfma_f32_16x16x32_bf16 v[76:79], a[120:123], v[48:51], v[76:79]
ds_read_b128 v[40:43], v18 offset:36864
s_add_u32 m0, s7, 0
s_add_u32 s43, s48, 0x8000c00
buffer_load_dwordx4 v96, s[12:15], s43 offen sc1 lds
v_mfma_f32_16x16x32_bf16 v[80:83], a[124:127], v[48:51], v[80:83]
s_waitcnt lgkmcnt(4)
v_mfma_f32_16x16x32_bf16 v[68:71], a[128:131], v[20:23], v[68:71]
ds_read_b128 v[44:47], v19 offset:32768
s_add_u32 m0, s21, 66560
v_mfma_f32_16x16x32_bf16 v[72:75], a[132:135], v[20:23], v[72:75]
buffer_load_dwordx4 v9, s[8:11], s20 offen lds
v_mfma_f32_16x16x32_bf16 v[76:79], a[128:131], v[24:27], v[76:79]
ds_read_b128 v[48:51], v19 offset:36864
v_mfma_f32_16x16x32_bf16 v[80:83], a[132:135], v[24:27], v[80:83]
s_waitcnt lgkmcnt(4)
s_add_u32 m0, s7, 1024
s_add_u32 s43, s48, 0x8001c00
buffer_load_dwordx4 v96, s[12:15], s43 offen sc1 lds
v_mfma_f32_16x16x32_bf16 v[68:71], a[136:139], v[28:31], v[68:71]
ds_read_b128 v[20:23], v16 offset:33024
v_mfma_f32_16x16x32_bf16 v[72:75], a[140:143], v[28:31], v[72:75]
v_mfma_f32_16x16x32_bf16 v[76:79], a[136:139], v[32:35], v[76:79]
ds_read_b128 v[24:27], v16 offset:37120
v_mfma_f32_16x16x32_bf16 v[80:83], a[140:143], v[32:35], v[80:83]
s_waitcnt lgkmcnt(4)
v_mfma_f32_16x16x32_bf16 v[68:71], a[144:147], v[36:39], v[68:71]
ds_read_b128 v[28:31], v17 offset:33024
s_add_u32 m0, s21, 67584
v_mfma_f32_16x16x32_bf16 v[72:75], a[148:151], v[36:39], v[72:75]
buffer_load_dwordx4 v10, s[8:11], s20 offen lds
v_mfma_f32_16x16x32_bf16 v[76:79], a[144:147], v[40:43], v[76:79]
ds_read_b128 v[32:35], v17 offset:37120
v_mfma_f32_16x16x32_bf16 v[80:83], a[148:151], v[40:43], v[80:83]
s_waitcnt lgkmcnt(4)
s_add_u32 m0, s7, 2048
s_add_u32 s43, s48, 0x8004c00
buffer_load_dwordx4 v96, s[12:15], s43 offen sc1 lds
v_mfma_f32_16x16x32_bf16 v[68:71], a[152:155], v[44:47], v[68:71]
ds_read_b128 v[36:39], v18 offset:33024
v_mfma_f32_16x16x32_bf16 v[72:75], a[156:159], v[44:47], v[72:75]
v_mfma_f32_16x16x32_bf16 v[76:79], a[152:155], v[48:51], v[76:79]
ds_read_b128 v[40:43], v18 offset:37120
v_mfma_f32_16x16x32_bf16 v[80:83], a[156:159], v[48:51], v[80:83]
s_waitcnt lgkmcnt(4)
v_mfma_f32_16x16x32_bf16 v[68:71], a[160:163], v[20:23], v[68:71]
ds_read_b128 v[44:47], v19 offset:33024
s_add_u32 m0, s21, 68608
v_mfma_f32_16x16x32_bf16 v[72:75], a[164:167], v[20:23], v[72:75]
buffer_load_dwordx4 v11, s[8:11], s20 offen lds
v_mfma_f32_16x16x32_bf16 v[76:79], a[160:163], v[24:27], v[76:79]
ds_read_b128 v[48:51], v19 offset:37120
v_mfma_f32_16x16x32_bf16 v[80:83], a[164:167], v[24:27], v[80:83]
s_waitcnt lgkmcnt(4)
s_add_u32 m0, s7, 3072
s_add_u32 s43, s48, 0x8005c00
buffer_load_dwordx4 v96, s[12:15], s43 offen sc1 lds
v_mfma_f32_16x16x32_bf16 v[68:71], a[168:171], v[28:31], v[68:71]
s_waitcnt vmcnt(55)
s_barrier
ds_read_b128 v[20:23], v16 offset:49152
v_mfma_f32_16x16x32_bf16 v[72:75], a[172:175], v[28:31], v[72:75]
s_add_u32 s20, s20, 512
v_mfma_f32_16x16x32_bf16 v[76:79], a[168:171], v[32:35], v[76:79]
ds_read_b128 v[24:27], v16 offset:53248
v_mfma_f32_16x16x32_bf16 v[80:83], a[172:175], v[32:35], v[80:83]
s_waitcnt lgkmcnt(4)
v_mfma_f32_16x16x32_bf16 v[68:71], a[176:179], v[36:39], v[68:71]
ds_read_b128 v[28:31], v17 offset:49152
s_add_u32 m0, s21, 81920
v_mfma_f32_16x16x32_bf16 v[72:75], a[180:183], v[36:39], v[72:75]
buffer_load_dwordx4 v8, s[8:11], s20 offen lds
v_mfma_f32_16x16x32_bf16 v[76:79], a[176:179], v[40:43], v[76:79]
ds_read_b128 v[32:35], v17 offset:53248
v_mfma_f32_16x16x32_bf16 v[80:83], a[180:183], v[40:43], v[80:83]
s_waitcnt lgkmcnt(4)
buffer_load_dword v87, v103, s[32:35], 0 offen sc1
v_mfma_f32_16x16x32_bf16 v[68:71], a[184:187], v[44:47], v[68:71]
ds_read_b128 v[36:39], v18 offset:49152
v_mfma_f32_16x16x32_bf16 v[72:75], a[188:191], v[44:47], v[72:75]
v_mfma_f32_16x16x32_bf16 v[76:79], a[184:187], v[48:51], v[76:79]
ds_read_b128 v[40:43], v18 offset:53248
v_mfma_f32_16x16x32_bf16 v[80:83], a[188:191], v[48:51], v[80:83]
s_waitcnt lgkmcnt(4)
v_mfma_f32_16x16x32_bf16 v[68:71], a[192:195], v[20:23], v[68:71]
ds_read_b128 v[44:47], v19 offset:49152
s_add_u32 m0, s21, 82944
v_mfma_f32_16x16x32_bf16 v[72:75], a[196:199], v[20:23], v[72:75]
buffer_load_dwordx4 v9, s[8:11], s20 offen lds
v_mfma_f32_16x16x32_bf16 v[76:79], a[192:195], v[24:27], v[76:79]
ds_read_b128 v[48:51], v19 offset:53248
v_mfma_f32_16x16x32_bf16 v[80:83], a[196:199], v[24:27], v[80:83]
s_waitcnt lgkmcnt(4)
v_mfma_f32_16x16x32_bf16 v[68:71], a[200:203], v[28:31], v[68:71]
ds_read_b128 v[20:23], v16 offset:49408
v_mfma_f32_16x16x32_bf16 v[72:75], a[204:207], v[28:31], v[72:75]
v_mfma_f32_16x16x32_bf16 v[76:79], a[200:203], v[32:35], v[76:79]
ds_read_b128 v[24:27], v16 offset:53504
v_mfma_f32_16x16x32_bf16 v[80:83], a[204:207], v[32:35], v[80:83]
s_waitcnt lgkmcnt(4)
v_mfma_f32_16x16x32_bf16 v[68:71], a[208:211], v[36:39], v[68:71]
ds_read_b128 v[28:31], v17 offset:49408
s_add_u32 m0, s21, 83968
v_mfma_f32_16x16x32_bf16 v[72:75], a[212:215], v[36:39], v[72:75]
buffer_load_dwordx4 v10, s[8:11], s20 offen lds
v_mfma_f32_16x16x32_bf16 v[76:79], a[208:211], v[40:43], v[76:79]
ds_read_b128 v[32:35], v17 offset:53504
v_mfma_f32_16x16x32_bf16 v[80:83], a[212:215], v[40:43], v[80:83]
s_waitcnt lgkmcnt(4)
v_mfma_f32_16x16x32_bf16 v[68:71], a[216:219], v[44:47], v[68:71]
ds_read_b128 v[36:39], v18 offset:49408
v_mfma_f32_16x16x32_bf16 v[72:75], a[220:223], v[44:47], v[72:75]
v_mfma_f32_16x16x32_bf16 v[76:79], a[216:219], v[48:51], v[76:79]
ds_read_b128 v[40:43], v18 offset:53504
v_mfma_f32_16x16x32_bf16 v[80:83], a[220:223], v[48:51], v[80:83]
s_waitcnt lgkmcnt(4)
v_mfma_f32_16x16x32_bf16 v[68:71], a[224:227], v[20:23], v[68:71]
ds_read_b128 v[44:47], v19 offset:49408
s_add_u32 m0, s21, 84992
v_mfma_f32_16x16x32_bf16 v[72:75], a[228:231], v[20:23], v[72:75]
buffer_load_dwordx4 v11, s[8:11], s20 offen lds
v_mfma_f32_16x16x32_bf16 v[76:79], a[224:227], v[24:27], v[76:79]
ds_read_b128 v[48:51], v19 offset:53504
v_mfma_f32_16x16x32_bf16 v[80:83], a[228:231], v[24:27], v[80:83]
s_waitcnt lgkmcnt(4)
v_mfma_f32_16x16x32_bf16 v[68:71], a[232:235], v[28:31], v[68:71]
s_waitcnt vmcnt(49)
s_barrier
ds_read_b128 v[20:23], v12 offset:0
v_mfma_f32_16x16x32_bf16 v[72:75], a[236:239], v[28:31], v[72:75]
s_add_u32 s20, s20, 512
v_mfma_f32_16x16x32_bf16 v[76:79], a[232:235], v[32:35], v[76:79]
ds_read_b128 v[24:27], v12 offset:4096
v_mfma_f32_16x16x32_bf16 v[80:83], a[236:239], v[32:35], v[80:83]
s_waitcnt lgkmcnt(4)
v_mfma_f32_16x16x32_bf16 v[68:71], a[240:243], v[36:39], v[68:71]
ds_read_b128 v[28:31], v13 offset:0
s_add_u32 m0, s21, 98304
v_mfma_f32_16x16x32_bf16 v[72:75], a[244:247], v[36:39], v[72:75]
buffer_load_dwordx4 v8, s[8:11], s20 offen lds
v_mfma_f32_16x16x32_bf16 v[76:79], a[240:243], v[40:43], v[76:79]
ds_read_b128 v[32:35], v13 offset:4096
v_mfma_f32_16x16x32_bf16 v[80:83], a[244:247], v[40:43], v[80:83]
s_waitcnt lgkmcnt(4)
v_mfma_f32_16x16x32_bf16 v[68:71], a[248:251], v[44:47], v[68:71]
ds_read_b128 v[36:39], v14 offset:0
v_mfma_f32_16x16x32_bf16 v[72:75], a[252:255], v[44:47], v[72:75]
v_mfma_f32_16x16x32_bf16 v[76:79], a[248:251], v[48:51], v[76:79]
ds_read_b128 v[40:43], v14 offset:4096
v_mfma_f32_16x16x32_bf16 v[80:83], a[252:255], v[48:51], v[80:83]
s_waitcnt lgkmcnt(4)
s_add_u32 s22, s22, 1
s_cmp_ge_u32 s22, s23
s_cbranch_scc0 L_st_470
L_fl1_465:
s_waitcnt lgkmcnt(0)
s_nop 7
s_sub_u32 s39, s22, 1
s_bitcmp1_b32 s39, 1
s_cselect_b32 s38, s54, s55
s_add_u32 s38, s38, s44
s_lshl_b32 s42, s39, 20
s_add_u32 s38, s38, s42
s_cmp_eq_u32 s37, 0
s_cselect_b32 s38, 0x7ff00000, s38
s_mov_b32 s37, 1
v_cvt_pk_bf16_f32 v88, v68, v69
v_cvt_pk_bf16_f32 v89, v70, v71
v_cvt_pk_bf16_f32 v90, v72, v73
v_cvt_pk_bf16_f32 v91, v74, v75
buffer_store_dwordx4 v[88:91], v86, s[12:15], s38 offen offset:0
v_cvt_pk_bf16_f32 v92, v76, v77
v_cvt_pk_bf16_f32 v93, v78, v79
v_cvt_pk_bf16_f32 v94, v80, v81
v_cvt_pk_bf16_f32 v95, v82, v83
buffer_store_dwordx4 v[92:95], v86, s[12:15], s38 offen offset:128
s_waitcnt vmcnt(0)
s_barrier
s_mov_b32 s25, 0x5901f80
v_mov_b32 v2, 0
L_pl_473:
buffer_load_dword v1, v2, s[12:15], s25 offen sc1
s_add_u32 s36, s36, 1
s_cmp_gt_u32 s36, 0x100000
s_cbranch_scc1 chain_kernel_wend
s_waitcnt vmcnt(0)
v_readfirstlane_b32 s26, v1
s_cmp_ge_u32 s26, 64
s_cbranch_scc1 L_plok_474
s_sleep 4
s_branch L_pl_473
L_plok_474:
s_cmp_eq_u32 s45, 0
s_cbranch_scc1 L_anext_459
L_att_458:
s_waitcnt lgkmcnt(0)
s_add_u32 s38, s47, s49
s_mov_b32 s28, 0x3e0293ee
s_mov_b32 s29, 0x3db504f3
s_cmp_ge_u32 s22, 64
s_cbranch_scc1 L_asrv_475
ds_read_b64 v[216:217], v99 offset:512
ds_read_b64 v[218:219], v99 offset:1536
ds_read_b64 v[220:221], v99 offset:2560
ds_read_b64 v[222:223], v99 offset:3584
v_mfma_f32_32x32x16_bf16 v[200:215], v[104:107], v[136:139], v[240:255]
v_mfma_f32_32x32x16_bf16 v[200:215], v[108:111], v[140:143], v[200:215]
ds_read_b128 v[104:107], v97 offset:0
v_mfma_f32_32x32x16_bf16 v[200:215], v[112:115], v[144:147], v[200:215]
ds_read_b128 v[108:111], v97 offset:256
v_mfma_f32_32x32x16_bf16 v[200:215], v[116:119], v[148:151], v[200:215]
ds_read_b128 v[112:115], v97 offset:1024
v_mfma_f32_32x32x16_bf16 v[200:215], v[120:123], v[152:155], v[200:215]
ds_read_b128 v[116:119], v97 offset:1280
v_mfma_f32_32x32x16_bf16 v[200:215], v[124:127], v[156:159], v[200:215]
ds_read_b128 v[120:123], v97 offset:2048
v_mfma_f32_32x32x16_bf16 v[200:215], v[128:131], v[160:163], v[200:215]
ds_read_b128 v[124:127], v97 offset:2304
v_mfma_f32_32x32x16_bf16 v[200:215], v[132:135], v[164:167], v[200:215]
ds_read_b128 v[128:131], v97 offset:3072
ds_read_b128 v[132:135], v97 offset:3328
s_waitcnt lgkmcnt(2)
v_mfma_f32_32x32x16_bf16 v[68:83], v[104:107], v[136:139], 0
s_nop 0
v_mfma_f32_32x32x16_bf16 v[68:83], v[108:111], v[140:143], v[68:83]
v_max3_f32 v234, v200, v201, v202
s_nop 0
v_mfma_f32_32x32x16_bf16 v[68:83], v[112:115], v[144:147], v[68:83]
v_max3_f32 v235, v203, v204, v205
s_nop 0
v_mfma_f32_32x32x16_bf16 v[68:83], v[116:119], v[148:151], v[68:83]
v_max3_f32 v234, v234, v206, v207
s_nop 0
v_mfma_f32_32x32x16_bf16 v[68:83], v[120:123], v[152:155], v[68:83]
v_max3_f32 v235, v235, v208, v209
s_nop 0
v_mfma_f32_32x32x16_bf16 v[68:83], v[124:127], v[156:159], v[68:83]
v_max3_f32 v234, v234, v210, v211
s_waitcnt lgkmcnt(1)
v_mfma_f32_32x32x16_bf16 v[68:83], v[128:131], v[160:163], v[68:83]
v_max3_f32 v235, v235, v212, v213
s_waitcnt lgkmcnt(0)
v_mfma_f32_32x32x16_bf16 v[68:83], v[132:135], v[164:167], v[68:83]
v_max3_f32 v234, v234, v214, v215
s_nop 10
s_branch L_atail_476
L_asrv_475:
v_mfma_f32_32x32x16_bf16 v[200:215], v[104:107], v[136:139], v[240:255]
v_mfma_f32_32x32x16_bf16 v[200:215], v[108:111], v[140:143], v[200:215]
v_mfma_f32_32x32x16_bf16 v[200:215], v[112:115], v[144:147], v[200:215]
v_mfma_f32_32x32x16_bf16 v[200:215], v[116:119], v[148:151], v[200:215]
v_mfma_f32_32x32x16_bf16 v[200:215], v[120:123], v[152:155], v[200:215]
v_mfma_f32_32x32x16_bf16 v[200:215], v[124:127], v[156:159], v[200:215]
v_mfma_f32_32x32x16_bf16 v[200:215], v[128:131], v[160:163], v[200:215]
v_mfma_f32_32x32x16_bf16 v[200:215], v[132:135], v[164:167], v[200:215]
s_nop 11
v_max3_f32 v234, v200, v201, v202
v_max3_f32 v235, v203, v204, v205
v_max3_f32 v234, v234, v206, v207
v_max3_f32 v235, v235, v208, v209
v_max3_f32 v234, v234, v210, v211
v_max3_f32 v235, v235, v212, v213
v_max3_f32 v234, v234, v214, v215
s_add_u32 s27, s38, 1
s_sub_u32 s26, s38, 1
s_min_u32 s26, s26, 61
s_cmp_ge_u32 s38, 52
s_cselect_b32 s27, s26, s27
v_mov_b32 v2, 4
L_cw_477:
buffer_load_dword v1, v2, s[32:35], 0 offen sc1
s_add_u32 s36, s36, 1
s_cmp_gt_u32 s36, 0x100000
s_cbranch_scc1 chain_kernel_wend
s_waitcnt vmcnt(0)
v_readfirstlane_b32 s25, v1
s_cmp_ge_u32 s25, s27
s_cbranch_scc1 L_cwok_478
s_sleep 4
s_branch L_cw_477
L_cwok_478:
s_add_u32 m0, s7, 0
s_add_u32 s43, s48, 0x8000c00
buffer_load_dwordx4 v96, s[12:15], s43 offen sc1 lds
s_add_u32 m0, s7, 1024
s_add_u32 s43, s48, 0x8001c00
buffer_load_dwordx4 v96, s[12:15], s43 offen sc1 lds
s_add_u32 m0, s7, 2048
s_add_u32 s43, s48, 0x8004c00
buffer_load_dwordx4 v96, s[12:15], s43 offen sc1 lds
s_add_u32 m0, s7, 3072
s_add_u32 s43, s48, 0x8005c00
buffer_load_dwordx4 v96, s[12:15], s43 offen sc1 lds
s_add_u32 s36, s36, 1
s_cmp_gt_u32 s36, 0x100000
s_cbranch_scc1 chain_kernel_wend
s_waitcnt vmcnt(0)
ds_read_b128 v[104:107], v97 offset:0
ds_read_b128 v[108:111], v97 offset:256
ds_read_b64 v[216:217], v99 offset:512
ds_read_b128 v[112:115], v97 offset:1024
ds_read_b128 v[116:119], v97 offset:1280
ds_read_b64 v[218:219], v99 offset:1536
ds_read_b128 v[120:123], v97 offset:2048
ds_read_b128 v[124:127], v97 offset:2304
ds_read_b64 v[220:221], v99 offset:2560
ds_read_b128 v[128:131], v97 offset:3072
ds_read_b128 v[132:135], v97 offset:3328
ds_read_b64 v[222:223], v99 offset:3584
v_mov_b32 v1, 0
s_waitcnt lgkmcnt(11)
v_mfma_f32_32x32x16_bf16 v[68:83], v[104:107], v[136:139], 0
v_max3_u32 v1, v1, v104, v105
v_max3_u32 v1, v1, v106, v107
s_waitcnt lgkmcnt(9)
v_mfma_f32_32x32x16_bf16 v[68:83], v[108:111], v[140:143], v[68:83]
v_max3_u32 v1, v1, v108, v109
v_max3_u32 v1, v1, v110, v111
v_max3_u32 v1, v1, v216, v217
s_waitcnt lgkmcnt(8)
v_mfma_f32_32x32x16_bf16 v[68:83], v[112:115], v[144:147], v[68:83]
v_max3_u32 v1, v1, v112, v113
v_max3_u32 v1, v1, v114, v115
s_waitcnt lgkmcnt(6)
v_mfma_f32_32x32x16_bf16 v[68:83], v[116:119], v[148:151], v[68:83]
v_max3_u32 v1, v1, v116, v117
v_max3_u32 v1, v1, v118, v119
v_max3_u32 v1, v1, v218, v219
s_waitcnt lgkmcnt(5)
v_mfma_f32_32x32x16_bf16 v[68:83], v[120:123], v[152:155], v[68:83]
v_max3_u32 v1, v1, v120, v121
v_max3_u32 v1, v1, v122, v123
s_waitcnt lgkmcnt(3)
v_mfma_f32_32x32x16_bf16 v[68:83], v[124:127], v[156:159], v[68:83]
v_max3_u32 v1, v1, v124, v125
v_max3_u32 v1, v1, v126, v127
v_max3_u32 v1, v1, v220, v221
s_waitcnt lgkmcnt(2)
v_mfma_f32_32x32x16_bf16 v[68:83], v[128:131], v[160:163], v[68:83]
v_max3_u32 v1, v1, v128, v129
v_max3_u32 v1, v1, v130, v131
s_waitcnt lgkmcnt(0)
v_mfma_f32_32x32x16_bf16 v[68:83], v[132:135], v[164:167], v[68:83]
v_max3_u32 v1, v1, v132, v133
v_max3_u32 v1, v1, v134, v135
v_max3_u32 v1, v1, v222, v223
v_cmp_eq_u32 vcc, 0xff81ff81, v1
s_cbranch_vccnz L_cwok_478
s_nop 4
s_cmp_ge_u32 s47, 60
s_cbranch_scc1 L_atail_476
s_add_u32 s43, s50, 4194304
buffer_load_dwordx4 a[32:35], v96, s[12:15], s43 offen offset:0
s_add_u32 s43, s50, 4194304
buffer_load_dwordx4 a[36:39], v96, s[12:15], s43 offen offset:1024
s_add_u32 s43, s48, 4194304
buffer_load_dwordx4 a[0:3], v96, s[12:15], s43 offen offset:0
s_add_u32 s43, s48, 4194304
buffer_load_dwordx4 a[4:7], v96, s[12:15], s43 offen offset:1024
s_add_u32 s43, s50, 4198400
buffer_load_dwordx4 a[40:43], v96, s[12:15], s43 offen offset:2048
s_add_u32 s43, s50, 4198400
buffer_load_dwordx4 a[44:47], v96, s[12:15], s43 offen offset:3072
s_add_u32 s43, s48, 4198400
buffer_load_dwordx4 a[8:11], v96, s[12:15], s43 offen offset:0
s_add_u32 s43, s48, 4198400
buffer_load_dwordx4 a[12:15], v96, s[12:15], s43 offen offset:1024
s_add_u32 s43, s50, 4210688
buffer_load_dwordx4 a[48:51], v96, s[12:15], s43 offen offset:0
s_add_u32 s43, s50, 4210688
buffer_load_dwordx4 a[52:55], v96, s[12:15], s43 offen offset:1024
s_add_u32 s43, s48, 4210688
buffer_load_dwordx4 a[16:19], v96, s[12:15], s43 offen offset:0
s_add_u32 s43, s48, 4210688
buffer_load_dwordx4 a[20:23], v96, s[12:15], s43 offen offset:1024
s_add_u32 s43, s50, 4214784
buffer_load_dwordx4 a[56:59], v96, s[12:15], s43 offen offset:2048
s_add_u32 s43, s50, 4214784
buffer_load_dwordx4 a[60:63], v96, s[12:15], s43 offen offset:3072
s_add_u32 s43, s48, 4214784
buffer_load_dwordx4 a[24:27], v96, s[12:15], s43 offen offset:0
s_add_u32 s43, s48, 4214784
buffer_load_dwordx4 a[28:31], v96, s[12:15], s43 offen offset:1024
s_add_u32 s43, s48, 4194304
buffer_load_dwordx4 a[64:67], v98, s[12:15], s43 offen offset:2048
s_add_u32 s43, s48, 4194304
buffer_load_dwordx4 a[68:71], v98, s[12:15], s43 offen offset:3072
s_add_u32 s43, s48, 4198400
buffer_load_dwordx4 a[72:75], v98, s[12:15], s43 offen offset:2048
s_add_u32 s43, s48, 4198400
buffer_load_dwordx4 a[76:79], v98, s[12:15], s43 offen offset:3072
s_add_u32 s43, s48, 4210688
buffer_load_dwordx4 a[80:83], v98, s[12:15], s43 offen offset:2048
s_add_u32 s43, s48, 4210688
buffer_load_dwordx4 a[84:87], v98, s[12:15], s43 offen offset:3072
s_add_u32 s43, s48, 4214784
buffer_load_dwordx4 a[88:91], v98, s[12:15], s43 offen offset:2048
s_add_u32 s43, s48, 4214784
buffer_load_dwordx4 a[92:95], v98, s[12:15], s43 offen offset:3072
L_atail_476:
v_max3_f32 v235, v235, v68, v69
v_max3_f32 v234, v234, v70, v71
v_max_f32 v234, v234, v235
v_mov_b32 v235, v234
s_nop 1
v_permlane32_swap_b32 v234, v235
s_nop 0
v_max_f32 v234, v234, v235
v_mul_f32 v234, s28, v234
v_fma_f32 v200, v200, s28, -v234
v_fma_f32 v201, v201, s28, -v234
v_fma_f32 v202, v202, s28, -v234
v_fma_f32 v203, v203, s28, -v234
v_fma_f32 v204, v204, s28, -v234
v_fma_f32 v205, v205, s28, -v234
v_fma_f32 v206, v206, s28, -v234
v_fma_f32 v207, v207, s28, -v234
v_fma_f32 v208, v208, s28, -v234
v_fma_f32 v209, v209, s28, -v234
v_fma_f32 v210, v210, s28, -v234
v_fma_f32 v211, v211, s28, -v234
v_fma_f32 v212, v212, s28, -v234
v_fma_f32 v213, v213, s28, -v234
v_fma_f32 v214, v214, s28, -v234
v_fma_f32 v215, v215, s28, -v234
v_fma_f32 v68, v68, s28, -v234
v_fma_f32 v69, v69, s28, -v234
v_fma_f32 v70, v70, s28, -v234
v_fma_f32 v71, v71, s28, -v234
v_exp_f32 v200, v200
v_exp_f32 v201, v201
v_exp_f32 v202, v202
v_exp_f32 v203, v203
v_exp_f32 v204, v204
v_exp_f32 v205, v205
v_exp_f32 v206, v206
v_exp_f32 v207, v207
v_exp_f32 v208, v208
v_exp_f32 v209, v209
v_exp_f32 v210, v210
v_exp_f32 v211, v211
v_exp_f32 v212, v212
v_exp_f32 v213, v213
v_exp_f32 v214, v214
v_exp_f32 v215, v215
v_exp_f32 v68, v68
v_exp_f32 v69, v69
v_exp_f32 v70, v70
v_exp_f32 v71, v71
v_pk_add_f32 v[236:237], v[200:201], v[202:203]
v_pk_add_f32 v[236:237], v[236:237], v[204:205]
v_pk_add_f32 v[236:237], v[236:237], v[206:207]
v_pk_add_f32 v[236:237], v[236:237], v[208:209]
v_pk_add_f32 v[236:237], v[236:237], v[210:211]
v_pk_add_f32 v[236:237], v[236:237], v[212:213]
v_pk_add_f32 v[236:237], v[236:237], v[214:215]
v_pk_add_f32 v[236:237], v[236:237], v[68:69]
v_pk_add_f32 v[236:237], v[236:237], v[70:71]
v_add_f32 v236, v236, v237
v_mov_b32 v235, v236
s_nop 1
v_permlane32_swap_b32 v236, v235
s_nop 0
v_add_f32 v236, v236, v235
v_rcp_f32 v236, v236
s_nop 0
v_pk_mul_f32 v[200:201], v[200:201], v[236:237] op_sel_hi:[1,0]
v_pk_mul_f32 v[202:203], v[202:203], v[236:237] op_sel_hi:[1,0]
v_pk_mul_f32 v[204:205], v[204:205], v[236:237] op_sel_hi:[1,0]
v_pk_mul_f32 v[206:207], v[206:207], v[236:237] op_sel_hi:[1,0]
v_pk_mul_f32 v[208:209], v[208:209], v[236:237] op_sel_hi:[1,0]
v_pk_mul_f32 v[210:211], v[210:211], v[236:237] op_sel_hi:[1,0]
v_pk_mul_f32 v[212:213], v[212:213], v[236:237] op_sel_hi:[1,0]
v_pk_mul_f32 v[214:215], v[214:215], v[236:237] op_sel_hi:[1,0]
v_pk_mul_f32 v[68:69], v[68:69], v[236:237] op_sel_hi:[1,0]
v_pk_mul_f32 v[70:71], v[70:71], v[236:237] op_sel_hi:[1,0]
v_cvt_pk_bf16_f32 v224, v200, v201
v_cvt_pk_bf16_f32 v225, v202, v203
v_cvt_pk_bf16_f32 v226, v204, v205
v_cvt_pk_bf16_f32 v227, v206, v207
v_cvt_pk_bf16_f32 v228, v208, v209
v_cvt_pk_bf16_f32 v229, v210, v211
v_cvt_pk_bf16_f32 v230, v212, v213
v_cvt_pk_bf16_f32 v231, v214, v215
v_cvt_pk_bf16_f32 v232, v68, v69
v_cvt_pk_bf16_f32 v233, v70, v71
s_nop 1
v_mfma_f32_32x32x16_bf16 v[104:119], v[168:171], v[224:227], 0
v_mfma_f32_32x32x16_bf16 v[104:119], v[172:175], v[228:231], v[104:119]
s_lshl_b32 s25, s38, 9
s_lshr_b32 s26, s46, 3
s_lshl_b32 s26, s26, 7
s_add_u32 s25, s25, s26
v_mfma_f32_32x32x8_bf16 v[104:119], v[216:217], v[232:233], v[104:119]
s_add_u32 s51, s25, 0x5904000
s_mov_b32 s94, s50
s_add_u32 s47, s47, 4
v_mfma_f32_32x32x16_bf16 v[120:135], v[176:179], v[224:227], 0
v_mfma_f32_32x32x16_bf16 v[120:135], v[180:183], v[228:231], v[120:135]
v_cvt_pk_bf16_f32 v168, v104, v105
v_cvt_pk_bf16_f32 v169, v106, v107
v_cvt_pk_bf16_f32 v170, v108, v109
v_cvt_pk_bf16_f32 v171, v110, v111
v_mfma_f32_32x32x8_bf16 v[120:135], v[218:219], v[232:233], v[120:135]
v_cvt_pk_bf16_f32 v172, v112, v113
v_cvt_pk_bf16_f32 v173, v114, v115
v_cvt_pk_bf16_f32 v174, v116, v117
v_cvt_pk_bf16_f32 v175, v118, v119
v_mfma_f32_32x32x16_bf16 v[136:151], v[184:187], v[224:227], 0
v_mfma_f32_32x32x16_bf16 v[136:151], v[188:191], v[228:231], v[136:151]
v_cvt_pk_bf16_f32 v176, v120, v121
v_cvt_pk_bf16_f32 v177, v122, v123
v_cvt_pk_bf16_f32 v178, v124, v125
v_cvt_pk_bf16_f32 v179, v126, v127
v_mfma_f32_32x32x8_bf16 v[136:151], v[220:221], v[232:233], v[136:151]
v_cvt_pk_bf16_f32 v180, v128, v129
v_cvt_pk_bf16_f32 v181, v130, v131
v_cvt_pk_bf16_f32 v182, v132, v133
v_cvt_pk_bf16_f32 v183, v134, v135
v_mfma_f32_32x32x16_bf16 v[152:167], v[192:195], v[224:227], 0
v_mfma_f32_32x32x16_bf16 v[152:167], v[196:199], v[228:231], v[152:167]
v_cvt_pk_bf16_f32 v184, v136, v137
v_cvt_pk_bf16_f32 v185, v138, v139
v_cvt_pk_bf16_f32 v186, v140, v141
v_cvt_pk_bf16_f32 v187, v142, v143
v_mfma_f32_32x32x8_bf16 v[152:167], v[222:223], v[232:233], v[152:167]
v_cvt_pk_bf16_f32 v188, v144, v145
v_cvt_pk_bf16_f32 v189, v146, v147
v_cvt_pk_bf16_f32 v190, v148, v149
v_cvt_pk_bf16_f32 v191, v150, v151
s_nop 7
v_cvt_pk_bf16_f32 v192, v152, v153
v_cvt_pk_bf16_f32 v193, v154, v155
v_cvt_pk_bf16_f32 v194, v156, v157
v_cvt_pk_bf16_f32 v195, v158, v159
v_cvt_pk_bf16_f32 v196, v160, v161
v_cvt_pk_bf16_f32 v197, v162, v163
v_cvt_pk_bf16_f32 v198, v164, v165
v_cvt_pk_bf16_f32 v199, v166, v167
L_anext_459:
s_add_u32 s27, s47, s49
s_lshl_b32 s25, s27, 20
s_lshl_b32 s26, s46, 15
s_add_u32 s25, s25, s26
s_bitcmp1_b32 s27, 1
s_cselect_b32 s48, s55, s54
s_cselect_b32 s50, s54, s55
s_add_u32 s48, s48, s25
s_add_u32 s50, s50, s25
s_waitcnt lgkmcnt(4)
s_cmp_ge_u32 s22, 64
s_cbranch_scc1 L_aserve_471
v_readfirstlane_b32 s25, v87
s_and_b32 s26, s46, 1
s_mul_i32 s26, s26, 2
s_sub_u32 s25, s25, s26
s_sub_u32 s26, s22, 3
s_min_i32 s25, s25, s26
s_add_u32 s26, s47, 4
s_cmp_ge_i32 s25, s26
s_cbranch_scc1 L_ago_479
s_cmp_eq_u32 s45, 0
s_mov_b32 s45, 0
s_cbranch_scc1 L_attr_460
s_branch L_attr_462
L_ago_479:
s_cmp_eq_u32 s45, 0
s_mov_b32 s45, 1
s_cbranch_scc1 L_attr_461
s_branch L_attr_463
L_aserve_471:
s_cmp_eq_u32 s45, 0
s_cbranch_scc1 L_afirst_480
s_add_u32 s43, s94, 0
buffer_store_dwordx4 v[168:171], v100, s[12:15], s43 offen offset:2048 sc1
s_add_u32 s43, s94, 0
buffer_store_dwordx4 v[172:175], v100, s[12:15], s43 offen offset:2560 sc1
s_add_u32 s43, s94, 4096
buffer_store_dwordx4 v[176:179], v100, s[12:15], s43 offen offset:0 sc1
s_add_u32 s43, s94, 4096
buffer_store_dwordx4 v[180:183], v100, s[12:15], s43 offen offset:512 sc1
s_add_u32 s43, s94, 16384
buffer_store_dwordx4 v[184:187], v100, s[12:15], s43 offen offset:2048 sc1
s_add_u32 s43, s94, 16384
buffer_store_dwordx4 v[188:191], v100, s[12:15], s43 offen offset:2560 sc1
s_add_u32 s43, s94, 20480
buffer_store_dwordx4 v[192:195], v100, s[12:15], s43 offen offset:0 sc1
s_add_u32 s43, s94, 20480
buffer_store_dwordx4 v[196:199], v100, s[12:15], s43 offen offset:512 sc1
s_waitcnt vmcnt(0)
buffer_atomic_add v84, v85, s[12:15], s51 offen sc1
s_cmp_ge_u32 s47, 64
s_cbranch_scc1 L_afin_472
v_accvgpr_read_b32 v104, a0
v_accvgpr_read_b32 v105, a1
v_accvgpr_read_b32 v106, a2
v_accvgpr_read_b32 v107, a3
v_accvgpr_read_b32 v108, a4
v_accvgpr_read_b32 v109, a5
v_accvgpr_read_b32 v110, a6
v_accvgpr_read_b32 v111, a7
v_accvgpr_read_b32 v112, a8
v_accvgpr_read_b32 v113, a9
v_accvgpr_read_b32 v114, a10
v_accvgpr_read_b32 v115, a11
v_accvgpr_read_b32 v116, a12
v_accvgpr_read_b32 v117, a13
v_accvgpr_read_b32 v118, a14
v_accvgpr_read_b32 v119, a15
v_accvgpr_read_b32 v120, a16
v_accvgpr_read_b32 v121, a17
v_accvgpr_read_b32 v122, a18
v_accvgpr_read_b32 v123, a19
v_accvgpr_read_b32 v124, a20
v_accvgpr_read_b32 v125, a21
v_accvgpr_read_b32 v126, a22
v_accvgpr_read_b32 v127, a23
v_accvgpr_read_b32 v128, a24
v_accvgpr_read_b32 v129, a25
v_accvgpr_read_b32 v130, a26
v_accvgpr_read_b32 v131, a27
v_accvgpr_read_b32 v132, a28
v_accvgpr_read_b32 v133, a29
v_accvgpr_read_b32 v134, a30
v_accvgpr_read_b32 v135, a31
v_accvgpr_read_b32 v136, a32
v_accvgpr_read_b32 v137, a33
v_accvgpr_read_b32 v138, a34
v_accvgpr_read_b32 v139, a35
v_accvgpr_read_b32 v140, a36
v_accvgpr_read_b32 v141, a37
v_accvgpr_read_b32 v142, a38
v_accvgpr_read_b32 v143, a39
v_accvgpr_read_b32 v144, a40
v_accvgpr_read_b32 v145, a41
v_accvgpr_read_b32 v146, a42
v_accvgpr_read_b32 v147, a43
v_accvgpr_read_b32 v148, a44
v_accvgpr_read_b32 v149, a45
v_accvgpr_read_b32 v150, a46
v_accvgpr_read_b32 v151, a47
v_accvgpr_read_b32 v152, a48
v_accvgpr_read_b32 v153, a49
v_accvgpr_read_b32 v154, a50
v_accvgpr_read_b32 v155, a51
v_accvgpr_read_b32 v156, a52
v_accvgpr_read_b32 v157, a53
v_accvgpr_read_b32 v158, a54
v_accvgpr_read_b32 v159, a55
v_accvgpr_read_b32 v160, a56
v_accvgpr_read_b32 v161, a57
v_accvgpr_read_b32 v162, a58
v_accvgpr_read_b32 v163, a59
v_accvgpr_read_b32 v164, a60
v_accvgpr_read_b32 v165, a61
v_accvgpr_read_b32 v166, a62
v_accvgpr_read_b32 v167, a63
v_accvgpr_read_b32 v168, a64
v_accvgpr_read_b32 v169, a65
v_accvgpr_read_b32 v170, a66
v_accvgpr_read_b32 v171, a67
v_accvgpr_read_b32 v172, a68
v_accvgpr_read_b32 v173, a69
v_accvgpr_read_b32 v174, a70
v_accvgpr_read_b32 v175, a71
v_accvgpr_read_b32 v176, a72
v_accvgpr_read_b32 v177, a73
v_accvgpr_read_b32 v178, a74
v_accvgpr_read_b32 v179, a75
v_accvgpr_read_b32 v180, a76
v_accvgpr_read_b32 v181, a77
v_accvgpr_read_b32 v182, a78
v_accvgpr_read_b32 v183, a79
v_accvgpr_read_b32 v184, a80
v_accvgpr_read_b32 v185, a81
v_accvgpr_read_b32 v186, a82
v_accvgpr_read_b32 v187, a83
v_accvgpr_read_b32 v188, a84
v_accvgpr_read_b32 v189, a85
v_accvgpr_read_b32 v190, a86
v_accvgpr_read_b32 v191, a87
v_accvgpr_read_b32 v192, a88
v_accvgpr_read_b32 v193, a89
v_accvgpr_read_b32 v194, a90
v_accvgpr_read_b32 v195, a91
v_accvgpr_read_b32 v196, a92
v_accvgpr_read_b32 v197, a93
v_accvgpr_read_b32 v198, a94
v_accvgpr_read_b32 v199, a95
s_branch L_att_458
L_afirst_480:
s_add_u32 s43, s50, 0
buffer_load_dwordx4 v[136:139], v96, s[12:15], s43 offen offset:0
s_add_u32 s43, s50, 0
buffer_load_dwordx4 v[140:143], v96, s[12:15], s43 offen offset:1024
s_add_u32 s43, s48, 0
buffer_load_dwordx4 v[104:107], v96, s[12:15], s43 offen offset:0
s_add_u32 s43, s48, 0
buffer_load_dwordx4 v[108:111], v96, s[12:15], s43 offen offset:1024
s_add_u32 s43, s50, 4096
buffer_load_dwordx4 v[144:147], v96, s[12:15], s43 offen offset:2048
s_add_u32 s43, s50, 4096
buffer_load_dwordx4 v[148:151], v96, s[12:15], s43 offen offset:3072
s_add_u32 s43, s48, 4096
buffer_load_dwordx4 v[112:115], v96, s[12:15], s43 offen offset:0
s_add_u32 s43, s48, 4096
buffer_load_dwordx4 v[116:119], v96, s[12:15], s43 offen offset:1024
s_add_u32 s43, s50, 16384
buffer_load_dwordx4 v[152:155], v96, s[12:15], s43 offen offset:0
s_add_u32 s43, s50, 16384
buffer_load_dwordx4 v[156:159], v96, s[12:15], s43 offen offset:1024
s_add_u32 s43, s48, 16384
buffer_load_dwordx4 v[120:123], v96, s[12:15], s43 offen offset:0
s_add_u32 s43, s48, 16384
buffer_load_dwordx4 v[124:127], v96, s[12:15], s43 offen offset:1024
s_add_u32 s43, s50, 20480
buffer_load_dwordx4 v[160:163], v96, s[12:15], s43 offen offset:2048
s_add_u32 s43, s50, 20480
buffer_load_dwordx4 v[164:167], v96, s[12:15], s43 offen offset:3072
s_add_u32 s43, s48, 20480
buffer_load_dwordx4 v[128:131], v96, s[12:15], s43 offen offset:0
s_add_u32 s43, s48, 20480
buffer_load_dwordx4 v[132:135], v96, s[12:15], s43 offen offset:1024
s_add_u32 s43, s48, 0
buffer_load_dwordx4 v[168:171], v98, s[12:15], s43 offen offset:2048
s_add_u32 s43, s48, 0
buffer_load_dwordx4 v[172:175], v98, s[12:15], s43 offen offset:3072
s_add_u32 s43, s48, 4096
buffer_load_dwordx4 v[176:179], v98, s[12:15], s43 offen offset:2048
s_add_u32 s43, s48, 4096
buffer_load_dwordx4 v[180:183], v98, s[12:15], s43 offen offset:3072
s_add_u32 s43, s48, 16384
buffer_load_dwordx4 v[184:187], v98, s[12:15], s43 offen offset:2048
s_add_u32 s43, s48, 16384
buffer_load_dwordx4 v[188:191], v98, s[12:15], s43 offen offset:3072
s_add_u32 s43, s48, 20480
buffer_load_dwordx4 v[192:195], v98, s[12:15], s43 offen offset:2048
s_add_u32 s43, s48, 20480
buffer_load_dwordx4 v[196:199], v98, s[12:15], s43 offen offset:3072
s_mov_b32 s45, 1
s_waitcnt vmcnt(0)
s_branch L_att_458
L_afin_472:
s_branch L_ste_466
L_fl0_464:
s_waitcnt lgkmcnt(0)
s_nop 7
L_ste_466:
s_branch chain_kernel_wend
L_g1_441:
s_cmp_ge_u32 s41, 16
s_cbranch_scc1 L_g2_442
s_mov_b32 s8, s64
s_and_b32 s9, s65, 0xffff
s_mov_b32 s10, 0x400000
s_mov_b32 s11, 0x00020000
v_lshlrev_b32 v1, 4, v0
s_lshl_b32 s25, s41, 12
buffer_load_dwordx4 v[52:55], v1, s[8:11], s25 offen
s_add_u32 s25, s25, 65536
buffer_load_dwordx4 v[52:55], v1, s[8:11], s25 offen
s_add_u32 s25, s25, 65536
buffer_load_dwordx4 v[52:55], v1, s[8:11], s25 offen
s_add_u32 s25, s25, 65536
buffer_load_dwordx4 v[52:55], v1, s[8:11], s25 offen
s_add_u32 s25, s25, 65536
s_lshl_b32 s46, s41, 6
s_lshl_b32 s25, s49, 4
s_add_u32 s46, s46, s25
v_and_b32 v1, 15, v0
v_add_u32 v1, s46, v1
v_bfe_u32 v2, v0, 4, 2
v_lshlrev_b32 v3, 1, v1
s_mov_b32 s16, s66
s_and_b32 s17, s67, 0xffff
s_mov_b32 s18, 0x800
s_mov_b32 s19, 0x00020000
buffer_load_ushort v128, v3, s[16:19], 0 offen
s_mov_b32 s16, s68
s_and_b32 s17, s69, 0xffff
s_mov_b32 s18, 0x800
s_mov_b32 s19, 0x00020000
buffer_load_ushort v129, v3, s[16:19], 0 offen
s_mov_b32 s16, s78
s_and_b32 s17, s79, 0xffff
s_mov_b32 s18, 0x800
s_mov_b32 s19, 0x00020000
buffer_load_ushort v130, v3, s[16:19], 0 offen
s_mov_b32 s16, s70
s_and_b32 s17, s71, 0xffff
s_mov_b32 s18, 0x200000
s_mov_b32 s19, 0x00020000
s_mov_b32 s32, s72
s_and_b32 s33, s73, 0xffff
s_mov_b32 s34, 0x200000
s_mov_b32 s35, 0x00020000
v_and_b32 v5, 3, v0
v_cmp_eq_u32 vcc, v5, v2
v_and_b32 v5, 1, v0
v_lshlrev_b32 v5, 4, v5
v_cndmask_b32 v116, 0, 1.0, vcc
v_mov_b32 v6, 0x3f80
v_lshlrev_b32 v6, v5, v6
v_bfe_u32 v5, v0, 1, 3
v_lshlrev_b32 v7, 2, v2
v_sub_u32 v5, v5, v7
v_cmp_eq_i32 vcc, 0, v5
s_nop 1
v_cndmask_b32 v172, 0, v6, vcc
v_cmp_eq_i32 vcc, 1, v5
s_nop 1
v_cndmask_b32 v173, 0, v6, vcc
v_cmp_eq_i32 vcc, 2, v5
s_nop 1
v_cndmask_b32 v174, 0, v6, vcc
v_cmp_eq_i32 vcc, 3, v5
s_nop 1
v_cndmask_b32 v175, 0, v6, vcc
v_cmp_eq_i32 vcc, -8, v5
s_nop 1
v_cndmask_b32 v176, 0, v6, vcc
v_cmp_eq_i32 vcc, -7, v5
s_nop 1
v_cndmask_b32 v177, 0, v6, vcc
v_cmp_eq_i32 vcc, -6, v5
s_nop 1
v_cndmask_b32 v178, 0, v6, vcc
v_cmp_eq_i32 vcc, -5, v5
s_nop 1
v_cndmask_b32 v179, 0, v6, vcc
s_lshl_b32 s25, s46, 6
v_and_b32 v5, 15, v0
v_lshlrev_b32 v5, 4, v5
v_bfe_u32 v6, v0, 5, 1
v_lshl_add_u32 v5, v6, 9, v5
v_bfe_u32 v6, v0, 4, 1
v_lshl_add_u32 v5, v6, 3, v5
v_add_u32 v86, s25, v5
v_and_b32 v1, 31, v0
v_bfe_u32 v2, v0, 5, 1
v_add_u32 v3, 0, v2
v_xor_b32 v4, v3, v1
v_lshlrev_b32 v4, 4, v4
v_add_u32 v3, s46, v3
v_lshl_add_u32 v20, v3, 11, v4
v_add_u32 v3, 2, v2
v_xor_b32 v4, v3, v1
v_lshlrev_b32 v4, 4, v4
v_add_u32 v3, s46, v3
v_lshl_add_u32 v21, v3, 11, v4
v_add_u32 v3, 4, v2
v_xor_b32 v4, v3, v1
v_lshlrev_b32 v4, 4, v4
v_add_u32 v3, s46, v3
v_lshl_add_u32 v22, v3, 11, v4
v_add_u32 v3, 6, v2
v_xor_b32 v4, v3, v1
v_lshlrev_b32 v4, 4, v4
v_add_u32 v3, s46, v3
v_lshl_add_u32 v23, v3, 11, v4
v_add_u32 v3, 8, v2
v_xor_b32 v4, v3, v1
v_lshlrev_b32 v4, 4, v4
v_add_u32 v3, s46, v3
v_lshl_add_u32 v24, v3, 11, v4
v_add_u32 v3, 10, v2
v_xor_b32 v4, v3, v1
v_lshlrev_b32 v4, 4, v4
v_add_u32 v3, s46, v3
v_lshl_add_u32 v25, v3, 11, v4
v_add_u32 v3, 12, v2
v_xor_b32 v4, v3, v1
v_lshlrev_b32 v4, 4, v4
v_add_u32 v3, s46, v3
v_lshl_add_u32 v26, v3, 11, v4
v_add_u32 v3, 14, v2
v_xor_b32 v4, v3, v1
v_lshlrev_b32 v4, 4, v4
v_add_u32 v3, s46, v3
v_lshl_add_u32 v27, v3, 11, v4
v_and_b32 v1, 15, v0
v_bfe_u32 v2, v0, 4, 2
v_lshrrev_b32 v3, 6, v0
v_lshlrev_b32 v3, 15, v3
v_lshl_add_u32 v3, v1, 9, v3
v_add_u32 v4, 0, v2
v_xor_b32 v4, v4, v1
v_lshl_add_u32 v28, v4, 4, v3
v_add_u32 v4, 4, v2
v_xor_b32 v4, v4, v1
v_lshl_add_u32 v29, v4, 4, v3
v_add_u32 v4, 8, v2
v_xor_b32 v4, v4, v1
v_lshl_add_u32 v30, v4, 4, v3
v_add_u32 v4, 12, v2
v_xor_b32 v4, v4, v1
v_lshl_add_u32 v31, v4, 4, v3
s_lshl_b32 s26, s49, 15
s_barrier
s_mov_b32 s27, 0
s_add_u32 m0, s26, 0
s_nop 0
buffer_load_dwordx4 v20, s[16:19], s27 offen nt lds
s_add_u32 m0, s26, 1024
s_nop 0
buffer_load_dwordx4 v21, s[16:19], s27 offen nt lds
s_add_u32 m0, s26, 2048
s_nop 0
buffer_load_dwordx4 v22, s[16:19], s27 offen nt lds
s_add_u32 m0, s26, 3072
s_nop 0
buffer_load_dwordx4 v23, s[16:19], s27 offen nt lds
s_add_u32 m0, s26, 4096
s_nop 0
buffer_load_dwordx4 v24, s[16:19], s27 offen nt lds
s_add_u32 m0, s26, 5120
s_nop 0
buffer_load_dwordx4 v25, s[16:19], s27 offen nt lds
s_add_u32 m0, s26, 6144
s_nop 0
buffer_load_dwordx4 v26, s[16:19], s27 offen nt lds
s_add_u32 m0, s26, 7168
s_nop 0
buffer_load_dwordx4 v27, s[16:19], s27 offen nt lds
s_mov_b32 s27, 0
s_add_u32 m0, s26, 8192
s_nop 0
buffer_load_dwordx4 v20, s[32:35], s27 offen nt lds
s_add_u32 m0, s26, 9216
s_nop 0
buffer_load_dwordx4 v21, s[32:35], s27 offen nt lds
s_add_u32 m0, s26, 10240
s_nop 0
buffer_load_dwordx4 v22, s[32:35], s27 offen nt lds
s_add_u32 m0, s26, 11264
s_nop 0
buffer_load_dwordx4 v23, s[32:35], s27 offen nt lds
s_add_u32 m0, s26, 12288
s_nop 0
buffer_load_dwordx4 v24, s[32:35], s27 offen nt lds
s_add_u32 m0, s26, 13312
s_nop 0
buffer_load_dwordx4 v25, s[32:35], s27 offen nt lds
s_add_u32 m0, s26, 14336
s_nop 0
buffer_load_dwordx4 v26, s[32:35], s27 offen nt lds
s_add_u32 m0, s26, 15360
s_nop 0
buffer_load_dwordx4 v27, s[32:35], s27 offen nt lds
s_mov_b32 s27, 512
s_add_u32 m0, s26, 16384
s_nop 0
buffer_load_dwordx4 v20, s[16:19], s27 offen nt lds
s_add_u32 m0, s26, 17408
s_nop 0
buffer_load_dwordx4 v21, s[16:19], s27 offen nt lds
s_add_u32 m0, s26, 18432
s_nop 0
buffer_load_dwordx4 v22, s[16:19], s27 offen nt lds
s_add_u32 m0, s26, 19456
s_nop 0
buffer_load_dwordx4 v23, s[16:19], s27 offen nt lds
s_add_u32 m0, s26, 20480
s_nop 0
buffer_load_dwordx4 v24, s[16:19], s27 offen nt lds
s_add_u32 m0, s26, 21504
s_nop 0
buffer_load_dwordx4 v25, s[16:19], s27 offen nt lds
s_add_u32 m0, s26, 22528
s_nop 0
buffer_load_dwordx4 v26, s[16:19], s27 offen nt lds
s_add_u32 m0, s26, 23552
s_nop 0
buffer_load_dwordx4 v27, s[16:19], s27 offen nt lds
s_mov_b32 s27, 512
s_add_u32 m0, s26, 24576
s_nop 0
buffer_load_dwordx4 v20, s[32:35], s27 offen nt lds
s_add_u32 m0, s26, 25600
s_nop 0
buffer_load_dwordx4 v21, s[32:35], s27 offen nt lds
s_add_u32 m0, s26, 26624
s_nop 0
buffer_load_dwordx4 v22, s[32:35], s27 offen nt lds
s_add_u32 m0, s26, 27648
s_nop 0
buffer_load_dwordx4 v23, s[32:35], s27 offen nt lds
s_add_u32 m0, s26, 28672
s_nop 0
buffer_load_dwordx4 v24, s[32:35], s27 offen nt lds
s_add_u32 m0, s26, 29696
s_nop 0
buffer_load_dwordx4 v25, s[32:35], s27 offen nt lds
s_add_u32 m0, s26, 30720
s_nop 0
buffer_load_dwordx4 v26, s[32:35], s27 offen nt lds
s_add_u32 m0, s26, 31744
s_nop 0
buffer_load_dwordx4 v27, s[32:35], s27 offen nt lds
s_waitcnt vmcnt(16)
ds_read_b128 a[0:3], v28 offset:0
ds_read_b128 a[4:7], v28 offset:8192
ds_read_b128 a[8:11], v29 offset:0
ds_read_b128 a[12:15], v29 offset:8192
ds_read_b128 a[16:19], v30 offset:0
ds_read_b128 a[20:23], v30 offset:8192
ds_read_b128 a[24:27], v31 offset:0
ds_read_b128 a[28:31], v31 offset:8192
s_waitcnt lgkmcnt(0)
ds_read_b128 a[32:35], v28 offset:256
ds_read_b128 a[36:39], v28 offset:8448
ds_read_b128 a[40:43], v29 offset:256
ds_read_b128 a[44:47], v29 offset:8448
ds_read_b128 a[48:51], v30 offset:256
ds_read_b128 a[52:55], v30 offset:8448
ds_read_b128 a[56:59], v31 offset:256
ds_read_b128 a[60:63], v31 offset:8448
s_waitcnt lgkmcnt(0)
s_mov_b32 s27, 1024
s_add_u32 m0, s26, 0
s_nop 0
buffer_load_dwordx4 v20, s[16:19], s27 offen nt lds
s_add_u32 m0, s26, 1024
s_nop 0
buffer_load_dwordx4 v21, s[16:19], s27 offen nt lds
s_add_u32 m0, s26, 2048
s_nop 0
buffer_load_dwordx4 v22, s[16:19], s27 offen nt lds
s_add_u32 m0, s26, 3072
s_nop 0
buffer_load_dwordx4 v23, s[16:19], s27 offen nt lds
s_add_u32 m0, s26, 4096
s_nop 0
buffer_load_dwordx4 v24, s[16:19], s27 offen nt lds
s_add_u32 m0, s26, 5120
s_nop 0
buffer_load_dwordx4 v25, s[16:19], s27 offen nt lds
s_add_u32 m0, s26, 6144
s_nop 0
buffer_load_dwordx4 v26, s[16:19], s27 offen nt lds
s_add_u32 m0, s26, 7168
s_nop 0
buffer_load_dwordx4 v27, s[16:19], s27 offen nt lds
s_mov_b32 s27, 1024
s_add_u32 m0, s26, 8192
s_nop 0
buffer_load_dwordx4 v20, s[32:35], s27 offen nt lds
s_add_u32 m0, s26, 9216
s_nop 0
buffer_load_dwordx4 v21, s[32:35], s27 offen nt lds
s_add_u32 m0, s26, 10240
s_nop 0
buffer_load_dwordx4 v22, s[32:35], s27 offen nt lds
s_add_u32 m0, s26, 11264
s_nop 0
buffer_load_dwordx4 v23, s[32:35], s27 offen nt lds
s_add_u32 m0, s26, 12288
s_nop 0
buffer_load_dwordx4 v24, s[32:35], s27 offen nt lds
s_add_u32 m0, s26, 13312
s_nop 0
buffer_load_dwordx4 v25, s[32:35], s27 offen nt lds
s_add_u32 m0, s26, 14336
s_nop 0
buffer_load_dwordx4 v26, s[32:35], s27 offen nt lds
s_add_u32 m0, s26, 15360
s_nop 0
buffer_load_dwordx4 v27, s[32:35], s27 offen nt lds
s_waitcnt vmcnt(16)
ds_read_b128 a[64:67], v28 offset:16384
ds_read_b128 a[68:71], v28 offset:24576
ds_read_b128 a[72:75], v29 offset:16384
ds_read_b128 a[76:79], v29 offset:24576
ds_read_b128 a[80:83], v30 offset:16384
ds_read_b128 a[84:87], v30 offset:24576
ds_read_b128 a[88:91], v31 offset:16384
ds_read_b128 a[92:95], v31 offset:24576
s_waitcnt lgkmcnt(0)
ds_read_b128 a[96:99], v28 offset:16640
ds_read_b128 a[100:103], v28 offset:24832
ds_read_b128 a[104:107], v29 offset:16640
ds_read_b128 a[108:111], v29 offset:24832
ds_read_b128 a[112:115], v30 offset:16640
ds_read_b128 a[116:119], v30 offset:24832
ds_read_b128 a[120:123], v31 offset:16640
ds_read_b128 a[124:127], v31 offset:24832
s_waitcnt lgkmcnt(0)
s_mov_b32 s27, 1536
s_add_u32 m0, s26, 16384
s_nop 0
buffer_load_dwordx4 v20, s[16:19], s27 offen nt lds
s_add_u32 m0, s26, 17408
s_nop 0
buffer_load_dwordx4 v21, s[16:19], s27 offen nt lds
s_add_u32 m0, s26, 18432
s_nop 0
buffer_load_dwordx4 v22, s[16:19], s27 offen nt lds
s_add_u32 m0, s26, 19456
s_nop 0
buffer_load_dwordx4 v23, s[16:19], s27 offen nt lds
s_add_u32 m0, s26, 20480
s_nop 0
buffer_load_dwordx4 v24, s[16:19], s27 offen nt lds
s_add_u32 m0, s26, 21504
s_nop 0
buffer_load_dwordx4 v25, s[16:19], s27 offen nt lds
s_add_u32 m0, s26, 22528
s_nop 0
buffer_load_dwordx4 v26, s[16:19], s27 offen nt lds
s_add_u32 m0, s26, 23552
s_nop 0
buffer_load_dwordx4 v27, s[16:19], s27 offen nt lds
s_mov_b32 s27, 1536
s_add_u32 m0, s26, 24576
s_nop 0
buffer_load_dwordx4 v20, s[32:35], s27 offen nt lds
s_add_u32 m0, s26, 25600
s_nop 0
buffer_load_dwordx4 v21, s[32:35], s27 offen nt lds
s_add_u32 m0, s26, 26624
s_nop 0
buffer_load_dwordx4 v22, s[32:35], s27 offen nt lds
s_add_u32 m0, s26, 27648
s_nop 0
buffer_load_dwordx4 v23, s[32:35], s27 offen nt lds
s_add_u32 m0, s26, 28672
s_nop 0
buffer_load_dwordx4 v24, s[32:35], s27 offen nt lds
s_add_u32 m0, s26, 29696
s_nop 0
buffer_load_dwordx4 v25, s[32:35], s27 offen nt lds
s_add_u32 m0, s26, 30720
s_nop 0
buffer_load_dwordx4 v26, s[32:35], s27 offen nt lds
s_add_u32 m0, s26, 31744
s_nop 0
buffer_load_dwordx4 v27, s[32:35], s27 offen nt lds
s_waitcnt vmcnt(16)
ds_read_b128 a[128:131], v28 offset:0
ds_read_b128 a[132:135], v28 offset:8192
ds_read_b128 a[136:139], v29 offset:0
ds_read_b128 a[140:143], v29 offset:8192
ds_read_b128 a[144:147], v30 offset:0
ds_read_b128 a[148:151], v30 offset:8192
ds_read_b128 a[152:155], v31 offset:0
ds_read_b128 a[156:159], v31 offset:8192
s_waitcnt lgkmcnt(0)
ds_read_b128 a[160:163], v28 offset:256
ds_read_b128 a[164:167], v28 offset:8448
ds_read_b128 a[168:171], v29 offset:256
ds_read_b128 a[172:175], v29 offset:8448
ds_read_b128 a[176:179], v30 offset:256
ds_read_b128 a[180:183], v30 offset:8448
ds_read_b128 a[184:187], v31 offset:256
ds_read_b128 a[188:191], v31 offset:8448
s_waitcnt lgkmcnt(0)
s_waitcnt vmcnt(0)
ds_read_b128 a[192:195], v28 offset:16384
ds_read_b128 a[196:199], v28 offset:24576
ds_read_b128 a[200:203], v29 offset:16384
ds_read_b128 a[204:207], v29 offset:24576
ds_read_b128 a[208:211], v30 offset:16384
ds_read_b128 a[212:215], v30 offset:24576
ds_read_b128 a[216:219], v31 offset:16384
ds_read_b128 a[220:223], v31 offset:24576
s_waitcnt lgkmcnt(0)
ds_read_b128 a[224:227], v28 offset:16640
ds_read_b128 a[228:231], v28 offset:24832
ds_read_b128 a[232:235], v29 offset:16640
ds_read_b128 a[236:239], v29 offset:24832
ds_read_b128 a[240:243], v30 offset:16640
ds_read_b128 a[244:247], v30 offset:24832
ds_read_b128 a[248:251], v31 offset:16640
ds_read_b128 a[252:255], v31 offset:24832
s_waitcnt lgkmcnt(0)
v_lshlrev_b32 v128, 16, v128
v_lshlrev_b32 v129, 16, v129
v_lshlrev_b32 v130, 16, v130
v_mul_f32 v131, 0x3fb8aa3b, v130
v_exp_f32 v131, v131
s_nop 0
v_cvt_pk_bf16_f32 v131, 0, v131
v_mul_f32 v132, v131, v128
v_mul_f32 v133, v131, v129
v_mul_f32 v132, 0x3fb8aa3b, v132
v_exp_f32 v132, v132
v_mul_f32 v133, 0x3e22f983, v133
v_fract_f32 v133, v133
v_cos_f32 v134, v133
v_sin_f32 v133, v133
s_nop 0
v_mul_f32 v88, v132, v134
v_mul_f32 v89, v132, v133
v_add_f32 v131, -1.0, v88
v_mul_f32 v132, v131, v128
v_fma_f32 v132, v89, v129, v132
v_mul_f32 v133, v89, v128
v_fma_f32 v133, -v131, v129, v133
v_mul_f32 v134, v128, v128
v_fma_f32 v134, v129, v129, v134
v_rcp_f32 v134, v134
s_nop 0
v_add_f32 v134, v134, v134
v_mul_f32 v90, v132, v134
v_mul_f32 v91, v133, v134
v_mov_b32 v92, v88
v_mov_b32 v93, v89
v_mul_f32 v131, v93, v93
v_mul_f32 v93, v92, v93
v_fma_f32 v92, v92, v92, -v131
v_add_f32 v93, v93, v93
v_mul_f32 v131, v93, v93
v_mul_f32 v93, v92, v93
v_fma_f32 v92, v92, v92, -v131
v_add_f32 v93, v93, v93
v_mul_f32 v131, v93, v93
v_mul_f32 v93, v92, v93
v_fma_f32 v92, v92, v92, -v131
v_add_f32 v93, v93, v93
v_xor_b32 v152, 0x80000000, v89
v_xor_b32 v153, 0x80000000, v93
v_xor_b32 v154, 0x80000000, v90
v_xor_b32 v155, 0x80000000, v91
v_mul_f32 v156, v88, v90
v_mul_f32 v157, v88, v91
v_fmac_f32 v156, v152, v91
v_fmac_f32 v157, v89, v90
v_mul_f32 v158, v88, v156
v_mul_f32 v159, v88, v157
v_fmac_f32 v158, v152, v157
v_fmac_f32 v159, v89, v156
v_mul_f32 v160, v88, v158
v_mul_f32 v161, v88, v159
v_fmac_f32 v160, v152, v159
v_fmac_f32 v161, v89, v158
v_mul_f32 v162, v88, v160
v_mul_f32 v163, v88, v161
v_fmac_f32 v162, v152, v161
v_fmac_f32 v163, v89, v160
v_mul_f32 v164, v88, v162
v_mul_f32 v165, v88, v163
v_fmac_f32 v164, v152, v163
v_fmac_f32 v165, v89, v162
v_mul_f32 v166, v88, v164
v_mul_f32 v167, v88, v165
v_fmac_f32 v166, v152, v165
v_fmac_f32 v167, v89, v164
v_mul_f32 v168, v88, v166
v_mul_f32 v169, v88, v167
v_fmac_f32 v168, v152, v167
v_fmac_f32 v169, v89, v166
v_mul_f32 v170, v88, v168
v_mul_f32 v171, v88, v169
v_fmac_f32 v170, v152, v169
v_fmac_f32 v171, v89, v168
v_mov_b32 v94, 0
v_mov_b32 v95, 0
v_mov_b32 v68, 0
v_mov_b32 v69, 0
v_mov_b32 v70, 0
v_mov_b32 v71, 0
v_mov_b32 v72, 0
v_mov_b32 v73, 0
v_mov_b32 v74, 0
v_mov_b32 v75, 0
v_mov_b32 v76, 0
v_mov_b32 v77, 0
v_mov_b32 v78, 0
v_mov_b32 v79, 0
v_mov_b32 v80, 0
v_mov_b32 v81, 0
v_mov_b32 v82, 0
v_mov_b32 v83, 0
s_lshl_b32 s21, s49, 12
v_and_b32 v1, 63, v0
v_and_b32 v2, 15, v0
v_bfe_u32 v3, v0, 4, 2
v_lshrrev_b32 v4, 6, v0
v_lshrrev_b32 v5, 5, v1
v_lshl_add_u32 v5, v4, 3, v5
v_add_u32 v5, 0, v5
v_and_b32 v6, 3, v5
v_lshrrev_b32 v7, 3, v5
v_lshl_add_u32 v6, v7, 2, v6
v_and_b32 v7, 31, v1
v_xor_b32 v6, v6, v7
v_lshlrev_b32 v6, 4, v6
v_lshl_add_u32 v8, v5, 11, v6
v_lshrrev_b32 v5, 5, v1
v_lshl_add_u32 v5, v4, 3, v5
v_add_u32 v5, 2, v5
v_and_b32 v6, 3, v5
v_lshrrev_b32 v7, 3, v5
v_lshl_add_u32 v6, v7, 2, v6
v_and_b32 v7, 31, v1
v_xor_b32 v6, v6, v7
v_lshlrev_b32 v6, 4, v6
v_lshl_add_u32 v9, v5, 11, v6
v_lshrrev_b32 v5, 5, v1
v_lshl_add_u32 v5, v4, 3, v5
v_add_u32 v5, 4, v5
v_and_b32 v6, 3, v5
v_lshrrev_b32 v7, 3, v5
v_lshl_add_u32 v6, v7, 2, v6
v_and_b32 v7, 31, v1
v_xor_b32 v6, v6, v7
v_lshlrev_b32 v6, 4, v6
v_lshl_add_u32 v10, v5, 11, v6
v_lshrrev_b32 v5, 5, v1
v_lshl_add_u32 v5, v4, 3, v5
v_add_u32 v5, 6, v5
v_and_b32 v6, 3, v5
v_lshrrev_b32 v7, 3, v5
v_lshl_add_u32 v6, v7, 2, v6
v_and_b32 v7, 31, v1
v_xor_b32 v6, v6, v7
v_lshlrev_b32 v6, 4, v6
v_lshl_add_u32 v11, v5, 11, v6
v_and_b32 v5, 12, v2
v_add_u32 v5, v5, v2
v_add_u32 v6, 0, v3
v_xor_b32 v6, v6, v2
v_lshlrev_b32 v6, 4, v6
v_lshl_add_u32 v12, v5, 9, v6
v_add_u32 v6, 4, v3
v_xor_b32 v6, v6, v2
v_lshlrev_b32 v6, 4, v6
v_lshl_add_u32 v13, v5, 9, v6
v_add_u32 v6, 8, v3
v_xor_b32 v6, v6, v2
v_lshlrev_b32 v6, 4, v6
v_lshl_add_u32 v14, v5, 9, v6
v_add_u32 v6, 12, v3
v_xor_b32 v6, v6, v2
v_lshlrev_b32 v6, 4, v6
v_lshl_add_u32 v15, v5, 9, v6
v_add_u32 v16, 0x10000, v12
v_add_u32 v17, 0x10000, v13
v_add_u32 v18, 0x10000, v14
v_add_u32 v19, 0x10000, v15
s_mov_b32 s32, s98
s_and_b32 s33, s99, 0xffff
s_mov_b32 s34, 0x100
s_mov_b32 s35, 0x00020000
s_mov_b32 s25, 0
v_mov_b32 v2, 0
L_pl_481:
buffer_load_dword v1, v2, s[32:35], s25 offen sc1
s_add_u32 s36, s36, 1
s_cmp_gt_u32 s36, 0x100000
s_cbranch_scc1 chain_kernel_wend
s_waitcnt vmcnt(0)
v_readfirstlane_b32 s26, v1
s_and_b32 s27, s26, 0xffff
s_cmp_ge_u32 s27, 256
s_cbranch_scc1 L_plok_482
s_sleep 4
s_branch L_pl_481
L_plok_482:
s_lshr_b32 s55, s26, 24
s_bfe_u32 s25, s26, 0x80010
s_cmp_gt_u32 s25, s55
s_cselect_b32 s25, 0x2000, 0x0
s_add_u32 s54, s100, 0x1fffff
s_and_b32 s54, s54, 0xffe00000
s_sub_u32 s55, s54, s100
s_add_u32 s54, s55, s25
s_xor_b32 s25, s25, 0x2000
s_add_u32 s55, s55, s25
s_mov_b32 s56, 0xffff0000
s_mov_b32 s57, 0xffffffff
s_mov_b32 s58, 0x0
s_mov_b32 s59, 0xffffffff
s_mov_b32 s60, 0x0
s_mov_b32 s61, 0xffff0000
s_mov_b32 s22, 0
s_mov_b32 s24, 0
s_mov_b32 s20, 0
s_mov_b32 s37, 0
s_mov_b32 s23, 64
s_mov_b32 s38, 0x7ff00000
s_mov_b32 s39, 0x7ff00000
s_mov_b32 s43, 0x7ff00000
s_barrier
s_add_u32 m0, s21, 0
s_nop 0
buffer_load_dwordx4 v8, s[8:11], s20 offen lds
s_add_u32 m0, s21, 1024
s_nop 0
buffer_load_dwordx4 v9, s[8:11], s20 offen lds
s_add_u32 m0, s21, 2048
s_nop 0
buffer_load_dwordx4 v10, s[8:11], s20 offen lds
s_add_u32 m0, s21, 3072
s_nop 0
buffer_load_dwordx4 v11, s[8:11], s20 offen lds
s_add_u32 s20, s20, 512
s_add_u32 m0, s21, 16384
s_nop 0
buffer_load_dwordx4 v8, s[8:11], s20 offen lds
s_add_u32 m0, s21, 17408
s_nop 0
buffer_load_dwordx4 v9, s[8:11], s20 offen lds
s_add_u32 m0, s21, 18432
s_nop 0
buffer_load_dwordx4 v10, s[8:11], s20 offen lds
s_add_u32 m0, s21, 19456
s_nop 0
buffer_load_dwordx4 v11, s[8:11], s20 offen lds
s_add_u32 s20, s20, 512
s_add_u32 m0, s21, 32768
s_nop 0
buffer_load_dwordx4 v8, s[8:11], s20 offen lds
s_add_u32 m0, s21, 33792
s_nop 0
buffer_load_dwordx4 v9, s[8:11], s20 offen lds
s_add_u32 m0, s21, 34816
s_nop 0
buffer_load_dwordx4 v10, s[8:11], s20 offen lds
s_add_u32 m0, s21, 35840
s_nop 0
buffer_load_dwordx4 v11, s[8:11], s20 offen lds
s_add_u32 s20, s20, 512
s_add_u32 m0, s21, 49152
s_nop 0
buffer_load_dwordx4 v8, s[8:11], s20 offen lds
s_add_u32 m0, s21, 50176
s_nop 0
buffer_load_dwordx4 v9, s[8:11], s20 offen lds
s_add_u32 m0, s21, 51200
s_nop 0
buffer_load_dwordx4 v10, s[8:11], s20 offen lds
s_add_u32 m0, s21, 52224
s_nop 0
buffer_load_dwordx4 v11, s[8:11], s20 offen lds
s_add_u32 s24, s24, 1
s_min_u32 s24, s24, 63
s_lshl_b32 s53, s24, 16
s_mov_b32 s20, s53
s_add_u32 m0, s21, 65536
s_nop 0
buffer_load_dwordx4 v8, s[8:11], s20 offen lds
s_add_u32 m0, s21, 66560
s_nop 0
buffer_load_dwordx4 v9, s[8:11], s20 offen lds
s_add_u32 m0, s21, 67584
s_nop 0
buffer_load_dwordx4 v10, s[8:11], s20 offen lds
s_add_u32 m0, s21, 68608
s_nop 0
buffer_load_dwordx4 v11, s[8:11], s20 offen lds
s_add_u32 s20, s20, 512
s_add_u32 m0, s21, 81920
s_nop 0
buffer_load_dwordx4 v8, s[8:11], s20 offen lds
s_add_u32 m0, s21, 82944
s_nop 0
buffer_load_dwordx4 v9, s[8:11], s20 offen lds
s_add_u32 m0, s21, 83968
s_nop 0
buffer_load_dwordx4 v10, s[8:11], s20 offen lds
s_add_u32 m0, s21, 84992
s_nop 0
buffer_load_dwordx4 v11, s[8:11], s20 offen lds
s_add_u32 s20, s20, 512
s_add_u32 m0, s21, 98304
s_nop 0
buffer_load_dwordx4 v8, s[8:11], s20 offen lds
s_waitcnt vmcnt(21)
s_barrier
ds_read_b128 v[20:23], v12 offset:0
ds_read_b128 v[24:27], v12 offset:2048
ds_read_b128 v[28:31], v13 offset:0
ds_read_b128 v[32:35], v13 offset:2048
ds_read_b128 v[36:39], v14 offset:0
ds_read_b128 v[40:43], v14 offset:2048
s_waitcnt lgkmcnt(4)
L_st_486:
v_mfma_f32_16x16x32_bf16 v[52:55], v[20:23], a[0:3], 0
ds_read_b128 v[44:47], v15 offset:0
s_add_u32 m0, s21, 99328
v_mfma_f32_16x16x32_bf16 v[56:59], v[20:23], a[4:7], 0
buffer_load_dwordx4 v9, s[8:11], s20 offen lds
v_mfma_f32_16x16x32_bf16 v[60:63], v[24:27], a[0:3], 0
ds_read_b128 v[48:51], v15 offset:2048
v_cvt_pk_bf16_f32 v144, v180, v181
v_mfma_f32_16x16x32_bf16 v[64:67], v[24:27], a[4:7], 0
s_waitcnt lgkmcnt(4)
v_cvt_pk_bf16_f32 v145, v182, v183
v_fmac_f32 v69, v88, v68
v_mfma_f32_16x16x32_bf16 v[52:55], v[28:31], a[8:11], v[52:55]
ds_read_b128 v[20:23], v12 offset:256
v_fmac_f32 v73, v88, v72
v_mul_f32 v128, v90, v68
v_mfma_f32_16x16x32_bf16 v[56:59], v[28:31], a[12:15], v[56:59]
buffer_store_dwordx2 v[144:145], v86, s[12:15], s38 offen offset:0 sc1
v_mfma_f32_16x16x32_bf16 v[60:63], v[32:35], a[8:11], v[60:63]
ds_read_b128 v[24:27], v12 offset:2304
v_cvt_pk_bf16_f32 v146, v184, v185
v_mul_f32 v136, v154, v72
v_mfma_f32_16x16x32_bf16 v[64:67], v[32:35], a[12:15], v[64:67]
s_waitcnt lgkmcnt(4)
v_fmac_f32 v69, v152, v72
v_fmac_f32 v73, v89, v68
v_mfma_f32_16x16x32_bf16 v[52:55], v[36:39], a[16:19], v[52:55]
ds_read_b128 v[28:31], v13 offset:256
s_add_u32 m0, s21, 100352
v_mfma_f32_16x16x32_bf16 v[56:59], v[36:39], a[20:23], v[56:59]
buffer_load_dwordx4 v10, s[8:11], s20 offen lds
v_fmac_f32 v128, v155, v72
v_mfma_f32_16x16x32_bf16 v[60:63], v[40:43], a[16:19], v[60:63]
ds_read_b128 v[32:35], v13 offset:2304
v_cvt_pk_bf16_f32 v147, v186, v187
v_fmac_f32 v136, v155, v68
v_mfma_f32_16x16x32_bf16 v[64:67], v[40:43], a[20:23], v[64:67]
s_waitcnt lgkmcnt(4)
v_fmac_f32 v70, v88, v69
v_mfma_f32_16x16x32_bf16 v[52:55], v[44:47], a[24:27], v[52:55]
ds_read_b128 v[36:39], v14 offset:256
v_fmac_f32 v74, v88, v73
v_mul_f32 v129, v90, v69
v_mfma_f32_16x16x32_bf16 v[56:59], v[44:47], a[28:31], v[56:59]
buffer_store_dwordx2 v[146:147], v86, s[12:15], s38 offen offset:256 sc1
v_mul_f32 v137, v154, v73
v_mfma_f32_16x16x32_bf16 v[60:63], v[48:51], a[24:27], v[60:63]
ds_read_b128 v[40:43], v14 offset:2304
v_cvt_pk_bf16_f32 v148, v188, v189
v_mfma_f32_16x16x32_bf16 v[64:67], v[48:51], a[28:31], v[64:67]
s_waitcnt lgkmcnt(4)
v_fmac_f32 v70, v152, v73
v_fmac_f32 v74, v89, v69
v_mfma_f32_16x16x32_bf16 v[52:55], v[20:23], a[32:35], v[52:55]
ds_read_b128 v[44:47], v15 offset:256
s_add_u32 m0, s21, 101376
v_fmac_f32 v129, v155, v73
v_mfma_f32_16x16x32_bf16 v[56:59], v[20:23], a[36:39], v[56:59]
buffer_load_dwordx4 v11, s[8:11], s20 offen lds
v_mfma_f32_16x16x32_bf16 v[60:63], v[24:27], a[32:35], v[60:63]
ds_read_b128 v[48:51], v15 offset:2304
v_cvt_pk_bf16_f32 v149, v190, v191
v_fmac_f32 v137, v155, v69
v_mfma_f32_16x16x32_bf16 v[64:67], v[24:27], a[36:39], v[64:67]
s_waitcnt lgkmcnt(4)
v_fmac_f32 v71, v88, v70
v_fmac_f32 v75, v88, v74
v_mfma_f32_16x16x32_bf16 v[52:55], v[28:31], a[40:43], v[52:55]
s_waitcnt vmcnt(20)
s_barrier
ds_read_b128 v[20:23], v12 offset:16384
v_mfma_f32_16x16x32_bf16 v[56:59], v[28:31], a[44:47], v[56:59]
s_add_u32 s20, s20, 512
buffer_store_dwordx2 v[148:149], v86, s[12:15], s43 offen offset:0 sc1
v_mfma_f32_16x16x32_bf16 v[60:63], v[32:35], a[40:43], v[60:63]
ds_read_b128 v[24:27], v12 offset:18432
v_cvt_pk_bf16_f32 v150, v192, v193
v_mfma_f32_16x16x32_bf16 v[64:67], v[32:35], a[44:47], v[64:67]
s_waitcnt lgkmcnt(4)
v_mul_f32 v130, v90, v70
v_mul_f32 v138, v154, v74
v_mfma_f32_16x16x32_bf16 v[52:55], v[36:39], a[48:51], v[52:55]
ds_read_b128 v[28:31], v13 offset:16384
s_add_u32 m0, s21, 114688
v_fmac_f32 v71, v152, v74
v_mfma_f32_16x16x32_bf16 v[56:59], v[36:39], a[52:55], v[56:59]
buffer_load_dwordx4 v8, s[8:11], s20 offen lds
v_mfma_f32_16x16x32_bf16 v[60:63], v[40:43], a[48:51], v[60:63]
ds_read_b128 v[32:35], v13 offset:18432
v_cvt_pk_bf16_f32 v151, v194, v195
v_fmac_f32 v75, v89, v70
v_mfma_f32_16x16x32_bf16 v[64:67], v[40:43], a[52:55], v[64:67]
s_waitcnt lgkmcnt(4)
v_fmac_f32 v130, v155, v74
v_fmac_f32 v138, v155, v70
v_mfma_f32_16x16x32_bf16 v[52:55], v[44:47], a[56:59], v[52:55]
ds_read_b128 v[36:39], v14 offset:16384
v_fmac_f32 v76, v88, v71
v_mfma_f32_16x16x32_bf16 v[56:59], v[44:47], a[60:63], v[56:59]
buffer_store_dwordx2 v[150:151], v86, s[12:15], s43 offen offset:256 sc1
v_fmac_f32 v80, v88, v75
v_mfma_f32_16x16x32_bf16 v[60:63], v[48:51], a[56:59], v[60:63]
ds_read_b128 v[40:43], v14 offset:18432
v_mul_f32 v131, v90, v71
v_mfma_f32_16x16x32_bf16 v[64:67], v[48:51], a[60:63], v[64:67]
s_waitcnt lgkmcnt(4)
v_mul_f32 v139, v154, v75
v_fmac_f32 v76, v152, v75
v_mfma_f32_16x16x32_bf16 v[52:55], v[20:23], a[64:67], v[52:55]
ds_read_b128 v[44:47], v15 offset:16384
s_add_u32 m0, s21, 115712
v_fmac_f32 v80, v89, v71
v_mfma_f32_16x16x32_bf16 v[56:59], v[20:23], a[68:71], v[56:59]
buffer_load_dwordx4 v9, s[8:11], s20 offen lds
v_mfma_f32_16x16x32_bf16 v[60:63], v[24:27], a[64:67], v[60:63]
ds_read_b128 v[48:51], v15 offset:18432
v_fmac_f32 v131, v155, v75
v_fmac_f32 v139, v155, v71
v_mfma_f32_16x16x32_bf16 v[64:67], v[24:27], a[68:71], v[64:67]
s_waitcnt lgkmcnt(4)
v_fmac_f32 v77, v88, v76
v_mfma_f32_16x16x32_bf16 v[52:55], v[28:31], a[72:75], v[52:55]
ds_read_b128 v[20:23], v12 offset:16640
v_fmac_f32 v81, v88, v80
v_mul_f32 v132, v90, v76
v_mfma_f32_16x16x32_bf16 v[56:59], v[28:31], a[76:79], v[56:59]
v_mul_f32 v140, v154, v80
v_fmac_f32 v77, v152, v80
v_mfma_f32_16x16x32_bf16 v[60:63], v[32:35], a[72:75], v[60:63]
ds_read_b128 v[24:27], v12 offset:18688
s_add_u32 s24, s24, 1
v_fmac_f32 v81, v89, v76
v_mfma_f32_16x16x32_bf16 v[64:67], v[32:35], a[76:79], v[64:67]
s_waitcnt lgkmcnt(4)
v_fmac_f32 v132, v155, v80
v_mfma_f32_16x16x32_bf16 v[52:55], v[36:39], a[80:83], v[52:55]
ds_read_b128 v[28:31], v13 offset:16640
s_add_u32 m0, s21, 116736
v_fmac_f32 v140, v155, v76
v_mfma_f32_16x16x32_bf16 v[56:59], v[36:39], a[84:87], v[56:59]
buffer_load_dwordx4 v10, s[8:11], s20 offen lds
v_fmac_f32 v78, v88, v77
v_mfma_f32_16x16x32_bf16 v[60:63], v[40:43], a[80:83], v[60:63]
ds_read_b128 v[32:35], v13 offset:18688
v_fmac_f32 v82, v88, v81
v_mfma_f32_16x16x32_bf16 v[64:67], v[40:43], a[84:87], v[64:67]
s_waitcnt lgkmcnt(4)
s_min_u32 s24, s24, 63
v_mul_f32 v133, v90, v77
v_mfma_f32_16x16x32_bf16 v[52:55], v[44:47], a[88:91], v[52:55]
ds_read_b128 v[36:39], v14 offset:16640
v_mul_f32 v141, v154, v81
v_mfma_f32_16x16x32_bf16 v[56:59], v[44:47], a[92:95], v[56:59]
v_fmac_f32 v78, v152, v81
v_fmac_f32 v82, v89, v77
v_fmac_f32 v133, v155, v81
v_mfma_f32_16x16x32_bf16 v[60:63], v[48:51], a[88:91], v[60:63]
ds_read_b128 v[40:43], v14 offset:18688
s_lshl_b32 s53, s24, 16
v_mfma_f32_16x16x32_bf16 v[64:67], v[48:51], a[92:95], v[64:67]
s_waitcnt lgkmcnt(4)
v_fmac_f32 v141, v155, v77
v_fmac_f32 v79, v88, v78
v_mfma_f32_16x16x32_bf16 v[52:55], v[20:23], a[96:99], v[52:55]
ds_read_b128 v[44:47], v15 offset:16640
s_add_u32 m0, s21, 117760
v_fmac_f32 v83, v88, v82
v_mfma_f32_16x16x32_bf16 v[56:59], v[20:23], a[100:103], v[56:59]
buffer_load_dwordx4 v11, s[8:11], s20 offen lds
v_mfma_f32_16x16x32_bf16 v[60:63], v[24:27], a[96:99], v[60:63]
ds_read_b128 v[48:51], v15 offset:18688
v_mul_f32 v134, v90, v78
v_mul_f32 v142, v154, v82
v_mfma_f32_16x16x32_bf16 v[64:67], v[24:27], a[100:103], v[64:67]
s_waitcnt lgkmcnt(4)
v_fmac_f32 v79, v152, v82
v_mfma_f32_16x16x32_bf16 v[52:55], v[28:31], a[104:107], v[52:55]
s_waitcnt vmcnt(20)
s_barrier
ds_read_b128 v[20:23], v12 offset:32768
v_mfma_f32_16x16x32_bf16 v[56:59], v[28:31], a[108:111], v[56:59]
s_mov_b32 s20, s53
v_fmac_f32 v83, v89, v78
v_fmac_f32 v134, v155, v82
v_mfma_f32_16x16x32_bf16 v[60:63], v[32:35], a[104:107], v[60:63]
ds_read_b128 v[24:27], v12 offset:34816
v_fmac_f32 v142, v155, v78
v_mfma_f32_16x16x32_bf16 v[64:67], v[32:35], a[108:111], v[64:67]
s_waitcnt lgkmcnt(4)
v_mfma_f32_16x16x4_f32 v[104:107], v116, v79, 0
v_mfma_f32_16x16x4_f32 v[108:111], v116, v83, 0
v_mfma_f32_16x16x32_bf16 v[52:55], v[36:39], a[112:115], v[52:55]
ds_read_b128 v[28:31], v13 offset:32768
s_add_u32 m0, s21, 0
v_mul_f32 v135, v90, v79
v_mfma_f32_16x16x32_bf16 v[56:59], v[36:39], a[116:119], v[56:59]
buffer_load_dwordx4 v8, s[8:11], s20 offen lds
v_mfma_f32_16x16x32_bf16 v[60:63], v[40:43], a[112:115], v[60:63]
ds_read_b128 v[32:35], v13 offset:34816
v_mul_f32 v143, v154, v83
v_fmac_f32 v135, v155, v83
v_mfma_f32_16x16x32_bf16 v[64:67], v[40:43], a[116:119], v[64:67]
s_waitcnt lgkmcnt(4)
v_fmac_f32 v143, v155, v79
v_mfma_f32_16x16x32_bf16 v[52:55], v[44:47], a[120:123], v[52:55]
ds_read_b128 v[36:39], v14 offset:32768
s_nop 0
s_nop 0
v_mfma_f32_16x16x32_bf16 v[56:59], v[44:47], a[124:127], v[56:59]
s_nop 0
s_nop 0
v_mfma_f32_16x16x32_bf16 v[60:63], v[48:51], a[120:123], v[60:63]
ds_read_b128 v[40:43], v14 offset:34816
s_nop 0
s_nop 0
v_mfma_f32_16x16x32_bf16 v[64:67], v[48:51], a[124:127], v[64:67]
s_waitcnt lgkmcnt(4)
s_nop 0
v_mfma_f32_16x16x32_bf16 v[52:55], v[20:23], a[128:131], v[52:55]
ds_read_b128 v[44:47], v15 offset:32768
s_add_u32 m0, s21, 1024
v_fmac_f32 v104, v92, v94
v_mfma_f32_16x16x32_bf16 v[56:59], v[20:23], a[132:135], v[56:59]
buffer_load_dwordx4 v9, s[8:11], s20 offen lds
v_fmac_f32 v108, v92, v95
v_mfma_f32_16x16x32_bf16 v[60:63], v[24:27], a[128:131], v[60:63]
ds_read_b128 v[48:51], v15 offset:34816
v_fmac_f32 v104, v153, v95
v_mfma_f32_16x16x32_bf16 v[64:67], v[24:27], a[132:135], v[64:67]
s_waitcnt lgkmcnt(4)
v_fmac_f32 v108, v93, v94
v_cndmask_b32 v96, v94, v104, s[56:57]
v_mfma_f32_16x16x32_bf16 v[52:55], v[28:31], a[136:139], v[52:55]
ds_read_b128 v[20:23], v12 offset:33024
v_cndmask_b32 v97, v95, v108, s[56:57]
v_mfma_f32_16x16x32_bf16 v[56:59], v[28:31], a[140:143], v[56:59]
v_fmac_f32 v105, v92, v104
v_fmac_f32 v109, v92, v108
v_mfma_f32_16x16x32_bf16 v[60:63], v[32:35], a[136:139], v[60:63]
ds_read_b128 v[24:27], v12 offset:35072
v_fmac_f32 v105, v153, v108
v_fmac_f32 v109, v93, v104
v_mfma_f32_16x16x32_bf16 v[64:67], v[32:35], a[140:143], v[64:67]
s_waitcnt lgkmcnt(4)
v_cndmask_b32 v96, v96, v105, s[58:59]
v_mfma_f32_16x16x32_bf16 v[52:55], v[36:39], a[144:147], v[52:55]
ds_read_b128 v[28:31], v13 offset:33024
s_add_u32 m0, s21, 2048
v_cndmask_b32 v97, v97, v109, s[58:59]
v_mfma_f32_16x16x32_bf16 v[56:59], v[36:39], a[148:151], v[56:59]
buffer_load_dwordx4 v10, s[8:11], s20 offen lds
v_fmac_f32 v106, v92, v105
v_mfma_f32_16x16x32_bf16 v[60:63], v[40:43], a[144:147], v[60:63]
ds_read_b128 v[32:35], v13 offset:35072
v_fmac_f32 v110, v92, v109
v_mfma_f32_16x16x32_bf16 v[64:67], v[40:43], a[148:151], v[64:67]
s_waitcnt lgkmcnt(4)
v_fmac_f32 v106, v153, v109
v_fmac_f32 v110, v93, v105
v_mfma_f32_16x16x32_bf16 v[52:55], v[44:47], a[152:155], v[52:55]
ds_read_b128 v[36:39], v14 offset:33024
v_cndmask_b32 v96, v96, v106, s[60:61]
v_mfma_f32_16x16x32_bf16 v[56:59], v[44:47], a[156:159], v[56:59]
v_cndmask_b32 v97, v97, v110, s[60:61]
v_fmac_f32 v107, v92, v106
v_mfma_f32_16x16x32_bf16 v[60:63], v[48:51], a[152:155], v[60:63]
ds_read_b128 v[40:43], v14 offset:35072
v_fmac_f32 v111, v92, v110
v_fmac_f32 v107, v153, v110
v_mfma_f32_16x16x32_bf16 v[64:67], v[48:51], a[156:159], v[64:67]
s_waitcnt lgkmcnt(4)
v_fmac_f32 v111, v93, v106
v_mfma_f32_16x16x32_bf16 v[52:55], v[20:23], a[160:163], v[52:55]
ds_read_b128 v[44:47], v15 offset:33024
s_add_u32 m0, s21, 3072
v_xor_b32 v98, 0x80000000, v96
v_mfma_f32_16x16x32_bf16 v[56:59], v[20:23], a[164:167], v[56:59]
buffer_load_dwordx4 v11, s[8:11], s20 offen lds
v_xor_b32 v99, 0x80000000, v97
v_mfma_f32_16x16x32_bf16 v[60:63], v[24:27], a[160:163], v[60:63]
ds_read_b128 v[48:51], v15 offset:35072
v_mov_b32 v94, v107
v_mfma_f32_16x16x32_bf16 v[64:67], v[24:27], a[164:167], v[64:67]
s_waitcnt lgkmcnt(4)
v_mov_b32 v95, v111
v_fmac_f32 v128, v156, v96
v_mfma_f32_16x16x32_bf16 v[52:55], v[28:31], a[168:171], v[52:55]
s_waitcnt vmcnt(7)
s_barrier
ds_read_b128 v[20:23], v12 offset:49152
v_mfma_f32_16x16x32_bf16 v[56:59], v[28:31], a[172:175], v[56:59]
s_add_u32 s20, s20, 512
buffer_atomic_add v84, v85, s[12:15], s39 offen sc1
v_mfma_f32_16x16x32_bf16 v[60:63], v[32:35], a[168:171], v[60:63]
ds_read_b128 v[24:27], v12 offset:51200
v_fmac_f32 v136, v156, v99
v_mfma_f32_16x16x32_bf16 v[64:67], v[32:35], a[172:175], v[64:67]
s_waitcnt lgkmcnt(4)
v_fmac_f32 v128, v157, v99
v_fmac_f32 v136, v157, v98
v_mfma_f32_16x16x32_bf16 v[52:55], v[36:39], a[176:179], v[52:55]
ds_read_b128 v[28:31], v13 offset:49152
s_add_u32 m0, s21, 16384
v_fmac_f32 v129, v158, v96
v_mfma_f32_16x16x32_bf16 v[56:59], v[36:39], a[180:183], v[56:59]
buffer_load_dwordx4 v8, s[8:11], s20 offen lds
v_mfma_f32_16x16x32_bf16 v[60:63], v[40:43], a[176:179], v[60:63]
ds_read_b128 v[32:35], v13 offset:51200
v_fmac_f32 v137, v158, v99
v_fmac_f32 v129, v159, v99
v_mfma_f32_16x16x32_bf16 v[64:67], v[40:43], a[180:183], v[64:67]
s_waitcnt lgkmcnt(4)
v_fmac_f32 v137, v159, v98
v_mfma_f32_16x16x32_bf16 v[52:55], v[44:47], a[184:187], v[52:55]
ds_read_b128 v[36:39], v14 offset:49152
v_cvt_pk_bf16_f32 v120, v128, v129
v_cvt_pk_bf16_f32 v124, v136, v137
v_mfma_f32_16x16x32_bf16 v[56:59], v[44:47], a[188:191], v[56:59]
v_fmac_f32 v130, v160, v96
v_fmac_f32 v138, v160, v99
v_mfma_f32_16x16x32_bf16 v[60:63], v[48:51], a[184:187], v[60:63]
ds_read_b128 v[40:43], v14 offset:51200
v_fmac_f32 v130, v161, v99
v_fmac_f32 v138, v161, v98
v_mfma_f32_16x16x32_bf16 v[64:67], v[48:51], a[188:191], v[64:67]
s_waitcnt lgkmcnt(4)
v_fmac_f32 v131, v162, v96
v_mfma_f32_16x16x32_bf16 v[52:55], v[20:23], a[192:195], v[52:55]
ds_read_b128 v[44:47], v15 offset:49152
s_add_u32 m0, s21, 17408
v_fmac_f32 v139, v162, v99
v_mfma_f32_16x16x32_bf16 v[56:59], v[20:23], a[196:199], v[56:59]
buffer_load_dwordx4 v9, s[8:11], s20 offen lds
v_fmac_f32 v131, v163, v99
v_mfma_f32_16x16x32_bf16 v[60:63], v[24:27], a[192:195], v[60:63]
ds_read_b128 v[48:51], v15 offset:51200
v_fmac_f32 v139, v163, v98
v_mfma_f32_16x16x32_bf16 v[64:67], v[24:27], a[196:199], v[64:67]
s_waitcnt lgkmcnt(4)
v_cvt_pk_bf16_f32 v121, v130, v131
v_mfma_f32_16x16x32_bf16 v[52:55], v[28:31], a[200:203], v[52:55]
ds_read_b128 v[20:23], v12 offset:49408
v_cvt_pk_bf16_f32 v125, v138, v139
v_fmac_f32 v132, v164, v96
v_mfma_f32_16x16x32_bf16 v[56:59], v[28:31], a[204:207], v[56:59]
v_fmac_f32 v140, v164, v99
v_fmac_f32 v132, v165, v99
v_mfma_f32_16x16x32_bf16 v[60:63], v[32:35], a[200:203], v[60:63]
ds_read_b128 v[24:27], v12 offset:51456
v_fmac_f32 v140, v165, v98
v_fmac_f32 v133, v166, v96
v_mfma_f32_16x16x32_bf16 v[64:67], v[32:35], a[204:207], v[64:67]
s_waitcnt lgkmcnt(4)
v_fmac_f32 v141, v166, v99
v_mfma_f32_16x16x32_bf16 v[52:55], v[36:39], a[208:211], v[52:55]
ds_read_b128 v[28:31], v13 offset:49408
s_add_u32 m0, s21, 18432
v_fmac_f32 v133, v167, v99
v_mfma_f32_16x16x32_bf16 v[56:59], v[36:39], a[212:215], v[56:59]
buffer_load_dwordx4 v10, s[8:11], s20 offen lds
v_fmac_f32 v141, v167, v98
v_mfma_f32_16x16x32_bf16 v[60:63], v[40:43], a[208:211], v[60:63]
ds_read_b128 v[32:35], v13 offset:51456
v_cvt_pk_bf16_f32 v122, v132, v133
v_mfma_f32_16x16x32_bf16 v[64:67], v[40:43], a[212:215], v[64:67]
s_waitcnt lgkmcnt(4)
v_cvt_pk_bf16_f32 v126, v140, v141
v_fmac_f32 v134, v168, v96
v_mfma_f32_16x16x32_bf16 v[52:55], v[44:47], a[216:219], v[52:55]
ds_read_b128 v[36:39], v14 offset:49408
v_fmac_f32 v142, v168, v99
v_mfma_f32_16x16x32_bf16 v[56:59], v[44:47], a[220:223], v[56:59]
v_fmac_f32 v134, v169, v99
v_fmac_f32 v142, v169, v98
v_mfma_f32_16x16x32_bf16 v[60:63], v[48:51], a[216:219], v[60:63]
ds_read_b128 v[40:43], v14 offset:51456
v_fmac_f32 v135, v170, v96
v_fmac_f32 v143, v170, v99
v_mfma_f32_16x16x32_bf16 v[64:67], v[48:51], a[220:223], v[64:67]
s_waitcnt lgkmcnt(4)
v_fmac_f32 v135, v171, v99
v_mfma_f32_16x16x32_bf16 v[52:55], v[20:23], a[224:227], v[52:55]
ds_read_b128 v[44:47], v15 offset:49408
s_add_u32 m0, s21, 19456
v_fmac_f32 v143, v171, v98
v_mfma_f32_16x16x32_bf16 v[56:59], v[20:23], a[228:231], v[56:59]
buffer_load_dwordx4 v11, s[8:11], s20 offen lds
v_cvt_pk_bf16_f32 v123, v134, v135
v_mfma_f32_16x16x32_bf16 v[60:63], v[24:27], a[224:227], v[60:63]
ds_read_b128 v[48:51], v15 offset:51456
v_cvt_pk_bf16_f32 v127, v142, v143
v_mfma_f32_16x16x32_bf16 v[64:67], v[24:27], a[228:231], v[64:67]
s_waitcnt lgkmcnt(4)
s_nop 0
s_nop 0
v_mfma_f32_16x16x32_bf16 v[52:55], v[28:31], a[232:235], v[52:55]
s_waitcnt vmcnt(20)
s_barrier
ds_read_b128 v[20:23], v16 offset:0
v_mfma_f32_16x16x32_bf16 v[56:59], v[28:31], a[236:239], v[56:59]
s_add_u32 s20, s20, 512
v_mfma_f32_16x16x32_bf16 v[180:183], v[120:123], v[172:175], 0
v_mfma_f32_16x16x32_bf16 v[60:63], v[32:35], a[232:235], v[60:63]
ds_read_b128 v[24:27], v16 offset:2048
v_mfma_f32_16x16x32_bf16 v[184:187], v[120:123], v[176:179], 0
v_mfma_f32_16x16x32_bf16 v[188:191], v[124:127], v[172:175], 0
v_mfma_f32_16x16x32_bf16 v[64:67], v[32:35], a[236:239], v[64:67]
s_waitcnt lgkmcnt(4)
v_mfma_f32_16x16x32_bf16 v[192:195], v[124:127], v[176:179], 0
v_mfma_f32_16x16x32_bf16 v[52:55], v[36:39], a[240:243], v[52:55]
ds_read_b128 v[28:31], v17 offset:0
s_add_u32 m0, s21, 32768
s_sub_u32 s39, s22, 1
v_mfma_f32_16x16x32_bf16 v[56:59], v[36:39], a[244:247], v[56:59]
buffer_load_dwordx4 v8, s[8:11], s20 offen lds
s_lshl_b32 s38, s39, 17
v_mfma_f32_16x16x32_bf16 v[60:63], v[40:43], a[240:243], v[60:63]
ds_read_b128 v[32:35], v17 offset:2048
s_add_u32 s38, s38, 0x4400000
v_mfma_f32_16x16x32_bf16 v[64:67], v[40:43], a[244:247], v[64:67]
s_waitcnt lgkmcnt(4)
s_add_u32 s43, s38, 0x10000
s_lshl_b32 s39, s39, 7
v_mfma_f32_16x16x32_bf16 v[52:55], v[44:47], a[248:251], v[52:55]
ds_read_b128 v[36:39], v18 offset:0
s_add_u32 s39, s39, 0x5902000
v_mfma_f32_16x16x32_bf16 v[56:59], v[44:47], a[252:255], v[56:59]
s_cmp_eq_u32 s37, 0
s_cselect_b32 s38, 0x7ff00000, s38
s_cselect_b32 s39, 0x7ff00000, s39
s_cselect_b32 s43, 0x7ff00000, s43
v_mfma_f32_16x16x32_bf16 v[60:63], v[48:51], a[248:251], v[60:63]
ds_read_b128 v[40:43], v18 offset:2048
v_mfma_f32_16x16x32_bf16 v[64:67], v[48:51], a[252:255], v[64:67]
s_waitcnt lgkmcnt(4)
s_mov_b32 s37, 1
s_add_u32 s22, s22, 1
s_cmp_ge_u32 s22, s23
s_cbranch_scc1 L_fl0_483
v_mfma_f32_16x16x32_bf16 v[68:71], v[20:23], a[0:3], 0
ds_read_b128 v[44:47], v19 offset:0
s_add_u32 m0, s21, 33792
v_mfma_f32_16x16x32_bf16 v[72:75], v[20:23], a[4:7], 0
buffer_load_dwordx4 v9, s[8:11], s20 offen lds
v_mfma_f32_16x16x32_bf16 v[76:79], v[24:27], a[0:3], 0
ds_read_b128 v[48:51], v19 offset:2048
v_cvt_pk_bf16_f32 v144, v180, v181
v_mfma_f32_16x16x32_bf16 v[80:83], v[24:27], a[4:7], 0
s_waitcnt lgkmcnt(4)
v_cvt_pk_bf16_f32 v145, v182, v183
v_fmac_f32 v53, v88, v52
v_mfma_f32_16x16x32_bf16 v[68:71], v[28:31], a[8:11], v[68:71]
ds_read_b128 v[20:23], v16 offset:256
v_fmac_f32 v57, v88, v56
v_mul_f32 v128, v90, v52
v_mfma_f32_16x16x32_bf16 v[72:75], v[28:31], a[12:15], v[72:75]
buffer_store_dwordx2 v[144:145], v86, s[12:15], s38 offen offset:0 sc1
v_mfma_f32_16x16x32_bf16 v[76:79], v[32:35], a[8:11], v[76:79]
ds_read_b128 v[24:27], v16 offset:2304
v_cvt_pk_bf16_f32 v146, v184, v185
v_mul_f32 v136, v154, v56
v_mfma_f32_16x16x32_bf16 v[80:83], v[32:35], a[12:15], v[80:83]
s_waitcnt lgkmcnt(4)
v_fmac_f32 v53, v152, v56
v_fmac_f32 v57, v89, v52
v_mfma_f32_16x16x32_bf16 v[68:71], v[36:39], a[16:19], v[68:71]
ds_read_b128 v[28:31], v17 offset:256
s_add_u32 m0, s21, 34816
v_mfma_f32_16x16x32_bf16 v[72:75], v[36:39], a[20:23], v[72:75]
buffer_load_dwordx4 v10, s[8:11], s20 offen lds
v_fmac_f32 v128, v155, v56
v_mfma_f32_16x16x32_bf16 v[76:79], v[40:43], a[16:19], v[76:79]
ds_read_b128 v[32:35], v17 offset:2304
v_cvt_pk_bf16_f32 v147, v186, v187
v_fmac_f32 v136, v155, v52
v_mfma_f32_16x16x32_bf16 v[80:83], v[40:43], a[20:23], v[80:83]
s_waitcnt lgkmcnt(4)
v_fmac_f32 v54, v88, v53
v_mfma_f32_16x16x32_bf16 v[68:71], v[44:47], a[24:27], v[68:71]
ds_read_b128 v[36:39], v18 offset:256
v_fmac_f32 v58, v88, v57
v_mul_f32 v129, v90, v53
v_mfma_f32_16x16x32_bf16 v[72:75], v[44:47], a[28:31], v[72:75]
buffer_store_dwordx2 v[146:147], v86, s[12:15], s38 offen offset:256 sc1
v_mul_f32 v137, v154, v57
v_mfma_f32_16x16x32_bf16 v[76:79], v[48:51], a[24:27], v[76:79]
ds_read_b128 v[40:43], v18 offset:2304
v_cvt_pk_bf16_f32 v148, v188, v189
v_mfma_f32_16x16x32_bf16 v[80:83], v[48:51], a[28:31], v[80:83]
s_waitcnt lgkmcnt(4)
v_fmac_f32 v54, v152, v57
v_fmac_f32 v58, v89, v53
v_mfma_f32_16x16x32_bf16 v[68:71], v[20:23], a[32:35], v[68:71]
ds_read_b128 v[44:47], v19 offset:256
s_add_u32 m0, s21, 35840
v_fmac_f32 v129, v155, v57
v_mfma_f32_16x16x32_bf16 v[72:75], v[20:23], a[36:39], v[72:75]
buffer_load_dwordx4 v11, s[8:11], s20 offen lds
v_mfma_f32_16x16x32_bf16 v[76:79], v[24:27], a[32:35], v[76:79]
ds_read_b128 v[48:51], v19 offset:2304
v_cvt_pk_bf16_f32 v149, v190, v191
v_fmac_f32 v137, v155, v53
v_mfma_f32_16x16x32_bf16 v[80:83], v[24:27], a[36:39], v[80:83]
s_waitcnt lgkmcnt(4)
v_fmac_f32 v55, v88, v54
v_fmac_f32 v59, v88, v58
v_mfma_f32_16x16x32_bf16 v[68:71], v[28:31], a[40:43], v[68:71]
s_waitcnt vmcnt(20)
s_barrier
ds_read_b128 v[20:23], v16 offset:16384
v_mfma_f32_16x16x32_bf16 v[72:75], v[28:31], a[44:47], v[72:75]
s_add_u32 s20, s20, 512
buffer_store_dwordx2 v[148:149], v86, s[12:15], s43 offen offset:0 sc1
v_mfma_f32_16x16x32_bf16 v[76:79], v[32:35], a[40:43], v[76:79]
ds_read_b128 v[24:27], v16 offset:18432
v_cvt_pk_bf16_f32 v150, v192, v193
v_mfma_f32_16x16x32_bf16 v[80:83], v[32:35], a[44:47], v[80:83]
s_waitcnt lgkmcnt(4)
v_mul_f32 v130, v90, v54
v_mul_f32 v138, v154, v58
v_mfma_f32_16x16x32_bf16 v[68:71], v[36:39], a[48:51], v[68:71]
ds_read_b128 v[28:31], v17 offset:16384
s_add_u32 m0, s21, 49152
v_fmac_f32 v55, v152, v58
v_mfma_f32_16x16x32_bf16 v[72:75], v[36:39], a[52:55], v[72:75]
buffer_load_dwordx4 v8, s[8:11], s20 offen lds
v_mfma_f32_16x16x32_bf16 v[76:79], v[40:43], a[48:51], v[76:79]
ds_read_b128 v[32:35], v17 offset:18432
v_cvt_pk_bf16_f32 v151, v194, v195
v_fmac_f32 v59, v89, v54
v_mfma_f32_16x16x32_bf16 v[80:83], v[40:43], a[52:55], v[80:83]
s_waitcnt lgkmcnt(4)
v_fmac_f32 v130, v155, v58
v_fmac_f32 v138, v155, v54
v_mfma_f32_16x16x32_bf16 v[68:71], v[44:47], a[56:59], v[68:71]
ds_read_b128 v[36:39], v18 offset:16384
v_fmac_f32 v60, v88, v55
v_mfma_f32_16x16x32_bf16 v[72:75], v[44:47], a[60:63], v[72:75]
buffer_store_dwordx2 v[150:151], v86, s[12:15], s43 offen offset:256 sc1
v_fmac_f32 v64, v88, v59
v_mfma_f32_16x16x32_bf16 v[76:79], v[48:51], a[56:59], v[76:79]
ds_read_b128 v[40:43], v18 offset:18432
v_mul_f32 v131, v90, v55
v_mfma_f32_16x16x32_bf16 v[80:83], v[48:51], a[60:63], v[80:83]
s_waitcnt lgkmcnt(4)
v_mul_f32 v139, v154, v59
v_fmac_f32 v60, v152, v59
v_mfma_f32_16x16x32_bf16 v[68:71], v[20:23], a[64:67], v[68:71]
ds_read_b128 v[44:47], v19 offset:16384
s_add_u32 m0, s21, 50176
v_fmac_f32 v64, v89, v55
v_mfma_f32_16x16x32_bf16 v[72:75], v[20:23], a[68:71], v[72:75]
buffer_load_dwordx4 v9, s[8:11], s20 offen lds
v_mfma_f32_16x16x32_bf16 v[76:79], v[24:27], a[64:67], v[76:79]
ds_read_b128 v[48:51], v19 offset:18432
v_fmac_f32 v131, v155, v59
v_fmac_f32 v139, v155, v55
v_mfma_f32_16x16x32_bf16 v[80:83], v[24:27], a[68:71], v[80:83]
s_waitcnt lgkmcnt(4)
v_fmac_f32 v61, v88, v60
v_mfma_f32_16x16x32_bf16 v[68:71], v[28:31], a[72:75], v[68:71]
ds_read_b128 v[20:23], v16 offset:16640
v_fmac_f32 v65, v88, v64
v_mul_f32 v132, v90, v60
v_mfma_f32_16x16x32_bf16 v[72:75], v[28:31], a[76:79], v[72:75]
v_mul_f32 v140, v154, v64
v_fmac_f32 v61, v152, v64
v_mfma_f32_16x16x32_bf16 v[76:79], v[32:35], a[72:75], v[76:79]
ds_read_b128 v[24:27], v16 offset:18688
s_add_u32 s24, s24, 1
v_fmac_f32 v65, v89, v60
v_mfma_f32_16x16x32_bf16 v[80:83], v[32:35], a[76:79], v[80:83]
s_waitcnt lgkmcnt(4)
v_fmac_f32 v132, v155, v64
v_mfma_f32_16x16x32_bf16 v[68:71], v[36:39], a[80:83], v[68:71]
ds_read_b128 v[28:31], v17 offset:16640
s_add_u32 m0, s21, 51200
v_fmac_f32 v140, v155, v60
v_mfma_f32_16x16x32_bf16 v[72:75], v[36:39], a[84:87], v[72:75]
buffer_load_dwordx4 v10, s[8:11], s20 offen lds
v_fmac_f32 v62, v88, v61
v_mfma_f32_16x16x32_bf16 v[76:79], v[40:43], a[80:83], v[76:79]
ds_read_b128 v[32:35], v17 offset:18688
v_fmac_f32 v66, v88, v65
v_mfma_f32_16x16x32_bf16 v[80:83], v[40:43], a[84:87], v[80:83]
s_waitcnt lgkmcnt(4)
s_min_u32 s24, s24, 63
v_mul_f32 v133, v90, v61
v_mfma_f32_16x16x32_bf16 v[68:71], v[44:47], a[88:91], v[68:71]
ds_read_b128 v[36:39], v18 offset:16640
v_mul_f32 v141, v154, v65
v_mfma_f32_16x16x32_bf16 v[72:75], v[44:47], a[92:95], v[72:75]
v_fmac_f32 v62, v152, v65
v_fmac_f32 v66, v89, v61
v_fmac_f32 v133, v155, v65
v_mfma_f32_16x16x32_bf16 v[76:79], v[48:51], a[88:91], v[76:79]
ds_read_b128 v[40:43], v18 offset:18688
s_lshl_b32 s53, s24, 16
v_mfma_f32_16x16x32_bf16 v[80:83], v[48:51], a[92:95], v[80:83]
s_waitcnt lgkmcnt(4)
v_fmac_f32 v141, v155, v61
v_fmac_f32 v63, v88, v62
v_mfma_f32_16x16x32_bf16 v[68:71], v[20:23], a[96:99], v[68:71]
ds_read_b128 v[44:47], v19 offset:16640
s_add_u32 m0, s21, 52224
v_fmac_f32 v67, v88, v66
v_mfma_f32_16x16x32_bf16 v[72:75], v[20:23], a[100:103], v[72:75]
buffer_load_dwordx4 v11, s[8:11], s20 offen lds
v_mfma_f32_16x16x32_bf16 v[76:79], v[24:27], a[96:99], v[76:79]
ds_read_b128 v[48:51], v19 offset:18688
v_mul_f32 v134, v90, v62
v_mul_f32 v142, v154, v66
v_mfma_f32_16x16x32_bf16 v[80:83], v[24:27], a[100:103], v[80:83]
s_waitcnt lgkmcnt(4)
v_fmac_f32 v63, v152, v66
v_mfma_f32_16x16x32_bf16 v[68:71], v[28:31], a[104:107], v[68:71]
s_waitcnt vmcnt(20)
s_barrier
ds_read_b128 v[20:23], v16 offset:32768
v_mfma_f32_16x16x32_bf16 v[72:75], v[28:31], a[108:111], v[72:75]
s_mov_b32 s20, s53
v_fmac_f32 v67, v89, v62
v_fmac_f32 v134, v155, v66
v_mfma_f32_16x16x32_bf16 v[76:79], v[32:35], a[104:107], v[76:79]
ds_read_b128 v[24:27], v16 offset:34816
v_fmac_f32 v142, v155, v62
v_mfma_f32_16x16x32_bf16 v[80:83], v[32:35], a[108:111], v[80:83]
s_waitcnt lgkmcnt(4)
v_mfma_f32_16x16x4_f32 v[104:107], v116, v63, 0
v_mfma_f32_16x16x4_f32 v[108:111], v116, v67, 0
v_mfma_f32_16x16x32_bf16 v[68:71], v[36:39], a[112:115], v[68:71]
ds_read_b128 v[28:31], v17 offset:32768
s_add_u32 m0, s21, 65536
v_mul_f32 v135, v90, v63
v_mfma_f32_16x16x32_bf16 v[72:75], v[36:39], a[116:119], v[72:75]
buffer_load_dwordx4 v8, s[8:11], s20 offen lds
v_mfma_f32_16x16x32_bf16 v[76:79], v[40:43], a[112:115], v[76:79]
ds_read_b128 v[32:35], v17 offset:34816
v_mul_f32 v143, v154, v67
v_fmac_f32 v135, v155, v67
v_mfma_f32_16x16x32_bf16 v[80:83], v[40:43], a[116:119], v[80:83]
s_waitcnt lgkmcnt(4)
v_fmac_f32 v143, v155, v63
v_mfma_f32_16x16x32_bf16 v[68:71], v[44:47], a[120:123], v[68:71]
ds_read_b128 v[36:39], v18 offset:32768
s_nop 0
s_nop 0
v_mfma_f32_16x16x32_bf16 v[72:75], v[44:47], a[124:127], v[72:75]
s_nop 0
s_nop 0
v_mfma_f32_16x16x32_bf16 v[76:79], v[48:51], a[120:123], v[76:79]
ds_read_b128 v[40:43], v18 offset:34816
s_nop 0
s_nop 0
v_mfma_f32_16x16x32_bf16 v[80:83], v[48:51], a[124:127], v[80:83]
s_waitcnt lgkmcnt(4)
s_nop 0
v_mfma_f32_16x16x32_bf16 v[68:71], v[20:23], a[128:131], v[68:71]
ds_read_b128 v[44:47], v19 offset:32768
s_add_u32 m0, s21, 66560
v_fmac_f32 v104, v92, v94
v_mfma_f32_16x16x32_bf16 v[72:75], v[20:23], a[132:135], v[72:75]
buffer_load_dwordx4 v9, s[8:11], s20 offen lds
v_fmac_f32 v108, v92, v95
v_mfma_f32_16x16x32_bf16 v[76:79], v[24:27], a[128:131], v[76:79]
ds_read_b128 v[48:51], v19 offset:34816
v_fmac_f32 v104, v153, v95
v_mfma_f32_16x16x32_bf16 v[80:83], v[24:27], a[132:135], v[80:83]
s_waitcnt lgkmcnt(4)
v_fmac_f32 v108, v93, v94
v_cndmask_b32 v96, v94, v104, s[56:57]
v_mfma_f32_16x16x32_bf16 v[68:71], v[28:31], a[136:139], v[68:71]
ds_read_b128 v[20:23], v16 offset:33024
v_cndmask_b32 v97, v95, v108, s[56:57]
v_mfma_f32_16x16x32_bf16 v[72:75], v[28:31], a[140:143], v[72:75]
v_fmac_f32 v105, v92, v104
v_fmac_f32 v109, v92, v108
v_mfma_f32_16x16x32_bf16 v[76:79], v[32:35], a[136:139], v[76:79]
ds_read_b128 v[24:27], v16 offset:35072
v_fmac_f32 v105, v153, v108
v_fmac_f32 v109, v93, v104
v_mfma_f32_16x16x32_bf16 v[80:83], v[32:35], a[140:143], v[80:83]
s_waitcnt lgkmcnt(4)
v_cndmask_b32 v96, v96, v105, s[58:59]
v_mfma_f32_16x16x32_bf16 v[68:71], v[36:39], a[144:147], v[68:71]
ds_read_b128 v[28:31], v17 offset:33024
s_add_u32 m0, s21, 67584
v_cndmask_b32 v97, v97, v109, s[58:59]
v_mfma_f32_16x16x32_bf16 v[72:75], v[36:39], a[148:151], v[72:75]
buffer_load_dwordx4 v10, s[8:11], s20 offen lds
v_fmac_f32 v106, v92, v105
v_mfma_f32_16x16x32_bf16 v[76:79], v[40:43], a[144:147], v[76:79]
ds_read_b128 v[32:35], v17 offset:35072
v_fmac_f32 v110, v92, v109
v_mfma_f32_16x16x32_bf16 v[80:83], v[40:43], a[148:151], v[80:83]
s_waitcnt lgkmcnt(4)
v_fmac_f32 v106, v153, v109
v_fmac_f32 v110, v93, v105
v_mfma_f32_16x16x32_bf16 v[68:71], v[44:47], a[152:155], v[68:71]
ds_read_b128 v[36:39], v18 offset:33024
v_cndmask_b32 v96, v96, v106, s[60:61]
v_mfma_f32_16x16x32_bf16 v[72:75], v[44:47], a[156:159], v[72:75]
v_cndmask_b32 v97, v97, v110, s[60:61]
v_fmac_f32 v107, v92, v106
v_mfma_f32_16x16x32_bf16 v[76:79], v[48:51], a[152:155], v[76:79]
ds_read_b128 v[40:43], v18 offset:35072
v_fmac_f32 v111, v92, v110
v_fmac_f32 v107, v153, v110
v_mfma_f32_16x16x32_bf16 v[80:83], v[48:51], a[156:159], v[80:83]
s_waitcnt lgkmcnt(4)
v_fmac_f32 v111, v93, v106
v_mfma_f32_16x16x32_bf16 v[68:71], v[20:23], a[160:163], v[68:71]
ds_read_b128 v[44:47], v19 offset:33024
s_add_u32 m0, s21, 68608
v_xor_b32 v98, 0x80000000, v96
v_mfma_f32_16x16x32_bf16 v[72:75], v[20:23], a[164:167], v[72:75]
buffer_load_dwordx4 v11, s[8:11], s20 offen lds
v_xor_b32 v99, 0x80000000, v97
v_mfma_f32_16x16x32_bf16 v[76:79], v[24:27], a[160:163], v[76:79]
ds_read_b128 v[48:51], v19 offset:35072
v_mov_b32 v94, v107
v_mfma_f32_16x16x32_bf16 v[80:83], v[24:27], a[164:167], v[80:83]
s_waitcnt lgkmcnt(4)
v_mov_b32 v95, v111
v_fmac_f32 v128, v156, v96
v_mfma_f32_16x16x32_bf16 v[68:71], v[28:31], a[168:171], v[68:71]
s_waitcnt vmcnt(7)
s_barrier
ds_read_b128 v[20:23], v16 offset:49152
v_mfma_f32_16x16x32_bf16 v[72:75], v[28:31], a[172:175], v[72:75]
s_add_u32 s20, s20, 512
buffer_atomic_add v84, v85, s[12:15], s39 offen sc1
v_mfma_f32_16x16x32_bf16 v[76:79], v[32:35], a[168:171], v[76:79]
ds_read_b128 v[24:27], v16 offset:51200
v_fmac_f32 v136, v156, v99
v_mfma_f32_16x16x32_bf16 v[80:83], v[32:35], a[172:175], v[80:83]
s_waitcnt lgkmcnt(4)
v_fmac_f32 v128, v157, v99
v_fmac_f32 v136, v157, v98
v_mfma_f32_16x16x32_bf16 v[68:71], v[36:39], a[176:179], v[68:71]
ds_read_b128 v[28:31], v17 offset:49152
s_add_u32 m0, s21, 81920
v_fmac_f32 v129, v158, v96
v_mfma_f32_16x16x32_bf16 v[72:75], v[36:39], a[180:183], v[72:75]
buffer_load_dwordx4 v8, s[8:11], s20 offen lds
v_mfma_f32_16x16x32_bf16 v[76:79], v[40:43], a[176:179], v[76:79]
ds_read_b128 v[32:35], v17 offset:51200
v_fmac_f32 v137, v158, v99
v_fmac_f32 v129, v159, v99
v_mfma_f32_16x16x32_bf16 v[80:83], v[40:43], a[180:183], v[80:83]
s_waitcnt lgkmcnt(4)
v_fmac_f32 v137, v159, v98
v_mfma_f32_16x16x32_bf16 v[68:71], v[44:47], a[184:187], v[68:71]
ds_read_b128 v[36:39], v18 offset:49152
v_cvt_pk_bf16_f32 v120, v128, v129
v_cvt_pk_bf16_f32 v124, v136, v137
v_mfma_f32_16x16x32_bf16 v[72:75], v[44:47], a[188:191], v[72:75]
v_fmac_f32 v130, v160, v96
v_fmac_f32 v138, v160, v99
v_mfma_f32_16x16x32_bf16 v[76:79], v[48:51], a[184:187], v[76:79]
ds_read_b128 v[40:43], v18 offset:51200
v_fmac_f32 v130, v161, v99
v_fmac_f32 v138, v161, v98
v_mfma_f32_16x16x32_bf16 v[80:83], v[48:51], a[188:191], v[80:83]
s_waitcnt lgkmcnt(4)
v_fmac_f32 v131, v162, v96
v_mfma_f32_16x16x32_bf16 v[68:71], v[20:23], a[192:195], v[68:71]
ds_read_b128 v[44:47], v19 offset:49152
s_add_u32 m0, s21, 82944
v_fmac_f32 v139, v162, v99
v_mfma_f32_16x16x32_bf16 v[72:75], v[20:23], a[196:199], v[72:75]
buffer_load_dwordx4 v9, s[8:11], s20 offen lds
v_fmac_f32 v131, v163, v99
v_mfma_f32_16x16x32_bf16 v[76:79], v[24:27], a[192:195], v[76:79]
ds_read_b128 v[48:51], v19 offset:51200
v_fmac_f32 v139, v163, v98
v_mfma_f32_16x16x32_bf16 v[80:83], v[24:27], a[196:199], v[80:83]
s_waitcnt lgkmcnt(4)
v_cvt_pk_bf16_f32 v121, v130, v131
v_mfma_f32_16x16x32_bf16 v[68:71], v[28:31], a[200:203], v[68:71]
ds_read_b128 v[20:23], v16 offset:49408
v_cvt_pk_bf16_f32 v125, v138, v139
v_fmac_f32 v132, v164, v96
v_mfma_f32_16x16x32_bf16 v[72:75], v[28:31], a[204:207], v[72:75]
v_fmac_f32 v140, v164, v99
v_fmac_f32 v132, v165, v99
v_mfma_f32_16x16x32_bf16 v[76:79], v[32:35], a[200:203], v[76:79]
ds_read_b128 v[24:27], v16 offset:51456
v_fmac_f32 v140, v165, v98
v_fmac_f32 v133, v166, v96
v_mfma_f32_16x16x32_bf16 v[80:83], v[32:35], a[204:207], v[80:83]
s_waitcnt lgkmcnt(4)
v_fmac_f32 v141, v166, v99
v_mfma_f32_16x16x32_bf16 v[68:71], v[36:39], a[208:211], v[68:71]
ds_read_b128 v[28:31], v17 offset:49408
s_add_u32 m0, s21, 83968
v_fmac_f32 v133, v167, v99
v_mfma_f32_16x16x32_bf16 v[72:75], v[36:39], a[212:215], v[72:75]
buffer_load_dwordx4 v10, s[8:11], s20 offen lds
v_fmac_f32 v141, v167, v98
v_mfma_f32_16x16x32_bf16 v[76:79], v[40:43], a[208:211], v[76:79]
ds_read_b128 v[32:35], v17 offset:51456
v_cvt_pk_bf16_f32 v122, v132, v133
v_mfma_f32_16x16x32_bf16 v[80:83], v[40:43], a[212:215], v[80:83]
s_waitcnt lgkmcnt(4)
v_cvt_pk_bf16_f32 v126, v140, v141
v_fmac_f32 v134, v168, v96
v_mfma_f32_16x16x32_bf16 v[68:71], v[44:47], a[216:219], v[68:71]
ds_read_b128 v[36:39], v18 offset:49408
v_fmac_f32 v142, v168, v99
v_mfma_f32_16x16x32_bf16 v[72:75], v[44:47], a[220:223], v[72:75]
v_fmac_f32 v134, v169, v99
v_fmac_f32 v142, v169, v98
v_mfma_f32_16x16x32_bf16 v[76:79], v[48:51], a[216:219], v[76:79]
ds_read_b128 v[40:43], v18 offset:51456
v_fmac_f32 v135, v170, v96
v_fmac_f32 v143, v170, v99
v_mfma_f32_16x16x32_bf16 v[80:83], v[48:51], a[220:223], v[80:83]
s_waitcnt lgkmcnt(4)
v_fmac_f32 v135, v171, v99
v_mfma_f32_16x16x32_bf16 v[68:71], v[20:23], a[224:227], v[68:71]
ds_read_b128 v[44:47], v19 offset:49408
s_add_u32 m0, s21, 84992
v_fmac_f32 v143, v171, v98
v_mfma_f32_16x16x32_bf16 v[72:75], v[20:23], a[228:231], v[72:75]
buffer_load_dwordx4 v11, s[8:11], s20 offen lds
v_cvt_pk_bf16_f32 v123, v134, v135
v_mfma_f32_16x16x32_bf16 v[76:79], v[24:27], a[224:227], v[76:79]
ds_read_b128 v[48:51], v19 offset:51456
v_cvt_pk_bf16_f32 v127, v142, v143
v_mfma_f32_16x16x32_bf16 v[80:83], v[24:27], a[228:231], v[80:83]
s_waitcnt lgkmcnt(4)
s_nop 0
s_nop 0
v_mfma_f32_16x16x32_bf16 v[68:71], v[28:31], a[232:235], v[68:71]
s_waitcnt vmcnt(20)
s_barrier
ds_read_b128 v[20:23], v12 offset:0
v_mfma_f32_16x16x32_bf16 v[72:75], v[28:31], a[236:239], v[72:75]
s_add_u32 s20, s20, 512
v_mfma_f32_16x16x32_bf16 v[180:183], v[120:123], v[172:175], 0
v_mfma_f32_16x16x32_bf16 v[76:79], v[32:35], a[232:235], v[76:79]
ds_read_b128 v[24:27], v12 offset:2048
v_mfma_f32_16x16x32_bf16 v[184:187], v[120:123], v[176:179], 0
v_mfma_f32_16x16x32_bf16 v[188:191], v[124:127], v[172:175], 0
v_mfma_f32_16x16x32_bf16 v[80:83], v[32:35], a[236:239], v[80:83]
s_waitcnt lgkmcnt(4)
v_mfma_f32_16x16x32_bf16 v[192:195], v[124:127], v[176:179], 0
v_mfma_f32_16x16x32_bf16 v[68:71], v[36:39], a[240:243], v[68:71]
ds_read_b128 v[28:31], v13 offset:0
s_add_u32 m0, s21, 98304
s_sub_u32 s39, s22, 1
v_mfma_f32_16x16x32_bf16 v[72:75], v[36:39], a[244:247], v[72:75]
buffer_load_dwordx4 v8, s[8:11], s20 offen lds
s_lshl_b32 s38, s39, 17
v_mfma_f32_16x16x32_bf16 v[76:79], v[40:43], a[240:243], v[76:79]
ds_read_b128 v[32:35], v13 offset:2048
s_add_u32 s38, s38, 0x4400000
v_mfma_f32_16x16x32_bf16 v[80:83], v[40:43], a[244:247], v[80:83]
s_waitcnt lgkmcnt(4)
s_add_u32 s43, s38, 0x10000
s_lshl_b32 s39, s39, 7
v_mfma_f32_16x16x32_bf16 v[68:71], v[44:47], a[248:251], v[68:71]
ds_read_b128 v[36:39], v14 offset:0
s_add_u32 s39, s39, 0x5902000
v_mfma_f32_16x16x32_bf16 v[72:75], v[44:47], a[252:255], v[72:75]
s_cmp_eq_u32 s37, 0
s_cselect_b32 s38, 0x7ff00000, s38
s_cselect_b32 s39, 0x7ff00000, s39
s_cselect_b32 s43, 0x7ff00000, s43
v_mfma_f32_16x16x32_bf16 v[76:79], v[48:51], a[248:251], v[76:79]
ds_read_b128 v[40:43], v14 offset:2048
v_mfma_f32_16x16x32_bf16 v[80:83], v[48:51], a[252:255], v[80:83]
s_waitcnt lgkmcnt(4)
s_mov_b32 s37, 1
s_add_u32 s22, s22, 1
s_cmp_ge_u32 s22, s23
s_cbranch_scc0 L_st_486
L_fl1_484:
s_waitcnt lgkmcnt(0)
s_nop 7
v_cvt_pk_bf16_f32 v144, v180, v181
v_cvt_pk_bf16_f32 v145, v182, v183
buffer_store_dwordx2 v[144:145], v86, s[12:15], s38 offen offset:0 sc1
v_cvt_pk_bf16_f32 v146, v184, v185
v_cvt_pk_bf16_f32 v147, v186, v187
buffer_store_dwordx2 v[146:147], v86, s[12:15], s38 offen offset:256 sc1
v_cvt_pk_bf16_f32 v148, v188, v189
v_cvt_pk_bf16_f32 v149, v190, v191
buffer_store_dwordx2 v[148:149], v86, s[12:15], s43 offen offset:0 sc1
v_cvt_pk_bf16_f32 v150, v192, v193
v_cvt_pk_bf16_f32 v151, v194, v195
buffer_store_dwordx2 v[150:151], v86, s[12:15], s43 offen offset:256 sc1
s_waitcnt vmcnt(0)
s_barrier
buffer_atomic_add v84, v85, s[12:15], s39 offen sc1
v_fmac_f32 v69, v88, v68
v_fmac_f32 v73, v88, v72
v_mul_f32 v128, v90, v68
v_mul_f32 v136, v154, v72
v_fmac_f32 v69, v152, v72
v_fmac_f32 v73, v89, v68
v_fmac_f32 v128, v155, v72
v_fmac_f32 v136, v155, v68
v_fmac_f32 v70, v88, v69
v_fmac_f32 v74, v88, v73
v_mul_f32 v129, v90, v69
v_mul_f32 v137, v154, v73
v_fmac_f32 v70, v152, v73
v_fmac_f32 v74, v89, v69
v_fmac_f32 v129, v155, v73
v_fmac_f32 v137, v155, v69
v_fmac_f32 v71, v88, v70
v_fmac_f32 v75, v88, v74
v_mul_f32 v130, v90, v70
v_mul_f32 v138, v154, v74
v_fmac_f32 v71, v152, v74
v_fmac_f32 v75, v89, v70
v_fmac_f32 v130, v155, v74
v_fmac_f32 v138, v155, v70
v_fmac_f32 v76, v88, v71
v_fmac_f32 v80, v88, v75
v_mul_f32 v131, v90, v71
v_mul_f32 v139, v154, v75
v_fmac_f32 v76, v152, v75
v_fmac_f32 v80, v89, v71
v_fmac_f32 v131, v155, v75
v_fmac_f32 v139, v155, v71
v_fmac_f32 v77, v88, v76
v_fmac_f32 v81, v88, v80
v_mul_f32 v132, v90, v76
v_mul_f32 v140, v154, v80
v_fmac_f32 v77, v152, v80
v_fmac_f32 v81, v89, v76
v_fmac_f32 v132, v155, v80
v_fmac_f32 v140, v155, v76
v_fmac_f32 v78, v88, v77
v_fmac_f32 v82, v88, v81
v_mul_f32 v133, v90, v77
v_mul_f32 v141, v154, v81
v_fmac_f32 v78, v152, v81
v_fmac_f32 v82, v89, v77
v_fmac_f32 v133, v155, v81
v_fmac_f32 v141, v155, v77
v_fmac_f32 v79, v88, v78
v_fmac_f32 v83, v88, v82
v_mul_f32 v134, v90, v78
v_mul_f32 v142, v154, v82
v_fmac_f32 v79, v152, v82
v_fmac_f32 v83, v89, v78
v_fmac_f32 v134, v155, v82
v_fmac_f32 v142, v155, v78
v_mfma_f32_16x16x4_f32 v[104:107], v116, v79, 0
v_mfma_f32_16x16x4_f32 v[108:111], v116, v83, 0
v_mul_f32 v135, v90, v79
v_mul_f32 v143, v154, v83
v_fmac_f32 v135, v155, v83
v_fmac_f32 v143, v155, v79
s_nop 0
s_nop 0
s_nop 0
s_nop 0
s_nop 0
s_nop 0
s_nop 0
v_fmac_f32 v104, v92, v94
v_fmac_f32 v108, v92, v95
v_fmac_f32 v104, v153, v95
v_fmac_f32 v108, v93, v94
v_cndmask_b32 v96, v94, v104, s[56:57]
v_cndmask_b32 v97, v95, v108, s[56:57]
v_fmac_f32 v105, v92, v104
v_fmac_f32 v109, v92, v108
v_fmac_f32 v105, v153, v108
v_fmac_f32 v109, v93, v104
v_cndmask_b32 v96, v96, v105, s[58:59]
v_cndmask_b32 v97, v97, v109, s[58:59]
v_fmac_f32 v106, v92, v105
v_fmac_f32 v110, v92, v109
v_fmac_f32 v106, v153, v109
v_fmac_f32 v110, v93, v105
v_cndmask_b32 v96, v96, v106, s[60:61]
v_cndmask_b32 v97, v97, v110, s[60:61]
v_fmac_f32 v107, v92, v106
v_fmac_f32 v111, v92, v110
v_fmac_f32 v107, v153, v110
v_fmac_f32 v111, v93, v106
v_xor_b32 v98, 0x80000000, v96
v_xor_b32 v99, 0x80000000, v97
v_mov_b32 v94, v107
v_mov_b32 v95, v111
v_fmac_f32 v128, v156, v96
v_fmac_f32 v136, v156, v99
v_fmac_f32 v128, v157, v99
v_fmac_f32 v136, v157, v98
v_fmac_f32 v129, v158, v96
v_fmac_f32 v137, v158, v99
v_fmac_f32 v129, v159, v99
v_fmac_f32 v137, v159, v98
v_cvt_pk_bf16_f32 v120, v128, v129
v_cvt_pk_bf16_f32 v124, v136, v137
v_fmac_f32 v130, v160, v96
v_fmac_f32 v138, v160, v99
v_fmac_f32 v130, v161, v99
v_fmac_f32 v138, v161, v98
v_fmac_f32 v131, v162, v96
v_fmac_f32 v139, v162, v99
v_fmac_f32 v131, v163, v99
v_fmac_f32 v139, v163, v98
v_cvt_pk_bf16_f32 v121, v130, v131
v_cvt_pk_bf16_f32 v125, v138, v139
v_fmac_f32 v132, v164, v96
v_fmac_f32 v140, v164, v99
v_fmac_f32 v132, v165, v99
v_fmac_f32 v140, v165, v98
v_fmac_f32 v133, v166, v96
v_fmac_f32 v141, v166, v99
v_fmac_f32 v133, v167, v99
v_fmac_f32 v141, v167, v98
v_cvt_pk_bf16_f32 v122, v132, v133
v_cvt_pk_bf16_f32 v126, v140, v141
v_fmac_f32 v134, v168, v96
v_fmac_f32 v142, v168, v99
v_fmac_f32 v134, v169, v99
v_fmac_f32 v142, v169, v98
v_fmac_f32 v135, v170, v96
v_fmac_f32 v143, v170, v99
v_fmac_f32 v135, v171, v99
v_fmac_f32 v143, v171, v98
v_cvt_pk_bf16_f32 v123, v134, v135
v_cvt_pk_bf16_f32 v127, v142, v143
s_nop 0
s_nop 0
v_mfma_f32_16x16x32_bf16 v[180:183], v[120:123], v[172:175], 0
v_mfma_f32_16x16x32_bf16 v[184:187], v[120:123], v[176:179], 0
v_mfma_f32_16x16x32_bf16 v[188:191], v[124:127], v[172:175], 0
v_mfma_f32_16x16x32_bf16 v[192:195], v[124:127], v[176:179], 0
s_sub_u32 s39, s22, 1
s_lshl_b32 s38, s39, 17
s_add_u32 s38, s38, 0x4400000
s_add_u32 s43, s38, 0x10000
s_lshl_b32 s39, s39, 7
s_add_u32 s39, s39, 0x5902000
s_cmp_eq_u32 s37, 0
s_cselect_b32 s38, 0x7ff00000, s38
s_cselect_b32 s39, 0x7ff00000, s39
s_cselect_b32 s43, 0x7ff00000, s43
s_mov_b32 s37, 1
v_cvt_pk_bf16_f32 v144, v180, v181
v_cvt_pk_bf16_f32 v145, v182, v183
buffer_store_dwordx2 v[144:145], v86, s[12:15], s38 offen offset:0 sc1
v_cvt_pk_bf16_f32 v146, v184, v185
v_cvt_pk_bf16_f32 v147, v186, v187
buffer_store_dwordx2 v[146:147], v86, s[12:15], s38 offen offset:256 sc1
v_cvt_pk_bf16_f32 v148, v188, v189
v_cvt_pk_bf16_f32 v149, v190, v191
buffer_store_dwordx2 v[148:149], v86, s[12:15], s43 offen offset:0 sc1
v_cvt_pk_bf16_f32 v150, v192, v193
v_cvt_pk_bf16_f32 v151, v194, v195
buffer_store_dwordx2 v[150:151], v86, s[12:15], s43 offen offset:256 sc1
s_waitcnt vmcnt(0)
s_barrier
buffer_atomic_add v84, v85, s[12:15], s39 offen sc1
s_branch L_ste_485
L_fl0_483:
s_waitcnt lgkmcnt(0)
s_nop 7
v_cvt_pk_bf16_f32 v144, v180, v181
v_cvt_pk_bf16_f32 v145, v182, v183
buffer_store_dwordx2 v[144:145], v86, s[12:15], s38 offen offset:0 sc1
v_cvt_pk_bf16_f32 v146, v184, v185
v_cvt_pk_bf16_f32 v147, v186, v187
buffer_store_dwordx2 v[146:147], v86, s[12:15], s38 offen offset:256 sc1
v_cvt_pk_bf16_f32 v148, v188, v189
v_cvt_pk_bf16_f32 v149, v190, v191
buffer_store_dwordx2 v[148:149], v86, s[12:15], s43 offen offset:0 sc1
v_cvt_pk_bf16_f32 v150, v192, v193
v_cvt_pk_bf16_f32 v151, v194, v195
buffer_store_dwordx2 v[150:151], v86, s[12:15], s43 offen offset:256 sc1
s_waitcnt vmcnt(0)
s_barrier
buffer_atomic_add v84, v85, s[12:15], s39 offen sc1
v_fmac_f32 v53, v88, v52
v_fmac_f32 v57, v88, v56
v_mul_f32 v128, v90, v52
v_mul_f32 v136, v154, v56
v_fmac_f32 v53, v152, v56
v_fmac_f32 v57, v89, v52
v_fmac_f32 v128, v155, v56
v_fmac_f32 v136, v155, v52
v_fmac_f32 v54, v88, v53
v_fmac_f32 v58, v88, v57
v_mul_f32 v129, v90, v53
v_mul_f32 v137, v154, v57
v_fmac_f32 v54, v152, v57
v_fmac_f32 v58, v89, v53
v_fmac_f32 v129, v155, v57
v_fmac_f32 v137, v155, v53
v_fmac_f32 v55, v88, v54
v_fmac_f32 v59, v88, v58
v_mul_f32 v130, v90, v54
v_mul_f32 v138, v154, v58
v_fmac_f32 v55, v152, v58
v_fmac_f32 v59, v89, v54
v_fmac_f32 v130, v155, v58
v_fmac_f32 v138, v155, v54
v_fmac_f32 v60, v88, v55
v_fmac_f32 v64, v88, v59
v_mul_f32 v131, v90, v55
v_mul_f32 v139, v154, v59
v_fmac_f32 v60, v152, v59
v_fmac_f32 v64, v89, v55
v_fmac_f32 v131, v155, v59
v_fmac_f32 v139, v155, v55
v_fmac_f32 v61, v88, v60
v_fmac_f32 v65, v88, v64
v_mul_f32 v132, v90, v60
v_mul_f32 v140, v154, v64
v_fmac_f32 v61, v152, v64
v_fmac_f32 v65, v89, v60
v_fmac_f32 v132, v155, v64
v_fmac_f32 v140, v155, v60
v_fmac_f32 v62, v88, v61
v_fmac_f32 v66, v88, v65
v_mul_f32 v133, v90, v61
v_mul_f32 v141, v154, v65
v_fmac_f32 v62, v152, v65
v_fmac_f32 v66, v89, v61
v_fmac_f32 v133, v155, v65
v_fmac_f32 v141, v155, v61
v_fmac_f32 v63, v88, v62
v_fmac_f32 v67, v88, v66
v_mul_f32 v134, v90, v62
v_mul_f32 v142, v154, v66
v_fmac_f32 v63, v152, v66
v_fmac_f32 v67, v89, v62
v_fmac_f32 v134, v155, v66
v_fmac_f32 v142, v155, v62
v_mfma_f32_16x16x4_f32 v[104:107], v116, v63, 0
v_mfma_f32_16x16x4_f32 v[108:111], v116, v67, 0
v_mul_f32 v135, v90, v63
v_mul_f32 v143, v154, v67
v_fmac_f32 v135, v155, v67
v_fmac_f32 v143, v155, v63
s_nop 0
s_nop 0
s_nop 0
s_nop 0
s_nop 0
s_nop 0
s_nop 0
v_fmac_f32 v104, v92, v94
v_fmac_f32 v108, v92, v95
v_fmac_f32 v104, v153, v95
v_fmac_f32 v108, v93, v94
v_cndmask_b32 v96, v94, v104, s[56:57]
v_cndmask_b32 v97, v95, v108, s[56:57]
v_fmac_f32 v105, v92, v104
v_fmac_f32 v109, v92, v108
v_fmac_f32 v105, v153, v108
v_fmac_f32 v109, v93, v104
v_cndmask_b32 v96, v96, v105, s[58:59]
v_cndmask_b32 v97, v97, v109, s[58:59]
v_fmac_f32 v106, v92, v105
v_fmac_f32 v110, v92, v109
v_fmac_f32 v106, v153, v109
v_fmac_f32 v110, v93, v105
v_cndmask_b32 v96, v96, v106, s[60:61]
v_cndmask_b32 v97, v97, v110, s[60:61]
v_fmac_f32 v107, v92, v106
v_fmac_f32 v111, v92, v110
v_fmac_f32 v107, v153, v110
v_fmac_f32 v111, v93, v106
v_xor_b32 v98, 0x80000000, v96
v_xor_b32 v99, 0x80000000, v97
v_mov_b32 v94, v107
v_mov_b32 v95, v111
v_fmac_f32 v128, v156, v96
v_fmac_f32 v136, v156, v99
v_fmac_f32 v128, v157, v99
v_fmac_f32 v136, v157, v98
v_fmac_f32 v129, v158, v96
v_fmac_f32 v137, v158, v99
v_fmac_f32 v129, v159, v99
v_fmac_f32 v137, v159, v98
v_cvt_pk_bf16_f32 v120, v128, v129
v_cvt_pk_bf16_f32 v124, v136, v137
v_fmac_f32 v130, v160, v96
v_fmac_f32 v138, v160, v99
v_fmac_f32 v130, v161, v99
v_fmac_f32 v138, v161, v98
v_fmac_f32 v131, v162, v96
v_fmac_f32 v139, v162, v99
v_fmac_f32 v131, v163, v99
v_fmac_f32 v139, v163, v98
v_cvt_pk_bf16_f32 v121, v130, v131
v_cvt_pk_bf16_f32 v125, v138, v139
v_fmac_f32 v132, v164, v96
v_fmac_f32 v140, v164, v99
v_fmac_f32 v132, v165, v99
v_fmac_f32 v140, v165, v98
v_fmac_f32 v133, v166, v96
v_fmac_f32 v141, v166, v99
v_fmac_f32 v133, v167, v99
v_fmac_f32 v141, v167, v98
v_cvt_pk_bf16_f32 v122, v132, v133
v_cvt_pk_bf16_f32 v126, v140, v141
v_fmac_f32 v134, v168, v96
v_fmac_f32 v142, v168, v99
v_fmac_f32 v134, v169, v99
v_fmac_f32 v142, v169, v98
v_fmac_f32 v135, v170, v96
v_fmac_f32 v143, v170, v99
v_fmac_f32 v135, v171, v99
v_fmac_f32 v143, v171, v98
v_cvt_pk_bf16_f32 v123, v134, v135
v_cvt_pk_bf16_f32 v127, v142, v143
s_nop 0
s_nop 0
v_mfma_f32_16x16x32_bf16 v[180:183], v[120:123], v[172:175], 0
v_mfma_f32_16x16x32_bf16 v[184:187], v[120:123], v[176:179], 0
v_mfma_f32_16x16x32_bf16 v[188:191], v[124:127], v[172:175], 0
v_mfma_f32_16x16x32_bf16 v[192:195], v[124:127], v[176:179], 0
s_sub_u32 s39, s22, 1
s_lshl_b32 s38, s39, 17
s_add_u32 s38, s38, 0x4400000
s_add_u32 s43, s38, 0x10000
s_lshl_b32 s39, s39, 7
s_add_u32 s39, s39, 0x5902000
s_cmp_eq_u32 s37, 0
s_cselect_b32 s38, 0x7ff00000, s38
s_cselect_b32 s39, 0x7ff00000, s39
s_cselect_b32 s43, 0x7ff00000, s43
s_mov_b32 s37, 1
v_cvt_pk_bf16_f32 v144, v180, v181
v_cvt_pk_bf16_f32 v145, v182, v183
buffer_store_dwordx2 v[144:145], v86, s[12:15], s38 offen offset:0 sc1
v_cvt_pk_bf16_f32 v146, v184, v185
v_cvt_pk_bf16_f32 v147, v186, v187
buffer_store_dwordx2 v[146:147], v86, s[12:15], s38 offen offset:256 sc1
v_cvt_pk_bf16_f32 v148, v188, v189
v_cvt_pk_bf16_f32 v149, v190, v191
buffer_store_dwordx2 v[148:149], v86, s[12:15], s43 offen offset:0 sc1
v_cvt_pk_bf16_f32 v150, v192, v193
v_cvt_pk_bf16_f32 v151, v194, v195
buffer_store_dwordx2 v[150:151], v86, s[12:15], s43 offen offset:256 sc1
s_waitcnt vmcnt(0)
s_barrier
buffer_atomic_add v84, v85, s[12:15], s39 offen sc1
L_ste_485:
s_branch L_op_443
L_g2_442:
s_and_b32 s46, s41, 15
s_mov_b32 s32, s64
s_and_b32 s33, s65, 0xffff
s_mov_b32 s34, 0x400000
s_mov_b32 s35, 0x00020000
v_lshlrev_b32 v1, 4, v0
s_lshl_b32 s25, s46, 12
L_warm_487:
buffer_load_dwordx4 v[20:23], v1, s[32:35], s25 offen
s_add_u32 s25, s25, 0x10000
buffer_load_dwordx4 v[24:27], v1, s[32:35], s25 offen
s_add_u32 s25, s25, 0x10000
buffer_load_dwordx4 v[28:31], v1, s[32:35], s25 offen
s_add_u32 s25, s25, 0x10000
buffer_load_dwordx4 v[32:35], v1, s[32:35], s25 offen
s_add_u32 s25, s25, 0x10000
buffer_load_dwordx4 v[36:39], v1, s[32:35], s25 offen
s_add_u32 s25, s25, 0x10000
buffer_load_dwordx4 v[40:43], v1, s[32:35], s25 offen
s_add_u32 s25, s25, 0x10000
buffer_load_dwordx4 v[44:47], v1, s[32:35], s25 offen
s_add_u32 s25, s25, 0x10000
buffer_load_dwordx4 v[48:51], v1, s[32:35], s25 offen
s_add_u32 s25, s25, 0x10000
buffer_load_dwordx4 v[52:55], v1, s[32:35], s25 offen
s_add_u32 s25, s25, 0x10000
buffer_load_dwordx4 v[56:59], v1, s[32:35], s25 offen
s_add_u32 s25, s25, 0x10000
buffer_load_dwordx4 v[60:63], v1, s[32:35], s25 offen
s_add_u32 s25, s25, 0x10000
buffer_load_dwordx4 v[64:67], v1, s[32:35], s25 offen
s_add_u32 s25, s25, 0x10000
buffer_load_dwordx4 v[68:71], v1, s[32:35], s25 offen
s_add_u32 s25, s25, 0x10000
buffer_load_dwordx4 v[72:75], v1, s[32:35], s25 offen
s_add_u32 s25, s25, 0x10000
buffer_load_dwordx4 v[76:79], v1, s[32:35], s25 offen
s_add_u32 s25, s25, 0x10000
buffer_load_dwordx4 v[80:83], v1, s[32:35], s25 offen
s_add_u32 s25, s25, 0x10000
s_waitcnt vmcnt(16)
s_cmp_lt_u32 s25, 0x400000
s_cbranch_scc1 L_warm_487
s_waitcnt vmcnt(0)
s_mov_b32 s32, s98
s_and_b32 s33, s99, 0xffff
s_mov_b32 s34, 0x100
s_mov_b32 s35, 0x00020000
s_mov_b32 s25, 0
v_mov_b32 v2, 0
L_pl_488:
buffer_load_dword v1, v2, s[32:35], s25 offen sc1
s_add_u32 s36, s36, 1
s_cmp_gt_u32 s36, 0x100000
s_cbranch_scc1 chain_kernel_wend
s_waitcnt vmcnt(0)
v_readfirstlane_b32 s26, v1
s_and_b32 s27, s26, 0xffff
s_cmp_ge_u32 s27, 256
s_cbranch_scc1 L_plok_489
s_sleep 4
s_branch L_pl_488
L_plok_489:
s_lshr_b32 s55, s26, 24
s_bfe_u32 s25, s26, 0x80010
s_cmp_gt_u32 s25, s55
s_cselect_b32 s25, 0x2000, 0x0
s_add_u32 s54, s100, 0x1fffff
s_and_b32 s54, s54, 0xffe00000
s_sub_u32 s55, s54, s100
s_add_u32 s54, s55, s25
s_xor_b32 s25, s25, 0x2000
s_add_u32 s55, s55, s25
s_lshl_b32 s44, s46, 15
s_lshl_b32 s25, s49, 13
s_add_u32 s44, s44, s25
s_xor_b32 s45, s44, 0x8000
s_add_u32 s44, s44, 0x6800000
s_add_u32 s45, s45, 0x6800000
s_lshr_b32 s48, s46, 1
s_lshl_b32 s48, s48, 7
s_add_u32 s48, s48, 0x590d000
v_mov_b32 v104, 0
v_mov_b32 v105, 0
v_mov_b32 v106, 0
v_mov_b32 v107, 0
v_and_b32 v2, 63, v0
v_lshlrev_b32 v3, 4, v2
v_lshlrev_b32 v112, 4, v2
s_add_u32 s28, s44, 0
buffer_store_dwordx4 v[104:107], v3, s[12:15], s28 offen sc1
s_add_u32 s28, s44, 1024
buffer_store_dwordx4 v[104:107], v3, s[12:15], s28 offen sc1
s_add_u32 s28, s44, 2048
buffer_store_dwordx4 v[104:107], v3, s[12:15], s28 offen sc1
s_add_u32 s28, s44, 3072
buffer_store_dwordx4 v[104:107], v3, s[12:15], s28 offen sc1
s_add_u32 s28, s44, 4096
buffer_store_dwordx4 v[104:107], v3, s[12:15], s28 offen sc1
s_add_u32 s28, s44, 5120
buffer_store_dwordx4 v[104:107], v3, s[12:15], s28 offen sc1
s_add_u32 s28, s44, 6144
buffer_store_dwordx4 v[104:107], v3, s[12:15], s28 offen sc1
s_add_u32 s28, s44, 7168
buffer_store_dwordx4 v[104:107], v3, s[12:15], s28 offen sc1
v_lshrrev_b32 v1, 6, v0
v_lshlrev_b32 v1, 11, v1
v_add_u32 v1, 0x21000, v1
s_waitcnt vmcnt(0)
s_barrier
buffer_atomic_add v84, v85, s[12:15], s48 offen sc1
v_mov_b32 v2, 0
L_pl_490:
buffer_load_dword v1, v2, s[12:15], s48 offen sc1
s_add_u32 s36, s36, 1
s_cmp_gt_u32 s36, 0x100000
s_cbranch_scc1 chain_kernel_wend
s_waitcnt vmcnt(0)
v_readfirstlane_b32 s26, v1
s_cmp_ge_u32 s26, 2
s_cbranch_scc1 L_plok_491
s_sleep 4
s_branch L_pl_490
L_plok_491:
s_and_b32 s47, s46, 1
s_cmp_eq_u32 s47, 1
s_cselect_b32 s16, s76, s74
s_cselect_b32 s17, s77, s75
s_and_b32 s17, s17, 0xffff
s_mov_b32 s18, 0x200000
s_mov_b32 s19, 0x00020000
s_lshr_b32 s25, s46, 1
s_lshl_b32 s25, s25, 7
s_lshl_b32 s26, s49, 5
s_add_u32 s25, s25, s26
v_and_b32 v5, 15, v0
v_lshl_add_u32 v5, v5, 1, s25
s_lshl_b32 s26, s47, 4
v_bfe_u32 v6, v0, 4, 2
v_lshl_add_u32 v6, v6, 2, s26
v_lshlrev_b32 v7, 1, v5
v_lshl_add_u32 v136, v6, 11, v7
v_add_u32 v137, 0x1000, v136
v_lshlrev_b32 v5, 2, v5
v_lshl_add_u32 v140, v6, 13, v5
v_add_u32 v141, 0x2000, v140
v_add_u32 v142, 0x4000, v140
v_add_u32 v143, 0x6000, v140
s_mov_b32 s32, s80
s_and_b32 s33, s81, 0xffff
s_mov_b32 s34, 0x800
s_mov_b32 s35, 0x00020000
buffer_load_dword v132, v7, s[32:35], 0 offen
v_and_b32 v1, 31, v0
v_bfe_u32 v2, v0, 5, 1
v_add_u32 v3, 0, v2
v_xor_b32 v4, v3, v1
v_lshlrev_b32 v4, 4, v4
v_lshlrev_b32 v3, 1, v3
v_add_u32 v3, s25, v3
v_lshl_add_u32 v20, v3, 11, v4
v_add_u32 v3, 2, v2
v_xor_b32 v4, v3, v1
v_lshlrev_b32 v4, 4, v4
v_lshlrev_b32 v3, 1, v3
v_add_u32 v3, s25, v3
v_lshl_add_u32 v21, v3, 11, v4
v_add_u32 v3, 4, v2
v_xor_b32 v4, v3, v1
v_lshlrev_b32 v4, 4, v4
v_lshlrev_b32 v3, 1, v3
v_add_u32 v3, s25, v3
v_lshl_add_u32 v22, v3, 11, v4
v_add_u32 v3, 6, v2
v_xor_b32 v4, v3, v1
v_lshlrev_b32 v4, 4, v4
v_lshlrev_b32 v3, 1, v3
v_add_u32 v3, s25, v3
v_lshl_add_u32 v23, v3, 11, v4
v_add_u32 v3, 8, v2
v_xor_b32 v4, v3, v1
v_lshlrev_b32 v4, 4, v4
v_lshlrev_b32 v3, 1, v3
v_add_u32 v3, s25, v3
v_lshl_add_u32 v24, v3, 11, v4
v_add_u32 v3, 10, v2
v_xor_b32 v4, v3, v1
v_lshlrev_b32 v4, 4, v4
v_lshlrev_b32 v3, 1, v3
v_add_u32 v3, s25, v3
v_lshl_add_u32 v25, v3, 11, v4
v_add_u32 v3, 12, v2
v_xor_b32 v4, v3, v1
v_lshlrev_b32 v4, 4, v4
v_lshlrev_b32 v3, 1, v3
v_add_u32 v3, s25, v3
v_lshl_add_u32 v26, v3, 11, v4
v_add_u32 v3, 14, v2
v_xor_b32 v4, v3, v1
v_lshlrev_b32 v4, 4, v4
v_lshlrev_b32 v3, 1, v3
v_add_u32 v3, s25, v3
v_lshl_add_u32 v27, v3, 11, v4
v_and_b32 v1, 15, v0
v_bfe_u32 v2, v0, 4, 2
v_lshrrev_b32 v3, 6, v0
v_lshlrev_b32 v3, 15, v3
v_lshl_add_u32 v3, v1, 9, v3
v_add_u32 v4, 0, v2
v_xor_b32 v4, v4, v1
v_lshl_add_u32 v28, v4, 4, v3
v_add_u32 v4, 4, v2
v_xor_b32 v4, v4, v1
v_lshl_add_u32 v29, v4, 4, v3
v_add_u32 v4, 8, v2
v_xor_b32 v4, v4, v1
v_lshl_add_u32 v30, v4, 4, v3
v_add_u32 v4, 12, v2
v_xor_b32 v4, v4, v1
v_lshl_add_u32 v31, v4, 4, v3
s_lshl_b32 s26, s49, 15
s_barrier
s_mov_b32 s27, 0
s_add_u32 m0, s26, 0
s_nop 0
buffer_load_dwordx4 v20, s[16:19], s27 offen nt lds
s_add_u32 m0, s26, 1024
s_nop 0
buffer_load_dwordx4 v21, s[16:19], s27 offen nt lds
s_add_u32 m0, s26, 2048
s_nop 0
buffer_load_dwordx4 v22, s[16:19], s27 offen nt lds
s_add_u32 m0, s26, 3072
s_nop 0
buffer_load_dwordx4 v23, s[16:19], s27 offen nt lds
s_add_u32 m0, s26, 4096
s_nop 0
buffer_load_dwordx4 v24, s[16:19], s27 offen nt lds
s_add_u32 m0, s26, 5120
s_nop 0
buffer_load_dwordx4 v25, s[16:19], s27 offen nt lds
s_add_u32 m0, s26, 6144
s_nop 0
buffer_load_dwordx4 v26, s[16:19], s27 offen nt lds
s_add_u32 m0, s26, 7168
s_nop 0
buffer_load_dwordx4 v27, s[16:19], s27 offen nt lds
s_mov_b32 s27, 2048
s_add_u32 m0, s26, 8192
s_nop 0
buffer_load_dwordx4 v20, s[16:19], s27 offen nt lds
s_add_u32 m0, s26, 9216
s_nop 0
buffer_load_dwordx4 v21, s[16:19], s27 offen nt lds
s_add_u32 m0, s26, 10240
s_nop 0
buffer_load_dwordx4 v22, s[16:19], s27 offen nt lds
s_add_u32 m0, s26, 11264
s_nop 0
buffer_load_dwordx4 v23, s[16:19], s27 offen nt lds
s_add_u32 m0, s26, 12288
s_nop 0
buffer_load_dwordx4 v24, s[16:19], s27 offen nt lds
s_add_u32 m0, s26, 13312
s_nop 0
buffer_load_dwordx4 v25, s[16:19], s27 offen nt lds
s_add_u32 m0, s26, 14336
s_nop 0
buffer_load_dwordx4 v26, s[16:19], s27 offen nt lds
s_add_u32 m0, s26, 15360
s_nop 0
buffer_load_dwordx4 v27, s[16:19], s27 offen nt lds
s_mov_b32 s27, 512
s_add_u32 m0, s26, 16384
s_nop 0
buffer_load_dwordx4 v20, s[16:19], s27 offen nt lds
s_add_u32 m0, s26, 17408
s_nop 0
buffer_load_dwordx4 v21, s[16:19], s27 offen nt lds
s_add_u32 m0, s26, 18432
s_nop 0
buffer_load_dwordx4 v22, s[16:19], s27 offen nt lds
s_add_u32 m0, s26, 19456
s_nop 0
buffer_load_dwordx4 v23, s[16:19], s27 offen nt lds
s_add_u32 m0, s26, 20480
s_nop 0
buffer_load_dwordx4 v24, s[16:19], s27 offen nt lds
s_add_u32 m0, s26, 21504
s_nop 0
buffer_load_dwordx4 v25, s[16:19], s27 offen nt lds
s_add_u32 m0, s26, 22528
s_nop 0
buffer_load_dwordx4 v26, s[16:19], s27 offen nt lds
s_add_u32 m0, s26, 23552
s_nop 0
buffer_load_dwordx4 v27, s[16:19], s27 offen nt lds
s_mov_b32 s27, 2560
s_add_u32 m0, s26, 24576
s_nop 0
buffer_load_dwordx4 v20, s[16:19], s27 offen nt lds
s_add_u32 m0, s26, 25600
s_nop 0
buffer_load_dwordx4 v21, s[16:19], s27 offen nt lds
s_add_u32 m0, s26, 26624
s_nop 0
buffer_load_dwordx4 v22, s[16:19], s27 offen nt lds
s_add_u32 m0, s26, 27648
s_nop 0
buffer_load_dwordx4 v23, s[16:19], s27 offen nt lds
s_add_u32 m0, s26, 28672
s_nop 0
buffer_load_dwordx4 v24, s[16:19], s27 offen nt lds
s_add_u32 m0, s26, 29696
s_nop 0
buffer_load_dwordx4 v25, s[16:19], s27 offen nt lds
s_add_u32 m0, s26, 30720
s_nop 0
buffer_load_dwordx4 v26, s[16:19], s27 offen nt lds
s_add_u32 m0, s26, 31744
s_nop 0
buffer_load_dwordx4 v27, s[16:19], s27 offen nt lds
s_waitcnt vmcnt(16)
ds_read_b128 a[0:3], v28 offset:0
ds_read_b128 a[4:7], v28 offset:8192
ds_read_b128 a[8:11], v29 offset:0
ds_read_b128 a[12:15], v29 offset:8192
ds_read_b128 a[16:19], v30 offset:0
ds_read_b128 a[20:23], v30 offset:8192
ds_read_b128 a[24:27], v31 offset:0
ds_read_b128 a[28:31], v31 offset:8192
s_waitcnt lgkmcnt(0)
ds_read_b128 a[32:35], v28 offset:256
ds_read_b128 a[36:39], v28 offset:8448
ds_read_b128 a[40:43], v29 offset:256
ds_read_b128 a[44:47], v29 offset:8448
ds_read_b128 a[48:51], v30 offset:256
ds_read_b128 a[52:55], v30 offset:8448
ds_read_b128 a[56:59], v31 offset:256
ds_read_b128 a[60:63], v31 offset:8448
s_waitcnt lgkmcnt(0)
s_mov_b32 s27, 1024
s_add_u32 m0, s26, 0
s_nop 0
buffer_load_dwordx4 v20, s[16:19], s27 offen nt lds
s_add_u32 m0, s26, 1024
s_nop 0
buffer_load_dwordx4 v21, s[16:19], s27 offen nt lds
s_add_u32 m0, s26, 2048
s_nop 0
buffer_load_dwordx4 v22, s[16:19], s27 offen nt lds
s_add_u32 m0, s26, 3072
s_nop 0
buffer_load_dwordx4 v23, s[16:19], s27 offen nt lds
s_add_u32 m0, s26, 4096
s_nop 0
buffer_load_dwordx4 v24, s[16:19], s27 offen nt lds
s_add_u32 m0, s26, 5120
s_nop 0
buffer_load_dwordx4 v25, s[16:19], s27 offen nt lds
s_add_u32 m0, s26, 6144
s_nop 0
buffer_load_dwordx4 v26, s[16:19], s27 offen nt lds
s_add_u32 m0, s26, 7168
s_nop 0
buffer_load_dwordx4 v27, s[16:19], s27 offen nt lds
s_mov_b32 s27, 3072
s_add_u32 m0, s26, 8192
s_nop 0
buffer_load_dwordx4 v20, s[16:19], s27 offen nt lds
s_add_u32 m0, s26, 9216
s_nop 0
buffer_load_dwordx4 v21, s[16:19], s27 offen nt lds
s_add_u32 m0, s26, 10240
s_nop 0
buffer_load_dwordx4 v22, s[16:19], s27 offen nt lds
s_add_u32 m0, s26, 11264
s_nop 0
buffer_load_dwordx4 v23, s[16:19], s27 offen nt lds
s_add_u32 m0, s26, 12288
s_nop 0
buffer_load_dwordx4 v24, s[16:19], s27 offen nt lds
s_add_u32 m0, s26, 13312
s_nop 0
buffer_load_dwordx4 v25, s[16:19], s27 offen nt lds
s_add_u32 m0, s26, 14336
s_nop 0
buffer_load_dwordx4 v26, s[16:19], s27 offen nt lds
s_add_u32 m0, s26, 15360
s_nop 0
buffer_load_dwordx4 v27, s[16:19], s27 offen nt lds
s_waitcnt vmcnt(16)
ds_read_b128 a[64:67], v28 offset:16384
ds_read_b128 a[68:71], v28 offset:24576
ds_read_b128 a[72:75], v29 offset:16384
ds_read_b128 a[76:79], v29 offset:24576
ds_read_b128 a[80:83], v30 offset:16384
ds_read_b128 a[84:87], v30 offset:24576
ds_read_b128 a[88:91], v31 offset:16384
ds_read_b128 a[92:95], v31 offset:24576
s_waitcnt lgkmcnt(0)
ds_read_b128 a[96:99], v28 offset:16640
ds_read_b128 a[100:103], v28 offset:24832
ds_read_b128 a[104:107], v29 offset:16640
ds_read_b128 a[108:111], v29 offset:24832
ds_read_b128 a[112:115], v30 offset:16640
ds_read_b128 a[116:119], v30 offset:24832
ds_read_b128 a[120:123], v31 offset:16640
ds_read_b128 a[124:127], v31 offset:24832
s_waitcnt lgkmcnt(0)
s_mov_b32 s27, 1536
s_add_u32 m0, s26, 16384
s_nop 0
buffer_load_dwordx4 v20, s[16:19], s27 offen nt lds
s_add_u32 m0, s26, 17408
s_nop 0
buffer_load_dwordx4 v21, s[16:19], s27 offen nt lds
s_add_u32 m0, s26, 18432
s_nop 0
buffer_load_dwordx4 v22, s[16:19], s27 offen nt lds
s_add_u32 m0, s26, 19456
s_nop 0
buffer_load_dwordx4 v23, s[16:19], s27 offen nt lds
s_add_u32 m0, s26, 20480
s_nop 0
buffer_load_dwordx4 v24, s[16:19], s27 offen nt lds
s_add_u32 m0, s26, 21504
s_nop 0
buffer_load_dwordx4 v25, s[16:19], s27 offen nt lds
s_add_u32 m0, s26, 22528
s_nop 0
buffer_load_dwordx4 v26, s[16:19], s27 offen nt lds
s_add_u32 m0, s26, 23552
s_nop 0
buffer_load_dwordx4 v27, s[16:19], s27 offen nt lds
s_mov_b32 s27, 3584
s_add_u32 m0, s26, 24576
s_nop 0
buffer_load_dwordx4 v20, s[16:19], s27 offen nt lds
s_add_u32 m0, s26, 25600
s_nop 0
buffer_load_dwordx4 v21, s[16:19], s27 offen nt lds
s_add_u32 m0, s26, 26624
s_nop 0
buffer_load_dwordx4 v22, s[16:19], s27 offen nt lds
s_add_u32 m0, s26, 27648
s_nop 0
buffer_load_dwordx4 v23, s[16:19], s27 offen nt lds
s_add_u32 m0, s26, 28672
s_nop 0
buffer_load_dwordx4 v24, s[16:19], s27 offen nt lds
s_add_u32 m0, s26, 29696
s_nop 0
buffer_load_dwordx4 v25, s[16:19], s27 offen nt lds
s_add_u32 m0, s26, 30720
s_nop 0
buffer_load_dwordx4 v26, s[16:19], s27 offen nt lds
s_add_u32 m0, s26, 31744
s_nop 0
buffer_load_dwordx4 v27, s[16:19], s27 offen nt lds
s_waitcnt vmcnt(16)
ds_read_b128 a[128:131], v28 offset:0
ds_read_b128 a[132:135], v28 offset:8192
ds_read_b128 a[136:139], v29 offset:0
ds_read_b128 a[140:143], v29 offset:8192
ds_read_b128 a[144:147], v30 offset:0
ds_read_b128 a[148:151], v30 offset:8192
ds_read_b128 a[152:155], v31 offset:0
ds_read_b128 a[156:159], v31 offset:8192
s_waitcnt lgkmcnt(0)
ds_read_b128 a[160:163], v28 offset:256
ds_read_b128 a[164:167], v28 offset:8448
ds_read_b128 a[168:171], v29 offset:256
ds_read_b128 a[172:175], v29 offset:8448
ds_read_b128 a[176:179], v30 offset:256
ds_read_b128 a[180:183], v30 offset:8448
ds_read_b128 a[184:187], v31 offset:256
ds_read_b128 a[188:191], v31 offset:8448
s_waitcnt lgkmcnt(0)
s_waitcnt vmcnt(0)
ds_read_b128 a[192:195], v28 offset:16384
ds_read_b128 a[196:199], v28 offset:24576
ds_read_b128 a[200:203], v29 offset:16384
ds_read_b128 a[204:207], v29 offset:24576
ds_read_b128 a[208:211], v30 offset:16384
ds_read_b128 a[212:215], v30 offset:24576
ds_read_b128 a[216:219], v31 offset:16384
ds_read_b128 a[220:223], v31 offset:24576
s_waitcnt lgkmcnt(0)
ds_read_b128 a[224:227], v28 offset:16640
ds_read_b128 a[228:231], v28 offset:24832
ds_read_b128 a[232:235], v29 offset:16640
ds_read_b128 a[236:239], v29 offset:24832
ds_read_b128 a[240:243], v30 offset:16640
ds_read_b128 a[244:247], v30 offset:24832
ds_read_b128 a[248:251], v31 offset:16640
ds_read_b128 a[252:255], v31 offset:24832
s_waitcnt lgkmcnt(0)
v_lshlrev_b32 v128, 16, v132
v_and_b32 v129, 0xffff0000, v132
s_mov_b32 s48, 0x5902000
s_lshl_b32 s50, s47, 16
s_add_u32 s50, s50, 0x4400000
s_mov_b32 s8, s100
s_and_b32 s9, s101, 0xffff
s_mov_b32 s10, 0x10000000
s_mov_b32 s11, 0x00020000
s_mov_b32 s16, s96
s_and_b32 s17, s97, 0xffff
s_mov_b32 s18, 0x1000000
s_mov_b32 s19, 0x00020000
s_mov_b32 s32, s64
s_and_b32 s33, s65, 0xffff
s_mov_b32 s34, 0x400000
s_mov_b32 s35, 0x00020000
s_lshl_b32 s47, s47, 8
s_lshl_b32 s21, s49, 12
v_and_b32 v1, 63, v0
v_and_b32 v2, 15, v0
v_bfe_u32 v3, v0, 4, 2
v_lshrrev_b32 v4, 6, v0
v_lshlrev_b32 v5, 4, v1
v_lshl_add_u32 v5, v4, 12, v5
v_add_u32 v8, 0, v5
v_add_u32 v9, 1024, v5
v_add_u32 v10, 2048, v5
v_add_u32 v11, 3072, v5
v_lshlrev_b32 v5, 4, v2
v_lshl_add_u32 v5, v3, 9, v5
v_xor_b32 v12, s47, v5
v_xor_b32 v13, 0x100, v12
v_add_u32 v16, 0x10000, v12
v_add_u32 v17, 0x10000, v13
s_mov_b32 s23, 64
s_mov_b32 s52, 0
v_mov_b32 v4, 0
s_mov_b32 s22, 0
s_sub_u32 s61, s23, 1
s_mov_b32 s24, s22
s_add_u32 s51, s24, 1
s_min_u32 s51, s51, s61
s_lshl_b32 s51, s51, 7
s_add_u32 s51, s51, s48
L_gw_493:
buffer_load_dword v87, v4, s[12:15], s51 offen sc1
s_add_u32 s36, s36, 1
s_cmp_gt_u32 s36, 0x100000
s_cbranch_scc1 chain_kernel_wend
s_waitcnt vmcnt(0)
v_readfirstlane_b32 s30, v87
s_cmp_lt_u32 s30, 16
s_cbranch_scc0 L_rgo_492
s_sleep 1
s_branch L_gw_493
L_rgo_492:
s_add_u32 s51, s24, 1
s_min_u32 s51, s51, s61
s_lshl_b32 s51, s51, 7
s_add_u32 s51, s51, s48
buffer_load_dword v87, v4, s[12:15], s51 offen sc1
s_mov_b32 s37, 0
s_mov_b32 s7, 0
v_mov_b32 v88, 0
v_mov_b32 v89, 0
v_mov_b32 v90, 0
v_mov_b32 v91, 0
v_mov_b32 v92, 0
v_mov_b32 v93, 0
v_mov_b32 v94, 0
v_mov_b32 v95, 0
s_lshl_b32 s53, s24, 17
s_add_u32 s53, s53, s50
s_mov_b32 s20, s53
s_mov_b32 s39, 0x7ff00000
s_mov_b32 s42, 0x7ff00000
s_mov_b32 s43, 0x7ff00000
s_barrier
s_add_u32 m0, s21, 0
s_nop 0
buffer_load_dwordx4 v8, s[8:11], s20 offen lds
s_add_u32 m0, s21, 1024
s_nop 0
buffer_load_dwordx4 v9, s[8:11], s20 offen lds
s_add_u32 m0, s21, 2048
s_nop 0
buffer_load_dwordx4 v10, s[8:11], s20 offen lds
s_add_u32 m0, s21, 3072
s_nop 0
buffer_load_dwordx4 v11, s[8:11], s20 offen lds
s_add_u32 s20, s20, 16384
s_add_u32 m0, s21, 16384
s_nop 0
buffer_load_dwordx4 v8, s[8:11], s20 offen lds
s_add_u32 m0, s21, 17408
s_nop 0
buffer_load_dwordx4 v9, s[8:11], s20 offen lds
s_add_u32 m0, s21, 18432
s_nop 0
buffer_load_dwordx4 v10, s[8:11], s20 offen lds
s_add_u32 m0, s21, 19456
s_nop 0
buffer_load_dwordx4 v11, s[8:11], s20 offen lds
s_add_u32 s20, s20, 16384
s_add_u32 m0, s21, 32768
s_nop 0
buffer_load_dwordx4 v8, s[8:11], s20 offen lds
s_add_u32 m0, s21, 33792
s_nop 0
buffer_load_dwordx4 v9, s[8:11], s20 offen lds
s_add_u32 m0, s21, 34816
s_nop 0
buffer_load_dwordx4 v10, s[8:11], s20 offen lds
s_add_u32 m0, s21, 35840
s_nop 0
buffer_load_dwordx4 v11, s[8:11], s20 offen lds
s_add_u32 s20, s20, 16384
s_add_u32 m0, s21, 49152
s_nop 0
buffer_load_dwordx4 v8, s[8:11], s20 offen lds
s_add_u32 m0, s21, 50176
s_nop 0
buffer_load_dwordx4 v9, s[8:11], s20 offen lds
s_add_u32 m0, s21, 51200
s_nop 0
buffer_load_dwordx4 v10, s[8:11], s20 offen lds
s_add_u32 m0, s21, 52224
s_nop 0
buffer_load_dwordx4 v11, s[8:11], s20 offen lds
L_gw_495:
buffer_load_dword v87, v4, s[12:15], s51 offen sc1
s_add_u32 s36, s36, 1
s_cmp_gt_u32 s36, 0x100000
s_cbranch_scc1 chain_kernel_wend
s_waitcnt vmcnt(0)
v_readfirstlane_b32 s30, v87
s_cmp_lt_u32 s30, 16
s_cbranch_scc0 L_gok_494
s_sleep 1
s_branch L_gw_495
L_gok_494:
s_add_u32 s24, s24, 1
s_min_u32 s24, s24, s61
s_lshl_b32 s53, s24, 17
s_add_u32 s53, s53, s50
s_add_u32 s51, s24, 1
s_min_u32 s51, s51, s61
s_lshl_b32 s51, s51, 7
s_add_u32 s51, s51, s48
buffer_load_dword v87, v4, s[12:15], s51 offen sc1
s_mov_b32 s20, s53
s_add_u32 m0, s21, 65536
s_nop 0
buffer_load_dwordx4 v8, s[8:11], s20 offen lds
s_waitcnt vmcnt(0)
s_barrier
ds_read_b128 v[20:23], v12 offset:0
ds_read_b128 v[24:27], v13 offset:0
ds_read_b128 v[28:31], v12 offset:2048
ds_read_b128 v[32:35], v13 offset:2048
ds_read_b128 v[36:39], v12 offset:4096
ds_read_b128 v[40:43], v13 offset:4096
s_waitcnt lgkmcnt(4)
L_st_499:
v_mfma_f32_16x16x32_bf16 v[52:55], v[20:23], a[0:3], 0
ds_read_b128 v[44:47], v12 offset:6144
s_add_u32 m0, s21, 66560
v_mfma_f32_16x16x32_bf16 v[56:59], v[20:23], a[4:7], 0
buffer_load_dwordx4 v9, s[8:11], s20 offen lds
v_mfma_f32_16x16x32_bf16 v[60:63], v[24:27], a[0:3], 0
ds_read_b128 v[48:51], v13 offset:6144
s_sub_u32 s38, s22, 1
v_mfma_f32_16x16x32_bf16 v[64:67], v[24:27], a[4:7], 0
s_waitcnt lgkmcnt(4)
s_and_b32 s31, s38, 3
v_mfma_f32_16x16x32_bf16 v[52:55], v[28:31], a[8:11], v[52:55]
ds_read_b128 v[20:23], v12 offset:8192
s_lshl_b32 s31, s31, 11
v_mfma_f32_16x16x32_bf16 v[56:59], v[28:31], a[12:15], v[56:59]
buffer_load_dword v132, v136, s[32:35], s42 offen offset:0
v_mfma_f32_16x16x32_bf16 v[60:63], v[32:35], a[8:11], v[60:63]
ds_read_b128 v[24:27], v13 offset:8192
v_mfma_f32_16x16x32_bf16 v[64:67], v[32:35], a[12:15], v[64:67]
s_waitcnt lgkmcnt(4)
s_bfe_u32 s38, s38, 0x10002
v_mfma_f32_16x16x32_bf16 v[52:55], v[36:39], a[16:19], v[52:55]
ds_read_b128 v[28:31], v12 offset:10240
s_add_u32 m0, s21, 67584
v_mfma_f32_16x16x32_bf16 v[56:59], v[36:39], a[20:23], v[56:59]
buffer_load_dwordx4 v10, s[8:11], s20 offen lds
v_mfma_f32_16x16x32_bf16 v[60:63], v[40:43], a[16:19], v[60:63]
ds_read_b128 v[32:35], v13 offset:10240
s_xor_b32 s38, s38, 1
v_mfma_f32_16x16x32_bf16 v[64:67], v[40:43], a[20:23], v[64:67]
s_waitcnt lgkmcnt(4)
s_cmp_eq_u32 s37, 0
s_cselect_b32 s31, 0x40000000, s31
s_cselect_b32 s38, 0, s38
v_mfma_f32_16x16x32_bf16 v[52:55], v[44:47], a[24:27], v[52:55]
ds_read_b128 v[36:39], v12 offset:12288
v_mfma_f32_16x16x32_bf16 v[56:59], v[44:47], a[28:31], v[56:59]
buffer_load_dword v133, v136, s[32:35], s42 offen offset:2048
v_mfma_f32_16x16x32_bf16 v[60:63], v[48:51], a[24:27], v[60:63]
ds_read_b128 v[40:43], v13 offset:12288
v_mfma_f32_16x16x32_bf16 v[64:67], v[48:51], a[28:31], v[64:67]
s_waitcnt lgkmcnt(4)
v_mfma_f32_16x16x32_bf16 v[52:55], v[20:23], a[32:35], v[52:55]
ds_read_b128 v[44:47], v12 offset:14336
s_add_u32 m0, s21, 68608
v_mfma_f32_16x16x32_bf16 v[56:59], v[20:23], a[36:39], v[56:59]
buffer_load_dwordx4 v11, s[8:11], s20 offen lds
v_mfma_f32_16x16x32_bf16 v[60:63], v[24:27], a[32:35], v[60:63]
ds_read_b128 v[48:51], v13 offset:14336
v_cvt_pk_bf16_f32 v104, v76, v80
v_mfma_f32_16x16x32_bf16 v[64:67], v[24:27], a[36:39], v[64:67]
s_waitcnt lgkmcnt(4)
v_mfma_f32_16x16x32_bf16 v[52:55], v[28:31], a[40:43], v[52:55]
s_waitcnt vmcnt(20)
s_barrier
ds_read_b128 v[20:23], v12 offset:16384
v_mfma_f32_16x16x32_bf16 v[56:59], v[28:31], a[44:47], v[56:59]
s_add_u32 s20, s20, 16384
v_cvt_pk_bf16_f32 v105, v77, v81
v_mfma_f32_16x16x32_bf16 v[60:63], v[32:35], a[40:43], v[60:63]
ds_read_b128 v[24:27], v13 offset:16384
v_cvt_pk_bf16_f32 v106, v78, v82
v_mfma_f32_16x16x32_bf16 v[64:67], v[32:35], a[44:47], v[64:67]
s_waitcnt lgkmcnt(4)
v_cvt_pk_bf16_f32 v107, v79, v83
v_mfma_f32_16x16x32_bf16 v[52:55], v[36:39], a[48:51], v[52:55]
ds_read_b128 v[28:31], v12 offset:18432
s_add_u32 m0, s21, 81920
v_mfma_f32_16x16x32_bf16 v[56:59], v[36:39], a[52:55], v[56:59]
buffer_load_dwordx4 v8, s[8:11], s20 offen lds
v_mfma_f32_16x16x32_bf16 v[60:63], v[40:43], a[48:51], v[60:63]
ds_read_b128 v[32:35], v13 offset:18432
v_mfma_f32_16x16x32_bf16 v[64:67], v[40:43], a[52:55], v[64:67]
s_waitcnt lgkmcnt(4)
v_and_or_b32 v104, v104, -2, s38
v_mfma_f32_16x16x32_bf16 v[52:55], v[44:47], a[56:59], v[52:55]
ds_read_b128 v[36:39], v12 offset:20480
v_and_or_b32 v105, v105, -2, s38
v_mfma_f32_16x16x32_bf16 v[56:59], v[44:47], a[60:63], v[56:59]
buffer_load_dword v134, v137, s[32:35], s42 offen offset:0
v_mfma_f32_16x16x32_bf16 v[60:63], v[48:51], a[56:59], v[60:63]
ds_read_b128 v[40:43], v13 offset:20480
v_and_or_b32 v106, v106, -2, s38
v_mfma_f32_16x16x32_bf16 v[64:67], v[48:51], a[60:63], v[64:67]
s_waitcnt lgkmcnt(4)
v_mfma_f32_16x16x32_bf16 v[52:55], v[20:23], a[64:67], v[52:55]
ds_read_b128 v[44:47], v12 offset:22528
s_add_u32 m0, s21, 82944
v_mfma_f32_16x16x32_bf16 v[56:59], v[20:23], a[68:71], v[56:59]
buffer_load_dwordx4 v9, s[8:11], s20 offen lds
v_mfma_f32_16x16x32_bf16 v[60:63], v[24:27], a[64:67], v[60:63]
ds_read_b128 v[48:51], v13 offset:22528
v_and_or_b32 v107, v107, -2, s38
v_mfma_f32_16x16x32_bf16 v[64:67], v[24:27], a[68:71], v[64:67]
s_waitcnt lgkmcnt(4)
s_add_u32 s29, s45, s31
v_mfma_f32_16x16x32_bf16 v[52:55], v[28:31], a[72:75], v[52:55]
ds_read_b128 v[20:23], v12 offset:24576
v_mfma_f32_16x16x32_bf16 v[56:59], v[28:31], a[76:79], v[56:59]
buffer_store_dwordx4 v[104:107], v112, s[12:15], s29 offen offset:0 sc1
v_mfma_f32_16x16x32_bf16 v[60:63], v[32:35], a[72:75], v[60:63]
ds_read_b128 v[24:27], v13 offset:24576
s_add_u32 s51, s24, 1
v_mfma_f32_16x16x32_bf16 v[64:67], v[32:35], a[76:79], v[64:67]
s_waitcnt lgkmcnt(4)
v_mfma_f32_16x16x32_bf16 v[52:55], v[36:39], a[80:83], v[52:55]
ds_read_b128 v[28:31], v12 offset:26624
s_add_u32 m0, s21, 83968
v_mfma_f32_16x16x32_bf16 v[56:59], v[36:39], a[84:87], v[56:59]
buffer_load_dwordx4 v10, s[8:11], s20 offen lds
v_mfma_f32_16x16x32_bf16 v[60:63], v[40:43], a[80:83], v[60:63]
ds_read_b128 v[32:35], v13 offset:26624
s_min_u32 s51, s51, s61
v_mfma_f32_16x16x32_bf16 v[64:67], v[40:43], a[84:87], v[64:67]
s_waitcnt lgkmcnt(4)
v_mfma_f32_16x16x32_bf16 v[52:55], v[44:47], a[88:91], v[52:55]
ds_read_b128 v[36:39], v12 offset:28672
s_lshl_b32 s51, s51, 7
v_mfma_f32_16x16x32_bf16 v[56:59], v[44:47], a[92:95], v[56:59]
buffer_load_dword v135, v137, s[32:35], s42 offen offset:2048
v_mfma_f32_16x16x32_bf16 v[60:63], v[48:51], a[88:91], v[60:63]
ds_read_b128 v[40:43], v13 offset:28672
v_mfma_f32_16x16x32_bf16 v[64:67], v[48:51], a[92:95], v[64:67]
s_waitcnt lgkmcnt(4)
s_add_u32 s51, s51, s48
v_mfma_f32_16x16x32_bf16 v[52:55], v[20:23], a[96:99], v[52:55]
ds_read_b128 v[44:47], v12 offset:30720
s_add_u32 m0, s21, 84992
v_mfma_f32_16x16x32_bf16 v[56:59], v[20:23], a[100:103], v[56:59]
buffer_load_dwordx4 v11, s[8:11], s20 offen lds
v_mfma_f32_16x16x32_bf16 v[60:63], v[24:27], a[96:99], v[60:63]
ds_read_b128 v[48:51], v13 offset:30720
s_waitcnt vmcnt(12)
v_xor_b32 v124, s7, v88
v_mfma_f32_16x16x32_bf16 v[64:67], v[24:27], a[100:103], v[64:67]
s_waitcnt lgkmcnt(4)
v_bitop3_b32 v124, v124, v89, s7 bitop3:0xf6
v_bitop3_b32 v124, v124, v90, s7 bitop3:0xf6
v_mfma_f32_16x16x32_bf16 v[52:55], v[28:31], a[104:107], v[52:55]
s_waitcnt vmcnt(22)
s_barrier
ds_read_b128 v[20:23], v12 offset:32768
v_mfma_f32_16x16x32_bf16 v[56:59], v[28:31], a[108:111], v[56:59]
s_add_u32 s20, s20, 16384
buffer_load_dword v87, v4, s[12:15], s51 offen sc1
v_mfma_f32_16x16x32_bf16 v[60:63], v[32:35], a[104:107], v[60:63]
ds_read_b128 v[24:27], v13 offset:32768
v_bitop3_b32 v124, v124, v91, s7 bitop3:0xf6
v_mfma_f32_16x16x32_bf16 v[64:67], v[32:35], a[108:111], v[64:67]
s_waitcnt lgkmcnt(4)
v_and_b32 v124, 1, v124
v_cmp_ne_u32 vcc, 0, v124
v_mfma_f32_16x16x32_bf16 v[52:55], v[36:39], a[112:115], v[52:55]
ds_read_b128 v[28:31], v12 offset:34816
s_add_u32 m0, s21, 98304
s_nop 0
v_mfma_f32_16x16x32_bf16 v[56:59], v[36:39], a[116:119], v[56:59]
buffer_load_dwordx4 v8, s[8:11], s20 offen lds
s_nop 0
v_mfma_f32_16x16x32_bf16 v[60:63], v[40:43], a[112:115], v[60:63]
ds_read_b128 v[32:35], v13 offset:34816
s_nop 0
v_mfma_f32_16x16x32_bf16 v[64:67], v[40:43], a[116:119], v[64:67]
s_waitcnt lgkmcnt(4)
s_cbranch_vccnz L_rbad_500
L_rok_501:
v_mfma_f32_16x16x32_bf16 v[52:55], v[44:47], a[120:123], v[52:55]
ds_read_b128 v[36:39], v12 offset:36864
v_lshlrev_b32 v124, 16, v88
v_and_b32 v125, 0xffff0000, v88
v_mfma_f32_16x16x32_bf16 v[56:59], v[44:47], a[124:127], v[56:59]
v_and_b32 v124, 0xfffe0000, v124
v_add_f32 v96, v116, v124
v_mfma_f32_16x16x32_bf16 v[60:63], v[48:51], a[120:123], v[60:63]
ds_read_b128 v[40:43], v13 offset:36864
v_add_f32 v97, v117, v125
v_lshlrev_b32 v124, 16, v89
v_mfma_f32_16x16x32_bf16 v[64:67], v[48:51], a[124:127], v[64:67]
s_waitcnt lgkmcnt(4)
v_and_b32 v125, 0xffff0000, v89
v_mfma_f32_16x16x32_bf16 v[52:55], v[20:23], a[128:131], v[52:55]
ds_read_b128 v[44:47], v12 offset:38912
s_add_u32 m0, s21, 99328
v_and_b32 v124, 0xfffe0000, v124
v_mfma_f32_16x16x32_bf16 v[56:59], v[20:23], a[132:135], v[56:59]
buffer_load_dwordx4 v9, s[8:11], s20 offen lds
v_add_f32 v98, v118, v124
v_mfma_f32_16x16x32_bf16 v[60:63], v[24:27], a[128:131], v[60:63]
ds_read_b128 v[48:51], v13 offset:38912
v_add_f32 v99, v119, v125
v_lshlrev_b32 v124, 16, v90
v_mfma_f32_16x16x32_bf16 v[64:67], v[24:27], a[132:135], v[64:67]
s_waitcnt lgkmcnt(4)
v_and_b32 v125, 0xffff0000, v90
v_mfma_f32_16x16x32_bf16 v[52:55], v[28:31], a[136:139], v[52:55]
ds_read_b128 v[20:23], v12 offset:40960
v_and_b32 v124, 0xfffe0000, v124
v_add_f32 v100, v120, v124
v_mfma_f32_16x16x32_bf16 v[56:59], v[28:31], a[140:143], v[56:59]
v_add_f32 v101, v121, v125
v_lshlrev_b32 v124, 16, v91
v_mfma_f32_16x16x32_bf16 v[60:63], v[32:35], a[136:139], v[60:63]
ds_read_b128 v[24:27], v13 offset:40960
v_and_b32 v125, 0xffff0000, v91
v_and_b32 v124, 0xfffe0000, v124
v_mfma_f32_16x16x32_bf16 v[64:67], v[32:35], a[140:143], v[64:67]
s_waitcnt lgkmcnt(4)
v_add_f32 v102, v122, v124
v_add_f32 v103, v123, v125
v_mfma_f32_16x16x32_bf16 v[52:55], v[36:39], a[144:147], v[52:55]
ds_read_b128 v[28:31], v12 offset:43008
s_add_u32 m0, s21, 100352
v_mfma_f32_16x16x32_bf16 v[56:59], v[36:39], a[148:151], v[56:59]
buffer_load_dwordx4 v10, s[8:11], s20 offen lds
v_mfma_f32_16x16x32_bf16 v[60:63], v[40:43], a[144:147], v[60:63]
ds_read_b128 v[32:35], v13 offset:43008
v_mfma_f32_16x16x32_bf16 v[64:67], v[40:43], a[148:151], v[64:67]
s_waitcnt lgkmcnt(4)
v_mfma_f32_16x16x32_bf16 v[52:55], v[44:47], a[152:155], v[52:55]
ds_read_b128 v[36:39], v12 offset:45056
s_waitcnt vmcnt(5)
v_lshlrev_b32 v130, 16, v132
v_mfma_f32_16x16x32_bf16 v[56:59], v[44:47], a[156:159], v[56:59]
v_and_b32 v131, 0xffff0000, v132
v_mfma_f32_16x16x32_bf16 v[60:63], v[48:51], a[152:155], v[60:63]
ds_read_b128 v[40:43], v13 offset:45056
v_mul_f32 v130, v130, v128
v_mul_f32 v131, v131, v129
v_mfma_f32_16x16x32_bf16 v[64:67], v[48:51], a[156:159], v[64:67]
s_waitcnt lgkmcnt(4)
v_cvt_pk_bf16_f32 v130, 0, v130
v_mfma_f32_16x16x32_bf16 v[52:55], v[20:23], a[160:163], v[52:55]
ds_read_b128 v[44:47], v12 offset:47104
s_add_u32 m0, s21, 101376
v_mfma_f32_16x16x32_bf16 v[56:59], v[20:23], a[164:167], v[56:59]
buffer_load_dwordx4 v11, s[8:11], s20 offen lds
v_cvt_pk_bf16_f32 v131, 0, v131
v_mfma_f32_16x16x32_bf16 v[60:63], v[24:27], a[160:163], v[60:63]
ds_read_b128 v[48:51], v13 offset:47104
v_add_f32 v96, v96, v130
v_mfma_f32_16x16x32_bf16 v[64:67], v[24:27], a[164:167], v[64:67]
s_waitcnt lgkmcnt(4)
v_add_f32 v97, v97, v131
v_mfma_f32_16x16x32_bf16 v[52:55], v[28:31], a[168:171], v[52:55]
s_waitcnt vmcnt(19)
s_barrier
ds_read_b128 v[20:23], v12 offset:49152
v_mfma_f32_16x16x32_bf16 v[56:59], v[28:31], a[172:175], v[56:59]
s_add_u32 s20, s20, 16384
buffer_store_dwordx2 v[96:97], v140, s[16:19], s43 offen
v_mfma_f32_16x16x32_bf16 v[60:63], v[32:35], a[168:171], v[60:63]
ds_read_b128 v[24:27], v13 offset:49152
v_lshlrev_b32 v130, 16, v133
v_and_b32 v131, 0xffff0000, v133
v_mfma_f32_16x16x32_bf16 v[64:67], v[32:35], a[172:175], v[64:67]
s_waitcnt lgkmcnt(4)
v_mul_f32 v130, v130, v128
v_mfma_f32_16x16x32_bf16 v[52:55], v[36:39], a[176:179], v[52:55]
ds_read_b128 v[28:31], v12 offset:51200
s_add_u32 m0, s21, 114688
v_mul_f32 v131, v131, v129
v_mfma_f32_16x16x32_bf16 v[56:59], v[36:39], a[180:183], v[56:59]
buffer_load_dwordx4 v8, s[8:11], s20 offen lds
v_mfma_f32_16x16x32_bf16 v[60:63], v[40:43], a[176:179], v[60:63]
ds_read_b128 v[32:35], v13 offset:51200
v_cvt_pk_bf16_f32 v130, 0, v130
v_mfma_f32_16x16x32_bf16 v[64:67], v[40:43], a[180:183], v[64:67]
s_waitcnt lgkmcnt(4)
v_cvt_pk_bf16_f32 v131, 0, v131
v_add_f32 v98, v98, v130
v_mfma_f32_16x16x32_bf16 v[52:55], v[44:47], a[184:187], v[52:55]
ds_read_b128 v[36:39], v12 offset:53248
v_add_f32 v99, v99, v131
v_mfma_f32_16x16x32_bf16 v[56:59], v[44:47], a[188:191], v[56:59]
buffer_store_dwordx2 v[98:99], v141, s[16:19], s43 offen
v_lshlrev_b32 v130, 16, v134
v_mfma_f32_16x16x32_bf16 v[60:63], v[48:51], a[184:187], v[60:63]
ds_read_b128 v[40:43], v13 offset:53248
v_and_b32 v131, 0xffff0000, v134
v_mfma_f32_16x16x32_bf16 v[64:67], v[48:51], a[188:191], v[64:67]
s_waitcnt lgkmcnt(4)
v_mul_f32 v130, v130, v128
v_mfma_f32_16x16x32_bf16 v[52:55], v[20:23], a[192:195], v[52:55]
ds_read_b128 v[44:47], v12 offset:55296
s_add_u32 m0, s21, 115712
v_mul_f32 v131, v131, v129
v_mfma_f32_16x16x32_bf16 v[56:59], v[20:23], a[196:199], v[56:59]
buffer_load_dwordx4 v9, s[8:11], s20 offen lds
v_mfma_f32_16x16x32_bf16 v[60:63], v[24:27], a[192:195], v[60:63]
ds_read_b128 v[48:51], v13 offset:55296
v_cvt_pk_bf16_f32 v130, 0, v130
v_cvt_pk_bf16_f32 v131, 0, v131
v_mfma_f32_16x16x32_bf16 v[64:67], v[24:27], a[196:199], v[64:67]
s_waitcnt lgkmcnt(4)
v_add_f32 v100, v100, v130
v_mfma_f32_16x16x32_bf16 v[52:55], v[28:31], a[200:203], v[52:55]
ds_read_b128 v[20:23], v12 offset:57344
v_add_f32 v101, v101, v131
v_mfma_f32_16x16x32_bf16 v[56:59], v[28:31], a[204:207], v[56:59]
buffer_store_dwordx2 v[100:101], v142, s[16:19], s43 offen
v_lshlrev_b32 v130, 16, v135
v_mfma_f32_16x16x32_bf16 v[60:63], v[32:35], a[200:203], v[60:63]
ds_read_b128 v[24:27], v13 offset:57344
s_add_u32 s24, s24, 1
v_and_b32 v131, 0xffff0000, v135
v_mfma_f32_16x16x32_bf16 v[64:67], v[32:35], a[204:207], v[64:67]
s_waitcnt lgkmcnt(4)
s_min_u32 s24, s24, s61
v_mul_f32 v130, v130, v128
v_mfma_f32_16x16x32_bf16 v[52:55], v[36:39], a[208:211], v[52:55]
ds_read_b128 v[28:31], v12 offset:59392
s_add_u32 m0, s21, 116736
s_lshl_b32 s53, s24, 17
v_mul_f32 v131, v131, v129
v_mfma_f32_16x16x32_bf16 v[56:59], v[36:39], a[212:215], v[56:59]
buffer_load_dwordx4 v10, s[8:11], s20 offen lds
v_cvt_pk_bf16_f32 v130, 0, v130
v_mfma_f32_16x16x32_bf16 v[60:63], v[40:43], a[208:211], v[60:63]
ds_read_b128 v[32:35], v13 offset:59392
s_add_u32 s53, s53, s50
v_cvt_pk_bf16_f32 v131, 0, v131
v_mfma_f32_16x16x32_bf16 v[64:67], v[40:43], a[212:215], v[64:67]
s_waitcnt lgkmcnt(4)
s_waitcnt vmcnt(10)
v_add_f32 v102, v102, v130
v_mfma_f32_16x16x32_bf16 v[52:55], v[44:47], a[216:219], v[52:55]
ds_read_b128 v[36:39], v12 offset:61440
v_readfirstlane_b32 s30, v87
v_add_f32 v103, v103, v131
v_mfma_f32_16x16x32_bf16 v[56:59], v[44:47], a[220:223], v[56:59]
s_nop 0
buffer_store_dwordx2 v[102:103], v143, s[16:19], s43 offen
v_mfma_f32_16x16x32_bf16 v[60:63], v[48:51], a[216:219], v[60:63]
ds_read_b128 v[40:43], v13 offset:61440
s_nop 0
v_mfma_f32_16x16x32_bf16 v[64:67], v[48:51], a[220:223], v[64:67]
s_waitcnt lgkmcnt(4)
s_cmp_lt_u32 s30, 16
s_cbranch_scc1 L_gw_503
L_gok_502:
v_mfma_f32_16x16x32_bf16 v[52:55], v[20:23], a[224:227], v[52:55]
ds_read_b128 v[44:47], v12 offset:63488
s_add_u32 m0, s21, 117760
v_mfma_f32_16x16x32_bf16 v[56:59], v[20:23], a[228:231], v[56:59]
buffer_load_dwordx4 v11, s[8:11], s20 offen lds
v_mfma_f32_16x16x32_bf16 v[60:63], v[24:27], a[224:227], v[60:63]
ds_read_b128 v[48:51], v13 offset:63488
v_mov_b32 v116, v68
v_mov_b32 v117, v72
v_mfma_f32_16x16x32_bf16 v[64:67], v[24:27], a[228:231], v[64:67]
s_waitcnt lgkmcnt(4)
v_mov_b32 v118, v69
v_mov_b32 v119, v73
v_mfma_f32_16x16x32_bf16 v[52:55], v[28:31], a[232:235], v[52:55]
s_waitcnt vmcnt(20)
s_barrier
ds_read_b128 v[20:23], v16 offset:0
v_mfma_f32_16x16x32_bf16 v[56:59], v[28:31], a[236:239], v[56:59]
s_mov_b32 s20, s53
v_mov_b32 v120, v70
v_mov_b32 v121, v74
v_mfma_f32_16x16x32_bf16 v[60:63], v[32:35], a[232:235], v[60:63]
ds_read_b128 v[24:27], v17 offset:0
v_mov_b32 v122, v71
v_mfma_f32_16x16x32_bf16 v[64:67], v[32:35], a[236:239], v[64:67]
s_waitcnt lgkmcnt(4)
v_mov_b32 v123, v75
s_mov_b32 s7, s38
v_mfma_f32_16x16x32_bf16 v[52:55], v[36:39], a[240:243], v[52:55]
ds_read_b128 v[28:31], v16 offset:2048
s_add_u32 m0, s21, 0
s_add_u32 s39, s44, s31
v_mfma_f32_16x16x32_bf16 v[56:59], v[36:39], a[244:247], v[56:59]
buffer_load_dwordx4 v8, s[8:11], s20 offen lds
s_sub_u32 s43, s22, 1
v_mfma_f32_16x16x32_bf16 v[60:63], v[40:43], a[240:243], v[60:63]
ds_read_b128 v[32:35], v17 offset:2048
s_lshl_b32 s42, s43, 16
v_mfma_f32_16x16x32_bf16 v[64:67], v[40:43], a[244:247], v[64:67]
s_waitcnt lgkmcnt(4)
s_lshl_b32 s43, s43, 18
s_cmp_eq_u32 s37, 0
s_cselect_b32 s42, 0x7ff00000, s42
s_cselect_b32 s43, 0x7ff00000, s43
v_mfma_f32_16x16x32_bf16 v[52:55], v[44:47], a[248:251], v[52:55]
ds_read_b128 v[36:39], v16 offset:4096
v_mfma_f32_16x16x32_bf16 v[56:59], v[44:47], a[252:255], v[56:59]
buffer_load_dwordx4 v[88:91], v112, s[12:15], s39 offen offset:0 sc1
v_mfma_f32_16x16x32_bf16 v[60:63], v[48:51], a[248:251], v[60:63]
ds_read_b128 v[40:43], v17 offset:4096
s_mov_b32 s37, 1
v_mfma_f32_16x16x32_bf16 v[64:67], v[48:51], a[252:255], v[64:67]
s_waitcnt lgkmcnt(4)
s_add_u32 s22, s22, 1
s_cmp_ge_u32 s22, s23
s_cbranch_scc1 L_fl0_496
v_mfma_f32_16x16x32_bf16 v[68:71], v[20:23], a[0:3], 0
ds_read_b128 v[44:47], v16 offset:6144
s_add_u32 m0, s21, 1024
v_mfma_f32_16x16x32_bf16 v[72:75], v[20:23], a[4:7], 0
buffer_load_dwordx4 v9, s[8:11], s20 offen lds
v_mfma_f32_16x16x32_bf16 v[76:79], v[24:27], a[0:3], 0
ds_read_b128 v[48:51], v17 offset:6144
s_sub_u32 s38, s22, 1
v_mfma_f32_16x16x32_bf16 v[80:83], v[24:27], a[4:7], 0
s_waitcnt lgkmcnt(4)
s_and_b32 s31, s38, 3
v_mfma_f32_16x16x32_bf16 v[68:71], v[28:31], a[8:11], v[68:71]
ds_read_b128 v[20:23], v16 offset:8192
s_lshl_b32 s31, s31, 11
v_mfma_f32_16x16x32_bf16 v[72:75], v[28:31], a[12:15], v[72:75]
buffer_load_dword v132, v136, s[32:35], s42 offen offset:0
v_mfma_f32_16x16x32_bf16 v[76:79], v[32:35], a[8:11], v[76:79]
ds_read_b128 v[24:27], v17 offset:8192
v_mfma_f32_16x16x32_bf16 v[80:83], v[32:35], a[12:15], v[80:83]
s_waitcnt lgkmcnt(4)
s_bfe_u32 s38, s38, 0x10002
v_mfma_f32_16x16x32_bf16 v[68:71], v[36:39], a[16:19], v[68:71]
ds_read_b128 v[28:31], v16 offset:10240
s_add_u32 m0, s21, 2048
v_mfma_f32_16x16x32_bf16 v[72:75], v[36:39], a[20:23], v[72:75]
buffer_load_dwordx4 v10, s[8:11], s20 offen lds
v_mfma_f32_16x16x32_bf16 v[76:79], v[40:43], a[16:19], v[76:79]
ds_read_b128 v[32:35], v17 offset:10240
s_xor_b32 s38, s38, 1
v_mfma_f32_16x16x32_bf16 v[80:83], v[40:43], a[20:23], v[80:83]
s_waitcnt lgkmcnt(4)
s_cmp_eq_u32 s37, 0
s_cselect_b32 s31, 0x40000000, s31
s_cselect_b32 s38, 0, s38
v_mfma_f32_16x16x32_bf16 v[68:71], v[44:47], a[24:27], v[68:71]
ds_read_b128 v[36:39], v16 offset:12288
v_mfma_f32_16x16x32_bf16 v[72:75], v[44:47], a[28:31], v[72:75]
buffer_load_dword v133, v136, s[32:35], s42 offen offset:2048
v_mfma_f32_16x16x32_bf16 v[76:79], v[48:51], a[24:27], v[76:79]
ds_read_b128 v[40:43], v17 offset:12288
v_mfma_f32_16x16x32_bf16 v[80:83], v[48:51], a[28:31], v[80:83]
s_waitcnt lgkmcnt(4)
v_mfma_f32_16x16x32_bf16 v[68:71], v[20:23], a[32:35], v[68:71]
ds_read_b128 v[44:47], v16 offset:14336
s_add_u32 m0, s21, 3072
v_mfma_f32_16x16x32_bf16 v[72:75], v[20:23], a[36:39], v[72:75]
buffer_load_dwordx4 v11, s[8:11], s20 offen lds
v_mfma_f32_16x16x32_bf16 v[76:79], v[24:27], a[32:35], v[76:79]
ds_read_b128 v[48:51], v17 offset:14336
v_cvt_pk_bf16_f32 v104, v60, v64
v_mfma_f32_16x16x32_bf16 v[80:83], v[24:27], a[36:39], v[80:83]
s_waitcnt lgkmcnt(4)
v_mfma_f32_16x16x32_bf16 v[68:71], v[28:31], a[40:43], v[68:71]
s_waitcnt vmcnt(20)
s_barrier
ds_read_b128 v[20:23], v16 offset:16384
v_mfma_f32_16x16x32_bf16 v[72:75], v[28:31], a[44:47], v[72:75]
s_add_u32 s20, s20, 16384
v_cvt_pk_bf16_f32 v105, v61, v65
v_mfma_f32_16x16x32_bf16 v[76:79], v[32:35], a[40:43], v[76:79]
ds_read_b128 v[24:27], v17 offset:16384
v_cvt_pk_bf16_f32 v106, v62, v66
v_mfma_f32_16x16x32_bf16 v[80:83], v[32:35], a[44:47], v[80:83]
s_waitcnt lgkmcnt(4)
v_cvt_pk_bf16_f32 v107, v63, v67
v_mfma_f32_16x16x32_bf16 v[68:71], v[36:39], a[48:51], v[68:71]
ds_read_b128 v[28:31], v16 offset:18432
s_add_u32 m0, s21, 16384
v_mfma_f32_16x16x32_bf16 v[72:75], v[36:39], a[52:55], v[72:75]
buffer_load_dwordx4 v8, s[8:11], s20 offen lds
v_mfma_f32_16x16x32_bf16 v[76:79], v[40:43], a[48:51], v[76:79]
ds_read_b128 v[32:35], v17 offset:18432
v_mfma_f32_16x16x32_bf16 v[80:83], v[40:43], a[52:55], v[80:83]
s_waitcnt lgkmcnt(4)
v_and_or_b32 v104, v104, -2, s38
v_mfma_f32_16x16x32_bf16 v[68:71], v[44:47], a[56:59], v[68:71]
ds_read_b128 v[36:39], v16 offset:20480
v_and_or_b32 v105, v105, -2, s38
v_mfma_f32_16x16x32_bf16 v[72:75], v[44:47], a[60:63], v[72:75]
buffer_load_dword v134, v137, s[32:35], s42 offen offset:0
v_mfma_f32_16x16x32_bf16 v[76:79], v[48:51], a[56:59], v[76:79]
ds_read_b128 v[40:43], v17 offset:20480
v_and_or_b32 v106, v106, -2, s38
v_mfma_f32_16x16x32_bf16 v[80:83], v[48:51], a[60:63], v[80:83]
s_waitcnt lgkmcnt(4)
v_mfma_f32_16x16x32_bf16 v[68:71], v[20:23], a[64:67], v[68:71]
ds_read_b128 v[44:47], v16 offset:22528
s_add_u32 m0, s21, 17408
v_mfma_f32_16x16x32_bf16 v[72:75], v[20:23], a[68:71], v[72:75]
buffer_load_dwordx4 v9, s[8:11], s20 offen lds
v_mfma_f32_16x16x32_bf16 v[76:79], v[24:27], a[64:67], v[76:79]
ds_read_b128 v[48:51], v17 offset:22528
v_and_or_b32 v107, v107, -2, s38
v_mfma_f32_16x16x32_bf16 v[80:83], v[24:27], a[68:71], v[80:83]
s_waitcnt lgkmcnt(4)
s_add_u32 s29, s45, s31
v_mfma_f32_16x16x32_bf16 v[68:71], v[28:31], a[72:75], v[68:71]
ds_read_b128 v[20:23], v16 offset:24576
v_mfma_f32_16x16x32_bf16 v[72:75], v[28:31], a[76:79], v[72:75]
buffer_store_dwordx4 v[104:107], v112, s[12:15], s29 offen offset:0 sc1
v_mfma_f32_16x16x32_bf16 v[76:79], v[32:35], a[72:75], v[76:79]
ds_read_b128 v[24:27], v17 offset:24576
s_add_u32 s51, s24, 1
v_mfma_f32_16x16x32_bf16 v[80:83], v[32:35], a[76:79], v[80:83]
s_waitcnt lgkmcnt(4)
v_mfma_f32_16x16x32_bf16 v[68:71], v[36:39], a[80:83], v[68:71]
ds_read_b128 v[28:31], v16 offset:26624
s_add_u32 m0, s21, 18432
v_mfma_f32_16x16x32_bf16 v[72:75], v[36:39], a[84:87], v[72:75]
buffer_load_dwordx4 v10, s[8:11], s20 offen lds
v_mfma_f32_16x16x32_bf16 v[76:79], v[40:43], a[80:83], v[76:79]
ds_read_b128 v[32:35], v17 offset:26624
s_min_u32 s51, s51, s61
v_mfma_f32_16x16x32_bf16 v[80:83], v[40:43], a[84:87], v[80:83]
s_waitcnt lgkmcnt(4)
v_mfma_f32_16x16x32_bf16 v[68:71], v[44:47], a[88:91], v[68:71]
ds_read_b128 v[36:39], v16 offset:28672
s_lshl_b32 s51, s51, 7
v_mfma_f32_16x16x32_bf16 v[72:75], v[44:47], a[92:95], v[72:75]
buffer_load_dword v135, v137, s[32:35], s42 offen offset:2048
v_mfma_f32_16x16x32_bf16 v[76:79], v[48:51], a[88:91], v[76:79]
ds_read_b128 v[40:43], v17 offset:28672
v_mfma_f32_16x16x32_bf16 v[80:83], v[48:51], a[92:95], v[80:83]
s_waitcnt lgkmcnt(4)
s_add_u32 s51, s51, s48
v_mfma_f32_16x16x32_bf16 v[68:71], v[20:23], a[96:99], v[68:71]
ds_read_b128 v[44:47], v16 offset:30720
s_add_u32 m0, s21, 19456
v_mfma_f32_16x16x32_bf16 v[72:75], v[20:23], a[100:103], v[72:75]
buffer_load_dwordx4 v11, s[8:11], s20 offen lds
v_mfma_f32_16x16x32_bf16 v[76:79], v[24:27], a[96:99], v[76:79]
ds_read_b128 v[48:51], v17 offset:30720
s_waitcnt vmcnt(12)
v_xor_b32 v124, s7, v88
v_mfma_f32_16x16x32_bf16 v[80:83], v[24:27], a[100:103], v[80:83]
s_waitcnt lgkmcnt(4)
v_bitop3_b32 v124, v124, v89, s7 bitop3:0xf6
v_bitop3_b32 v124, v124, v90, s7 bitop3:0xf6
v_mfma_f32_16x16x32_bf16 v[68:71], v[28:31], a[104:107], v[68:71]
s_waitcnt vmcnt(22)
s_barrier
ds_read_b128 v[20:23], v16 offset:32768
v_mfma_f32_16x16x32_bf16 v[72:75], v[28:31], a[108:111], v[72:75]
s_add_u32 s20, s20, 16384
buffer_load_dword v87, v4, s[12:15], s51 offen sc1
v_mfma_f32_16x16x32_bf16 v[76:79], v[32:35], a[104:107], v[76:79]
ds_read_b128 v[24:27], v17 offset:32768
v_bitop3_b32 v124, v124, v91, s7 bitop3:0xf6
v_mfma_f32_16x16x32_bf16 v[80:83], v[32:35], a[108:111], v[80:83]
s_waitcnt lgkmcnt(4)
v_and_b32 v124, 1, v124
v_cmp_ne_u32 vcc, 0, v124
v_mfma_f32_16x16x32_bf16 v[68:71], v[36:39], a[112:115], v[68:71]
ds_read_b128 v[28:31], v16 offset:34816
s_add_u32 m0, s21, 32768
s_nop 0
v_mfma_f32_16x16x32_bf16 v[72:75], v[36:39], a[116:119], v[72:75]
buffer_load_dwordx4 v8, s[8:11], s20 offen lds
s_nop 0
v_mfma_f32_16x16x32_bf16 v[76:79], v[40:43], a[112:115], v[76:79]
ds_read_b128 v[32:35], v17 offset:34816
s_nop 0
v_mfma_f32_16x16x32_bf16 v[80:83], v[40:43], a[116:119], v[80:83]
s_waitcnt lgkmcnt(4)
s_cbranch_vccnz L_rbad_504
L_rok_505:
v_mfma_f32_16x16x32_bf16 v[68:71], v[44:47], a[120:123], v[68:71]
ds_read_b128 v[36:39], v16 offset:36864
v_lshlrev_b32 v124, 16, v88
v_and_b32 v125, 0xffff0000, v88
v_mfma_f32_16x16x32_bf16 v[72:75], v[44:47], a[124:127], v[72:75]
v_and_b32 v124, 0xfffe0000, v124
v_add_f32 v96, v116, v124
v_mfma_f32_16x16x32_bf16 v[76:79], v[48:51], a[120:123], v[76:79]
ds_read_b128 v[40:43], v17 offset:36864
v_add_f32 v97, v117, v125
v_lshlrev_b32 v124, 16, v89
v_mfma_f32_16x16x32_bf16 v[80:83], v[48:51], a[124:127], v[80:83]
s_waitcnt lgkmcnt(4)
v_and_b32 v125, 0xffff0000, v89
v_mfma_f32_16x16x32_bf16 v[68:71], v[20:23], a[128:131], v[68:71]
ds_read_b128 v[44:47], v16 offset:38912
s_add_u32 m0, s21, 33792
v_and_b32 v124, 0xfffe0000, v124
v_mfma_f32_16x16x32_bf16 v[72:75], v[20:23], a[132:135], v[72:75]
buffer_load_dwordx4 v9, s[8:11], s20 offen lds
v_add_f32 v98, v118, v124
v_mfma_f32_16x16x32_bf16 v[76:79], v[24:27], a[128:131], v[76:79]
ds_read_b128 v[48:51], v17 offset:38912
v_add_f32 v99, v119, v125
v_lshlrev_b32 v124, 16, v90
v_mfma_f32_16x16x32_bf16 v[80:83], v[24:27], a[132:135], v[80:83]
s_waitcnt lgkmcnt(4)
v_and_b32 v125, 0xffff0000, v90
v_mfma_f32_16x16x32_bf16 v[68:71], v[28:31], a[136:139], v[68:71]
ds_read_b128 v[20:23], v16 offset:40960
v_and_b32 v124, 0xfffe0000, v124
v_add_f32 v100, v120, v124
v_mfma_f32_16x16x32_bf16 v[72:75], v[28:31], a[140:143], v[72:75]
v_add_f32 v101, v121, v125
v_lshlrev_b32 v124, 16, v91
v_mfma_f32_16x16x32_bf16 v[76:79], v[32:35], a[136:139], v[76:79]
ds_read_b128 v[24:27], v17 offset:40960
v_and_b32 v125, 0xffff0000, v91
v_and_b32 v124, 0xfffe0000, v124
v_mfma_f32_16x16x32_bf16 v[80:83], v[32:35], a[140:143], v[80:83]
s_waitcnt lgkmcnt(4)
v_add_f32 v102, v122, v124
v_add_f32 v103, v123, v125
v_mfma_f32_16x16x32_bf16 v[68:71], v[36:39], a[144:147], v[68:71]
ds_read_b128 v[28:31], v16 offset:43008
s_add_u32 m0, s21, 34816
v_mfma_f32_16x16x32_bf16 v[72:75], v[36:39], a[148:151], v[72:75]
buffer_load_dwordx4 v10, s[8:11], s20 offen lds
v_mfma_f32_16x16x32_bf16 v[76:79], v[40:43], a[144:147], v[76:79]
ds_read_b128 v[32:35], v17 offset:43008
v_mfma_f32_16x16x32_bf16 v[80:83], v[40:43], a[148:151], v[80:83]
s_waitcnt lgkmcnt(4)
v_mfma_f32_16x16x32_bf16 v[68:71], v[44:47], a[152:155], v[68:71]
ds_read_b128 v[36:39], v16 offset:45056
s_waitcnt vmcnt(5)
v_lshlrev_b32 v130, 16, v132
v_mfma_f32_16x16x32_bf16 v[72:75], v[44:47], a[156:159], v[72:75]
v_and_b32 v131, 0xffff0000, v132
v_mfma_f32_16x16x32_bf16 v[76:79], v[48:51], a[152:155], v[76:79]
ds_read_b128 v[40:43], v17 offset:45056
v_mul_f32 v130, v130, v128
v_mul_f32 v131, v131, v129
v_mfma_f32_16x16x32_bf16 v[80:83], v[48:51], a[156:159], v[80:83]
s_waitcnt lgkmcnt(4)
v_cvt_pk_bf16_f32 v130, 0, v130
v_mfma_f32_16x16x32_bf16 v[68:71], v[20:23], a[160:163], v[68:71]
ds_read_b128 v[44:47], v16 offset:47104
s_add_u32 m0, s21, 35840
v_mfma_f32_16x16x32_bf16 v[72:75], v[20:23], a[164:167], v[72:75]
buffer_load_dwordx4 v11, s[8:11], s20 offen lds
v_cvt_pk_bf16_f32 v131, 0, v131
v_mfma_f32_16x16x32_bf16 v[76:79], v[24:27], a[160:163], v[76:79]
ds_read_b128 v[48:51], v17 offset:47104
v_add_f32 v96, v96, v130
v_mfma_f32_16x16x32_bf16 v[80:83], v[24:27], a[164:167], v[80:83]
s_waitcnt lgkmcnt(4)
v_add_f32 v97, v97, v131
v_mfma_f32_16x16x32_bf16 v[68:71], v[28:31], a[168:171], v[68:71]
s_waitcnt vmcnt(19)
s_barrier
ds_read_b128 v[20:23], v16 offset:49152
v_mfma_f32_16x16x32_bf16 v[72:75], v[28:31], a[172:175], v[72:75]
s_add_u32 s20, s20, 16384
buffer_store_dwordx2 v[96:97], v140, s[16:19], s43 offen
v_mfma_f32_16x16x32_bf16 v[76:79], v[32:35], a[168:171], v[76:79]
ds_read_b128 v[24:27], v17 offset:49152
v_lshlrev_b32 v130, 16, v133
v_and_b32 v131, 0xffff0000, v133
v_mfma_f32_16x16x32_bf16 v[80:83], v[32:35], a[172:175], v[80:83]
s_waitcnt lgkmcnt(4)
v_mul_f32 v130, v130, v128
v_mfma_f32_16x16x32_bf16 v[68:71], v[36:39], a[176:179], v[68:71]
ds_read_b128 v[28:31], v16 offset:51200
s_add_u32 m0, s21, 49152
v_mul_f32 v131, v131, v129
v_mfma_f32_16x16x32_bf16 v[72:75], v[36:39], a[180:183], v[72:75]
buffer_load_dwordx4 v8, s[8:11], s20 offen lds
v_mfma_f32_16x16x32_bf16 v[76:79], v[40:43], a[176:179], v[76:79]
ds_read_b128 v[32:35], v17 offset:51200
v_cvt_pk_bf16_f32 v130, 0, v130
v_mfma_f32_16x16x32_bf16 v[80:83], v[40:43], a[180:183], v[80:83]
s_waitcnt lgkmcnt(4)
v_cvt_pk_bf16_f32 v131, 0, v131
v_add_f32 v98, v98, v130
v_mfma_f32_16x16x32_bf16 v[68:71], v[44:47], a[184:187], v[68:71]
ds_read_b128 v[36:39], v16 offset:53248
v_add_f32 v99, v99, v131
v_mfma_f32_16x16x32_bf16 v[72:75], v[44:47], a[188:191], v[72:75]
buffer_store_dwordx2 v[98:99], v141, s[16:19], s43 offen
v_lshlrev_b32 v130, 16, v134
v_mfma_f32_16x16x32_bf16 v[76:79], v[48:51], a[184:187], v[76:79]
ds_read_b128 v[40:43], v17 offset:53248
v_and_b32 v131, 0xffff0000, v134
v_mfma_f32_16x16x32_bf16 v[80:83], v[48:51], a[188:191], v[80:83]
s_waitcnt lgkmcnt(4)
v_mul_f32 v130, v130, v128
v_mfma_f32_16x16x32_bf16 v[68:71], v[20:23], a[192:195], v[68:71]
ds_read_b128 v[44:47], v16 offset:55296
s_add_u32 m0, s21, 50176
v_mul_f32 v131, v131, v129
v_mfma_f32_16x16x32_bf16 v[72:75], v[20:23], a[196:199], v[72:75]
buffer_load_dwordx4 v9, s[8:11], s20 offen lds
v_mfma_f32_16x16x32_bf16 v[76:79], v[24:27], a[192:195], v[76:79]
ds_read_b128 v[48:51], v17 offset:55296
v_cvt_pk_bf16_f32 v130, 0, v130
v_cvt_pk_bf16_f32 v131, 0, v131
v_mfma_f32_16x16x32_bf16 v[80:83], v[24:27], a[196:199], v[80:83]
s_waitcnt lgkmcnt(4)
v_add_f32 v100, v100, v130
v_mfma_f32_16x16x32_bf16 v[68:71], v[28:31], a[200:203], v[68:71]
ds_read_b128 v[20:23], v16 offset:57344
v_add_f32 v101, v101, v131
v_mfma_f32_16x16x32_bf16 v[72:75], v[28:31], a[204:207], v[72:75]
buffer_store_dwordx2 v[100:101], v142, s[16:19], s43 offen
v_lshlrev_b32 v130, 16, v135
v_mfma_f32_16x16x32_bf16 v[76:79], v[32:35], a[200:203], v[76:79]
ds_read_b128 v[24:27], v17 offset:57344
s_add_u32 s24, s24, 1
v_and_b32 v131, 0xffff0000, v135
v_mfma_f32_16x16x32_bf16 v[80:83], v[32:35], a[204:207], v[80:83]
s_waitcnt lgkmcnt(4)
s_min_u32 s24, s24, s61
v_mul_f32 v130, v130, v128
v_mfma_f32_16x16x32_bf16 v[68:71], v[36:39], a[208:211], v[68:71]
ds_read_b128 v[28:31], v16 offset:59392
s_add_u32 m0, s21, 51200
s_lshl_b32 s53, s24, 17
v_mul_f32 v131, v131, v129
v_mfma_f32_16x16x32_bf16 v[72:75], v[36:39], a[212:215], v[72:75]
buffer_load_dwordx4 v10, s[8:11], s20 offen lds
v_cvt_pk_bf16_f32 v130, 0, v130
v_mfma_f32_16x16x32_bf16 v[76:79], v[40:43], a[208:211], v[76:79]
ds_read_b128 v[32:35], v17 offset:59392
s_add_u32 s53, s53, s50
v_cvt_pk_bf16_f32 v131, 0, v131
v_mfma_f32_16x16x32_bf16 v[80:83], v[40:43], a[212:215], v[80:83]
s_waitcnt lgkmcnt(4)
s_waitcnt vmcnt(10)
v_add_f32 v102, v102, v130
v_mfma_f32_16x16x32_bf16 v[68:71], v[44:47], a[216:219], v[68:71]
ds_read_b128 v[36:39], v16 offset:61440
v_readfirstlane_b32 s30, v87
v_add_f32 v103, v103, v131
v_mfma_f32_16x16x32_bf16 v[72:75], v[44:47], a[220:223], v[72:75]
s_nop 0
buffer_store_dwordx2 v[102:103], v143, s[16:19], s43 offen
v_mfma_f32_16x16x32_bf16 v[76:79], v[48:51], a[216:219], v[76:79]
ds_read_b128 v[40:43], v17 offset:61440
s_nop 0
v_mfma_f32_16x16x32_bf16 v[80:83], v[48:51], a[220:223], v[80:83]
s_waitcnt lgkmcnt(4)
s_cmp_lt_u32 s30, 16
s_cbranch_scc1 L_gw_507
L_gok_506:
v_mfma_f32_16x16x32_bf16 v[68:71], v[20:23], a[224:227], v[68:71]
ds_read_b128 v[44:47], v16 offset:63488
s_add_u32 m0, s21, 52224
v_mfma_f32_16x16x32_bf16 v[72:75], v[20:23], a[228:231], v[72:75]
buffer_load_dwordx4 v11, s[8:11], s20 offen lds
v_mfma_f32_16x16x32_bf16 v[76:79], v[24:27], a[224:227], v[76:79]
ds_read_b128 v[48:51], v17 offset:63488
v_mov_b32 v116, v52
v_mov_b32 v117, v56
v_mfma_f32_16x16x32_bf16 v[80:83], v[24:27], a[228:231], v[80:83]
s_waitcnt lgkmcnt(4)
v_mov_b32 v118, v53
v_mov_b32 v119, v57
v_mfma_f32_16x16x32_bf16 v[68:71], v[28:31], a[232:235], v[68:71]
s_waitcnt vmcnt(20)
s_barrier
ds_read_b128 v[20:23], v12 offset:0
v_mfma_f32_16x16x32_bf16 v[72:75], v[28:31], a[236:239], v[72:75]
s_mov_b32 s20, s53
v_mov_b32 v120, v54
v_mov_b32 v121, v58
v_mfma_f32_16x16x32_bf16 v[76:79], v[32:35], a[232:235], v[76:79]
ds_read_b128 v[24:27], v13 offset:0
v_mov_b32 v122, v55
v_mfma_f32_16x16x32_bf16 v[80:83], v[32:35], a[236:239], v[80:83]
s_waitcnt lgkmcnt(4)
v_mov_b32 v123, v59
s_mov_b32 s7, s38
v_mfma_f32_16x16x32_bf16 v[68:71], v[36:39], a[240:243], v[68:71]
ds_read_b128 v[28:31], v12 offset:2048
s_add_u32 m0, s21, 65536
s_add_u32 s39, s44, s31
v_mfma_f32_16x16x32_bf16 v[72:75], v[36:39], a[244:247], v[72:75]
buffer_load_dwordx4 v8, s[8:11], s20 offen lds
s_sub_u32 s43, s22, 1
v_mfma_f32_16x16x32_bf16 v[76:79], v[40:43], a[240:243], v[76:79]
ds_read_b128 v[32:35], v13 offset:2048
s_lshl_b32 s42, s43, 16
v_mfma_f32_16x16x32_bf16 v[80:83], v[40:43], a[244:247], v[80:83]
s_waitcnt lgkmcnt(4)
s_lshl_b32 s43, s43, 18
s_cmp_eq_u32 s37, 0
s_cselect_b32 s42, 0x7ff00000, s42
s_cselect_b32 s43, 0x7ff00000, s43
v_mfma_f32_16x16x32_bf16 v[68:71], v[44:47], a[248:251], v[68:71]
ds_read_b128 v[36:39], v12 offset:4096
v_mfma_f32_16x16x32_bf16 v[72:75], v[44:47], a[252:255], v[72:75]
buffer_load_dwordx4 v[88:91], v112, s[12:15], s39 offen offset:0 sc1
v_mfma_f32_16x16x32_bf16 v[76:79], v[48:51], a[248:251], v[76:79]
ds_read_b128 v[40:43], v13 offset:4096
s_mov_b32 s37, 1
v_mfma_f32_16x16x32_bf16 v[80:83], v[48:51], a[252:255], v[80:83]
s_waitcnt lgkmcnt(4)
s_add_u32 s22, s22, 1
s_cmp_ge_u32 s22, s23
s_cbranch_scc0 L_st_499
L_fl1_497:
s_waitcnt lgkmcnt(0)
s_nop 7
s_sub_u32 s38, s22, 1
s_and_b32 s31, s38, 3
s_lshl_b32 s31, s31, 11
s_bfe_u32 s38, s38, 0x10002
s_xor_b32 s38, s38, 1
s_cmp_eq_u32 s37, 0
s_cselect_b32 s31, 0x40000000, s31
s_cselect_b32 s38, 0, s38
v_cvt_pk_bf16_f32 v104, v76, v80
v_cvt_pk_bf16_f32 v105, v77, v81
v_cvt_pk_bf16_f32 v106, v78, v82
v_cvt_pk_bf16_f32 v107, v79, v83
v_and_or_b32 v104, v104, -2, s38
v_and_or_b32 v105, v105, -2, s38
v_and_or_b32 v106, v106, -2, s38
v_and_or_b32 v107, v107, -2, s38
s_add_u32 s29, s45, s31
buffer_store_dwordx4 v[104:107], v112, s[12:15], s29 offen offset:0 sc1
buffer_load_dword v132, v136, s[32:35], s42 offen offset:0
buffer_load_dword v133, v136, s[32:35], s42 offen offset:2048
buffer_load_dword v134, v137, s[32:35], s42 offen offset:0
buffer_load_dword v135, v137, s[32:35], s42 offen offset:2048
s_waitcnt vmcnt(0)
v_xor_b32 v124, s7, v88
v_bitop3_b32 v124, v124, v89, s7 bitop3:0xf6
v_bitop3_b32 v124, v124, v90, s7 bitop3:0xf6
v_bitop3_b32 v124, v124, v91, s7 bitop3:0xf6
v_and_b32 v124, 1, v124
v_cmp_ne_u32 vcc, 0, v124
s_nop 0
s_nop 0
s_nop 0
s_cbranch_vccnz L_rbad_508
L_rok_509:
v_lshlrev_b32 v124, 16, v88
v_and_b32 v125, 0xffff0000, v88
v_and_b32 v124, 0xfffe0000, v124
v_add_f32 v96, v116, v124
v_add_f32 v97, v117, v125
v_lshlrev_b32 v124, 16, v89
v_and_b32 v125, 0xffff0000, v89
v_and_b32 v124, 0xfffe0000, v124
v_add_f32 v98, v118, v124
v_add_f32 v99, v119, v125
v_lshlrev_b32 v124, 16, v90
v_and_b32 v125, 0xffff0000, v90
v_and_b32 v124, 0xfffe0000, v124
v_add_f32 v100, v120, v124
v_add_f32 v101, v121, v125
v_lshlrev_b32 v124, 16, v91
v_and_b32 v125, 0xffff0000, v91
v_and_b32 v124, 0xfffe0000, v124
v_add_f32 v102, v122, v124
v_add_f32 v103, v123, v125
s_waitcnt vmcnt(0)
v_lshlrev_b32 v130, 16, v132
v_and_b32 v131, 0xffff0000, v132
v_mul_f32 v130, v130, v128
v_mul_f32 v131, v131, v129
v_cvt_pk_bf16_f32 v130, 0, v130
v_cvt_pk_bf16_f32 v131, 0, v131
v_add_f32 v96, v96, v130
v_add_f32 v97, v97, v131
buffer_store_dwordx2 v[96:97], v140, s[16:19], s43 offen
v_lshlrev_b32 v130, 16, v133
v_and_b32 v131, 0xffff0000, v133
v_mul_f32 v130, v130, v128
v_mul_f32 v131, v131, v129
v_cvt_pk_bf16_f32 v130, 0, v130
v_cvt_pk_bf16_f32 v131, 0, v131
v_add_f32 v98, v98, v130
v_add_f32 v99, v99, v131
buffer_store_dwordx2 v[98:99], v141, s[16:19], s43 offen
v_lshlrev_b32 v130, 16, v134
v_and_b32 v131, 0xffff0000, v134
v_mul_f32 v130, v130, v128
v_mul_f32 v131, v131, v129
v_cvt_pk_bf16_f32 v130, 0, v130
v_cvt_pk_bf16_f32 v131, 0, v131
v_add_f32 v100, v100, v130
v_add_f32 v101, v101, v131
buffer_store_dwordx2 v[100:101], v142, s[16:19], s43 offen
v_lshlrev_b32 v130, 16, v135
v_and_b32 v131, 0xffff0000, v135
v_mul_f32 v130, v130, v128
v_mul_f32 v131, v131, v129
v_cvt_pk_bf16_f32 v130, 0, v130
v_cvt_pk_bf16_f32 v131, 0, v131
v_add_f32 v102, v102, v130
v_add_f32 v103, v103, v131
buffer_store_dwordx2 v[102:103], v143, s[16:19], s43 offen
v_mov_b32 v116, v68
v_mov_b32 v117, v72
v_mov_b32 v118, v69
v_mov_b32 v119, v73
v_mov_b32 v120, v70
v_mov_b32 v121, v74
v_mov_b32 v122, v71
v_mov_b32 v123, v75
s_mov_b32 s7, s38
s_add_u32 s39, s44, s31
s_sub_u32 s43, s22, 1
s_lshl_b32 s42, s43, 16
s_lshl_b32 s43, s43, 18
s_cmp_eq_u32 s37, 0
s_cselect_b32 s42, 0x7ff00000, s42
s_cselect_b32 s43, 0x7ff00000, s43
buffer_load_dwordx4 v[88:91], v112, s[12:15], s39 offen offset:0 sc1
s_mov_b32 s37, 1
buffer_load_dword v132, v136, s[32:35], s42 offen offset:0
buffer_load_dword v133, v136, s[32:35], s42 offen offset:2048
buffer_load_dword v134, v137, s[32:35], s42 offen offset:0
buffer_load_dword v135, v137, s[32:35], s42 offen offset:2048
s_waitcnt vmcnt(0)
v_xor_b32 v124, s7, v88
v_bitop3_b32 v124, v124, v89, s7 bitop3:0xf6
v_bitop3_b32 v124, v124, v90, s7 bitop3:0xf6
v_bitop3_b32 v124, v124, v91, s7 bitop3:0xf6
v_and_b32 v124, 1, v124
v_cmp_ne_u32 vcc, 0, v124
s_nop 0
s_nop 0
s_nop 0
s_cbranch_vccnz L_rbad_510
L_rok_511:
v_lshlrev_b32 v124, 16, v88
v_and_b32 v125, 0xffff0000, v88
v_and_b32 v124, 0xfffe0000, v124
v_add_f32 v96, v116, v124
v_add_f32 v97, v117, v125
v_lshlrev_b32 v124, 16, v89
v_and_b32 v125, 0xffff0000, v89
v_and_b32 v124, 0xfffe0000, v124
v_add_f32 v98, v118, v124
v_add_f32 v99, v119, v125
v_lshlrev_b32 v124, 16, v90
v_and_b32 v125, 0xffff0000, v90
v_and_b32 v124, 0xfffe0000, v124
v_add_f32 v100, v120, v124
v_add_f32 v101, v121, v125
v_lshlrev_b32 v124, 16, v91
v_and_b32 v125, 0xffff0000, v91
v_and_b32 v124, 0xfffe0000, v124
v_add_f32 v102, v122, v124
v_add_f32 v103, v123, v125
s_waitcnt vmcnt(0)
v_lshlrev_b32 v130, 16, v132
v_and_b32 v131, 0xffff0000, v132
v_mul_f32 v130, v130, v128
v_mul_f32 v131, v131, v129
v_cvt_pk_bf16_f32 v130, 0, v130
v_cvt_pk_bf16_f32 v131, 0, v131
v_add_f32 v96, v96, v130
v_add_f32 v97, v97, v131
buffer_store_dwordx2 v[96:97], v140, s[16:19], s43 offen
v_lshlrev_b32 v130, 16, v133
v_and_b32 v131, 0xffff0000, v133
v_mul_f32 v130, v130, v128
v_mul_f32 v131, v131, v129
v_cvt_pk_bf16_f32 v130, 0, v130
v_cvt_pk_bf16_f32 v131, 0, v131
v_add_f32 v98, v98, v130
v_add_f32 v99, v99, v131
buffer_store_dwordx2 v[98:99], v141, s[16:19], s43 offen
v_lshlrev_b32 v130, 16, v134
v_and_b32 v131, 0xffff0000, v134
v_mul_f32 v130, v130, v128
v_mul_f32 v131, v131, v129
v_cvt_pk_bf16_f32 v130, 0, v130
v_cvt_pk_bf16_f32 v131, 0, v131
v_add_f32 v100, v100, v130
v_add_f32 v101, v101, v131
buffer_store_dwordx2 v[100:101], v142, s[16:19], s43 offen
v_lshlrev_b32 v130, 16, v135
v_and_b32 v131, 0xffff0000, v135
v_mul_f32 v130, v130, v128
v_mul_f32 v131, v131, v129
v_cvt_pk_bf16_f32 v130, 0, v130
v_cvt_pk_bf16_f32 v131, 0, v131
v_add_f32 v102, v102, v130
v_add_f32 v103, v103, v131
buffer_store_dwordx2 v[102:103], v143, s[16:19], s43 offen
s_branch L_ste_498
L_rbad_500:
buffer_load_dwordx4 v[88:91], v112, s[12:15], s39 offen offset:0 sc1
s_add_u32 s36, s36, 1
s_cmp_gt_u32 s36, 0x100000
s_cbranch_scc1 chain_kernel_wend
s_waitcnt vmcnt(0)
v_xor_b32 v124, s7, v88
v_bitop3_b32 v124, v124, v89, s7 bitop3:0xf6
v_bitop3_b32 v124, v124, v90, s7 bitop3:0xf6
v_bitop3_b32 v124, v124, v91, s7 bitop3:0xf6
v_and_b32 v124, 1, v124
v_cmp_ne_u32 vcc, 0, v124
s_cbranch_vccnz L_rbad_500
s_branch L_rok_501
L_gw_503:
buffer_load_dword v87, v4, s[12:15], s51 offen sc1
s_add_u32 s36, s36, 1
s_cmp_gt_u32 s36, 0x100000
s_cbranch_scc1 chain_kernel_wend
s_waitcnt vmcnt(0)
v_readfirstlane_b32 s30, v87
s_cmp_lt_u32 s30, 16
s_cbranch_scc0 L_gok_502
s_sleep 1
s_branch L_gw_503
L_rbad_504:
buffer_load_dwordx4 v[88:91], v112, s[12:15], s39 offen offset:0 sc1
s_add_u32 s36, s36, 1
s_cmp_gt_u32 s36, 0x100000
s_cbranch_scc1 chain_kernel_wend
s_waitcnt vmcnt(0)
v_xor_b32 v124, s7, v88
v_bitop3_b32 v124, v124, v89, s7 bitop3:0xf6
v_bitop3_b32 v124, v124, v90, s7 bitop3:0xf6
v_bitop3_b32 v124, v124, v91, s7 bitop3:0xf6
v_and_b32 v124, 1, v124
v_cmp_ne_u32 vcc, 0, v124
s_cbranch_vccnz L_rbad_504
s_branch L_rok_505
L_gw_507:
buffer_load_dword v87, v4, s[12:15], s51 offen sc1
s_add_u32 s36, s36, 1
s_cmp_gt_u32 s36, 0x100000
s_cbranch_scc1 chain_kernel_wend
s_waitcnt vmcnt(0)
v_readfirstlane_b32 s30, v87
s_cmp_lt_u32 s30, 16
s_cbranch_scc0 L_gok_506
s_sleep 1
s_branch L_gw_507
L_rbad_508:
buffer_load_dwordx4 v[88:91], v112, s[12:15], s39 offen offset:0 sc1
s_add_u32 s36, s36, 1
s_cmp_gt_u32 s36, 0x100000
s_cbranch_scc1 chain_kernel_wend
s_waitcnt vmcnt(0)
v_xor_b32 v124, s7, v88
v_bitop3_b32 v124, v124, v89, s7 bitop3:0xf6
v_bitop3_b32 v124, v124, v90, s7 bitop3:0xf6
v_bitop3_b32 v124, v124, v91, s7 bitop3:0xf6
v_and_b32 v124, 1, v124
v_cmp_ne_u32 vcc, 0, v124
s_cbranch_vccnz L_rbad_508
s_branch L_rok_509
L_rbad_510:
buffer_load_dwordx4 v[88:91], v112, s[12:15], s39 offen offset:0 sc1
s_add_u32 s36, s36, 1
s_cmp_gt_u32 s36, 0x100000
s_cbranch_scc1 chain_kernel_wend
s_waitcnt vmcnt(0)
v_xor_b32 v124, s7, v88
v_bitop3_b32 v124, v124, v89, s7 bitop3:0xf6
v_bitop3_b32 v124, v124, v90, s7 bitop3:0xf6
v_bitop3_b32 v124, v124, v91, s7 bitop3:0xf6
v_and_b32 v124, 1, v124
v_cmp_ne_u32 vcc, 0, v124
s_cbranch_vccnz L_rbad_510
s_branch L_rok_511
L_fl0_496:
s_waitcnt lgkmcnt(0)
s_nop 7
s_sub_u32 s38, s22, 1
s_and_b32 s31, s38, 3
s_lshl_b32 s31, s31, 11
s_bfe_u32 s38, s38, 0x10002
s_xor_b32 s38, s38, 1
s_cmp_eq_u32 s37, 0
s_cselect_b32 s31, 0x40000000, s31
s_cselect_b32 s38, 0, s38
v_cvt_pk_bf16_f32 v104, v60, v64
v_cvt_pk_bf16_f32 v105, v61, v65
v_cvt_pk_bf16_f32 v106, v62, v66
v_cvt_pk_bf16_f32 v107, v63, v67
v_and_or_b32 v104, v104, -2, s38
v_and_or_b32 v105, v105, -2, s38
v_and_or_b32 v106, v106, -2, s38
v_and_or_b32 v107, v107, -2, s38
s_add_u32 s29, s45, s31
buffer_store_dwordx4 v[104:107], v112, s[12:15], s29 offen offset:0 sc1
buffer_load_dword v132, v136, s[32:35], s42 offen offset:0
buffer_load_dword v133, v136, s[32:35], s42 offen offset:2048
buffer_load_dword v134, v137, s[32:35], s42 offen offset:0
buffer_load_dword v135, v137, s[32:35], s42 offen offset:2048
s_waitcnt vmcnt(0)
v_xor_b32 v124, s7, v88
v_bitop3_b32 v124, v124, v89, s7 bitop3:0xf6
v_bitop3_b32 v124, v124, v90, s7 bitop3:0xf6
v_bitop3_b32 v124, v124, v91, s7 bitop3:0xf6
v_and_b32 v124, 1, v124
v_cmp_ne_u32 vcc, 0, v124
s_nop 0
s_nop 0
s_nop 0
s_cbranch_vccnz L_rbad_512
L_rok_513:
v_lshlrev_b32 v124, 16, v88
v_and_b32 v125, 0xffff0000, v88
v_and_b32 v124, 0xfffe0000, v124
v_add_f32 v96, v116, v124
v_add_f32 v97, v117, v125
v_lshlrev_b32 v124, 16, v89
v_and_b32 v125, 0xffff0000, v89
v_and_b32 v124, 0xfffe0000, v124
v_add_f32 v98, v118, v124
v_add_f32 v99, v119, v125
v_lshlrev_b32 v124, 16, v90
v_and_b32 v125, 0xffff0000, v90
v_and_b32 v124, 0xfffe0000, v124
v_add_f32 v100, v120, v124
v_add_f32 v101, v121, v125
v_lshlrev_b32 v124, 16, v91
v_and_b32 v125, 0xffff0000, v91
v_and_b32 v124, 0xfffe0000, v124
v_add_f32 v102, v122, v124
v_add_f32 v103, v123, v125
s_waitcnt vmcnt(0)
v_lshlrev_b32 v130, 16, v132
v_and_b32 v131, 0xffff0000, v132
v_mul_f32 v130, v130, v128
v_mul_f32 v131, v131, v129
v_cvt_pk_bf16_f32 v130, 0, v130
v_cvt_pk_bf16_f32 v131, 0, v131
v_add_f32 v96, v96, v130
v_add_f32 v97, v97, v131
buffer_store_dwordx2 v[96:97], v140, s[16:19], s43 offen
v_lshlrev_b32 v130, 16, v133
v_and_b32 v131, 0xffff0000, v133
v_mul_f32 v130, v130, v128
v_mul_f32 v131, v131, v129
v_cvt_pk_bf16_f32 v130, 0, v130
v_cvt_pk_bf16_f32 v131, 0, v131
v_add_f32 v98, v98, v130
v_add_f32 v99, v99, v131
buffer_store_dwordx2 v[98:99], v141, s[16:19], s43 offen
v_lshlrev_b32 v130, 16, v134
v_and_b32 v131, 0xffff0000, v134
v_mul_f32 v130, v130, v128
v_mul_f32 v131, v131, v129
v_cvt_pk_bf16_f32 v130, 0, v130
v_cvt_pk_bf16_f32 v131, 0, v131
v_add_f32 v100, v100, v130
v_add_f32 v101, v101, v131
buffer_store_dwordx2 v[100:101], v142, s[16:19], s43 offen
v_lshlrev_b32 v130, 16, v135
v_and_b32 v131, 0xffff0000, v135
v_mul_f32 v130, v130, v128
v_mul_f32 v131, v131, v129
v_cvt_pk_bf16_f32 v130, 0, v130
v_cvt_pk_bf16_f32 v131, 0, v131
v_add_f32 v102, v102, v130
v_add_f32 v103, v103, v131
buffer_store_dwordx2 v[102:103], v143, s[16:19], s43 offen
v_mov_b32 v116, v52
v_mov_b32 v117, v56
v_mov_b32 v118, v53
v_mov_b32 v119, v57
v_mov_b32 v120, v54
v_mov_b32 v121, v58
v_mov_b32 v122, v55
v_mov_b32 v123, v59
s_mov_b32 s7, s38
s_add_u32 s39, s44, s31
s_sub_u32 s43, s22, 1
s_lshl_b32 s42, s43, 16
s_lshl_b32 s43, s43, 18
s_cmp_eq_u32 s37, 0
s_cselect_b32 s42, 0x7ff00000, s42
s_cselect_b32 s43, 0x7ff00000, s43
buffer_load_dwordx4 v[88:91], v112, s[12:15], s39 offen offset:0 sc1
s_mov_b32 s37, 1
buffer_load_dword v132, v136, s[32:35], s42 offen offset:0
buffer_load_dword v133, v136, s[32:35], s42 offen offset:2048
buffer_load_dword v134, v137, s[32:35], s42 offen offset:0
buffer_load_dword v135, v137, s[32:35], s42 offen offset:2048
s_waitcnt vmcnt(0)
v_xor_b32 v124, s7, v88
v_bitop3_b32 v124, v124, v89, s7 bitop3:0xf6
v_bitop3_b32 v124, v124, v90, s7 bitop3:0xf6
v_bitop3_b32 v124, v124, v91, s7 bitop3:0xf6
v_and_b32 v124, 1, v124
v_cmp_ne_u32 vcc, 0, v124
s_nop 0
s_nop 0
s_nop 0
s_cbranch_vccnz L_rbad_514
L_rok_515:
v_lshlrev_b32 v124, 16, v88
v_and_b32 v125, 0xffff0000, v88
v_and_b32 v124, 0xfffe0000, v124
v_add_f32 v96, v116, v124
v_add_f32 v97, v117, v125
v_lshlrev_b32 v124, 16, v89
v_and_b32 v125, 0xffff0000, v89
v_and_b32 v124, 0xfffe0000, v124
v_add_f32 v98, v118, v124
v_add_f32 v99, v119, v125
v_lshlrev_b32 v124, 16, v90
v_and_b32 v125, 0xffff0000, v90
v_and_b32 v124, 0xfffe0000, v124
v_add_f32 v100, v120, v124
v_add_f32 v101, v121, v125
v_lshlrev_b32 v124, 16, v91
v_and_b32 v125, 0xffff0000, v91
v_and_b32 v124, 0xfffe0000, v124
v_add_f32 v102, v122, v124
v_add_f32 v103, v123, v125
s_waitcnt vmcnt(0)
v_lshlrev_b32 v130, 16, v132
v_and_b32 v131, 0xffff0000, v132
v_mul_f32 v130, v130, v128
v_mul_f32 v131, v131, v129
v_cvt_pk_bf16_f32 v130, 0, v130
v_cvt_pk_bf16_f32 v131, 0, v131
v_add_f32 v96, v96, v130
v_add_f32 v97, v97, v131
buffer_store_dwordx2 v[96:97], v140, s[16:19], s43 offen
v_lshlrev_b32 v130, 16, v133
v_and_b32 v131, 0xffff0000, v133
v_mul_f32 v130, v130, v128
v_mul_f32 v131, v131, v129
v_cvt_pk_bf16_f32 v130, 0, v130
v_cvt_pk_bf16_f32 v131, 0, v131
v_add_f32 v98, v98, v130
v_add_f32 v99, v99, v131
buffer_store_dwordx2 v[98:99], v141, s[16:19], s43 offen
v_lshlrev_b32 v130, 16, v134
v_and_b32 v131, 0xffff0000, v134
v_mul_f32 v130, v130, v128
v_mul_f32 v131, v131, v129
v_cvt_pk_bf16_f32 v130, 0, v130
v_cvt_pk_bf16_f32 v131, 0, v131
v_add_f32 v100, v100, v130
v_add_f32 v101, v101, v131
buffer_store_dwordx2 v[100:101], v142, s[16:19], s43 offen
v_lshlrev_b32 v130, 16, v135
v_and_b32 v131, 0xffff0000, v135
v_mul_f32 v130, v130, v128
v_mul_f32 v131, v131, v129
v_cvt_pk_bf16_f32 v130, 0, v130
v_cvt_pk_bf16_f32 v131, 0, v131
v_add_f32 v102, v102, v130
v_add_f32 v103, v103, v131
buffer_store_dwordx2 v[102:103], v143, s[16:19], s43 offen
s_branch L_ste_498
L_rbad_512:
buffer_load_dwordx4 v[88:91], v112, s[12:15], s39 offen offset:0 sc1
s_add_u32 s36, s36, 1
s_cmp_gt_u32 s36, 0x100000
s_cbranch_scc1 chain_kernel_wend
s_waitcnt vmcnt(0)
v_xor_b32 v124, s7, v88
v_bitop3_b32 v124, v124, v89, s7 bitop3:0xf6
v_bitop3_b32 v124, v124, v90, s7 bitop3:0xf6
v_bitop3_b32 v124, v124, v91, s7 bitop3:0xf6
v_and_b32 v124, 1, v124
v_cmp_ne_u32 vcc, 0, v124
s_cbranch_vccnz L_rbad_512
s_branch L_rok_513
L_rbad_514:
buffer_load_dwordx4 v[88:91], v112, s[12:15], s39 offen offset:0 sc1
s_add_u32 s36, s36, 1
s_cmp_gt_u32 s36, 0x100000
s_cbranch_scc1 chain_kernel_wend
s_waitcnt vmcnt(0)
v_xor_b32 v124, s7, v88
v_bitop3_b32 v124, v124, v89, s7 bitop3:0xf6
v_bitop3_b32 v124, v124, v90, s7 bitop3:0xf6
v_bitop3_b32 v124, v124, v91, s7 bitop3:0xf6
v_and_b32 v124, 1, v124
v_cmp_ne_u32 vcc, 0, v124
s_cbranch_vccnz L_rbad_514
s_branch L_rok_515
L_ste_498:
L_op_443:
s_mov_b32 s38, s41
s_and_b32 s39, s38, 3
s_lshr_b32 s42, s41, 2
s_or_b32 s25, s42, 4
s_cmp_eq_u32 s40, 0
s_cselect_b32 s42, s25, s42
s_and_b32 s25, s42, 3
s_cmp_eq_u32 s40, 1
s_cselect_b32 s42, s25, s42
s_lshl_b32 s44, s40, 5
s_add_u32 s44, s44, s38
s_lshl_b32 s44, s44, 15
s_lshl_b32 s25, s49, 13
s_add_u32 s44, s44, s25
s_xor_b32 s45, s44, 0x8000
s_add_u32 s45, s45, 0x6900000
s_xor_b32 s46, s44, 0x10000
s_add_u32 s46, s46, 0x6900000
s_xor_b32 s47, s44, 0x18000
s_add_u32 s47, s47, 0x6900000
s_add_u32 s44, s44, 0x6900000
s_lshl_b32 s48, s40, 3
s_lshr_b32 s25, s38, 2
s_add_u32 s48, s48, s25
s_lshl_b32 s94, s48, 8
s_add_u32 s94, s94, 0x590d800
s_lshl_b32 s95, s42, 7
s_add_u32 s95, s95, 0x590d400
s_cmp_eq_u32 s39, 0
s_cselect_b32 s95, s95, 0x40000000
s_cselect_b32 s60, s94, 0x40000000
s_lshl_b32 s48, s48, 7
s_add_u32 s48, s48, 0x590c000
s_mov_b32 s16, s92
s_and_b32 s17, s93, 0xffff
s_mov_b32 s18, 0x800000
s_mov_b32 s19, 0x00020000
s_lshl_b32 s50, s39, 21
s_lshl_b32 s25, s42, 8
s_add_u32 s50, s50, s25
v_mov_b32 v104, 0
v_mov_b32 v105, 0
v_mov_b32 v106, 0
v_mov_b32 v107, 0
v_and_b32 v2, 63, v0
v_lshlrev_b32 v3, 4, v2
v_lshlrev_b32 v112, 3, v2
s_add_u32 s28, s44, 0
buffer_store_dwordx4 v[104:107], v3, s[12:15], s28 offen sc1
s_add_u32 s28, s44, 1024
buffer_store_dwordx4 v[104:107], v3, s[12:15], s28 offen sc1
s_add_u32 s28, s44, 2048
buffer_store_dwordx4 v[104:107], v3, s[12:15], s28 offen sc1
s_add_u32 s28, s44, 3072
buffer_store_dwordx4 v[104:107], v3, s[12:15], s28 offen sc1
s_add_u32 s28, s44, 4096
buffer_store_dwordx4 v[104:107], v3, s[12:15], s28 offen sc1
s_add_u32 s28, s44, 5120
buffer_store_dwordx4 v[104:107], v3, s[12:15], s28 offen sc1
s_add_u32 s28, s44, 6144
buffer_store_dwordx4 v[104:107], v3, s[12:15], s28 offen sc1
s_add_u32 s28, s44, 7168
buffer_store_dwordx4 v[104:107], v3, s[12:15], s28 offen sc1
v_lshrrev_b32 v1, 6, v0
v_lshlrev_b32 v1, 11, v1
v_add_u32 v1, 0x21000, v1
v_add_u32 v113, v1, v3
v_and_b32 v2, 15, v0
v_lshl_add_u32 v1, v2, 2, v1
v_bfe_u32 v2, v0, 4, 2
v_lshl_add_u32 v114, v2, 7, v1
v_and_b32 v1, 15, v0
v_bfe_u32 v2, v0, 4, 2
v_lshrrev_b32 v3, 6, v0
v_lshlrev_b32 v4, 2, v2
v_xor_b32 v4, v4, v1
v_lshlrev_b32 v4, 4, v4
v_lshl_add_u32 v5, v3, 5, v2
s_mov_b32 s25, 2048
v_mul_lo_u32 v5, v5, s25
v_add_u32 v20, v5, v4
v_bfe_u32 v4, v0, 2, 2
v_lshl_add_u32 v5, v2, 3, v4
v_lshlrev_b32 v5, 8, v5
v_xor_b32 v4, v4, v3
v_lshl_add_u32 v5, v4, 6, v5
v_and_b32 v4, 3, v0
v_lshl_add_u32 v5, v4, 3, v5
v_mov_b32 v21, v5
v_add_u32 v22, 32, v21
v_add_u32 v23, 0x10000, v21
v_add_u32 v24, 0x10000, v22
s_lshl_b32 s26, s49, 13
s_mov_b32 s25, s50
s_barrier
s_add_u32 m0, s26, 0
s_add_u32 s27, s25, 0
buffer_load_dwordx4 v20, s[16:19], s27 offen lds
s_add_u32 m0, s26, 1024
s_add_u32 s27, s25, 8192
buffer_load_dwordx4 v20, s[16:19], s27 offen lds
s_add_u32 m0, s26, 2048
s_add_u32 s27, s25, 16384
buffer_load_dwordx4 v20, s[16:19], s27 offen lds
s_add_u32 m0, s26, 3072
s_add_u32 s27, s25, 24576
buffer_load_dwordx4 v20, s[16:19], s27 offen lds
s_add_u32 m0, s26, 4096
s_add_u32 s27, s25, 32768
buffer_load_dwordx4 v20, s[16:19], s27 offen lds
s_add_u32 m0, s26, 5120
s_add_u32 s27, s25, 40960
buffer_load_dwordx4 v20, s[16:19], s27 offen lds
s_add_u32 m0, s26, 6144
s_add_u32 s27, s25, 49152
buffer_load_dwordx4 v20, s[16:19], s27 offen lds
s_add_u32 m0, s26, 7168
s_add_u32 s27, s25, 57344
buffer_load_dwordx4 v20, s[16:19], s27 offen lds
s_add_u32 m0, s26, 32768
s_add_u32 s27, s25, 262144
buffer_load_dwordx4 v20, s[16:19], s27 offen lds
s_add_u32 m0, s26, 33792
s_add_u32 s27, s25, 270336
buffer_load_dwordx4 v20, s[16:19], s27 offen lds
s_add_u32 m0, s26, 34816
s_add_u32 s27, s25, 278528
buffer_load_dwordx4 v20, s[16:19], s27 offen lds
s_add_u32 m0, s26, 35840
s_add_u32 s27, s25, 286720
buffer_load_dwordx4 v20, s[16:19], s27 offen lds
s_add_u32 m0, s26, 36864
s_add_u32 s27, s25, 294912
buffer_load_dwordx4 v20, s[16:19], s27 offen lds
s_add_u32 m0, s26, 37888
s_add_u32 s27, s25, 303104
buffer_load_dwordx4 v20, s[16:19], s27 offen lds
s_add_u32 m0, s26, 38912
s_add_u32 s27, s25, 311296
buffer_load_dwordx4 v20, s[16:19], s27 offen lds
s_add_u32 m0, s26, 39936
s_add_u32 s27, s25, 319488
buffer_load_dwordx4 v20, s[16:19], s27 offen lds
s_add_u32 m0, s26, 65536
s_add_u32 s27, s25, 524288
buffer_load_dwordx4 v20, s[16:19], s27 offen lds
s_add_u32 m0, s26, 66560
s_add_u32 s27, s25, 532480
buffer_load_dwordx4 v20, s[16:19], s27 offen lds
s_add_u32 m0, s26, 67584
s_add_u32 s27, s25, 540672
buffer_load_dwordx4 v20, s[16:19], s27 offen lds
s_add_u32 m0, s26, 68608
s_add_u32 s27, s25, 548864
buffer_load_dwordx4 v20, s[16:19], s27 offen lds
s_add_u32 m0, s26, 69632
s_add_u32 s27, s25, 557056
buffer_load_dwordx4 v20, s[16:19], s27 offen lds
s_add_u32 m0, s26, 70656
s_add_u32 s27, s25, 565248
buffer_load_dwordx4 v20, s[16:19], s27 offen lds
s_add_u32 m0, s26, 71680
s_add_u32 s27, s25, 573440
buffer_load_dwordx4 v20, s[16:19], s27 offen lds
s_add_u32 m0, s26, 72704
s_add_u32 s27, s25, 581632
buffer_load_dwordx4 v20, s[16:19], s27 offen lds
s_add_u32 m0, s26, 98304
s_add_u32 s27, s25, 786432
buffer_load_dwordx4 v20, s[16:19], s27 offen lds
s_add_u32 m0, s26, 99328
s_add_u32 s27, s25, 794624
buffer_load_dwordx4 v20, s[16:19], s27 offen lds
s_add_u32 m0, s26, 100352
s_add_u32 s27, s25, 802816
buffer_load_dwordx4 v20, s[16:19], s27 offen lds
s_add_u32 m0, s26, 101376
s_add_u32 s27, s25, 811008
buffer_load_dwordx4 v20, s[16:19], s27 offen lds
s_add_u32 m0, s26, 102400
s_add_u32 s27, s25, 819200
buffer_load_dwordx4 v20, s[16:19], s27 offen lds
s_add_u32 m0, s26, 103424
s_add_u32 s27, s25, 827392
buffer_load_dwordx4 v20, s[16:19], s27 offen lds
s_add_u32 m0, s26, 104448
s_add_u32 s27, s25, 835584
buffer_load_dwordx4 v20, s[16:19], s27 offen lds
s_add_u32 m0, s26, 105472
s_add_u32 s27, s25, 843776
buffer_load_dwordx4 v20, s[16:19], s27 offen lds
s_waitcnt vmcnt(24)
s_barrier
buffer_atomic_add v84, v85, s[12:15], s48 offen sc1
ds_read_b64_tr_b16 a[0:1], v21 offset:0
ds_read_b64_tr_b16 a[2:3], v21 offset:1024
ds_read_b64_tr_b16 a[4:5], v22 offset:0
ds_read_b64_tr_b16 a[6:7], v22 offset:1024
ds_read_b64_tr_b16 a[8:9], v21 offset:8192
ds_read_b64_tr_b16 a[10:11], v21 offset:9216
ds_read_b64_tr_b16 a[12:13], v22 offset:8192
ds_read_b64_tr_b16 a[14:15], v22 offset:9216
s_waitcnt lgkmcnt(0)
ds_read_b64_tr_b16 a[16:17], v21 offset:16384
ds_read_b64_tr_b16 a[18:19], v21 offset:17408
ds_read_b64_tr_b16 a[20:21], v22 offset:16384
ds_read_b64_tr_b16 a[22:23], v22 offset:17408
ds_read_b64_tr_b16 a[24:25], v21 offset:24576
ds_read_b64_tr_b16 a[26:27], v21 offset:25600
ds_read_b64_tr_b16 a[28:29], v22 offset:24576
ds_read_b64_tr_b16 a[30:31], v22 offset:25600
s_waitcnt lgkmcnt(0)
s_barrier
s_add_u32 m0, s26, 0
s_add_u32 s27, s25, 1048576
buffer_load_dwordx4 v20, s[16:19], s27 offen lds
s_add_u32 m0, s26, 1024
s_add_u32 s27, s25, 1056768
buffer_load_dwordx4 v20, s[16:19], s27 offen lds
s_add_u32 m0, s26, 2048
s_add_u32 s27, s25, 1064960
buffer_load_dwordx4 v20, s[16:19], s27 offen lds
s_add_u32 m0, s26, 3072
s_add_u32 s27, s25, 1073152
buffer_load_dwordx4 v20, s[16:19], s27 offen lds
s_add_u32 m0, s26, 4096
s_add_u32 s27, s25, 1081344
buffer_load_dwordx4 v20, s[16:19], s27 offen lds
s_add_u32 m0, s26, 5120
s_add_u32 s27, s25, 1089536
buffer_load_dwordx4 v20, s[16:19], s27 offen lds
s_add_u32 m0, s26, 6144
s_add_u32 s27, s25, 1097728
buffer_load_dwordx4 v20, s[16:19], s27 offen lds
s_add_u32 m0, s26, 7168
s_add_u32 s27, s25, 1105920
buffer_load_dwordx4 v20, s[16:19], s27 offen lds
s_waitcnt vmcnt(24)
s_barrier
ds_read_b64_tr_b16 a[32:33], v21 offset:32768
ds_read_b64_tr_b16 a[34:35], v21 offset:33792
ds_read_b64_tr_b16 a[36:37], v22 offset:32768
ds_read_b64_tr_b16 a[38:39], v22 offset:33792
ds_read_b64_tr_b16 a[40:41], v21 offset:40960
ds_read_b64_tr_b16 a[42:43], v21 offset:41984
ds_read_b64_tr_b16 a[44:45], v22 offset:40960
ds_read_b64_tr_b16 a[46:47], v22 offset:41984
s_waitcnt lgkmcnt(0)
ds_read_b64_tr_b16 a[48:49], v21 offset:49152
ds_read_b64_tr_b16 a[50:51], v21 offset:50176
ds_read_b64_tr_b16 a[52:53], v22 offset:49152
ds_read_b64_tr_b16 a[54:55], v22 offset:50176
ds_read_b64_tr_b16 a[56:57], v21 offset:57344
ds_read_b64_tr_b16 a[58:59], v21 offset:58368
ds_read_b64_tr_b16 a[60:61], v22 offset:57344
ds_read_b64_tr_b16 a[62:63], v22 offset:58368
s_waitcnt lgkmcnt(0)
s_barrier
s_add_u32 m0, s26, 32768
s_add_u32 s27, s25, 1310720
buffer_load_dwordx4 v20, s[16:19], s27 offen lds
s_add_u32 m0, s26, 33792
s_add_u32 s27, s25, 1318912
buffer_load_dwordx4 v20, s[16:19], s27 offen lds
s_add_u32 m0, s26, 34816
s_add_u32 s27, s25, 1327104
buffer_load_dwordx4 v20, s[16:19], s27 offen lds
s_add_u32 m0, s26, 35840
s_add_u32 s27, s25, 1335296
buffer_load_dwordx4 v20, s[16:19], s27 offen lds
s_add_u32 m0, s26, 36864
s_add_u32 s27, s25, 1343488
buffer_load_dwordx4 v20, s[16:19], s27 offen lds
s_add_u32 m0, s26, 37888
s_add_u32 s27, s25, 1351680
buffer_load_dwordx4 v20, s[16:19], s27 offen lds
s_add_u32 m0, s26, 38912
s_add_u32 s27, s25, 1359872
buffer_load_dwordx4 v20, s[16:19], s27 offen lds
s_add_u32 m0, s26, 39936
s_add_u32 s27, s25, 1368064
buffer_load_dwordx4 v20, s[16:19], s27 offen lds
s_waitcnt vmcnt(24)
s_barrier
ds_read_b64_tr_b16 a[64:65], v23 offset:0
ds_read_b64_tr_b16 a[66:67], v23 offset:1024
ds_read_b64_tr_b16 a[68:69], v24 offset:0
ds_read_b64_tr_b16 a[70:71], v24 offset:1024
ds_read_b64_tr_b16 a[72:73], v23 offset:8192
ds_read_b64_tr_b16 a[74:75], v23 offset:9216
ds_read_b64_tr_b16 a[76:77], v24 offset:8192
ds_read_b64_tr_b16 a[78:79], v24 offset:9216
s_waitcnt lgkmcnt(0)
ds_read_b64_tr_b16 a[80:81], v23 offset:16384
ds_read_b64_tr_b16 a[82:83], v23 offset:17408
ds_read_b64_tr_b16 a[84:85], v24 offset:16384
ds_read_b64_tr_b16 a[86:87], v24 offset:17408
ds_read_b64_tr_b16 a[88:89], v23 offset:24576
ds_read_b64_tr_b16 a[90:91], v23 offset:25600
ds_read_b64_tr_b16 a[92:93], v24 offset:24576
ds_read_b64_tr_b16 a[94:95], v24 offset:25600
s_waitcnt lgkmcnt(0)
s_barrier
s_add_u32 m0, s26, 65536
s_add_u32 s27, s25, 1572864
buffer_load_dwordx4 v20, s[16:19], s27 offen lds
s_add_u32 m0, s26, 66560
s_add_u32 s27, s25, 1581056
buffer_load_dwordx4 v20, s[16:19], s27 offen lds
s_add_u32 m0, s26, 67584
s_add_u32 s27, s25, 1589248
buffer_load_dwordx4 v20, s[16:19], s27 offen lds
s_add_u32 m0, s26, 68608
s_add_u32 s27, s25, 1597440
buffer_load_dwordx4 v20, s[16:19], s27 offen lds
s_add_u32 m0, s26, 69632
s_add_u32 s27, s25, 1605632
buffer_load_dwordx4 v20, s[16:19], s27 offen lds
s_add_u32 m0, s26, 70656
s_add_u32 s27, s25, 1613824
buffer_load_dwordx4 v20, s[16:19], s27 offen lds
s_add_u32 m0, s26, 71680
s_add_u32 s27, s25, 1622016
buffer_load_dwordx4 v20, s[16:19], s27 offen lds
s_add_u32 m0, s26, 72704
s_add_u32 s27, s25, 1630208
buffer_load_dwordx4 v20, s[16:19], s27 offen lds
s_waitcnt vmcnt(24)
s_barrier
v_mov_b32 v131, 3
buffer_atomic_add v131, v85, s[12:15], s95 offen sc0 sc1
ds_read_b64_tr_b16 a[96:97], v23 offset:32768
ds_read_b64_tr_b16 a[98:99], v23 offset:33792
ds_read_b64_tr_b16 a[100:101], v24 offset:32768
ds_read_b64_tr_b16 a[102:103], v24 offset:33792
ds_read_b64_tr_b16 a[104:105], v23 offset:40960
ds_read_b64_tr_b16 a[106:107], v23 offset:41984
ds_read_b64_tr_b16 a[108:109], v24 offset:40960
ds_read_b64_tr_b16 a[110:111], v24 offset:41984
s_waitcnt lgkmcnt(0)
ds_read_b64_tr_b16 a[112:113], v23 offset:49152
ds_read_b64_tr_b16 a[114:115], v23 offset:50176
ds_read_b64_tr_b16 a[116:117], v24 offset:49152
ds_read_b64_tr_b16 a[118:119], v24 offset:50176
ds_read_b64_tr_b16 a[120:121], v23 offset:57344
ds_read_b64_tr_b16 a[122:123], v23 offset:58368
ds_read_b64_tr_b16 a[124:125], v24 offset:57344
ds_read_b64_tr_b16 a[126:127], v24 offset:58368
s_waitcnt lgkmcnt(0)
s_barrier
s_add_u32 m0, s26, 98304
s_add_u32 s27, s25, 1835008
buffer_load_dwordx4 v20, s[16:19], s27 offen lds
s_add_u32 m0, s26, 99328
s_add_u32 s27, s25, 1843200
buffer_load_dwordx4 v20, s[16:19], s27 offen lds
s_add_u32 m0, s26, 100352
s_add_u32 s27, s25, 1851392
buffer_load_dwordx4 v20, s[16:19], s27 offen lds
s_add_u32 m0, s26, 101376
s_add_u32 s27, s25, 1859584
buffer_load_dwordx4 v20, s[16:19], s27 offen lds
s_add_u32 m0, s26, 102400
s_add_u32 s27, s25, 1867776
buffer_load_dwordx4 v20, s[16:19], s27 offen lds
s_add_u32 m0, s26, 103424
s_add_u32 s27, s25, 1875968
buffer_load_dwordx4 v20, s[16:19], s27 offen lds
s_add_u32 m0, s26, 104448
s_add_u32 s27, s25, 1884160
buffer_load_dwordx4 v20, s[16:19], s27 offen lds
s_add_u32 m0, s26, 105472
s_add_u32 s27, s25, 1892352
buffer_load_dwordx4 v20, s[16:19], s27 offen lds
s_waitcnt vmcnt(24)
s_barrier
ds_read_b64_tr_b16 a[128:129], v21 offset:0
ds_read_b64_tr_b16 a[130:131], v21 offset:1024
ds_read_b64_tr_b16 a[132:133], v22 offset:0
ds_read_b64_tr_b16 a[134:135], v22 offset:1024
ds_read_b64_tr_b16 a[136:137], v21 offset:8192
ds_read_b64_tr_b16 a[138:139], v21 offset:9216
ds_read_b64_tr_b16 a[140:141], v22 offset:8192
ds_read_b64_tr_b16 a[142:143], v22 offset:9216
s_waitcnt lgkmcnt(0)
ds_read_b64_tr_b16 a[144:145], v21 offset:16384
ds_read_b64_tr_b16 a[146:147], v21 offset:17408
ds_read_b64_tr_b16 a[148:149], v22 offset:16384
ds_read_b64_tr_b16 a[150:151], v22 offset:17408
ds_read_b64_tr_b16 a[152:153], v21 offset:24576
ds_read_b64_tr_b16 a[154:155], v21 offset:25600
ds_read_b64_tr_b16 a[156:157], v22 offset:24576
ds_read_b64_tr_b16 a[158:159], v22 offset:25600
s_waitcnt lgkmcnt(0)
s_waitcnt vmcnt(16)
s_barrier
ds_read_b64_tr_b16 a[160:161], v21 offset:32768
ds_read_b64_tr_b16 a[162:163], v21 offset:33792
ds_read_b64_tr_b16 a[164:165], v22 offset:32768
ds_read_b64_tr_b16 a[166:167], v22 offset:33792
ds_read_b64_tr_b16 a[168:169], v21 offset:40960
ds_read_b64_tr_b16 a[170:171], v21 offset:41984
ds_read_b64_tr_b16 a[172:173], v22 offset:40960
ds_read_b64_tr_b16 a[174:175], v22 offset:41984
s_waitcnt lgkmcnt(0)
ds_read_b64_tr_b16 a[176:177], v21 offset:49152
ds_read_b64_tr_b16 a[178:179], v21 offset:50176
ds_read_b64_tr_b16 a[180:181], v22 offset:49152
ds_read_b64_tr_b16 a[182:183], v22 offset:50176
ds_read_b64_tr_b16 a[184:185], v21 offset:57344
ds_read_b64_tr_b16 a[186:187], v21 offset:58368
ds_read_b64_tr_b16 a[188:189], v22 offset:57344
ds_read_b64_tr_b16 a[190:191], v22 offset:58368
s_waitcnt lgkmcnt(0)
s_waitcnt vmcnt(8)
s_barrier
ds_read_b64_tr_b16 a[192:193], v23 offset:0
ds_read_b64_tr_b16 a[194:195], v23 offset:1024
ds_read_b64_tr_b16 a[196:197], v24 offset:0
ds_read_b64_tr_b16 a[198:199], v24 offset:1024
ds_read_b64_tr_b16 a[200:201], v23 offset:8192
ds_read_b64_tr_b16 a[202:203], v23 offset:9216
ds_read_b64_tr_b16 a[204:205], v24 offset:8192
ds_read_b64_tr_b16 a[206:207], v24 offset:9216
s_waitcnt lgkmcnt(0)
ds_read_b64_tr_b16 a[208:209], v23 offset:16384
ds_read_b64_tr_b16 a[210:211], v23 offset:17408
ds_read_b64_tr_b16 a[212:213], v24 offset:16384
ds_read_b64_tr_b16 a[214:215], v24 offset:17408
ds_read_b64_tr_b16 a[216:217], v23 offset:24576
ds_read_b64_tr_b16 a[218:219], v23 offset:25600
ds_read_b64_tr_b16 a[220:221], v24 offset:24576
ds_read_b64_tr_b16 a[222:223], v24 offset:25600
s_waitcnt lgkmcnt(0)
s_waitcnt vmcnt(0)
s_barrier
v_add_u32 v88, 1, v131
v_add_u32 v89, 2, v131
v_add_u32 v90, 3, v131
buffer_store_dwordx3 v[88:90], v85, s[12:15], s60 offen sc1
ds_read_b64_tr_b16 a[224:225], v23 offset:32768
ds_read_b64_tr_b16 a[226:227], v23 offset:33792
ds_read_b64_tr_b16 a[228:229], v24 offset:32768
ds_read_b64_tr_b16 a[230:231], v24 offset:33792
ds_read_b64_tr_b16 a[232:233], v23 offset:40960
ds_read_b64_tr_b16 a[234:235], v23 offset:41984
ds_read_b64_tr_b16 a[236:237], v24 offset:40960
ds_read_b64_tr_b16 a[238:239], v24 offset:41984
s_waitcnt lgkmcnt(0)
ds_read_b64_tr_b16 a[240:241], v23 offset:49152
ds_read_b64_tr_b16 a[242:243], v23 offset:50176
ds_read_b64_tr_b16 a[244:245], v24 offset:49152
ds_read_b64_tr_b16 a[246:247], v24 offset:50176
ds_read_b64_tr_b16 a[248:249], v23 offset:57344
ds_read_b64_tr_b16 a[250:251], v23 offset:58368
ds_read_b64_tr_b16 a[252:253], v24 offset:57344
ds_read_b64_tr_b16 a[254:255], v24 offset:58368
s_waitcnt lgkmcnt(0)
v_mov_b32 v2, 0
L_pl_516:
buffer_load_dword v1, v2, s[12:15], s48 offen sc1
s_add_u32 s36, s36, 1
s_cmp_gt_u32 s36, 0x100000
s_cbranch_scc1 chain_kernel_wend
s_waitcnt vmcnt(0)
v_readfirstlane_b32 s26, v1
s_cmp_ge_u32 s26, 4
s_cbranch_scc1 L_plok_517
s_sleep 4
s_branch L_pl_516
L_plok_517:
s_lshl_b32 s25, s42, 9
s_lshl_b32 s26, s49, 7
s_add_u32 s25, s25, s26
s_lshl_b32 s26, s39, 13
s_add_u32 s25, s25, s26
s_add_u32 s25, s25, 4096
v_bfe_u32 v1, v0, 3, 3
v_and_b32 v2, 7, v0
v_lshlrev_b32 v1, 15, v1
v_lshl_add_u32 v1, v2, 4, v1
v_add_u32 v128, s25, v1
s_lshl_b32 s48, s39, 7
s_add_u32 s48, s48, 0x5904000
s_lshl_b32 s50, s39, 18
s_add_u32 s50, s50, 2048
s_mov_b32 s8, s100
s_and_b32 s9, s101, 0xffff
s_mov_b32 s10, 0x10000000
s_mov_b32 s11, 0x00020000
s_mov_b32 s16, s96
s_and_b32 s17, s97, 0xffff
s_mov_b32 s18, 0x1000000
s_mov_b32 s19, 0x00020000
s_lshl_b32 s39, s39, 4
s_lshl_b32 s21, s49, 12
v_and_b32 v1, 63, v0
v_and_b32 v2, 15, v0
v_bfe_u32 v3, v0, 4, 2
v_lshrrev_b32 v4, 6, v0
v_lshlrev_b32 v5, 4, v1
v_lshl_add_u32 v5, v4, 14, v5
v_add_u32 v8, 0, v5
v_add_u32 v9, 1024, v5
v_add_u32 v10, 2048, v5
v_add_u32 v11, 3072, v5
v_lshlrev_b32 v5, 4, v2
v_lshl_add_u32 v5, v3, 9, v5
v_xor_b32 v12, s39, v5
v_xor_b32 v13, 0x100, v12
v_add_u32 v16, 0x10000, v12
v_add_u32 v17, 0x10000, v13
v_and_b32 v130, 63, v0
v_lshlrev_b32 v130, 2, v130
s_mov_b32 s23, 62
s_mov_b32 s3, 1
L_sw_520:
buffer_load_dword v129, v130, s[12:15], s94 offen sc1
s_add_u32 s36, s36, 1
s_cmp_gt_u32 s36, 0x100000
s_cbranch_scc1 chain_kernel_wend
s_waitcnt vmcnt(0)
v_readlane_b32 s28, v129, s3
s_cmp_lg_u32 s28, 0
s_cbranch_scc1 L_sok_519
s_sleep 1
s_branch L_sw_520
L_sok_519:
s_cmp_gt_u32 s28, 62
s_cselect_b32 s3, s3, 64
s_min_u32 s23, s23, s3
s_sub_u32 s61, s23, 1
s_mov_b32 s3, 0
v_readlane_b32 s28, v129, 0
s_cmp_lg_u32 s28, 0
s_cbranch_scc1 L_sok_521
L_sw_522:
buffer_load_dword v129, v130, s[12:15], s94 offen sc1
s_add_u32 s36, s36, 1
s_cmp_gt_u32 s36, 0x100000
s_cbranch_scc1 chain_kernel_wend
s_waitcnt vmcnt(0)
v_readlane_b32 s28, v129, s3
s_cmp_lg_u32 s28, 0
s_cbranch_scc1 L_sok_521
s_sleep 1
s_branch L_sw_522
L_sok_521:
s_cmp_gt_u32 s28, 62
s_cselect_b32 s3, s3, 64
s_min_u32 s23, s23, s3
s_sub_u32 s61, s23, 1
s_cmp_eq_u32 s23, 0
s_cbranch_scc1 L_opdone_518
s_mov_b32 s52, 0
v_mov_b32 v4, 0
s_mov_b32 s22, 0
s_sub_u32 s61, s23, 1
s_mov_b32 s24, s22
s_add_u32 s51, s24, 0
s_min_u32 s51, s51, s61
v_readlane_b32 s51, v129, s51
s_nop 0
s_nop 0
s_sub_u32 s51, s51, 1
s_lshl_b32 s51, s51, 9
s_add_u32 s51, s51, s48
L_gw_524:
buffer_load_dword v87, v4, s[12:15], s51 offen sc1
s_add_u32 s36, s36, 1
s_cmp_gt_u32 s36, 0x100000
s_cbranch_scc1 chain_kernel_wend
s_waitcnt vmcnt(0)
v_readfirstlane_b32 s30, v87
s_cmp_lt_u32 s30, 8
s_cbranch_scc0 L_rgo_523
s_sleep 1
s_branch L_gw_524
L_rgo_523:
s_add_u32 s51, s24, 1
s_min_u32 s51, s51, s61
v_readlane_b32 s51, v129, s51
s_nop 0
s_nop 0
s_sub_u32 s51, s51, 1
s_lshl_b32 s51, s51, 9
s_add_u32 s51, s51, s48
buffer_load_dword v87, v4, s[12:15], s51 offen sc1
s_mov_b32 s37, 0
s_mov_b32 s7, 0
v_mov_b32 v88, 0
v_mov_b32 v89, 0
v_mov_b32 v90, 0
v_mov_b32 v91, 0
v_mov_b32 v92, 0
v_mov_b32 v93, 0
v_mov_b32 v94, 0
v_mov_b32 v95, 0
s_mov_b32 s30, s24
v_readlane_b32 s30, v129, s30
s_nop 0
s_nop 0
s_sub_u32 s30, s30, 1
s_bitcmp1_b32 s30, 1
s_cselect_b32 s53, s54, s55
s_lshl_b32 s30, s30, 20
s_add_u32 s53, s53, s30
s_add_u32 s53, s53, s50
s_mov_b32 s20, s53
s_mov_b32 s39, 0x7ff00000
s_mov_b32 s42, 0x7ff00000
s_mov_b32 s43, 0x7ff00000
s_barrier
s_add_u32 m0, s21, 0
s_nop 0
buffer_load_dwordx4 v8, s[8:11], s20 offen lds
s_add_u32 m0, s21, 1024
s_nop 0
buffer_load_dwordx4 v9, s[8:11], s20 offen lds
s_add_u32 m0, s21, 2048
s_nop 0
buffer_load_dwordx4 v10, s[8:11], s20 offen lds
s_add_u32 m0, s21, 3072
s_nop 0
buffer_load_dwordx4 v11, s[8:11], s20 offen lds
s_add_u32 s20, s20, 65536
s_add_u32 m0, s21, 16384
s_nop 0
buffer_load_dwordx4 v8, s[8:11], s20 offen lds
s_add_u32 m0, s21, 17408
s_nop 0
buffer_load_dwordx4 v9, s[8:11], s20 offen lds
s_add_u32 m0, s21, 18432
s_nop 0
buffer_load_dwordx4 v10, s[8:11], s20 offen lds
s_add_u32 m0, s21, 19456
s_nop 0
buffer_load_dwordx4 v11, s[8:11], s20 offen lds
s_add_u32 s20, s20, 65536
s_add_u32 m0, s21, 32768
s_nop 0
buffer_load_dwordx4 v8, s[8:11], s20 offen lds
s_add_u32 m0, s21, 33792
s_nop 0
buffer_load_dwordx4 v9, s[8:11], s20 offen lds
s_add_u32 m0, s21, 34816
s_nop 0
buffer_load_dwordx4 v10, s[8:11], s20 offen lds
s_add_u32 m0, s21, 35840
s_nop 0
buffer_load_dwordx4 v11, s[8:11], s20 offen lds
s_add_u32 s20, s20, 65536
s_add_u32 m0, s21, 49152
s_nop 0
buffer_load_dwordx4 v8, s[8:11], s20 offen lds
s_waitcnt vmcnt(0)
s_barrier
ds_read_b128 v[20:23], v12 offset:0
ds_read_b128 v[24:27], v13 offset:0
ds_read_b128 v[28:31], v12 offset:2048
ds_read_b128 v[32:35], v13 offset:2048
ds_read_b128 v[36:39], v12 offset:4096
ds_read_b128 v[40:43], v13 offset:4096
s_waitcnt lgkmcnt(4)
L_st_528:
v_mfma_f32_16x16x32_bf16 v[52:55], v[20:23], a[0:3], 0
ds_read_b128 v[44:47], v12 offset:6144
s_add_u32 m0, s21, 50176
s_cmp_lt_u32 s22, 57
s_cselect_b32 s27, 1, 0
s_cselect_b32 s26, 1, 0x80
v_mfma_f32_16x16x32_bf16 v[56:59], v[20:23], a[4:7], 0
buffer_load_dwordx4 v9, s[8:11], s20 offen lds
s_sub_u32 s38, s22, 1
v_mfma_f32_16x16x32_bf16 v[60:63], v[24:27], a[0:3], 0
ds_read_b128 v[48:51], v13 offset:6144
s_and_b32 s31, s38, 3
s_lshl_b32 s31, s31, 11
v_mfma_f32_16x16x32_bf16 v[64:67], v[24:27], a[4:7], 0
s_waitcnt lgkmcnt(4)
s_bfe_u32 s38, s38, 0x10002
v_mfma_f32_16x16x32_bf16 v[52:55], v[28:31], a[8:11], v[52:55]
ds_read_b128 v[20:23], v12 offset:8192
v_mov_b32 v131, s27
s_xor_b32 s38, s38, 1
v_mfma_f32_16x16x32_bf16 v[56:59], v[28:31], a[12:15], v[56:59]
buffer_atomic_add v131, v85, s[12:15], s95 offen sc0 sc1
v_mfma_f32_16x16x32_bf16 v[60:63], v[32:35], a[8:11], v[60:63]
ds_read_b128 v[24:27], v13 offset:8192
s_add_u32 s24, s24, 1
s_min_u32 s24, s24, s61
s_cmp_eq_u32 s37, 0
s_cselect_b32 s31, 0x40000000, s31
s_cselect_b32 s38, 0, s38
v_mfma_f32_16x16x32_bf16 v[64:67], v[32:35], a[12:15], v[64:67]
s_waitcnt lgkmcnt(4)
s_mov_b32 s30, s24
v_readlane_b32 s30, v129, s30
v_mfma_f32_16x16x32_bf16 v[52:55], v[36:39], a[16:19], v[52:55]
ds_read_b128 v[28:31], v12 offset:10240
s_add_u32 m0, s21, 51200
s_nop 0
v_mfma_f32_16x16x32_bf16 v[56:59], v[36:39], a[20:23], v[56:59]
buffer_load_dwordx4 v10, s[8:11], s20 offen lds
v_mfma_f32_16x16x32_bf16 v[60:63], v[40:43], a[16:19], v[60:63]
ds_read_b128 v[32:35], v13 offset:10240
s_nop 0
s_sub_u32 s30, s30, 1
v_mfma_f32_16x16x32_bf16 v[64:67], v[40:43], a[20:23], v[64:67]
s_waitcnt lgkmcnt(4)
s_bitcmp1_b32 s30, 1
s_cselect_b32 s53, s54, s55
v_mfma_f32_16x16x32_bf16 v[52:55], v[44:47], a[24:27], v[52:55]
ds_read_b128 v[36:39], v12 offset:12288
s_lshl_b32 s30, s30, 20
v_cvt_pk_bf16_f32 v104, v69, v73
v_mfma_f32_16x16x32_bf16 v[56:59], v[44:47], a[28:31], v[56:59]
s_add_u32 s53, s53, s30
buffer_load_dword v129, v130, s[12:15], s94 offen sc1
v_mfma_f32_16x16x32_bf16 v[60:63], v[48:51], a[24:27], v[60:63]
ds_read_b128 v[40:43], v13 offset:12288
s_add_u32 s53, s53, s50
s_waitcnt vmcnt(13)
v_cvt_pk_bf16_f32 v105, v77, v81
v_mfma_f32_16x16x32_bf16 v[64:67], v[48:51], a[28:31], v[64:67]
s_waitcnt lgkmcnt(4)
v_readfirstlane_b32 s30, v87
s_nop 0
v_mfma_f32_16x16x32_bf16 v[52:55], v[20:23], a[32:35], v[52:55]
ds_read_b128 v[44:47], v12 offset:14336
s_add_u32 m0, s21, 52224
v_and_or_b32 v104, v104, -2, s38
v_mfma_f32_16x16x32_bf16 v[56:59], v[20:23], a[36:39], v[56:59]
buffer_load_dwordx4 v11, s[8:11], s20 offen lds
s_nop 0
v_mfma_f32_16x16x32_bf16 v[60:63], v[24:27], a[32:35], v[60:63]
ds_read_b128 v[48:51], v13 offset:14336
s_cmp_lt_u32 s30, 8
s_cbranch_scc1 L_gw_534
L_gok_533:
v_mfma_f32_16x16x32_bf16 v[64:67], v[24:27], a[36:39], v[64:67]
s_waitcnt lgkmcnt(4)
v_and_or_b32 v105, v105, -2, s38
s_add_u32 s29, s45, s31
v_mfma_f32_16x16x32_bf16 v[52:55], v[28:31], a[40:43], v[52:55]
s_waitcnt vmcnt(15)
s_barrier
ds_read_b128 v[20:23], v12 offset:16384
v_mfma_f32_16x16x32_bf16 v[56:59], v[28:31], a[44:47], v[56:59]
s_mov_b32 s20, s53
buffer_store_dwordx2 v[104:105], v112, s[12:15], s29 offen offset:0 sc1
v_mfma_f32_16x16x32_bf16 v[60:63], v[32:35], a[40:43], v[60:63]
ds_read_b128 v[24:27], v13 offset:16384
v_cvt_pk_bf16_f32 v106, v70, v74
v_mfma_f32_16x16x32_bf16 v[64:67], v[32:35], a[44:47], v[64:67]
s_waitcnt lgkmcnt(4)
v_cvt_pk_bf16_f32 v107, v78, v82
v_mfma_f32_16x16x32_bf16 v[52:55], v[36:39], a[48:51], v[52:55]
ds_read_b128 v[28:31], v12 offset:18432
s_add_u32 m0, s21, 65536
v_mfma_f32_16x16x32_bf16 v[56:59], v[36:39], a[52:55], v[56:59]
buffer_load_dwordx4 v8, s[8:11], s20 offen lds
v_mfma_f32_16x16x32_bf16 v[60:63], v[40:43], a[48:51], v[60:63]
ds_read_b128 v[32:35], v13 offset:18432
v_and_or_b32 v106, v106, -2, s38
v_mfma_f32_16x16x32_bf16 v[64:67], v[40:43], a[52:55], v[64:67]
s_waitcnt lgkmcnt(4)
v_and_or_b32 v107, v107, -2, s38
v_mfma_f32_16x16x32_bf16 v[52:55], v[44:47], a[56:59], v[52:55]
ds_read_b128 v[36:39], v12 offset:20480
s_add_u32 s29, s46, s31
v_mfma_f32_16x16x32_bf16 v[56:59], v[44:47], a[60:63], v[56:59]
buffer_store_dwordx2 v[106:107], v112, s[12:15], s29 offen offset:512 sc1
v_mfma_f32_16x16x32_bf16 v[60:63], v[48:51], a[56:59], v[60:63]
ds_read_b128 v[40:43], v13 offset:20480
v_cvt_pk_bf16_f32 v108, v71, v75
v_mfma_f32_16x16x32_bf16 v[64:67], v[48:51], a[60:63], v[64:67]
s_waitcnt lgkmcnt(4)
v_cvt_pk_bf16_f32 v109, v79, v83
v_mfma_f32_16x16x32_bf16 v[52:55], v[20:23], a[64:67], v[52:55]
ds_read_b128 v[44:47], v12 offset:22528
s_add_u32 m0, s21, 66560
v_mfma_f32_16x16x32_bf16 v[56:59], v[20:23], a[68:71], v[56:59]
buffer_load_dwordx4 v9, s[8:11], s20 offen lds
v_mfma_f32_16x16x32_bf16 v[60:63], v[24:27], a[64:67], v[60:63]
ds_read_b128 v[48:51], v13 offset:22528
v_and_or_b32 v108, v108, -2, s38
v_mfma_f32_16x16x32_bf16 v[64:67], v[24:27], a[68:71], v[64:67]
s_waitcnt lgkmcnt(4)
v_and_or_b32 v109, v109, -2, s38
v_mfma_f32_16x16x32_bf16 v[52:55], v[28:31], a[72:75], v[52:55]
ds_read_b128 v[20:23], v12 offset:24576
s_add_u32 s29, s47, s31
v_mfma_f32_16x16x32_bf16 v[56:59], v[28:31], a[76:79], v[56:59]
buffer_store_dwordx2 v[108:109], v112, s[12:15], s29 offen offset:1024 sc1
v_mfma_f32_16x16x32_bf16 v[60:63], v[32:35], a[72:75], v[60:63]
ds_read_b128 v[24:27], v13 offset:24576
v_mfma_f32_16x16x32_bf16 v[64:67], v[32:35], a[76:79], v[64:67]
s_waitcnt lgkmcnt(4)
v_mfma_f32_16x16x32_bf16 v[52:55], v[36:39], a[80:83], v[52:55]
ds_read_b128 v[28:31], v12 offset:26624
s_add_u32 m0, s21, 67584
v_mfma_f32_16x16x32_bf16 v[56:59], v[36:39], a[84:87], v[56:59]
buffer_load_dwordx4 v10, s[8:11], s20 offen lds
v_mfma_f32_16x16x32_bf16 v[60:63], v[40:43], a[80:83], v[60:63]
ds_read_b128 v[32:35], v13 offset:26624
v_mfma_f32_16x16x32_bf16 v[64:67], v[40:43], a[84:87], v[64:67]
s_waitcnt lgkmcnt(4)
v_mfma_f32_16x16x32_bf16 v[52:55], v[44:47], a[88:91], v[52:55]
ds_read_b128 v[36:39], v12 offset:28672
v_mfma_f32_16x16x32_bf16 v[56:59], v[44:47], a[92:95], v[56:59]
v_mfma_f32_16x16x32_bf16 v[60:63], v[48:51], a[88:91], v[60:63]
ds_read_b128 v[40:43], v13 offset:28672
v_mfma_f32_16x16x32_bf16 v[64:67], v[48:51], a[92:95], v[64:67]
s_waitcnt lgkmcnt(4)
v_mfma_f32_16x16x32_bf16 v[52:55], v[20:23], a[96:99], v[52:55]
ds_read_b128 v[44:47], v12 offset:30720
s_add_u32 m0, s21, 68608
v_mfma_f32_16x16x32_bf16 v[56:59], v[20:23], a[100:103], v[56:59]
buffer_load_dwordx4 v11, s[8:11], s20 offen lds
v_mfma_f32_16x16x32_bf16 v[60:63], v[24:27], a[96:99], v[60:63]
ds_read_b128 v[48:51], v13 offset:30720
v_mfma_f32_16x16x32_bf16 v[64:67], v[24:27], a[100:103], v[64:67]
s_waitcnt lgkmcnt(4)
v_mfma_f32_16x16x32_bf16 v[52:55], v[28:31], a[104:107], v[52:55]
s_waitcnt vmcnt(15)
s_barrier
ds_read_b128 v[20:23], v12 offset:32768
v_mfma_f32_16x16x32_bf16 v[56:59], v[28:31], a[108:111], v[56:59]
s_add_u32 s20, s20, 65536
v_mfma_f32_16x16x32_bf16 v[60:63], v[32:35], a[104:107], v[60:63]
ds_read_b128 v[24:27], v13 offset:32768
v_mfma_f32_16x16x32_bf16 v[64:67], v[32:35], a[108:111], v[64:67]
s_waitcnt lgkmcnt(4)
v_mfma_f32_16x16x32_bf16 v[52:55], v[36:39], a[112:115], v[52:55]
ds_read_b128 v[28:31], v12 offset:34816
s_add_u32 m0, s21, 81920
s_waitcnt vmcnt(12)
v_xor_b32 v124, s7, v88
v_mfma_f32_16x16x32_bf16 v[56:59], v[36:39], a[116:119], v[56:59]
buffer_load_dwordx4 v8, s[8:11], s20 offen lds
v_bitop3_b32 v124, v124, v89, s7 bitop3:0xf6
v_mfma_f32_16x16x32_bf16 v[60:63], v[40:43], a[112:115], v[60:63]
ds_read_b128 v[32:35], v13 offset:34816
v_bitop3_b32 v124, v124, v90, s7 bitop3:0xf6
v_bitop3_b32 v124, v124, v91, s7 bitop3:0xf6
v_mfma_f32_16x16x32_bf16 v[64:67], v[40:43], a[116:119], v[64:67]
s_waitcnt lgkmcnt(4)
v_bitop3_b32 v124, v124, v92, s7 bitop3:0xf6
v_bitop3_b32 v124, v124, v93, s7 bitop3:0xf6
v_mfma_f32_16x16x32_bf16 v[52:55], v[44:47], a[120:123], v[52:55]
ds_read_b128 v[36:39], v12 offset:36864
s_lshl_b32 s27, s22, 2
v_and_b32 v124, 1, v124
v_cmp_ne_u32 vcc, 0, v124
v_mfma_f32_16x16x32_bf16 v[56:59], v[44:47], a[124:127], v[56:59]
s_add_u32 s3, s22, 2
s_waitcnt vmcnt(9)
s_nop 0
v_mfma_f32_16x16x32_bf16 v[60:63], v[48:51], a[120:123], v[60:63]
ds_read_b128 v[40:43], v13 offset:36864
v_readlane_b32 s28, v129, s3
s_nop 0
s_nop 0
v_mfma_f32_16x16x32_bf16 v[64:67], v[48:51], a[124:127], v[64:67]
s_waitcnt lgkmcnt(4)
s_nop 0
s_cbranch_vccnz L_rbad_529
L_rok_530:
v_mfma_f32_16x16x32_bf16 v[52:55], v[20:23], a[128:131], v[52:55]
ds_read_b128 v[44:47], v12 offset:38912
s_add_u32 m0, s21, 82944
v_mfma_f32_16x16x32_bf16 v[56:59], v[20:23], a[132:135], v[56:59]
buffer_load_dwordx4 v9, s[8:11], s20 offen lds
s_nop 0
v_lshlrev_b32 v124, 16, v88
v_mfma_f32_16x16x32_bf16 v[60:63], v[24:27], a[128:131], v[60:63]
ds_read_b128 v[48:51], v13 offset:38912
s_cmp_eq_u32 s28, 0
s_cbranch_scc1 L_sw_532
L_sok_531:
v_mfma_f32_16x16x32_bf16 v[64:67], v[24:27], a[132:135], v[64:67]
s_waitcnt lgkmcnt(4)
s_add_u32 s27, s27, s60
v_and_b32 v125, 0xffff0000, v88
v_mfma_f32_16x16x32_bf16 v[52:55], v[28:31], a[136:139], v[52:55]
ds_read_b128 v[20:23], v12 offset:40960
s_waitcnt vmcnt(12)
v_and_b32 v124, 0xfffe0000, v124
v_add_f32 v96, v116, v124
v_mfma_f32_16x16x32_bf16 v[56:59], v[28:31], a[140:143], v[56:59]
s_cmp_gt_u32 s28, 62
s_cselect_b32 s3, s3, 64
v_add_f32 v97, v117, v125
v_mfma_f32_16x16x32_bf16 v[60:63], v[32:35], a[136:139], v[60:63]
ds_read_b128 v[24:27], v13 offset:40960
v_add_u32 v131, s26, v131
v_lshlrev_b32 v124, 16, v89
v_and_b32 v125, 0xffff0000, v89
v_mfma_f32_16x16x32_bf16 v[64:67], v[32:35], a[140:143], v[64:67]
s_waitcnt lgkmcnt(4)
s_min_u32 s23, s23, s3
v_and_b32 v124, 0xfffe0000, v124
v_mfma_f32_16x16x32_bf16 v[52:55], v[36:39], a[144:147], v[52:55]
ds_read_b128 v[28:31], v12 offset:43008
s_add_u32 m0, s21, 83968
s_sub_u32 s61, s23, 1
v_add_f32 v98, v118, v124
v_mfma_f32_16x16x32_bf16 v[56:59], v[36:39], a[148:151], v[56:59]
buffer_load_dwordx4 v10, s[8:11], s20 offen lds
v_add_f32 v99, v119, v125
v_mfma_f32_16x16x32_bf16 v[60:63], v[40:43], a[144:147], v[60:63]
ds_read_b128 v[32:35], v13 offset:43008
s_add_u32 s51, s24, 1
v_lshlrev_b32 v124, 16, v90
v_mfma_f32_16x16x32_bf16 v[64:67], v[40:43], a[148:151], v[64:67]
s_waitcnt lgkmcnt(4)
s_min_u32 s51, s51, s61
v_and_b32 v125, 0xffff0000, v90
v_and_b32 v124, 0xfffe0000, v124
v_mfma_f32_16x16x32_bf16 v[52:55], v[44:47], a[152:155], v[52:55]
ds_read_b128 v[36:39], v12 offset:45056
v_readlane_b32 s51, v129, s51
v_add_f32 v96, v96, v124
v_mfma_f32_16x16x32_bf16 v[56:59], v[44:47], a[156:159], v[56:59]
s_nop 0
buffer_store_dword v131, v85, s[12:15], s27 offen offset:12 sc1
v_add_f32 v97, v97, v125
v_mfma_f32_16x16x32_bf16 v[60:63], v[48:51], a[152:155], v[60:63]
ds_read_b128 v[40:43], v13 offset:45056
s_nop 0
v_lshlrev_b32 v124, 16, v91
v_mfma_f32_16x16x32_bf16 v[64:67], v[48:51], a[156:159], v[64:67]
s_waitcnt lgkmcnt(4)
s_sub_u32 s51, s51, 1
v_and_b32 v125, 0xffff0000, v91
v_and_b32 v124, 0xfffe0000, v124
v_mfma_f32_16x16x32_bf16 v[52:55], v[20:23], a[160:163], v[52:55]
ds_read_b128 v[44:47], v12 offset:47104
s_add_u32 m0, s21, 84992
v_add_f32 v98, v98, v124
v_mfma_f32_16x16x32_bf16 v[56:59], v[20:23], a[164:167], v[56:59]
buffer_load_dwordx4 v11, s[8:11], s20 offen lds
s_lshl_b32 s51, s51, 9
v_add_f32 v99, v99, v125
v_mfma_f32_16x16x32_bf16 v[60:63], v[24:27], a[160:163], v[60:63]
ds_read_b128 v[48:51], v13 offset:47104
s_add_u32 s51, s51, s48
v_lshlrev_b32 v124, 16, v92
v_mfma_f32_16x16x32_bf16 v[64:67], v[24:27], a[164:167], v[64:67]
s_waitcnt lgkmcnt(4)
v_and_b32 v125, 0xffff0000, v92
v_and_b32 v124, 0xfffe0000, v124
v_mfma_f32_16x16x32_bf16 v[52:55], v[28:31], a[168:171], v[52:55]
s_waitcnt vmcnt(12)
s_barrier
ds_read_b128 v[20:23], v12 offset:49152
v_add_f32 v96, v96, v124
v_mfma_f32_16x16x32_bf16 v[56:59], v[28:31], a[172:175], v[56:59]
s_add_u32 s20, s20, 65536
buffer_load_dword v87, v4, s[12:15], s51 offen sc1
v_add_f32 v97, v97, v125
v_mfma_f32_16x16x32_bf16 v[60:63], v[32:35], a[168:171], v[60:63]
ds_read_b128 v[24:27], v13 offset:49152
v_lshlrev_b32 v124, 16, v93
v_and_b32 v125, 0xffff0000, v93
v_mfma_f32_16x16x32_bf16 v[64:67], v[32:35], a[172:175], v[64:67]
s_waitcnt lgkmcnt(4)
v_and_b32 v124, 0xfffe0000, v124
v_add_f32 v98, v98, v124
v_mfma_f32_16x16x32_bf16 v[52:55], v[36:39], a[176:179], v[52:55]
ds_read_b128 v[28:31], v12 offset:51200
s_add_u32 m0, s21, 98304
v_add_f32 v99, v99, v125
v_mfma_f32_16x16x32_bf16 v[56:59], v[36:39], a[180:183], v[56:59]
buffer_load_dwordx4 v8, s[8:11], s20 offen lds
ds_write2_b32 v114, v96, v97 offset0:0 offset1:16
v_mfma_f32_16x16x32_bf16 v[60:63], v[40:43], a[176:179], v[60:63]
ds_read_b128 v[32:35], v13 offset:51200
ds_write2_b32 v114, v98, v99 offset0:128 offset1:144
ds_read_b128 v[88:91], v113 offset:0
v_mfma_f32_16x16x32_bf16 v[64:67], v[40:43], a[180:183], v[64:67]
s_waitcnt lgkmcnt(4)
v_mfma_f32_16x16x32_bf16 v[52:55], v[44:47], a[184:187], v[52:55]
ds_read_b128 v[36:39], v12 offset:53248
v_mfma_f32_16x16x32_bf16 v[56:59], v[44:47], a[188:191], v[56:59]
v_mfma_f32_16x16x32_bf16 v[60:63], v[48:51], a[184:187], v[60:63]
ds_read_b128 v[40:43], v13 offset:53248
s_waitcnt lgkmcnt(2)
v_mfma_f32_16x16x32_bf16 v[64:67], v[48:51], a[188:191], v[64:67]
s_waitcnt lgkmcnt(4)
v_cvt_pk_bf16_f32 v96, 0, v88
v_mfma_f32_16x16x32_bf16 v[52:55], v[20:23], a[192:195], v[52:55]
ds_read_b128 v[44:47], v12 offset:55296
s_add_u32 m0, s21, 99328
v_mfma_f32_16x16x32_bf16 v[56:59], v[20:23], a[196:199], v[56:59]
buffer_load_dwordx4 v9, s[8:11], s20 offen lds
v_mfma_f32_16x16x32_bf16 v[60:63], v[24:27], a[192:195], v[60:63]
ds_read_b128 v[48:51], v13 offset:55296
v_cvt_pk_bf16_f32 v97, 0, v89
v_mfma_f32_16x16x32_bf16 v[64:67], v[24:27], a[196:199], v[64:67]
s_waitcnt lgkmcnt(4)
v_cvt_pk_bf16_f32 v98, 0, v90
v_mfma_f32_16x16x32_bf16 v[52:55], v[28:31], a[200:203], v[52:55]
ds_read_b128 v[20:23], v12 offset:57344
v_cvt_pk_bf16_f32 v99, 0, v91
v_mfma_f32_16x16x32_bf16 v[56:59], v[28:31], a[204:207], v[56:59]
buffer_store_dwordx4 v[96:99], v128, s[16:19], s43 offen
v_mfma_f32_16x16x32_bf16 v[60:63], v[32:35], a[200:203], v[60:63]
ds_read_b128 v[24:27], v13 offset:57344
v_mfma_f32_16x16x32_bf16 v[64:67], v[32:35], a[204:207], v[64:67]
s_waitcnt lgkmcnt(4)
v_mfma_f32_16x16x32_bf16 v[52:55], v[36:39], a[208:211], v[52:55]
ds_read_b128 v[28:31], v12 offset:59392
s_add_u32 m0, s21, 100352
v_mov_b32 v116, v68
v_mov_b32 v117, v72
v_mfma_f32_16x16x32_bf16 v[56:59], v[36:39], a[212:215], v[56:59]
buffer_load_dwordx4 v10, s[8:11], s20 offen lds
v_mov_b32 v118, v76
v_mov_b32 v119, v80
v_mfma_f32_16x16x32_bf16 v[60:63], v[40:43], a[208:211], v[60:63]
ds_read_b128 v[32:35], v13 offset:59392
s_mov_b32 s7, s38
s_add_u32 s39, s44, s31
s_sub_u32 s43, s22, 1
v_mfma_f32_16x16x32_bf16 v[64:67], v[40:43], a[212:215], v[64:67]
s_waitcnt lgkmcnt(4)
s_and_b32 s43, s43, 63
v_readlane_b32 s43, v129, s43
s_nop 0
v_mfma_f32_16x16x32_bf16 v[52:55], v[44:47], a[216:219], v[52:55]
ds_read_b128 v[36:39], v12 offset:61440
s_nop 0
s_sub_u32 s43, s43, 1
s_lshl_b32 s43, s43, 18
v_mfma_f32_16x16x32_bf16 v[56:59], v[44:47], a[220:223], v[56:59]
s_cmp_eq_u32 s37, 0
s_cselect_b32 s43, 0x7ff00000, s43
buffer_load_dwordx2 v[88:89], v112, s[12:15], s39 offen offset:0 sc1
v_mfma_f32_16x16x32_bf16 v[60:63], v[48:51], a[216:219], v[60:63]
ds_read_b128 v[40:43], v13 offset:61440
v_mfma_f32_16x16x32_bf16 v[64:67], v[48:51], a[220:223], v[64:67]
s_waitcnt lgkmcnt(4)
v_mfma_f32_16x16x32_bf16 v[52:55], v[20:23], a[224:227], v[52:55]
ds_read_b128 v[44:47], v12 offset:63488
s_add_u32 m0, s21, 101376
v_mfma_f32_16x16x32_bf16 v[56:59], v[20:23], a[228:231], v[56:59]
buffer_load_dwordx4 v11, s[8:11], s20 offen lds
v_mfma_f32_16x16x32_bf16 v[60:63], v[24:27], a[224:227], v[60:63]
ds_read_b128 v[48:51], v13 offset:63488
v_mfma_f32_16x16x32_bf16 v[64:67], v[24:27], a[228:231], v[64:67]
s_waitcnt lgkmcnt(4)
v_mfma_f32_16x16x32_bf16 v[52:55], v[28:31], a[232:235], v[52:55]
s_waitcnt vmcnt(12)
s_barrier
ds_read_b128 v[20:23], v16 offset:0
v_mfma_f32_16x16x32_bf16 v[56:59], v[28:31], a[236:239], v[56:59]
s_add_u32 s20, s20, 65536
buffer_load_dwordx2 v[90:91], v112, s[12:15], s39 offen offset:512 sc1
v_mfma_f32_16x16x32_bf16 v[60:63], v[32:35], a[232:235], v[60:63]
ds_read_b128 v[24:27], v17 offset:0
v_mfma_f32_16x16x32_bf16 v[64:67], v[32:35], a[236:239], v[64:67]
s_waitcnt lgkmcnt(4)
v_mfma_f32_16x16x32_bf16 v[52:55], v[36:39], a[240:243], v[52:55]
ds_read_b128 v[28:31], v16 offset:2048
s_add_u32 m0, s21, 114688
v_mfma_f32_16x16x32_bf16 v[56:59], v[36:39], a[244:247], v[56:59]
buffer_load_dwordx4 v8, s[8:11], s20 offen lds
v_mfma_f32_16x16x32_bf16 v[60:63], v[40:43], a[240:243], v[60:63]
ds_read_b128 v[32:35], v17 offset:2048
v_mfma_f32_16x16x32_bf16 v[64:67], v[40:43], a[244:247], v[64:67]
s_waitcnt lgkmcnt(4)
v_mfma_f32_16x16x32_bf16 v[52:55], v[44:47], a[248:251], v[52:55]
ds_read_b128 v[36:39], v16 offset:4096
v_mfma_f32_16x16x32_bf16 v[56:59], v[44:47], a[252:255], v[56:59]
buffer_load_dwordx2 v[92:93], v112, s[12:15], s39 offen offset:1024 sc1
v_mfma_f32_16x16x32_bf16 v[60:63], v[48:51], a[248:251], v[60:63]
ds_read_b128 v[40:43], v17 offset:4096
s_mov_b32 s37, 1
v_mfma_f32_16x16x32_bf16 v[64:67], v[48:51], a[252:255], v[64:67]
s_waitcnt lgkmcnt(4)
s_add_u32 s22, s22, 1
s_cmp_ge_u32 s22, s23
s_cbranch_scc1 L_fl0_525
v_mfma_f32_16x16x32_bf16 v[68:71], v[20:23], a[0:3], 0
ds_read_b128 v[44:47], v16 offset:6144
s_add_u32 m0, s21, 115712
s_cmp_lt_u32 s22, 57
s_cselect_b32 s27, 1, 0
s_cselect_b32 s26, 1, 0x80
v_mfma_f32_16x16x32_bf16 v[72:75], v[20:23], a[4:7], 0
buffer_load_dwordx4 v9, s[8:11], s20 offen lds
s_sub_u32 s38, s22, 1
v_mfma_f32_16x16x32_bf16 v[76:79], v[24:27], a[0:3], 0
ds_read_b128 v[48:51], v17 offset:6144
s_and_b32 s31, s38, 3
s_lshl_b32 s31, s31, 11
v_mfma_f32_16x16x32_bf16 v[80:83], v[24:27], a[4:7], 0
s_waitcnt lgkmcnt(4)
s_bfe_u32 s38, s38, 0x10002
v_mfma_f32_16x16x32_bf16 v[68:71], v[28:31], a[8:11], v[68:71]
ds_read_b128 v[20:23], v16 offset:8192
v_mov_b32 v131, s27
s_xor_b32 s38, s38, 1
v_mfma_f32_16x16x32_bf16 v[72:75], v[28:31], a[12:15], v[72:75]
buffer_atomic_add v131, v85, s[12:15], s95 offen sc0 sc1
v_mfma_f32_16x16x32_bf16 v[76:79], v[32:35], a[8:11], v[76:79]
ds_read_b128 v[24:27], v17 offset:8192
s_add_u32 s24, s24, 1
s_min_u32 s24, s24, s61
s_cmp_eq_u32 s37, 0
s_cselect_b32 s31, 0x40000000, s31
s_cselect_b32 s38, 0, s38
v_mfma_f32_16x16x32_bf16 v[80:83], v[32:35], a[12:15], v[80:83]
s_waitcnt lgkmcnt(4)
s_mov_b32 s30, s24
v_readlane_b32 s30, v129, s30
v_mfma_f32_16x16x32_bf16 v[68:71], v[36:39], a[16:19], v[68:71]
ds_read_b128 v[28:31], v16 offset:10240
s_add_u32 m0, s21, 116736
s_nop 0
v_mfma_f32_16x16x32_bf16 v[72:75], v[36:39], a[20:23], v[72:75]
buffer_load_dwordx4 v10, s[8:11], s20 offen lds
v_mfma_f32_16x16x32_bf16 v[76:79], v[40:43], a[16:19], v[76:79]
ds_read_b128 v[32:35], v17 offset:10240
s_nop 0
s_sub_u32 s30, s30, 1
v_mfma_f32_16x16x32_bf16 v[80:83], v[40:43], a[20:23], v[80:83]
s_waitcnt lgkmcnt(4)
s_bitcmp1_b32 s30, 1
s_cselect_b32 s53, s54, s55
v_mfma_f32_16x16x32_bf16 v[68:71], v[44:47], a[24:27], v[68:71]
ds_read_b128 v[36:39], v16 offset:12288
s_lshl_b32 s30, s30, 20
v_cvt_pk_bf16_f32 v104, v53, v57
v_mfma_f32_16x16x32_bf16 v[72:75], v[44:47], a[28:31], v[72:75]
s_add_u32 s53, s53, s30
buffer_load_dword v129, v130, s[12:15], s94 offen sc1
v_mfma_f32_16x16x32_bf16 v[76:79], v[48:51], a[24:27], v[76:79]
ds_read_b128 v[40:43], v17 offset:12288
s_add_u32 s53, s53, s50
s_waitcnt vmcnt(13)
v_cvt_pk_bf16_f32 v105, v61, v65
v_mfma_f32_16x16x32_bf16 v[80:83], v[48:51], a[28:31], v[80:83]
s_waitcnt lgkmcnt(4)
v_readfirstlane_b32 s30, v87
s_nop 0
v_mfma_f32_16x16x32_bf16 v[68:71], v[20:23], a[32:35], v[68:71]
ds_read_b128 v[44:47], v16 offset:14336
s_add_u32 m0, s21, 117760
v_and_or_b32 v104, v104, -2, s38
v_mfma_f32_16x16x32_bf16 v[72:75], v[20:23], a[36:39], v[72:75]
buffer_load_dwordx4 v11, s[8:11], s20 offen lds
s_nop 0
v_mfma_f32_16x16x32_bf16 v[76:79], v[24:27], a[32:35], v[76:79]
ds_read_b128 v[48:51], v17 offset:14336
s_cmp_lt_u32 s30, 8
s_cbranch_scc1 L_gw_540
L_gok_539:
v_mfma_f32_16x16x32_bf16 v[80:83], v[24:27], a[36:39], v[80:83]
s_waitcnt lgkmcnt(4)
v_and_or_b32 v105, v105, -2, s38
s_add_u32 s29, s45, s31
v_mfma_f32_16x16x32_bf16 v[68:71], v[28:31], a[40:43], v[68:71]
s_waitcnt vmcnt(15)
s_barrier
ds_read_b128 v[20:23], v16 offset:16384
v_mfma_f32_16x16x32_bf16 v[72:75], v[28:31], a[44:47], v[72:75]
s_mov_b32 s20, s53
buffer_store_dwordx2 v[104:105], v112, s[12:15], s29 offen offset:0 sc1
v_mfma_f32_16x16x32_bf16 v[76:79], v[32:35], a[40:43], v[76:79]
ds_read_b128 v[24:27], v17 offset:16384
v_cvt_pk_bf16_f32 v106, v54, v58
v_mfma_f32_16x16x32_bf16 v[80:83], v[32:35], a[44:47], v[80:83]
s_waitcnt lgkmcnt(4)
v_cvt_pk_bf16_f32 v107, v62, v66
v_mfma_f32_16x16x32_bf16 v[68:71], v[36:39], a[48:51], v[68:71]
ds_read_b128 v[28:31], v16 offset:18432
s_add_u32 m0, s21, 0
v_mfma_f32_16x16x32_bf16 v[72:75], v[36:39], a[52:55], v[72:75]
buffer_load_dwordx4 v8, s[8:11], s20 offen lds
v_mfma_f32_16x16x32_bf16 v[76:79], v[40:43], a[48:51], v[76:79]
ds_read_b128 v[32:35], v17 offset:18432
v_and_or_b32 v106, v106, -2, s38
v_mfma_f32_16x16x32_bf16 v[80:83], v[40:43], a[52:55], v[80:83]
s_waitcnt lgkmcnt(4)
v_and_or_b32 v107, v107, -2, s38
v_mfma_f32_16x16x32_bf16 v[68:71], v[44:47], a[56:59], v[68:71]
ds_read_b128 v[36:39], v16 offset:20480
s_add_u32 s29, s46, s31
v_mfma_f32_16x16x32_bf16 v[72:75], v[44:47], a[60:63], v[72:75]
buffer_store_dwordx2 v[106:107], v112, s[12:15], s29 offen offset:512 sc1
v_mfma_f32_16x16x32_bf16 v[76:79], v[48:51], a[56:59], v[76:79]
ds_read_b128 v[40:43], v17 offset:20480
v_cvt_pk_bf16_f32 v108, v55, v59
v_mfma_f32_16x16x32_bf16 v[80:83], v[48:51], a[60:63], v[80:83]
s_waitcnt lgkmcnt(4)
v_cvt_pk_bf16_f32 v109, v63, v67
v_mfma_f32_16x16x32_bf16 v[68:71], v[20:23], a[64:67], v[68:71]
ds_read_b128 v[44:47], v16 offset:22528
s_add_u32 m0, s21, 1024
v_mfma_f32_16x16x32_bf16 v[72:75], v[20:23], a[68:71], v[72:75]
buffer_load_dwordx4 v9, s[8:11], s20 offen lds
v_mfma_f32_16x16x32_bf16 v[76:79], v[24:27], a[64:67], v[76:79]
ds_read_b128 v[48:51], v17 offset:22528
v_and_or_b32 v108, v108, -2, s38
v_mfma_f32_16x16x32_bf16 v[80:83], v[24:27], a[68:71], v[80:83]
s_waitcnt lgkmcnt(4)
v_and_or_b32 v109, v109, -2, s38
v_mfma_f32_16x16x32_bf16 v[68:71], v[28:31], a[72:75], v[68:71]
ds_read_b128 v[20:23], v16 offset:24576
s_add_u32 s29, s47, s31
v_mfma_f32_16x16x32_bf16 v[72:75], v[28:31], a[76:79], v[72:75]
buffer_store_dwordx2 v[108:109], v112, s[12:15], s29 offen offset:1024 sc1
v_mfma_f32_16x16x32_bf16 v[76:79], v[32:35], a[72:75], v[76:79]
ds_read_b128 v[24:27], v17 offset:24576
v_mfma_f32_16x16x32_bf16 v[80:83], v[32:35], a[76:79], v[80:83]
s_waitcnt lgkmcnt(4)
v_mfma_f32_16x16x32_bf16 v[68:71], v[36:39], a[80:83], v[68:71]
ds_read_b128 v[28:31], v16 offset:26624
s_add_u32 m0, s21, 2048
v_mfma_f32_16x16x32_bf16 v[72:75], v[36:39], a[84:87], v[72:75]
buffer_load_dwordx4 v10, s[8:11], s20 offen lds
v_mfma_f32_16x16x32_bf16 v[76:79], v[40:43], a[80:83], v[76:79]
ds_read_b128 v[32:35], v17 offset:26624
v_mfma_f32_16x16x32_bf16 v[80:83], v[40:43], a[84:87], v[80:83]
s_waitcnt lgkmcnt(4)
v_mfma_f32_16x16x32_bf16 v[68:71], v[44:47], a[88:91], v[68:71]
ds_read_b128 v[36:39], v16 offset:28672
v_mfma_f32_16x16x32_bf16 v[72:75], v[44:47], a[92:95], v[72:75]
v_mfma_f32_16x16x32_bf16 v[76:79], v[48:51], a[88:91], v[76:79]
ds_read_b128 v[40:43], v17 offset:28672
v_mfma_f32_16x16x32_bf16 v[80:83], v[48:51], a[92:95], v[80:83]
s_waitcnt lgkmcnt(4)
v_mfma_f32_16x16x32_bf16 v[68:71], v[20:23], a[96:99], v[68:71]
ds_read_b128 v[44:47], v16 offset:30720
s_add_u32 m0, s21, 3072
v_mfma_f32_16x16x32_bf16 v[72:75], v[20:23], a[100:103], v[72:75]
buffer_load_dwordx4 v11, s[8:11], s20 offen lds
v_mfma_f32_16x16x32_bf16 v[76:79], v[24:27], a[96:99], v[76:79]
ds_read_b128 v[48:51], v17 offset:30720
v_mfma_f32_16x16x32_bf16 v[80:83], v[24:27], a[100:103], v[80:83]
s_waitcnt lgkmcnt(4)
v_mfma_f32_16x16x32_bf16 v[68:71], v[28:31], a[104:107], v[68:71]
s_waitcnt vmcnt(15)
s_barrier
ds_read_b128 v[20:23], v16 offset:32768
v_mfma_f32_16x16x32_bf16 v[72:75], v[28:31], a[108:111], v[72:75]
s_add_u32 s20, s20, 65536
v_mfma_f32_16x16x32_bf16 v[76:79], v[32:35], a[104:107], v[76:79]
ds_read_b128 v[24:27], v17 offset:32768
v_mfma_f32_16x16x32_bf16 v[80:83], v[32:35], a[108:111], v[80:83]
s_waitcnt lgkmcnt(4)
v_mfma_f32_16x16x32_bf16 v[68:71], v[36:39], a[112:115], v[68:71]
ds_read_b128 v[28:31], v16 offset:34816
s_add_u32 m0, s21, 16384
s_waitcnt vmcnt(12)
v_xor_b32 v124, s7, v88
v_mfma_f32_16x16x32_bf16 v[72:75], v[36:39], a[116:119], v[72:75]
buffer_load_dwordx4 v8, s[8:11], s20 offen lds
v_bitop3_b32 v124, v124, v89, s7 bitop3:0xf6
v_mfma_f32_16x16x32_bf16 v[76:79], v[40:43], a[112:115], v[76:79]
ds_read_b128 v[32:35], v17 offset:34816
v_bitop3_b32 v124, v124, v90, s7 bitop3:0xf6
v_bitop3_b32 v124, v124, v91, s7 bitop3:0xf6
v_mfma_f32_16x16x32_bf16 v[80:83], v[40:43], a[116:119], v[80:83]
s_waitcnt lgkmcnt(4)
v_bitop3_b32 v124, v124, v92, s7 bitop3:0xf6
v_bitop3_b32 v124, v124, v93, s7 bitop3:0xf6
v_mfma_f32_16x16x32_bf16 v[68:71], v[44:47], a[120:123], v[68:71]
ds_read_b128 v[36:39], v16 offset:36864
s_lshl_b32 s27, s22, 2
v_and_b32 v124, 1, v124
v_cmp_ne_u32 vcc, 0, v124
v_mfma_f32_16x16x32_bf16 v[72:75], v[44:47], a[124:127], v[72:75]
s_add_u32 s3, s22, 2
s_waitcnt vmcnt(9)
s_nop 0
v_mfma_f32_16x16x32_bf16 v[76:79], v[48:51], a[120:123], v[76:79]
ds_read_b128 v[40:43], v17 offset:36864
v_readlane_b32 s28, v129, s3
s_nop 0
s_nop 0
v_mfma_f32_16x16x32_bf16 v[80:83], v[48:51], a[124:127], v[80:83]
s_waitcnt lgkmcnt(4)
s_nop 0
s_cbranch_vccnz L_rbad_535
L_rok_536:
v_mfma_f32_16x16x32_bf16 v[68:71], v[20:23], a[128:131], v[68:71]
ds_read_b128 v[44:47], v16 offset:38912
s_add_u32 m0, s21, 17408
v_mfma_f32_16x16x32_bf16 v[72:75], v[20:23], a[132:135], v[72:75]
buffer_load_dwordx4 v9, s[8:11], s20 offen lds
s_nop 0
v_lshlrev_b32 v124, 16, v88
v_mfma_f32_16x16x32_bf16 v[76:79], v[24:27], a[128:131], v[76:79]
ds_read_b128 v[48:51], v17 offset:38912
s_cmp_eq_u32 s28, 0
s_cbranch_scc1 L_sw_538
L_sok_537:
v_mfma_f32_16x16x32_bf16 v[80:83], v[24:27], a[132:135], v[80:83]
s_waitcnt lgkmcnt(4)
s_add_u32 s27, s27, s60
v_and_b32 v125, 0xffff0000, v88
v_mfma_f32_16x16x32_bf16 v[68:71], v[28:31], a[136:139], v[68:71]
ds_read_b128 v[20:23], v16 offset:40960
s_waitcnt vmcnt(12)
v_and_b32 v124, 0xfffe0000, v124
v_add_f32 v96, v116, v124
v_mfma_f32_16x16x32_bf16 v[72:75], v[28:31], a[140:143], v[72:75]
s_cmp_gt_u32 s28, 62
s_cselect_b32 s3, s3, 64
v_add_f32 v97, v117, v125
v_mfma_f32_16x16x32_bf16 v[76:79], v[32:35], a[136:139], v[76:79]
ds_read_b128 v[24:27], v17 offset:40960
v_add_u32 v131, s26, v131
v_lshlrev_b32 v124, 16, v89
v_and_b32 v125, 0xffff0000, v89
v_mfma_f32_16x16x32_bf16 v[80:83], v[32:35], a[140:143], v[80:83]
s_waitcnt lgkmcnt(4)
s_min_u32 s23, s23, s3
v_and_b32 v124, 0xfffe0000, v124
v_mfma_f32_16x16x32_bf16 v[68:71], v[36:39], a[144:147], v[68:71]
ds_read_b128 v[28:31], v16 offset:43008
s_add_u32 m0, s21, 18432
s_sub_u32 s61, s23, 1
v_add_f32 v98, v118, v124
v_mfma_f32_16x16x32_bf16 v[72:75], v[36:39], a[148:151], v[72:75]
buffer_load_dwordx4 v10, s[8:11], s20 offen lds
v_add_f32 v99, v119, v125
v_mfma_f32_16x16x32_bf16 v[76:79], v[40:43], a[144:147], v[76:79]
ds_read_b128 v[32:35], v17 offset:43008
s_add_u32 s51, s24, 1
v_lshlrev_b32 v124, 16, v90
v_mfma_f32_16x16x32_bf16 v[80:83], v[40:43], a[148:151], v[80:83]
s_waitcnt lgkmcnt(4)
s_min_u32 s51, s51, s61
v_and_b32 v125, 0xffff0000, v90
v_and_b32 v124, 0xfffe0000, v124
v_mfma_f32_16x16x32_bf16 v[68:71], v[44:47], a[152:155], v[68:71]
ds_read_b128 v[36:39], v16 offset:45056
v_readlane_b32 s51, v129, s51
v_add_f32 v96, v96, v124
v_mfma_f32_16x16x32_bf16 v[72:75], v[44:47], a[156:159], v[72:75]
s_nop 0
buffer_store_dword v131, v85, s[12:15], s27 offen offset:12 sc1
v_add_f32 v97, v97, v125
v_mfma_f32_16x16x32_bf16 v[76:79], v[48:51], a[152:155], v[76:79]
ds_read_b128 v[40:43], v17 offset:45056
s_nop 0
v_lshlrev_b32 v124, 16, v91
v_mfma_f32_16x16x32_bf16 v[80:83], v[48:51], a[156:159], v[80:83]
s_waitcnt lgkmcnt(4)
s_sub_u32 s51, s51, 1
v_and_b32 v125, 0xffff0000, v91
v_and_b32 v124, 0xfffe0000, v124
v_mfma_f32_16x16x32_bf16 v[68:71], v[20:23], a[160:163], v[68:71]
ds_read_b128 v[44:47], v16 offset:47104
s_add_u32 m0, s21, 19456
v_add_f32 v98, v98, v124
v_mfma_f32_16x16x32_bf16 v[72:75], v[20:23], a[164:167], v[72:75]
buffer_load_dwordx4 v11, s[8:11], s20 offen lds
s_lshl_b32 s51, s51, 9
v_add_f32 v99, v99, v125
v_mfma_f32_16x16x32_bf16 v[76:79], v[24:27], a[160:163], v[76:79]
ds_read_b128 v[48:51], v17 offset:47104
s_add_u32 s51, s51, s48
v_lshlrev_b32 v124, 16, v92
v_mfma_f32_16x16x32_bf16 v[80:83], v[24:27], a[164:167], v[80:83]
s_waitcnt lgkmcnt(4)
v_and_b32 v125, 0xffff0000, v92
v_and_b32 v124, 0xfffe0000, v124
v_mfma_f32_16x16x32_bf16 v[68:71], v[28:31], a[168:171], v[68:71]
s_waitcnt vmcnt(12)
s_barrier
ds_read_b128 v[20:23], v16 offset:49152
v_add_f32 v96, v96, v124
v_mfma_f32_16x16x32_bf16 v[72:75], v[28:31], a[172:175], v[72:75]
s_add_u32 s20, s20, 65536
buffer_load_dword v87, v4, s[12:15], s51 offen sc1
v_add_f32 v97, v97, v125
v_mfma_f32_16x16x32_bf16 v[76:79], v[32:35], a[168:171], v[76:79]
ds_read_b128 v[24:27], v17 offset:49152
v_lshlrev_b32 v124, 16, v93
v_and_b32 v125, 0xffff0000, v93
v_mfma_f32_16x16x32_bf16 v[80:83], v[32:35], a[172:175], v[80:83]
s_waitcnt lgkmcnt(4)
v_and_b32 v124, 0xfffe0000, v124
v_add_f32 v98, v98, v124
v_mfma_f32_16x16x32_bf16 v[68:71], v[36:39], a[176:179], v[68:71]
ds_read_b128 v[28:31], v16 offset:51200
s_add_u32 m0, s21, 32768
v_add_f32 v99, v99, v125
v_mfma_f32_16x16x32_bf16 v[72:75], v[36:39], a[180:183], v[72:75]
buffer_load_dwordx4 v8, s[8:11], s20 offen lds
ds_write2_b32 v114, v96, v97 offset0:0 offset1:16
v_mfma_f32_16x16x32_bf16 v[76:79], v[40:43], a[176:179], v[76:79]
ds_read_b128 v[32:35], v17 offset:51200
ds_write2_b32 v114, v98, v99 offset0:128 offset1:144
ds_read_b128 v[88:91], v113 offset:0
v_mfma_f32_16x16x32_bf16 v[80:83], v[40:43], a[180:183], v[80:83]
s_waitcnt lgkmcnt(4)
v_mfma_f32_16x16x32_bf16 v[68:71], v[44:47], a[184:187], v[68:71]
ds_read_b128 v[36:39], v16 offset:53248
v_mfma_f32_16x16x32_bf16 v[72:75], v[44:47], a[188:191], v[72:75]
v_mfma_f32_16x16x32_bf16 v[76:79], v[48:51], a[184:187], v[76:79]
ds_read_b128 v[40:43], v17 offset:53248
s_waitcnt lgkmcnt(2)
v_mfma_f32_16x16x32_bf16 v[80:83], v[48:51], a[188:191], v[80:83]
s_waitcnt lgkmcnt(4)
v_cvt_pk_bf16_f32 v96, 0, v88
v_mfma_f32_16x16x32_bf16 v[68:71], v[20:23], a[192:195], v[68:71]
ds_read_b128 v[44:47], v16 offset:55296
s_add_u32 m0, s21, 33792
v_mfma_f32_16x16x32_bf16 v[72:75], v[20:23], a[196:199], v[72:75]
buffer_load_dwordx4 v9, s[8:11], s20 offen lds
v_mfma_f32_16x16x32_bf16 v[76:79], v[24:27], a[192:195], v[76:79]
ds_read_b128 v[48:51], v17 offset:55296
v_cvt_pk_bf16_f32 v97, 0, v89
v_mfma_f32_16x16x32_bf16 v[80:83], v[24:27], a[196:199], v[80:83]
s_waitcnt lgkmcnt(4)
v_cvt_pk_bf16_f32 v98, 0, v90
v_mfma_f32_16x16x32_bf16 v[68:71], v[28:31], a[200:203], v[68:71]
ds_read_b128 v[20:23], v16 offset:57344
v_cvt_pk_bf16_f32 v99, 0, v91
v_mfma_f32_16x16x32_bf16 v[72:75], v[28:31], a[204:207], v[72:75]
buffer_store_dwordx4 v[96:99], v128, s[16:19], s43 offen
v_mfma_f32_16x16x32_bf16 v[76:79], v[32:35], a[200:203], v[76:79]
ds_read_b128 v[24:27], v17 offset:57344
v_mfma_f32_16x16x32_bf16 v[80:83], v[32:35], a[204:207], v[80:83]
s_waitcnt lgkmcnt(4)
v_mfma_f32_16x16x32_bf16 v[68:71], v[36:39], a[208:211], v[68:71]
ds_read_b128 v[28:31], v16 offset:59392
s_add_u32 m0, s21, 34816
v_mov_b32 v116, v52
v_mov_b32 v117, v56
v_mfma_f32_16x16x32_bf16 v[72:75], v[36:39], a[212:215], v[72:75]
buffer_load_dwordx4 v10, s[8:11], s20 offen lds
v_mov_b32 v118, v60
v_mov_b32 v119, v64
v_mfma_f32_16x16x32_bf16 v[76:79], v[40:43], a[208:211], v[76:79]
ds_read_b128 v[32:35], v17 offset:59392
s_mov_b32 s7, s38
s_add_u32 s39, s44, s31
s_sub_u32 s43, s22, 1
v_mfma_f32_16x16x32_bf16 v[80:83], v[40:43], a[212:215], v[80:83]
s_waitcnt lgkmcnt(4)
s_and_b32 s43, s43, 63
v_readlane_b32 s43, v129, s43
s_nop 0
v_mfma_f32_16x16x32_bf16 v[68:71], v[44:47], a[216:219], v[68:71]
ds_read_b128 v[36:39], v16 offset:61440
s_nop 0
s_sub_u32 s43, s43, 1
s_lshl_b32 s43, s43, 18
v_mfma_f32_16x16x32_bf16 v[72:75], v[44:47], a[220:223], v[72:75]
s_cmp_eq_u32 s37, 0
s_cselect_b32 s43, 0x7ff00000, s43
buffer_load_dwordx2 v[88:89], v112, s[12:15], s39 offen offset:0 sc1
v_mfma_f32_16x16x32_bf16 v[76:79], v[48:51], a[216:219], v[76:79]
ds_read_b128 v[40:43], v17 offset:61440
v_mfma_f32_16x16x32_bf16 v[80:83], v[48:51], a[220:223], v[80:83]
s_waitcnt lgkmcnt(4)
v_mfma_f32_16x16x32_bf16 v[68:71], v[20:23], a[224:227], v[68:71]
ds_read_b128 v[44:47], v16 offset:63488
s_add_u32 m0, s21, 35840
v_mfma_f32_16x16x32_bf16 v[72:75], v[20:23], a[228:231], v[72:75]
buffer_load_dwordx4 v11, s[8:11], s20 offen lds
v_mfma_f32_16x16x32_bf16 v[76:79], v[24:27], a[224:227], v[76:79]
ds_read_b128 v[48:51], v17 offset:63488
v_mfma_f32_16x16x32_bf16 v[80:83], v[24:27], a[228:231], v[80:83]
s_waitcnt lgkmcnt(4)
v_mfma_f32_16x16x32_bf16 v[68:71], v[28:31], a[232:235], v[68:71]
s_waitcnt vmcnt(12)
s_barrier
ds_read_b128 v[20:23], v12 offset:0
v_mfma_f32_16x16x32_bf16 v[72:75], v[28:31], a[236:239], v[72:75]
s_add_u32 s20, s20, 65536
buffer_load_dwordx2 v[90:91], v112, s[12:15], s39 offen offset:512 sc1
v_mfma_f32_16x16x32_bf16 v[76:79], v[32:35], a[232:235], v[76:79]
ds_read_b128 v[24:27], v13 offset:0
v_mfma_f32_16x16x32_bf16 v[80:83], v[32:35], a[236:239], v[80:83]
s_waitcnt lgkmcnt(4)
v_mfma_f32_16x16x32_bf16 v[68:71], v[36:39], a[240:243], v[68:71]
ds_read_b128 v[28:31], v12 offset:2048
s_add_u32 m0, s21, 49152
v_mfma_f32_16x16x32_bf16 v[72:75], v[36:39], a[244:247], v[72:75]
buffer_load_dwordx4 v8, s[8:11], s20 offen lds
v_mfma_f32_16x16x32_bf16 v[76:79], v[40:43], a[240:243], v[76:79]
ds_read_b128 v[32:35], v13 offset:2048
v_mfma_f32_16x16x32_bf16 v[80:83], v[40:43], a[244:247], v[80:83]
s_waitcnt lgkmcnt(4)
v_mfma_f32_16x16x32_bf16 v[68:71], v[44:47], a[248:251], v[68:71]
ds_read_b128 v[36:39], v12 offset:4096
v_mfma_f32_16x16x32_bf16 v[72:75], v[44:47], a[252:255], v[72:75]
buffer_load_dwordx2 v[92:93], v112, s[12:15], s39 offen offset:1024 sc1
v_mfma_f32_16x16x32_bf16 v[76:79], v[48:51], a[248:251], v[76:79]
ds_read_b128 v[40:43], v13 offset:4096
s_mov_b32 s37, 1
v_mfma_f32_16x16x32_bf16 v[80:83], v[48:51], a[252:255], v[80:83]
s_waitcnt lgkmcnt(4)
s_add_u32 s22, s22, 1
s_cmp_ge_u32 s22, s23
s_cbranch_scc0 L_st_528
L_fl1_526:
s_waitcnt lgkmcnt(0)
s_nop 7
s_sub_u32 s38, s22, 1
s_and_b32 s31, s38, 3
s_lshl_b32 s31, s31, 11
s_bfe_u32 s38, s38, 0x10002
s_xor_b32 s38, s38, 1
s_cmp_eq_u32 s37, 0
s_cselect_b32 s31, 0x40000000, s31
s_cselect_b32 s38, 0, s38
v_cvt_pk_bf16_f32 v104, v69, v73
v_cvt_pk_bf16_f32 v105, v77, v81
v_and_or_b32 v104, v104, -2, s38
v_and_or_b32 v105, v105, -2, s38
s_add_u32 s29, s45, s31
buffer_store_dwordx2 v[104:105], v112, s[12:15], s29 offen offset:0 sc1
v_cvt_pk_bf16_f32 v106, v70, v74
v_cvt_pk_bf16_f32 v107, v78, v82
v_and_or_b32 v106, v106, -2, s38
v_and_or_b32 v107, v107, -2, s38
s_add_u32 s29, s46, s31
buffer_store_dwordx2 v[106:107], v112, s[12:15], s29 offen offset:512 sc1
v_cvt_pk_bf16_f32 v108, v71, v75
v_cvt_pk_bf16_f32 v109, v79, v83
v_and_or_b32 v108, v108, -2, s38
v_and_or_b32 v109, v109, -2, s38
s_add_u32 s29, s47, s31
buffer_store_dwordx2 v[108:109], v112, s[12:15], s29 offen offset:1024 sc1
s_waitcnt vmcnt(0)
v_xor_b32 v124, s7, v88
v_bitop3_b32 v124, v124, v89, s7 bitop3:0xf6
v_bitop3_b32 v124, v124, v90, s7 bitop3:0xf6
v_bitop3_b32 v124, v124, v91, s7 bitop3:0xf6
v_bitop3_b32 v124, v124, v92, s7 bitop3:0xf6
v_bitop3_b32 v124, v124, v93, s7 bitop3:0xf6
v_and_b32 v124, 1, v124
v_cmp_ne_u32 vcc, 0, v124
s_nop 0
s_nop 0
s_nop 0
s_cbranch_vccnz L_rbad_541
L_rok_542:
v_lshlrev_b32 v124, 16, v88
v_and_b32 v125, 0xffff0000, v88
v_and_b32 v124, 0xfffe0000, v124
v_add_f32 v96, v116, v124
v_add_f32 v97, v117, v125
v_lshlrev_b32 v124, 16, v89
v_and_b32 v125, 0xffff0000, v89
v_and_b32 v124, 0xfffe0000, v124
v_add_f32 v98, v118, v124
v_add_f32 v99, v119, v125
v_lshlrev_b32 v124, 16, v90
v_and_b32 v125, 0xffff0000, v90
v_and_b32 v124, 0xfffe0000, v124
v_add_f32 v96, v96, v124
v_add_f32 v97, v97, v125
v_lshlrev_b32 v124, 16, v91
v_and_b32 v125, 0xffff0000, v91
v_and_b32 v124, 0xfffe0000, v124
v_add_f32 v98, v98, v124
v_add_f32 v99, v99, v125
v_lshlrev_b32 v124, 16, v92
v_and_b32 v125, 0xffff0000, v92
v_and_b32 v124, 0xfffe0000, v124
v_add_f32 v96, v96, v124
v_add_f32 v97, v97, v125
v_lshlrev_b32 v124, 16, v93
v_and_b32 v125, 0xffff0000, v93
v_and_b32 v124, 0xfffe0000, v124
v_add_f32 v98, v98, v124
v_add_f32 v99, v99, v125
ds_write2_b32 v114, v96, v97 offset0:0 offset1:16
ds_write2_b32 v114, v98, v99 offset0:128 offset1:144
ds_read_b128 v[88:91], v113 offset:0
s_waitcnt lgkmcnt(0)
v_cvt_pk_bf16_f32 v96, 0, v88
v_cvt_pk_bf16_f32 v97, 0, v89
v_cvt_pk_bf16_f32 v98, 0, v90
v_cvt_pk_bf16_f32 v99, 0, v91
buffer_store_dwordx4 v[96:99], v128, s[16:19], s43 offen
v_mov_b32 v116, v68
v_mov_b32 v117, v72
v_mov_b32 v118, v76
v_mov_b32 v119, v80
s_mov_b32 s7, s38
s_add_u32 s39, s44, s31
s_sub_u32 s43, s22, 1
s_and_b32 s43, s43, 63
v_readlane_b32 s43, v129, s43
s_nop 0
s_nop 0
s_sub_u32 s43, s43, 1
s_lshl_b32 s43, s43, 18
s_cmp_eq_u32 s37, 0
s_cselect_b32 s43, 0x7ff00000, s43
buffer_load_dwordx2 v[88:89], v112, s[12:15], s39 offen offset:0 sc1
buffer_load_dwordx2 v[90:91], v112, s[12:15], s39 offen offset:512 sc1
buffer_load_dwordx2 v[92:93], v112, s[12:15], s39 offen offset:1024 sc1
s_mov_b32 s37, 1
s_waitcnt vmcnt(0)
v_xor_b32 v124, s7, v88
v_bitop3_b32 v124, v124, v89, s7 bitop3:0xf6
v_bitop3_b32 v124, v124, v90, s7 bitop3:0xf6
v_bitop3_b32 v124, v124, v91, s7 bitop3:0xf6
v_bitop3_b32 v124, v124, v92, s7 bitop3:0xf6
v_bitop3_b32 v124, v124, v93, s7 bitop3:0xf6
v_and_b32 v124, 1, v124
v_cmp_ne_u32 vcc, 0, v124
s_nop 0
s_nop 0
s_nop 0
s_cbranch_vccnz L_rbad_543
L_rok_544:
v_lshlrev_b32 v124, 16, v88
v_and_b32 v125, 0xffff0000, v88
v_and_b32 v124, 0xfffe0000, v124
v_add_f32 v96, v116, v124
v_add_f32 v97, v117, v125
v_lshlrev_b32 v124, 16, v89
v_and_b32 v125, 0xffff0000, v89
v_and_b32 v124, 0xfffe0000, v124
v_add_f32 v98, v118, v124
v_add_f32 v99, v119, v125
v_lshlrev_b32 v124, 16, v90
v_and_b32 v125, 0xffff0000, v90
v_and_b32 v124, 0xfffe0000, v124
v_add_f32 v96, v96, v124
v_add_f32 v97, v97, v125
v_lshlrev_b32 v124, 16, v91
v_and_b32 v125, 0xffff0000, v91
v_and_b32 v124, 0xfffe0000, v124
v_add_f32 v98, v98, v124
v_add_f32 v99, v99, v125
v_lshlrev_b32 v124, 16, v92
v_and_b32 v125, 0xffff0000, v92
v_and_b32 v124, 0xfffe0000, v124
v_add_f32 v96, v96, v124
v_add_f32 v97, v97, v125
v_lshlrev_b32 v124, 16, v93
v_and_b32 v125, 0xffff0000, v93
v_and_b32 v124, 0xfffe0000, v124
v_add_f32 v98, v98, v124
v_add_f32 v99, v99, v125
ds_write2_b32 v114, v96, v97 offset0:0 offset1:16
ds_write2_b32 v114, v98, v99 offset0:128 offset1:144
ds_read_b128 v[88:91], v113 offset:0
s_waitcnt lgkmcnt(0)
v_cvt_pk_bf16_f32 v96, 0, v88
v_cvt_pk_bf16_f32 v97, 0, v89
v_cvt_pk_bf16_f32 v98, 0, v90
v_cvt_pk_bf16_f32 v99, 0, v91
buffer_store_dwordx4 v[96:99], v128, s[16:19], s43 offen
s_branch L_ste_527
L_rbad_529:
buffer_load_dwordx2 v[88:89], v112, s[12:15], s39 offen offset:0 sc1
buffer_load_dwordx2 v[90:91], v112, s[12:15], s39 offen offset:512 sc1
buffer_load_dwordx2 v[92:93], v112, s[12:15], s39 offen offset:1024 sc1
s_add_u32 s36, s36, 1
s_cmp_gt_u32 s36, 0x100000
s_cbranch_scc1 chain_kernel_wend
s_waitcnt vmcnt(0)
v_xor_b32 v124, s7, v88
v_bitop3_b32 v124, v124, v89, s7 bitop3:0xf6
v_bitop3_b32 v124, v124, v90, s7 bitop3:0xf6
v_bitop3_b32 v124, v124, v91, s7 bitop3:0xf6
v_bitop3_b32 v124, v124, v92, s7 bitop3:0xf6
v_bitop3_b32 v124, v124, v93, s7 bitop3:0xf6
v_and_b32 v124, 1, v124
v_cmp_ne_u32 vcc, 0, v124
s_cbranch_vccnz L_rbad_529
s_branch L_rok_530
L_sw_532:
buffer_load_dword v129, v130, s[12:15], s94 offen sc1
s_add_u32 s36, s36, 1
s_cmp_gt_u32 s36, 0x100000
s_cbranch_scc1 chain_kernel_wend
s_waitcnt vmcnt(0)
v_readlane_b32 s28, v129, s3
s_cmp_lg_u32 s28, 0
s_cbranch_scc1 L_sok_531
s_sleep 1
s_branch L_sw_532
L_gw_534:
buffer_load_dword v87, v4, s[12:15], s51 offen sc1
s_add_u32 s36, s36, 1
s_cmp_gt_u32 s36, 0x100000
s_cbranch_scc1 chain_kernel_wend
s_waitcnt vmcnt(0)
v_readfirstlane_b32 s30, v87
s_cmp_lt_u32 s30, 8
s_cbranch_scc0 L_gok_533
s_sleep 1
s_branch L_gw_534
L_rbad_535:
buffer_load_dwordx2 v[88:89], v112, s[12:15], s39 offen offset:0 sc1
buffer_load_dwordx2 v[90:91], v112, s[12:15], s39 offen offset:512 sc1
buffer_load_dwordx2 v[92:93], v112, s[12:15], s39 offen offset:1024 sc1
s_add_u32 s36, s36, 1
s_cmp_gt_u32 s36, 0x100000
s_cbranch_scc1 chain_kernel_wend
s_waitcnt vmcnt(0)
v_xor_b32 v124, s7, v88
v_bitop3_b32 v124, v124, v89, s7 bitop3:0xf6
v_bitop3_b32 v124, v124, v90, s7 bitop3:0xf6
v_bitop3_b32 v124, v124, v91, s7 bitop3:0xf6
v_bitop3_b32 v124, v124, v92, s7 bitop3:0xf6
v_bitop3_b32 v124, v124, v93, s7 bitop3:0xf6
v_and_b32 v124, 1, v124
v_cmp_ne_u32 vcc, 0, v124
s_cbranch_vccnz L_rbad_535
s_branch L_rok_536
L_sw_538:
buffer_load_dword v129, v130, s[12:15], s94 offen sc1
s_add_u32 s36, s36, 1
s_cmp_gt_u32 s36, 0x100000
s_cbranch_scc1 chain_kernel_wend
s_waitcnt vmcnt(0)
v_readlane_b32 s28, v129, s3
s_cmp_lg_u32 s28, 0
s_cbranch_scc1 L_sok_537
s_sleep 1
s_branch L_sw_538
L_gw_540:
buffer_load_dword v87, v4, s[12:15], s51 offen sc1
s_add_u32 s36, s36, 1
s_cmp_gt_u32 s36, 0x100000
s_cbranch_scc1 chain_kernel_wend
s_waitcnt vmcnt(0)
v_readfirstlane_b32 s30, v87
s_cmp_lt_u32 s30, 8
s_cbranch_scc0 L_gok_539
s_sleep 1
s_branch L_gw_540
L_rbad_541:
buffer_load_dwordx2 v[88:89], v112, s[12:15], s39 offen offset:0 sc1
buffer_load_dwordx2 v[90:91], v112, s[12:15], s39 offen offset:512 sc1
buffer_load_dwordx2 v[92:93], v112, s[12:15], s39 offen offset:1024 sc1
s_add_u32 s36, s36, 1
s_cmp_gt_u32 s36, 0x100000
s_cbranch_scc1 chain_kernel_wend
s_waitcnt vmcnt(0)
v_xor_b32 v124, s7, v88
v_bitop3_b32 v124, v124, v89, s7 bitop3:0xf6
v_bitop3_b32 v124, v124, v90, s7 bitop3:0xf6
v_bitop3_b32 v124, v124, v91, s7 bitop3:0xf6
v_bitop3_b32 v124, v124, v92, s7 bitop3:0xf6
v_bitop3_b32 v124, v124, v93, s7 bitop3:0xf6
v_and_b32 v124, 1, v124
v_cmp_ne_u32 vcc, 0, v124
s_cbranch_vccnz L_rbad_541
s_branch L_rok_542
L_rbad_543:
buffer_load_dwordx2 v[88:89], v112, s[12:15], s39 offen offset:0 sc1
buffer_load_dwordx2 v[90:91], v112, s[12:15], s39 offen offset:512 sc1
buffer_load_dwordx2 v[92:93], v112, s[12:15], s39 offen offset:1024 sc1
s_add_u32 s36, s36, 1
s_cmp_gt_u32 s36, 0x100000
s_cbranch_scc1 chain_kernel_wend
s_waitcnt vmcnt(0)
v_xor_b32 v124, s7, v88
v_bitop3_b32 v124, v124, v89, s7 bitop3:0xf6
v_bitop3_b32 v124, v124, v90, s7 bitop3:0xf6
v_bitop3_b32 v124, v124, v91, s7 bitop3:0xf6
v_bitop3_b32 v124, v124, v92, s7 bitop3:0xf6
v_bitop3_b32 v124, v124, v93, s7 bitop3:0xf6
v_and_b32 v124, 1, v124
v_cmp_ne_u32 vcc, 0, v124
s_cbranch_vccnz L_rbad_543
s_branch L_rok_544
L_fl0_525:
s_waitcnt lgkmcnt(0)
s_nop 7
s_sub_u32 s38, s22, 1
s_and_b32 s31, s38, 3
s_lshl_b32 s31, s31, 11
s_bfe_u32 s38, s38, 0x10002
s_xor_b32 s38, s38, 1
s_cmp_eq_u32 s37, 0
s_cselect_b32 s31, 0x40000000, s31
s_cselect_b32 s38, 0, s38
v_cvt_pk_bf16_f32 v104, v53, v57
v_cvt_pk_bf16_f32 v105, v61, v65
v_and_or_b32 v104, v104, -2, s38
v_and_or_b32 v105, v105, -2, s38
s_add_u32 s29, s45, s31
buffer_store_dwordx2 v[104:105], v112, s[12:15], s29 offen offset:0 sc1
v_cvt_pk_bf16_f32 v106, v54, v58
v_cvt_pk_bf16_f32 v107, v62, v66
v_and_or_b32 v106, v106, -2, s38
v_and_or_b32 v107, v107, -2, s38
s_add_u32 s29, s46, s31
buffer_store_dwordx2 v[106:107], v112, s[12:15], s29 offen offset:512 sc1
v_cvt_pk_bf16_f32 v108, v55, v59
v_cvt_pk_bf16_f32 v109, v63, v67
v_and_or_b32 v108, v108, -2, s38
v_and_or_b32 v109, v109, -2, s38
s_add_u32 s29, s47, s31
buffer_store_dwordx2 v[108:109], v112, s[12:15], s29 offen offset:1024 sc1
s_waitcnt vmcnt(0)
v_xor_b32 v124, s7, v88
v_bitop3_b32 v124, v124, v89, s7 bitop3:0xf6
v_bitop3_b32 v124, v124, v90, s7 bitop3:0xf6
v_bitop3_b32 v124, v124, v91, s7 bitop3:0xf6
v_bitop3_b32 v124, v124, v92, s7 bitop3:0xf6
v_bitop3_b32 v124, v124, v93, s7 bitop3:0xf6
v_and_b32 v124, 1, v124
v_cmp_ne_u32 vcc, 0, v124
s_nop 0
s_nop 0
s_nop 0
s_cbranch_vccnz L_rbad_545
L_rok_546:
v_lshlrev_b32 v124, 16, v88
v_and_b32 v125, 0xffff0000, v88
v_and_b32 v124, 0xfffe0000, v124
v_add_f32 v96, v116, v124
v_add_f32 v97, v117, v125
v_lshlrev_b32 v124, 16, v89
v_and_b32 v125, 0xffff0000, v89
v_and_b32 v124, 0xfffe0000, v124
v_add_f32 v98, v118, v124
v_add_f32 v99, v119, v125
v_lshlrev_b32 v124, 16, v90
v_and_b32 v125, 0xffff0000, v90
v_and_b32 v124, 0xfffe0000, v124
v_add_f32 v96, v96, v124
v_add_f32 v97, v97, v125
v_lshlrev_b32 v124, 16, v91
v_and_b32 v125, 0xffff0000, v91
v_and_b32 v124, 0xfffe0000, v124
v_add_f32 v98, v98, v124
v_add_f32 v99, v99, v125
v_lshlrev_b32 v124, 16, v92
v_and_b32 v125, 0xffff0000, v92
v_and_b32 v124, 0xfffe0000, v124
v_add_f32 v96, v96, v124
v_add_f32 v97, v97, v125
v_lshlrev_b32 v124, 16, v93
v_and_b32 v125, 0xffff0000, v93
v_and_b32 v124, 0xfffe0000, v124
v_add_f32 v98, v98, v124
v_add_f32 v99, v99, v125
ds_write2_b32 v114, v96, v97 offset0:0 offset1:16
ds_write2_b32 v114, v98, v99 offset0:128 offset1:144
ds_read_b128 v[88:91], v113 offset:0
s_waitcnt lgkmcnt(0)
v_cvt_pk_bf16_f32 v96, 0, v88
v_cvt_pk_bf16_f32 v97, 0, v89
v_cvt_pk_bf16_f32 v98, 0, v90
v_cvt_pk_bf16_f32 v99, 0, v91
buffer_store_dwordx4 v[96:99], v128, s[16:19], s43 offen
v_mov_b32 v116, v52
v_mov_b32 v117, v56
v_mov_b32 v118, v60
v_mov_b32 v119, v64
s_mov_b32 s7, s38
s_add_u32 s39, s44, s31
s_sub_u32 s43, s22, 1
s_and_b32 s43, s43, 63
v_readlane_b32 s43, v129, s43
s_nop 0
s_nop 0
s_sub_u32 s43, s43, 1
s_lshl_b32 s43, s43, 18
s_cmp_eq_u32 s37, 0
s_cselect_b32 s43, 0x7ff00000, s43
buffer_load_dwordx2 v[88:89], v112, s[12:15], s39 offen offset:0 sc1
buffer_load_dwordx2 v[90:91], v112, s[12:15], s39 offen offset:512 sc1
buffer_load_dwordx2 v[92:93], v112, s[12:15], s39 offen offset:1024 sc1
s_mov_b32 s37, 1
s_waitcnt vmcnt(0)
v_xor_b32 v124, s7, v88
v_bitop3_b32 v124, v124, v89, s7 bitop3:0xf6
v_bitop3_b32 v124, v124, v90, s7 bitop3:0xf6
v_bitop3_b32 v124, v124, v91, s7 bitop3:0xf6
v_bitop3_b32 v124, v124, v92, s7 bitop3:0xf6
v_bitop3_b32 v124, v124, v93, s7 bitop3:0xf6
v_and_b32 v124, 1, v124
v_cmp_ne_u32 vcc, 0, v124
s_nop 0
s_nop 0
s_nop 0
s_cbranch_vccnz L_rbad_547
L_rok_548:
v_lshlrev_b32 v124, 16, v88
v_and_b32 v125, 0xffff0000, v88
v_and_b32 v124, 0xfffe0000, v124
v_add_f32 v96, v116, v124
v_add_f32 v97, v117, v125
v_lshlrev_b32 v124, 16, v89
v_and_b32 v125, 0xffff0000, v89
v_and_b32 v124, 0xfffe0000, v124
v_add_f32 v98, v118, v124
v_add_f32 v99, v119, v125
v_lshlrev_b32 v124, 16, v90
v_and_b32 v125, 0xffff0000, v90
v_and_b32 v124, 0xfffe0000, v124
v_add_f32 v96, v96, v124
v_add_f32 v97, v97, v125
v_lshlrev_b32 v124, 16, v91
v_and_b32 v125, 0xffff0000, v91
v_and_b32 v124, 0xfffe0000, v124
v_add_f32 v98, v98, v124
v_add_f32 v99, v99, v125
v_lshlrev_b32 v124, 16, v92
v_and_b32 v125, 0xffff0000, v92
v_and_b32 v124, 0xfffe0000, v124
v_add_f32 v96, v96, v124
v_add_f32 v97, v97, v125
v_lshlrev_b32 v124, 16, v93
v_and_b32 v125, 0xffff0000, v93
v_and_b32 v124, 0xfffe0000, v124
v_add_f32 v98, v98, v124
v_add_f32 v99, v99, v125
ds_write2_b32 v114, v96, v97 offset0:0 offset1:16
ds_write2_b32 v114, v98, v99 offset0:128 offset1:144
ds_read_b128 v[88:91], v113 offset:0
s_waitcnt lgkmcnt(0)
v_cvt_pk_bf16_f32 v96, 0, v88
v_cvt_pk_bf16_f32 v97, 0, v89
v_cvt_pk_bf16_f32 v98, 0, v90
v_cvt_pk_bf16_f32 v99, 0, v91
buffer_store_dwordx4 v[96:99], v128, s[16:19], s43 offen
s_branch L_ste_527
L_rbad_545:
buffer_load_dwordx2 v[88:89], v112, s[12:15], s39 offen offset:0 sc1
buffer_load_dwordx2 v[90:91], v112, s[12:15], s39 offen offset:512 sc1
buffer_load_dwordx2 v[92:93], v112, s[12:15], s39 offen offset:1024 sc1
s_add_u32 s36, s36, 1
s_cmp_gt_u32 s36, 0x100000
s_cbranch_scc1 chain_kernel_wend
s_waitcnt vmcnt(0)
v_xor_b32 v124, s7, v88
v_bitop3_b32 v124, v124, v89, s7 bitop3:0xf6
v_bitop3_b32 v124, v124, v90, s7 bitop3:0xf6
v_bitop3_b32 v124, v124, v91, s7 bitop3:0xf6
v_bitop3_b32 v124, v124, v92, s7 bitop3:0xf6
v_bitop3_b32 v124, v124, v93, s7 bitop3:0xf6
v_and_b32 v124, 1, v124
v_cmp_ne_u32 vcc, 0, v124
s_cbranch_vccnz L_rbad_545
s_branch L_rok_546
L_rbad_547:
buffer_load_dwordx2 v[88:89], v112, s[12:15], s39 offen offset:0 sc1
buffer_load_dwordx2 v[90:91], v112, s[12:15], s39 offen offset:512 sc1
buffer_load_dwordx2 v[92:93], v112, s[12:15], s39 offen offset:1024 sc1
s_add_u32 s36, s36, 1
s_cmp_gt_u32 s36, 0x100000
s_cbranch_scc1 chain_kernel_wend
s_waitcnt vmcnt(0)
v_xor_b32 v124, s7, v88
v_bitop3_b32 v124, v124, v89, s7 bitop3:0xf6
v_bitop3_b32 v124, v124, v90, s7 bitop3:0xf6
v_bitop3_b32 v124, v124, v91, s7 bitop3:0xf6
v_bitop3_b32 v124, v124, v92, s7 bitop3:0xf6
v_bitop3_b32 v124, v124, v93, s7 bitop3:0xf6
v_and_b32 v124, 1, v124
v_cmp_ne_u32 vcc, 0, v124
s_cbranch_vccnz L_rbad_547
s_branch L_rok_548
L_ste_527:
L_opdone_518:
chain_kernel_wend:
chain_kernel_end:
s_endpgm
.section .rodata,"a"
.p2align 6
.amdhsa_kernel chain_kernel
  .amdhsa_next_free_vgpr 512
  .amdhsa_next_free_sgpr 102
  .amdhsa_accum_offset 256
  .amdhsa_group_segment_fixed_size 0
  .amdhsa_kernarg_size 152
  .amdhsa_user_sgpr_count 2
  .amdhsa_user_sgpr_kernarg_segment_ptr 1
  .amdhsa_system_sgpr_workgroup_id_x 1
  .amdhsa_float_denorm_mode_32 3
  .amdhsa_float_denorm_mode_16_64 3
.end_amdhsa_kernel
```
